```python
import torch

def _softmax(x, axis=-1):
    return torch.softmax(x, dim=axis)
def _gelu(x):
    return torch.nn.functional.gelu(x, approximate="tanh")
def _silu(x):
    return torch.nn.functional.silu(x)
def _sigmoid(x):
    return torch.sigmoid(x)
def _layernorm(x, axis=-1, eps=1e-5):
    m = x.mean(dim=axis, keepdim=True)
    v = x.var(dim=axis, keepdim=True, unbiased=False)
    return (x - m) / torch.sqrt(v + eps)
def _scatter_add(tgt, idx, src, axis=0):
    return tgt.clone().index_add_(axis, idx, src)
def _segment_sum(src, seg, n):
    out = torch.zeros((n,) + src.shape[1:], dtype=src.dtype)
    return out.index_add_(0, seg, src)
def _pad(x, pw):
    flat = tuple(v for pair in reversed(pw) for v in pair)
    return torch.nn.functional.pad(x, flat)

kernel_name = 'gated_mix__linear_kernel_hedgehog__moe_arch_mod__prompt'

def setup_inputs():

    _w = (lambda a: (lambda t: t.to(torch.bfloat16) if t.is_floating_point() else t)(torch.as_tensor(a)))
    def _A_setup():
        B, S, D, H = 1, 2048, 1024, 32
        Dh = D // H
        return {
            "x": _w((lambda *s: torch.randn(*s, dtype=torch.bfloat16) * 0.05)(B, S, D)),
            "wqkv": _w((lambda *s: torch.randn(*s, dtype=torch.bfloat16) * 1.6)(D, 3 * D)),
            "w_phi": _w((lambda *s: torch.randn(*s, dtype=torch.bfloat16) * 1.6)(H, Dh, Dh) * (Dh ** -0.5)),
            "wo": _w((lambda *s: torch.randn(*s, dtype=torch.bfloat16) * 1.6)(D, D)),
        }
    _A_in = _A_setup()

    def _B_setup():
        B, S, D, F, C = 1, 2048, 1024, 3584, 1
        return {
            "x": _w((lambda *s: torch.randn(*s, dtype=torch.bfloat16) * 0.05)(B, S, D)),
            "w_r": _w((lambda *s: torch.randn(*s, dtype=torch.bfloat16) * 1.6)(D)),
            "w_gate": _w((lambda *s: torch.randn(*s, dtype=torch.bfloat16) * 0.8)(D, F)),
            "w_up": _w((lambda *s: torch.randn(*s, dtype=torch.bfloat16) * 0.8)(D, F)),
            "w_down": _w((lambda *s: torch.randn(*s, dtype=torch.bfloat16) * 0.8)(F, D)),
        }
    _B_in = _B_setup()

    return {
        "A_x": _A_in["x"],
        "A_wqkv": _A_in["wqkv"],
        "A_w_phi": _A_in["w_phi"],
        "A_wo": _A_in["wo"],
        "B_x": _B_in["x"],
        "B_w_r": _B_in["w_r"],
        "B_w_gate": _B_in["w_gate"],
        "B_w_up": _B_in["w_up"],
        "B_w_down": _B_in["w_down"],
        "gate_w": _w((lambda *s: torch.randn(*s, dtype=torch.bfloat16) * 0.05)(1024) * 16.0),
    }

def reference(A_x, A_wqkv, A_w_phi, A_wo, B_x, B_w_r, B_w_gate, B_w_up, B_w_down, gate_w):
    def _A_ref(x, wqkv, w_phi, wo):
        B, S, D = x.shape
        H = 32; Dh = D // H
        qkv = (lambda x, *d: x.permute(*d))((x @ wqkv).reshape(B, S, 3, H, Dh), 2, 0, 3, 1, 4)
        q, k, v = qkv[0], qkv[1], qkv[2]
        pq = torch.einsum("bhsd,hdf->bhsf", q, w_phi)
        pk = torch.einsum("bhsd,hdf->bhsf", k, w_phi)
        phi_q = torch.concatenate([_softmax(pq, axis=-1), _softmax(-pq, axis=-1)], axis=-1)
        phi_k = torch.concatenate([_softmax(pk, axis=-1), _softmax(-pk, axis=-1)], axis=-1)
        kv = torch.einsum("bhsf,bhsd->bhfd", phi_k, v)
        z  = torch.einsum("bhsf->bhf", phi_k)
        num = torch.einsum("bhqf,bhfd->bhqd", phi_q, kv)
        den = torch.einsum("bhqf,bhf->bhq", phi_q, z)[..., None] + 1e-6
        o = num / den
        return (lambda x, *d: x.permute(*d))(o, 0, 2, 1, 3).reshape(B, S, D) @ wo

    def _B_ref(x, w_r, w_gate, w_up, w_down):
        B, S, D = x.shape
        C = 1
        r = x @ w_r
        idx = torch.argsort(-r, axis=-1)[:, :C]
        idx_e = (lambda x, n, axis: torch.repeat_interleave(x, n, dim=axis))(idx.reshape(B, C, 1), D, axis=2)
        x_sel = (lambda x, i, axis: torch.take_along_dim(x, i, dim=axis))(x, idx_e, axis=1)
        g = _silu(x_sel @ w_gate)
        u = x_sel @ w_up
        y = (g * u) @ w_down
        r_sel = _sigmoid((lambda x, i, axis: torch.take_along_dim(x, i, dim=axis))(r, idx, axis=1))
        y = y * r_sel.reshape(B, C, 1)
        b_off = (torch.arange(B) * S).reshape(B, 1)
        flat_idx = (idx + b_off).reshape(B * C)
        zero = (x * 0.0).reshape(B * S, D)
        upd = _scatter_add(zero, flat_idx, y.reshape(B * C, D), axis=0)
        return x + upd.reshape(B, S, D)

    x = A_x
    g = _sigmoid((x * gate_w).sum(-1, keepdims=True))
    a = _A_ref(x, A_wqkv, A_w_phi, A_wo)
    b = _B_ref(x, B_w_r, B_w_gate, B_w_up, B_w_down)
    return g * a + (1 - g) * b
```

```asm
; @launch grid=(256,1,1) block=(512,1,1) lds=163840
.amdgcn_target "amdgcn-amd-amdhsa--gfx950"
.text
.globl gated_mix__linear_kernel_hedgehog__moe_arch_mod__prompt_kernel
.p2align 8
.type gated_mix__linear_kernel_hedgehog__moe_arch_mod__prompt_kernel,@function
gated_mix__linear_kernel_hedgehog__moe_arch_mod__prompt_kernel:
    s_cmp_ge_u32 s2, 256
    s_cbranch_scc1 L_end
    s_load_dwordx4 s[4:7], s[0:1], 0
    s_load_dwordx4 s[8:11], s[0:1], 16
    s_load_dwordx16 s[48:63], s[0:1], 40
    v_lshrrev_b32 v1, 6, v0
    v_and_b32 v2, 63, v0
    v_readfirstlane_b32 s20, v1
    s_and_b32 s16, s2, 7
    s_lshr_b32 s17, s2, 3
    s_and_b32 s18, s16, 1
    s_lshl_b32 s18, s18, 3
    s_and_b32 s19, s17, 7
    s_add_u32 s18, s18, s19
    s_lshr_b32 s19, s16, 1
    s_lshl_b32 s19, s19, 2
    s_lshr_b32 s12, s17, 3
    s_add_u32 s19, s19, s12
    v_lshlrev_b32 v5, 4, v2
    s_cmp_lt_u32 s20, 4
    s_cbranch_scc1 L_compute
    s_sub_u32 s21, s20, 4
    s_mov_b32 s68, 0x76543210
    s_mov_b32 s69, 0xfedcba98
    s_lshl_b32 s12, s16, 1
    s_mul_i32 s12, s12, 0x11111111
    s_xor_b32 s68, s68, s12
    s_xor_b32 s69, s69, s12
    v_lshrrev_b32 v4, 3, v2
    v_lshlrev_b32 v9, 11, v4
    v_and_b32 v6, 7, v2
    v_lshrrev_b32 v7, 4, v2
    v_xor_b32 v8, v6, v7
    v_lshl_add_u32 v10, v8, 4, v9
    v_xor_b32 v8, 4, v8
    v_lshl_add_u32 v11, v8, 4, v9
    v_mul_u32_u24 v12, 6144, v4
    v_and_b32 v7, 1, v7
    v_lshlrev_b32 v7, 2, v7
    v_xor_b32 v8, v6, v7
    v_lshl_add_u32 v12, v8, 4, v12
    s_lshl_b32 s12, s18, 18
    s_lshl_b32 s13, s21, 16
    s_add_u32 s12, s12, s13
    s_add_u32 s13, s12, 0
    v_add_u32 v20, s13, v10
    s_add_u32 s13, s12, 15360
    v_add_u32 v21, s13, v11
    s_add_u32 s13, s12, 30720
    v_add_u32 v22, s13, v10
    s_add_u32 s13, s12, 46080
    v_add_u32 v23, s13, v11
    s_lshl_b32 s12, s19, 7
    s_mul_i32 s14, s21, 6
    s_add_u32 s13, s14, 0
    s_and_b32 s15, s13, 7
    s_mul_i32 s15, s15, 49152
    s_lshr_b32 s13, s13, 3
    s_lshl_b32 s13, s13, 11
    s_add_u32 s13, s13, s15
    s_add_u32 s13, s13, s12
    s_sub_u32 s13, s13, 0
    v_add_u32 v24, s13, v12
    s_add_u32 s13, s14, 1
    s_and_b32 s15, s13, 7
    s_mul_i32 s15, s15, 49152
    s_lshr_b32 s13, s13, 3
    s_lshl_b32 s13, s13, 11
    s_add_u32 s13, s13, s15
    s_add_u32 s13, s13, s12
    s_sub_u32 s13, s13, 1024
    v_add_u32 v25, s13, v12
    s_add_u32 s13, s14, 2
    s_and_b32 s15, s13, 7
    s_mul_i32 s15, s15, 49152
    s_lshr_b32 s13, s13, 3
    s_lshl_b32 s13, s13, 11
    s_add_u32 s13, s13, s15
    s_add_u32 s13, s13, s12
    s_sub_u32 s13, s13, 2048
    v_add_u32 v26, s13, v12
    s_add_u32 s13, s14, 3
    s_and_b32 s15, s13, 7
    s_mul_i32 s15, s15, 49152
    s_lshr_b32 s13, s13, 3
    s_lshl_b32 s13, s13, 11
    s_add_u32 s13, s13, s15
    s_add_u32 s13, s13, s12
    s_sub_u32 s13, s13, 0
    v_add_u32 v27, s13, v12
    s_add_u32 s13, s14, 4
    s_and_b32 s15, s13, 7
    s_mul_i32 s15, s15, 49152
    s_lshr_b32 s13, s13, 3
    s_lshl_b32 s13, s13, 11
    s_add_u32 s13, s13, s15
    s_add_u32 s13, s13, s12
    s_sub_u32 s13, s13, 1024
    v_add_u32 v28, s13, v12
    s_add_u32 s13, s14, 5
    s_and_b32 s15, s13, 7
    s_mul_i32 s15, s15, 49152
    s_lshr_b32 s13, s13, 3
    s_lshl_b32 s13, s13, 11
    s_add_u32 s13, s13, s15
    s_add_u32 s13, s13, s12
    s_sub_u32 s13, s13, 2048
    v_add_u32 v29, s13, v12
    s_lshl_b32 s94, s21, 12
    s_mul_i32 s95, s21, 6144
    s_add_u32 s95, s95, 16384
    s_waitcnt lgkmcnt(0)
    s_mov_b32 s24, s4
    s_and_b32 s25, s5, 0xffff
    s_mov_b32 s26, 4194304
    s_mov_b32 s27, 0x00020000
    s_mov_b32 s28, s6
    s_and_b32 s29, s7, 0xffff
    s_mov_b32 s30, 6291456
    s_mov_b32 s31, 0x00020000
    s_bfe_u32 s91, s68, 0x40000
    s_lshl_b32 s92, s91, 7
    s_mul_i32 s93, s91, 393216
    s_add_u32 m0, s94, 0
    s_nop 0
    buffer_load_dwordx4 v20, s[24:27], s92 offen offset:0 lds
    buffer_load_dwordx4 v21, s[24:27], s92 offen offset:1024 lds
    buffer_load_dwordx4 v22, s[24:27], s92 offen offset:2048 lds
    buffer_load_dwordx4 v23, s[24:27], s92 offen offset:3072 lds
    s_add_u32 m0, s95, 0
    s_nop 0
    buffer_load_dwordx4 v24, s[28:31], s93 offen offset:0 lds
    buffer_load_dwordx4 v25, s[28:31], s93 offen offset:1024 lds
    buffer_load_dwordx4 v26, s[28:31], s93 offen offset:2048 lds
    s_add_u32 m0, s95, 3072
    s_nop 0
    buffer_load_dwordx4 v27, s[28:31], s93 offen offset:0 lds
    buffer_load_dwordx4 v28, s[28:31], s93 offen offset:1024 lds
    buffer_load_dwordx4 v29, s[28:31], s93 offen offset:2048 lds
    s_bfe_u32 s91, s68, 0x40004
    s_lshl_b32 s92, s91, 7
    s_mul_i32 s93, s91, 393216
    s_add_u32 m0, s94, 40960
    s_nop 0
    buffer_load_dwordx4 v20, s[24:27], s92 offen offset:0 lds
    buffer_load_dwordx4 v21, s[24:27], s92 offen offset:1024 lds
    buffer_load_dwordx4 v22, s[24:27], s92 offen offset:2048 lds
    buffer_load_dwordx4 v23, s[24:27], s92 offen offset:3072 lds
    s_add_u32 m0, s95, 40960
    s_nop 0
    buffer_load_dwordx4 v24, s[28:31], s93 offen offset:0 lds
    buffer_load_dwordx4 v25, s[28:31], s93 offen offset:1024 lds
    s_mov_b32 s32, s62
    s_and_b32 s33, s63, 0xffff
    s_mov_b32 s34, 33554432
    s_mov_b32 s35, 0x00020000
    s_mov_b32 s36, s10
    s_and_b32 s37, s11, 0xffff
    s_mov_b32 s38, 2097152
    s_mov_b32 s39, 0x00020000
    s_mov_b32 s40, s50
    s_and_b32 s41, s51, 0xffff
    s_mov_b32 s42, 7340032
    s_mov_b32 s43, 0x00020000
    s_mov_b32 s44, s52
    s_and_b32 s45, s53, 0xffff
    s_mov_b32 s46, 7340032
    s_mov_b32 s47, 0x00020000
    s_mov_b32 s64, s54
    s_and_b32 s65, s55, 0xffff
    s_mov_b32 s66, 7340032
    s_mov_b32 s67, 0x00020000
    s_mov_b32 s72, s60
    s_and_b32 s73, s61, 0xffff
    s_mov_b32 s74, 256
    s_mov_b32 s75, 0x00020000
    s_mov_b32 s76, s8
    s_and_b32 s77, s9, 0xffff
    s_mov_b32 s78, 65536
    s_mov_b32 s79, 0x00020000
    s_mov_b32 s80, s48
    s_and_b32 s81, s49, 0xffff
    s_mov_b32 s82, 2048
    s_mov_b32 s83, 0x00020000
    s_mov_b32 s84, s56
    s_and_b32 s85, s57, 0xffff
    s_mov_b32 s86, 2048
    s_mov_b32 s87, 0x00020000
    s_cmp_lt_u32 s2, 224
    s_cselect_b32 s42, s42, 0
    s_cselect_b32 s46, s46, 0
    s_and_b32 s88, s16, 1
    s_lshl_b32 s88, s88, 1
    s_bfe_u32 s89, s16, 0x10001
    s_add_u32 s88, s88, s89
    s_lshl_b32 s88, s88, 2
    s_and_b32 s89, s17, 3
    s_add_u32 s88, s88, s89
    s_lshr_b32 s89, s16, 2
    s_lshl_b32 s89, s89, 3
    s_lshr_b32 s90, s17, 2
    s_add_u32 s89, s89, s90
    v_mov_b32 v13, 0
    v_mul_u32_u24 v30, 57344, v4
    v_lshl_add_u32 v30, v6, 4, v30
    v_lshl_add_u32 v31, v6, 4, v9
    v_lshl_add_u32 v32, v8, 4, v9
    s_lshl_b32 s12, s89, 7
    v_add_u32 v32, s12, v32
    v_lshlrev_b32 v34, 4, v4
    s_and_b32 s12, s2, 3
    s_lshl_b32 s12, s12, 8
    s_lshl_b32 s13, s21, 6
    s_add_u32 s70, s12, s13
    s_mul_i32 s71, s70, 7168
    s_lshr_b32 s12, s2, 2
    s_lshl_b32 s12, s12, 7
    s_add_u32 s71, s71, s12
    s_and_b32 s12, s2, 15
    s_mul_i32 s12, s12, 224
    s_mul_i32 s13, s21, 56
    s_add_u32 s96, s12, s13
    s_lshl_b32 s97, s96, 11
    s_lshr_b32 s12, s2, 4
    s_lshl_b32 s12, s12, 7
    s_add_u32 s97, s97, s12
    s_lshl_b32 s22, s18, 7
    s_lshl_b32 s12, s19, 3
    s_add_u32 s22, s22, s12
    s_lshl_b32 s12, s21, 1
    s_add_u32 s22, s22, s12
    s_waitcnt vmcnt(6)
    s_barrier
    s_add_u32 m0, s95, 40960
    s_nop 0
    buffer_load_dwordx4 v26, s[28:31], s93 offen offset:2048 lds
    s_add_u32 m0, s95, 44032
    s_nop 0
    buffer_load_dwordx4 v27, s[28:31], s93 offen offset:0 lds
    buffer_load_dwordx4 v28, s[28:31], s93 offen offset:1024 lds
    buffer_load_dwordx4 v29, s[28:31], s93 offen offset:2048 lds
    s_bfe_u32 s91, s68, 0x40008
    s_lshl_b32 s92, s91, 7
    s_mul_i32 s93, s91, 393216
    s_add_u32 m0, s94, 81920
    s_nop 0
    buffer_load_dwordx4 v20, s[24:27], s92 offen offset:0 lds
    buffer_load_dwordx4 v21, s[24:27], s92 offen offset:1024 lds
    buffer_load_dwordx4 v22, s[24:27], s92 offen offset:2048 lds
    buffer_load_dwordx4 v23, s[24:27], s92 offen offset:3072 lds
    s_add_u32 m0, s95, 81920
    s_nop 0
    buffer_load_dwordx4 v24, s[28:31], s93 offen offset:0 lds
    buffer_load_dwordx4 v25, s[28:31], s93 offen offset:1024 lds
    buffer_load_dwordx4 v26, s[28:31], s93 offen offset:2048 lds
    s_add_u32 m0, s95, 84992
    s_nop 0
    buffer_load_dwordx4 v27, s[28:31], s93 offen offset:0 lds
    buffer_load_dwordx4 v28, s[28:31], s93 offen offset:1024 lds
    buffer_load_dwordx4 v29, s[28:31], s93 offen offset:2048 lds
    s_lshl_b32 s12, s19, 2
    s_add_u32 s12, s12, s21
    s_lshl_b32 s12, s12, 10
    s_lshl_b32 s13, s21, 10
    s_add_u32 m0, s13, 155648
    s_nop 0
    buffer_load_dwordx4 v5, s[76:79], s12 offen lds
    s_lshl_b32 s12, s22, 11
    buffer_load_dwordx4 v[40:43], v5, s[24:27], s12 offen offset:0
    buffer_load_dwordx4 v[44:47], v5, s[24:27], s12 offen offset:1024
    buffer_load_dwordx4 v[48:51], v5, s[24:27], s12 offen offset:2048
    buffer_load_dwordx4 v[52:55], v5, s[24:27], s12 offen offset:3072
    buffer_load_dwordx4 v[56:59], v5, s[80:83], 0 offen offset:0
    buffer_load_dwordx4 v[60:63], v5, s[80:83], 0 offen offset:1024
    buffer_load_dwordx4 v[64:67], v5, s[84:87], 0 offen offset:0
    buffer_load_dwordx4 v[68:71], v5, s[84:87], 0 offen offset:1024
    s_waitcnt vmcnt(19)
    s_barrier
    s_bfe_u32 s91, s68, 0x4000c
    s_lshl_b32 s92, s91, 7
    s_mul_i32 s93, s91, 393216
    s_add_u32 m0, s94, 0
    s_nop 0
    buffer_load_dwordx4 v20, s[24:27], s92 offen offset:0 lds
    buffer_load_dwordx4 v21, s[24:27], s92 offen offset:1024 lds
    buffer_load_dwordx4 v22, s[24:27], s92 offen offset:2048 lds
    buffer_load_dwordx4 v23, s[24:27], s92 offen offset:3072 lds
    s_add_u32 m0, s95, 0
    s_nop 0
    buffer_load_dwordx4 v24, s[28:31], s93 offen offset:0 lds
    buffer_load_dwordx4 v25, s[28:31], s93 offen offset:1024 lds
    buffer_load_dwordx4 v26, s[28:31], s93 offen offset:2048 lds
    s_add_u32 m0, s95, 3072
    s_nop 0
    buffer_load_dwordx4 v27, s[28:31], s93 offen offset:0 lds
    buffer_load_dwordx4 v28, s[28:31], s93 offen offset:1024 lds
    buffer_load_dwordx4 v29, s[28:31], s93 offen offset:2048 lds
    s_cmp_lg_u32 s21, 0
    s_cbranch_scc1 L_noclr
    v_mov_b32 v104, -1
    v_mov_b32 v105, -1
    v_mov_b32 v106, -1
    v_mov_b32 v107, -1
    s_lshl_b32 s12, s19, 13
    s_lshl_b32 s13, s18, 9
    s_add_u32 s12, s12, s13
    s_add_u32 s12, s12, 32768
    s_lshl_b32 s13, s19, 8
    s_lshl_b32 s90, s18, 4
    s_add_u32 s13, s13, s90
    s_add_u32 s13, s13, 163840
    s_mov_b32 exec_hi, 0
    buffer_store_dwordx4 v[104:107], v5, s[32:35], s12 offen sc1
    s_mov_b32 exec_lo, 1
    buffer_store_dwordx4 v[104:107], v13, s[32:35], s13 offen sc1
    s_mov_b64 exec, -1
L_noclr:
    s_add_u32 s12, s71, 0
    buffer_load_dwordx4 v[128:131], v30, s[40:43], s12 offen nt
    s_add_u32 s12, s71, 7168
    buffer_load_dwordx4 v[132:135], v30, s[40:43], s12 offen nt
    s_add_u32 s12, s71, 14336
    buffer_load_dwordx4 v[136:139], v30, s[40:43], s12 offen nt
    s_add_u32 s12, s71, 21504
    buffer_load_dwordx4 v[140:143], v30, s[40:43], s12 offen nt
    s_add_u32 s12, s71, 28672
    buffer_load_dwordx4 v[144:147], v30, s[40:43], s12 offen nt
    s_add_u32 s12, s71, 35840
    buffer_load_dwordx4 v[148:151], v30, s[40:43], s12 offen nt
    s_add_u32 s12, s71, 43008
    buffer_load_dwordx4 v[152:155], v30, s[40:43], s12 offen nt
    s_add_u32 s12, s71, 50176
    buffer_load_dwordx4 v[156:159], v30, s[40:43], s12 offen nt
    s_waitcnt vmcnt(27)
    s_barrier
    s_bfe_u32 s91, s68, 0x40010
    s_lshl_b32 s92, s91, 7
    s_mul_i32 s93, s91, 393216
    s_add_u32 m0, s94, 40960
    s_nop 0
    buffer_load_dwordx4 v20, s[24:27], s92 offen offset:0 lds
    buffer_load_dwordx4 v21, s[24:27], s92 offen offset:1024 lds
    buffer_load_dwordx4 v22, s[24:27], s92 offen offset:2048 lds
    buffer_load_dwordx4 v23, s[24:27], s92 offen offset:3072 lds
    s_add_u32 m0, s95, 40960
    s_nop 0
    buffer_load_dwordx4 v24, s[28:31], s93 offen offset:0 lds
    buffer_load_dwordx4 v25, s[28:31], s93 offen offset:1024 lds
    buffer_load_dwordx4 v26, s[28:31], s93 offen offset:2048 lds
    s_add_u32 m0, s95, 44032
    s_nop 0
    buffer_load_dwordx4 v27, s[28:31], s93 offen offset:0 lds
    buffer_load_dwordx4 v28, s[28:31], s93 offen offset:1024 lds
    buffer_load_dwordx4 v29, s[28:31], s93 offen offset:2048 lds
    s_waitcnt vmcnt(28)
    v_lshlrev_b32 v72, 16, v64
    v_and_b32 v73, 0xffff0000, v64
    v_lshlrev_b32 v74, 16, v65
    v_and_b32 v75, 0xffff0000, v65
    v_lshlrev_b32 v76, 16, v66
    v_and_b32 v77, 0xffff0000, v66
    v_lshlrev_b32 v78, 16, v67
    v_and_b32 v79, 0xffff0000, v67
    v_lshlrev_b32 v80, 16, v68
    v_and_b32 v81, 0xffff0000, v68
    v_lshlrev_b32 v82, 16, v69
    v_and_b32 v83, 0xffff0000, v69
    v_lshlrev_b32 v84, 16, v70
    v_and_b32 v85, 0xffff0000, v70
    v_lshlrev_b32 v86, 16, v71
    v_and_b32 v87, 0xffff0000, v71
    v_mov_b32 v90, 0
    v_mov_b32 v91, 0
    v_dot2_f32_bf16 v90, v40, v56, v90
    v_lshlrev_b32 v94, 16, v40
    v_and_b32 v95, 0xffff0000, v40
    v_mul_f32 v94, v94, v72
    v_mul_f32 v95, v95, v73
    v_cvt_pk_bf16_f32 v94, v94, v95
    v_lshlrev_b32 v95, 16, v94
    v_and_b32 v94, 0xffff0000, v94
    v_add_f32 v91, v91, v95
    v_add_f32 v91, v91, v94
    v_dot2_f32_bf16 v90, v41, v57, v90
    v_lshlrev_b32 v94, 16, v41
    v_and_b32 v95, 0xffff0000, v41
    v_mul_f32 v94, v94, v74
    v_mul_f32 v95, v95, v75
    v_cvt_pk_bf16_f32 v94, v94, v95
    v_lshlrev_b32 v95, 16, v94
    v_and_b32 v94, 0xffff0000, v94
    v_add_f32 v91, v91, v95
    v_add_f32 v91, v91, v94
    v_dot2_f32_bf16 v90, v42, v58, v90
    v_lshlrev_b32 v94, 16, v42
    v_and_b32 v95, 0xffff0000, v42
    v_mul_f32 v94, v94, v76
    v_mul_f32 v95, v95, v77
    v_cvt_pk_bf16_f32 v94, v94, v95
    v_lshlrev_b32 v95, 16, v94
    v_and_b32 v94, 0xffff0000, v94
    v_add_f32 v91, v91, v95
    v_add_f32 v91, v91, v94
    v_dot2_f32_bf16 v90, v43, v59, v90
    v_lshlrev_b32 v94, 16, v43
    v_and_b32 v95, 0xffff0000, v43
    v_mul_f32 v94, v94, v78
    v_mul_f32 v95, v95, v79
    v_cvt_pk_bf16_f32 v94, v94, v95
    v_lshlrev_b32 v95, 16, v94
    v_and_b32 v94, 0xffff0000, v94
    v_add_f32 v91, v91, v95
    v_add_f32 v91, v91, v94
    v_dot2_f32_bf16 v90, v44, v60, v90
    v_lshlrev_b32 v94, 16, v44
    v_and_b32 v95, 0xffff0000, v44
    v_mul_f32 v94, v94, v80
    v_mul_f32 v95, v95, v81
    v_cvt_pk_bf16_f32 v94, v94, v95
    v_lshlrev_b32 v95, 16, v94
    v_and_b32 v94, 0xffff0000, v94
    v_add_f32 v91, v91, v95
    v_add_f32 v91, v91, v94
    v_dot2_f32_bf16 v90, v45, v61, v90
    v_lshlrev_b32 v94, 16, v45
    v_and_b32 v95, 0xffff0000, v45
    v_mul_f32 v94, v94, v82
    v_mul_f32 v95, v95, v83
    v_cvt_pk_bf16_f32 v94, v94, v95
    v_lshlrev_b32 v95, 16, v94
    v_and_b32 v94, 0xffff0000, v94
    v_add_f32 v91, v91, v95
    v_add_f32 v91, v91, v94
    v_dot2_f32_bf16 v90, v46, v62, v90
    v_lshlrev_b32 v94, 16, v46
    v_and_b32 v95, 0xffff0000, v46
    v_mul_f32 v94, v94, v84
    v_mul_f32 v95, v95, v85
    v_cvt_pk_bf16_f32 v94, v94, v95
    v_lshlrev_b32 v95, 16, v94
    v_and_b32 v94, 0xffff0000, v94
    v_add_f32 v91, v91, v95
    v_add_f32 v91, v91, v94
    v_dot2_f32_bf16 v90, v47, v63, v90
    v_lshlrev_b32 v94, 16, v47
    v_and_b32 v95, 0xffff0000, v47
    v_mul_f32 v94, v94, v86
    v_mul_f32 v95, v95, v87
    v_cvt_pk_bf16_f32 v94, v94, v95
    v_lshlrev_b32 v95, 16, v94
    v_and_b32 v94, 0xffff0000, v94
    v_add_f32 v91, v91, v95
    v_add_f32 v91, v91, v94
    v_mov_b32 v92, 0
    v_mov_b32 v93, 0
    v_dot2_f32_bf16 v92, v48, v56, v92
    v_lshlrev_b32 v94, 16, v48
    v_and_b32 v95, 0xffff0000, v48
    v_mul_f32 v94, v94, v72
    v_mul_f32 v95, v95, v73
    v_cvt_pk_bf16_f32 v94, v94, v95
    v_lshlrev_b32 v95, 16, v94
    v_and_b32 v94, 0xffff0000, v94
    v_add_f32 v93, v93, v95
    v_add_f32 v93, v93, v94
    v_dot2_f32_bf16 v92, v49, v57, v92
    v_lshlrev_b32 v94, 16, v49
    v_and_b32 v95, 0xffff0000, v49
    v_mul_f32 v94, v94, v74
    v_mul_f32 v95, v95, v75
    v_cvt_pk_bf16_f32 v94, v94, v95
    v_lshlrev_b32 v95, 16, v94
    v_and_b32 v94, 0xffff0000, v94
    v_add_f32 v93, v93, v95
    v_add_f32 v93, v93, v94
    v_dot2_f32_bf16 v92, v50, v58, v92
    buffer_load_dword v15, v13, s[72:75], 0 offen offset:4 sc1
    s_waitcnt vmcnt(19)
    s_barrier
    s_bfe_u32 s91, s68, 0x40014
    s_lshl_b32 s92, s91, 7
    s_mul_i32 s93, s91, 393216
    s_add_u32 m0, s94, 81920
    s_nop 0
    buffer_load_dwordx4 v20, s[24:27], s92 offen offset:0 lds
    buffer_load_dwordx4 v21, s[24:27], s92 offen offset:1024 lds
    buffer_load_dwordx4 v22, s[24:27], s92 offen offset:2048 lds
    buffer_load_dwordx4 v23, s[24:27], s92 offen offset:3072 lds
    s_add_u32 m0, s95, 81920
    s_nop 0
    buffer_load_dwordx4 v24, s[28:31], s93 offen offset:0 lds
    buffer_load_dwordx4 v25, s[28:31], s93 offen offset:1024 lds
    buffer_load_dwordx4 v26, s[28:31], s93 offen offset:2048 lds
    s_add_u32 m0, s95, 84992
    s_nop 0
    buffer_load_dwordx4 v27, s[28:31], s93 offen offset:0 lds
    buffer_load_dwordx4 v28, s[28:31], s93 offen offset:1024 lds
    buffer_load_dwordx4 v29, s[28:31], s93 offen offset:2048 lds
    v_lshlrev_b32 v94, 16, v50
    v_and_b32 v95, 0xffff0000, v50
    v_mul_f32 v94, v94, v76
    v_mul_f32 v95, v95, v77
    v_cvt_pk_bf16_f32 v94, v94, v95
    v_lshlrev_b32 v95, 16, v94
    v_and_b32 v94, 0xffff0000, v94
    v_add_f32 v93, v93, v95
    v_add_f32 v93, v93, v94
    v_dot2_f32_bf16 v92, v51, v59, v92
    v_lshlrev_b32 v94, 16, v51
    v_and_b32 v95, 0xffff0000, v51
    v_mul_f32 v94, v94, v78
    v_mul_f32 v95, v95, v79
    v_cvt_pk_bf16_f32 v94, v94, v95
    v_lshlrev_b32 v95, 16, v94
    v_and_b32 v94, 0xffff0000, v94
    v_add_f32 v93, v93, v95
    v_add_f32 v93, v93, v94
    v_dot2_f32_bf16 v92, v52, v60, v92
    v_lshlrev_b32 v94, 16, v52
    v_and_b32 v95, 0xffff0000, v52
    v_mul_f32 v94, v94, v80
    v_mul_f32 v95, v95, v81
    v_cvt_pk_bf16_f32 v94, v94, v95
    v_lshlrev_b32 v95, 16, v94
    v_and_b32 v94, 0xffff0000, v94
    v_add_f32 v93, v93, v95
    v_add_f32 v93, v93, v94
    v_dot2_f32_bf16 v92, v53, v61, v92
    v_lshlrev_b32 v94, 16, v53
    v_and_b32 v95, 0xffff0000, v53
    v_mul_f32 v94, v94, v82
    v_mul_f32 v95, v95, v83
    v_cvt_pk_bf16_f32 v94, v94, v95
    v_lshlrev_b32 v95, 16, v94
    v_and_b32 v94, 0xffff0000, v94
    v_add_f32 v93, v93, v95
    v_add_f32 v93, v93, v94
    v_dot2_f32_bf16 v92, v54, v62, v92
    v_lshlrev_b32 v94, 16, v54
    v_and_b32 v95, 0xffff0000, v54
    v_mul_f32 v94, v94, v84
    v_mul_f32 v95, v95, v85
    v_cvt_pk_bf16_f32 v94, v94, v95
    v_lshlrev_b32 v95, 16, v94
    v_and_b32 v94, 0xffff0000, v94
    v_add_f32 v93, v93, v95
    v_add_f32 v93, v93, v94
    v_dot2_f32_bf16 v92, v55, v63, v92
    v_lshlrev_b32 v94, 16, v55
    v_and_b32 v95, 0xffff0000, v55
    v_mul_f32 v94, v94, v86
    v_mul_f32 v95, v95, v87
    v_cvt_pk_bf16_f32 v94, v94, v95
    v_lshlrev_b32 v95, 16, v94
    v_and_b32 v94, 0xffff0000, v94
    v_add_f32 v93, v93, v95
    v_add_f32 v93, v93, v94
    v_add_f32_dpp v90, v90, v90 row_shr:1 row_mask:0xf bank_mask:0xf
    v_add_f32_dpp v91, v91, v91 row_shr:1 row_mask:0xf bank_mask:0xf
    v_add_f32_dpp v92, v92, v92 row_shr:1 row_mask:0xf bank_mask:0xf
    v_add_f32_dpp v93, v93, v93 row_shr:1 row_mask:0xf bank_mask:0xf
    v_add_f32_dpp v90, v90, v90 row_shr:2 row_mask:0xf bank_mask:0xf
    v_add_f32_dpp v91, v91, v91 row_shr:2 row_mask:0xf bank_mask:0xf
    v_add_f32_dpp v92, v92, v92 row_shr:2 row_mask:0xf bank_mask:0xf
    v_add_f32_dpp v93, v93, v93 row_shr:2 row_mask:0xf bank_mask:0xf
    v_add_f32_dpp v90, v90, v90 row_shr:4 row_mask:0xf bank_mask:0xf
    v_add_f32_dpp v91, v91, v91 row_shr:4 row_mask:0xf bank_mask:0xf
    v_add_f32_dpp v92, v92, v92 row_shr:4 row_mask:0xf bank_mask:0xf
    v_add_f32_dpp v93, v93, v93 row_shr:4 row_mask:0xf bank_mask:0xf
    v_add_f32_dpp v90, v90, v90 row_shr:8 row_mask:0xf bank_mask:0xf
    v_add_f32_dpp v91, v91, v91 row_shr:8 row_mask:0xf bank_mask:0xf
    v_add_f32_dpp v92, v92, v92 row_shr:8 row_mask:0xf bank_mask:0xf
    v_add_f32_dpp v93, v93, v93 row_shr:8 row_mask:0xf bank_mask:0xf
    v_add_f32_dpp v90, v90, v90 row_bcast:15 row_mask:0xa bank_mask:0xf
    v_add_f32_dpp v91, v91, v91 row_bcast:15 row_mask:0xa bank_mask:0xf
    v_add_f32_dpp v92, v92, v92 row_bcast:15 row_mask:0xa bank_mask:0xf
    v_add_f32_dpp v93, v93, v93 row_bcast:15 row_mask:0xa bank_mask:0xf
    v_add_f32_dpp v90, v90, v90 row_bcast:31 row_mask:0xc bank_mask:0xf
    v_add_f32_dpp v91, v91, v91 row_bcast:31 row_mask:0xc bank_mask:0xf
    v_add_f32_dpp v92, v92, v92 row_bcast:31 row_mask:0xc bank_mask:0xf
    v_add_f32_dpp v93, v93, v93 row_bcast:31 row_mask:0xc bank_mask:0xf
    v_cvt_pk_bf16_f32 v94, v90, v91
    v_and_b32 v95, 0xffff, v94
    v_and_b32 v96, 0x8000, v94
    v_cmp_ne_u32 vcc, 0, v96
    v_mov_b32 v97, 0x8000
    v_mov_b32 v98, 0xffff
    v_cndmask_b32 v96, v97, v98, vcc
    v_xor_b32 v95, v95, v96
    s_sub_u32 s12, 2047, s22
    v_lshlrev_b32 v95, 11, v95
    v_or_b32 v100, s12, v95
    v_and_b32 v94, 0xffff0000, v94
    v_mul_f32 v94, 0xbfb8aa3b, v94
    v_exp_f32 v94, v94
    s_nop 0
    v_add_f32 v94, 1.0, v94
    v_rcp_f32 v94, v94
    s_nop 0
    v_cvt_pk_bf16_f32 v94, v94, v94
    v_lshlrev_b32 v102, 16, v94
    v_cvt_pk_bf16_f32 v94, v92, v93
    v_and_b32 v95, 0xffff, v94
    v_and_b32 v96, 0x8000, v94
    v_cmp_ne_u32 vcc, 0, v96
    v_mov_b32 v97, 0x8000
    v_mov_b32 v98, 0xffff
    v_cndmask_b32 v96, v97, v98, vcc
    v_xor_b32 v95, v95, v96
    s_sub_u32 s12, 2046, s22
    v_lshlrev_b32 v95, 11, v95
    v_or_b32 v101, s12, v95
    v_and_b32 v94, 0xffff0000, v94
    v_mul_f32 v94, 0xbfb8aa3b, v94
    v_exp_f32 v94, v94
    s_nop 0
    v_add_f32 v94, 1.0, v94
    v_rcp_f32 v94, v94
    s_nop 0
    v_cvt_pk_bf16_f32 v94, v94, v94
    v_lshlrev_b32 v103, 16, v94
    v_max_u32 v100, v100, v101
    s_lshl_b32 s12, s22, 2
    s_add_u32 s12, s12, 4096
    s_lshl_b32 s13, s21, 2
    s_add_u32 s13, s13, 162880
    v_mov_b32 v14, s13
    s_mov_b32 exec_lo, 0
    s_mov_b32 exec_hi, 0x80000000
    buffer_store_dwordx2 v[102:103], v13, s[32:35], s12 offen sc1
    ds_write_b32 v14, v100
    s_mov_b64 exec, -1
    s_waitcnt lgkmcnt(0)
    s_waitcnt vmcnt(12)
    s_barrier
    s_bfe_u32 s91, s68, 0x40018
    s_lshl_b32 s92, s91, 7
    s_mul_i32 s93, s91, 393216
    s_add_u32 m0, s94, 0
    s_nop 0
    buffer_load_dwordx4 v20, s[24:27], s92 offen offset:0 lds
    buffer_load_dwordx4 v21, s[24:27], s92 offen offset:1024 lds
    buffer_load_dwordx4 v22, s[24:27], s92 offen offset:2048 lds
    buffer_load_dwordx4 v23, s[24:27], s92 offen offset:3072 lds
    s_add_u32 m0, s95, 0
    s_nop 0
    buffer_load_dwordx4 v24, s[28:31], s93 offen offset:0 lds
    buffer_load_dwordx4 v25, s[28:31], s93 offen offset:1024 lds
    buffer_load_dwordx4 v26, s[28:31], s93 offen offset:2048 lds
    s_add_u32 m0, s95, 3072
    s_nop 0
    buffer_load_dwordx4 v27, s[28:31], s93 offen offset:0 lds
    buffer_load_dwordx4 v28, s[28:31], s93 offen offset:1024 lds
    buffer_load_dwordx4 v29, s[28:31], s93 offen offset:2048 lds
    s_add_u32 s12, s71, 0
    buffer_load_dwordx4 v[160:163], v30, s[44:47], s12 offen nt
    s_add_u32 s12, s71, 7168
    buffer_load_dwordx4 v[164:167], v30, s[44:47], s12 offen nt
    s_add_u32 s12, s71, 14336
    buffer_load_dwordx4 v[168:171], v30, s[44:47], s12 offen nt
    s_add_u32 s12, s71, 21504
    buffer_load_dwordx4 v[172:175], v30, s[44:47], s12 offen nt
    s_add_u32 s12, s71, 28672
    buffer_load_dwordx4 v[176:179], v30, s[44:47], s12 offen nt
    s_add_u32 s12, s71, 35840
    buffer_load_dwordx4 v[180:183], v30, s[44:47], s12 offen nt
    s_add_u32 s12, s71, 43008
    buffer_load_dwordx4 v[184:187], v30, s[44:47], s12 offen nt
    s_add_u32 s12, s71, 50176
    buffer_load_dwordx4 v[188:191], v30, s[44:47], s12 offen nt
    s_waitcnt vmcnt(19)
    s_barrier
    s_bfe_u32 s91, s68, 0x4001c
    s_lshl_b32 s92, s91, 7
    s_mul_i32 s93, s91, 393216
    s_add_u32 m0, s94, 40960
    s_nop 0
    buffer_load_dwordx4 v20, s[24:27], s92 offen offset:0 lds
    buffer_load_dwordx4 v21, s[24:27], s92 offen offset:1024 lds
    buffer_load_dwordx4 v22, s[24:27], s92 offen offset:2048 lds
    buffer_load_dwordx4 v23, s[24:27], s92 offen offset:3072 lds
    s_add_u32 m0, s95, 40960
    s_nop 0
    buffer_load_dwordx4 v24, s[28:31], s93 offen offset:0 lds
    buffer_load_dwordx4 v25, s[28:31], s93 offen offset:1024 lds
    buffer_load_dwordx4 v26, s[28:31], s93 offen offset:2048 lds
    s_add_u32 m0, s95, 44032
    s_nop 0
    buffer_load_dwordx4 v27, s[28:31], s93 offen offset:0 lds
    buffer_load_dwordx4 v28, s[28:31], s93 offen offset:1024 lds
    buffer_load_dwordx4 v29, s[28:31], s93 offen offset:2048 lds
    s_waitcnt vmcnt(18)
    s_barrier
    s_bfe_u32 s91, s69, 0x40000
    s_lshl_b32 s92, s91, 7
    s_mul_i32 s93, s91, 393216
    s_add_u32 m0, s94, 81920
    s_nop 0
    buffer_load_dwordx4 v20, s[24:27], s92 offen offset:0 lds
    buffer_load_dwordx4 v21, s[24:27], s92 offen offset:1024 lds
    buffer_load_dwordx4 v22, s[24:27], s92 offen offset:2048 lds
    buffer_load_dwordx4 v23, s[24:27], s92 offen offset:3072 lds
    s_add_u32 m0, s95, 81920
    s_nop 0
    buffer_load_dwordx4 v24, s[28:31], s93 offen offset:0 lds
    buffer_load_dwordx4 v25, s[28:31], s93 offen offset:1024 lds
    buffer_load_dwordx4 v26, s[28:31], s93 offen offset:2048 lds
    s_add_u32 m0, s95, 84992
    s_nop 0
    buffer_load_dwordx4 v27, s[28:31], s93 offen offset:0 lds
    buffer_load_dwordx4 v28, s[28:31], s93 offen offset:1024 lds
    buffer_load_dwordx4 v29, s[28:31], s93 offen offset:2048 lds
    s_mov_b32 s13, 0
L_tagchk:
    v_readfirstlane_b32 s23, v15
    s_nop 1
    s_cmp_lg_u32 s23, 0
    s_cbranch_scc1 L_tagok
    s_add_u32 s13, s13, 1
    s_cmp_ge_u32 s13, 16384
    s_cbranch_scc1 L_tagok
    buffer_load_dword v15, v13, s[72:75], 0 offen offset:4 sc1
    s_waitcnt vmcnt(0)
    s_branch L_tagchk
L_tagok:
    s_and_b32 s76, s23, 0xff
    s_bfe_u32 s77, s23, 0x80008
    s_bfe_u32 s78, s23, 0x80010
    s_lshr_b32 s79, s23, 24
    v_and_b32 v35, 3, v2
    v_lshlrev_b32 v35, 3, v35
    v_bfe_u32 v35, s23, v35, 8
    s_cmp_lg_u32 s21, 0
    s_cbranch_scc1 L_nopub
    v_mov_b32 v14, 162880
    ds_read_b128 v[104:107], v14
    s_lshl_b32 s12, s2, 3
    s_add_u32 s12, s12, 0
    s_waitcnt lgkmcnt(0)
    v_max3_u32 v104, v104, v105, v106
    v_max_u32 v104, v104, v107
    v_mov_b32 v105, s23
    s_mov_b64 exec, 1
    buffer_store_dwordx2 v[104:105], v13, s[32:35], s12 offen sc1
    s_mov_b64 exec, -1
L_nopub:
    s_waitcnt vmcnt(10)
    s_barrier
    s_bfe_u32 s91, s69, 0x40004
    s_lshl_b32 s92, s91, 7
    s_mul_i32 s93, s91, 393216
    s_add_u32 m0, s94, 0
    s_nop 0
    buffer_load_dwordx4 v20, s[24:27], s92 offen offset:0 lds
    buffer_load_dwordx4 v21, s[24:27], s92 offen offset:1024 lds
    buffer_load_dwordx4 v22, s[24:27], s92 offen offset:2048 lds
    buffer_load_dwordx4 v23, s[24:27], s92 offen offset:3072 lds
    s_add_u32 m0, s95, 0
    s_nop 0
    buffer_load_dwordx4 v24, s[28:31], s93 offen offset:0 lds
    buffer_load_dwordx4 v25, s[28:31], s93 offen offset:1024 lds
    buffer_load_dwordx4 v26, s[28:31], s93 offen offset:2048 lds
    s_add_u32 m0, s95, 3072
    s_nop 0
    buffer_load_dwordx4 v27, s[28:31], s93 offen offset:0 lds
    buffer_load_dwordx4 v28, s[28:31], s93 offen offset:1024 lds
    buffer_load_dwordx4 v29, s[28:31], s93 offen offset:2048 lds
    s_add_u32 s12, s97, 0
    buffer_load_dwordx4 v[192:195], v31, s[64:67], s12 offen nt
    s_add_u32 s12, s97, 16384
    buffer_load_dwordx4 v[196:199], v31, s[64:67], s12 offen nt
    s_add_u32 s12, s97, 32768
    buffer_load_dwordx4 v[200:203], v31, s[64:67], s12 offen nt
    s_add_u32 s12, s97, 49152
    buffer_load_dwordx4 v[204:207], v31, s[64:67], s12 offen nt
    s_add_u32 s12, s97, 65536
    buffer_load_dwordx4 v[208:211], v31, s[64:67], s12 offen nt
    s_add_u32 s12, s97, 81920
    buffer_load_dwordx4 v[212:215], v31, s[64:67], s12 offen nt
    s_add_u32 s12, s97, 98304
    buffer_load_dwordx4 v[216:219], v31, s[64:67], s12 offen nt
    s_waitcnt vmcnt(17)
    s_barrier
    s_bfe_u32 s91, s69, 0x40008
    s_lshl_b32 s92, s91, 7
    s_mul_i32 s93, s91, 393216
    s_add_u32 m0, s94, 40960
    s_nop 0
    buffer_load_dwordx4 v20, s[24:27], s92 offen offset:0 lds
    buffer_load_dwordx4 v21, s[24:27], s92 offen offset:1024 lds
    buffer_load_dwordx4 v22, s[24:27], s92 offen offset:2048 lds
    buffer_load_dwordx4 v23, s[24:27], s92 offen offset:3072 lds
    s_add_u32 m0, s95, 40960
    s_nop 0
    buffer_load_dwordx4 v24, s[28:31], s93 offen offset:0 lds
    buffer_load_dwordx4 v25, s[28:31], s93 offen offset:1024 lds
    buffer_load_dwordx4 v26, s[28:31], s93 offen offset:2048 lds
    s_add_u32 m0, s95, 44032
    s_nop 0
    buffer_load_dwordx4 v27, s[28:31], s93 offen offset:0 lds
    buffer_load_dwordx4 v28, s[28:31], s93 offen offset:1024 lds
    buffer_load_dwordx4 v29, s[28:31], s93 offen offset:2048 lds
    s_waitcnt vmcnt(17)
    s_barrier
    s_bfe_u32 s91, s69, 0x4000c
    s_lshl_b32 s92, s91, 7
    s_mul_i32 s93, s91, 393216
    s_add_u32 m0, s94, 81920
    s_nop 0
    buffer_load_dwordx4 v20, s[24:27], s92 offen offset:0 lds
    buffer_load_dwordx4 v21, s[24:27], s92 offen offset:1024 lds
    buffer_load_dwordx4 v22, s[24:27], s92 offen offset:2048 lds
    buffer_load_dwordx4 v23, s[24:27], s92 offen offset:3072 lds
    s_add_u32 m0, s95, 81920
    s_nop 0
    buffer_load_dwordx4 v24, s[28:31], s93 offen offset:0 lds
    buffer_load_dwordx4 v25, s[28:31], s93 offen offset:1024 lds
    buffer_load_dwordx4 v26, s[28:31], s93 offen offset:2048 lds
    s_add_u32 m0, s95, 84992
    s_nop 0
    buffer_load_dwordx4 v27, s[28:31], s93 offen offset:0 lds
    buffer_load_dwordx4 v28, s[28:31], s93 offen offset:1024 lds
    buffer_load_dwordx4 v29, s[28:31], s93 offen offset:2048 lds
    s_waitcnt vmcnt(10)
    s_barrier
    s_bfe_u32 s91, s69, 0x40010
    s_lshl_b32 s92, s91, 7
    s_mul_i32 s93, s91, 393216
    s_add_u32 m0, s94, 0
    s_nop 0
    buffer_load_dwordx4 v20, s[24:27], s92 offen offset:0 lds
    buffer_load_dwordx4 v21, s[24:27], s92 offen offset:1024 lds
    buffer_load_dwordx4 v22, s[24:27], s92 offen offset:2048 lds
    buffer_load_dwordx4 v23, s[24:27], s92 offen offset:3072 lds
    s_add_u32 m0, s95, 0
    s_nop 0
    buffer_load_dwordx4 v24, s[28:31], s93 offen offset:0 lds
    buffer_load_dwordx4 v25, s[28:31], s93 offen offset:1024 lds
    buffer_load_dwordx4 v26, s[28:31], s93 offen offset:2048 lds
    s_add_u32 m0, s95, 3072
    s_nop 0
    buffer_load_dwordx4 v27, s[28:31], s93 offen offset:0 lds
    buffer_load_dwordx4 v28, s[28:31], s93 offen offset:1024 lds
    buffer_load_dwordx4 v29, s[28:31], s93 offen offset:2048 lds
    s_waitcnt vmcnt(10)
    s_barrier
    s_bfe_u32 s91, s69, 0x40014
    s_lshl_b32 s92, s91, 7
    s_mul_i32 s93, s91, 393216
    s_add_u32 m0, s94, 40960
    s_nop 0
    buffer_load_dwordx4 v20, s[24:27], s92 offen offset:0 lds
    buffer_load_dwordx4 v21, s[24:27], s92 offen offset:1024 lds
    buffer_load_dwordx4 v22, s[24:27], s92 offen offset:2048 lds
    buffer_load_dwordx4 v23, s[24:27], s92 offen offset:3072 lds
    s_add_u32 m0, s95, 40960
    s_nop 0
    buffer_load_dwordx4 v24, s[28:31], s93 offen offset:0 lds
    buffer_load_dwordx4 v25, s[28:31], s93 offen offset:1024 lds
    buffer_load_dwordx4 v26, s[28:31], s93 offen offset:2048 lds
    s_add_u32 m0, s95, 44032
    s_nop 0
    buffer_load_dwordx4 v27, s[28:31], s93 offen offset:0 lds
    buffer_load_dwordx4 v28, s[28:31], s93 offen offset:1024 lds
    buffer_load_dwordx4 v29, s[28:31], s93 offen offset:2048 lds
    s_mov_b32 s12, 0
    buffer_load_dwordx4 v[104:107], v5, s[32:35], s12 offen offset:0 sc1
    buffer_load_dwordx4 v[108:111], v5, s[32:35], s12 offen offset:1024 sc1
    s_waitcnt vmcnt(12)
    s_barrier
    s_bfe_u32 s91, s69, 0x40018
    s_lshl_b32 s92, s91, 7
    s_mul_i32 s93, s91, 393216
    s_add_u32 m0, s94, 81920
    s_nop 0
    buffer_load_dwordx4 v20, s[24:27], s92 offen offset:0 lds
    buffer_load_dwordx4 v21, s[24:27], s92 offen offset:1024 lds
    buffer_load_dwordx4 v22, s[24:27], s92 offen offset:2048 lds
    buffer_load_dwordx4 v23, s[24:27], s92 offen offset:3072 lds
    s_add_u32 m0, s95, 81920
    s_nop 0
    buffer_load_dwordx4 v24, s[28:31], s93 offen offset:0 lds
    buffer_load_dwordx4 v25, s[28:31], s93 offen offset:1024 lds
    buffer_load_dwordx4 v26, s[28:31], s93 offen offset:2048 lds
    s_add_u32 m0, s95, 84992
    s_nop 0
    buffer_load_dwordx4 v27, s[28:31], s93 offen offset:0 lds
    buffer_load_dwordx4 v28, s[28:31], s93 offen offset:1024 lds
    buffer_load_dwordx4 v29, s[28:31], s93 offen offset:2048 lds
    s_waitcnt vmcnt(12)
    s_barrier
    s_bfe_u32 s91, s69, 0x4001c
    s_lshl_b32 s92, s91, 7
    s_mul_i32 s93, s91, 393216
    s_add_u32 m0, s94, 0
    s_nop 0
    buffer_load_dwordx4 v20, s[24:27], s92 offen offset:0 lds
    buffer_load_dwordx4 v21, s[24:27], s92 offen offset:1024 lds
    buffer_load_dwordx4 v22, s[24:27], s92 offen offset:2048 lds
    buffer_load_dwordx4 v23, s[24:27], s92 offen offset:3072 lds
    s_add_u32 m0, s95, 0
    s_nop 0
    buffer_load_dwordx4 v24, s[28:31], s93 offen offset:0 lds
    buffer_load_dwordx4 v25, s[28:31], s93 offen offset:1024 lds
    buffer_load_dwordx4 v26, s[28:31], s93 offen offset:2048 lds
    s_add_u32 m0, s95, 3072
    s_nop 0
    buffer_load_dwordx4 v27, s[28:31], s93 offen offset:0 lds
    buffer_load_dwordx4 v28, s[28:31], s93 offen offset:1024 lds
    buffer_load_dwordx4 v29, s[28:31], s93 offen offset:2048 lds
    s_waitcnt vmcnt(20)
    s_mov_b32 s13, 0
L_keychk:
    v_xor_b32 v105, s23, v105
    v_xor_b32 v107, s23, v107
    v_xor_b32 v109, s23, v109
    v_xor_b32 v111, s23, v111
    v_or3_b32 v105, v105, v107, v109
    v_or_b32 v105, v105, v111
    v_cmp_ne_u32 vcc, 0, v105
    s_cbranch_vccz L_keyok
    s_add_u32 s13, s13, 1
    s_cmp_ge_u32 s13, 16384
    s_cbranch_scc1 L_keyok
    s_mov_b32 s12, 0
    buffer_load_dwordx4 v[104:107], v5, s[32:35], s12 offen offset:0 sc1
    buffer_load_dwordx4 v[108:111], v5, s[32:35], s12 offen offset:1024 sc1
    s_waitcnt vmcnt(0)
    s_branch L_keychk
L_keyok:
    v_max3_u32 v104, v104, v106, v108
    v_max_u32 v104, v104, v110
    s_nop 1
    v_max_u32_dpp v104, v104, v104 row_shr:1 row_mask:0xf bank_mask:0xf
    s_nop 1
    v_max_u32_dpp v104, v104, v104 row_shr:2 row_mask:0xf bank_mask:0xf
    s_nop 1
    v_max_u32_dpp v104, v104, v104 row_shr:4 row_mask:0xf bank_mask:0xf
    s_nop 1
    v_max_u32_dpp v104, v104, v104 row_shr:8 row_mask:0xf bank_mask:0xf
    s_nop 1
    v_max_u32_dpp v104, v104, v104 row_bcast:15 row_mask:0xa bank_mask:0xf
    s_nop 1
    v_max_u32_dpp v104, v104, v104 row_bcast:31 row_mask:0xc bank_mask:0xf
    s_nop 0
    v_readlane_b32 s14, v104, 63
    s_nop 1
    s_and_b32 s15, s14, 2047
    s_sub_u32 s15, 2047, s15
    s_lshl_b32 s12, s15, 11
    s_lshl_b32 s13, s70, 1
    s_add_u32 s12, s12, s13
    buffer_load_dwordx4 v[36:39], v34, s[24:27], s12 offen
    s_lshr_b32 s12, s14, 11
    s_and_b32 s13, s12, 0x8000
    s_cmp_lg_u32 s13, 0
    s_mov_b32 s13, 0xffff
    s_cselect_b32 s13, 0x8000, s13
    s_xor_b32 s12, s12, s13
    s_lshl_b32 s12, s12, 16
    v_mov_b32 v105, s12
    v_mul_f32 v105, 0xbfb8aa3b, v105
    v_exp_f32 v105, v105
    s_nop 0
    v_add_f32 v105, 1.0, v105
    v_rcp_f32 v105, v105
    s_nop 0
    v_cvt_pk_bf16_f32 v105, v105, v105
    v_lshlrev_b32 v105, 16, v105
    s_nop 0
    v_readfirstlane_b32 s14, v105
    s_add_u32 s12, s15, 1
    v_mov_b32 v104, s12
    v_mov_b32 v106, s23
    v_mov_b32 v14, 162864
    s_mov_b64 exec, 1
    ds_write_b96 v14, v[104:106]
    s_mov_b64 exec, -1
    s_waitcnt lgkmcnt(0)
    s_waitcnt vmcnt(11)
    s_barrier
    s_mul_i32 s12, s21, 8
    s_add_u32 s12, s12, 96
    s_lshl_b32 s13, s12, 10
    s_lshl_b32 s12, s12, 14
    s_add_u32 m0, s13, 24576
    s_add_u32 s90, s12, 0
    buffer_load_dwordx4 v32, s[36:39], s90 offen lds
    s_add_u32 m0, s13, 25600
    s_add_u32 s90, s12, 16384
    buffer_load_dwordx4 v32, s[36:39], s90 offen lds
    s_add_u32 m0, s13, 26624
    s_add_u32 s90, s12, 32768
    buffer_load_dwordx4 v32, s[36:39], s90 offen lds
    s_add_u32 m0, s13, 27648
    s_add_u32 s90, s12, 49152
    buffer_load_dwordx4 v32, s[36:39], s90 offen lds
    s_add_u32 m0, s13, 28672
    s_add_u32 s90, s12, 65536
    buffer_load_dwordx4 v32, s[36:39], s90 offen lds
    s_add_u32 m0, s13, 29696
    s_add_u32 s90, s12, 81920
    buffer_load_dwordx4 v32, s[36:39], s90 offen lds
    s_add_u32 m0, s13, 30720
    s_add_u32 s90, s12, 98304
    buffer_load_dwordx4 v32, s[36:39], s90 offen lds
    s_add_u32 m0, s13, 31744
    s_add_u32 s90, s12, 114688
    buffer_load_dwordx4 v32, s[36:39], s90 offen lds
    s_waitcnt vmcnt(9)
    s_barrier
    s_mul_i32 s12, s21, 4
    s_add_u32 s12, s12, 40
    s_lshl_b32 s13, s12, 10
    s_lshl_b32 s12, s12, 14
    s_add_u32 m0, s13, 24576
    s_add_u32 s90, s12, 0
    buffer_load_dwordx4 v32, s[36:39], s90 offen lds
    s_add_u32 m0, s13, 25600
    s_add_u32 s90, s12, 16384
    buffer_load_dwordx4 v32, s[36:39], s90 offen lds
    s_add_u32 m0, s13, 26624
    s_add_u32 s90, s12, 32768
    buffer_load_dwordx4 v32, s[36:39], s90 offen lds
    s_add_u32 m0, s13, 27648
    s_add_u32 s90, s12, 49152
    buffer_load_dwordx4 v32, s[36:39], s90 offen lds
    s_mul_i32 s12, s21, 10
    s_add_u32 s12, s12, 56
    s_lshl_b32 s13, s12, 10
    s_lshl_b32 s12, s12, 14
    s_add_u32 m0, s13, 24576
    s_add_u32 s90, s12, 0
    buffer_load_dwordx4 v32, s[36:39], s90 offen lds
    s_add_u32 m0, s13, 25600
    s_add_u32 s90, s12, 16384
    buffer_load_dwordx4 v32, s[36:39], s90 offen lds
    s_add_u32 m0, s13, 26624
    s_add_u32 s90, s12, 32768
    buffer_load_dwordx4 v32, s[36:39], s90 offen lds
    s_add_u32 m0, s13, 27648
    s_add_u32 s90, s12, 49152
    buffer_load_dwordx4 v32, s[36:39], s90 offen lds
    s_add_u32 m0, s13, 28672
    s_add_u32 s90, s12, 65536
    buffer_load_dwordx4 v32, s[36:39], s90 offen lds
    s_add_u32 m0, s13, 29696
    s_add_u32 s90, s12, 81920
    buffer_load_dwordx4 v32, s[36:39], s90 offen lds
    s_add_u32 m0, s13, 30720
    s_add_u32 s90, s12, 98304
    buffer_load_dwordx4 v32, s[36:39], s90 offen lds
    s_add_u32 m0, s13, 31744
    s_add_u32 s90, s12, 114688
    buffer_load_dwordx4 v32, s[36:39], s90 offen lds
    s_add_u32 m0, s13, 32768
    s_add_u32 s90, s12, 131072
    buffer_load_dwordx4 v32, s[36:39], s90 offen lds
    s_add_u32 m0, s13, 33792
    s_add_u32 s90, s12, 147456
    buffer_load_dwordx4 v32, s[36:39], s90 offen lds
    v_mov_b32 v14, 162816
    s_mov_b32 s13, 0
L_dspin:
    ds_read_b128 v[104:107], v14
    s_add_u32 s13, s13, 1
    s_cmp_ge_u32 s13, 262144
    s_cbranch_scc1 L_dok
    s_waitcnt lgkmcnt(0)
    v_and_b32 v104, v104, v105
    v_and_b32 v106, v106, v107
    v_and_b32 v104, v104, v106
    v_cmp_eq_u32 vcc, 1, v104
    s_cbranch_vccz L_dspin
L_dok:
    s_waitcnt lgkmcnt(0)
    s_mul_i32 s12, s21, 10
    s_add_u32 s12, s12, 0
    s_lshl_b32 s13, s12, 10
    s_lshl_b32 s12, s12, 14
    s_add_u32 m0, s13, 0
    s_add_u32 s90, s12, 0
    buffer_load_dwordx4 v32, s[36:39], s90 offen lds
    s_add_u32 m0, s13, 1024
    s_add_u32 s90, s12, 16384
    buffer_load_dwordx4 v32, s[36:39], s90 offen lds
    s_add_u32 m0, s13, 2048
    s_add_u32 s90, s12, 32768
    buffer_load_dwordx4 v32, s[36:39], s90 offen lds
    s_add_u32 m0, s13, 3072
    s_add_u32 s90, s12, 49152
    buffer_load_dwordx4 v32, s[36:39], s90 offen lds
    s_add_u32 m0, s13, 4096
    s_add_u32 s90, s12, 65536
    buffer_load_dwordx4 v32, s[36:39], s90 offen lds
    s_add_u32 m0, s13, 5120
    s_add_u32 s90, s12, 81920
    buffer_load_dwordx4 v32, s[36:39], s90 offen lds
    s_add_u32 m0, s13, 6144
    s_add_u32 s90, s12, 98304
    buffer_load_dwordx4 v32, s[36:39], s90 offen lds
    s_add_u32 m0, s13, 7168
    s_add_u32 s90, s12, 114688
    buffer_load_dwordx4 v32, s[36:39], s90 offen lds
    s_add_u32 m0, s13, 8192
    s_add_u32 s90, s12, 131072
    buffer_load_dwordx4 v32, s[36:39], s90 offen lds
    s_add_u32 m0, s13, 9216
    s_add_u32 s90, s12, 147456
    buffer_load_dwordx4 v32, s[36:39], s90 offen lds
    s_waitcnt vmcnt(32)
    v_and_b32 v40, 0xffff, v36
    v_lshlrev_b32 v41, 16, v36
    v_lshrrev_b32 v42, 16, v36
    v_and_b32 v43, 0xffff0000, v36
    v_and_b32 v44, 0xffff, v37
    v_lshlrev_b32 v45, 16, v37
    v_lshrrev_b32 v46, 16, v37
    v_and_b32 v47, 0xffff0000, v37
    v_and_b32 v48, 0xffff, v38
    v_lshlrev_b32 v49, 16, v38
    v_lshrrev_b32 v50, 16, v38
    v_and_b32 v51, 0xffff0000, v38
    v_and_b32 v52, 0xffff, v39
    v_lshlrev_b32 v53, 16, v39
    v_lshrrev_b32 v54, 16, v39
    v_and_b32 v55, 0xffff0000, v39
    v_dot2_f32_bf16 v220, v128, v40, 0
    v_dot2_f32_bf16 v221, v128, v41, 0
    v_dot2_f32_bf16 v222, v129, v40, 0
    v_dot2_f32_bf16 v223, v129, v41, 0
    v_dot2_f32_bf16 v224, v130, v40, 0
    v_dot2_f32_bf16 v225, v130, v41, 0
    v_dot2_f32_bf16 v226, v131, v40, 0
    v_dot2_f32_bf16 v227, v131, v41, 0
    v_dot2_f32_bf16 v228, v160, v40, 0
    v_dot2_f32_bf16 v229, v160, v41, 0
    v_dot2_f32_bf16 v230, v161, v40, 0
    v_dot2_f32_bf16 v231, v161, v41, 0
    v_dot2_f32_bf16 v232, v162, v40, 0
    v_dot2_f32_bf16 v233, v162, v41, 0
    v_dot2_f32_bf16 v234, v163, v40, 0
    v_dot2_f32_bf16 v235, v163, v41, 0
    v_dot2_f32_bf16 v220, v132, v42, v220
    v_dot2_f32_bf16 v221, v132, v43, v221
    v_dot2_f32_bf16 v222, v133, v42, v222
    v_dot2_f32_bf16 v223, v133, v43, v223
    v_dot2_f32_bf16 v224, v134, v42, v224
    v_dot2_f32_bf16 v225, v134, v43, v225
    v_dot2_f32_bf16 v226, v135, v42, v226
    v_dot2_f32_bf16 v227, v135, v43, v227
    v_dot2_f32_bf16 v228, v164, v42, v228
    v_dot2_f32_bf16 v229, v164, v43, v229
    v_dot2_f32_bf16 v230, v165, v42, v230
    v_dot2_f32_bf16 v231, v165, v43, v231
    v_dot2_f32_bf16 v232, v166, v42, v232
    v_dot2_f32_bf16 v233, v166, v43, v233
    v_dot2_f32_bf16 v234, v167, v42, v234
    v_dot2_f32_bf16 v235, v167, v43, v235
    v_dot2_f32_bf16 v220, v136, v44, v220
    v_dot2_f32_bf16 v221, v136, v45, v221
    v_dot2_f32_bf16 v222, v137, v44, v222
    v_dot2_f32_bf16 v223, v137, v45, v223
    v_dot2_f32_bf16 v224, v138, v44, v224
    v_dot2_f32_bf16 v225, v138, v45, v225
    v_dot2_f32_bf16 v226, v139, v44, v226
    v_dot2_f32_bf16 v227, v139, v45, v227
    v_dot2_f32_bf16 v228, v168, v44, v228
    v_dot2_f32_bf16 v229, v168, v45, v229
    v_dot2_f32_bf16 v230, v169, v44, v230
    v_dot2_f32_bf16 v231, v169, v45, v231
    v_dot2_f32_bf16 v232, v170, v44, v232
    v_dot2_f32_bf16 v233, v170, v45, v233
    v_dot2_f32_bf16 v234, v171, v44, v234
    v_dot2_f32_bf16 v235, v171, v45, v235
    v_dot2_f32_bf16 v220, v140, v46, v220
    v_dot2_f32_bf16 v221, v140, v47, v221
    v_dot2_f32_bf16 v222, v141, v46, v222
    v_dot2_f32_bf16 v223, v141, v47, v223
    v_dot2_f32_bf16 v224, v142, v46, v224
    v_dot2_f32_bf16 v225, v142, v47, v225
    v_dot2_f32_bf16 v226, v143, v46, v226
    v_dot2_f32_bf16 v227, v143, v47, v227
    v_dot2_f32_bf16 v228, v172, v46, v228
    v_dot2_f32_bf16 v229, v172, v47, v229
    v_dot2_f32_bf16 v230, v173, v46, v230
    v_dot2_f32_bf16 v231, v173, v47, v231
    v_dot2_f32_bf16 v232, v174, v46, v232
    v_dot2_f32_bf16 v233, v174, v47, v233
    v_dot2_f32_bf16 v234, v175, v46, v234
    v_dot2_f32_bf16 v235, v175, v47, v235
    v_dot2_f32_bf16 v220, v144, v48, v220
    v_dot2_f32_bf16 v221, v144, v49, v221
    v_dot2_f32_bf16 v222, v145, v48, v222
    v_dot2_f32_bf16 v223, v145, v49, v223
    v_dot2_f32_bf16 v224, v146, v48, v224
    v_dot2_f32_bf16 v225, v146, v49, v225
    v_dot2_f32_bf16 v226, v147, v48, v226
    v_dot2_f32_bf16 v227, v147, v49, v227
    v_dot2_f32_bf16 v228, v176, v48, v228
    v_dot2_f32_bf16 v229, v176, v49, v229
    v_dot2_f32_bf16 v230, v177, v48, v230
    v_dot2_f32_bf16 v231, v177, v49, v231
    v_dot2_f32_bf16 v232, v178, v48, v232
    v_dot2_f32_bf16 v233, v178, v49, v233
    v_dot2_f32_bf16 v234, v179, v48, v234
    v_dot2_f32_bf16 v235, v179, v49, v235
    v_dot2_f32_bf16 v220, v148, v50, v220
    v_dot2_f32_bf16 v221, v148, v51, v221
    v_dot2_f32_bf16 v222, v149, v50, v222
    v_dot2_f32_bf16 v223, v149, v51, v223
    v_dot2_f32_bf16 v224, v150, v50, v224
    v_dot2_f32_bf16 v225, v150, v51, v225
    v_dot2_f32_bf16 v226, v151, v50, v226
    v_dot2_f32_bf16 v227, v151, v51, v227
    v_dot2_f32_bf16 v228, v180, v50, v228
    v_dot2_f32_bf16 v229, v180, v51, v229
    v_dot2_f32_bf16 v230, v181, v50, v230
    v_dot2_f32_bf16 v231, v181, v51, v231
    v_dot2_f32_bf16 v232, v182, v50, v232
    v_dot2_f32_bf16 v233, v182, v51, v233
    v_dot2_f32_bf16 v234, v183, v50, v234
    v_dot2_f32_bf16 v235, v183, v51, v235
    v_dot2_f32_bf16 v220, v152, v52, v220
    v_dot2_f32_bf16 v221, v152, v53, v221
    v_dot2_f32_bf16 v222, v153, v52, v222
    v_dot2_f32_bf16 v223, v153, v53, v223
    v_dot2_f32_bf16 v224, v154, v52, v224
    v_dot2_f32_bf16 v225, v154, v53, v225
    v_dot2_f32_bf16 v226, v155, v52, v226
    v_dot2_f32_bf16 v227, v155, v53, v227
    v_dot2_f32_bf16 v228, v184, v52, v228
    v_dot2_f32_bf16 v229, v184, v53, v229
    v_dot2_f32_bf16 v230, v185, v52, v230
    v_dot2_f32_bf16 v231, v185, v53, v231
    v_dot2_f32_bf16 v232, v186, v52, v232
    v_dot2_f32_bf16 v233, v186, v53, v233
    v_dot2_f32_bf16 v234, v187, v52, v234
    v_dot2_f32_bf16 v235, v187, v53, v235
    v_dot2_f32_bf16 v220, v156, v54, v220
    v_dot2_f32_bf16 v221, v156, v55, v221
    v_dot2_f32_bf16 v222, v157, v54, v222
    v_dot2_f32_bf16 v223, v157, v55, v223
    v_dot2_f32_bf16 v224, v158, v54, v224
    v_dot2_f32_bf16 v225, v158, v55, v225
    v_dot2_f32_bf16 v226, v159, v54, v226
    v_dot2_f32_bf16 v227, v159, v55, v227
    v_dot2_f32_bf16 v228, v188, v54, v228
    v_dot2_f32_bf16 v229, v188, v55, v229
    v_dot2_f32_bf16 v230, v189, v54, v230
    v_dot2_f32_bf16 v231, v189, v55, v231
    v_dot2_f32_bf16 v232, v190, v54, v232
    v_dot2_f32_bf16 v233, v190, v55, v233
    v_dot2_f32_bf16 v234, v191, v54, v234
    v_dot2_f32_bf16 v235, v191, v55, v235
    v_permlane32_swap_b32 v220, v228
    v_permlane32_swap_b32 v221, v229
    v_permlane32_swap_b32 v222, v230
    v_permlane32_swap_b32 v223, v231
    v_permlane32_swap_b32 v224, v232
    v_permlane32_swap_b32 v225, v233
    v_permlane32_swap_b32 v226, v234
    v_permlane32_swap_b32 v227, v235
    v_add_f32 v220, v220, v228
    v_add_f32 v221, v221, v229
    v_add_f32 v222, v222, v230
    v_add_f32 v223, v223, v231
    v_add_f32 v224, v224, v232
    v_add_f32 v225, v225, v233
    v_add_f32 v226, v226, v234
    v_add_f32 v227, v227, v235
    v_permlane16_swap_b32 v220, v224
    v_permlane16_swap_b32 v221, v225
    v_permlane16_swap_b32 v222, v226
    v_permlane16_swap_b32 v223, v227
    v_add_f32 v220, v220, v224
    v_add_f32 v221, v221, v225
    v_add_f32 v222, v222, v226
    v_add_f32 v223, v223, v227
    v_add_f32_dpp v220, v220, v220 row_ror:8 row_mask:0xf bank_mask:0xf
    v_add_f32_dpp v221, v221, v221 row_ror:8 row_mask:0xf bank_mask:0xf
    v_add_f32_dpp v222, v222, v222 row_ror:8 row_mask:0xf bank_mask:0xf
    v_add_f32_dpp v223, v223, v223 row_ror:8 row_mask:0xf bank_mask:0xf
    v_lshrrev_b32 v14, 5, v2
    v_lshlrev_b32 v14, 8, v14
    v_lshl_add_u32 v14, v6, 5, v14
    v_and_b32 v16, 16, v2
    v_add_u32 v14, v14, v16
    s_lshl_b32 s12, s21, 9
    s_add_u32 s12, s12, 159744
    v_add_u32 v14, s12, v14
    ds_write_b128 v14, v[220:223]
    v_mov_b32 v14, 162848
    v_mov_b32 v16, 1
    s_mov_b64 exec, 1
    ds_add_rtn_u32 v17, v14, v16
    s_mov_b64 exec, -1
    s_waitcnt lgkmcnt(0)
    v_readfirstlane_b32 s12, v17
    s_nop 1
    s_cmp_lg_u32 s12, 3
    s_cbranch_scc1 L_nogu
    s_cmp_ge_u32 s2, 224
    s_cbranch_scc1 L_nogu
    v_lshlrev_b32 v14, 2, v2
    v_add_u32 v14, 159744, v14
    ds_read2st64_b32 v[220:221], v14 offset0:0 offset1:1
    ds_read2st64_b32 v[222:223], v14 offset0:2 offset1:3
    ds_read2st64_b32 v[224:225], v14 offset0:4 offset1:5
    ds_read2st64_b32 v[226:227], v14 offset0:6 offset1:7
    s_and_b32 s12, s2, 3
    s_mul_i32 s12, s12, 28672
    s_lshr_b32 s13, s2, 2
    s_lshl_b32 s13, s13, 9
    s_add_u32 s12, s12, s13
    s_add_u32 s12, s12, 327680
    v_lshlrev_b32 v14, 3, v2
    v_and_b32 v16, 1, v2
    v_lshlrev_b32 v16, 4, v16
    v_lshrrev_b32 v16, v16, s23
    v_bfe_u32 v17, v16, 8, 8
    v_and_b32 v16, 0xff, v16
    s_mov_b32 s13, 0xffffff00
    s_waitcnt lgkmcnt(0)
    v_pk_add_f32 v[220:221], v[220:221], v[222:223]
    v_pk_add_f32 v[224:225], v[224:225], v[226:227]
    v_pk_add_f32 v[220:221], v[220:221], v[224:225]
    v_and_or_b32 v220, v220, s13, v16
    v_and_or_b32 v221, v221, s13, v17
    buffer_store_dwordx2 v[220:221], v14, s[32:35], s12 offen sc1
L_nogu:
    s_cmp_lg_u32 s21, 0
    s_cbranch_scc1 L_nohop
    s_lshl_b32 s12, s19, 18
    s_lshl_b32 s13, s18, 14
    s_add_u32 s12, s12, s13
    s_add_u32 s90, s12, 1048576
    s_add_u32 s91, s90, 4096
    s_add_u32 s92, s90, 8192
    s_add_u32 s93, s90, 12288
    s_lshl_b32 s12, s19, 13
    s_lshl_b32 s13, s18, 9
    s_add_u32 s12, s12, s13
    s_add_u32 s94, s12, 196608
    v_and_b32 v14, 15, v2
    v_lshlrev_b32 v14, 5, v14
    v_lshrrev_b32 v16, 5, v2
    v_lshl_add_u32 v14, v16, 4, v14
    s_mov_b32 s13, 0
L_h1z:
    buffer_load_dwordx4 v[104:107], v14, s[32:35], s94 offen sc1
    s_add_u32 s13, s13, 1
    s_cmp_ge_u32 s13, 16384
    s_cbranch_scc1 L_h1y
    s_waitcnt vmcnt(0)
    v_msad_u8 v108, v104, s76, 0
    v_msad_u8 v108, v105, s77, v108
    v_msad_u8 v108, v106, s78, v108
    v_msad_u8 v108, v107, s79, v108
    v_cmp_ne_u32 vcc, 0, v108
    s_nop 1
    s_or_b32 s12, vcc_lo, vcc_hi
    s_and_b32 s12, s12, 0xffff
    s_bcnt1_i32_b32 s12, s12
    s_cmp_gt_u32 s12, 6
    s_cbranch_scc1 L_h1z
L_h1y:
L_h1a:
    s_mov_b32 s95, 0xffff
L_h1:
    buffer_load_dwordx4 v[104:107], v14, s[32:35], s94 offen sc1
    s_bitcmp1_b32 s95, 0
    s_cselect_b64 exec, -1, 0
    buffer_load_dwordx4 v[128:131], v5, s[32:35], s90 offen offset:0 sc1
    s_bitcmp1_b32 s95, 1
    s_cselect_b64 exec, -1, 0
    buffer_load_dwordx4 v[132:135], v5, s[32:35], s90 offen offset:1024 sc1
    s_bitcmp1_b32 s95, 2
    s_cselect_b64 exec, -1, 0
    buffer_load_dwordx4 v[136:139], v5, s[32:35], s90 offen offset:2048 sc1
    s_bitcmp1_b32 s95, 3
    s_cselect_b64 exec, -1, 0
    buffer_load_dwordx4 v[140:143], v5, s[32:35], s90 offen offset:3072 sc1
    s_bitcmp1_b32 s95, 4
    s_cselect_b64 exec, -1, 0
    buffer_load_dwordx4 v[144:147], v5, s[32:35], s91 offen offset:0 sc1
    s_bitcmp1_b32 s95, 5
    s_cselect_b64 exec, -1, 0
    buffer_load_dwordx4 v[148:151], v5, s[32:35], s91 offen offset:1024 sc1
    s_bitcmp1_b32 s95, 6
    s_cselect_b64 exec, -1, 0
    buffer_load_dwordx4 v[152:155], v5, s[32:35], s91 offen offset:2048 sc1
    s_bitcmp1_b32 s95, 7
    s_cselect_b64 exec, -1, 0
    buffer_load_dwordx4 v[156:159], v5, s[32:35], s91 offen offset:3072 sc1
    s_bitcmp1_b32 s95, 8
    s_cselect_b64 exec, -1, 0
    buffer_load_dwordx4 v[160:163], v5, s[32:35], s92 offen offset:0 sc1
    s_bitcmp1_b32 s95, 9
    s_cselect_b64 exec, -1, 0
    buffer_load_dwordx4 v[164:167], v5, s[32:35], s92 offen offset:1024 sc1
    s_bitcmp1_b32 s95, 10
    s_cselect_b64 exec, -1, 0
    buffer_load_dwordx4 v[168:171], v5, s[32:35], s92 offen offset:2048 sc1
    s_bitcmp1_b32 s95, 11
    s_cselect_b64 exec, -1, 0
    buffer_load_dwordx4 v[172:175], v5, s[32:35], s92 offen offset:3072 sc1
    s_bitcmp1_b32 s95, 12
    s_cselect_b64 exec, -1, 0
    buffer_load_dwordx4 v[176:179], v5, s[32:35], s93 offen offset:0 sc1
    s_bitcmp1_b32 s95, 13
    s_cselect_b64 exec, -1, 0
    buffer_load_dwordx4 v[180:183], v5, s[32:35], s93 offen offset:1024 sc1
    s_bitcmp1_b32 s95, 14
    s_cselect_b64 exec, -1, 0
    buffer_load_dwordx4 v[184:187], v5, s[32:35], s93 offen offset:2048 sc1
    s_bitcmp1_b32 s95, 15
    s_cselect_b64 exec, -1, 0
    buffer_load_dwordx4 v[188:191], v5, s[32:35], s93 offen offset:3072 sc1
    s_mov_b64 exec, -1
    s_add_u32 s13, s13, 1
    s_cmp_ge_u32 s13, 16384
    s_cbranch_scc1 L_h1ok
    s_waitcnt vmcnt(16)
    v_msad_u8 v108, v104, s76, 0
    v_msad_u8 v108, v105, s77, v108
    v_msad_u8 v108, v106, s78, v108
    v_msad_u8 v108, v107, s79, v108
    v_cmp_ne_u32 vcc, 0, v108
    s_nop 1
    s_or_b32 s95, vcc_lo, vcc_hi
    s_and_b32 s95, s95, 0xffff
    s_waitcnt vmcnt(0)
    s_cbranch_scc1 L_h1
    v_msad_u8 v108, v128, v35, 0
    v_msad_u8 v109, v132, v35, 0
    v_msad_u8 v108, v136, v35, v108
    v_msad_u8 v109, v140, v35, v109
    v_msad_u8 v108, v144, v35, v108
    v_msad_u8 v109, v148, v35, v109
    v_msad_u8 v108, v152, v35, v108
    v_msad_u8 v109, v156, v35, v109
    v_msad_u8 v108, v160, v35, v108
    v_msad_u8 v109, v164, v35, v109
    v_msad_u8 v108, v168, v35, v108
    v_msad_u8 v109, v172, v35, v109
    v_msad_u8 v108, v176, v35, v108
    v_msad_u8 v109, v180, v35, v109
    v_msad_u8 v108, v184, v35, v108
    v_msad_u8 v109, v188, v35, v109
    v_or_b32 v108, v108, v109
    v_cmp_ne_u32 vcc, 0, v108
    s_cbranch_vccnz L_h1a
L_h1ok:
    s_waitcnt vmcnt(0)
    v_pk_add_f32 v[128:129], v[128:129], v[160:161]
    v_pk_add_f32 v[130:131], v[130:131], v[162:163]
    v_pk_add_f32 v[132:133], v[132:133], v[164:165]
    v_pk_add_f32 v[134:135], v[134:135], v[166:167]
    v_pk_add_f32 v[136:137], v[136:137], v[168:169]
    v_pk_add_f32 v[138:139], v[138:139], v[170:171]
    v_pk_add_f32 v[140:141], v[140:141], v[172:173]
    v_pk_add_f32 v[142:143], v[142:143], v[174:175]
    v_pk_add_f32 v[144:145], v[144:145], v[176:177]
    v_pk_add_f32 v[146:147], v[146:147], v[178:179]
    v_pk_add_f32 v[148:149], v[148:149], v[180:181]
    v_pk_add_f32 v[150:151], v[150:151], v[182:183]
    v_pk_add_f32 v[152:153], v[152:153], v[184:185]
    v_pk_add_f32 v[154:155], v[154:155], v[186:187]
    v_pk_add_f32 v[156:157], v[156:157], v[188:189]
    v_pk_add_f32 v[158:159], v[158:159], v[190:191]
    v_pk_add_f32 v[128:129], v[128:129], v[144:145]
    v_pk_add_f32 v[130:131], v[130:131], v[146:147]
    v_pk_add_f32 v[132:133], v[132:133], v[148:149]
    v_pk_add_f32 v[134:135], v[134:135], v[150:151]
    v_pk_add_f32 v[136:137], v[136:137], v[152:153]
    v_pk_add_f32 v[138:139], v[138:139], v[154:155]
    v_pk_add_f32 v[140:141], v[140:141], v[156:157]
    v_pk_add_f32 v[142:143], v[142:143], v[158:159]
    v_pk_add_f32 v[128:129], v[128:129], v[136:137]
    v_pk_add_f32 v[130:131], v[130:131], v[138:139]
    v_pk_add_f32 v[132:133], v[132:133], v[140:141]
    v_pk_add_f32 v[134:135], v[134:135], v[142:143]
    v_pk_add_f32 v[128:129], v[128:129], v[132:133]
    v_pk_add_f32 v[130:131], v[130:131], v[134:135]
    v_add_f32_dpp v104, v104, v104 row_ror:1 row_mask:0xf bank_mask:0xf
    v_add_f32_dpp v105, v105, v105 row_ror:1 row_mask:0xf bank_mask:0xf
    v_add_f32_dpp v106, v106, v106 row_ror:1 row_mask:0xf bank_mask:0xf
    v_add_f32_dpp v107, v107, v107 row_ror:1 row_mask:0xf bank_mask:0xf
    v_add_f32_dpp v104, v104, v104 row_ror:2 row_mask:0xf bank_mask:0xf
    v_add_f32_dpp v105, v105, v105 row_ror:2 row_mask:0xf bank_mask:0xf
    v_add_f32_dpp v106, v106, v106 row_ror:2 row_mask:0xf bank_mask:0xf
    v_add_f32_dpp v107, v107, v107 row_ror:2 row_mask:0xf bank_mask:0xf
    v_add_f32_dpp v104, v104, v104 row_ror:4 row_mask:0xf bank_mask:0xf
    v_add_f32_dpp v105, v105, v105 row_ror:4 row_mask:0xf bank_mask:0xf
    v_add_f32_dpp v106, v106, v106 row_ror:4 row_mask:0xf bank_mask:0xf
    v_add_f32_dpp v107, v107, v107 row_ror:4 row_mask:0xf bank_mask:0xf
    v_add_f32_dpp v104, v104, v104 row_ror:8 row_mask:0xf bank_mask:0xf
    v_add_f32_dpp v105, v105, v105 row_ror:8 row_mask:0xf bank_mask:0xf
    v_add_f32_dpp v106, v106, v106 row_ror:8 row_mask:0xf bank_mask:0xf
    v_add_f32_dpp v107, v107, v107 row_ror:8 row_mask:0xf bank_mask:0xf
    v_cvt_pk_bf16_f32 v108, v128, v129
    v_cvt_pk_bf16_f32 v109, v130, v131
    v_cvt_pk_bf16_f32 v112, v104, v105
    v_cvt_pk_bf16_f32 v113, v106, v107
    v_mov_b32 v110, v108
    v_mov_b32 v111, v109
    v_mov_b32 v114, v112
    v_mov_b32 v115, v113
    s_lshl_b32 s12, s19, 13
    s_lshl_b32 s13, s18, 9
    s_add_u32 s12, s12, s13
    s_add_u32 s12, s12, 32768
    s_lshl_b32 s13, s19, 8
    s_lshl_b32 s90, s18, 4
    s_add_u32 s13, s13, s90
    s_add_u32 s13, s13, 163840
    v_permlane32_swap_b32 v108, v110
    v_permlane32_swap_b32 v109, v111
    v_permlane32_swap_b32 v112, v114
    v_permlane32_swap_b32 v113, v115
    s_mov_b32 exec_hi, 0
    buffer_store_dwordx4 v[108:111], v5, s[32:35], s12 offen sc1
    s_mov_b32 exec_lo, 1
    buffer_store_dwordx4 v[112:115], v13, s[32:35], s13 offen sc1
    s_mov_b64 exec, -1
L_nohop:
    v_min_u32 v14, 6, v6
    v_lshl_add_u32 v14, v14, 3, v4
    v_lshlrev_b32 v14, 3, v14
    s_lshl_b32 s12, s96, 3
    s_add_u32 s90, s12, 327680
    s_add_u32 s91, s90, 28672
    s_add_u32 s92, s90, 57344
    s_add_u32 s93, s90, 86016
    v_and_b32 v16, 1, v4
    v_lshlrev_b32 v16, 4, v16
    v_lshrrev_b32 v16, v16, s23
    v_bfe_u32 v17, v16, 8, 8
    v_and_b32 v16, 0xff, v16
    s_mov_b32 s13, 0
L_gu:
    buffer_load_dwordx2 v[104:105], v14, s[32:35], s90 offen sc1
    buffer_load_dwordx2 v[106:107], v14, s[32:35], s91 offen sc1
    buffer_load_dwordx2 v[108:109], v14, s[32:35], s92 offen sc1
    buffer_load_dwordx2 v[110:111], v14, s[32:35], s93 offen sc1
    s_add_u32 s13, s13, 1
    s_waitcnt vmcnt(0)
    v_msad_u8 v112, v104, v16, 0
    v_msad_u8 v112, v105, v17, v112
    v_msad_u8 v112, v106, v16, v112
    v_msad_u8 v112, v107, v17, v112
    v_msad_u8 v112, v108, v16, v112
    v_msad_u8 v112, v109, v17, v112
    v_msad_u8 v112, v110, v16, v112
    v_msad_u8 v112, v111, v17, v112
    v_cmp_ne_u32 vcc, 0, v112
    s_cbranch_vccz L_guok
    s_cmp_lt_u32 s13, 16384
    s_cbranch_scc1 L_gu
L_guok:
    v_pk_add_f32 v[104:105], v[104:105], v[106:107]
    v_pk_add_f32 v[108:109], v[108:109], v[110:111]
    v_pk_add_f32 v[104:105], v[104:105], v[108:109]
    v_cvt_pk_bf16_f32 v104, v104, v105
    v_and_b32 v105, 0xffff0000, v104
    v_lshlrev_b32 v104, 16, v104
    v_mul_f32 v106, 0xbfb8aa3b, v104
    v_exp_f32 v106, v106
    s_nop 0
    v_add_f32 v106, 1.0, v106
    v_rcp_f32 v106, v106
    s_nop 0
    v_mul_f32 v106, v106, v104
    v_cvt_pk_bf16_f32 v106, v106, v106
    v_lshlrev_b32 v106, 16, v106
    v_mul_f32 v106, v106, v105
    v_cvt_pk_bf16_f32 v106, v106, v106
    ds_swizzle_b32 v40, v106 offset:0x18
    ds_swizzle_b32 v42, v106 offset:0x38
    ds_swizzle_b32 v44, v106 offset:0x58
    ds_swizzle_b32 v46, v106 offset:0x78
    ds_swizzle_b32 v48, v106 offset:0x98
    ds_swizzle_b32 v50, v106 offset:0xb8
    ds_swizzle_b32 v52, v106 offset:0xd8
    s_waitcnt lgkmcnt(0)
    v_and_b32 v41, 0xffff0000, v40
    v_and_b32 v40, 0xffff, v40
    v_and_b32 v43, 0xffff0000, v42
    v_and_b32 v42, 0xffff, v42
    v_and_b32 v45, 0xffff0000, v44
    v_and_b32 v44, 0xffff, v44
    v_and_b32 v47, 0xffff0000, v46
    v_and_b32 v46, 0xffff, v46
    v_and_b32 v49, 0xffff0000, v48
    v_and_b32 v48, 0xffff, v48
    v_and_b32 v51, 0xffff0000, v50
    v_and_b32 v50, 0xffff, v50
    v_and_b32 v53, 0xffff0000, v52
    v_and_b32 v52, 0xffff, v52
    v_dot2_f32_bf16 v220, v192, v40, 0
    v_dot2_f32_bf16 v221, v192, v41, 0
    v_dot2_f32_bf16 v222, v193, v40, 0
    v_dot2_f32_bf16 v223, v193, v41, 0
    v_dot2_f32_bf16 v224, v194, v40, 0
    v_dot2_f32_bf16 v225, v194, v41, 0
    v_dot2_f32_bf16 v226, v195, v40, 0
    v_dot2_f32_bf16 v227, v195, v41, 0
    v_dot2_f32_bf16 v220, v196, v42, v220
    v_dot2_f32_bf16 v221, v196, v43, v221
    v_dot2_f32_bf16 v222, v197, v42, v222
    v_dot2_f32_bf16 v223, v197, v43, v223
    v_dot2_f32_bf16 v224, v198, v42, v224
    v_dot2_f32_bf16 v225, v198, v43, v225
    v_dot2_f32_bf16 v226, v199, v42, v226
    v_dot2_f32_bf16 v227, v199, v43, v227
    v_dot2_f32_bf16 v220, v200, v44, v220
    v_dot2_f32_bf16 v221, v200, v45, v221
    v_dot2_f32_bf16 v222, v201, v44, v222
    v_dot2_f32_bf16 v223, v201, v45, v223
    v_dot2_f32_bf16 v224, v202, v44, v224
    v_dot2_f32_bf16 v225, v202, v45, v225
    v_dot2_f32_bf16 v226, v203, v44, v226
    v_dot2_f32_bf16 v227, v203, v45, v227
    v_dot2_f32_bf16 v220, v204, v46, v220
    v_dot2_f32_bf16 v221, v204, v47, v221
    v_dot2_f32_bf16 v222, v205, v46, v222
    v_dot2_f32_bf16 v223, v205, v47, v223
    v_dot2_f32_bf16 v224, v206, v46, v224
    v_dot2_f32_bf16 v225, v206, v47, v225
    v_dot2_f32_bf16 v226, v207, v46, v226
    v_dot2_f32_bf16 v227, v207, v47, v227
    v_dot2_f32_bf16 v220, v208, v48, v220
    v_dot2_f32_bf16 v221, v208, v49, v221
    v_dot2_f32_bf16 v222, v209, v48, v222
    v_dot2_f32_bf16 v223, v209, v49, v223
    v_dot2_f32_bf16 v224, v210, v48, v224
    v_dot2_f32_bf16 v225, v210, v49, v225
    v_dot2_f32_bf16 v226, v211, v48, v226
    v_dot2_f32_bf16 v227, v211, v49, v227
    v_dot2_f32_bf16 v220, v212, v50, v220
    v_dot2_f32_bf16 v221, v212, v51, v221
    v_dot2_f32_bf16 v222, v213, v50, v222
    v_dot2_f32_bf16 v223, v213, v51, v223
    v_dot2_f32_bf16 v224, v214, v50, v224
    v_dot2_f32_bf16 v225, v214, v51, v225
    v_dot2_f32_bf16 v226, v215, v50, v226
    v_dot2_f32_bf16 v227, v215, v51, v227
    v_dot2_f32_bf16 v220, v216, v52, v220
    v_dot2_f32_bf16 v221, v216, v53, v221
    v_dot2_f32_bf16 v222, v217, v52, v222
    v_dot2_f32_bf16 v223, v217, v53, v223
    v_dot2_f32_bf16 v224, v218, v52, v224
    v_dot2_f32_bf16 v225, v218, v53, v225
    v_dot2_f32_bf16 v226, v219, v52, v226
    v_dot2_f32_bf16 v227, v219, v53, v227
    v_permlane32_swap_b32 v220, v224
    v_permlane32_swap_b32 v221, v225
    v_permlane32_swap_b32 v222, v226
    v_permlane32_swap_b32 v223, v227
    v_add_f32 v220, v220, v224
    v_add_f32 v221, v221, v225
    v_add_f32 v222, v222, v226
    v_add_f32 v223, v223, v227
    s_nop 0
    v_permlane16_swap_b32 v220, v222
    v_permlane16_swap_b32 v221, v223
    v_add_f32 v220, v220, v222
    v_add_f32 v221, v221, v223
    s_nop 0
    v_add_f32_dpp v220, v220, v220 row_ror:8 row_mask:0xf bank_mask:0xf
    v_add_f32_dpp v221, v221, v221 row_ror:8 row_mask:0xf bank_mask:0xf
    v_lshrrev_b32 v14, 4, v2
    v_lshlrev_b32 v14, 3, v14
    v_lshl_add_u32 v14, v6, 5, v14
    s_lshl_b32 s12, s21, 8
    s_add_u32 s12, s12, 161792
    v_add_u32 v14, s12, v14
    ds_write_b64 v14, v[220:221]
    v_mov_b32 v14, 162848
    v_mov_b32 v16, 1
    s_mov_b64 exec, 1
    ds_add_rtn_u32 v17, v14, v16 offset:4
    s_mov_b64 exec, -1
    s_waitcnt lgkmcnt(0)
    v_readfirstlane_b32 s12, v17
    s_nop 1
    s_cmp_lg_u32 s12, 3
    s_cbranch_scc1 L_noy
    v_lshlrev_b32 v16, 2, v2
    v_add_u32 v14, 161792, v16
    ds_read2st64_b32 v[220:221], v14 offset0:0 offset1:1
    ds_read2st64_b32 v[222:223], v14 offset0:2 offset1:3
    s_lshr_b32 s12, s2, 4
    s_lshl_b32 s12, s12, 4
    s_and_b32 s13, s2, 15
    s_add_u32 s12, s12, s13
    s_lshl_b32 s12, s12, 8
    s_add_u32 s12, s12, 458752
    s_mov_b32 s13, 0xffffff00
    s_waitcnt lgkmcnt(0)
    v_pk_add_f32 v[220:221], v[220:221], v[222:223]
    v_add_f32 v220, v220, v221
    v_and_or_b32 v220, v220, s13, v35
    buffer_store_dword v220, v16, s[32:35], s12 offen sc1
L_noy:
    s_mov_b32 s21, s15
    s_mov_b32 s22, s14
    s_branch L_phaseb
L_compute:
    s_setprio 1
    s_lshr_b32 s21, s20, 1
    s_and_b32 s22, s20, 1
    v_lshrrev_b32 v3, 5, v2
    v_and_b32 v4, 31, v2
    s_lshl_b32 s12, s21, 13
    v_lshlrev_b32 v6, 7, v4
    v_add_u32 v6, s12, v6
    v_bfe_u32 v7, v2, 1, 3
    v_add_u32 v8, 0, v3
    v_xor_b32 v8, v8, v7
    v_lshl_add_u32 v20, v8, 4, v6
    v_add_u32 v8, 2, v3
    v_xor_b32 v8, v8, v7
    v_lshl_add_u32 v21, v8, 4, v6
    v_add_u32 v8, 4, v3
    v_xor_b32 v8, v8, v7
    v_lshl_add_u32 v22, v8, 4, v6
    v_add_u32 v8, 6, v3
    v_xor_b32 v8, v8, v7
    v_lshl_add_u32 v23, v8, 4, v6
    v_lshlrev_b32 v6, 10, v3
    v_bfe_u32 v7, v2, 2, 2
    v_lshl_add_u32 v6, v7, 7, v6
    v_bfe_u32 v8, v2, 3, 1
    v_xor_b32 v8, s22, v8
    v_lshl_add_u32 v6, v8, 6, v6
    v_bfe_u32 v8, v2, 4, 1
    v_lshlrev_b32 v8, 5, v8
    v_and_b32 v9, 3, v2
    v_lshl_add_u32 v8, v9, 3, v8
    v_add_u32 v6, v6, v8
    v_add_u32 v36, 16384, v6
    v_lshl_add_u32 v7, v3, 2, v7
    v_lshl_add_u32 v12, v7, 6, v8
    s_lshl_b32 s12, s22, 11
    s_add_u32 s12, s12, 155648
    v_add_u32 v12, s12, v12
    v_lshlrev_b32 v6, 14, v3
    v_lshl_add_u32 v6, v4, 4, v6
    v_lshlrev_b32 v7, 9, v3
    s_lshl_b32 s12, s22, 3
    s_lshl_b32 s13, s21, 2
    s_add_u32 s12, s12, s13
    s_lshl_b32 s13, s12, 14
    s_lshl_b32 s14, s19, 18
    s_add_u32 s13, s13, s14
    s_lshl_b32 s14, s18, 10
    s_add_u32 s13, s13, s14
    s_add_u32 s40, s13, 1048576
    s_add_u32 s41, s40, 32768
    s_lshl_b32 s13, s12, 9
    s_lshl_b32 s14, s19, 13
    s_add_u32 s13, s13, s14
    s_lshl_b32 s14, s18, 5
    s_add_u32 s13, s13, s14
    s_add_u32 s42, s13, 196608
    s_lshl_b32 s13, s21, 4
    s_lshl_b32 s44, 1, s13
    s_xor_b32 s13, s13, 16
    s_lshl_b32 s45, 1, s13
    v_mov_b32 v68, 0
    v_mov_b32 v69, 0
    v_mov_b32 v70, 0
    v_mov_b32 v71, 0
    v_mov_b32 v160, 0
    v_mov_b32 v161, 0
    v_mov_b32 v162, 0
    v_mov_b32 v163, 0
    v_mov_b32 v164, 0
    v_mov_b32 v165, 0
    v_mov_b32 v166, 0
    v_mov_b32 v167, 0
    v_mov_b32 v168, 0
    v_mov_b32 v169, 0
    v_mov_b32 v170, 0
    v_mov_b32 v171, 0
    v_mov_b32 v172, 0
    v_mov_b32 v173, 0
    v_mov_b32 v174, 0
    v_mov_b32 v175, 0
    v_mov_b32 v176, 0
    v_mov_b32 v177, 0
    v_mov_b32 v178, 0
    v_mov_b32 v179, 0
    v_mov_b32 v180, 0
    v_mov_b32 v181, 0
    v_mov_b32 v182, 0
    v_mov_b32 v183, 0
    v_mov_b32 v184, 0
    v_mov_b32 v185, 0
    v_mov_b32 v186, 0
    v_mov_b32 v187, 0
    v_mov_b32 v188, 0
    v_mov_b32 v189, 0
    v_mov_b32 v190, 0
    v_mov_b32 v191, 0
    v_mov_b32 v192, 0
    v_mov_b32 v193, 0
    v_mov_b32 v194, 0
    v_mov_b32 v195, 0
    v_mov_b32 v196, 0
    v_mov_b32 v197, 0
    v_mov_b32 v198, 0
    v_mov_b32 v199, 0
    v_mov_b32 v200, 0
    v_mov_b32 v201, 0
    v_mov_b32 v202, 0
    v_mov_b32 v203, 0
    v_mov_b32 v204, 0
    v_mov_b32 v205, 0
    v_mov_b32 v206, 0
    v_mov_b32 v207, 0
    v_mov_b32 v208, 0
    v_mov_b32 v209, 0
    v_mov_b32 v210, 0
    v_mov_b32 v211, 0
    v_mov_b32 v212, 0
    v_mov_b32 v213, 0
    v_mov_b32 v214, 0
    v_mov_b32 v215, 0
    v_mov_b32 v216, 0
    v_mov_b32 v217, 0
    v_mov_b32 v218, 0
    v_mov_b32 v219, 0
    v_mov_b32 v220, 0
    v_mov_b32 v221, 0
    v_mov_b32 v222, 0
    v_mov_b32 v223, 0
    v_mov_b32 v224, 0
    v_mov_b32 v225, 0
    v_mov_b32 v226, 0
    v_mov_b32 v227, 0
    v_mov_b32 v228, 0
    v_mov_b32 v229, 0
    v_mov_b32 v230, 0
    v_mov_b32 v231, 0
    v_mov_b32 v232, 0
    v_mov_b32 v233, 0
    v_mov_b32 v234, 0
    v_mov_b32 v235, 0
    v_mov_b32 v236, 0
    v_mov_b32 v237, 0
    v_mov_b32 v238, 0
    v_mov_b32 v239, 0
    v_mov_b32 v240, 0
    v_mov_b32 v241, 0
    v_mov_b32 v242, 0
    v_mov_b32 v243, 0
    v_mov_b32 v244, 0
    v_mov_b32 v245, 0
    v_mov_b32 v246, 0
    v_mov_b32 v247, 0
    v_mov_b32 v248, 0
    v_mov_b32 v249, 0
    v_mov_b32 v250, 0
    v_mov_b32 v251, 0
    v_mov_b32 v252, 0
    v_mov_b32 v253, 0
    v_mov_b32 v254, 0
    v_mov_b32 v255, 0
    v_lshlrev_b32 v8, 2, v3
    v_sub_u32 v8, v4, v8
    v_mov_b32 v9, 0x3f80
    v_mov_b32 v10, 0x3f800000
    v_cmp_eq_u32 vcc, 0, v8
    s_nop 1
    v_cndmask_b32 v11, 0, v9, vcc
    v_cmp_eq_u32 vcc, 1, v8
    s_nop 1
    v_cndmask_b32 v48, v11, v10, vcc
    v_cmp_eq_u32 vcc, 2, v8
    s_nop 1
    v_cndmask_b32 v11, 0, v9, vcc
    v_cmp_eq_u32 vcc, 3, v8
    s_nop 1
    v_cndmask_b32 v49, v11, v10, vcc
    v_cmp_eq_u32 vcc, 8, v8
    s_nop 1
    v_cndmask_b32 v11, 0, v9, vcc
    v_cmp_eq_u32 vcc, 9, v8
    s_nop 1
    v_cndmask_b32 v50, v11, v10, vcc
    v_cmp_eq_u32 vcc, 10, v8
    s_nop 1
    v_cndmask_b32 v11, 0, v9, vcc
    v_cmp_eq_u32 vcc, 11, v8
    s_nop 1
    v_cndmask_b32 v51, v11, v10, vcc
    v_cmp_eq_u32 vcc, 16, v8
    s_nop 1
    v_cndmask_b32 v11, 0, v9, vcc
    v_cmp_eq_u32 vcc, 17, v8
    s_nop 1
    v_cndmask_b32 v52, v11, v10, vcc
    v_cmp_eq_u32 vcc, 18, v8
    s_nop 1
    v_cndmask_b32 v11, 0, v9, vcc
    v_cmp_eq_u32 vcc, 19, v8
    s_nop 1
    v_cndmask_b32 v53, v11, v10, vcc
    v_cmp_eq_u32 vcc, 24, v8
    s_nop 1
    v_cndmask_b32 v11, 0, v9, vcc
    v_cmp_eq_u32 vcc, 25, v8
    s_nop 1
    v_cndmask_b32 v54, v11, v10, vcc
    v_cmp_eq_u32 vcc, 26, v8
    s_nop 1
    v_cndmask_b32 v11, 0, v9, vcc
    v_cmp_eq_u32 vcc, 27, v8
    s_nop 1
    v_cndmask_b32 v55, v11, v10, vcc
    v_mov_b32 v9, 0x3f803f80
    v_cmp_gt_u32 vcc, 16, v4
    s_nop 1
    v_cndmask_b32 v56, 0, v9, vcc
    v_cndmask_b32 v60, v9, 0, vcc
    v_cndmask_b32 v57, 0, v9, vcc
    v_cndmask_b32 v61, v9, 0, vcc
    v_cndmask_b32 v58, 0, v9, vcc
    v_cndmask_b32 v62, v9, 0, vcc
    v_cndmask_b32 v59, 0, v9, vcc
    v_cndmask_b32 v63, v9, 0, vcc
    s_waitcnt lgkmcnt(0)
    s_mov_b32 s32, s62
    s_and_b32 s33, s63, 0xffff
    s_mov_b32 s34, 33554432
    s_mov_b32 s35, 0x00020000
    s_mov_b32 s24, s4
    s_and_b32 s25, s5, 0xffff
    s_mov_b32 s26, 4194304
    s_mov_b32 s27, 0x00020000
    s_cmp_lg_u32 s20, 0
    s_cbranch_scc1 L_c_noinit
    v_add_u32 v8, 162816, v5
    s_mov_b64 exec, 0xff
    ds_write_b128 v8, v[68:71]
    s_mov_b64 exec, -1
    s_cmp_lg_u32 s2, 0
    s_cbranch_scc1 L_c_noinit
    s_mov_b32 s72, s60
    s_and_b32 s73, s61, 0xffff
    s_mov_b32 s74, 256
    s_mov_b32 s75, 0x00020000
    s_memrealtime s[14:15]
    s_waitcnt lgkmcnt(0)
    s_mul_i32 s14, s14, 0x9e3779b1
    s_or_b32 s14, s14, 0x01010101
    v_mov_b32 v8, s14
    s_mov_b64 exec, 1
    buffer_store_dword v8, v68, s[72:75], 0 offen offset:4 sc1
    s_mov_b64 exec, -1
L_c_noinit:
    s_lshl_b32 s14, s22, 1
    s_add_u32 s15, s14, s21
    s_xor_b32 s14, s15, 1
    s_mul_i32 s14, s14, 4224
    s_mul_i32 s15, s15, 4224
    s_add_u32 s14, s14, 40960
    s_add_u32 s15, s15, 40960
    v_add_u32 v8, s14, v5
    v_add_u32 v9, s15, v5
    v_lshlrev_b32 v11, 4, v3
    v_add_u32 v10, s14, v11
    v_add_u32 v11, s15, v11
    s_lshl_b32 s14, s20, 2
    s_add_u32 s15, s14, 162832
    v_mov_b32 v13, s15
    v_xor_b32 v14, 8, v13
    v_subrev_u32 v17, 16, v13
    v_mov_b32 v15, 1
    s_waitcnt lgkmcnt(0)
    s_barrier
    ds_read_b128 v[100:103], v20
    ds_read_b64_tr_b16 v[108:109], v36 offset:0
    ds_read_b64_tr_b16 v[110:111], v36 offset:512
    ds_read_b128 v[104:107], v20 offset:4096
    ds_read_b64_tr_b16 v[112:113], v36 offset:8192
    ds_read_b64_tr_b16 v[114:115], v36 offset:8704
    ds_read_b64_tr_b16 v[116:117], v36 offset:16384
    ds_read_b64_tr_b16 v[118:119], v36 offset:16896
    s_mov_b32 s48, 0
    s_mov_b32 s49, 0
.p2align 3
L_c_loop:
    s_add_u32 s49, s49, 1
    s_cmp_eq_u32 s49, 3
    s_mov_b32 s50, 40960
    s_cselect_b32 s50, 4294885376, s50
    s_cselect_b32 s49, 0, s49
    s_waitcnt lgkmcnt(5)
    v_mfma_f32_32x32x16_bf16 v[160:175], v[108:111], v[100:103], v[160:175]
    ds_read_b128 v[120:123], v21
    ds_read_b64_tr_b16 v[128:129], v36 offset:2048
    s_waitcnt lgkmcnt(6)
    v_mfma_f32_32x32x16_bf16 v[176:191], v[108:111], v[104:107], v[176:191]
    ds_read_b64_tr_b16 v[130:131], v36 offset:2560
    s_waitcnt lgkmcnt(5)
    v_mfma_f32_32x32x16_bf16 v[192:207], v[112:115], v[100:103], v[192:207]
    ds_read_b128 v[124:127], v21 offset:4096
    v_mfma_f32_32x32x16_bf16 v[208:223], v[112:115], v[104:107], v[208:223]
    ds_read_b64_tr_b16 v[132:133], v36 offset:10240
    ds_read_b64_tr_b16 v[134:135], v36 offset:10752
    s_waitcnt lgkmcnt(6)
    v_mfma_f32_32x32x16_bf16 v[224:239], v[100:103], v[116:119], v[224:239]
    ds_read_b64_tr_b16 v[136:137], v36 offset:18432
    v_add_u32 v21, s50, v21
    v_mfma_f32_32x32x16_bf16 v[240:255], v[104:107], v[116:119], v[240:255]
    ds_read_b64_tr_b16 v[138:139], v36 offset:18944
    v_add_u32 v20, s50, v20
    s_waitcnt lgkmcnt(5)
    v_mfma_f32_32x32x16_bf16 v[160:175], v[128:131], v[120:123], v[160:175]
    ds_read_b128 v[100:103], v22
    ds_read_b64_tr_b16 v[108:109], v36 offset:4096
    s_waitcnt lgkmcnt(6)
    v_mfma_f32_32x32x16_bf16 v[176:191], v[128:131], v[124:127], v[176:191]
    ds_read_b64_tr_b16 v[110:111], v36 offset:4608
    s_waitcnt lgkmcnt(5)
    v_mfma_f32_32x32x16_bf16 v[192:207], v[132:135], v[120:123], v[192:207]
    ds_read_b128 v[104:107], v22 offset:4096
    v_mfma_f32_32x32x16_bf16 v[208:223], v[132:135], v[124:127], v[208:223]
    ds_read_b64_tr_b16 v[112:113], v36 offset:12288
    ds_read_b64_tr_b16 v[114:115], v36 offset:12800
    s_waitcnt lgkmcnt(6)
    v_mfma_f32_32x32x16_bf16 v[224:239], v[120:123], v[136:139], v[224:239]
    ds_read_b64_tr_b16 v[116:117], v36 offset:20480
    v_add_u32 v22, s50, v22
    v_mfma_f32_32x32x16_bf16 v[240:255], v[124:127], v[136:139], v[240:255]
    ds_read_b64_tr_b16 v[118:119], v36 offset:20992
    s_waitcnt lgkmcnt(5)
    v_mfma_f32_32x32x16_bf16 v[160:175], v[108:111], v[100:103], v[160:175]
    ds_read_b128 v[120:123], v23
    ds_read_b64_tr_b16 v[128:129], v36 offset:6144
    ds_read_b64_tr_b16 v[130:131], v36 offset:6656
    s_waitcnt lgkmcnt(7)
    v_mfma_f32_32x32x16_bf16 v[176:191], v[108:111], v[104:107], v[176:191]
    ds_read_b128 v[124:127], v23 offset:4096
    ds_read_b64_tr_b16 v[132:133], v36 offset:14336
    ds_read_b64_tr_b16 v[134:135], v36 offset:14848
    s_waitcnt lgkmcnt(8)
    v_mfma_f32_32x32x16_bf16 v[192:207], v[112:115], v[100:103], v[192:207]
    ds_read_b64_tr_b16 v[136:137], v36 offset:22528
    ds_read_b64_tr_b16 v[138:139], v36 offset:23040
    v_mfma_f32_32x32x16_bf16 v[208:223], v[112:115], v[104:107], v[208:223]
    s_waitcnt lgkmcnt(8)
    v_mfma_f32_32x32x16_bf16 v[224:239], v[100:103], v[116:119], v[224:239]
    v_add_u32 v23, s50, v23
    v_mfma_f32_32x32x16_bf16 v[240:255], v[104:107], v[116:119], v[240:255]
    v_add_u32 v36, s50, v36
    s_waitcnt lgkmcnt(0)
    v_mfma_f32_32x32x16_bf16 v[160:175], v[128:131], v[120:123], v[160:175]
    s_barrier
    ds_read_b128 v[100:103], v20
    ds_read_b64_tr_b16 v[108:109], v36 offset:0
    ds_read_b64_tr_b16 v[110:111], v36 offset:512
    v_mfma_f32_32x32x16_bf16 v[176:191], v[128:131], v[124:127], v[176:191]
    ds_read_b128 v[104:107], v20 offset:4096
    ds_read_b64_tr_b16 v[112:113], v36 offset:8192
    ds_read_b64_tr_b16 v[114:115], v36 offset:8704
    v_mfma_f32_32x32x16_bf16 v[192:207], v[132:135], v[120:123], v[192:207]
    ds_read_b64_tr_b16 v[116:117], v36 offset:16384
    ds_read_b64_tr_b16 v[118:119], v36 offset:16896
    v_mfma_f32_32x32x16_bf16 v[208:223], v[132:135], v[124:127], v[208:223]
    v_mfma_f32_32x32x16_bf16 v[224:239], v[120:123], v[136:139], v[224:239]
    s_add_u32 s48, s48, 1
    s_cmp_lt_u32 s48, 15
    v_mfma_f32_32x32x16_bf16 v[240:255], v[124:127], v[136:139], v[240:255]
    s_cbranch_scc1 L_c_loop
    s_waitcnt lgkmcnt(5)
    v_mfma_f32_32x32x16_bf16 v[160:175], v[108:111], v[100:103], v[160:175]
    ds_read_b128 v[120:123], v21
    ds_read_b64_tr_b16 v[128:129], v36 offset:2048
    s_waitcnt lgkmcnt(6)
    v_mfma_f32_32x32x16_bf16 v[176:191], v[108:111], v[104:107], v[176:191]
    ds_read_b64_tr_b16 v[130:131], v36 offset:2560
    s_waitcnt lgkmcnt(5)
    v_mfma_f32_32x32x16_bf16 v[192:207], v[112:115], v[100:103], v[192:207]
    ds_read_b128 v[124:127], v21 offset:4096
    v_mfma_f32_32x32x16_bf16 v[208:223], v[112:115], v[104:107], v[208:223]
    ds_read_b64_tr_b16 v[132:133], v36 offset:10240
    ds_read_b64_tr_b16 v[134:135], v36 offset:10752
    s_waitcnt lgkmcnt(6)
    v_mfma_f32_32x32x16_bf16 v[224:239], v[100:103], v[116:119], v[224:239]
    ds_read_b64_tr_b16 v[136:137], v36 offset:18432
    v_mfma_f32_32x32x16_bf16 v[240:255], v[104:107], v[116:119], v[240:255]
    ds_read_b64_tr_b16 v[138:139], v36 offset:18944
    s_waitcnt lgkmcnt(5)
    v_mfma_f32_32x32x16_bf16 v[160:175], v[128:131], v[120:123], v[160:175]
    ds_read_b128 v[100:103], v22
    ds_read_b64_tr_b16 v[108:109], v36 offset:4096
    s_waitcnt lgkmcnt(6)
    v_mfma_f32_32x32x16_bf16 v[176:191], v[128:131], v[124:127], v[176:191]
    ds_read_b64_tr_b16 v[110:111], v36 offset:4608
    s_waitcnt lgkmcnt(5)
    v_mfma_f32_32x32x16_bf16 v[192:207], v[132:135], v[120:123], v[192:207]
    ds_read_b128 v[104:107], v22 offset:4096
    v_mfma_f32_32x32x16_bf16 v[208:223], v[132:135], v[124:127], v[208:223]
    ds_read_b64_tr_b16 v[112:113], v36 offset:12288
    ds_read_b64_tr_b16 v[114:115], v36 offset:12800
    s_waitcnt lgkmcnt(6)
    v_mfma_f32_32x32x16_bf16 v[224:239], v[120:123], v[136:139], v[224:239]
    ds_read_b64_tr_b16 v[116:117], v36 offset:20480
    v_mfma_f32_32x32x16_bf16 v[240:255], v[124:127], v[136:139], v[240:255]
    ds_read_b64_tr_b16 v[118:119], v36 offset:20992
    s_waitcnt lgkmcnt(5)
    v_mfma_f32_32x32x16_bf16 v[160:175], v[108:111], v[100:103], v[160:175]
    ds_read_b128 v[120:123], v23
    ds_read_b64_tr_b16 v[128:129], v36 offset:6144
    ds_read_b64_tr_b16 v[130:131], v36 offset:6656
    s_waitcnt lgkmcnt(7)
    v_mfma_f32_32x32x16_bf16 v[176:191], v[108:111], v[104:107], v[176:191]
    ds_read_b128 v[124:127], v23 offset:4096
    ds_read_b64_tr_b16 v[132:133], v36 offset:14336
    ds_read_b64_tr_b16 v[134:135], v36 offset:14848
    s_waitcnt lgkmcnt(8)
    v_mfma_f32_32x32x16_bf16 v[192:207], v[112:115], v[100:103], v[192:207]
    ds_read_b64_tr_b16 v[136:137], v36 offset:22528
    ds_read_b64_tr_b16 v[138:139], v36 offset:23040
    v_mfma_f32_32x32x16_bf16 v[208:223], v[112:115], v[104:107], v[208:223]
    s_waitcnt lgkmcnt(8)
    v_mfma_f32_32x32x16_bf16 v[224:239], v[100:103], v[116:119], v[224:239]
    v_mfma_f32_32x32x16_bf16 v[240:255], v[104:107], v[116:119], v[240:255]
    s_waitcnt lgkmcnt(0)
    v_mfma_f32_32x32x16_bf16 v[160:175], v[128:131], v[120:123], v[160:175]
    s_mov_b64 exec, 1
    ds_write_b32 v17, v15
    s_mov_b64 exec, -1
    ds_read_b64_tr_b16 v[40:41], v12 offset:0
    ds_read_b64_tr_b16 v[42:43], v12 offset:512
    ds_read_b64_tr_b16 v[44:45], v12 offset:1024
    ds_read_b64_tr_b16 v[46:47], v12 offset:1536
    v_mov_b32 v16, 162864
    ds_read_b96 v[24:26], v16
    v_mfma_f32_32x32x16_bf16 v[176:191], v[128:131], v[124:127], v[176:191]
    v_mfma_f32_32x32x16_bf16 v[192:207], v[132:135], v[120:123], v[192:207]
    v_mfma_f32_32x32x16_bf16 v[208:223], v[132:135], v[124:127], v[208:223]
    v_mfma_f32_32x32x16_bf16 v[224:239], v[120:123], v[136:139], v[224:239]
    v_mfma_f32_32x32x16_bf16 v[240:255], v[124:127], v[136:139], v[240:255]
    s_mov_b32 s48, 0x3fb8aa3b
    s_mov_b32 s52, 0xbfb8aa3b
    s_nop 6
    v_cvt_pk_bf16_f32 v64, v192, v193
    v_cvt_pk_bf16_f32 v65, v194, v195
    v_cvt_pk_bf16_f32 v66, v196, v197
    v_cvt_pk_bf16_f32 v67, v198, v199
    v_cvt_pk_bf16_f32 v68, v200, v201
    v_cvt_pk_bf16_f32 v69, v202, v203
    v_cvt_pk_bf16_f32 v70, v204, v205
    v_cvt_pk_bf16_f32 v71, v206, v207
    s_waitcnt lgkmcnt(0)
    v_mfma_f32_32x32x16_bf16 v[192:207], v[40:43], v[64:67], 0
    v_mfma_f32_32x32x16_bf16 v[192:207], v[44:47], v[68:71], v[192:207]
    v_cvt_pk_bf16_f32 v72, v208, v209
    v_cvt_pk_bf16_f32 v73, v210, v211
    v_cvt_pk_bf16_f32 v74, v212, v213
    v_cvt_pk_bf16_f32 v75, v214, v215
    v_cvt_pk_bf16_f32 v76, v216, v217
    v_cvt_pk_bf16_f32 v77, v218, v219
    v_cvt_pk_bf16_f32 v78, v220, v221
    v_cvt_pk_bf16_f32 v79, v222, v223
    v_mfma_f32_32x32x16_bf16 v[208:223], v[40:43], v[72:75], 0
    s_nop 0
    v_mfma_f32_32x32x16_bf16 v[208:223], v[44:47], v[76:79], v[208:223]
    v_readfirstlane_b32 s72, v24
    v_readfirstlane_b32 s73, v25
    v_readfirstlane_b32 s74, v26
    v_and_b32 v27, 3, v2
    v_lshlrev_b32 v27, 3, v27
    v_bfe_u32 v27, v26, v27, 8
    v_mov_b32 v28, 0xffffff00
    s_and_b32 s76, s74, 0xff
    s_bfe_u32 s77, s74, 0x80008
    s_bfe_u32 s78, s74, 0x80010
    s_lshr_b32 s79, s74, 24
    v_cvt_pk_bf16_f32 v80, v224, v225
    v_cvt_pk_bf16_f32 v81, v226, v227
    v_cvt_pk_bf16_f32 v82, v228, v229
    v_cvt_pk_bf16_f32 v83, v230, v231
    v_cvt_pk_bf16_f32 v84, v232, v233
    v_cvt_pk_bf16_f32 v85, v234, v235
    v_cvt_pk_bf16_f32 v86, v236, v237
    v_cvt_pk_bf16_f32 v87, v238, v239
    v_cvt_pk_bf16_f32 v88, v240, v241
    v_cvt_pk_bf16_f32 v89, v242, v243
    v_cvt_pk_bf16_f32 v90, v244, v245
    v_cvt_pk_bf16_f32 v91, v246, v247
    v_cvt_pk_bf16_f32 v92, v248, v249
    v_cvt_pk_bf16_f32 v93, v250, v251
    v_cvt_pk_bf16_f32 v94, v252, v253
    v_cvt_pk_bf16_f32 v95, v254, v255
    v_cvt_pk_bf16_f32 v64, v192, v193
    v_cvt_pk_bf16_f32 v65, v194, v195
    v_cvt_pk_bf16_f32 v66, v196, v197
    v_cvt_pk_bf16_f32 v67, v198, v199
    v_cvt_pk_bf16_f32 v68, v200, v201
    v_cvt_pk_bf16_f32 v69, v202, v203
    v_cvt_pk_bf16_f32 v70, v204, v205
    v_cvt_pk_bf16_f32 v71, v206, v207
    v_lshlrev_b32 v192, 16, v64
    v_and_b32 v193, 0xffff0000, v64
    v_lshlrev_b32 v194, 16, v65
    v_and_b32 v195, 0xffff0000, v65
    v_lshlrev_b32 v196, 16, v66
    v_and_b32 v197, 0xffff0000, v66
    v_lshlrev_b32 v198, 16, v67
    v_and_b32 v199, 0xffff0000, v67
    v_lshlrev_b32 v200, 16, v68
    v_and_b32 v201, 0xffff0000, v68
    v_lshlrev_b32 v202, 16, v69
    v_and_b32 v203, 0xffff0000, v69
    v_lshlrev_b32 v204, 16, v70
    v_and_b32 v205, 0xffff0000, v70
    v_lshlrev_b32 v206, 16, v71
    v_and_b32 v207, 0xffff0000, v71
    v_cvt_pk_bf16_f32 v72, v208, v209
    v_cvt_pk_bf16_f32 v73, v210, v211
    v_cvt_pk_bf16_f32 v74, v212, v213
    v_cvt_pk_bf16_f32 v75, v214, v215
    v_cvt_pk_bf16_f32 v76, v216, v217
    v_cvt_pk_bf16_f32 v77, v218, v219
    v_cvt_pk_bf16_f32 v78, v220, v221
    v_cvt_pk_bf16_f32 v79, v222, v223
    v_lshlrev_b32 v208, 16, v72
    v_and_b32 v209, 0xffff0000, v72
    v_lshlrev_b32 v210, 16, v73
    v_and_b32 v211, 0xffff0000, v73
    v_lshlrev_b32 v212, 16, v74
    v_and_b32 v213, 0xffff0000, v74
    v_lshlrev_b32 v214, 16, v75
    v_and_b32 v215, 0xffff0000, v75
    v_lshlrev_b32 v216, 16, v76
    v_and_b32 v217, 0xffff0000, v76
    v_lshlrev_b32 v218, 16, v77
    v_and_b32 v219, 0xffff0000, v77
    v_lshlrev_b32 v220, 16, v78
    v_and_b32 v221, 0xffff0000, v78
    v_lshlrev_b32 v222, 16, v79
    v_and_b32 v223, 0xffff0000, v79
    v_max3_f32 v144, v192, v193, v194
    v_max3_f32 v145, v195, v196, v197
    v_max3_f32 v146, v198, v199, v200
    v_max3_f32 v147, v201, v202, v203
    v_max3_f32 v148, v204, v205, v206
    v_max3_f32 v144, v144, v145, v207
    v_max3_f32 v146, v146, v147, v148
    v_max_f32 v144, v144, v146
    v_min3_f32 v150, v192, v193, v194
    v_min3_f32 v151, v195, v196, v197
    v_min3_f32 v152, v198, v199, v200
    v_min3_f32 v153, v201, v202, v203
    v_min3_f32 v154, v204, v205, v206
    v_min3_f32 v150, v150, v151, v207
    v_min3_f32 v152, v152, v153, v154
    v_min_f32 v150, v150, v152
    v_mov_b32 v145, v144
    v_mov_b32 v151, v150
    s_nop 0
    v_permlane32_swap_b32 v144, v145
    v_permlane32_swap_b32 v150, v151
    v_max_f32 v144, v144, v145
    v_min_f32 v150, v150, v151
    v_mul_f32 v144, s52, v144
    v_mul_f32 v150, s48, v150
    v_pk_fma_f32 v[224:225], v[192:193], s[48:49], v[144:145] op_sel_hi:[1,0,0]
    v_pk_fma_f32 v[112:113], v[192:193], s[52:53], v[150:151] op_sel_hi:[1,0,0]
    v_pk_fma_f32 v[226:227], v[194:195], s[48:49], v[144:145] op_sel_hi:[1,0,0]
    v_pk_fma_f32 v[114:115], v[194:195], s[52:53], v[150:151] op_sel_hi:[1,0,0]
    v_pk_fma_f32 v[228:229], v[196:197], s[48:49], v[144:145] op_sel_hi:[1,0,0]
    v_pk_fma_f32 v[116:117], v[196:197], s[52:53], v[150:151] op_sel_hi:[1,0,0]
    v_pk_fma_f32 v[230:231], v[198:199], s[48:49], v[144:145] op_sel_hi:[1,0,0]
    v_pk_fma_f32 v[118:119], v[198:199], s[52:53], v[150:151] op_sel_hi:[1,0,0]
    v_pk_fma_f32 v[232:233], v[200:201], s[48:49], v[144:145] op_sel_hi:[1,0,0]
    v_pk_fma_f32 v[120:121], v[200:201], s[52:53], v[150:151] op_sel_hi:[1,0,0]
    v_pk_fma_f32 v[234:235], v[202:203], s[48:49], v[144:145] op_sel_hi:[1,0,0]
    v_pk_fma_f32 v[122:123], v[202:203], s[52:53], v[150:151] op_sel_hi:[1,0,0]
    v_pk_fma_f32 v[236:237], v[204:205], s[48:49], v[144:145] op_sel_hi:[1,0,0]
    v_pk_fma_f32 v[124:125], v[204:205], s[52:53], v[150:151] op_sel_hi:[1,0,0]
    v_pk_fma_f32 v[238:239], v[206:207], s[48:49], v[144:145] op_sel_hi:[1,0,0]
    v_pk_fma_f32 v[126:127], v[206:207], s[52:53], v[150:151] op_sel_hi:[1,0,0]
    v_exp_f32 v224, v224
    v_exp_f32 v112, v112
    v_exp_f32 v225, v225
    v_exp_f32 v113, v113
    v_exp_f32 v226, v226
    v_exp_f32 v114, v114
    v_exp_f32 v227, v227
    v_exp_f32 v115, v115
    v_exp_f32 v228, v228
    v_exp_f32 v116, v116
    v_exp_f32 v229, v229
    v_exp_f32 v117, v117
    v_exp_f32 v230, v230
    v_exp_f32 v118, v118
    v_exp_f32 v231, v231
    v_exp_f32 v119, v119
    v_exp_f32 v232, v232
    v_exp_f32 v120, v120
    v_exp_f32 v233, v233
    v_exp_f32 v121, v121
    v_exp_f32 v234, v234
    v_exp_f32 v122, v122
    v_exp_f32 v235, v235
    v_exp_f32 v123, v123
    v_exp_f32 v236, v236
    v_exp_f32 v124, v124
    v_exp_f32 v237, v237
    v_exp_f32 v125, v125
    v_exp_f32 v238, v238
    v_exp_f32 v126, v126
    v_exp_f32 v239, v239
    v_exp_f32 v127, v127
    v_pk_add_f32 v[144:145], v[224:225], v[226:227]
    v_pk_add_f32 v[146:147], v[228:229], v[230:231]
    v_pk_add_f32 v[148:149], v[232:233], v[234:235]
    v_pk_add_f32 v[150:151], v[112:113], v[114:115]
    v_pk_add_f32 v[152:153], v[116:117], v[118:119]
    v_pk_add_f32 v[154:155], v[120:121], v[122:123]
    v_pk_add_f32 v[144:145], v[144:145], v[236:237]
    v_pk_add_f32 v[146:147], v[146:147], v[238:239]
    v_pk_add_f32 v[150:151], v[150:151], v[124:125]
    v_pk_add_f32 v[152:153], v[152:153], v[126:127]
    v_pk_add_f32 v[144:145], v[144:145], v[148:149]
    v_pk_add_f32 v[150:151], v[150:151], v[154:155]
    v_pk_add_f32 v[144:145], v[144:145], v[146:147]
    v_pk_add_f32 v[150:151], v[150:151], v[152:153]
    v_add_f32 v144, v144, v145
    v_add_f32 v150, v150, v151
    v_mov_b32 v145, v144
    v_mov_b32 v151, v150
    s_nop 0
    v_permlane32_swap_b32 v144, v145
    v_permlane32_swap_b32 v150, v151
    v_add_f32 v144, v144, v145
    v_add_f32 v150, v150, v151
    v_rcp_f32 v144, v144
    v_rcp_f32 v150, v150
    v_pk_mul_f32 v[224:225], v[224:225], v[144:145] op_sel_hi:[1,0]
    v_pk_mul_f32 v[112:113], v[112:113], v[150:151] op_sel_hi:[1,0]
    v_pk_mul_f32 v[226:227], v[226:227], v[144:145] op_sel_hi:[1,0]
    v_pk_mul_f32 v[114:115], v[114:115], v[150:151] op_sel_hi:[1,0]
    v_pk_mul_f32 v[228:229], v[228:229], v[144:145] op_sel_hi:[1,0]
    v_pk_mul_f32 v[116:117], v[116:117], v[150:151] op_sel_hi:[1,0]
    v_pk_mul_f32 v[230:231], v[230:231], v[144:145] op_sel_hi:[1,0]
    v_pk_mul_f32 v[118:119], v[118:119], v[150:151] op_sel_hi:[1,0]
    v_pk_mul_f32 v[232:233], v[232:233], v[144:145] op_sel_hi:[1,0]
    v_pk_mul_f32 v[120:121], v[120:121], v[150:151] op_sel_hi:[1,0]
    v_pk_mul_f32 v[234:235], v[234:235], v[144:145] op_sel_hi:[1,0]
    v_pk_mul_f32 v[122:123], v[122:123], v[150:151] op_sel_hi:[1,0]
    v_pk_mul_f32 v[236:237], v[236:237], v[144:145] op_sel_hi:[1,0]
    v_pk_mul_f32 v[124:125], v[124:125], v[150:151] op_sel_hi:[1,0]
    v_pk_mul_f32 v[238:239], v[238:239], v[144:145] op_sel_hi:[1,0]
    v_pk_mul_f32 v[126:127], v[126:127], v[150:151] op_sel_hi:[1,0]
    v_cvt_pk_bf16_f32 v64, v224, v225
    v_cvt_pk_bf16_f32 v96, v112, v113
    v_cvt_pk_bf16_f32 v65, v226, v227
    v_cvt_pk_bf16_f32 v97, v114, v115
    v_cvt_pk_bf16_f32 v66, v228, v229
    v_cvt_pk_bf16_f32 v98, v116, v117
    v_cvt_pk_bf16_f32 v67, v230, v231
    v_cvt_pk_bf16_f32 v99, v118, v119
    v_cvt_pk_bf16_f32 v68, v232, v233
    v_cvt_pk_bf16_f32 v100, v120, v121
    v_cvt_pk_bf16_f32 v69, v234, v235
    v_cvt_pk_bf16_f32 v101, v122, v123
    v_cvt_pk_bf16_f32 v70, v236, v237
    v_cvt_pk_bf16_f32 v102, v124, v125
    v_cvt_pk_bf16_f32 v71, v238, v239
    v_cvt_pk_bf16_f32 v103, v126, v127
    v_mfma_f32_32x32x16_bf16 v[192:207], v[64:67], v[48:51], 0
    v_mfma_f32_32x32x16_bf16 v[192:207], v[68:71], v[52:55], v[192:207]
    v_mfma_f32_32x32x16_bf16 v[224:239], v[96:99], v[48:51], 0
    v_mfma_f32_32x32x16_bf16 v[224:239], v[100:103], v[52:55], v[224:239]
    v_max3_f32 v144, v208, v209, v210
    v_max3_f32 v145, v211, v212, v213
    v_max3_f32 v146, v214, v215, v216
    v_max3_f32 v147, v217, v218, v219
    v_max3_f32 v148, v220, v221, v222
    v_max3_f32 v144, v144, v145, v223
    v_max3_f32 v146, v146, v147, v148
    v_max_f32 v144, v144, v146
    v_min3_f32 v150, v208, v209, v210
    v_min3_f32 v151, v211, v212, v213
    v_min3_f32 v152, v214, v215, v216
    v_min3_f32 v153, v217, v218, v219
    v_min3_f32 v154, v220, v221, v222
    v_min3_f32 v150, v150, v151, v223
    v_min3_f32 v152, v152, v153, v154
    v_min_f32 v150, v150, v152
    v_mov_b32 v145, v144
    v_mov_b32 v151, v150
    s_nop 0
    v_permlane32_swap_b32 v144, v145
    v_permlane32_swap_b32 v150, v151
    v_max_f32 v144, v144, v145
    v_min_f32 v150, v150, v151
    v_mul_f32 v144, s52, v144
    v_mul_f32 v150, s48, v150
    v_pk_fma_f32 v[240:241], v[208:209], s[48:49], v[144:145] op_sel_hi:[1,0,0]
    v_pk_fma_f32 v[128:129], v[208:209], s[52:53], v[150:151] op_sel_hi:[1,0,0]
    v_pk_fma_f32 v[242:243], v[210:211], s[48:49], v[144:145] op_sel_hi:[1,0,0]
    v_pk_fma_f32 v[130:131], v[210:211], s[52:53], v[150:151] op_sel_hi:[1,0,0]
    v_pk_fma_f32 v[244:245], v[212:213], s[48:49], v[144:145] op_sel_hi:[1,0,0]
    v_pk_fma_f32 v[132:133], v[212:213], s[52:53], v[150:151] op_sel_hi:[1,0,0]
    v_pk_fma_f32 v[246:247], v[214:215], s[48:49], v[144:145] op_sel_hi:[1,0,0]
    v_pk_fma_f32 v[134:135], v[214:215], s[52:53], v[150:151] op_sel_hi:[1,0,0]
    v_pk_fma_f32 v[248:249], v[216:217], s[48:49], v[144:145] op_sel_hi:[1,0,0]
    v_pk_fma_f32 v[136:137], v[216:217], s[52:53], v[150:151] op_sel_hi:[1,0,0]
    v_pk_fma_f32 v[250:251], v[218:219], s[48:49], v[144:145] op_sel_hi:[1,0,0]
    v_pk_fma_f32 v[138:139], v[218:219], s[52:53], v[150:151] op_sel_hi:[1,0,0]
    v_pk_fma_f32 v[252:253], v[220:221], s[48:49], v[144:145] op_sel_hi:[1,0,0]
    v_pk_fma_f32 v[140:141], v[220:221], s[52:53], v[150:151] op_sel_hi:[1,0,0]
    v_pk_fma_f32 v[254:255], v[222:223], s[48:49], v[144:145] op_sel_hi:[1,0,0]
    v_pk_fma_f32 v[142:143], v[222:223], s[52:53], v[150:151] op_sel_hi:[1,0,0]
    v_exp_f32 v240, v240
    v_exp_f32 v128, v128
    v_exp_f32 v241, v241
    v_exp_f32 v129, v129
    v_exp_f32 v242, v242
    v_exp_f32 v130, v130
    v_exp_f32 v243, v243
    v_exp_f32 v131, v131
    v_exp_f32 v244, v244
    v_exp_f32 v132, v132
    v_exp_f32 v245, v245
    v_exp_f32 v133, v133
    v_exp_f32 v246, v246
    v_exp_f32 v134, v134
    v_exp_f32 v247, v247
    v_exp_f32 v135, v135
    v_exp_f32 v248, v248
    v_exp_f32 v136, v136
    v_exp_f32 v249, v249
    v_exp_f32 v137, v137
    v_exp_f32 v250, v250
    v_exp_f32 v138, v138
    v_exp_f32 v251, v251
    v_exp_f32 v139, v139
    v_exp_f32 v252, v252
    v_exp_f32 v140, v140
    v_exp_f32 v253, v253
    v_exp_f32 v141, v141
    v_exp_f32 v254, v254
    v_exp_f32 v142, v142
    v_exp_f32 v255, v255
    v_exp_f32 v143, v143
    v_pk_add_f32 v[144:145], v[240:241], v[242:243]
    v_pk_add_f32 v[146:147], v[244:245], v[246:247]
    v_pk_add_f32 v[148:149], v[248:249], v[250:251]
    v_pk_add_f32 v[150:151], v[128:129], v[130:131]
    v_pk_add_f32 v[152:153], v[132:133], v[134:135]
    v_pk_add_f32 v[154:155], v[136:137], v[138:139]
    v_pk_add_f32 v[144:145], v[144:145], v[252:253]
    v_pk_add_f32 v[146:147], v[146:147], v[254:255]
    v_pk_add_f32 v[150:151], v[150:151], v[140:141]
    v_pk_add_f32 v[152:153], v[152:153], v[142:143]
    v_pk_add_f32 v[144:145], v[144:145], v[148:149]
    v_pk_add_f32 v[150:151], v[150:151], v[154:155]
    v_pk_add_f32 v[144:145], v[144:145], v[146:147]
    v_pk_add_f32 v[150:151], v[150:151], v[152:153]
    v_add_f32 v144, v144, v145
    v_add_f32 v150, v150, v151
    v_mov_b32 v145, v144
    v_mov_b32 v151, v150
    s_nop 0
    v_permlane32_swap_b32 v144, v145
    v_permlane32_swap_b32 v150, v151
    v_add_f32 v144, v144, v145
    v_add_f32 v150, v150, v151
    v_rcp_f32 v144, v144
    v_rcp_f32 v150, v150
    v_pk_mul_f32 v[240:241], v[240:241], v[144:145] op_sel_hi:[1,0]
    v_pk_mul_f32 v[128:129], v[128:129], v[150:151] op_sel_hi:[1,0]
    v_pk_mul_f32 v[242:243], v[242:243], v[144:145] op_sel_hi:[1,0]
    v_pk_mul_f32 v[130:131], v[130:131], v[150:151] op_sel_hi:[1,0]
    v_pk_mul_f32 v[244:245], v[244:245], v[144:145] op_sel_hi:[1,0]
    v_pk_mul_f32 v[132:133], v[132:133], v[150:151] op_sel_hi:[1,0]
    v_pk_mul_f32 v[246:247], v[246:247], v[144:145] op_sel_hi:[1,0]
    v_pk_mul_f32 v[134:135], v[134:135], v[150:151] op_sel_hi:[1,0]
    v_pk_mul_f32 v[248:249], v[248:249], v[144:145] op_sel_hi:[1,0]
    v_pk_mul_f32 v[136:137], v[136:137], v[150:151] op_sel_hi:[1,0]
    v_pk_mul_f32 v[250:251], v[250:251], v[144:145] op_sel_hi:[1,0]
    v_pk_mul_f32 v[138:139], v[138:139], v[150:151] op_sel_hi:[1,0]
    v_pk_mul_f32 v[252:253], v[252:253], v[144:145] op_sel_hi:[1,0]
    v_pk_mul_f32 v[140:141], v[140:141], v[150:151] op_sel_hi:[1,0]
    v_pk_mul_f32 v[254:255], v[254:255], v[144:145] op_sel_hi:[1,0]
    v_pk_mul_f32 v[142:143], v[142:143], v[150:151] op_sel_hi:[1,0]
    v_cvt_pk_bf16_f32 v72, v240, v241
    v_cvt_pk_bf16_f32 v104, v128, v129
    v_cvt_pk_bf16_f32 v73, v242, v243
    v_cvt_pk_bf16_f32 v105, v130, v131
    v_cvt_pk_bf16_f32 v74, v244, v245
    v_cvt_pk_bf16_f32 v106, v132, v133
    v_cvt_pk_bf16_f32 v75, v246, v247
    v_cvt_pk_bf16_f32 v107, v134, v135
    v_cvt_pk_bf16_f32 v76, v248, v249
    v_cvt_pk_bf16_f32 v108, v136, v137
    v_cvt_pk_bf16_f32 v77, v250, v251
    v_cvt_pk_bf16_f32 v109, v138, v139
    v_cvt_pk_bf16_f32 v78, v252, v253
    v_cvt_pk_bf16_f32 v110, v140, v141
    v_cvt_pk_bf16_f32 v79, v254, v255
    v_cvt_pk_bf16_f32 v111, v142, v143
    v_mfma_f32_32x32x16_bf16 v[208:223], v[72:75], v[48:51], 0
    v_mfma_f32_32x32x16_bf16 v[208:223], v[76:79], v[52:55], v[208:223]
    v_mfma_f32_32x32x16_bf16 v[240:255], v[104:107], v[48:51], 0
    v_mfma_f32_32x32x16_bf16 v[240:255], v[108:111], v[52:55], v[240:255]
    v_cvt_pk_bf16_f32 v64, v192, v193
    v_cvt_pk_bf16_f32 v65, v194, v195
    v_cvt_pk_bf16_f32 v66, v196, v197
    v_cvt_pk_bf16_f32 v67, v198, v199
    v_cvt_pk_bf16_f32 v68, v200, v201
    v_cvt_pk_bf16_f32 v69, v202, v203
    v_cvt_pk_bf16_f32 v70, v204, v205
    v_cvt_pk_bf16_f32 v71, v206, v207
    v_cvt_pk_bf16_f32 v96, v224, v225
    v_cvt_pk_bf16_f32 v97, v226, v227
    v_cvt_pk_bf16_f32 v98, v228, v229
    v_cvt_pk_bf16_f32 v99, v230, v231
    v_cvt_pk_bf16_f32 v100, v232, v233
    v_cvt_pk_bf16_f32 v101, v234, v235
    v_cvt_pk_bf16_f32 v102, v236, v237
    v_cvt_pk_bf16_f32 v103, v238, v239
    v_mfma_f32_32x32x16_bf16 v[112:127], v[64:67], v[80:83], 0
    v_mfma_f32_32x32x16_bf16 v[112:127], v[68:71], v[84:87], v[112:127]
    v_mfma_f32_32x32x16_bf16 v[128:143], v[96:99], v[80:83], 0
    v_mfma_f32_32x32x16_bf16 v[128:143], v[100:103], v[84:87], v[128:143]
    v_mfma_f32_32x32x16_bf16 v[144:159], v[64:67], v[56:59], 0
    v_mfma_f32_32x32x16_bf16 v[144:159], v[68:71], v[56:59], v[144:159]
    v_mfma_f32_32x32x16_bf16 v[144:159], v[96:99], v[60:63], v[144:159]
    v_mfma_f32_32x32x16_bf16 v[144:159], v[100:103], v[60:63], v[144:159]
    v_cvt_pk_bf16_f32 v72, v208, v209
    v_cvt_pk_bf16_f32 v73, v210, v211
    v_cvt_pk_bf16_f32 v74, v212, v213
    v_cvt_pk_bf16_f32 v75, v214, v215
    v_cvt_pk_bf16_f32 v76, v216, v217
    v_cvt_pk_bf16_f32 v77, v218, v219
    v_cvt_pk_bf16_f32 v78, v220, v221
    v_cvt_pk_bf16_f32 v79, v222, v223
    v_cvt_pk_bf16_f32 v104, v240, v241
    v_cvt_pk_bf16_f32 v105, v242, v243
    v_cvt_pk_bf16_f32 v106, v244, v245
    v_cvt_pk_bf16_f32 v107, v246, v247
    v_cvt_pk_bf16_f32 v108, v248, v249
    v_cvt_pk_bf16_f32 v109, v250, v251
    v_cvt_pk_bf16_f32 v110, v252, v253
    v_cvt_pk_bf16_f32 v111, v254, v255
    v_mfma_f32_32x32x16_bf16 v[112:127], v[72:75], v[88:91], v[112:127]
    v_mfma_f32_32x32x16_bf16 v[112:127], v[76:79], v[92:95], v[112:127]
    v_mfma_f32_32x32x16_bf16 v[128:143], v[104:107], v[88:91], v[128:143]
    v_mfma_f32_32x32x16_bf16 v[128:143], v[108:111], v[92:95], v[128:143]
    v_mfma_f32_32x32x16_bf16 v[144:159], v[72:75], v[56:59], v[144:159]
    v_mfma_f32_32x32x16_bf16 v[144:159], v[76:79], v[56:59], v[144:159]
    v_mfma_f32_32x32x16_bf16 v[144:159], v[104:107], v[60:63], v[144:159]
    v_mfma_f32_32x32x16_bf16 v[144:159], v[108:111], v[60:63], v[144:159]
    s_cmp_eq_u32 s21, 0
    s_cbranch_scc0 L_c_rw1
    s_nop 5
    ds_write_b128 v8, v[128:131] offset:0
    ds_write_b128 v8, v[132:135] offset:1024
    ds_write_b128 v8, v[136:139] offset:2048
    ds_write_b128 v8, v[140:143] offset:3072
    s_mov_b32 exec_lo, s45
    s_mov_b32 exec_hi, s45
    ds_write_b128 v10, v[144:147] offset:4096
    ds_write_b128 v10, v[148:151] offset:4128
    ds_write_b128 v10, v[152:155] offset:4160
    ds_write_b128 v10, v[156:159] offset:4192
    ds_write_b32 v13, v15
    s_mov_b64 exec, -1
    s_mov_b32 s13, 0
L_c_x0:
    ds_read_b32 v16, v14
    ds_read_b128 v[192:195], v9 offset:0
    ds_read_b128 v[196:199], v9 offset:1024
    ds_read_b128 v[200:203], v9 offset:2048
    ds_read_b128 v[204:207], v9 offset:3072
    ds_read_b128 v[208:211], v11 offset:4096
    ds_read_b128 v[212:215], v11 offset:4128
    ds_read_b128 v[216:219], v11 offset:4160
    ds_read_b128 v[220:223], v11 offset:4192
    s_add_u32 s13, s13, 1
    s_cmp_ge_u32 s13, 262144
    s_cbranch_scc1 L_c_y0
    s_waitcnt lgkmcnt(8)
    v_cmp_eq_u32 vcc, 1, v16
    s_cbranch_vccz L_c_x0
L_c_y0:
    s_waitcnt lgkmcnt(4)
    v_pk_add_f32 v[112:113], v[112:113], v[192:193]
    v_pk_add_f32 v[114:115], v[114:115], v[194:195]
    v_pk_add_f32 v[116:117], v[116:117], v[196:197]
    v_pk_add_f32 v[118:119], v[118:119], v[198:199]
    v_pk_add_f32 v[120:121], v[120:121], v[200:201]
    v_pk_add_f32 v[122:123], v[122:123], v[202:203]
    v_pk_add_f32 v[124:125], v[124:125], v[204:205]
    v_pk_add_f32 v[126:127], v[126:127], v[206:207]
    v_and_or_b32 v112, v112, v28, v27
    buffer_store_dwordx4 v[112:115], v6, s[32:35], s40 offen offset:0 sc1
    v_and_or_b32 v116, v116, v28, v27
    buffer_store_dwordx4 v[116:119], v6, s[32:35], s40 offen offset:512 sc1
    v_and_or_b32 v120, v120, v28, v27
    buffer_store_dwordx4 v[120:123], v6, s[32:35], s41 offen offset:0 sc1
    v_and_or_b32 v124, v124, v28, v27
    buffer_store_dwordx4 v[124:127], v6, s[32:35], s41 offen offset:512 sc1
    s_branch L_c_zs
L_c_rw1:
    s_nop 7
    ds_write_b128 v8, v[112:115] offset:0
    ds_write_b128 v8, v[116:119] offset:1024
    ds_write_b128 v8, v[120:123] offset:2048
    ds_write_b128 v8, v[124:127] offset:3072
    s_mov_b32 exec_lo, s45
    s_mov_b32 exec_hi, s45
    ds_write_b128 v10, v[144:147] offset:4096
    ds_write_b128 v10, v[148:151] offset:4128
    ds_write_b128 v10, v[152:155] offset:4160
    ds_write_b128 v10, v[156:159] offset:4192
    ds_write_b32 v13, v15
    s_mov_b64 exec, -1
    s_mov_b32 s13, 0
L_c_x1:
    ds_read_b32 v16, v14
    ds_read_b128 v[192:195], v9 offset:0
    ds_read_b128 v[196:199], v9 offset:1024
    ds_read_b128 v[200:203], v9 offset:2048
    ds_read_b128 v[204:207], v9 offset:3072
    ds_read_b128 v[208:211], v11 offset:4096
    ds_read_b128 v[212:215], v11 offset:4128
    ds_read_b128 v[216:219], v11 offset:4160
    ds_read_b128 v[220:223], v11 offset:4192
    s_add_u32 s13, s13, 1
    s_cmp_ge_u32 s13, 262144
    s_cbranch_scc1 L_c_y1
    s_waitcnt lgkmcnt(8)
    v_cmp_eq_u32 vcc, 1, v16
    s_cbranch_vccz L_c_x1
L_c_y1:
    s_waitcnt lgkmcnt(4)
    v_pk_add_f32 v[128:129], v[128:129], v[192:193]
    v_pk_add_f32 v[130:131], v[130:131], v[194:195]
    v_pk_add_f32 v[132:133], v[132:133], v[196:197]
    v_pk_add_f32 v[134:135], v[134:135], v[198:199]
    v_pk_add_f32 v[136:137], v[136:137], v[200:201]
    v_pk_add_f32 v[138:139], v[138:139], v[202:203]
    v_pk_add_f32 v[140:141], v[140:141], v[204:205]
    v_pk_add_f32 v[142:143], v[142:143], v[206:207]
    v_and_or_b32 v128, v128, v28, v27
    buffer_store_dwordx4 v[128:131], v6, s[32:35], s40 offen offset:0 sc1
    v_and_or_b32 v132, v132, v28, v27
    buffer_store_dwordx4 v[132:135], v6, s[32:35], s40 offen offset:512 sc1
    v_and_or_b32 v136, v136, v28, v27
    buffer_store_dwordx4 v[136:139], v6, s[32:35], s41 offen offset:0 sc1
    v_and_or_b32 v140, v140, v28, v27
    buffer_store_dwordx4 v[140:143], v6, s[32:35], s41 offen offset:512 sc1
L_c_zs:
    s_waitcnt lgkmcnt(0)
    v_pk_add_f32 v[144:145], v[144:145], v[208:209]
    v_pk_add_f32 v[146:147], v[146:147], v[210:211]
    v_pk_add_f32 v[148:149], v[148:149], v[212:213]
    v_pk_add_f32 v[150:151], v[150:151], v[214:215]
    v_pk_add_f32 v[152:153], v[152:153], v[216:217]
    v_pk_add_f32 v[154:155], v[154:155], v[218:219]
    v_pk_add_f32 v[156:157], v[156:157], v[220:221]
    v_pk_add_f32 v[158:159], v[158:159], v[222:223]
    v_and_or_b32 v144, v144, v28, s76
    v_and_or_b32 v145, v145, v28, s77
    v_and_or_b32 v146, v146, v28, s78
    v_and_or_b32 v147, v147, v28, s79
    v_and_or_b32 v148, v148, v28, s76
    v_and_or_b32 v149, v149, v28, s77
    v_and_or_b32 v150, v150, v28, s78
    v_and_or_b32 v151, v151, v28, s79
    v_and_or_b32 v152, v152, v28, s76
    v_and_or_b32 v153, v153, v28, s77
    v_and_or_b32 v154, v154, v28, s78
    v_and_or_b32 v155, v155, v28, s79
    v_and_or_b32 v156, v156, v28, s76
    v_and_or_b32 v157, v157, v28, s77
    v_and_or_b32 v158, v158, v28, s78
    v_and_or_b32 v159, v159, v28, s79
    s_mov_b32 exec_lo, s44
    s_mov_b32 exec_hi, s44
    buffer_store_dwordx4 v[144:147], v7, s[32:35], s42 offen offset:0 sc1
    buffer_store_dwordx4 v[148:151], v7, s[32:35], s42 offen offset:16 sc1
    buffer_store_dwordx4 v[152:155], v7, s[32:35], s42 offen offset:1024 sc1
    buffer_store_dwordx4 v[156:159], v7, s[32:35], s42 offen offset:1040 sc1
    s_mov_b64 exec, -1
    v_cvt_pk_bf16_f32 v64, v160, v161
    v_cvt_pk_bf16_f32 v65, v162, v163
    v_cvt_pk_bf16_f32 v66, v164, v165
    v_cvt_pk_bf16_f32 v67, v166, v167
    v_cvt_pk_bf16_f32 v68, v168, v169
    v_cvt_pk_bf16_f32 v69, v170, v171
    v_cvt_pk_bf16_f32 v70, v172, v173
    v_cvt_pk_bf16_f32 v71, v174, v175
    v_mfma_f32_32x32x16_bf16 v[160:175], v[40:43], v[64:67], 0
    s_nop 0
    v_mfma_f32_32x32x16_bf16 v[160:175], v[44:47], v[68:71], v[160:175]
    v_cvt_pk_bf16_f32 v72, v176, v177
    v_cvt_pk_bf16_f32 v73, v178, v179
    v_cvt_pk_bf16_f32 v74, v180, v181
    v_cvt_pk_bf16_f32 v75, v182, v183
    v_cvt_pk_bf16_f32 v76, v184, v185
    v_cvt_pk_bf16_f32 v77, v186, v187
    v_cvt_pk_bf16_f32 v78, v188, v189
    v_cvt_pk_bf16_f32 v79, v190, v191
    v_mfma_f32_32x32x16_bf16 v[176:191], v[40:43], v[72:75], 0
    s_nop 0
    v_mfma_f32_32x32x16_bf16 v[176:191], v[44:47], v[76:79], v[176:191]
    s_nop 0
    v_cvt_pk_bf16_f32 v64, v160, v161
    v_cvt_pk_bf16_f32 v65, v162, v163
    v_cvt_pk_bf16_f32 v66, v164, v165
    v_cvt_pk_bf16_f32 v67, v166, v167
    v_cvt_pk_bf16_f32 v68, v168, v169
    v_cvt_pk_bf16_f32 v69, v170, v171
    v_cvt_pk_bf16_f32 v70, v172, v173
    v_cvt_pk_bf16_f32 v71, v174, v175
    v_lshlrev_b32 v160, 16, v64
    v_and_b32 v161, 0xffff0000, v64
    v_lshlrev_b32 v162, 16, v65
    v_and_b32 v163, 0xffff0000, v65
    v_lshlrev_b32 v164, 16, v66
    v_and_b32 v165, 0xffff0000, v66
    v_lshlrev_b32 v166, 16, v67
    v_and_b32 v167, 0xffff0000, v67
    v_lshlrev_b32 v168, 16, v68
    v_and_b32 v169, 0xffff0000, v68
    v_lshlrev_b32 v170, 16, v69
    v_and_b32 v171, 0xffff0000, v69
    v_lshlrev_b32 v172, 16, v70
    v_and_b32 v173, 0xffff0000, v70
    v_lshlrev_b32 v174, 16, v71
    v_and_b32 v175, 0xffff0000, v71
    v_cvt_pk_bf16_f32 v72, v176, v177
    v_cvt_pk_bf16_f32 v73, v178, v179
    v_cvt_pk_bf16_f32 v74, v180, v181
    v_cvt_pk_bf16_f32 v75, v182, v183
    v_cvt_pk_bf16_f32 v76, v184, v185
    v_cvt_pk_bf16_f32 v77, v186, v187
    v_cvt_pk_bf16_f32 v78, v188, v189
    v_cvt_pk_bf16_f32 v79, v190, v191
    v_lshlrev_b32 v176, 16, v72
    v_and_b32 v177, 0xffff0000, v72
    v_lshlrev_b32 v178, 16, v73
    v_and_b32 v179, 0xffff0000, v73
    v_lshlrev_b32 v180, 16, v74
    v_and_b32 v181, 0xffff0000, v74
    v_lshlrev_b32 v182, 16, v75
    v_and_b32 v183, 0xffff0000, v75
    v_lshlrev_b32 v184, 16, v76
    v_and_b32 v185, 0xffff0000, v76
    v_lshlrev_b32 v186, 16, v77
    v_and_b32 v187, 0xffff0000, v77
    v_lshlrev_b32 v188, 16, v78
    v_and_b32 v189, 0xffff0000, v78
    v_lshlrev_b32 v190, 16, v79
    v_and_b32 v191, 0xffff0000, v79
    v_max3_f32 v24, v160, v161, v162
    v_max3_f32 v25, v163, v164, v165
    v_max3_f32 v26, v166, v167, v168
    v_max3_f32 v27, v169, v170, v171
    v_max3_f32 v28, v172, v173, v174
    v_max3_f32 v24, v24, v25, v175
    v_max3_f32 v26, v26, v27, v28
    v_max_f32 v24, v24, v26
    v_min3_f32 v30, v160, v161, v162
    v_min3_f32 v31, v163, v164, v165
    v_min3_f32 v32, v166, v167, v168
    v_min3_f32 v33, v169, v170, v171
    v_min3_f32 v34, v172, v173, v174
    v_min3_f32 v30, v30, v31, v175
    v_min3_f32 v32, v32, v33, v34
    v_min_f32 v30, v30, v32
    v_mov_b32 v25, v24
    v_mov_b32 v31, v30
    s_nop 0
    v_permlane32_swap_b32 v24, v25
    v_permlane32_swap_b32 v30, v31
    v_max_f32 v24, v24, v25
    v_min_f32 v30, v30, v31
    v_mul_f32 v24, s52, v24
    v_mul_f32 v30, s48, v30
    v_pk_fma_f32 v[192:193], v[160:161], s[48:49], v[24:25] op_sel_hi:[1,0,0]
    v_pk_fma_f32 v[224:225], v[160:161], s[52:53], v[30:31] op_sel_hi:[1,0,0]
    v_pk_fma_f32 v[194:195], v[162:163], s[48:49], v[24:25] op_sel_hi:[1,0,0]
    v_pk_fma_f32 v[226:227], v[162:163], s[52:53], v[30:31] op_sel_hi:[1,0,0]
    v_pk_fma_f32 v[196:197], v[164:165], s[48:49], v[24:25] op_sel_hi:[1,0,0]
    v_pk_fma_f32 v[228:229], v[164:165], s[52:53], v[30:31] op_sel_hi:[1,0,0]
    v_pk_fma_f32 v[198:199], v[166:167], s[48:49], v[24:25] op_sel_hi:[1,0,0]
    v_pk_fma_f32 v[230:231], v[166:167], s[52:53], v[30:31] op_sel_hi:[1,0,0]
    v_pk_fma_f32 v[200:201], v[168:169], s[48:49], v[24:25] op_sel_hi:[1,0,0]
    v_pk_fma_f32 v[232:233], v[168:169], s[52:53], v[30:31] op_sel_hi:[1,0,0]
    v_pk_fma_f32 v[202:203], v[170:171], s[48:49], v[24:25] op_sel_hi:[1,0,0]
    v_pk_fma_f32 v[234:235], v[170:171], s[52:53], v[30:31] op_sel_hi:[1,0,0]
    v_pk_fma_f32 v[204:205], v[172:173], s[48:49], v[24:25] op_sel_hi:[1,0,0]
    v_pk_fma_f32 v[236:237], v[172:173], s[52:53], v[30:31] op_sel_hi:[1,0,0]
    v_pk_fma_f32 v[206:207], v[174:175], s[48:49], v[24:25] op_sel_hi:[1,0,0]
    v_pk_fma_f32 v[238:239], v[174:175], s[52:53], v[30:31] op_sel_hi:[1,0,0]
    v_exp_f32 v192, v192
    v_exp_f32 v224, v224
    v_exp_f32 v193, v193
    v_exp_f32 v225, v225
    v_exp_f32 v194, v194
    v_exp_f32 v226, v226
    v_exp_f32 v195, v195
    v_exp_f32 v227, v227
    v_exp_f32 v196, v196
    v_exp_f32 v228, v228
    v_exp_f32 v197, v197
    v_exp_f32 v229, v229
    v_exp_f32 v198, v198
    v_exp_f32 v230, v230
    v_exp_f32 v199, v199
    v_exp_f32 v231, v231
    v_exp_f32 v200, v200
    v_exp_f32 v232, v232
    v_exp_f32 v201, v201
    v_exp_f32 v233, v233
    v_exp_f32 v202, v202
    v_exp_f32 v234, v234
    v_exp_f32 v203, v203
    v_exp_f32 v235, v235
    v_exp_f32 v204, v204
    v_exp_f32 v236, v236
    v_exp_f32 v205, v205
    v_exp_f32 v237, v237
    v_exp_f32 v206, v206
    v_exp_f32 v238, v238
    v_exp_f32 v207, v207
    v_exp_f32 v239, v239
    v_pk_add_f32 v[24:25], v[192:193], v[194:195]
    v_pk_add_f32 v[26:27], v[196:197], v[198:199]
    v_pk_add_f32 v[28:29], v[200:201], v[202:203]
    v_pk_add_f32 v[30:31], v[224:225], v[226:227]
    v_pk_add_f32 v[32:33], v[228:229], v[230:231]
    v_pk_add_f32 v[34:35], v[232:233], v[234:235]
    v_pk_add_f32 v[24:25], v[24:25], v[204:205]
    v_pk_add_f32 v[26:27], v[26:27], v[206:207]
    v_pk_add_f32 v[30:31], v[30:31], v[236:237]
    v_pk_add_f32 v[32:33], v[32:33], v[238:239]
    v_pk_add_f32 v[24:25], v[24:25], v[28:29]
    v_pk_add_f32 v[30:31], v[30:31], v[34:35]
    v_pk_add_f32 v[24:25], v[24:25], v[26:27]
    v_pk_add_f32 v[30:31], v[30:31], v[32:33]
    v_add_f32 v24, v24, v25
    v_add_f32 v30, v30, v31
    v_mov_b32 v25, v24
    v_mov_b32 v31, v30
    s_nop 0
    v_permlane32_swap_b32 v24, v25
    v_permlane32_swap_b32 v30, v31
    v_add_f32 v24, v24, v25
    v_add_f32 v30, v30, v31
    v_rcp_f32 v24, v24
    v_rcp_f32 v30, v30
    v_pk_mul_f32 v[192:193], v[192:193], v[24:25] op_sel_hi:[1,0]
    v_pk_mul_f32 v[224:225], v[224:225], v[30:31] op_sel_hi:[1,0]
    v_pk_mul_f32 v[194:195], v[194:195], v[24:25] op_sel_hi:[1,0]
    v_pk_mul_f32 v[226:227], v[226:227], v[30:31] op_sel_hi:[1,0]
    v_pk_mul_f32 v[196:197], v[196:197], v[24:25] op_sel_hi:[1,0]
    v_pk_mul_f32 v[228:229], v[228:229], v[30:31] op_sel_hi:[1,0]
    v_pk_mul_f32 v[198:199], v[198:199], v[24:25] op_sel_hi:[1,0]
    v_pk_mul_f32 v[230:231], v[230:231], v[30:31] op_sel_hi:[1,0]
    v_pk_mul_f32 v[200:201], v[200:201], v[24:25] op_sel_hi:[1,0]
    v_pk_mul_f32 v[232:233], v[232:233], v[30:31] op_sel_hi:[1,0]
    v_pk_mul_f32 v[202:203], v[202:203], v[24:25] op_sel_hi:[1,0]
    v_pk_mul_f32 v[234:235], v[234:235], v[30:31] op_sel_hi:[1,0]
    v_pk_mul_f32 v[204:205], v[204:205], v[24:25] op_sel_hi:[1,0]
    v_pk_mul_f32 v[236:237], v[236:237], v[30:31] op_sel_hi:[1,0]
    v_pk_mul_f32 v[206:207], v[206:207], v[24:25] op_sel_hi:[1,0]
    v_pk_mul_f32 v[238:239], v[238:239], v[30:31] op_sel_hi:[1,0]
    v_cvt_pk_bf16_f32 v80, v192, v193
    v_cvt_pk_bf16_f32 v88, v224, v225
    v_cvt_pk_bf16_f32 v81, v194, v195
    v_cvt_pk_bf16_f32 v89, v226, v227
    v_cvt_pk_bf16_f32 v82, v196, v197
    v_cvt_pk_bf16_f32 v90, v228, v229
    v_cvt_pk_bf16_f32 v83, v198, v199
    v_cvt_pk_bf16_f32 v91, v230, v231
    v_cvt_pk_bf16_f32 v84, v200, v201
    v_cvt_pk_bf16_f32 v92, v232, v233
    v_cvt_pk_bf16_f32 v85, v202, v203
    v_cvt_pk_bf16_f32 v93, v234, v235
    v_cvt_pk_bf16_f32 v86, v204, v205
    v_cvt_pk_bf16_f32 v94, v236, v237
    v_cvt_pk_bf16_f32 v87, v206, v207
    v_cvt_pk_bf16_f32 v95, v238, v239
    v_max3_f32 v24, v176, v177, v178
    v_max3_f32 v25, v179, v180, v181
    v_max3_f32 v26, v182, v183, v184
    v_max3_f32 v27, v185, v186, v187
    v_max3_f32 v28, v188, v189, v190
    v_max3_f32 v24, v24, v25, v191
    v_max3_f32 v26, v26, v27, v28
    v_max_f32 v24, v24, v26
    v_min3_f32 v30, v176, v177, v178
    v_min3_f32 v31, v179, v180, v181
    v_min3_f32 v32, v182, v183, v184
    v_min3_f32 v33, v185, v186, v187
    v_min3_f32 v34, v188, v189, v190
    v_min3_f32 v30, v30, v31, v191
    v_min3_f32 v32, v32, v33, v34
    v_min_f32 v30, v30, v32
    v_mov_b32 v25, v24
    v_mov_b32 v31, v30
    s_nop 0
    v_permlane32_swap_b32 v24, v25
    v_permlane32_swap_b32 v30, v31
    v_max_f32 v24, v24, v25
    v_min_f32 v30, v30, v31
    v_mul_f32 v24, s52, v24
    v_mul_f32 v30, s48, v30
    v_pk_fma_f32 v[208:209], v[176:177], s[48:49], v[24:25] op_sel_hi:[1,0,0]
    v_pk_fma_f32 v[240:241], v[176:177], s[52:53], v[30:31] op_sel_hi:[1,0,0]
    v_pk_fma_f32 v[210:211], v[178:179], s[48:49], v[24:25] op_sel_hi:[1,0,0]
    v_pk_fma_f32 v[242:243], v[178:179], s[52:53], v[30:31] op_sel_hi:[1,0,0]
    v_pk_fma_f32 v[212:213], v[180:181], s[48:49], v[24:25] op_sel_hi:[1,0,0]
    v_pk_fma_f32 v[244:245], v[180:181], s[52:53], v[30:31] op_sel_hi:[1,0,0]
    v_pk_fma_f32 v[214:215], v[182:183], s[48:49], v[24:25] op_sel_hi:[1,0,0]
    v_pk_fma_f32 v[246:247], v[182:183], s[52:53], v[30:31] op_sel_hi:[1,0,0]
    v_pk_fma_f32 v[216:217], v[184:185], s[48:49], v[24:25] op_sel_hi:[1,0,0]
    v_pk_fma_f32 v[248:249], v[184:185], s[52:53], v[30:31] op_sel_hi:[1,0,0]
    v_pk_fma_f32 v[218:219], v[186:187], s[48:49], v[24:25] op_sel_hi:[1,0,0]
    v_pk_fma_f32 v[250:251], v[186:187], s[52:53], v[30:31] op_sel_hi:[1,0,0]
    v_pk_fma_f32 v[220:221], v[188:189], s[48:49], v[24:25] op_sel_hi:[1,0,0]
    v_pk_fma_f32 v[252:253], v[188:189], s[52:53], v[30:31] op_sel_hi:[1,0,0]
    v_pk_fma_f32 v[222:223], v[190:191], s[48:49], v[24:25] op_sel_hi:[1,0,0]
    v_pk_fma_f32 v[254:255], v[190:191], s[52:53], v[30:31] op_sel_hi:[1,0,0]
    v_exp_f32 v208, v208
    v_exp_f32 v240, v240
    v_exp_f32 v209, v209
    v_exp_f32 v241, v241
    v_exp_f32 v210, v210
    v_exp_f32 v242, v242
    v_exp_f32 v211, v211
    v_exp_f32 v243, v243
    v_exp_f32 v212, v212
    v_exp_f32 v244, v244
    v_exp_f32 v213, v213
    v_exp_f32 v245, v245
    v_exp_f32 v214, v214
    v_exp_f32 v246, v246
    v_exp_f32 v215, v215
    v_exp_f32 v247, v247
    v_exp_f32 v216, v216
    v_exp_f32 v248, v248
    v_exp_f32 v217, v217
    v_exp_f32 v249, v249
    v_exp_f32 v218, v218
    v_exp_f32 v250, v250
    v_exp_f32 v219, v219
    v_exp_f32 v251, v251
    v_exp_f32 v220, v220
    v_exp_f32 v252, v252
    v_exp_f32 v221, v221
    v_exp_f32 v253, v253
    v_exp_f32 v222, v222
    v_exp_f32 v254, v254
    v_exp_f32 v223, v223
    v_exp_f32 v255, v255
    v_pk_add_f32 v[24:25], v[208:209], v[210:211]
    v_pk_add_f32 v[26:27], v[212:213], v[214:215]
    v_pk_add_f32 v[28:29], v[216:217], v[218:219]
    v_pk_add_f32 v[30:31], v[240:241], v[242:243]
    v_pk_add_f32 v[32:33], v[244:245], v[246:247]
    v_pk_add_f32 v[34:35], v[248:249], v[250:251]
    v_pk_add_f32 v[24:25], v[24:25], v[220:221]
    v_pk_add_f32 v[26:27], v[26:27], v[222:223]
    v_pk_add_f32 v[30:31], v[30:31], v[252:253]
    v_pk_add_f32 v[32:33], v[32:33], v[254:255]
    v_pk_add_f32 v[24:25], v[24:25], v[28:29]
    v_pk_add_f32 v[30:31], v[30:31], v[34:35]
    v_pk_add_f32 v[24:25], v[24:25], v[26:27]
    v_pk_add_f32 v[30:31], v[30:31], v[32:33]
    v_add_f32 v24, v24, v25
    v_add_f32 v30, v30, v31
    v_mov_b32 v25, v24
    v_mov_b32 v31, v30
    s_nop 0
    v_permlane32_swap_b32 v24, v25
    v_permlane32_swap_b32 v30, v31
    v_add_f32 v24, v24, v25
    v_add_f32 v30, v30, v31
    v_rcp_f32 v24, v24
    v_rcp_f32 v30, v30
    v_pk_mul_f32 v[208:209], v[208:209], v[24:25] op_sel_hi:[1,0]
    v_pk_mul_f32 v[240:241], v[240:241], v[30:31] op_sel_hi:[1,0]
    v_pk_mul_f32 v[210:211], v[210:211], v[24:25] op_sel_hi:[1,0]
    v_pk_mul_f32 v[242:243], v[242:243], v[30:31] op_sel_hi:[1,0]
    v_pk_mul_f32 v[212:213], v[212:213], v[24:25] op_sel_hi:[1,0]
    v_pk_mul_f32 v[244:245], v[244:245], v[30:31] op_sel_hi:[1,0]
    v_pk_mul_f32 v[214:215], v[214:215], v[24:25] op_sel_hi:[1,0]
    v_pk_mul_f32 v[246:247], v[246:247], v[30:31] op_sel_hi:[1,0]
    v_pk_mul_f32 v[216:217], v[216:217], v[24:25] op_sel_hi:[1,0]
    v_pk_mul_f32 v[248:249], v[248:249], v[30:31] op_sel_hi:[1,0]
    v_pk_mul_f32 v[218:219], v[218:219], v[24:25] op_sel_hi:[1,0]
    v_pk_mul_f32 v[250:251], v[250:251], v[30:31] op_sel_hi:[1,0]
    v_pk_mul_f32 v[220:221], v[220:221], v[24:25] op_sel_hi:[1,0]
    v_pk_mul_f32 v[252:253], v[252:253], v[30:31] op_sel_hi:[1,0]
    v_pk_mul_f32 v[222:223], v[222:223], v[24:25] op_sel_hi:[1,0]
    v_pk_mul_f32 v[254:255], v[254:255], v[30:31] op_sel_hi:[1,0]
    v_cvt_pk_bf16_f32 v96, v208, v209
    v_cvt_pk_bf16_f32 v104, v240, v241
    v_cvt_pk_bf16_f32 v97, v210, v211
    v_cvt_pk_bf16_f32 v105, v242, v243
    v_cvt_pk_bf16_f32 v98, v212, v213
    v_cvt_pk_bf16_f32 v106, v244, v245
    v_cvt_pk_bf16_f32 v99, v214, v215
    v_cvt_pk_bf16_f32 v107, v246, v247
    v_cvt_pk_bf16_f32 v100, v216, v217
    v_cvt_pk_bf16_f32 v108, v248, v249
    v_cvt_pk_bf16_f32 v101, v218, v219
    v_cvt_pk_bf16_f32 v109, v250, v251
    v_cvt_pk_bf16_f32 v102, v220, v221
    v_cvt_pk_bf16_f32 v110, v252, v253
    v_cvt_pk_bf16_f32 v103, v222, v223
    v_cvt_pk_bf16_f32 v111, v254, v255
    s_lshl_b32 s12, s19, 1
    s_add_u32 s23, s12, s22
    s_lshl_b32 s12, s23, 12
    s_add_u32 s12, s12, 32768
    s_lshl_b32 s14, s23, 7
    s_add_u32 s14, s14, 163840
    v_lshlrev_b32 v16, 4, v3
    s_lshl_b32 s40, s18, 1
    s_add_u32 s40, s40, s21
    s_lshl_b32 s41, s40, 6
    s_add_u32 s41, s41, s23
    s_lshl_b32 s41, s41, 11
    s_add_u32 s41, s41, 8388608
    s_add_u32 s42, s41, 65536
    s_lshl_b32 s40, s40, 5
    s_add_u32 s40, s40, s23
    s_lshl_b32 s40, s40, 2
    s_add_u32 s40, s40, 16384
    s_sub_u32 s21, s72, 1
    s_mov_b32 s22, s73
    s_mov_b32 s23, s74
    v_lshlrev_b32 v24, 2, v4
    s_mov_b32 s13, 0
L_c_kz:
    buffer_load_dword v17, v24, s[32:35], s14 offen sc1
    s_add_u32 s13, s13, 1
    s_cmp_ge_u32 s13, 16384
    s_cbranch_scc1 L_c_kzok
    s_waitcnt vmcnt(0)
    v_cmp_eq_u32 vcc, -1, v17
    s_nop 1
    s_bcnt1_i32_b32 s15, vcc_lo
    s_cmp_gt_u32 s15, 8
    s_cbranch_scc1 L_c_kz
L_c_kzok:
L_c_kv:
    buffer_load_dwordx4 v[112:115], v5, s[32:35], s12 offen offset:0 sc1
    buffer_load_dwordx4 v[116:119], v5, s[32:35], s12 offen offset:1024 sc1
    buffer_load_dwordx4 v[120:123], v5, s[32:35], s12 offen offset:2048 sc1
    buffer_load_dwordx4 v[124:127], v5, s[32:35], s12 offen offset:3072 sc1
    buffer_load_dwordx4 v[128:131], v16, s[32:35], s14 offen offset:0 sc1
    buffer_load_dwordx4 v[132:135], v16, s[32:35], s14 offen offset:32 sc1
    buffer_load_dwordx4 v[136:139], v16, s[32:35], s14 offen offset:64 sc1
    buffer_load_dwordx4 v[140:143], v16, s[32:35], s14 offen offset:96 sc1
    s_add_u32 s13, s13, 1
    s_waitcnt vmcnt(0)
    v_max3_u32 v17, v112, v113, v114
    v_max3_u32 v17, v17, v115, v116
    v_max3_u32 v17, v17, v117, v118
    v_max3_u32 v17, v17, v119, v120
    v_max3_u32 v17, v17, v121, v122
    v_max3_u32 v17, v17, v123, v124
    v_max3_u32 v17, v17, v125, v126
    v_max3_u32 v17, v17, v127, v128
    v_max3_u32 v17, v17, v129, v130
    v_max3_u32 v17, v17, v131, v132
    v_max3_u32 v17, v17, v133, v134
    v_max3_u32 v17, v17, v135, v136
    v_max3_u32 v17, v17, v137, v138
    v_max3_u32 v17, v17, v139, v140
    v_max3_u32 v17, v17, v141, v142
    v_max_u32 v17, v17, v143
    v_cmp_eq_u32 vcc, -1, v17
    s_cbranch_vccz L_c_kvok
    s_cmp_lt_u32 s13, 16384
    s_cbranch_scc1 L_c_kv
L_c_kvok:
    v_mfma_f32_32x32x16_bf16 v[192:207], v[128:131], v[80:83], 0
    v_mfma_f32_32x32x16_bf16 v[160:175], v[112:115], v[80:83], 0
    v_mfma_f32_32x32x16_bf16 v[192:207], v[132:135], v[84:87], v[192:207]
    v_mfma_f32_32x32x16_bf16 v[160:175], v[116:119], v[84:87], v[160:175]
    v_mfma_f32_32x32x16_bf16 v[192:207], v[136:139], v[88:91], v[192:207]
    v_mfma_f32_32x32x16_bf16 v[160:175], v[120:123], v[88:91], v[160:175]
    v_mfma_f32_32x32x16_bf16 v[192:207], v[140:143], v[92:95], v[192:207]
    v_mfma_f32_32x32x16_bf16 v[160:175], v[124:127], v[92:95], v[160:175]
    v_mfma_f32_32x32x16_bf16 v[208:223], v[128:131], v[96:99], 0
    v_mfma_f32_32x32x16_bf16 v[176:191], v[112:115], v[96:99], 0
    v_mfma_f32_32x32x16_bf16 v[208:223], v[132:135], v[100:103], v[208:223]
    v_mfma_f32_32x32x16_bf16 v[176:191], v[116:119], v[100:103], v[176:191]
    v_mfma_f32_32x32x16_bf16 v[208:223], v[136:139], v[104:107], v[208:223]
    v_mfma_f32_32x32x16_bf16 v[176:191], v[120:123], v[104:107], v[176:191]
    v_mfma_f32_32x32x16_bf16 v[208:223], v[140:143], v[108:111], v[208:223]
    v_mfma_f32_32x32x16_bf16 v[176:191], v[124:127], v[108:111], v[176:191]
    s_nop 2
    v_cvt_pk_bf16_f32 v24, v192, v192
    v_lshlrev_b32 v24, 16, v24
    v_add_f32 v24, 0x358637bd, v24
    v_cvt_pk_bf16_f32 v24, v24, v24
    v_lshlrev_b32 v24, 16, v24
    v_rcp_f32 v24, v24
    v_cvt_pk_bf16_f32 v64, v160, v161
    v_cvt_pk_bf16_f32 v65, v162, v163
    v_cvt_pk_bf16_f32 v66, v164, v165
    v_cvt_pk_bf16_f32 v67, v166, v167
    v_cvt_pk_bf16_f32 v68, v168, v169
    v_cvt_pk_bf16_f32 v69, v170, v171
    v_cvt_pk_bf16_f32 v70, v172, v173
    v_cvt_pk_bf16_f32 v71, v174, v175
    v_lshlrev_b32 v160, 16, v64
    v_and_b32 v161, 0xffff0000, v64
    v_lshlrev_b32 v162, 16, v65
    v_and_b32 v163, 0xffff0000, v65
    v_lshlrev_b32 v164, 16, v66
    v_and_b32 v165, 0xffff0000, v66
    v_lshlrev_b32 v166, 16, v67
    v_and_b32 v167, 0xffff0000, v67
    v_lshlrev_b32 v168, 16, v68
    v_and_b32 v169, 0xffff0000, v68
    v_lshlrev_b32 v170, 16, v69
    v_and_b32 v171, 0xffff0000, v69
    v_lshlrev_b32 v172, 16, v70
    v_and_b32 v173, 0xffff0000, v70
    v_lshlrev_b32 v174, 16, v71
    v_and_b32 v175, 0xffff0000, v71
    v_pk_mul_f32 v[160:161], v[160:161], v[24:25] op_sel_hi:[1,0]
    v_pk_mul_f32 v[162:163], v[162:163], v[24:25] op_sel_hi:[1,0]
    v_pk_mul_f32 v[164:165], v[164:165], v[24:25] op_sel_hi:[1,0]
    v_pk_mul_f32 v[166:167], v[166:167], v[24:25] op_sel_hi:[1,0]
    v_pk_mul_f32 v[168:169], v[168:169], v[24:25] op_sel_hi:[1,0]
    v_pk_mul_f32 v[170:171], v[170:171], v[24:25] op_sel_hi:[1,0]
    v_pk_mul_f32 v[172:173], v[172:173], v[24:25] op_sel_hi:[1,0]
    v_pk_mul_f32 v[174:175], v[174:175], v[24:25] op_sel_hi:[1,0]
    v_cvt_pk_bf16_f32 v64, v160, v161
    v_cvt_pk_bf16_f32 v65, v162, v163
    v_cvt_pk_bf16_f32 v66, v164, v165
    v_cvt_pk_bf16_f32 v67, v166, v167
    v_cvt_pk_bf16_f32 v68, v168, v169
    v_cvt_pk_bf16_f32 v69, v170, v171
    v_cvt_pk_bf16_f32 v70, v172, v173
    v_cvt_pk_bf16_f32 v71, v174, v175
    buffer_store_dwordx4 v[64:67], v5, s[32:35], s41 offen sc1
    buffer_store_dwordx4 v[68:71], v5, s[32:35], s41 offen offset:1024 sc1
    v_cvt_pk_bf16_f32 v26, v208, v208
    v_lshlrev_b32 v26, 16, v26
    v_add_f32 v26, 0x358637bd, v26
    v_cvt_pk_bf16_f32 v26, v26, v26
    v_lshlrev_b32 v26, 16, v26
    v_rcp_f32 v26, v26
    v_cvt_pk_bf16_f32 v72, v176, v177
    v_cvt_pk_bf16_f32 v73, v178, v179
    v_cvt_pk_bf16_f32 v74, v180, v181
    v_cvt_pk_bf16_f32 v75, v182, v183
    v_cvt_pk_bf16_f32 v76, v184, v185
    v_cvt_pk_bf16_f32 v77, v186, v187
    v_cvt_pk_bf16_f32 v78, v188, v189
    v_cvt_pk_bf16_f32 v79, v190, v191
    v_lshlrev_b32 v176, 16, v72
    v_and_b32 v177, 0xffff0000, v72
    v_lshlrev_b32 v178, 16, v73
    v_and_b32 v179, 0xffff0000, v73
    v_lshlrev_b32 v180, 16, v74
    v_and_b32 v181, 0xffff0000, v74
    v_lshlrev_b32 v182, 16, v75
    v_and_b32 v183, 0xffff0000, v75
    v_lshlrev_b32 v184, 16, v76
    v_and_b32 v185, 0xffff0000, v76
    v_lshlrev_b32 v186, 16, v77
    v_and_b32 v187, 0xffff0000, v77
    v_lshlrev_b32 v188, 16, v78
    v_and_b32 v189, 0xffff0000, v78
    v_lshlrev_b32 v190, 16, v79
    v_and_b32 v191, 0xffff0000, v79
    v_pk_mul_f32 v[176:177], v[176:177], v[26:27] op_sel_hi:[1,0]
    v_pk_mul_f32 v[178:179], v[178:179], v[26:27] op_sel_hi:[1,0]
    v_pk_mul_f32 v[180:181], v[180:181], v[26:27] op_sel_hi:[1,0]
    v_pk_mul_f32 v[182:183], v[182:183], v[26:27] op_sel_hi:[1,0]
    v_pk_mul_f32 v[184:185], v[184:185], v[26:27] op_sel_hi:[1,0]
    v_pk_mul_f32 v[186:187], v[186:187], v[26:27] op_sel_hi:[1,0]
    v_pk_mul_f32 v[188:189], v[188:189], v[26:27] op_sel_hi:[1,0]
    v_pk_mul_f32 v[190:191], v[190:191], v[26:27] op_sel_hi:[1,0]
    v_cvt_pk_bf16_f32 v72, v176, v177
    v_cvt_pk_bf16_f32 v73, v178, v179
    v_cvt_pk_bf16_f32 v74, v180, v181
    v_cvt_pk_bf16_f32 v75, v182, v183
    v_cvt_pk_bf16_f32 v76, v184, v185
    v_cvt_pk_bf16_f32 v77, v186, v187
    v_cvt_pk_bf16_f32 v78, v188, v189
    v_cvt_pk_bf16_f32 v79, v190, v191
    buffer_store_dwordx4 v[72:75], v5, s[32:35], s42 offen sc1
    buffer_store_dwordx4 v[76:79], v5, s[32:35], s42 offen offset:1024 sc1
    v_mov_b32 v16, s23
    v_mov_b32 v17, 0
    s_and_b32 s88, s16, 1
    s_lshl_b32 s88, s88, 1
    s_bfe_u32 s89, s16, 0x10001
    s_add_u32 s88, s88, s89
    s_lshl_b32 s88, s88, 2
    s_and_b32 s89, s17, 3
    s_add_u32 s88, s88, s89
    s_lshr_b32 s89, s16, 2
    s_lshl_b32 s89, s89, 3
    s_lshr_b32 s90, s17, 2
    s_add_u32 s89, s89, s90
    s_waitcnt vmcnt(0)
    s_mov_b64 exec, 1
    buffer_store_dword v16, v17, s[32:35], s40 offen sc1
    s_mov_b64 exec, -1
L_phaseb:
    s_setprio 0
    s_nop 4
    s_mov_b32 s68, s58
    s_and_b32 s69, s59, 0xffff
    s_mov_b32 s70, 4194304
    s_mov_b32 s71, 0x00020000
    s_and_b32 s90, s20, 3
    s_lshr_b32 s91, s20, 2
    s_lshl_b32 s12, s88, 3
    s_lshl_b32 s13, s90, 1
    s_add_u32 s12, s12, s13
    s_add_u32 s92, s12, s91
    s_lshl_b32 s12, s92, 4
    v_and_b32 v3, 15, v2
    v_add_u32 v6, s12, v3
    v_lshlrev_b32 v8, 2, v6
    v_bfe_u32 v9, v2, 4, 1
    v_lshrrev_b32 v10, 5, v2
    v_lshlrev_b32 v7, 11, v6
    v_lshl_add_u32 v7, v9, 6, v7
    v_lshl_add_u32 v7, v10, 4, v7
    s_lshl_b32 s12, s89, 7
    v_add_u32 v7, s12, v7
    s_mov_b32 s12, 4096
    buffer_load_dwordx4 v[24:27], v7, s[24:27], 0 offen
    buffer_load_dwordx4 v[28:31], v7, s[24:27], 0 offen offset:32
    buffer_load_dword v48, v8, s[32:35], s12 offen sc1
    v_lshlrev_b32 v12, 8, v3
    v_lshl_add_u32 v12, v9, 7, v12
    v_lshl_add_u32 v12, v10, 5, v12
    v_lshlrev_b32 v10, 9, v10
    v_bfe_u32 v11, v2, 2, 2
    v_lshl_add_u32 v10, v11, 7, v10
    v_bfe_u32 v11, v2, 3, 1
    v_lshl_add_u32 v10, v11, 6, v10
    v_lshl_add_u32 v10, v9, 5, v10
    v_and_b32 v11, 3, v2
    v_lshl_add_u32 v10, v11, 3, v10
    v_xor_b32 v11, 64, v10
    s_lshl_b32 s12, s91, 8
    v_xor_b32 v17, s12, v5
    v_lshlrev_b32 v8, 2, v3
    s_lshl_b32 s12, s20, 12
    s_mov_b32 s15, 40960
    s_cmp_lt_u32 s20, 6
    s_cselect_b32 s13, s15, 131072
    s_add_u32 s12, s12, s13
    v_add_u32 v20, s12, v5
    s_xor_b32 s14, s20, 4
    s_lshl_b32 s12, s14, 12
    s_cmp_lt_u32 s14, 6
    s_cselect_b32 s13, s15, 131072
    s_add_u32 s12, s12, s13
    v_add_u32 v21, s12, v5
    s_lshl_b32 s12, s88, 2
    s_add_u32 s12, s12, s90
    s_lshl_b32 s13, s12, 16
    s_lshl_b32 s14, s91, 15
    s_add_u32 s13, s13, s14
    s_add_u32 s95, s13, 8388608
    s_lshr_b32 s12, s12, 1
    s_lshl_b32 s12, s12, 7
    s_lshl_b32 s13, s91, 6
    s_add_u32 s12, s12, s13
    s_add_u32 s15, s12, 16384
    s_lshl_b32 s97, s91, 4
    s_and_b32 s93, s89, 7
    s_lshl_b32 s93, s93, 1
    s_mov_b32 s96, s93
    s_lshr_b32 s12, s21, 4
    s_cmp_lg_u32 s12, s92
    s_cbranch_scc1 L_b_noown
    s_lshl_b32 s12, s89, 12
    s_add_u32 s12, s12, 458752
    s_mov_b32 s13, 0
L_b_y:
    buffer_load_dwordx4 v[64:67], v12, s[32:35], s12 offen offset:0 sc1
    buffer_load_dwordx4 v[68:71], v12, s[32:35], s12 offen offset:16 sc1
    buffer_load_dwordx4 v[72:75], v12, s[32:35], s12 offen offset:64 sc1
    buffer_load_dwordx4 v[76:79], v12, s[32:35], s12 offen offset:80 sc1
    s_add_u32 s13, s13, 1
    s_waitcnt vmcnt(0)
    v_msad_u8 v80, v64, s76, 0
    v_msad_u8 v80, v65, s77, v80
    v_msad_u8 v80, v66, s78, v80
    v_msad_u8 v80, v67, s79, v80
    v_msad_u8 v80, v68, s76, v80
    v_msad_u8 v80, v69, s77, v80
    v_msad_u8 v80, v70, s78, v80
    v_msad_u8 v80, v71, s79, v80
    v_msad_u8 v80, v72, s76, v80
    v_msad_u8 v80, v73, s77, v80
    v_msad_u8 v80, v74, s78, v80
    v_msad_u8 v80, v75, s79, v80
    v_msad_u8 v80, v76, s76, v80
    v_msad_u8 v80, v77, s77, v80
    v_msad_u8 v80, v78, s78, v80
    v_msad_u8 v80, v79, s79, v80
    v_cmp_ne_u32 vcc, 0, v80
    s_cbranch_vccz L_b_yok
    s_cmp_lt_u32 s13, 16384
    s_cbranch_scc1 L_b_y
L_b_yok:
    v_add_f32_dpp v64, v64, v64 row_ror:1 row_mask:0xf bank_mask:0xf
    v_add_f32_dpp v65, v65, v65 row_ror:1 row_mask:0xf bank_mask:0xf
    v_add_f32_dpp v66, v66, v66 row_ror:1 row_mask:0xf bank_mask:0xf
    v_add_f32_dpp v67, v67, v67 row_ror:1 row_mask:0xf bank_mask:0xf
    v_add_f32_dpp v68, v68, v68 row_ror:1 row_mask:0xf bank_mask:0xf
    v_add_f32_dpp v69, v69, v69 row_ror:1 row_mask:0xf bank_mask:0xf
    v_add_f32_dpp v70, v70, v70 row_ror:1 row_mask:0xf bank_mask:0xf
    v_add_f32_dpp v71, v71, v71 row_ror:1 row_mask:0xf bank_mask:0xf
    v_add_f32_dpp v72, v72, v72 row_ror:1 row_mask:0xf bank_mask:0xf
    v_add_f32_dpp v73, v73, v73 row_ror:1 row_mask:0xf bank_mask:0xf
    v_add_f32_dpp v74, v74, v74 row_ror:1 row_mask:0xf bank_mask:0xf
    v_add_f32_dpp v75, v75, v75 row_ror:1 row_mask:0xf bank_mask:0xf
    v_add_f32_dpp v76, v76, v76 row_ror:1 row_mask:0xf bank_mask:0xf
    v_add_f32_dpp v77, v77, v77 row_ror:1 row_mask:0xf bank_mask:0xf
    v_add_f32_dpp v78, v78, v78 row_ror:1 row_mask:0xf bank_mask:0xf
    v_add_f32_dpp v79, v79, v79 row_ror:1 row_mask:0xf bank_mask:0xf
    v_add_f32_dpp v64, v64, v64 row_ror:2 row_mask:0xf bank_mask:0xf
    v_add_f32_dpp v65, v65, v65 row_ror:2 row_mask:0xf bank_mask:0xf
    v_add_f32_dpp v66, v66, v66 row_ror:2 row_mask:0xf bank_mask:0xf
    v_add_f32_dpp v67, v67, v67 row_ror:2 row_mask:0xf bank_mask:0xf
    v_add_f32_dpp v68, v68, v68 row_ror:2 row_mask:0xf bank_mask:0xf
    v_add_f32_dpp v69, v69, v69 row_ror:2 row_mask:0xf bank_mask:0xf
    v_add_f32_dpp v70, v70, v70 row_ror:2 row_mask:0xf bank_mask:0xf
    v_add_f32_dpp v71, v71, v71 row_ror:2 row_mask:0xf bank_mask:0xf
    v_add_f32_dpp v72, v72, v72 row_ror:2 row_mask:0xf bank_mask:0xf
    v_add_f32_dpp v73, v73, v73 row_ror:2 row_mask:0xf bank_mask:0xf
    v_add_f32_dpp v74, v74, v74 row_ror:2 row_mask:0xf bank_mask:0xf
    v_add_f32_dpp v75, v75, v75 row_ror:2 row_mask:0xf bank_mask:0xf
    v_add_f32_dpp v76, v76, v76 row_ror:2 row_mask:0xf bank_mask:0xf
    v_add_f32_dpp v77, v77, v77 row_ror:2 row_mask:0xf bank_mask:0xf
    v_add_f32_dpp v78, v78, v78 row_ror:2 row_mask:0xf bank_mask:0xf
    v_add_f32_dpp v79, v79, v79 row_ror:2 row_mask:0xf bank_mask:0xf
    v_add_f32_dpp v64, v64, v64 row_ror:4 row_mask:0xf bank_mask:0xf
    v_add_f32_dpp v65, v65, v65 row_ror:4 row_mask:0xf bank_mask:0xf
    v_add_f32_dpp v66, v66, v66 row_ror:4 row_mask:0xf bank_mask:0xf
    v_add_f32_dpp v67, v67, v67 row_ror:4 row_mask:0xf bank_mask:0xf
    v_add_f32_dpp v68, v68, v68 row_ror:4 row_mask:0xf bank_mask:0xf
    v_add_f32_dpp v69, v69, v69 row_ror:4 row_mask:0xf bank_mask:0xf
    v_add_f32_dpp v70, v70, v70 row_ror:4 row_mask:0xf bank_mask:0xf
    v_add_f32_dpp v71, v71, v71 row_ror:4 row_mask:0xf bank_mask:0xf
    v_add_f32_dpp v72, v72, v72 row_ror:4 row_mask:0xf bank_mask:0xf
    v_add_f32_dpp v73, v73, v73 row_ror:4 row_mask:0xf bank_mask:0xf
    v_add_f32_dpp v74, v74, v74 row_ror:4 row_mask:0xf bank_mask:0xf
    v_add_f32_dpp v75, v75, v75 row_ror:4 row_mask:0xf bank_mask:0xf
    v_add_f32_dpp v76, v76, v76 row_ror:4 row_mask:0xf bank_mask:0xf
    v_add_f32_dpp v77, v77, v77 row_ror:4 row_mask:0xf bank_mask:0xf
    v_add_f32_dpp v78, v78, v78 row_ror:4 row_mask:0xf bank_mask:0xf
    v_add_f32_dpp v79, v79, v79 row_ror:4 row_mask:0xf bank_mask:0xf
    v_add_f32_dpp v64, v64, v64 row_ror:8 row_mask:0xf bank_mask:0xf
    v_add_f32_dpp v65, v65, v65 row_ror:8 row_mask:0xf bank_mask:0xf
    v_add_f32_dpp v66, v66, v66 row_ror:8 row_mask:0xf bank_mask:0xf
    v_add_f32_dpp v67, v67, v67 row_ror:8 row_mask:0xf bank_mask:0xf
    v_add_f32_dpp v68, v68, v68 row_ror:8 row_mask:0xf bank_mask:0xf
    v_add_f32_dpp v69, v69, v69 row_ror:8 row_mask:0xf bank_mask:0xf
    v_add_f32_dpp v70, v70, v70 row_ror:8 row_mask:0xf bank_mask:0xf
    v_add_f32_dpp v71, v71, v71 row_ror:8 row_mask:0xf bank_mask:0xf
    v_add_f32_dpp v72, v72, v72 row_ror:8 row_mask:0xf bank_mask:0xf
    v_add_f32_dpp v73, v73, v73 row_ror:8 row_mask:0xf bank_mask:0xf
    v_add_f32_dpp v74, v74, v74 row_ror:8 row_mask:0xf bank_mask:0xf
    v_add_f32_dpp v75, v75, v75 row_ror:8 row_mask:0xf bank_mask:0xf
    v_add_f32_dpp v76, v76, v76 row_ror:8 row_mask:0xf bank_mask:0xf
    v_add_f32_dpp v77, v77, v77 row_ror:8 row_mask:0xf bank_mask:0xf
    v_add_f32_dpp v78, v78, v78 row_ror:8 row_mask:0xf bank_mask:0xf
    v_add_f32_dpp v79, v79, v79 row_ror:8 row_mask:0xf bank_mask:0xf
    v_cvt_pk_bf16_f32 v80, v64, v65
    v_cvt_pk_bf16_f32 v81, v66, v67
    v_cvt_pk_bf16_f32 v82, v68, v69
    v_cvt_pk_bf16_f32 v83, v70, v71
    v_cvt_pk_bf16_f32 v84, v72, v73
    v_cvt_pk_bf16_f32 v85, v74, v75
    v_cvt_pk_bf16_f32 v86, v76, v77
    v_cvt_pk_bf16_f32 v87, v78, v79
    v_lshlrev_b32 v64, 16, v80
    v_and_b32 v65, 0xffff0000, v80
    v_lshlrev_b32 v66, 16, v81
    v_and_b32 v67, 0xffff0000, v81
    v_lshlrev_b32 v68, 16, v82
    v_and_b32 v69, 0xffff0000, v82
    v_lshlrev_b32 v70, 16, v83
    v_and_b32 v71, 0xffff0000, v83
    v_lshlrev_b32 v72, 16, v84
    v_and_b32 v73, 0xffff0000, v84
    v_lshlrev_b32 v74, 16, v85
    v_and_b32 v75, 0xffff0000, v85
    v_lshlrev_b32 v76, 16, v86
    v_and_b32 v77, 0xffff0000, v86
    v_lshlrev_b32 v78, 16, v87
    v_and_b32 v79, 0xffff0000, v87
    v_mul_f32 v64, s22, v64
    v_mul_f32 v65, s22, v65
    v_mul_f32 v66, s22, v66
    v_mul_f32 v67, s22, v67
    v_mul_f32 v68, s22, v68
    v_mul_f32 v69, s22, v69
    v_mul_f32 v70, s22, v70
    v_mul_f32 v71, s22, v71
    v_mul_f32 v72, s22, v72
    v_mul_f32 v73, s22, v73
    v_mul_f32 v74, s22, v74
    v_mul_f32 v75, s22, v75
    v_mul_f32 v76, s22, v76
    v_mul_f32 v77, s22, v77
    v_mul_f32 v78, s22, v78
    v_mul_f32 v79, s22, v79
    v_cvt_pk_bf16_f32 v80, v64, v65
    v_cvt_pk_bf16_f32 v81, v66, v67
    v_cvt_pk_bf16_f32 v82, v68, v69
    v_cvt_pk_bf16_f32 v83, v70, v71
    v_cvt_pk_bf16_f32 v84, v72, v73
    v_cvt_pk_bf16_f32 v85, v74, v75
    v_cvt_pk_bf16_f32 v86, v76, v77
    v_cvt_pk_bf16_f32 v87, v78, v79
    v_lshlrev_b32 v64, 16, v80
    v_and_b32 v65, 0xffff0000, v80
    v_lshlrev_b32 v66, 16, v81
    v_and_b32 v67, 0xffff0000, v81
    v_lshlrev_b32 v68, 16, v82
    v_and_b32 v69, 0xffff0000, v82
    v_lshlrev_b32 v70, 16, v83
    v_and_b32 v71, 0xffff0000, v83
    v_lshlrev_b32 v72, 16, v84
    v_and_b32 v73, 0xffff0000, v84
    v_lshlrev_b32 v74, 16, v85
    v_and_b32 v75, 0xffff0000, v85
    v_lshlrev_b32 v76, 16, v86
    v_and_b32 v77, 0xffff0000, v86
    v_lshlrev_b32 v78, 16, v87
    v_and_b32 v79, 0xffff0000, v87
    v_lshlrev_b32 v96, 16, v24
    v_and_b32 v97, 0xffff0000, v24
    v_lshlrev_b32 v98, 16, v25
    v_and_b32 v99, 0xffff0000, v25
    v_lshlrev_b32 v100, 16, v26
    v_and_b32 v101, 0xffff0000, v26
    v_lshlrev_b32 v102, 16, v27
    v_and_b32 v103, 0xffff0000, v27
    v_lshlrev_b32 v104, 16, v28
    v_and_b32 v105, 0xffff0000, v28
    v_lshlrev_b32 v106, 16, v29
    v_and_b32 v107, 0xffff0000, v29
    v_lshlrev_b32 v108, 16, v30
    v_and_b32 v109, 0xffff0000, v30
    v_lshlrev_b32 v110, 16, v31
    v_and_b32 v111, 0xffff0000, v31
    v_add_f32 v64, v64, v96
    v_add_f32 v65, v65, v97
    v_add_f32 v66, v66, v98
    v_add_f32 v67, v67, v99
    v_add_f32 v68, v68, v100
    v_add_f32 v69, v69, v101
    v_add_f32 v70, v70, v102
    v_add_f32 v71, v71, v103
    v_add_f32 v72, v72, v104
    v_add_f32 v73, v73, v105
    v_add_f32 v74, v74, v106
    v_add_f32 v75, v75, v107
    v_add_f32 v76, v76, v108
    v_add_f32 v77, v77, v109
    v_add_f32 v78, v78, v110
    v_add_f32 v79, v79, v111
    v_cvt_pk_bf16_f32 v80, v64, v65
    v_cvt_pk_bf16_f32 v81, v66, v67
    v_cvt_pk_bf16_f32 v82, v68, v69
    v_cvt_pk_bf16_f32 v83, v70, v71
    v_cvt_pk_bf16_f32 v84, v72, v73
    v_cvt_pk_bf16_f32 v85, v74, v75
    v_cvt_pk_bf16_f32 v86, v76, v77
    v_cvt_pk_bf16_f32 v87, v78, v79
    v_cmp_eq_u32 vcc, s21, v6
    s_nop 1
    v_cndmask_b32 v24, v24, v80, vcc
    v_cndmask_b32 v25, v25, v81, vcc
    v_cndmask_b32 v26, v26, v82, vcc
    v_cndmask_b32 v27, v27, v83, vcc
    v_cndmask_b32 v28, v28, v84, vcc
    v_cndmask_b32 v29, v29, v85, vcc
    v_cndmask_b32 v30, v30, v86, vcc
    v_cndmask_b32 v31, v31, v87, vcc
L_b_noown:
    s_waitcnt vmcnt(0)
    v_sub_f32 v50, 1.0, v48
    v_cvt_pk_bf16_f32 v50, v50, v50
    v_lshlrev_b32 v50, 16, v50
    v_lshlrev_b32 v32, 16, v24
    v_and_b32 v33, 0xffff0000, v24
    v_lshlrev_b32 v34, 16, v25
    v_and_b32 v35, 0xffff0000, v25
    v_lshlrev_b32 v36, 16, v26
    v_and_b32 v37, 0xffff0000, v26
    v_lshlrev_b32 v38, 16, v27
    v_and_b32 v39, 0xffff0000, v27
    v_lshlrev_b32 v40, 16, v28
    v_and_b32 v41, 0xffff0000, v28
    v_lshlrev_b32 v42, 16, v29
    v_and_b32 v43, 0xffff0000, v29
    v_lshlrev_b32 v44, 16, v30
    v_and_b32 v45, 0xffff0000, v30
    v_lshlrev_b32 v46, 16, v31
    v_and_b32 v47, 0xffff0000, v31
    v_pk_mul_f32 v[32:33], v[32:33], v[50:51] op_sel_hi:[1,0]
    v_pk_mul_f32 v[34:35], v[34:35], v[50:51] op_sel_hi:[1,0]
    v_pk_mul_f32 v[36:37], v[36:37], v[50:51] op_sel_hi:[1,0]
    v_pk_mul_f32 v[38:39], v[38:39], v[50:51] op_sel_hi:[1,0]
    v_pk_mul_f32 v[40:41], v[40:41], v[50:51] op_sel_hi:[1,0]
    v_pk_mul_f32 v[42:43], v[42:43], v[50:51] op_sel_hi:[1,0]
    v_pk_mul_f32 v[44:45], v[44:45], v[50:51] op_sel_hi:[1,0]
    v_pk_mul_f32 v[46:47], v[46:47], v[50:51] op_sel_hi:[1,0]
    v_cvt_pk_bf16_f32 v24, v32, v33
    v_cvt_pk_bf16_f32 v25, v34, v35
    v_cvt_pk_bf16_f32 v26, v36, v37
    v_cvt_pk_bf16_f32 v27, v38, v39
    v_cvt_pk_bf16_f32 v28, v40, v41
    v_cvt_pk_bf16_f32 v29, v42, v43
    v_cvt_pk_bf16_f32 v30, v44, v45
    v_cvt_pk_bf16_f32 v31, v46, v47
    v_lshlrev_b32 v32, 16, v24
    v_and_b32 v33, 0xffff0000, v24
    v_lshlrev_b32 v34, 16, v25
    v_and_b32 v35, 0xffff0000, v25
    v_lshlrev_b32 v36, 16, v26
    v_and_b32 v37, 0xffff0000, v26
    v_lshlrev_b32 v38, 16, v27
    v_and_b32 v39, 0xffff0000, v27
    v_lshlrev_b32 v40, 16, v28
    v_and_b32 v41, 0xffff0000, v28
    v_lshlrev_b32 v42, 16, v29
    v_and_b32 v43, 0xffff0000, v29
    v_lshlrev_b32 v44, 16, v30
    v_and_b32 v45, 0xffff0000, v30
    v_lshlrev_b32 v46, 16, v31
    v_and_b32 v47, 0xffff0000, v31
    s_barrier
    s_add_u32 s12, s96, s97
    s_lshl_b32 s13, s12, 12
    s_cmp_ge_u32 s12, 10
    s_cselect_b32 s12, 24576, 0
    s_add_u32 s13, s13, s12
    v_add_u32 v12, s13, v10
    v_add_u32 v13, s13, v11
    s_add_u32 s96, s96, 1
    s_and_b32 s96, s96, 15
    ds_read_b64_tr_b16 v[128:129], v12 offset:0
    ds_read_b64_tr_b16 v[130:131], v12 offset:1024
    ds_read_b64_tr_b16 v[132:133], v13 offset:0
    ds_read_b64_tr_b16 v[134:135], v13 offset:1024
    ds_read_b64_tr_b16 v[136:137], v12 offset:2048
    ds_read_b64_tr_b16 v[138:139], v12 offset:3072
    ds_read_b64_tr_b16 v[140:141], v13 offset:2048
    ds_read_b64_tr_b16 v[142:143], v13 offset:3072
    s_mov_b32 s13, 0
L_b_fl:
    buffer_load_dword v9, v8, s[32:35], s15 offen sc1
    s_add_u32 s13, s13, 1
    s_cmp_ge_u32 s13, 16384
    s_cbranch_scc1 L_b_flok
    s_waitcnt vmcnt(0)
    v_cmp_ne_u32 vcc, s23, v9
    s_cbranch_vccnz L_b_fl
L_b_flok:
    s_lshl_b32 s94, s93, 11
    s_add_u32 s94, s94, s95
    buffer_load_dwordx4 v[96:99], v17, s[32:35], s94 offen
    buffer_load_dwordx4 v[100:103], v17, s[32:35], s94 offen offset:1024
    s_add_u32 s93, s93, 1
    s_and_b32 s93, s93, 15
    s_lshl_b32 s94, s93, 11
    s_add_u32 s94, s94, s95
    buffer_load_dwordx4 v[104:107], v17, s[32:35], s94 offen
    buffer_load_dwordx4 v[108:111], v17, s[32:35], s94 offen offset:1024
    s_add_u32 s93, s93, 1
    s_and_b32 s93, s93, 15
    s_lshl_b32 s94, s93, 11
    s_add_u32 s94, s94, s95
    buffer_load_dwordx4 v[112:115], v17, s[32:35], s94 offen
    buffer_load_dwordx4 v[116:119], v17, s[32:35], s94 offen offset:1024
    s_add_u32 s93, s93, 1
    s_and_b32 s93, s93, 15
    s_lshl_b32 s94, s93, 11
    s_add_u32 s94, s94, s95
    buffer_load_dwordx4 v[120:123], v17, s[32:35], s94 offen
    buffer_load_dwordx4 v[124:127], v17, s[32:35], s94 offen offset:1024
    s_add_u32 s93, s93, 1
    s_and_b32 s93, s93, 15
    s_add_u32 s12, s96, s97
    s_lshl_b32 s13, s12, 12
    s_cmp_ge_u32 s12, 10
    s_cselect_b32 s12, 24576, 0
    s_add_u32 s13, s13, s12
    v_add_u32 v14, s13, v10
    v_add_u32 v15, s13, v11
    s_add_u32 s96, s96, 1
    s_and_b32 s96, s96, 15
    s_waitcnt vmcnt(6)
    s_waitcnt lgkmcnt(6)
    v_mfma_f32_32x32x16_bf16 v[64:79], v[128:131], v[96:99], 0
    ds_read_b64_tr_b16 v[144:145], v14 offset:0
    ds_read_b64_tr_b16 v[146:147], v14 offset:1024
    s_waitcnt lgkmcnt(6)
    v_mfma_f32_32x32x16_bf16 v[80:95], v[132:135], v[96:99], 0
    ds_read_b64_tr_b16 v[148:149], v15 offset:0
    ds_read_b64_tr_b16 v[150:151], v15 offset:1024
    s_waitcnt lgkmcnt(6)
    v_mfma_f32_32x32x16_bf16 v[64:79], v[136:139], v[100:103], v[64:79]
    ds_read_b64_tr_b16 v[152:153], v14 offset:2048
    ds_read_b64_tr_b16 v[154:155], v14 offset:3072
    s_waitcnt lgkmcnt(6)
    v_mfma_f32_32x32x16_bf16 v[80:95], v[140:143], v[100:103], v[80:95]
    ds_read_b64_tr_b16 v[156:157], v15 offset:2048
    ds_read_b64_tr_b16 v[158:159], v15 offset:3072
    s_lshl_b32 s94, s93, 11
    s_add_u32 s94, s94, s95
    buffer_load_dwordx4 v[96:99], v17, s[32:35], s94 offen
    buffer_load_dwordx4 v[100:103], v17, s[32:35], s94 offen offset:1024
    s_add_u32 s93, s93, 1
    s_and_b32 s93, s93, 15
    s_add_u32 s12, s96, s97
    s_lshl_b32 s13, s12, 12
    s_cmp_ge_u32 s12, 10
    s_cselect_b32 s12, 24576, 0
    s_add_u32 s13, s13, s12
    v_add_u32 v12, s13, v10
    v_add_u32 v13, s13, v11
    s_add_u32 s96, s96, 1
    s_and_b32 s96, s96, 15
    s_waitcnt vmcnt(6)
    s_waitcnt lgkmcnt(6)
    v_mfma_f32_32x32x16_bf16 v[64:79], v[144:147], v[104:107], v[64:79]
    ds_read_b64_tr_b16 v[128:129], v12 offset:0
    ds_read_b64_tr_b16 v[130:131], v12 offset:1024
    s_waitcnt lgkmcnt(6)
    v_mfma_f32_32x32x16_bf16 v[80:95], v[148:151], v[104:107], v[80:95]
    ds_read_b64_tr_b16 v[132:133], v13 offset:0
    ds_read_b64_tr_b16 v[134:135], v13 offset:1024
    s_waitcnt lgkmcnt(6)
    v_mfma_f32_32x32x16_bf16 v[64:79], v[152:155], v[108:111], v[64:79]
    ds_read_b64_tr_b16 v[136:137], v12 offset:2048
    ds_read_b64_tr_b16 v[138:139], v12 offset:3072
    s_waitcnt lgkmcnt(6)
    v_mfma_f32_32x32x16_bf16 v[80:95], v[156:159], v[108:111], v[80:95]
    ds_read_b64_tr_b16 v[140:141], v13 offset:2048
    ds_read_b64_tr_b16 v[142:143], v13 offset:3072
    s_lshl_b32 s94, s93, 11
    s_add_u32 s94, s94, s95
    buffer_load_dwordx4 v[104:107], v17, s[32:35], s94 offen
    buffer_load_dwordx4 v[108:111], v17, s[32:35], s94 offen offset:1024
    s_add_u32 s93, s93, 1
    s_and_b32 s93, s93, 15
    s_add_u32 s12, s96, s97
    s_lshl_b32 s13, s12, 12
    s_cmp_ge_u32 s12, 10
    s_cselect_b32 s12, 24576, 0
    s_add_u32 s13, s13, s12
    v_add_u32 v14, s13, v10
    v_add_u32 v15, s13, v11
    s_add_u32 s96, s96, 1
    s_and_b32 s96, s96, 15
    s_waitcnt vmcnt(6)
    s_waitcnt lgkmcnt(6)
    v_mfma_f32_32x32x16_bf16 v[64:79], v[128:131], v[112:115], v[64:79]
    ds_read_b64_tr_b16 v[144:145], v14 offset:0
    ds_read_b64_tr_b16 v[146:147], v14 offset:1024
    s_waitcnt lgkmcnt(6)
    v_mfma_f32_32x32x16_bf16 v[80:95], v[132:135], v[112:115], v[80:95]
    ds_read_b64_tr_b16 v[148:149], v15 offset:0
    ds_read_b64_tr_b16 v[150:151], v15 offset:1024
    s_waitcnt lgkmcnt(6)
    v_mfma_f32_32x32x16_bf16 v[64:79], v[136:139], v[116:119], v[64:79]
    ds_read_b64_tr_b16 v[152:153], v14 offset:2048
    ds_read_b64_tr_b16 v[154:155], v14 offset:3072
    s_waitcnt lgkmcnt(6)
    v_mfma_f32_32x32x16_bf16 v[80:95], v[140:143], v[116:119], v[80:95]
    ds_read_b64_tr_b16 v[156:157], v15 offset:2048
    ds_read_b64_tr_b16 v[158:159], v15 offset:3072
    s_lshl_b32 s94, s93, 11
    s_add_u32 s94, s94, s95
    buffer_load_dwordx4 v[112:115], v17, s[32:35], s94 offen
    buffer_load_dwordx4 v[116:119], v17, s[32:35], s94 offen offset:1024
    s_add_u32 s93, s93, 1
    s_and_b32 s93, s93, 15
    s_add_u32 s12, s96, s97
    s_lshl_b32 s13, s12, 12
    s_cmp_ge_u32 s12, 10
    s_cselect_b32 s12, 24576, 0
    s_add_u32 s13, s13, s12
    v_add_u32 v12, s13, v10
    v_add_u32 v13, s13, v11
    s_add_u32 s96, s96, 1
    s_and_b32 s96, s96, 15
    s_waitcnt vmcnt(6)
    s_waitcnt lgkmcnt(6)
    v_mfma_f32_32x32x16_bf16 v[64:79], v[144:147], v[120:123], v[64:79]
    ds_read_b64_tr_b16 v[128:129], v12 offset:0
    ds_read_b64_tr_b16 v[130:131], v12 offset:1024
    s_waitcnt lgkmcnt(6)
    v_mfma_f32_32x32x16_bf16 v[80:95], v[148:151], v[120:123], v[80:95]
    ds_read_b64_tr_b16 v[132:133], v13 offset:0
    ds_read_b64_tr_b16 v[134:135], v13 offset:1024
    s_waitcnt lgkmcnt(6)
    v_mfma_f32_32x32x16_bf16 v[64:79], v[152:155], v[124:127], v[64:79]
    ds_read_b64_tr_b16 v[136:137], v12 offset:2048
    ds_read_b64_tr_b16 v[138:139], v12 offset:3072
    s_waitcnt lgkmcnt(6)
    v_mfma_f32_32x32x16_bf16 v[80:95], v[156:159], v[124:127], v[80:95]
    ds_read_b64_tr_b16 v[140:141], v13 offset:2048
    ds_read_b64_tr_b16 v[142:143], v13 offset:3072
    s_lshl_b32 s94, s93, 11
    s_add_u32 s94, s94, s95
    buffer_load_dwordx4 v[120:123], v17, s[32:35], s94 offen
    buffer_load_dwordx4 v[124:127], v17, s[32:35], s94 offen offset:1024
    s_add_u32 s93, s93, 1
    s_and_b32 s93, s93, 15
    s_add_u32 s12, s96, s97
    s_lshl_b32 s13, s12, 12
    s_cmp_ge_u32 s12, 10
    s_cselect_b32 s12, 24576, 0
    s_add_u32 s13, s13, s12
    v_add_u32 v14, s13, v10
    v_add_u32 v15, s13, v11
    s_add_u32 s96, s96, 1
    s_and_b32 s96, s96, 15
    s_waitcnt vmcnt(6)
    s_waitcnt lgkmcnt(6)
    v_mfma_f32_32x32x16_bf16 v[64:79], v[128:131], v[96:99], v[64:79]
    ds_read_b64_tr_b16 v[144:145], v14 offset:0
    ds_read_b64_tr_b16 v[146:147], v14 offset:1024
    s_waitcnt lgkmcnt(6)
    v_mfma_f32_32x32x16_bf16 v[80:95], v[132:135], v[96:99], v[80:95]
    ds_read_b64_tr_b16 v[148:149], v15 offset:0
    ds_read_b64_tr_b16 v[150:151], v15 offset:1024
    s_waitcnt lgkmcnt(6)
    v_mfma_f32_32x32x16_bf16 v[64:79], v[136:139], v[100:103], v[64:79]
    ds_read_b64_tr_b16 v[152:153], v14 offset:2048
    ds_read_b64_tr_b16 v[154:155], v14 offset:3072
    s_waitcnt lgkmcnt(6)
    v_mfma_f32_32x32x16_bf16 v[80:95], v[140:143], v[100:103], v[80:95]
    ds_read_b64_tr_b16 v[156:157], v15 offset:2048
    ds_read_b64_tr_b16 v[158:159], v15 offset:3072
    s_lshl_b32 s94, s93, 11
    s_add_u32 s94, s94, s95
    buffer_load_dwordx4 v[96:99], v17, s[32:35], s94 offen
    buffer_load_dwordx4 v[100:103], v17, s[32:35], s94 offen offset:1024
    s_add_u32 s93, s93, 1
    s_and_b32 s93, s93, 15
    s_add_u32 s12, s96, s97
    s_lshl_b32 s13, s12, 12
    s_cmp_ge_u32 s12, 10
    s_cselect_b32 s12, 24576, 0
    s_add_u32 s13, s13, s12
    v_add_u32 v12, s13, v10
    v_add_u32 v13, s13, v11
    s_add_u32 s96, s96, 1
    s_and_b32 s96, s96, 15
    s_waitcnt vmcnt(6)
    s_waitcnt lgkmcnt(6)
    v_mfma_f32_32x32x16_bf16 v[64:79], v[144:147], v[104:107], v[64:79]
    ds_read_b64_tr_b16 v[128:129], v12 offset:0
    ds_read_b64_tr_b16 v[130:131], v12 offset:1024
    s_waitcnt lgkmcnt(6)
    v_mfma_f32_32x32x16_bf16 v[80:95], v[148:151], v[104:107], v[80:95]
    ds_read_b64_tr_b16 v[132:133], v13 offset:0
    ds_read_b64_tr_b16 v[134:135], v13 offset:1024
    s_waitcnt lgkmcnt(6)
    v_mfma_f32_32x32x16_bf16 v[64:79], v[152:155], v[108:111], v[64:79]
    ds_read_b64_tr_b16 v[136:137], v12 offset:2048
    ds_read_b64_tr_b16 v[138:139], v12 offset:3072
    s_waitcnt lgkmcnt(6)
    v_mfma_f32_32x32x16_bf16 v[80:95], v[156:159], v[108:111], v[80:95]
    ds_read_b64_tr_b16 v[140:141], v13 offset:2048
    ds_read_b64_tr_b16 v[142:143], v13 offset:3072
    s_lshl_b32 s94, s93, 11
    s_add_u32 s94, s94, s95
    buffer_load_dwordx4 v[104:107], v17, s[32:35], s94 offen
    buffer_load_dwordx4 v[108:111], v17, s[32:35], s94 offen offset:1024
    s_add_u32 s93, s93, 1
    s_and_b32 s93, s93, 15
    s_add_u32 s12, s96, s97
    s_lshl_b32 s13, s12, 12
    s_cmp_ge_u32 s12, 10
    s_cselect_b32 s12, 24576, 0
    s_add_u32 s13, s13, s12
    v_add_u32 v14, s13, v10
    v_add_u32 v15, s13, v11
    s_add_u32 s96, s96, 1
    s_and_b32 s96, s96, 15
    s_waitcnt vmcnt(6)
    s_waitcnt lgkmcnt(6)
    v_mfma_f32_32x32x16_bf16 v[64:79], v[128:131], v[112:115], v[64:79]
    ds_read_b64_tr_b16 v[144:145], v14 offset:0
    ds_read_b64_tr_b16 v[146:147], v14 offset:1024
    s_waitcnt lgkmcnt(6)
    v_mfma_f32_32x32x16_bf16 v[80:95], v[132:135], v[112:115], v[80:95]
    ds_read_b64_tr_b16 v[148:149], v15 offset:0
    ds_read_b64_tr_b16 v[150:151], v15 offset:1024
    s_waitcnt lgkmcnt(6)
    v_mfma_f32_32x32x16_bf16 v[64:79], v[136:139], v[116:119], v[64:79]
    ds_read_b64_tr_b16 v[152:153], v14 offset:2048
    ds_read_b64_tr_b16 v[154:155], v14 offset:3072
    s_waitcnt lgkmcnt(6)
    v_mfma_f32_32x32x16_bf16 v[80:95], v[140:143], v[116:119], v[80:95]
    ds_read_b64_tr_b16 v[156:157], v15 offset:2048
    ds_read_b64_tr_b16 v[158:159], v15 offset:3072
    s_lshl_b32 s94, s93, 11
    s_add_u32 s94, s94, s95
    buffer_load_dwordx4 v[112:115], v17, s[32:35], s94 offen
    buffer_load_dwordx4 v[116:119], v17, s[32:35], s94 offen offset:1024
    s_add_u32 s93, s93, 1
    s_and_b32 s93, s93, 15
    s_add_u32 s12, s96, s97
    s_lshl_b32 s13, s12, 12
    s_cmp_ge_u32 s12, 10
    s_cselect_b32 s12, 24576, 0
    s_add_u32 s13, s13, s12
    v_add_u32 v12, s13, v10
    v_add_u32 v13, s13, v11
    s_add_u32 s96, s96, 1
    s_and_b32 s96, s96, 15
    s_waitcnt vmcnt(6)
    s_waitcnt lgkmcnt(6)
    v_mfma_f32_32x32x16_bf16 v[64:79], v[144:147], v[120:123], v[64:79]
    ds_read_b64_tr_b16 v[128:129], v12 offset:0
    ds_read_b64_tr_b16 v[130:131], v12 offset:1024
    s_waitcnt lgkmcnt(6)
    v_mfma_f32_32x32x16_bf16 v[80:95], v[148:151], v[120:123], v[80:95]
    ds_read_b64_tr_b16 v[132:133], v13 offset:0
    ds_read_b64_tr_b16 v[134:135], v13 offset:1024
    s_waitcnt lgkmcnt(6)
    v_mfma_f32_32x32x16_bf16 v[64:79], v[152:155], v[124:127], v[64:79]
    ds_read_b64_tr_b16 v[136:137], v12 offset:2048
    ds_read_b64_tr_b16 v[138:139], v12 offset:3072
    s_waitcnt lgkmcnt(6)
    v_mfma_f32_32x32x16_bf16 v[80:95], v[156:159], v[124:127], v[80:95]
    ds_read_b64_tr_b16 v[140:141], v13 offset:2048
    ds_read_b64_tr_b16 v[142:143], v13 offset:3072
    s_lshl_b32 s94, s93, 11
    s_add_u32 s94, s94, s95
    buffer_load_dwordx4 v[120:123], v17, s[32:35], s94 offen
    buffer_load_dwordx4 v[124:127], v17, s[32:35], s94 offen offset:1024
    s_add_u32 s93, s93, 1
    s_and_b32 s93, s93, 15
    s_add_u32 s12, s96, s97
    s_lshl_b32 s13, s12, 12
    s_cmp_ge_u32 s12, 10
    s_cselect_b32 s12, 24576, 0
    s_add_u32 s13, s13, s12
    v_add_u32 v14, s13, v10
    v_add_u32 v15, s13, v11
    s_add_u32 s96, s96, 1
    s_and_b32 s96, s96, 15
    s_waitcnt vmcnt(6)
    s_waitcnt lgkmcnt(6)
    v_mfma_f32_32x32x16_bf16 v[64:79], v[128:131], v[96:99], v[64:79]
    ds_read_b64_tr_b16 v[144:145], v14 offset:0
    ds_read_b64_tr_b16 v[146:147], v14 offset:1024
    s_waitcnt lgkmcnt(6)
    v_mfma_f32_32x32x16_bf16 v[80:95], v[132:135], v[96:99], v[80:95]
    ds_read_b64_tr_b16 v[148:149], v15 offset:0
    ds_read_b64_tr_b16 v[150:151], v15 offset:1024
    s_waitcnt lgkmcnt(6)
    v_mfma_f32_32x32x16_bf16 v[64:79], v[136:139], v[100:103], v[64:79]
    ds_read_b64_tr_b16 v[152:153], v14 offset:2048
    ds_read_b64_tr_b16 v[154:155], v14 offset:3072
    s_waitcnt lgkmcnt(6)
    v_mfma_f32_32x32x16_bf16 v[80:95], v[140:143], v[100:103], v[80:95]
    ds_read_b64_tr_b16 v[156:157], v15 offset:2048
    ds_read_b64_tr_b16 v[158:159], v15 offset:3072
    s_lshl_b32 s94, s93, 11
    s_add_u32 s94, s94, s95
    buffer_load_dwordx4 v[96:99], v17, s[32:35], s94 offen
    buffer_load_dwordx4 v[100:103], v17, s[32:35], s94 offen offset:1024
    s_add_u32 s93, s93, 1
    s_and_b32 s93, s93, 15
    s_add_u32 s12, s96, s97
    s_lshl_b32 s13, s12, 12
    s_cmp_ge_u32 s12, 10
    s_cselect_b32 s12, 24576, 0
    s_add_u32 s13, s13, s12
    v_add_u32 v12, s13, v10
    v_add_u32 v13, s13, v11
    s_add_u32 s96, s96, 1
    s_and_b32 s96, s96, 15
    s_waitcnt vmcnt(6)
    s_waitcnt lgkmcnt(6)
    v_mfma_f32_32x32x16_bf16 v[64:79], v[144:147], v[104:107], v[64:79]
    ds_read_b64_tr_b16 v[128:129], v12 offset:0
    ds_read_b64_tr_b16 v[130:131], v12 offset:1024
    s_waitcnt lgkmcnt(6)
    v_mfma_f32_32x32x16_bf16 v[80:95], v[148:151], v[104:107], v[80:95]
    ds_read_b64_tr_b16 v[132:133], v13 offset:0
    ds_read_b64_tr_b16 v[134:135], v13 offset:1024
    s_waitcnt lgkmcnt(6)
    v_mfma_f32_32x32x16_bf16 v[64:79], v[152:155], v[108:111], v[64:79]
    ds_read_b64_tr_b16 v[136:137], v12 offset:2048
    ds_read_b64_tr_b16 v[138:139], v12 offset:3072
    s_waitcnt lgkmcnt(6)
    v_mfma_f32_32x32x16_bf16 v[80:95], v[156:159], v[108:111], v[80:95]
    ds_read_b64_tr_b16 v[140:141], v13 offset:2048
    ds_read_b64_tr_b16 v[142:143], v13 offset:3072
    s_lshl_b32 s94, s93, 11
    s_add_u32 s94, s94, s95
    buffer_load_dwordx4 v[104:107], v17, s[32:35], s94 offen
    buffer_load_dwordx4 v[108:111], v17, s[32:35], s94 offen offset:1024
    s_add_u32 s93, s93, 1
    s_and_b32 s93, s93, 15
    s_add_u32 s12, s96, s97
    s_lshl_b32 s13, s12, 12
    s_cmp_ge_u32 s12, 10
    s_cselect_b32 s12, 24576, 0
    s_add_u32 s13, s13, s12
    v_add_u32 v14, s13, v10
    v_add_u32 v15, s13, v11
    s_add_u32 s96, s96, 1
    s_and_b32 s96, s96, 15
    s_waitcnt vmcnt(6)
    s_waitcnt lgkmcnt(6)
    v_mfma_f32_32x32x16_bf16 v[64:79], v[128:131], v[112:115], v[64:79]
    ds_read_b64_tr_b16 v[144:145], v14 offset:0
    ds_read_b64_tr_b16 v[146:147], v14 offset:1024
    s_waitcnt lgkmcnt(6)
    v_mfma_f32_32x32x16_bf16 v[80:95], v[132:135], v[112:115], v[80:95]
    ds_read_b64_tr_b16 v[148:149], v15 offset:0
    ds_read_b64_tr_b16 v[150:151], v15 offset:1024
    s_waitcnt lgkmcnt(6)
    v_mfma_f32_32x32x16_bf16 v[64:79], v[136:139], v[116:119], v[64:79]
    ds_read_b64_tr_b16 v[152:153], v14 offset:2048
    ds_read_b64_tr_b16 v[154:155], v14 offset:3072
    s_waitcnt lgkmcnt(6)
    v_mfma_f32_32x32x16_bf16 v[80:95], v[140:143], v[116:119], v[80:95]
    ds_read_b64_tr_b16 v[156:157], v15 offset:2048
    ds_read_b64_tr_b16 v[158:159], v15 offset:3072
    s_lshl_b32 s94, s93, 11
    s_add_u32 s94, s94, s95
    buffer_load_dwordx4 v[112:115], v17, s[32:35], s94 offen
    buffer_load_dwordx4 v[116:119], v17, s[32:35], s94 offen offset:1024
    s_add_u32 s93, s93, 1
    s_and_b32 s93, s93, 15
    s_add_u32 s12, s96, s97
    s_lshl_b32 s13, s12, 12
    s_cmp_ge_u32 s12, 10
    s_cselect_b32 s12, 24576, 0
    s_add_u32 s13, s13, s12
    v_add_u32 v12, s13, v10
    v_add_u32 v13, s13, v11
    s_add_u32 s96, s96, 1
    s_and_b32 s96, s96, 15
    s_waitcnt vmcnt(6)
    s_waitcnt lgkmcnt(6)
    v_mfma_f32_32x32x16_bf16 v[64:79], v[144:147], v[120:123], v[64:79]
    ds_read_b64_tr_b16 v[128:129], v12 offset:0
    ds_read_b64_tr_b16 v[130:131], v12 offset:1024
    s_waitcnt lgkmcnt(6)
    v_mfma_f32_32x32x16_bf16 v[80:95], v[148:151], v[120:123], v[80:95]
    ds_read_b64_tr_b16 v[132:133], v13 offset:0
    ds_read_b64_tr_b16 v[134:135], v13 offset:1024
    s_waitcnt lgkmcnt(6)
    v_mfma_f32_32x32x16_bf16 v[64:79], v[152:155], v[124:127], v[64:79]
    ds_read_b64_tr_b16 v[136:137], v12 offset:2048
    ds_read_b64_tr_b16 v[138:139], v12 offset:3072
    s_waitcnt lgkmcnt(6)
    v_mfma_f32_32x32x16_bf16 v[80:95], v[156:159], v[124:127], v[80:95]
    ds_read_b64_tr_b16 v[140:141], v13 offset:2048
    ds_read_b64_tr_b16 v[142:143], v13 offset:3072
    s_lshl_b32 s94, s93, 11
    s_add_u32 s94, s94, s95
    buffer_load_dwordx4 v[120:123], v17, s[32:35], s94 offen
    buffer_load_dwordx4 v[124:127], v17, s[32:35], s94 offen offset:1024
    s_add_u32 s93, s93, 1
    s_and_b32 s93, s93, 15
    s_add_u32 s12, s96, s97
    s_lshl_b32 s13, s12, 12
    s_cmp_ge_u32 s12, 10
    s_cselect_b32 s12, 24576, 0
    s_add_u32 s13, s13, s12
    v_add_u32 v14, s13, v10
    v_add_u32 v15, s13, v11
    s_add_u32 s96, s96, 1
    s_and_b32 s96, s96, 15
    s_waitcnt vmcnt(6)
    s_waitcnt lgkmcnt(6)
    v_mfma_f32_32x32x16_bf16 v[64:79], v[128:131], v[96:99], v[64:79]
    ds_read_b64_tr_b16 v[144:145], v14 offset:0
    ds_read_b64_tr_b16 v[146:147], v14 offset:1024
    s_waitcnt lgkmcnt(6)
    v_mfma_f32_32x32x16_bf16 v[80:95], v[132:135], v[96:99], v[80:95]
    ds_read_b64_tr_b16 v[148:149], v15 offset:0
    ds_read_b64_tr_b16 v[150:151], v15 offset:1024
    s_waitcnt lgkmcnt(6)
    v_mfma_f32_32x32x16_bf16 v[64:79], v[136:139], v[100:103], v[64:79]
    ds_read_b64_tr_b16 v[152:153], v14 offset:2048
    ds_read_b64_tr_b16 v[154:155], v14 offset:3072
    s_waitcnt lgkmcnt(6)
    v_mfma_f32_32x32x16_bf16 v[80:95], v[140:143], v[100:103], v[80:95]
    ds_read_b64_tr_b16 v[156:157], v15 offset:2048
    ds_read_b64_tr_b16 v[158:159], v15 offset:3072
    s_add_u32 s12, s96, s97
    s_lshl_b32 s13, s12, 12
    s_cmp_ge_u32 s12, 10
    s_cselect_b32 s12, 24576, 0
    s_add_u32 s13, s13, s12
    v_add_u32 v12, s13, v10
    v_add_u32 v13, s13, v11
    s_add_u32 s96, s96, 1
    s_and_b32 s96, s96, 15
    s_waitcnt vmcnt(4)
    s_waitcnt lgkmcnt(6)
    v_mfma_f32_32x32x16_bf16 v[64:79], v[144:147], v[104:107], v[64:79]
    ds_read_b64_tr_b16 v[128:129], v12 offset:0
    ds_read_b64_tr_b16 v[130:131], v12 offset:1024
    s_waitcnt lgkmcnt(6)
    v_mfma_f32_32x32x16_bf16 v[80:95], v[148:151], v[104:107], v[80:95]
    ds_read_b64_tr_b16 v[132:133], v13 offset:0
    ds_read_b64_tr_b16 v[134:135], v13 offset:1024
    s_waitcnt lgkmcnt(6)
    v_mfma_f32_32x32x16_bf16 v[64:79], v[152:155], v[108:111], v[64:79]
    ds_read_b64_tr_b16 v[136:137], v12 offset:2048
    ds_read_b64_tr_b16 v[138:139], v12 offset:3072
    s_waitcnt lgkmcnt(6)
    v_mfma_f32_32x32x16_bf16 v[80:95], v[156:159], v[108:111], v[80:95]
    ds_read_b64_tr_b16 v[140:141], v13 offset:2048
    ds_read_b64_tr_b16 v[142:143], v13 offset:3072
    s_add_u32 s12, s96, s97
    s_lshl_b32 s13, s12, 12
    s_cmp_ge_u32 s12, 10
    s_cselect_b32 s12, 24576, 0
    s_add_u32 s13, s13, s12
    v_add_u32 v14, s13, v10
    v_add_u32 v15, s13, v11
    s_add_u32 s96, s96, 1
    s_and_b32 s96, s96, 15
    s_waitcnt vmcnt(2)
    s_waitcnt lgkmcnt(6)
    v_mfma_f32_32x32x16_bf16 v[64:79], v[128:131], v[112:115], v[64:79]
    ds_read_b64_tr_b16 v[144:145], v14 offset:0
    ds_read_b64_tr_b16 v[146:147], v14 offset:1024
    s_waitcnt lgkmcnt(6)
    v_mfma_f32_32x32x16_bf16 v[80:95], v[132:135], v[112:115], v[80:95]
    ds_read_b64_tr_b16 v[148:149], v15 offset:0
    ds_read_b64_tr_b16 v[150:151], v15 offset:1024
    s_waitcnt lgkmcnt(6)
    v_mfma_f32_32x32x16_bf16 v[64:79], v[136:139], v[116:119], v[64:79]
    ds_read_b64_tr_b16 v[152:153], v14 offset:2048
    ds_read_b64_tr_b16 v[154:155], v14 offset:3072
    s_waitcnt lgkmcnt(6)
    v_mfma_f32_32x32x16_bf16 v[80:95], v[140:143], v[116:119], v[80:95]
    ds_read_b64_tr_b16 v[156:157], v15 offset:2048
    ds_read_b64_tr_b16 v[158:159], v15 offset:3072
    s_waitcnt vmcnt(0)
    s_waitcnt lgkmcnt(6)
    v_mfma_f32_32x32x16_bf16 v[64:79], v[144:147], v[120:123], v[64:79]
    s_waitcnt lgkmcnt(4)
    v_mfma_f32_32x32x16_bf16 v[80:95], v[148:151], v[120:123], v[80:95]
    s_waitcnt lgkmcnt(2)
    v_mfma_f32_32x32x16_bf16 v[64:79], v[152:155], v[124:127], v[64:79]
    s_waitcnt lgkmcnt(0)
    v_mfma_f32_32x32x16_bf16 v[80:95], v[156:159], v[124:127], v[80:95]
    s_nop 11
    v_permlane16_swap_b32 v64, v80
    v_permlane16_swap_b32 v65, v81
    v_permlane16_swap_b32 v66, v82
    v_permlane16_swap_b32 v67, v83
    v_permlane16_swap_b32 v68, v84
    v_permlane16_swap_b32 v69, v85
    v_permlane16_swap_b32 v70, v86
    v_permlane16_swap_b32 v71, v87
    v_permlane16_swap_b32 v72, v88
    v_permlane16_swap_b32 v73, v89
    v_permlane16_swap_b32 v74, v90
    v_permlane16_swap_b32 v75, v91
    v_permlane16_swap_b32 v76, v92
    v_permlane16_swap_b32 v77, v93
    v_permlane16_swap_b32 v78, v94
    v_permlane16_swap_b32 v79, v95
    ds_write_b128 v20, v[80:83] offset:0
    ds_write_b128 v20, v[84:87] offset:1024
    ds_write_b128 v20, v[88:91] offset:2048
    ds_write_b128 v20, v[92:95] offset:3072
    s_waitcnt lgkmcnt(0)
    s_barrier
    ds_read_b128 v[80:83], v21 offset:0
    ds_read_b128 v[84:87], v21 offset:1024
    ds_read_b128 v[88:91], v21 offset:2048
    ds_read_b128 v[92:95], v21 offset:3072
    s_waitcnt lgkmcnt(3)
    v_pk_add_f32 v[64:65], v[64:65], v[80:81]
    v_pk_add_f32 v[66:67], v[66:67], v[82:83]
    v_cvt_pk_bf16_f32 v96, v64, v65
    v_cvt_pk_bf16_f32 v97, v66, v67
    s_waitcnt lgkmcnt(2)
    v_pk_add_f32 v[68:69], v[68:69], v[84:85]
    v_pk_add_f32 v[70:71], v[70:71], v[86:87]
    v_cvt_pk_bf16_f32 v98, v68, v69
    v_cvt_pk_bf16_f32 v99, v70, v71
    s_waitcnt lgkmcnt(1)
    v_pk_add_f32 v[72:73], v[72:73], v[88:89]
    v_pk_add_f32 v[74:75], v[74:75], v[90:91]
    v_cvt_pk_bf16_f32 v100, v72, v73
    v_cvt_pk_bf16_f32 v101, v74, v75
    s_waitcnt lgkmcnt(0)
    v_pk_add_f32 v[76:77], v[76:77], v[92:93]
    v_pk_add_f32 v[78:79], v[78:79], v[94:95]
    v_cvt_pk_bf16_f32 v102, v76, v77
    v_cvt_pk_bf16_f32 v103, v78, v79
    v_permlane32_swap_b32 v96, v98
    v_permlane32_swap_b32 v97, v99
    v_permlane32_swap_b32 v100, v102
    v_permlane32_swap_b32 v101, v103
    v_lshlrev_b32 v104, 16, v96
    v_and_b32 v105, 0xffff0000, v96
    v_lshlrev_b32 v106, 16, v97
    v_and_b32 v107, 0xffff0000, v97
    v_lshlrev_b32 v108, 16, v98
    v_and_b32 v109, 0xffff0000, v98
    v_lshlrev_b32 v110, 16, v99
    v_and_b32 v111, 0xffff0000, v99
    v_pk_mul_f32 v[104:105], v[104:105], v[48:49] op_sel_hi:[1,0]
    v_pk_mul_f32 v[106:107], v[106:107], v[48:49] op_sel_hi:[1,0]
    v_pk_mul_f32 v[108:109], v[108:109], v[48:49] op_sel_hi:[1,0]
    v_pk_mul_f32 v[110:111], v[110:111], v[48:49] op_sel_hi:[1,0]
    v_cvt_pk_bf16_f32 v96, v104, v105
    v_cvt_pk_bf16_f32 v97, v106, v107
    v_cvt_pk_bf16_f32 v98, v108, v109
    v_cvt_pk_bf16_f32 v99, v110, v111
    v_lshlrev_b32 v104, 16, v96
    v_and_b32 v105, 0xffff0000, v96
    v_lshlrev_b32 v106, 16, v97
    v_and_b32 v107, 0xffff0000, v97
    v_lshlrev_b32 v108, 16, v98
    v_and_b32 v109, 0xffff0000, v98
    v_lshlrev_b32 v110, 16, v99
    v_and_b32 v111, 0xffff0000, v99
    v_pk_add_f32 v[104:105], v[104:105], v[32:33]
    v_pk_add_f32 v[106:107], v[106:107], v[34:35]
    v_pk_add_f32 v[108:109], v[108:109], v[36:37]
    v_pk_add_f32 v[110:111], v[110:111], v[38:39]
    v_cvt_pk_bf16_f32 v96, v104, v105
    v_cvt_pk_bf16_f32 v97, v106, v107
    v_cvt_pk_bf16_f32 v98, v108, v109
    v_cvt_pk_bf16_f32 v99, v110, v111
    buffer_store_dwordx4 v[96:99], v7, s[68:71], 0 offen offset:0 sc1
    v_lshlrev_b32 v112, 16, v100
    v_and_b32 v113, 0xffff0000, v100
    v_lshlrev_b32 v114, 16, v101
    v_and_b32 v115, 0xffff0000, v101
    v_lshlrev_b32 v116, 16, v102
    v_and_b32 v117, 0xffff0000, v102
    v_lshlrev_b32 v118, 16, v103
    v_and_b32 v119, 0xffff0000, v103
    v_pk_mul_f32 v[112:113], v[112:113], v[48:49] op_sel_hi:[1,0]
    v_pk_mul_f32 v[114:115], v[114:115], v[48:49] op_sel_hi:[1,0]
    v_pk_mul_f32 v[116:117], v[116:117], v[48:49] op_sel_hi:[1,0]
    v_pk_mul_f32 v[118:119], v[118:119], v[48:49] op_sel_hi:[1,0]
    v_cvt_pk_bf16_f32 v100, v112, v113
    v_cvt_pk_bf16_f32 v101, v114, v115
    v_cvt_pk_bf16_f32 v102, v116, v117
    v_cvt_pk_bf16_f32 v103, v118, v119
    v_lshlrev_b32 v112, 16, v100
    v_and_b32 v113, 0xffff0000, v100
    v_lshlrev_b32 v114, 16, v101
    v_and_b32 v115, 0xffff0000, v101
    v_lshlrev_b32 v116, 16, v102
    v_and_b32 v117, 0xffff0000, v102
    v_lshlrev_b32 v118, 16, v103
    v_and_b32 v119, 0xffff0000, v103
    v_pk_add_f32 v[112:113], v[112:113], v[40:41]
    v_pk_add_f32 v[114:115], v[114:115], v[42:43]
    v_pk_add_f32 v[116:117], v[116:117], v[44:45]
    v_pk_add_f32 v[118:119], v[118:119], v[46:47]
    v_cvt_pk_bf16_f32 v100, v112, v113
    v_cvt_pk_bf16_f32 v101, v114, v115
    v_cvt_pk_bf16_f32 v102, v116, v117
    v_cvt_pk_bf16_f32 v103, v118, v119
    buffer_store_dwordx4 v[100:103], v7, s[68:71], 0 offen offset:32 sc1
    s_endpgm
L_end:
    s_endpgm
.section .rodata,"a"
.p2align 6
.amdhsa_kernel gated_mix__linear_kernel_hedgehog__moe_arch_mod__prompt_kernel
  .amdhsa_next_free_vgpr 256
  .amdhsa_next_free_sgpr 102
  .amdhsa_accum_offset 256
  .amdhsa_group_segment_fixed_size 0
  .amdhsa_kernarg_size 104
  .amdhsa_user_sgpr_count 2
  .amdhsa_user_sgpr_kernarg_segment_ptr 1
  .amdhsa_system_sgpr_workgroup_id_x 1
.end_amdhsa_kernel
```

```asm
; @launch grid=(256,1,1) block=(512,1,1) lds=163840
.amdgcn_target "amdgcn-amd-amdhsa--gfx950"
.text
.globl gated_mix__linear_kernel_hedgehog__moe_arch_mod__prompt_kernel
.p2align 8
.type gated_mix__linear_kernel_hedgehog__moe_arch_mod__prompt_kernel,@function
gated_mix__linear_kernel_hedgehog__moe_arch_mod__prompt_kernel:
    s_cmp_ge_u32 s2, 256
    s_cbranch_scc1 L_end
    s_load_dwordx4 s[4:7], s[0:1], 0
    s_load_dwordx4 s[8:11], s[0:1], 16
    s_load_dwordx16 s[48:63], s[0:1], 40
    v_lshrrev_b32 v1, 6, v0
    v_and_b32 v2, 63, v0
    v_readfirstlane_b32 s20, v1
    s_and_b32 s16, s2, 7
    s_lshr_b32 s17, s2, 3
    s_and_b32 s18, s16, 1
    s_lshl_b32 s18, s18, 3
    s_and_b32 s19, s17, 7
    s_add_u32 s18, s18, s19
    s_lshr_b32 s19, s16, 1
    s_lshl_b32 s19, s19, 2
    s_lshr_b32 s12, s17, 3
    s_add_u32 s19, s19, s12
    v_lshlrev_b32 v5, 4, v2
    s_cmp_lt_u32 s20, 4
    s_cbranch_scc1 L_compute
    s_sub_u32 s21, s20, 4
    s_mov_b32 s68, 0x76543210
    s_mov_b32 s69, 0xfedcba98
    s_lshl_b32 s12, s16, 1
    s_mul_i32 s12, s12, 0x11111111
    s_xor_b32 s68, s68, s12
    s_xor_b32 s69, s69, s12
    v_lshrrev_b32 v4, 3, v2
    v_lshlrev_b32 v9, 11, v4
    v_and_b32 v6, 7, v2
    v_lshrrev_b32 v7, 4, v2
    v_xor_b32 v8, v6, v7
    v_lshl_add_u32 v10, v8, 4, v9
    v_xor_b32 v8, 4, v8
    v_lshl_add_u32 v11, v8, 4, v9
    v_mul_u32_u24 v12, 6144, v4
    v_and_b32 v7, 1, v7
    v_lshlrev_b32 v7, 2, v7
    v_xor_b32 v8, v6, v7
    v_lshl_add_u32 v12, v8, 4, v12
    s_lshl_b32 s12, s18, 18
    s_lshl_b32 s13, s21, 16
    s_add_u32 s12, s12, s13
    s_add_u32 s13, s12, 0
    v_add_u32 v20, s13, v10
    s_add_u32 s13, s12, 15360
    v_add_u32 v21, s13, v11
    s_add_u32 s13, s12, 30720
    v_add_u32 v22, s13, v10
    s_add_u32 s13, s12, 46080
    v_add_u32 v23, s13, v11
    s_lshl_b32 s12, s19, 7
    s_mul_i32 s14, s21, 6
    s_add_u32 s13, s14, 0
    s_and_b32 s15, s13, 7
    s_mul_i32 s15, s15, 49152
    s_lshr_b32 s13, s13, 3
    s_lshl_b32 s13, s13, 11
    s_add_u32 s13, s13, s15
    s_add_u32 s13, s13, s12
    s_sub_u32 s13, s13, 0
    v_add_u32 v24, s13, v12
    s_add_u32 s13, s14, 1
    s_and_b32 s15, s13, 7
    s_mul_i32 s15, s15, 49152
    s_lshr_b32 s13, s13, 3
    s_lshl_b32 s13, s13, 11
    s_add_u32 s13, s13, s15
    s_add_u32 s13, s13, s12
    s_sub_u32 s13, s13, 1024
    v_add_u32 v25, s13, v12
    s_add_u32 s13, s14, 2
    s_and_b32 s15, s13, 7
    s_mul_i32 s15, s15, 49152
    s_lshr_b32 s13, s13, 3
    s_lshl_b32 s13, s13, 11
    s_add_u32 s13, s13, s15
    s_add_u32 s13, s13, s12
    s_sub_u32 s13, s13, 2048
    v_add_u32 v26, s13, v12
    s_add_u32 s13, s14, 3
    s_and_b32 s15, s13, 7
    s_mul_i32 s15, s15, 49152
    s_lshr_b32 s13, s13, 3
    s_lshl_b32 s13, s13, 11
    s_add_u32 s13, s13, s15
    s_add_u32 s13, s13, s12
    s_sub_u32 s13, s13, 0
    v_add_u32 v27, s13, v12
    s_add_u32 s13, s14, 4
    s_and_b32 s15, s13, 7
    s_mul_i32 s15, s15, 49152
    s_lshr_b32 s13, s13, 3
    s_lshl_b32 s13, s13, 11
    s_add_u32 s13, s13, s15
    s_add_u32 s13, s13, s12
    s_sub_u32 s13, s13, 1024
    v_add_u32 v28, s13, v12
    s_add_u32 s13, s14, 5
    s_and_b32 s15, s13, 7
    s_mul_i32 s15, s15, 49152
    s_lshr_b32 s13, s13, 3
    s_lshl_b32 s13, s13, 11
    s_add_u32 s13, s13, s15
    s_add_u32 s13, s13, s12
    s_sub_u32 s13, s13, 2048
    v_add_u32 v29, s13, v12
    s_lshl_b32 s94, s21, 12
    s_mul_i32 s95, s21, 6144
    s_add_u32 s95, s95, 16384
    s_waitcnt lgkmcnt(0)
    s_mov_b32 s24, s4
    s_and_b32 s25, s5, 0xffff
    s_mov_b32 s26, 4194304
    s_mov_b32 s27, 0x00020000
    s_mov_b32 s28, s6
    s_and_b32 s29, s7, 0xffff
    s_mov_b32 s30, 6291456
    s_mov_b32 s31, 0x00020000
    s_bfe_u32 s91, s68, 0x40000
    s_lshl_b32 s92, s91, 7
    s_mul_i32 s93, s91, 393216
    s_add_u32 m0, s94, 0
    s_nop 0
    buffer_load_dwordx4 v20, s[24:27], s92 offen offset:0 lds
    buffer_load_dwordx4 v21, s[24:27], s92 offen offset:1024 lds
    buffer_load_dwordx4 v22, s[24:27], s92 offen offset:2048 lds
    buffer_load_dwordx4 v23, s[24:27], s92 offen offset:3072 lds
    s_add_u32 m0, s95, 0
    s_nop 0
    buffer_load_dwordx4 v24, s[28:31], s93 offen offset:0 lds
    buffer_load_dwordx4 v25, s[28:31], s93 offen offset:1024 lds
    buffer_load_dwordx4 v26, s[28:31], s93 offen offset:2048 lds
    s_add_u32 m0, s95, 3072
    s_nop 0
    buffer_load_dwordx4 v27, s[28:31], s93 offen offset:0 lds
    buffer_load_dwordx4 v28, s[28:31], s93 offen offset:1024 lds
    buffer_load_dwordx4 v29, s[28:31], s93 offen offset:2048 lds
    s_bfe_u32 s91, s68, 0x40004
    s_lshl_b32 s92, s91, 7
    s_mul_i32 s93, s91, 393216
    s_add_u32 m0, s94, 40960
    s_nop 0
    buffer_load_dwordx4 v20, s[24:27], s92 offen offset:0 lds
    buffer_load_dwordx4 v21, s[24:27], s92 offen offset:1024 lds
    buffer_load_dwordx4 v22, s[24:27], s92 offen offset:2048 lds
    buffer_load_dwordx4 v23, s[24:27], s92 offen offset:3072 lds
    s_add_u32 m0, s95, 40960
    s_nop 0
    buffer_load_dwordx4 v24, s[28:31], s93 offen offset:0 lds
    buffer_load_dwordx4 v25, s[28:31], s93 offen offset:1024 lds
    s_mov_b32 s32, s62
    s_and_b32 s33, s63, 0xffff
    s_mov_b32 s34, 33554432
    s_mov_b32 s35, 0x00020000
    s_mov_b32 s36, s10
    s_and_b32 s37, s11, 0xffff
    s_mov_b32 s38, 2097152
    s_mov_b32 s39, 0x00020000
    s_mov_b32 s40, s50
    s_and_b32 s41, s51, 0xffff
    s_mov_b32 s42, 7340032
    s_mov_b32 s43, 0x00020000
    s_mov_b32 s44, s52
    s_and_b32 s45, s53, 0xffff
    s_mov_b32 s46, 7340032
    s_mov_b32 s47, 0x00020000
    s_mov_b32 s64, s54
    s_and_b32 s65, s55, 0xffff
    s_mov_b32 s66, 7340032
    s_mov_b32 s67, 0x00020000
    s_mov_b32 s72, s60
    s_and_b32 s73, s61, 0xffff
    s_mov_b32 s74, 256
    s_mov_b32 s75, 0x00020000
    s_mov_b32 s76, s8
    s_and_b32 s77, s9, 0xffff
    s_mov_b32 s78, 65536
    s_mov_b32 s79, 0x00020000
    s_mov_b32 s80, s48
    s_and_b32 s81, s49, 0xffff
    s_mov_b32 s82, 2048
    s_mov_b32 s83, 0x00020000
    s_mov_b32 s84, s56
    s_and_b32 s85, s57, 0xffff
    s_mov_b32 s86, 2048
    s_mov_b32 s87, 0x00020000
    s_cmp_lt_u32 s2, 224
    s_cselect_b32 s42, s42, 0
    s_cselect_b32 s46, s46, 0
    s_and_b32 s88, s16, 1
    s_lshl_b32 s88, s88, 3
    s_lshr_b32 s89, s16, 1
    s_lshl_b32 s89, s89, 1
    s_add_u32 s88, s88, s89
    s_lshr_b32 s89, s17, 4
    s_add_u32 s88, s88, s89
    s_and_b32 s89, s17, 15
    v_mov_b32 v13, 0
    v_mul_u32_u24 v30, 57344, v4
    v_lshl_add_u32 v30, v6, 4, v30
    v_lshl_add_u32 v31, v6, 4, v9
    v_lshl_add_u32 v32, v8, 4, v9
    s_lshl_b32 s12, s89, 7
    v_add_u32 v32, s12, v32
    v_lshlrev_b32 v34, 4, v4
    s_and_b32 s12, s2, 3
    s_lshl_b32 s12, s12, 8
    s_lshl_b32 s13, s21, 6
    s_add_u32 s70, s12, s13
    s_mul_i32 s71, s70, 7168
    s_lshr_b32 s12, s2, 2
    s_lshl_b32 s12, s12, 7
    s_add_u32 s71, s71, s12
    s_and_b32 s12, s2, 15
    s_mul_i32 s12, s12, 224
    s_mul_i32 s13, s21, 56
    s_add_u32 s96, s12, s13
    s_lshl_b32 s97, s96, 11
    s_lshr_b32 s12, s2, 4
    s_lshl_b32 s12, s12, 7
    s_add_u32 s97, s97, s12
    s_lshl_b32 s22, s18, 7
    s_lshl_b32 s12, s19, 3
    s_add_u32 s22, s22, s12
    s_lshl_b32 s12, s21, 1
    s_add_u32 s22, s22, s12
    s_waitcnt vmcnt(6)
    s_barrier
    s_add_u32 m0, s95, 40960
    s_nop 0
    buffer_load_dwordx4 v26, s[28:31], s93 offen offset:2048 lds
    s_add_u32 m0, s95, 44032
    s_nop 0
    buffer_load_dwordx4 v27, s[28:31], s93 offen offset:0 lds
    buffer_load_dwordx4 v28, s[28:31], s93 offen offset:1024 lds
    buffer_load_dwordx4 v29, s[28:31], s93 offen offset:2048 lds
    s_bfe_u32 s91, s68, 0x40008
    s_lshl_b32 s92, s91, 7
    s_mul_i32 s93, s91, 393216
    s_add_u32 m0, s94, 81920
    s_nop 0
    buffer_load_dwordx4 v20, s[24:27], s92 offen offset:0 lds
    buffer_load_dwordx4 v21, s[24:27], s92 offen offset:1024 lds
    buffer_load_dwordx4 v22, s[24:27], s92 offen offset:2048 lds
    buffer_load_dwordx4 v23, s[24:27], s92 offen offset:3072 lds
    s_add_u32 m0, s95, 81920
    s_nop 0
    buffer_load_dwordx4 v24, s[28:31], s93 offen offset:0 lds
    buffer_load_dwordx4 v25, s[28:31], s93 offen offset:1024 lds
    buffer_load_dwordx4 v26, s[28:31], s93 offen offset:2048 lds
    s_add_u32 m0, s95, 84992
    s_nop 0
    buffer_load_dwordx4 v27, s[28:31], s93 offen offset:0 lds
    buffer_load_dwordx4 v28, s[28:31], s93 offen offset:1024 lds
    buffer_load_dwordx4 v29, s[28:31], s93 offen offset:2048 lds
    s_lshl_b32 s12, s19, 2
    s_add_u32 s12, s12, s21
    s_lshl_b32 s12, s12, 10
    s_lshl_b32 s13, s21, 10
    s_add_u32 m0, s13, 155648
    s_nop 0
    buffer_load_dwordx4 v5, s[76:79], s12 offen lds
    s_lshl_b32 s12, s22, 11
    buffer_load_dwordx4 v[40:43], v5, s[24:27], s12 offen offset:0
    buffer_load_dwordx4 v[44:47], v5, s[24:27], s12 offen offset:1024
    buffer_load_dwordx4 v[48:51], v5, s[24:27], s12 offen offset:2048
    buffer_load_dwordx4 v[52:55], v5, s[24:27], s12 offen offset:3072
    buffer_load_dwordx4 v[56:59], v5, s[80:83], 0 offen offset:0
    buffer_load_dwordx4 v[60:63], v5, s[80:83], 0 offen offset:1024
    buffer_load_dwordx4 v[64:67], v5, s[84:87], 0 offen offset:0
    buffer_load_dwordx4 v[68:71], v5, s[84:87], 0 offen offset:1024
    s_waitcnt vmcnt(19)
    s_barrier
    s_bfe_u32 s91, s68, 0x4000c
    s_lshl_b32 s92, s91, 7
    s_mul_i32 s93, s91, 393216
    s_add_u32 m0, s94, 0
    s_nop 0
    buffer_load_dwordx4 v20, s[24:27], s92 offen offset:0 lds
    buffer_load_dwordx4 v21, s[24:27], s92 offen offset:1024 lds
    buffer_load_dwordx4 v22, s[24:27], s92 offen offset:2048 lds
    buffer_load_dwordx4 v23, s[24:27], s92 offen offset:3072 lds
    s_add_u32 m0, s95, 0
    s_nop 0
    buffer_load_dwordx4 v24, s[28:31], s93 offen offset:0 lds
    buffer_load_dwordx4 v25, s[28:31], s93 offen offset:1024 lds
    buffer_load_dwordx4 v26, s[28:31], s93 offen offset:2048 lds
    s_add_u32 m0, s95, 3072
    s_nop 0
    buffer_load_dwordx4 v27, s[28:31], s93 offen offset:0 lds
    buffer_load_dwordx4 v28, s[28:31], s93 offen offset:1024 lds
    buffer_load_dwordx4 v29, s[28:31], s93 offen offset:2048 lds
    s_cmp_lg_u32 s21, 0
    s_cbranch_scc1 L_noclr
    v_mov_b32 v104, -1
    v_mov_b32 v105, -1
    v_mov_b32 v106, -1
    v_mov_b32 v107, -1
    s_lshl_b32 s12, s19, 13
    s_lshl_b32 s13, s18, 9
    s_add_u32 s12, s12, s13
    s_add_u32 s12, s12, 32768
    s_lshl_b32 s13, s19, 8
    s_lshl_b32 s90, s18, 4
    s_add_u32 s13, s13, s90
    s_add_u32 s13, s13, 163840
    s_mov_b32 exec_hi, 0
    buffer_store_dwordx4 v[104:107], v5, s[32:35], s12 offen sc1
    s_mov_b32 exec_lo, 1
    buffer_store_dwordx4 v[104:107], v13, s[32:35], s13 offen sc1
    s_mov_b64 exec, -1
L_noclr:
    s_add_u32 s12, s71, 0
    buffer_load_dwordx4 v[128:131], v30, s[40:43], s12 offen nt
    s_add_u32 s12, s71, 7168
    buffer_load_dwordx4 v[132:135], v30, s[40:43], s12 offen nt
    s_add_u32 s12, s71, 14336
    buffer_load_dwordx4 v[136:139], v30, s[40:43], s12 offen nt
    s_add_u32 s12, s71, 21504
    buffer_load_dwordx4 v[140:143], v30, s[40:43], s12 offen nt
    s_add_u32 s12, s71, 28672
    buffer_load_dwordx4 v[144:147], v30, s[40:43], s12 offen nt
    s_add_u32 s12, s71, 35840
    buffer_load_dwordx4 v[148:151], v30, s[40:43], s12 offen nt
    s_add_u32 s12, s71, 43008
    buffer_load_dwordx4 v[152:155], v30, s[40:43], s12 offen nt
    s_add_u32 s12, s71, 50176
    buffer_load_dwordx4 v[156:159], v30, s[40:43], s12 offen nt
    s_waitcnt vmcnt(27)
    s_barrier
    s_bfe_u32 s91, s68, 0x40010
    s_lshl_b32 s92, s91, 7
    s_mul_i32 s93, s91, 393216
    s_add_u32 m0, s94, 40960
    s_nop 0
    buffer_load_dwordx4 v20, s[24:27], s92 offen offset:0 lds
    buffer_load_dwordx4 v21, s[24:27], s92 offen offset:1024 lds
    buffer_load_dwordx4 v22, s[24:27], s92 offen offset:2048 lds
    buffer_load_dwordx4 v23, s[24:27], s92 offen offset:3072 lds
    s_add_u32 m0, s95, 40960
    s_nop 0
    buffer_load_dwordx4 v24, s[28:31], s93 offen offset:0 lds
    buffer_load_dwordx4 v25, s[28:31], s93 offen offset:1024 lds
    buffer_load_dwordx4 v26, s[28:31], s93 offen offset:2048 lds
    s_add_u32 m0, s95, 44032
    s_nop 0
    buffer_load_dwordx4 v27, s[28:31], s93 offen offset:0 lds
    buffer_load_dwordx4 v28, s[28:31], s93 offen offset:1024 lds
    buffer_load_dwordx4 v29, s[28:31], s93 offen offset:2048 lds
    s_waitcnt vmcnt(28)
    v_lshlrev_b32 v72, 16, v64
    v_and_b32 v73, 0xffff0000, v64
    v_lshlrev_b32 v74, 16, v65
    v_and_b32 v75, 0xffff0000, v65
    v_lshlrev_b32 v76, 16, v66
    v_and_b32 v77, 0xffff0000, v66
    v_lshlrev_b32 v78, 16, v67
    v_and_b32 v79, 0xffff0000, v67
    v_lshlrev_b32 v80, 16, v68
    v_and_b32 v81, 0xffff0000, v68
    v_lshlrev_b32 v82, 16, v69
    v_and_b32 v83, 0xffff0000, v69
    v_lshlrev_b32 v84, 16, v70
    v_and_b32 v85, 0xffff0000, v70
    v_lshlrev_b32 v86, 16, v71
    v_and_b32 v87, 0xffff0000, v71
    v_mov_b32 v90, 0
    v_mov_b32 v91, 0
    v_dot2_f32_bf16 v90, v40, v56, v90
    v_lshlrev_b32 v94, 16, v40
    v_and_b32 v95, 0xffff0000, v40
    v_mul_f32 v94, v94, v72
    v_mul_f32 v95, v95, v73
    v_cvt_pk_bf16_f32 v94, v94, v95
    v_lshlrev_b32 v95, 16, v94
    v_and_b32 v94, 0xffff0000, v94
    v_add_f32 v91, v91, v95
    v_add_f32 v91, v91, v94
    v_dot2_f32_bf16 v90, v41, v57, v90
    v_lshlrev_b32 v94, 16, v41
    v_and_b32 v95, 0xffff0000, v41
    v_mul_f32 v94, v94, v74
    v_mul_f32 v95, v95, v75
    v_cvt_pk_bf16_f32 v94, v94, v95
    v_lshlrev_b32 v95, 16, v94
    v_and_b32 v94, 0xffff0000, v94
    v_add_f32 v91, v91, v95
    v_add_f32 v91, v91, v94
    v_dot2_f32_bf16 v90, v42, v58, v90
    v_lshlrev_b32 v94, 16, v42
    v_and_b32 v95, 0xffff0000, v42
    v_mul_f32 v94, v94, v76
    v_mul_f32 v95, v95, v77
    v_cvt_pk_bf16_f32 v94, v94, v95
    v_lshlrev_b32 v95, 16, v94
    v_and_b32 v94, 0xffff0000, v94
    v_add_f32 v91, v91, v95
    v_add_f32 v91, v91, v94
    v_dot2_f32_bf16 v90, v43, v59, v90
    v_lshlrev_b32 v94, 16, v43
    v_and_b32 v95, 0xffff0000, v43
    v_mul_f32 v94, v94, v78
    v_mul_f32 v95, v95, v79
    v_cvt_pk_bf16_f32 v94, v94, v95
    v_lshlrev_b32 v95, 16, v94
    v_and_b32 v94, 0xffff0000, v94
    v_add_f32 v91, v91, v95
    v_add_f32 v91, v91, v94
    v_dot2_f32_bf16 v90, v44, v60, v90
    v_lshlrev_b32 v94, 16, v44
    v_and_b32 v95, 0xffff0000, v44
    v_mul_f32 v94, v94, v80
    v_mul_f32 v95, v95, v81
    v_cvt_pk_bf16_f32 v94, v94, v95
    v_lshlrev_b32 v95, 16, v94
    v_and_b32 v94, 0xffff0000, v94
    v_add_f32 v91, v91, v95
    v_add_f32 v91, v91, v94
    v_dot2_f32_bf16 v90, v45, v61, v90
    v_lshlrev_b32 v94, 16, v45
    v_and_b32 v95, 0xffff0000, v45
    v_mul_f32 v94, v94, v82
    v_mul_f32 v95, v95, v83
    v_cvt_pk_bf16_f32 v94, v94, v95
    v_lshlrev_b32 v95, 16, v94
    v_and_b32 v94, 0xffff0000, v94
    v_add_f32 v91, v91, v95
    v_add_f32 v91, v91, v94
    v_dot2_f32_bf16 v90, v46, v62, v90
    v_lshlrev_b32 v94, 16, v46
    v_and_b32 v95, 0xffff0000, v46
    v_mul_f32 v94, v94, v84
    v_mul_f32 v95, v95, v85
    v_cvt_pk_bf16_f32 v94, v94, v95
    v_lshlrev_b32 v95, 16, v94
    v_and_b32 v94, 0xffff0000, v94
    v_add_f32 v91, v91, v95
    v_add_f32 v91, v91, v94
    v_dot2_f32_bf16 v90, v47, v63, v90
    v_lshlrev_b32 v94, 16, v47
    v_and_b32 v95, 0xffff0000, v47
    v_mul_f32 v94, v94, v86
    v_mul_f32 v95, v95, v87
    v_cvt_pk_bf16_f32 v94, v94, v95
    v_lshlrev_b32 v95, 16, v94
    v_and_b32 v94, 0xffff0000, v94
    v_add_f32 v91, v91, v95
    v_add_f32 v91, v91, v94
    v_mov_b32 v92, 0
    v_mov_b32 v93, 0
    v_dot2_f32_bf16 v92, v48, v56, v92
    v_lshlrev_b32 v94, 16, v48
    v_and_b32 v95, 0xffff0000, v48
    v_mul_f32 v94, v94, v72
    v_mul_f32 v95, v95, v73
    v_cvt_pk_bf16_f32 v94, v94, v95
    v_lshlrev_b32 v95, 16, v94
    v_and_b32 v94, 0xffff0000, v94
    v_add_f32 v93, v93, v95
    v_add_f32 v93, v93, v94
    v_dot2_f32_bf16 v92, v49, v57, v92
    v_lshlrev_b32 v94, 16, v49
    v_and_b32 v95, 0xffff0000, v49
    v_mul_f32 v94, v94, v74
    v_mul_f32 v95, v95, v75
    v_cvt_pk_bf16_f32 v94, v94, v95
    v_lshlrev_b32 v95, 16, v94
    v_and_b32 v94, 0xffff0000, v94
    v_add_f32 v93, v93, v95
    v_add_f32 v93, v93, v94
    v_dot2_f32_bf16 v92, v50, v58, v92
    buffer_load_dword v15, v13, s[72:75], 0 offen offset:4 sc1
    s_waitcnt vmcnt(19)
    s_barrier
    s_bfe_u32 s91, s68, 0x40014
    s_lshl_b32 s92, s91, 7
    s_mul_i32 s93, s91, 393216
    s_add_u32 m0, s94, 81920
    s_nop 0
    buffer_load_dwordx4 v20, s[24:27], s92 offen offset:0 lds
    buffer_load_dwordx4 v21, s[24:27], s92 offen offset:1024 lds
    buffer_load_dwordx4 v22, s[24:27], s92 offen offset:2048 lds
    buffer_load_dwordx4 v23, s[24:27], s92 offen offset:3072 lds
    s_add_u32 m0, s95, 81920
    s_nop 0
    buffer_load_dwordx4 v24, s[28:31], s93 offen offset:0 lds
    buffer_load_dwordx4 v25, s[28:31], s93 offen offset:1024 lds
    buffer_load_dwordx4 v26, s[28:31], s93 offen offset:2048 lds
    s_add_u32 m0, s95, 84992
    s_nop 0
    buffer_load_dwordx4 v27, s[28:31], s93 offen offset:0 lds
    buffer_load_dwordx4 v28, s[28:31], s93 offen offset:1024 lds
    buffer_load_dwordx4 v29, s[28:31], s93 offen offset:2048 lds
    v_lshlrev_b32 v94, 16, v50
    v_and_b32 v95, 0xffff0000, v50
    v_mul_f32 v94, v94, v76
    v_mul_f32 v95, v95, v77
    v_cvt_pk_bf16_f32 v94, v94, v95
    v_lshlrev_b32 v95, 16, v94
    v_and_b32 v94, 0xffff0000, v94
    v_add_f32 v93, v93, v95
    v_add_f32 v93, v93, v94
    v_dot2_f32_bf16 v92, v51, v59, v92
    v_lshlrev_b32 v94, 16, v51
    v_and_b32 v95, 0xffff0000, v51
    v_mul_f32 v94, v94, v78
    v_mul_f32 v95, v95, v79
    v_cvt_pk_bf16_f32 v94, v94, v95
    v_lshlrev_b32 v95, 16, v94
    v_and_b32 v94, 0xffff0000, v94
    v_add_f32 v93, v93, v95
    v_add_f32 v93, v93, v94
    v_dot2_f32_bf16 v92, v52, v60, v92
    v_lshlrev_b32 v94, 16, v52
    v_and_b32 v95, 0xffff0000, v52
    v_mul_f32 v94, v94, v80
    v_mul_f32 v95, v95, v81
    v_cvt_pk_bf16_f32 v94, v94, v95
    v_lshlrev_b32 v95, 16, v94
    v_and_b32 v94, 0xffff0000, v94
    v_add_f32 v93, v93, v95
    v_add_f32 v93, v93, v94
    v_dot2_f32_bf16 v92, v53, v61, v92
    v_lshlrev_b32 v94, 16, v53
    v_and_b32 v95, 0xffff0000, v53
    v_mul_f32 v94, v94, v82
    v_mul_f32 v95, v95, v83
    v_cvt_pk_bf16_f32 v94, v94, v95
    v_lshlrev_b32 v95, 16, v94
    v_and_b32 v94, 0xffff0000, v94
    v_add_f32 v93, v93, v95
    v_add_f32 v93, v93, v94
    v_dot2_f32_bf16 v92, v54, v62, v92
    v_lshlrev_b32 v94, 16, v54
    v_and_b32 v95, 0xffff0000, v54
    v_mul_f32 v94, v94, v84
    v_mul_f32 v95, v95, v85
    v_cvt_pk_bf16_f32 v94, v94, v95
    v_lshlrev_b32 v95, 16, v94
    v_and_b32 v94, 0xffff0000, v94
    v_add_f32 v93, v93, v95
    v_add_f32 v93, v93, v94
    v_dot2_f32_bf16 v92, v55, v63, v92
    v_lshlrev_b32 v94, 16, v55
    v_and_b32 v95, 0xffff0000, v55
    v_mul_f32 v94, v94, v86
    v_mul_f32 v95, v95, v87
    v_cvt_pk_bf16_f32 v94, v94, v95
    v_lshlrev_b32 v95, 16, v94
    v_and_b32 v94, 0xffff0000, v94
    v_add_f32 v93, v93, v95
    v_add_f32 v93, v93, v94
    v_add_f32_dpp v90, v90, v90 row_shr:1 row_mask:0xf bank_mask:0xf
    v_add_f32_dpp v91, v91, v91 row_shr:1 row_mask:0xf bank_mask:0xf
    v_add_f32_dpp v92, v92, v92 row_shr:1 row_mask:0xf bank_mask:0xf
    v_add_f32_dpp v93, v93, v93 row_shr:1 row_mask:0xf bank_mask:0xf
    v_add_f32_dpp v90, v90, v90 row_shr:2 row_mask:0xf bank_mask:0xf
    v_add_f32_dpp v91, v91, v91 row_shr:2 row_mask:0xf bank_mask:0xf
    v_add_f32_dpp v92, v92, v92 row_shr:2 row_mask:0xf bank_mask:0xf
    v_add_f32_dpp v93, v93, v93 row_shr:2 row_mask:0xf bank_mask:0xf
    v_add_f32_dpp v90, v90, v90 row_shr:4 row_mask:0xf bank_mask:0xf
    v_add_f32_dpp v91, v91, v91 row_shr:4 row_mask:0xf bank_mask:0xf
    v_add_f32_dpp v92, v92, v92 row_shr:4 row_mask:0xf bank_mask:0xf
    v_add_f32_dpp v93, v93, v93 row_shr:4 row_mask:0xf bank_mask:0xf
    v_add_f32_dpp v90, v90, v90 row_shr:8 row_mask:0xf bank_mask:0xf
    v_add_f32_dpp v91, v91, v91 row_shr:8 row_mask:0xf bank_mask:0xf
    v_add_f32_dpp v92, v92, v92 row_shr:8 row_mask:0xf bank_mask:0xf
    v_add_f32_dpp v93, v93, v93 row_shr:8 row_mask:0xf bank_mask:0xf
    v_add_f32_dpp v90, v90, v90 row_bcast:15 row_mask:0xa bank_mask:0xf
    v_add_f32_dpp v91, v91, v91 row_bcast:15 row_mask:0xa bank_mask:0xf
    v_add_f32_dpp v92, v92, v92 row_bcast:15 row_mask:0xa bank_mask:0xf
    v_add_f32_dpp v93, v93, v93 row_bcast:15 row_mask:0xa bank_mask:0xf
    v_add_f32_dpp v90, v90, v90 row_bcast:31 row_mask:0xc bank_mask:0xf
    v_add_f32_dpp v91, v91, v91 row_bcast:31 row_mask:0xc bank_mask:0xf
    v_add_f32_dpp v92, v92, v92 row_bcast:31 row_mask:0xc bank_mask:0xf
    v_add_f32_dpp v93, v93, v93 row_bcast:31 row_mask:0xc bank_mask:0xf
    v_cvt_pk_bf16_f32 v94, v90, v91
    v_and_b32 v95, 0xffff, v94
    v_and_b32 v96, 0x8000, v94
    v_cmp_ne_u32 vcc, 0, v96
    v_mov_b32 v97, 0x8000
    v_mov_b32 v98, 0xffff
    v_cndmask_b32 v96, v97, v98, vcc
    v_xor_b32 v95, v95, v96
    s_sub_u32 s12, 2047, s22
    v_lshlrev_b32 v95, 11, v95
    v_or_b32 v100, s12, v95
    v_and_b32 v94, 0xffff0000, v94
    v_mul_f32 v94, 0xbfb8aa3b, v94
    v_exp_f32 v94, v94
    s_nop 0
    v_add_f32 v94, 1.0, v94
    v_rcp_f32 v94, v94
    s_nop 0
    v_cvt_pk_bf16_f32 v94, v94, v94
    v_lshlrev_b32 v102, 16, v94
    v_cvt_pk_bf16_f32 v94, v92, v93
    v_and_b32 v95, 0xffff, v94
    v_and_b32 v96, 0x8000, v94
    v_cmp_ne_u32 vcc, 0, v96
    v_mov_b32 v97, 0x8000
    v_mov_b32 v98, 0xffff
    v_cndmask_b32 v96, v97, v98, vcc
    v_xor_b32 v95, v95, v96
    s_sub_u32 s12, 2046, s22
    v_lshlrev_b32 v95, 11, v95
    v_or_b32 v101, s12, v95
    v_and_b32 v94, 0xffff0000, v94
    v_mul_f32 v94, 0xbfb8aa3b, v94
    v_exp_f32 v94, v94
    s_nop 0
    v_add_f32 v94, 1.0, v94
    v_rcp_f32 v94, v94
    s_nop 0
    v_cvt_pk_bf16_f32 v94, v94, v94
    v_lshlrev_b32 v103, 16, v94
    v_max_u32 v100, v100, v101
    s_lshl_b32 s12, s22, 2
    s_add_u32 s12, s12, 4096
    s_lshl_b32 s13, s21, 2
    s_add_u32 s13, s13, 162880
    v_mov_b32 v14, s13
    s_mov_b32 exec_lo, 0
    s_mov_b32 exec_hi, 0x80000000
    buffer_store_dwordx2 v[102:103], v13, s[32:35], s12 offen sc1
    ds_write_b32 v14, v100
    s_mov_b64 exec, -1
    s_waitcnt lgkmcnt(0)
    s_waitcnt vmcnt(12)
    s_barrier
    s_bfe_u32 s91, s68, 0x40018
    s_lshl_b32 s92, s91, 7
    s_mul_i32 s93, s91, 393216
    s_add_u32 m0, s94, 0
    s_nop 0
    buffer_load_dwordx4 v20, s[24:27], s92 offen offset:0 lds
    buffer_load_dwordx4 v21, s[24:27], s92 offen offset:1024 lds
    buffer_load_dwordx4 v22, s[24:27], s92 offen offset:2048 lds
    buffer_load_dwordx4 v23, s[24:27], s92 offen offset:3072 lds
    s_add_u32 m0, s95, 0
    s_nop 0
    buffer_load_dwordx4 v24, s[28:31], s93 offen offset:0 lds
    buffer_load_dwordx4 v25, s[28:31], s93 offen offset:1024 lds
    buffer_load_dwordx4 v26, s[28:31], s93 offen offset:2048 lds
    s_add_u32 m0, s95, 3072
    s_nop 0
    buffer_load_dwordx4 v27, s[28:31], s93 offen offset:0 lds
    buffer_load_dwordx4 v28, s[28:31], s93 offen offset:1024 lds
    buffer_load_dwordx4 v29, s[28:31], s93 offen offset:2048 lds
    s_add_u32 s12, s71, 0
    buffer_load_dwordx4 v[160:163], v30, s[44:47], s12 offen nt
    s_add_u32 s12, s71, 7168
    buffer_load_dwordx4 v[164:167], v30, s[44:47], s12 offen nt
    s_add_u32 s12, s71, 14336
    buffer_load_dwordx4 v[168:171], v30, s[44:47], s12 offen nt
    s_add_u32 s12, s71, 21504
    buffer_load_dwordx4 v[172:175], v30, s[44:47], s12 offen nt
    s_add_u32 s12, s71, 28672
    buffer_load_dwordx4 v[176:179], v30, s[44:47], s12 offen nt
    s_add_u32 s12, s71, 35840
    buffer_load_dwordx4 v[180:183], v30, s[44:47], s12 offen nt
    s_add_u32 s12, s71, 43008
    buffer_load_dwordx4 v[184:187], v30, s[44:47], s12 offen nt
    s_add_u32 s12, s71, 50176
    buffer_load_dwordx4 v[188:191], v30, s[44:47], s12 offen nt
    s_waitcnt vmcnt(19)
    s_barrier
    s_bfe_u32 s91, s68, 0x4001c
    s_lshl_b32 s92, s91, 7
    s_mul_i32 s93, s91, 393216
    s_add_u32 m0, s94, 40960
    s_nop 0
    buffer_load_dwordx4 v20, s[24:27], s92 offen offset:0 lds
    buffer_load_dwordx4 v21, s[24:27], s92 offen offset:1024 lds
    buffer_load_dwordx4 v22, s[24:27], s92 offen offset:2048 lds
    buffer_load_dwordx4 v23, s[24:27], s92 offen offset:3072 lds
    s_add_u32 m0, s95, 40960
    s_nop 0
    buffer_load_dwordx4 v24, s[28:31], s93 offen offset:0 lds
    buffer_load_dwordx4 v25, s[28:31], s93 offen offset:1024 lds
    buffer_load_dwordx4 v26, s[28:31], s93 offen offset:2048 lds
    s_add_u32 m0, s95, 44032
    s_nop 0
    buffer_load_dwordx4 v27, s[28:31], s93 offen offset:0 lds
    buffer_load_dwordx4 v28, s[28:31], s93 offen offset:1024 lds
    buffer_load_dwordx4 v29, s[28:31], s93 offen offset:2048 lds
    s_waitcnt vmcnt(18)
    s_barrier
    s_bfe_u32 s91, s69, 0x40000
    s_lshl_b32 s92, s91, 7
    s_mul_i32 s93, s91, 393216
    s_add_u32 m0, s94, 81920
    s_nop 0
    buffer_load_dwordx4 v20, s[24:27], s92 offen offset:0 lds
    buffer_load_dwordx4 v21, s[24:27], s92 offen offset:1024 lds
    buffer_load_dwordx4 v22, s[24:27], s92 offen offset:2048 lds
    buffer_load_dwordx4 v23, s[24:27], s92 offen offset:3072 lds
    s_add_u32 m0, s95, 81920
    s_nop 0
    buffer_load_dwordx4 v24, s[28:31], s93 offen offset:0 lds
    buffer_load_dwordx4 v25, s[28:31], s93 offen offset:1024 lds
    buffer_load_dwordx4 v26, s[28:31], s93 offen offset:2048 lds
    s_add_u32 m0, s95, 84992
    s_nop 0
    buffer_load_dwordx4 v27, s[28:31], s93 offen offset:0 lds
    buffer_load_dwordx4 v28, s[28:31], s93 offen offset:1024 lds
    buffer_load_dwordx4 v29, s[28:31], s93 offen offset:2048 lds
    s_mov_b32 s13, 0
L_tagchk:
    v_readfirstlane_b32 s23, v15
    s_nop 1
    s_cmp_lg_u32 s23, 0
    s_cbranch_scc1 L_tagok
    s_add_u32 s13, s13, 1
    s_cmp_ge_u32 s13, 16384
    s_cbranch_scc1 L_tagok
    buffer_load_dword v15, v13, s[72:75], 0 offen offset:4 sc1
    s_waitcnt vmcnt(0)
    s_branch L_tagchk
L_tagok:
    s_and_b32 s76, s23, 0xff
    s_bfe_u32 s77, s23, 0x80008
    s_bfe_u32 s78, s23, 0x80010
    s_lshr_b32 s79, s23, 24
    v_and_b32 v35, 3, v2
    v_lshlrev_b32 v35, 3, v35
    v_bfe_u32 v35, s23, v35, 8
    s_cmp_lg_u32 s21, 0
    s_cbranch_scc1 L_nopub
    v_mov_b32 v14, 162880
    ds_read_b128 v[104:107], v14
    s_lshl_b32 s12, s2, 3
    s_add_u32 s12, s12, 0
    s_waitcnt lgkmcnt(0)
    v_max3_u32 v104, v104, v105, v106
    v_max_u32 v104, v104, v107
    v_mov_b32 v105, s23
    s_mov_b64 exec, 1
    buffer_store_dwordx2 v[104:105], v13, s[32:35], s12 offen sc1
    s_mov_b64 exec, -1
L_nopub:
    s_waitcnt vmcnt(10)
    s_barrier
    s_bfe_u32 s91, s69, 0x40004
    s_lshl_b32 s92, s91, 7
    s_mul_i32 s93, s91, 393216
    s_add_u32 m0, s94, 0
    s_nop 0
    buffer_load_dwordx4 v20, s[24:27], s92 offen offset:0 lds
    buffer_load_dwordx4 v21, s[24:27], s92 offen offset:1024 lds
    buffer_load_dwordx4 v22, s[24:27], s92 offen offset:2048 lds
    buffer_load_dwordx4 v23, s[24:27], s92 offen offset:3072 lds
    s_add_u32 m0, s95, 0
    s_nop 0
    buffer_load_dwordx4 v24, s[28:31], s93 offen offset:0 lds
    buffer_load_dwordx4 v25, s[28:31], s93 offen offset:1024 lds
    buffer_load_dwordx4 v26, s[28:31], s93 offen offset:2048 lds
    s_add_u32 m0, s95, 3072
    s_nop 0
    buffer_load_dwordx4 v27, s[28:31], s93 offen offset:0 lds
    buffer_load_dwordx4 v28, s[28:31], s93 offen offset:1024 lds
    buffer_load_dwordx4 v29, s[28:31], s93 offen offset:2048 lds
    s_add_u32 s12, s97, 0
    buffer_load_dwordx4 v[192:195], v31, s[64:67], s12 offen nt
    s_add_u32 s12, s97, 16384
    buffer_load_dwordx4 v[196:199], v31, s[64:67], s12 offen nt
    s_add_u32 s12, s97, 32768
    buffer_load_dwordx4 v[200:203], v31, s[64:67], s12 offen nt
    s_add_u32 s12, s97, 49152
    buffer_load_dwordx4 v[204:207], v31, s[64:67], s12 offen nt
    s_add_u32 s12, s97, 65536
    buffer_load_dwordx4 v[208:211], v31, s[64:67], s12 offen nt
    s_add_u32 s12, s97, 81920
    buffer_load_dwordx4 v[212:215], v31, s[64:67], s12 offen nt
    s_add_u32 s12, s97, 98304
    buffer_load_dwordx4 v[216:219], v31, s[64:67], s12 offen nt
    s_waitcnt vmcnt(17)
    s_barrier
    s_bfe_u32 s91, s69, 0x40008
    s_lshl_b32 s92, s91, 7
    s_mul_i32 s93, s91, 393216
    s_add_u32 m0, s94, 40960
    s_nop 0
    buffer_load_dwordx4 v20, s[24:27], s92 offen offset:0 lds
    buffer_load_dwordx4 v21, s[24:27], s92 offen offset:1024 lds
    buffer_load_dwordx4 v22, s[24:27], s92 offen offset:2048 lds
    buffer_load_dwordx4 v23, s[24:27], s92 offen offset:3072 lds
    s_add_u32 m0, s95, 40960
    s_nop 0
    buffer_load_dwordx4 v24, s[28:31], s93 offen offset:0 lds
    buffer_load_dwordx4 v25, s[28:31], s93 offen offset:1024 lds
    buffer_load_dwordx4 v26, s[28:31], s93 offen offset:2048 lds
    s_add_u32 m0, s95, 44032
    s_nop 0
    buffer_load_dwordx4 v27, s[28:31], s93 offen offset:0 lds
    buffer_load_dwordx4 v28, s[28:31], s93 offen offset:1024 lds
    buffer_load_dwordx4 v29, s[28:31], s93 offen offset:2048 lds
    s_waitcnt vmcnt(17)
    s_barrier
    s_bfe_u32 s91, s69, 0x4000c
    s_lshl_b32 s92, s91, 7
    s_mul_i32 s93, s91, 393216
    s_add_u32 m0, s94, 81920
    s_nop 0
    buffer_load_dwordx4 v20, s[24:27], s92 offen offset:0 lds
    buffer_load_dwordx4 v21, s[24:27], s92 offen offset:1024 lds
    buffer_load_dwordx4 v22, s[24:27], s92 offen offset:2048 lds
    buffer_load_dwordx4 v23, s[24:27], s92 offen offset:3072 lds
    s_add_u32 m0, s95, 81920
    s_nop 0
    buffer_load_dwordx4 v24, s[28:31], s93 offen offset:0 lds
    buffer_load_dwordx4 v25, s[28:31], s93 offen offset:1024 lds
    buffer_load_dwordx4 v26, s[28:31], s93 offen offset:2048 lds
    s_add_u32 m0, s95, 84992
    s_nop 0
    buffer_load_dwordx4 v27, s[28:31], s93 offen offset:0 lds
    buffer_load_dwordx4 v28, s[28:31], s93 offen offset:1024 lds
    buffer_load_dwordx4 v29, s[28:31], s93 offen offset:2048 lds
    s_waitcnt vmcnt(10)
    s_barrier
    s_bfe_u32 s91, s69, 0x40010
    s_lshl_b32 s92, s91, 7
    s_mul_i32 s93, s91, 393216
    s_add_u32 m0, s94, 0
    s_nop 0
    buffer_load_dwordx4 v20, s[24:27], s92 offen offset:0 lds
    buffer_load_dwordx4 v21, s[24:27], s92 offen offset:1024 lds
    buffer_load_dwordx4 v22, s[24:27], s92 offen offset:2048 lds
    buffer_load_dwordx4 v23, s[24:27], s92 offen offset:3072 lds
    s_add_u32 m0, s95, 0
    s_nop 0
    buffer_load_dwordx4 v24, s[28:31], s93 offen offset:0 lds
    buffer_load_dwordx4 v25, s[28:31], s93 offen offset:1024 lds
    buffer_load_dwordx4 v26, s[28:31], s93 offen offset:2048 lds
    s_add_u32 m0, s95, 3072
    s_nop 0
    buffer_load_dwordx4 v27, s[28:31], s93 offen offset:0 lds
    buffer_load_dwordx4 v28, s[28:31], s93 offen offset:1024 lds
    buffer_load_dwordx4 v29, s[28:31], s93 offen offset:2048 lds
    s_waitcnt vmcnt(10)
    s_barrier
    s_bfe_u32 s91, s69, 0x40014
    s_lshl_b32 s92, s91, 7
    s_mul_i32 s93, s91, 393216
    s_add_u32 m0, s94, 40960
    s_nop 0
    buffer_load_dwordx4 v20, s[24:27], s92 offen offset:0 lds
    buffer_load_dwordx4 v21, s[24:27], s92 offen offset:1024 lds
    buffer_load_dwordx4 v22, s[24:27], s92 offen offset:2048 lds
    buffer_load_dwordx4 v23, s[24:27], s92 offen offset:3072 lds
    s_add_u32 m0, s95, 40960
    s_nop 0
    buffer_load_dwordx4 v24, s[28:31], s93 offen offset:0 lds
    buffer_load_dwordx4 v25, s[28:31], s93 offen offset:1024 lds
    buffer_load_dwordx4 v26, s[28:31], s93 offen offset:2048 lds
    s_add_u32 m0, s95, 44032
    s_nop 0
    buffer_load_dwordx4 v27, s[28:31], s93 offen offset:0 lds
    buffer_load_dwordx4 v28, s[28:31], s93 offen offset:1024 lds
    buffer_load_dwordx4 v29, s[28:31], s93 offen offset:2048 lds
    s_mov_b32 s12, 0
    buffer_load_dwordx4 v[104:107], v5, s[32:35], s12 offen offset:0 sc1
    buffer_load_dwordx4 v[108:111], v5, s[32:35], s12 offen offset:1024 sc1
    s_waitcnt vmcnt(12)
    s_barrier
    s_bfe_u32 s91, s69, 0x40018
    s_lshl_b32 s92, s91, 7
    s_mul_i32 s93, s91, 393216
    s_add_u32 m0, s94, 81920
    s_nop 0
    buffer_load_dwordx4 v20, s[24:27], s92 offen offset:0 lds
    buffer_load_dwordx4 v21, s[24:27], s92 offen offset:1024 lds
    buffer_load_dwordx4 v22, s[24:27], s92 offen offset:2048 lds
    buffer_load_dwordx4 v23, s[24:27], s92 offen offset:3072 lds
    s_add_u32 m0, s95, 81920
    s_nop 0
    buffer_load_dwordx4 v24, s[28:31], s93 offen offset:0 lds
    buffer_load_dwordx4 v25, s[28:31], s93 offen offset:1024 lds
    buffer_load_dwordx4 v26, s[28:31], s93 offen offset:2048 lds
    s_add_u32 m0, s95, 84992
    s_nop 0
    buffer_load_dwordx4 v27, s[28:31], s93 offen offset:0 lds
    buffer_load_dwordx4 v28, s[28:31], s93 offen offset:1024 lds
    buffer_load_dwordx4 v29, s[28:31], s93 offen offset:2048 lds
    s_waitcnt vmcnt(12)
    s_barrier
    s_bfe_u32 s91, s69, 0x4001c
    s_lshl_b32 s92, s91, 7
    s_mul_i32 s93, s91, 393216
    s_add_u32 m0, s94, 0
    s_nop 0
    buffer_load_dwordx4 v20, s[24:27], s92 offen offset:0 lds
    buffer_load_dwordx4 v21, s[24:27], s92 offen offset:1024 lds
    buffer_load_dwordx4 v22, s[24:27], s92 offen offset:2048 lds
    buffer_load_dwordx4 v23, s[24:27], s92 offen offset:3072 lds
    s_add_u32 m0, s95, 0
    s_nop 0
    buffer_load_dwordx4 v24, s[28:31], s93 offen offset:0 lds
    buffer_load_dwordx4 v25, s[28:31], s93 offen offset:1024 lds
    buffer_load_dwordx4 v26, s[28:31], s93 offen offset:2048 lds
    s_add_u32 m0, s95, 3072
    s_nop 0
    buffer_load_dwordx4 v27, s[28:31], s93 offen offset:0 lds
    buffer_load_dwordx4 v28, s[28:31], s93 offen offset:1024 lds
    buffer_load_dwordx4 v29, s[28:31], s93 offen offset:2048 lds
    s_waitcnt vmcnt(20)
    s_mov_b32 s13, 0
L_keychk:
    v_xor_b32 v105, s23, v105
    v_xor_b32 v107, s23, v107
    v_xor_b32 v109, s23, v109
    v_xor_b32 v111, s23, v111
    v_or3_b32 v105, v105, v107, v109
    v_or_b32 v105, v105, v111
    v_cmp_ne_u32 vcc, 0, v105
    s_cbranch_vccz L_keyok
    s_add_u32 s13, s13, 1
    s_cmp_ge_u32 s13, 16384
    s_cbranch_scc1 L_keyok
    s_mov_b32 s12, 0
    buffer_load_dwordx4 v[104:107], v5, s[32:35], s12 offen offset:0 sc1
    buffer_load_dwordx4 v[108:111], v5, s[32:35], s12 offen offset:1024 sc1
    s_waitcnt vmcnt(0)
    s_branch L_keychk
L_keyok:
    v_max3_u32 v104, v104, v106, v108
    v_max_u32 v104, v104, v110
    s_nop 1
    v_max_u32_dpp v104, v104, v104 row_shr:1 row_mask:0xf bank_mask:0xf
    s_nop 1
    v_max_u32_dpp v104, v104, v104 row_shr:2 row_mask:0xf bank_mask:0xf
    s_nop 1
    v_max_u32_dpp v104, v104, v104 row_shr:4 row_mask:0xf bank_mask:0xf
    s_nop 1
    v_max_u32_dpp v104, v104, v104 row_shr:8 row_mask:0xf bank_mask:0xf
    s_nop 1
    v_max_u32_dpp v104, v104, v104 row_bcast:15 row_mask:0xa bank_mask:0xf
    s_nop 1
    v_max_u32_dpp v104, v104, v104 row_bcast:31 row_mask:0xc bank_mask:0xf
    s_nop 0
    v_readlane_b32 s14, v104, 63
    s_nop 1
    s_and_b32 s15, s14, 2047
    s_sub_u32 s15, 2047, s15
    s_lshl_b32 s12, s15, 11
    s_lshl_b32 s13, s70, 1
    s_add_u32 s12, s12, s13
    buffer_load_dwordx4 v[36:39], v34, s[24:27], s12 offen
    s_lshr_b32 s12, s14, 11
    s_and_b32 s13, s12, 0x8000
    s_cmp_lg_u32 s13, 0
    s_mov_b32 s13, 0xffff
    s_cselect_b32 s13, 0x8000, s13
    s_xor_b32 s12, s12, s13
    s_lshl_b32 s12, s12, 16
    v_mov_b32 v105, s12
    v_mul_f32 v105, 0xbfb8aa3b, v105
    v_exp_f32 v105, v105
    s_nop 0
    v_add_f32 v105, 1.0, v105
    v_rcp_f32 v105, v105
    s_nop 0
    v_cvt_pk_bf16_f32 v105, v105, v105
    v_lshlrev_b32 v105, 16, v105
    s_nop 0
    v_readfirstlane_b32 s14, v105
    s_add_u32 s12, s15, 1
    v_mov_b32 v104, s12
    v_mov_b32 v106, s23
    v_mov_b32 v14, 162864
    s_mov_b64 exec, 1
    ds_write_b96 v14, v[104:106]
    s_mov_b64 exec, -1
    s_waitcnt lgkmcnt(0)
    s_waitcnt vmcnt(11)
    s_barrier
    s_mul_i32 s12, s21, 8
    s_add_u32 s12, s12, 96
    s_lshl_b32 s13, s12, 10
    s_lshl_b32 s12, s12, 14
    s_add_u32 m0, s13, 24576
    s_add_u32 s90, s12, 0
    buffer_load_dwordx4 v32, s[36:39], s90 offen lds
    s_add_u32 m0, s13, 25600
    s_add_u32 s90, s12, 16384
    buffer_load_dwordx4 v32, s[36:39], s90 offen lds
    s_add_u32 m0, s13, 26624
    s_add_u32 s90, s12, 32768
    buffer_load_dwordx4 v32, s[36:39], s90 offen lds
    s_add_u32 m0, s13, 27648
    s_add_u32 s90, s12, 49152
    buffer_load_dwordx4 v32, s[36:39], s90 offen lds
    s_add_u32 m0, s13, 28672
    s_add_u32 s90, s12, 65536
    buffer_load_dwordx4 v32, s[36:39], s90 offen lds
    s_add_u32 m0, s13, 29696
    s_add_u32 s90, s12, 81920
    buffer_load_dwordx4 v32, s[36:39], s90 offen lds
    s_add_u32 m0, s13, 30720
    s_add_u32 s90, s12, 98304
    buffer_load_dwordx4 v32, s[36:39], s90 offen lds
    s_add_u32 m0, s13, 31744
    s_add_u32 s90, s12, 114688
    buffer_load_dwordx4 v32, s[36:39], s90 offen lds
    s_waitcnt vmcnt(9)
    s_barrier
    s_mul_i32 s12, s21, 4
    s_add_u32 s12, s12, 40
    s_lshl_b32 s13, s12, 10
    s_lshl_b32 s12, s12, 14
    s_add_u32 m0, s13, 24576
    s_add_u32 s90, s12, 0
    buffer_load_dwordx4 v32, s[36:39], s90 offen lds
    s_add_u32 m0, s13, 25600
    s_add_u32 s90, s12, 16384
    buffer_load_dwordx4 v32, s[36:39], s90 offen lds
    s_add_u32 m0, s13, 26624
    s_add_u32 s90, s12, 32768
    buffer_load_dwordx4 v32, s[36:39], s90 offen lds
    s_add_u32 m0, s13, 27648
    s_add_u32 s90, s12, 49152
    buffer_load_dwordx4 v32, s[36:39], s90 offen lds
    s_mul_i32 s12, s21, 10
    s_add_u32 s12, s12, 56
    s_lshl_b32 s13, s12, 10
    s_lshl_b32 s12, s12, 14
    s_add_u32 m0, s13, 24576
    s_add_u32 s90, s12, 0
    buffer_load_dwordx4 v32, s[36:39], s90 offen lds
    s_add_u32 m0, s13, 25600
    s_add_u32 s90, s12, 16384
    buffer_load_dwordx4 v32, s[36:39], s90 offen lds
    s_add_u32 m0, s13, 26624
    s_add_u32 s90, s12, 32768
    buffer_load_dwordx4 v32, s[36:39], s90 offen lds
    s_add_u32 m0, s13, 27648
    s_add_u32 s90, s12, 49152
    buffer_load_dwordx4 v32, s[36:39], s90 offen lds
    s_add_u32 m0, s13, 28672
    s_add_u32 s90, s12, 65536
    buffer_load_dwordx4 v32, s[36:39], s90 offen lds
    s_add_u32 m0, s13, 29696
    s_add_u32 s90, s12, 81920
    buffer_load_dwordx4 v32, s[36:39], s90 offen lds
    s_add_u32 m0, s13, 30720
    s_add_u32 s90, s12, 98304
    buffer_load_dwordx4 v32, s[36:39], s90 offen lds
    s_add_u32 m0, s13, 31744
    s_add_u32 s90, s12, 114688
    buffer_load_dwordx4 v32, s[36:39], s90 offen lds
    s_add_u32 m0, s13, 32768
    s_add_u32 s90, s12, 131072
    buffer_load_dwordx4 v32, s[36:39], s90 offen lds
    s_add_u32 m0, s13, 33792
    s_add_u32 s90, s12, 147456
    buffer_load_dwordx4 v32, s[36:39], s90 offen lds
    v_mov_b32 v14, 162816
    s_mov_b32 s13, 0
L_dspin:
    ds_read_b128 v[104:107], v14
    s_add_u32 s13, s13, 1
    s_cmp_ge_u32 s13, 262144
    s_cbranch_scc1 L_dok
    s_waitcnt lgkmcnt(0)
    v_and_b32 v104, v104, v105
    v_and_b32 v106, v106, v107
    v_and_b32 v104, v104, v106
    v_cmp_eq_u32 vcc, 1, v104
    s_cbranch_vccz L_dspin
L_dok:
    s_waitcnt lgkmcnt(0)
    s_mul_i32 s12, s21, 10
    s_add_u32 s12, s12, 0
    s_lshl_b32 s13, s12, 10
    s_lshl_b32 s12, s12, 14
    s_add_u32 m0, s13, 0
    s_add_u32 s90, s12, 0
    buffer_load_dwordx4 v32, s[36:39], s90 offen lds
    s_add_u32 m0, s13, 1024
    s_add_u32 s90, s12, 16384
    buffer_load_dwordx4 v32, s[36:39], s90 offen lds
    s_add_u32 m0, s13, 2048
    s_add_u32 s90, s12, 32768
    buffer_load_dwordx4 v32, s[36:39], s90 offen lds
    s_add_u32 m0, s13, 3072
    s_add_u32 s90, s12, 49152
    buffer_load_dwordx4 v32, s[36:39], s90 offen lds
    s_add_u32 m0, s13, 4096
    s_add_u32 s90, s12, 65536
    buffer_load_dwordx4 v32, s[36:39], s90 offen lds
    s_add_u32 m0, s13, 5120
    s_add_u32 s90, s12, 81920
    buffer_load_dwordx4 v32, s[36:39], s90 offen lds
    s_add_u32 m0, s13, 6144
    s_add_u32 s90, s12, 98304
    buffer_load_dwordx4 v32, s[36:39], s90 offen lds
    s_add_u32 m0, s13, 7168
    s_add_u32 s90, s12, 114688
    buffer_load_dwordx4 v32, s[36:39], s90 offen lds
    s_add_u32 m0, s13, 8192
    s_add_u32 s90, s12, 131072
    buffer_load_dwordx4 v32, s[36:39], s90 offen lds
    s_add_u32 m0, s13, 9216
    s_add_u32 s90, s12, 147456
    buffer_load_dwordx4 v32, s[36:39], s90 offen lds
    s_waitcnt vmcnt(32)
    v_and_b32 v40, 0xffff, v36
    v_lshlrev_b32 v41, 16, v36
    v_lshrrev_b32 v42, 16, v36
    v_and_b32 v43, 0xffff0000, v36
    v_and_b32 v44, 0xffff, v37
    v_lshlrev_b32 v45, 16, v37
    v_lshrrev_b32 v46, 16, v37
    v_and_b32 v47, 0xffff0000, v37
    v_and_b32 v48, 0xffff, v38
    v_lshlrev_b32 v49, 16, v38
    v_lshrrev_b32 v50, 16, v38
    v_and_b32 v51, 0xffff0000, v38
    v_and_b32 v52, 0xffff, v39
    v_lshlrev_b32 v53, 16, v39
    v_lshrrev_b32 v54, 16, v39
    v_and_b32 v55, 0xffff0000, v39
    v_dot2_f32_bf16 v220, v128, v40, 0
    v_dot2_f32_bf16 v221, v128, v41, 0
    v_dot2_f32_bf16 v222, v129, v40, 0
    v_dot2_f32_bf16 v223, v129, v41, 0
    v_dot2_f32_bf16 v224, v130, v40, 0
    v_dot2_f32_bf16 v225, v130, v41, 0
    v_dot2_f32_bf16 v226, v131, v40, 0
    v_dot2_f32_bf16 v227, v131, v41, 0
    v_dot2_f32_bf16 v228, v160, v40, 0
    v_dot2_f32_bf16 v229, v160, v41, 0
    v_dot2_f32_bf16 v230, v161, v40, 0
    v_dot2_f32_bf16 v231, v161, v41, 0
    v_dot2_f32_bf16 v232, v162, v40, 0
    v_dot2_f32_bf16 v233, v162, v41, 0
    v_dot2_f32_bf16 v234, v163, v40, 0
    v_dot2_f32_bf16 v235, v163, v41, 0
    v_dot2_f32_bf16 v220, v132, v42, v220
    v_dot2_f32_bf16 v221, v132, v43, v221
    v_dot2_f32_bf16 v222, v133, v42, v222
    v_dot2_f32_bf16 v223, v133, v43, v223
    v_dot2_f32_bf16 v224, v134, v42, v224
    v_dot2_f32_bf16 v225, v134, v43, v225
    v_dot2_f32_bf16 v226, v135, v42, v226
    v_dot2_f32_bf16 v227, v135, v43, v227
    v_dot2_f32_bf16 v228, v164, v42, v228
    v_dot2_f32_bf16 v229, v164, v43, v229
    v_dot2_f32_bf16 v230, v165, v42, v230
    v_dot2_f32_bf16 v231, v165, v43, v231
    v_dot2_f32_bf16 v232, v166, v42, v232
    v_dot2_f32_bf16 v233, v166, v43, v233
    v_dot2_f32_bf16 v234, v167, v42, v234
    v_dot2_f32_bf16 v235, v167, v43, v235
    v_dot2_f32_bf16 v220, v136, v44, v220
    v_dot2_f32_bf16 v221, v136, v45, v221
    v_dot2_f32_bf16 v222, v137, v44, v222
    v_dot2_f32_bf16 v223, v137, v45, v223
    v_dot2_f32_bf16 v224, v138, v44, v224
    v_dot2_f32_bf16 v225, v138, v45, v225
    v_dot2_f32_bf16 v226, v139, v44, v226
    v_dot2_f32_bf16 v227, v139, v45, v227
    v_dot2_f32_bf16 v228, v168, v44, v228
    v_dot2_f32_bf16 v229, v168, v45, v229
    v_dot2_f32_bf16 v230, v169, v44, v230
    v_dot2_f32_bf16 v231, v169, v45, v231
    v_dot2_f32_bf16 v232, v170, v44, v232
    v_dot2_f32_bf16 v233, v170, v45, v233
    v_dot2_f32_bf16 v234, v171, v44, v234
    v_dot2_f32_bf16 v235, v171, v45, v235
    v_dot2_f32_bf16 v220, v140, v46, v220
    v_dot2_f32_bf16 v221, v140, v47, v221
    v_dot2_f32_bf16 v222, v141, v46, v222
    v_dot2_f32_bf16 v223, v141, v47, v223
    v_dot2_f32_bf16 v224, v142, v46, v224
    v_dot2_f32_bf16 v225, v142, v47, v225
    v_dot2_f32_bf16 v226, v143, v46, v226
    v_dot2_f32_bf16 v227, v143, v47, v227
    v_dot2_f32_bf16 v228, v172, v46, v228
    v_dot2_f32_bf16 v229, v172, v47, v229
    v_dot2_f32_bf16 v230, v173, v46, v230
    v_dot2_f32_bf16 v231, v173, v47, v231
    v_dot2_f32_bf16 v232, v174, v46, v232
    v_dot2_f32_bf16 v233, v174, v47, v233
    v_dot2_f32_bf16 v234, v175, v46, v234
    v_dot2_f32_bf16 v235, v175, v47, v235
    v_dot2_f32_bf16 v220, v144, v48, v220
    v_dot2_f32_bf16 v221, v144, v49, v221
    v_dot2_f32_bf16 v222, v145, v48, v222
    v_dot2_f32_bf16 v223, v145, v49, v223
    v_dot2_f32_bf16 v224, v146, v48, v224
    v_dot2_f32_bf16 v225, v146, v49, v225
    v_dot2_f32_bf16 v226, v147, v48, v226
    v_dot2_f32_bf16 v227, v147, v49, v227
    v_dot2_f32_bf16 v228, v176, v48, v228
    v_dot2_f32_bf16 v229, v176, v49, v229
    v_dot2_f32_bf16 v230, v177, v48, v230
    v_dot2_f32_bf16 v231, v177, v49, v231
    v_dot2_f32_bf16 v232, v178, v48, v232
    v_dot2_f32_bf16 v233, v178, v49, v233
    v_dot2_f32_bf16 v234, v179, v48, v234
    v_dot2_f32_bf16 v235, v179, v49, v235
    v_dot2_f32_bf16 v220, v148, v50, v220
    v_dot2_f32_bf16 v221, v148, v51, v221
    v_dot2_f32_bf16 v222, v149, v50, v222
    v_dot2_f32_bf16 v223, v149, v51, v223
    v_dot2_f32_bf16 v224, v150, v50, v224
    v_dot2_f32_bf16 v225, v150, v51, v225
    v_dot2_f32_bf16 v226, v151, v50, v226
    v_dot2_f32_bf16 v227, v151, v51, v227
    v_dot2_f32_bf16 v228, v180, v50, v228
    v_dot2_f32_bf16 v229, v180, v51, v229
    v_dot2_f32_bf16 v230, v181, v50, v230
    v_dot2_f32_bf16 v231, v181, v51, v231
    v_dot2_f32_bf16 v232, v182, v50, v232
    v_dot2_f32_bf16 v233, v182, v51, v233
    v_dot2_f32_bf16 v234, v183, v50, v234
    v_dot2_f32_bf16 v235, v183, v51, v235
    v_dot2_f32_bf16 v220, v152, v52, v220
    v_dot2_f32_bf16 v221, v152, v53, v221
    v_dot2_f32_bf16 v222, v153, v52, v222
    v_dot2_f32_bf16 v223, v153, v53, v223
    v_dot2_f32_bf16 v224, v154, v52, v224
    v_dot2_f32_bf16 v225, v154, v53, v225
    v_dot2_f32_bf16 v226, v155, v52, v226
    v_dot2_f32_bf16 v227, v155, v53, v227
    v_dot2_f32_bf16 v228, v184, v52, v228
    v_dot2_f32_bf16 v229, v184, v53, v229
    v_dot2_f32_bf16 v230, v185, v52, v230
    v_dot2_f32_bf16 v231, v185, v53, v231
    v_dot2_f32_bf16 v232, v186, v52, v232
    v_dot2_f32_bf16 v233, v186, v53, v233
    v_dot2_f32_bf16 v234, v187, v52, v234
    v_dot2_f32_bf16 v235, v187, v53, v235
    v_dot2_f32_bf16 v220, v156, v54, v220
    v_dot2_f32_bf16 v221, v156, v55, v221
    v_dot2_f32_bf16 v222, v157, v54, v222
    v_dot2_f32_bf16 v223, v157, v55, v223
    v_dot2_f32_bf16 v224, v158, v54, v224
    v_dot2_f32_bf16 v225, v158, v55, v225
    v_dot2_f32_bf16 v226, v159, v54, v226
    v_dot2_f32_bf16 v227, v159, v55, v227
    v_dot2_f32_bf16 v228, v188, v54, v228
    v_dot2_f32_bf16 v229, v188, v55, v229
    v_dot2_f32_bf16 v230, v189, v54, v230
    v_dot2_f32_bf16 v231, v189, v55, v231
    v_dot2_f32_bf16 v232, v190, v54, v232
    v_dot2_f32_bf16 v233, v190, v55, v233
    v_dot2_f32_bf16 v234, v191, v54, v234
    v_dot2_f32_bf16 v235, v191, v55, v235
    v_permlane32_swap_b32 v220, v228
    v_permlane32_swap_b32 v221, v229
    v_permlane32_swap_b32 v222, v230
    v_permlane32_swap_b32 v223, v231
    v_permlane32_swap_b32 v224, v232
    v_permlane32_swap_b32 v225, v233
    v_permlane32_swap_b32 v226, v234
    v_permlane32_swap_b32 v227, v235
    v_add_f32 v220, v220, v228
    v_add_f32 v221, v221, v229
    v_add_f32 v222, v222, v230
    v_add_f32 v223, v223, v231
    v_add_f32 v224, v224, v232
    v_add_f32 v225, v225, v233
    v_add_f32 v226, v226, v234
    v_add_f32 v227, v227, v235
    v_permlane16_swap_b32 v220, v224
    v_permlane16_swap_b32 v221, v225
    v_permlane16_swap_b32 v222, v226
    v_permlane16_swap_b32 v223, v227
    v_add_f32 v220, v220, v224
    v_add_f32 v221, v221, v225
    v_add_f32 v222, v222, v226
    v_add_f32 v223, v223, v227
    v_add_f32_dpp v220, v220, v220 row_ror:8 row_mask:0xf bank_mask:0xf
    v_add_f32_dpp v221, v221, v221 row_ror:8 row_mask:0xf bank_mask:0xf
    v_add_f32_dpp v222, v222, v222 row_ror:8 row_mask:0xf bank_mask:0xf
    v_add_f32_dpp v223, v223, v223 row_ror:8 row_mask:0xf bank_mask:0xf
    v_lshrrev_b32 v14, 5, v2
    v_lshlrev_b32 v14, 8, v14
    v_lshl_add_u32 v14, v6, 5, v14
    v_and_b32 v16, 16, v2
    v_add_u32 v14, v14, v16
    s_lshl_b32 s12, s21, 9
    s_add_u32 s12, s12, 159744
    v_add_u32 v14, s12, v14
    ds_write_b128 v14, v[220:223]
    v_mov_b32 v14, 162848
    v_mov_b32 v16, 1
    s_mov_b64 exec, 1
    ds_add_rtn_u32 v17, v14, v16
    s_mov_b64 exec, -1
    s_waitcnt lgkmcnt(0)
    v_readfirstlane_b32 s12, v17
    s_nop 1
    s_cmp_lg_u32 s12, 3
    s_cbranch_scc1 L_nogu
    s_cmp_ge_u32 s2, 224
    s_cbranch_scc1 L_nogu
    v_lshlrev_b32 v14, 2, v2
    v_add_u32 v14, 159744, v14
    ds_read2st64_b32 v[220:221], v14 offset0:0 offset1:1
    ds_read2st64_b32 v[222:223], v14 offset0:2 offset1:3
    ds_read2st64_b32 v[224:225], v14 offset0:4 offset1:5
    ds_read2st64_b32 v[226:227], v14 offset0:6 offset1:7
    s_and_b32 s12, s2, 3
    s_mul_i32 s12, s12, 28672
    s_lshr_b32 s13, s2, 2
    s_lshl_b32 s13, s13, 9
    s_add_u32 s12, s12, s13
    s_add_u32 s12, s12, 327680
    v_lshlrev_b32 v14, 3, v2
    v_and_b32 v16, 1, v2
    v_lshlrev_b32 v16, 4, v16
    v_lshrrev_b32 v16, v16, s23
    v_bfe_u32 v17, v16, 8, 8
    v_and_b32 v16, 0xff, v16
    s_mov_b32 s13, 0xffffff00
    s_waitcnt lgkmcnt(0)
    v_pk_add_f32 v[220:221], v[220:221], v[222:223]
    v_pk_add_f32 v[224:225], v[224:225], v[226:227]
    v_pk_add_f32 v[220:221], v[220:221], v[224:225]
    v_and_or_b32 v220, v220, s13, v16
    v_and_or_b32 v221, v221, s13, v17
    buffer_store_dwordx2 v[220:221], v14, s[32:35], s12 offen sc1
L_nogu:
    v_mov_b32 v62, v6
    v_mov_b32 v63, v35
    s_mov_b32 s86, s96
    s_mov_b32 s36, s15
    s_mov_b32 s37, s14
    s_mov_b32 s68, s58
    s_and_b32 s69, s59, 0xffff
    s_mov_b32 s70, 4194304
    s_mov_b32 s71, 0x00020000
    s_and_b32 s90, s20, 3
    s_lshr_b32 s91, s20, 2
    s_lshl_b32 s12, s88, 3
    s_lshl_b32 s13, s90, 1
    s_add_u32 s12, s12, s13
    s_add_u32 s92, s12, s91
    s_lshl_b32 s12, s92, 4
    v_and_b32 v3, 15, v2
    v_add_u32 v6, s12, v3
    v_lshlrev_b32 v8, 2, v6
    v_bfe_u32 v9, v2, 4, 1
    v_lshrrev_b32 v10, 5, v2
    v_lshlrev_b32 v7, 11, v6
    v_lshl_add_u32 v7, v9, 6, v7
    v_lshl_add_u32 v7, v10, 4, v7
    s_lshl_b32 s12, s89, 7
    v_add_u32 v7, s12, v7
    s_mov_b32 s12, 4096
    buffer_load_dwordx4 v[24:27], v7, s[24:27], 0 offen
    buffer_load_dwordx4 v[28:31], v7, s[24:27], 0 offen offset:32
    buffer_load_dword v48, v8, s[32:35], s12 offen sc1
    v_lshlrev_b32 v12, 8, v3
    v_lshl_add_u32 v12, v9, 7, v12
    v_lshl_add_u32 v12, v10, 5, v12
    v_lshlrev_b32 v10, 9, v10
    v_bfe_u32 v11, v2, 2, 2
    v_lshl_add_u32 v10, v11, 7, v10
    v_bfe_u32 v11, v2, 3, 1
    v_lshl_add_u32 v10, v11, 6, v10
    v_lshl_add_u32 v10, v9, 5, v10
    v_and_b32 v11, 3, v2
    v_lshl_add_u32 v10, v11, 3, v10
    v_xor_b32 v11, 64, v10
    s_lshl_b32 s12, s91, 8
    v_xor_b32 v17, s12, v5
    v_lshlrev_b32 v8, 2, v3
    s_lshl_b32 s12, s20, 12
    s_mov_b32 s15, 40960
    s_cmp_lt_u32 s20, 6
    s_cselect_b32 s13, s15, 131072
    s_add_u32 s12, s12, s13
    v_add_u32 v20, s12, v5
    s_xor_b32 s14, s20, 4
    s_lshl_b32 s12, s14, 12
    s_cmp_lt_u32 s14, 6
    s_cselect_b32 s13, s15, 131072
    s_add_u32 s12, s12, s13
    v_add_u32 v21, s12, v5
    s_lshl_b32 s12, s88, 2
    s_add_u32 s12, s12, s90
    s_lshl_b32 s13, s12, 16
    s_lshl_b32 s14, s91, 15
    s_add_u32 s13, s13, s14
    s_add_u32 s95, s13, 8388608
    s_lshl_b32 s12, s88, 12
    s_lshl_b32 s13, s89, 8
    s_mul_i32 s13, s13, 1
    s_add_u32 s12, s12, s13
    s_lshr_b32 s13, s90, 1
    s_lshl_b32 s13, s13, 7
    s_add_u32 s12, s12, s13
    s_lshl_b32 s13, s91, 6
    s_add_u32 s12, s12, s13
    s_add_u32 s15, s12, 524288
    s_lshl_b32 s97, s91, 4
    s_mov_b32 s93, s89
    s_waitcnt vmcnt(0)
    v_sub_f32 v50, 1.0, v48
    v_cvt_pk_bf16_f32 v50, v50, v50
    v_lshlrev_b32 v50, 16, v50
    v_lshlrev_b32 v32, 16, v24
    v_and_b32 v33, 0xffff0000, v24
    v_lshlrev_b32 v34, 16, v25
    v_and_b32 v35, 0xffff0000, v25
    v_lshlrev_b32 v36, 16, v26
    v_and_b32 v37, 0xffff0000, v26
    v_lshlrev_b32 v38, 16, v27
    v_and_b32 v39, 0xffff0000, v27
    v_lshlrev_b32 v40, 16, v28
    v_and_b32 v41, 0xffff0000, v28
    v_lshlrev_b32 v42, 16, v29
    v_and_b32 v43, 0xffff0000, v29
    v_lshlrev_b32 v44, 16, v30
    v_and_b32 v45, 0xffff0000, v30
    v_lshlrev_b32 v46, 16, v31
    v_and_b32 v47, 0xffff0000, v31
    v_pk_mul_f32 v[32:33], v[32:33], v[50:51] op_sel_hi:[1,0]
    v_pk_mul_f32 v[34:35], v[34:35], v[50:51] op_sel_hi:[1,0]
    v_pk_mul_f32 v[36:37], v[36:37], v[50:51] op_sel_hi:[1,0]
    v_pk_mul_f32 v[38:39], v[38:39], v[50:51] op_sel_hi:[1,0]
    v_pk_mul_f32 v[40:41], v[40:41], v[50:51] op_sel_hi:[1,0]
    v_pk_mul_f32 v[42:43], v[42:43], v[50:51] op_sel_hi:[1,0]
    v_pk_mul_f32 v[44:45], v[44:45], v[50:51] op_sel_hi:[1,0]
    v_pk_mul_f32 v[46:47], v[46:47], v[50:51] op_sel_hi:[1,0]
    v_cvt_pk_bf16_f32 v33, v32, v33
    v_cvt_pk_bf16_f32 v35, v34, v35
    v_cvt_pk_bf16_f32 v37, v36, v37
    v_cvt_pk_bf16_f32 v39, v38, v39
    v_cvt_pk_bf16_f32 v41, v40, v41
    v_cvt_pk_bf16_f32 v43, v42, v43
    v_cvt_pk_bf16_f32 v45, v44, v45
    v_cvt_pk_bf16_f32 v47, v46, v47
    v_lshlrev_b32 v32, 16, v33
    v_and_b32 v33, 0xffff0000, v33
    v_lshlrev_b32 v34, 16, v35
    v_and_b32 v35, 0xffff0000, v35
    v_lshlrev_b32 v36, 16, v37
    v_and_b32 v37, 0xffff0000, v37
    v_lshlrev_b32 v38, 16, v39
    v_and_b32 v39, 0xffff0000, v39
    v_lshlrev_b32 v40, 16, v41
    v_and_b32 v41, 0xffff0000, v41
    v_lshlrev_b32 v42, 16, v43
    v_and_b32 v43, 0xffff0000, v43
    v_lshlrev_b32 v44, 16, v45
    v_and_b32 v45, 0xffff0000, v45
    v_lshlrev_b32 v46, 16, v47
    v_and_b32 v47, 0xffff0000, v47
    s_cmp_lg_u32 s21, 0
    s_cbranch_scc1 L_nohop
    s_lshl_b32 s12, s19, 18
    s_lshl_b32 s13, s18, 14
    s_add_u32 s12, s12, s13
    s_add_u32 s80, s12, 1048576
    s_add_u32 s81, s80, 4096
    s_add_u32 s82, s80, 8192
    s_add_u32 s83, s80, 12288
    s_lshl_b32 s12, s19, 13
    s_lshl_b32 s13, s18, 9
    s_add_u32 s12, s12, s13
    s_add_u32 s84, s12, 5242880
    v_and_b32 v80, 15, v2
    v_lshlrev_b32 v80, 5, v80
    v_lshrrev_b32 v78, 5, v2
    v_lshl_add_u32 v80, v78, 4, v80
    s_mov_b32 s13, 0
L_h1z:
    buffer_load_dwordx4 v[104:107], v80, s[32:35], s84 offen sc1
    s_add_u32 s13, s13, 1
    s_cmp_ge_u32 s13, 16384
    s_cbranch_scc1 L_h1y
    s_waitcnt vmcnt(0)
    v_msad_u8 v108, v104, s76, 0
    v_msad_u8 v108, v105, s77, v108
    v_msad_u8 v108, v106, s78, v108
    v_msad_u8 v108, v107, s79, v108
    v_cmp_ne_u32 vcc, 0, v108
    s_nop 1
    s_or_b32 s12, vcc_lo, vcc_hi
    s_and_b32 s12, s12, 0xffff
    s_bcnt1_i32_b32 s12, s12
    s_cmp_gt_u32 s12, 6
    s_cbranch_scc1 L_h1z
L_h1y:
L_h1a:
    s_mov_b32 s85, 0xffff
L_h1:
    buffer_load_dwordx4 v[104:107], v80, s[32:35], s84 offen sc1
    s_bitcmp1_b32 s85, 0
    s_cselect_b64 exec, -1, 0
    buffer_load_dwordx4 v[128:131], v5, s[32:35], s80 offen offset:0 sc1
    s_bitcmp1_b32 s85, 1
    s_cselect_b64 exec, -1, 0
    buffer_load_dwordx4 v[132:135], v5, s[32:35], s80 offen offset:1024 sc1
    s_bitcmp1_b32 s85, 2
    s_cselect_b64 exec, -1, 0
    buffer_load_dwordx4 v[136:139], v5, s[32:35], s80 offen offset:2048 sc1
    s_bitcmp1_b32 s85, 3
    s_cselect_b64 exec, -1, 0
    buffer_load_dwordx4 v[140:143], v5, s[32:35], s80 offen offset:3072 sc1
    s_bitcmp1_b32 s85, 4
    s_cselect_b64 exec, -1, 0
    buffer_load_dwordx4 v[144:147], v5, s[32:35], s81 offen offset:0 sc1
    s_bitcmp1_b32 s85, 5
    s_cselect_b64 exec, -1, 0
    buffer_load_dwordx4 v[148:151], v5, s[32:35], s81 offen offset:1024 sc1
    s_bitcmp1_b32 s85, 6
    s_cselect_b64 exec, -1, 0
    buffer_load_dwordx4 v[152:155], v5, s[32:35], s81 offen offset:2048 sc1
    s_bitcmp1_b32 s85, 7
    s_cselect_b64 exec, -1, 0
    buffer_load_dwordx4 v[156:159], v5, s[32:35], s81 offen offset:3072 sc1
    s_bitcmp1_b32 s85, 8
    s_cselect_b64 exec, -1, 0
    buffer_load_dwordx4 v[160:163], v5, s[32:35], s82 offen offset:0 sc1
    s_bitcmp1_b32 s85, 9
    s_cselect_b64 exec, -1, 0
    buffer_load_dwordx4 v[164:167], v5, s[32:35], s82 offen offset:1024 sc1
    s_bitcmp1_b32 s85, 10
    s_cselect_b64 exec, -1, 0
    buffer_load_dwordx4 v[168:171], v5, s[32:35], s82 offen offset:2048 sc1
    s_bitcmp1_b32 s85, 11
    s_cselect_b64 exec, -1, 0
    buffer_load_dwordx4 v[172:175], v5, s[32:35], s82 offen offset:3072 sc1
    s_bitcmp1_b32 s85, 12
    s_cselect_b64 exec, -1, 0
    buffer_load_dwordx4 v[176:179], v5, s[32:35], s83 offen offset:0 sc1
    s_bitcmp1_b32 s85, 13
    s_cselect_b64 exec, -1, 0
    buffer_load_dwordx4 v[180:183], v5, s[32:35], s83 offen offset:1024 sc1
    s_bitcmp1_b32 s85, 14
    s_cselect_b64 exec, -1, 0
    buffer_load_dwordx4 v[184:187], v5, s[32:35], s83 offen offset:2048 sc1
    s_bitcmp1_b32 s85, 15
    s_cselect_b64 exec, -1, 0
    buffer_load_dwordx4 v[188:191], v5, s[32:35], s83 offen offset:3072 sc1
    s_mov_b64 exec, -1
    s_add_u32 s13, s13, 1
    s_cmp_ge_u32 s13, 16384
    s_cbranch_scc1 L_h1ok
    s_waitcnt vmcnt(16)
    v_msad_u8 v108, v104, s76, 0
    v_msad_u8 v108, v105, s77, v108
    v_msad_u8 v108, v106, s78, v108
    v_msad_u8 v108, v107, s79, v108
    v_cmp_ne_u32 vcc, 0, v108
    s_nop 1
    s_or_b32 s85, vcc_lo, vcc_hi
    s_and_b32 s85, s85, 0xffff
    s_waitcnt vmcnt(0)
    s_cbranch_scc1 L_h1
    v_msad_u8 v108, v128, v63, 0
    v_msad_u8 v109, v132, v63, 0
    v_msad_u8 v108, v136, v63, v108
    v_msad_u8 v109, v140, v63, v109
    v_msad_u8 v108, v144, v63, v108
    v_msad_u8 v109, v148, v63, v109
    v_msad_u8 v108, v152, v63, v108
    v_msad_u8 v109, v156, v63, v109
    v_msad_u8 v108, v160, v63, v108
    v_msad_u8 v109, v164, v63, v109
    v_msad_u8 v108, v168, v63, v108
    v_msad_u8 v109, v172, v63, v109
    v_msad_u8 v108, v176, v63, v108
    v_msad_u8 v109, v180, v63, v109
    v_msad_u8 v108, v184, v63, v108
    v_msad_u8 v109, v188, v63, v109
    v_or_b32 v108, v108, v109
    v_cmp_ne_u32 vcc, 0, v108
    s_cbranch_vccnz L_h1a
L_h1ok:
    s_waitcnt vmcnt(0)
    v_pk_add_f32 v[128:129], v[128:129], v[160:161]
    v_pk_add_f32 v[130:131], v[130:131], v[162:163]
    v_pk_add_f32 v[132:133], v[132:133], v[164:165]
    v_pk_add_f32 v[134:135], v[134:135], v[166:167]
    v_pk_add_f32 v[136:137], v[136:137], v[168:169]
    v_pk_add_f32 v[138:139], v[138:139], v[170:171]
    v_pk_add_f32 v[140:141], v[140:141], v[172:173]
    v_pk_add_f32 v[142:143], v[142:143], v[174:175]
    v_pk_add_f32 v[144:145], v[144:145], v[176:177]
    v_pk_add_f32 v[146:147], v[146:147], v[178:179]
    v_pk_add_f32 v[148:149], v[148:149], v[180:181]
    v_pk_add_f32 v[150:151], v[150:151], v[182:183]
    v_pk_add_f32 v[152:153], v[152:153], v[184:185]
    v_pk_add_f32 v[154:155], v[154:155], v[186:187]
    v_pk_add_f32 v[156:157], v[156:157], v[188:189]
    v_pk_add_f32 v[158:159], v[158:159], v[190:191]
    v_pk_add_f32 v[128:129], v[128:129], v[144:145]
    v_pk_add_f32 v[130:131], v[130:131], v[146:147]
    v_pk_add_f32 v[132:133], v[132:133], v[148:149]
    v_pk_add_f32 v[134:135], v[134:135], v[150:151]
    v_pk_add_f32 v[136:137], v[136:137], v[152:153]
    v_pk_add_f32 v[138:139], v[138:139], v[154:155]
    v_pk_add_f32 v[140:141], v[140:141], v[156:157]
    v_pk_add_f32 v[142:143], v[142:143], v[158:159]
    v_pk_add_f32 v[128:129], v[128:129], v[136:137]
    v_pk_add_f32 v[130:131], v[130:131], v[138:139]
    v_pk_add_f32 v[132:133], v[132:133], v[140:141]
    v_pk_add_f32 v[134:135], v[134:135], v[142:143]
    v_pk_add_f32 v[128:129], v[128:129], v[132:133]
    v_pk_add_f32 v[130:131], v[130:131], v[134:135]
    v_add_f32_dpp v104, v104, v104 row_ror:1 row_mask:0xf bank_mask:0xf
    v_add_f32_dpp v105, v105, v105 row_ror:1 row_mask:0xf bank_mask:0xf
    v_add_f32_dpp v106, v106, v106 row_ror:1 row_mask:0xf bank_mask:0xf
    v_add_f32_dpp v107, v107, v107 row_ror:1 row_mask:0xf bank_mask:0xf
    v_add_f32_dpp v104, v104, v104 row_ror:2 row_mask:0xf bank_mask:0xf
    v_add_f32_dpp v105, v105, v105 row_ror:2 row_mask:0xf bank_mask:0xf
    v_add_f32_dpp v106, v106, v106 row_ror:2 row_mask:0xf bank_mask:0xf
    v_add_f32_dpp v107, v107, v107 row_ror:2 row_mask:0xf bank_mask:0xf
    v_add_f32_dpp v104, v104, v104 row_ror:4 row_mask:0xf bank_mask:0xf
    v_add_f32_dpp v105, v105, v105 row_ror:4 row_mask:0xf bank_mask:0xf
    v_add_f32_dpp v106, v106, v106 row_ror:4 row_mask:0xf bank_mask:0xf
    v_add_f32_dpp v107, v107, v107 row_ror:4 row_mask:0xf bank_mask:0xf
    v_add_f32_dpp v104, v104, v104 row_ror:8 row_mask:0xf bank_mask:0xf
    v_add_f32_dpp v105, v105, v105 row_ror:8 row_mask:0xf bank_mask:0xf
    v_add_f32_dpp v106, v106, v106 row_ror:8 row_mask:0xf bank_mask:0xf
    v_add_f32_dpp v107, v107, v107 row_ror:8 row_mask:0xf bank_mask:0xf
    v_cvt_pk_bf16_f32 v108, v128, v129
    v_cvt_pk_bf16_f32 v109, v130, v131
    v_cvt_pk_bf16_f32 v112, v104, v105
    v_cvt_pk_bf16_f32 v113, v106, v107
    v_mov_b32 v110, v108
    v_mov_b32 v111, v109
    v_mov_b32 v114, v112
    v_mov_b32 v115, v113
    s_lshl_b32 s12, s19, 13
    s_lshl_b32 s13, s18, 9
    s_add_u32 s12, s12, s13
    s_add_u32 s12, s12, 32768
    s_lshl_b32 s13, s19, 8
    s_lshl_b32 s80, s18, 4
    s_add_u32 s13, s13, s80
    s_add_u32 s13, s13, 163840
    v_permlane32_swap_b32 v108, v110
    v_permlane32_swap_b32 v109, v111
    v_permlane32_swap_b32 v112, v114
    v_permlane32_swap_b32 v113, v115
    s_mov_b32 exec_hi, 0
    buffer_store_dwordx4 v[108:111], v5, s[32:35], s12 offen sc1
    s_mov_b32 exec_lo, 1
    buffer_store_dwordx4 v[112:115], v13, s[32:35], s13 offen sc1
    s_mov_b64 exec, -1
L_nohop:
    v_min_u32 v80, 6, v62
    v_lshl_add_u32 v80, v80, 3, v4
    v_lshlrev_b32 v80, 3, v80
    s_lshl_b32 s12, s86, 3
    s_add_u32 s80, s12, 327680
    s_add_u32 s81, s80, 28672
    s_add_u32 s82, s80, 57344
    s_add_u32 s83, s80, 86016
    v_and_b32 v78, 1, v4
    v_lshlrev_b32 v78, 4, v78
    v_lshrrev_b32 v78, v78, s23
    v_bfe_u32 v79, v78, 8, 8
    v_and_b32 v78, 0xff, v78
    s_mov_b32 s13, 0
L_gu:
    buffer_load_dwordx2 v[104:105], v80, s[32:35], s80 offen sc1
    buffer_load_dwordx2 v[106:107], v80, s[32:35], s81 offen sc1
    buffer_load_dwordx2 v[108:109], v80, s[32:35], s82 offen sc1
    buffer_load_dwordx2 v[110:111], v80, s[32:35], s83 offen sc1
    s_add_u32 s13, s13, 1
    s_cmp_lg_u32 s21, 0
    s_cbranch_scc1 L_nofl
    s_waitcnt vmcnt(4)
    v_mov_b32 v112, 162896
    v_mov_b32 v113, 1
    s_mov_b64 exec, 1
    ds_write_b32 v112, v113
    s_mov_b64 exec, -1
L_nofl:
    s_waitcnt vmcnt(0)
    v_msad_u8 v112, v104, v78, 0
    v_msad_u8 v112, v105, v79, v112
    v_msad_u8 v112, v106, v78, v112
    v_msad_u8 v112, v107, v79, v112
    v_msad_u8 v112, v108, v78, v112
    v_msad_u8 v112, v109, v79, v112
    v_msad_u8 v112, v110, v78, v112
    v_msad_u8 v112, v111, v79, v112
    v_cmp_ne_u32 vcc, 0, v112
    s_cbranch_vccz L_guok
    s_cmp_lt_u32 s13, 16384
    s_cbranch_scc1 L_gu
L_guok:
    v_pk_add_f32 v[104:105], v[104:105], v[106:107]
    v_pk_add_f32 v[108:109], v[108:109], v[110:111]
    v_pk_add_f32 v[104:105], v[104:105], v[108:109]
    v_cvt_pk_bf16_f32 v104, v104, v105
    v_and_b32 v105, 0xffff0000, v104
    v_lshlrev_b32 v104, 16, v104
    v_mul_f32 v106, 0xbfb8aa3b, v104
    v_exp_f32 v106, v106
    s_nop 0
    v_add_f32 v106, 1.0, v106
    v_rcp_f32 v106, v106
    s_nop 0
    v_mul_f32 v106, v106, v104
    v_cvt_pk_bf16_f32 v106, v106, v106
    v_lshlrev_b32 v106, 16, v106
    v_mul_f32 v106, v106, v105
    v_cvt_pk_bf16_f32 v106, v106, v106
    ds_swizzle_b32 v64, v106 offset:0x18
    ds_swizzle_b32 v66, v106 offset:0x38
    ds_swizzle_b32 v68, v106 offset:0x58
    ds_swizzle_b32 v70, v106 offset:0x78
    ds_swizzle_b32 v72, v106 offset:0x98
    ds_swizzle_b32 v74, v106 offset:0xb8
    ds_swizzle_b32 v76, v106 offset:0xd8
    s_waitcnt lgkmcnt(0)
    v_and_b32 v65, 0xffff0000, v64
    v_and_b32 v64, 0xffff, v64
    v_and_b32 v67, 0xffff0000, v66
    v_and_b32 v66, 0xffff, v66
    v_and_b32 v69, 0xffff0000, v68
    v_and_b32 v68, 0xffff, v68
    v_and_b32 v71, 0xffff0000, v70
    v_and_b32 v70, 0xffff, v70
    v_and_b32 v73, 0xffff0000, v72
    v_and_b32 v72, 0xffff, v72
    v_and_b32 v75, 0xffff0000, v74
    v_and_b32 v74, 0xffff, v74
    v_and_b32 v77, 0xffff0000, v76
    v_and_b32 v76, 0xffff, v76
    v_dot2_f32_bf16 v220, v192, v64, 0
    v_dot2_f32_bf16 v221, v192, v65, 0
    v_dot2_f32_bf16 v222, v193, v64, 0
    v_dot2_f32_bf16 v223, v193, v65, 0
    v_dot2_f32_bf16 v224, v194, v64, 0
    v_dot2_f32_bf16 v225, v194, v65, 0
    v_dot2_f32_bf16 v226, v195, v64, 0
    v_dot2_f32_bf16 v227, v195, v65, 0
    v_dot2_f32_bf16 v220, v196, v66, v220
    v_dot2_f32_bf16 v221, v196, v67, v221
    v_dot2_f32_bf16 v222, v197, v66, v222
    v_dot2_f32_bf16 v223, v197, v67, v223
    v_dot2_f32_bf16 v224, v198, v66, v224
    v_dot2_f32_bf16 v225, v198, v67, v225
    v_dot2_f32_bf16 v226, v199, v66, v226
    v_dot2_f32_bf16 v227, v199, v67, v227
    v_dot2_f32_bf16 v220, v200, v68, v220
    v_dot2_f32_bf16 v221, v200, v69, v221
    v_dot2_f32_bf16 v222, v201, v68, v222
    v_dot2_f32_bf16 v223, v201, v69, v223
    v_dot2_f32_bf16 v224, v202, v68, v224
    v_dot2_f32_bf16 v225, v202, v69, v225
    v_dot2_f32_bf16 v226, v203, v68, v226
    v_dot2_f32_bf16 v227, v203, v69, v227
    v_dot2_f32_bf16 v220, v204, v70, v220
    v_dot2_f32_bf16 v221, v204, v71, v221
    v_dot2_f32_bf16 v222, v205, v70, v222
    v_dot2_f32_bf16 v223, v205, v71, v223
    v_dot2_f32_bf16 v224, v206, v70, v224
    v_dot2_f32_bf16 v225, v206, v71, v225
    v_dot2_f32_bf16 v226, v207, v70, v226
    v_dot2_f32_bf16 v227, v207, v71, v227
    v_dot2_f32_bf16 v220, v208, v72, v220
    v_dot2_f32_bf16 v221, v208, v73, v221
    v_dot2_f32_bf16 v222, v209, v72, v222
    v_dot2_f32_bf16 v223, v209, v73, v223
    v_dot2_f32_bf16 v224, v210, v72, v224
    v_dot2_f32_bf16 v225, v210, v73, v225
    v_dot2_f32_bf16 v226, v211, v72, v226
    v_dot2_f32_bf16 v227, v211, v73, v227
    v_dot2_f32_bf16 v220, v212, v74, v220
    v_dot2_f32_bf16 v221, v212, v75, v221
    v_dot2_f32_bf16 v222, v213, v74, v222
    v_dot2_f32_bf16 v223, v213, v75, v223
    v_dot2_f32_bf16 v224, v214, v74, v224
    v_dot2_f32_bf16 v225, v214, v75, v225
    v_dot2_f32_bf16 v226, v215, v74, v226
    v_dot2_f32_bf16 v227, v215, v75, v227
    v_dot2_f32_bf16 v220, v216, v76, v220
    v_dot2_f32_bf16 v221, v216, v77, v221
    v_dot2_f32_bf16 v222, v217, v76, v222
    v_dot2_f32_bf16 v223, v217, v77, v223
    v_dot2_f32_bf16 v224, v218, v76, v224
    v_dot2_f32_bf16 v225, v218, v77, v225
    v_dot2_f32_bf16 v226, v219, v76, v226
    v_dot2_f32_bf16 v227, v219, v77, v227
    v_permlane32_swap_b32 v220, v224
    v_permlane32_swap_b32 v221, v225
    v_permlane32_swap_b32 v222, v226
    v_permlane32_swap_b32 v223, v227
    v_add_f32 v220, v220, v224
    v_add_f32 v221, v221, v225
    v_add_f32 v222, v222, v226
    v_add_f32 v223, v223, v227
    s_nop 0
    v_permlane16_swap_b32 v220, v222
    v_permlane16_swap_b32 v221, v223
    v_add_f32 v220, v220, v222
    v_add_f32 v221, v221, v223
    s_nop 0
    v_add_f32_dpp v220, v220, v220 row_ror:8 row_mask:0xf bank_mask:0xf
    v_add_f32_dpp v221, v221, v221 row_ror:8 row_mask:0xf bank_mask:0xf
    v_lshrrev_b32 v80, 4, v2
    v_lshlrev_b32 v80, 3, v80
    v_lshl_add_u32 v80, v62, 5, v80
    s_lshl_b32 s12, s21, 8
    s_add_u32 s12, s12, 161792
    v_add_u32 v80, s12, v80
    ds_write_b64 v80, v[220:221]
    v_mov_b32 v80, 162848
    v_mov_b32 v78, 1
    s_mov_b64 exec, 1
    ds_add_rtn_u32 v79, v80, v78 offset:4
    s_mov_b64 exec, -1
    s_waitcnt lgkmcnt(0)
    v_readfirstlane_b32 s12, v79
    s_nop 1
    s_cmp_lg_u32 s12, 3
    s_cbranch_scc1 L_noy
    v_lshlrev_b32 v78, 2, v2
    v_add_u32 v80, 161792, v78
    ds_read2st64_b32 v[220:221], v80 offset0:0 offset1:1
    ds_read2st64_b32 v[222:223], v80 offset0:2 offset1:3
    s_lshr_b32 s12, s2, 4
    s_lshl_b32 s12, s12, 4
    s_and_b32 s13, s2, 15
    s_add_u32 s12, s12, s13
    s_lshl_b32 s12, s12, 8
    s_add_u32 s12, s12, 458752
    s_mov_b32 s13, 0xffffff00
    s_waitcnt lgkmcnt(0)
    v_pk_add_f32 v[220:221], v[220:221], v[222:223]
    v_add_f32 v220, v220, v221
    v_and_or_b32 v220, v220, s13, v63
    buffer_store_dword v220, v78, s[32:35], s12 offen sc1
L_noy:
    s_mov_b32 s21, s36
    s_mov_b32 s22, s37
    s_lshr_b32 s12, s21, 4
    s_cmp_lg_u32 s12, s92
    s_cbranch_scc1 L_b_noownl
    s_lshl_b32 s12, s89, 12
    s_add_u32 s12, s12, 458752
    buffer_load_dwordx4 v[224:227], v12, s[32:35], s12 offen offset:0 sc1
    buffer_load_dwordx4 v[228:231], v12, s[32:35], s12 offen offset:16 sc1
    buffer_load_dwordx4 v[232:235], v12, s[32:35], s12 offen offset:64 sc1
    buffer_load_dwordx4 v[236:239], v12, s[32:35], s12 offen offset:80 sc1
    s_mov_b32 s13, 0
L_b_yl:
    s_waitcnt vmcnt(0)
    v_msad_u8 v240, v224, s76, 0
    v_msad_u8 v240, v225, s77, v240
    v_msad_u8 v240, v226, s78, v240
    v_msad_u8 v240, v227, s79, v240
    v_msad_u8 v240, v228, s76, v240
    v_msad_u8 v240, v229, s77, v240
    v_msad_u8 v240, v230, s78, v240
    v_msad_u8 v240, v231, s79, v240
    v_msad_u8 v240, v232, s76, v240
    v_msad_u8 v240, v233, s77, v240
    v_msad_u8 v240, v234, s78, v240
    v_msad_u8 v240, v235, s79, v240
    v_msad_u8 v240, v236, s76, v240
    v_msad_u8 v240, v237, s77, v240
    v_msad_u8 v240, v238, s78, v240
    v_msad_u8 v240, v239, s79, v240
    v_cmp_ne_u32 vcc, 0, v240
    s_cbranch_vccz L_b_yokl
    buffer_load_dwordx4 v[224:227], v12, s[32:35], s12 offen offset:0 sc1
    buffer_load_dwordx4 v[228:231], v12, s[32:35], s12 offen offset:16 sc1
    buffer_load_dwordx4 v[232:235], v12, s[32:35], s12 offen offset:64 sc1
    buffer_load_dwordx4 v[236:239], v12, s[32:35], s12 offen offset:80 sc1
    s_add_u32 s13, s13, 1
    s_cmp_lt_u32 s13, 16384
    s_cbranch_scc1 L_b_yl
    s_waitcnt vmcnt(0)
L_b_yokl:
    v_add_f32_dpp v224, v224, v224 row_ror:1 row_mask:0xf bank_mask:0xf
    v_add_f32_dpp v225, v225, v225 row_ror:1 row_mask:0xf bank_mask:0xf
    v_add_f32_dpp v226, v226, v226 row_ror:1 row_mask:0xf bank_mask:0xf
    v_add_f32_dpp v227, v227, v227 row_ror:1 row_mask:0xf bank_mask:0xf
    v_add_f32_dpp v228, v228, v228 row_ror:1 row_mask:0xf bank_mask:0xf
    v_add_f32_dpp v229, v229, v229 row_ror:1 row_mask:0xf bank_mask:0xf
    v_add_f32_dpp v230, v230, v230 row_ror:1 row_mask:0xf bank_mask:0xf
    v_add_f32_dpp v231, v231, v231 row_ror:1 row_mask:0xf bank_mask:0xf
    v_add_f32_dpp v232, v232, v232 row_ror:1 row_mask:0xf bank_mask:0xf
    v_add_f32_dpp v233, v233, v233 row_ror:1 row_mask:0xf bank_mask:0xf
    v_add_f32_dpp v234, v234, v234 row_ror:1 row_mask:0xf bank_mask:0xf
    v_add_f32_dpp v235, v235, v235 row_ror:1 row_mask:0xf bank_mask:0xf
    v_add_f32_dpp v236, v236, v236 row_ror:1 row_mask:0xf bank_mask:0xf
    v_add_f32_dpp v237, v237, v237 row_ror:1 row_mask:0xf bank_mask:0xf
    v_add_f32_dpp v238, v238, v238 row_ror:1 row_mask:0xf bank_mask:0xf
    v_add_f32_dpp v239, v239, v239 row_ror:1 row_mask:0xf bank_mask:0xf
    v_add_f32_dpp v224, v224, v224 row_ror:2 row_mask:0xf bank_mask:0xf
    v_add_f32_dpp v225, v225, v225 row_ror:2 row_mask:0xf bank_mask:0xf
    v_add_f32_dpp v226, v226, v226 row_ror:2 row_mask:0xf bank_mask:0xf
    v_add_f32_dpp v227, v227, v227 row_ror:2 row_mask:0xf bank_mask:0xf
    v_add_f32_dpp v228, v228, v228 row_ror:2 row_mask:0xf bank_mask:0xf
    v_add_f32_dpp v229, v229, v229 row_ror:2 row_mask:0xf bank_mask:0xf
    v_add_f32_dpp v230, v230, v230 row_ror:2 row_mask:0xf bank_mask:0xf
    v_add_f32_dpp v231, v231, v231 row_ror:2 row_mask:0xf bank_mask:0xf
    v_add_f32_dpp v232, v232, v232 row_ror:2 row_mask:0xf bank_mask:0xf
    v_add_f32_dpp v233, v233, v233 row_ror:2 row_mask:0xf bank_mask:0xf
    v_add_f32_dpp v234, v234, v234 row_ror:2 row_mask:0xf bank_mask:0xf
    v_add_f32_dpp v235, v235, v235 row_ror:2 row_mask:0xf bank_mask:0xf
    v_add_f32_dpp v236, v236, v236 row_ror:2 row_mask:0xf bank_mask:0xf
    v_add_f32_dpp v237, v237, v237 row_ror:2 row_mask:0xf bank_mask:0xf
    v_add_f32_dpp v238, v238, v238 row_ror:2 row_mask:0xf bank_mask:0xf
    v_add_f32_dpp v239, v239, v239 row_ror:2 row_mask:0xf bank_mask:0xf
    v_add_f32_dpp v224, v224, v224 row_ror:4 row_mask:0xf bank_mask:0xf
    v_add_f32_dpp v225, v225, v225 row_ror:4 row_mask:0xf bank_mask:0xf
    v_add_f32_dpp v226, v226, v226 row_ror:4 row_mask:0xf bank_mask:0xf
    v_add_f32_dpp v227, v227, v227 row_ror:4 row_mask:0xf bank_mask:0xf
    v_add_f32_dpp v228, v228, v228 row_ror:4 row_mask:0xf bank_mask:0xf
    v_add_f32_dpp v229, v229, v229 row_ror:4 row_mask:0xf bank_mask:0xf
    v_add_f32_dpp v230, v230, v230 row_ror:4 row_mask:0xf bank_mask:0xf
    v_add_f32_dpp v231, v231, v231 row_ror:4 row_mask:0xf bank_mask:0xf
    v_add_f32_dpp v232, v232, v232 row_ror:4 row_mask:0xf bank_mask:0xf
    v_add_f32_dpp v233, v233, v233 row_ror:4 row_mask:0xf bank_mask:0xf
    v_add_f32_dpp v234, v234, v234 row_ror:4 row_mask:0xf bank_mask:0xf
    v_add_f32_dpp v235, v235, v235 row_ror:4 row_mask:0xf bank_mask:0xf
    v_add_f32_dpp v236, v236, v236 row_ror:4 row_mask:0xf bank_mask:0xf
    v_add_f32_dpp v237, v237, v237 row_ror:4 row_mask:0xf bank_mask:0xf
    v_add_f32_dpp v238, v238, v238 row_ror:4 row_mask:0xf bank_mask:0xf
    v_add_f32_dpp v239, v239, v239 row_ror:4 row_mask:0xf bank_mask:0xf
    v_add_f32_dpp v224, v224, v224 row_ror:8 row_mask:0xf bank_mask:0xf
    v_add_f32_dpp v225, v225, v225 row_ror:8 row_mask:0xf bank_mask:0xf
    v_add_f32_dpp v226, v226, v226 row_ror:8 row_mask:0xf bank_mask:0xf
    v_add_f32_dpp v227, v227, v227 row_ror:8 row_mask:0xf bank_mask:0xf
    v_add_f32_dpp v228, v228, v228 row_ror:8 row_mask:0xf bank_mask:0xf
    v_add_f32_dpp v229, v229, v229 row_ror:8 row_mask:0xf bank_mask:0xf
    v_add_f32_dpp v230, v230, v230 row_ror:8 row_mask:0xf bank_mask:0xf
    v_add_f32_dpp v231, v231, v231 row_ror:8 row_mask:0xf bank_mask:0xf
    v_add_f32_dpp v232, v232, v232 row_ror:8 row_mask:0xf bank_mask:0xf
    v_add_f32_dpp v233, v233, v233 row_ror:8 row_mask:0xf bank_mask:0xf
    v_add_f32_dpp v234, v234, v234 row_ror:8 row_mask:0xf bank_mask:0xf
    v_add_f32_dpp v235, v235, v235 row_ror:8 row_mask:0xf bank_mask:0xf
    v_add_f32_dpp v236, v236, v236 row_ror:8 row_mask:0xf bank_mask:0xf
    v_add_f32_dpp v237, v237, v237 row_ror:8 row_mask:0xf bank_mask:0xf
    v_add_f32_dpp v238, v238, v238 row_ror:8 row_mask:0xf bank_mask:0xf
    v_add_f32_dpp v239, v239, v239 row_ror:8 row_mask:0xf bank_mask:0xf
    v_cvt_pk_bf16_f32 v240, v224, v225
    v_cvt_pk_bf16_f32 v241, v226, v227
    v_cvt_pk_bf16_f32 v242, v228, v229
    v_cvt_pk_bf16_f32 v243, v230, v231
    v_cvt_pk_bf16_f32 v244, v232, v233
    v_cvt_pk_bf16_f32 v245, v234, v235
    v_cvt_pk_bf16_f32 v246, v236, v237
    v_cvt_pk_bf16_f32 v247, v238, v239
    v_lshlrev_b32 v224, 16, v240
    v_and_b32 v225, 0xffff0000, v240
    v_lshlrev_b32 v226, 16, v241
    v_and_b32 v227, 0xffff0000, v241
    v_lshlrev_b32 v228, 16, v242
    v_and_b32 v229, 0xffff0000, v242
    v_lshlrev_b32 v230, 16, v243
    v_and_b32 v231, 0xffff0000, v243
    v_lshlrev_b32 v232, 16, v244
    v_and_b32 v233, 0xffff0000, v244
    v_lshlrev_b32 v234, 16, v245
    v_and_b32 v235, 0xffff0000, v245
    v_lshlrev_b32 v236, 16, v246
    v_and_b32 v237, 0xffff0000, v246
    v_lshlrev_b32 v238, 16, v247
    v_and_b32 v239, 0xffff0000, v247
    v_mul_f32 v224, s22, v224
    v_mul_f32 v225, s22, v225
    v_mul_f32 v226, s22, v226
    v_mul_f32 v227, s22, v227
    v_mul_f32 v228, s22, v228
    v_mul_f32 v229, s22, v229
    v_mul_f32 v230, s22, v230
    v_mul_f32 v231, s22, v231
    v_mul_f32 v232, s22, v232
    v_mul_f32 v233, s22, v233
    v_mul_f32 v234, s22, v234
    v_mul_f32 v235, s22, v235
    v_mul_f32 v236, s22, v236
    v_mul_f32 v237, s22, v237
    v_mul_f32 v238, s22, v238
    v_mul_f32 v239, s22, v239
    v_cvt_pk_bf16_f32 v240, v224, v225
    v_cvt_pk_bf16_f32 v241, v226, v227
    v_cvt_pk_bf16_f32 v242, v228, v229
    v_cvt_pk_bf16_f32 v243, v230, v231
    v_cvt_pk_bf16_f32 v244, v232, v233
    v_cvt_pk_bf16_f32 v245, v234, v235
    v_cvt_pk_bf16_f32 v246, v236, v237
    v_cvt_pk_bf16_f32 v247, v238, v239
    v_lshlrev_b32 v224, 16, v240
    v_and_b32 v225, 0xffff0000, v240
    v_lshlrev_b32 v226, 16, v241
    v_and_b32 v227, 0xffff0000, v241
    v_lshlrev_b32 v228, 16, v242
    v_and_b32 v229, 0xffff0000, v242
    v_lshlrev_b32 v230, 16, v243
    v_and_b32 v231, 0xffff0000, v243
    v_lshlrev_b32 v232, 16, v244
    v_and_b32 v233, 0xffff0000, v244
    v_lshlrev_b32 v234, 16, v245
    v_and_b32 v235, 0xffff0000, v245
    v_lshlrev_b32 v236, 16, v246
    v_and_b32 v237, 0xffff0000, v246
    v_lshlrev_b32 v238, 16, v247
    v_and_b32 v239, 0xffff0000, v247
    v_lshlrev_b32 v32, 16, v24
    v_and_b32 v33, 0xffff0000, v24
    v_lshlrev_b32 v34, 16, v25
    v_and_b32 v35, 0xffff0000, v25
    v_lshlrev_b32 v36, 16, v26
    v_and_b32 v37, 0xffff0000, v26
    v_lshlrev_b32 v38, 16, v27
    v_and_b32 v39, 0xffff0000, v27
    v_lshlrev_b32 v40, 16, v28
    v_and_b32 v41, 0xffff0000, v28
    v_lshlrev_b32 v42, 16, v29
    v_and_b32 v43, 0xffff0000, v29
    v_lshlrev_b32 v44, 16, v30
    v_and_b32 v45, 0xffff0000, v30
    v_lshlrev_b32 v46, 16, v31
    v_and_b32 v47, 0xffff0000, v31
    v_add_f32 v224, v224, v32
    v_add_f32 v225, v225, v33
    v_add_f32 v226, v226, v34
    v_add_f32 v227, v227, v35
    v_add_f32 v228, v228, v36
    v_add_f32 v229, v229, v37
    v_add_f32 v230, v230, v38
    v_add_f32 v231, v231, v39
    v_add_f32 v232, v232, v40
    v_add_f32 v233, v233, v41
    v_add_f32 v234, v234, v42
    v_add_f32 v235, v235, v43
    v_add_f32 v236, v236, v44
    v_add_f32 v237, v237, v45
    v_add_f32 v238, v238, v46
    v_add_f32 v239, v239, v47
    v_cvt_pk_bf16_f32 v240, v224, v225
    v_cvt_pk_bf16_f32 v241, v226, v227
    v_cvt_pk_bf16_f32 v242, v228, v229
    v_cvt_pk_bf16_f32 v243, v230, v231
    v_cvt_pk_bf16_f32 v244, v232, v233
    v_cvt_pk_bf16_f32 v245, v234, v235
    v_cvt_pk_bf16_f32 v246, v236, v237
    v_cvt_pk_bf16_f32 v247, v238, v239
    v_cmp_eq_u32 vcc, s21, v6
    s_nop 1
    v_cndmask_b32 v24, v24, v240, vcc
    v_cndmask_b32 v25, v25, v241, vcc
    v_cndmask_b32 v26, v26, v242, vcc
    v_cndmask_b32 v27, v27, v243, vcc
    v_cndmask_b32 v28, v28, v244, vcc
    v_cndmask_b32 v29, v29, v245, vcc
    v_cndmask_b32 v30, v30, v246, vcc
    v_cndmask_b32 v31, v31, v247, vcc
    v_lshlrev_b32 v32, 16, v24
    v_and_b32 v33, 0xffff0000, v24
    v_lshlrev_b32 v34, 16, v25
    v_and_b32 v35, 0xffff0000, v25
    v_lshlrev_b32 v36, 16, v26
    v_and_b32 v37, 0xffff0000, v26
    v_lshlrev_b32 v38, 16, v27
    v_and_b32 v39, 0xffff0000, v27
    v_lshlrev_b32 v40, 16, v28
    v_and_b32 v41, 0xffff0000, v28
    v_lshlrev_b32 v42, 16, v29
    v_and_b32 v43, 0xffff0000, v29
    v_lshlrev_b32 v44, 16, v30
    v_and_b32 v45, 0xffff0000, v30
    v_lshlrev_b32 v46, 16, v31
    v_and_b32 v47, 0xffff0000, v31
    v_pk_mul_f32 v[32:33], v[32:33], v[50:51] op_sel_hi:[1,0]
    v_pk_mul_f32 v[34:35], v[34:35], v[50:51] op_sel_hi:[1,0]
    v_pk_mul_f32 v[36:37], v[36:37], v[50:51] op_sel_hi:[1,0]
    v_pk_mul_f32 v[38:39], v[38:39], v[50:51] op_sel_hi:[1,0]
    v_pk_mul_f32 v[40:41], v[40:41], v[50:51] op_sel_hi:[1,0]
    v_pk_mul_f32 v[42:43], v[42:43], v[50:51] op_sel_hi:[1,0]
    v_pk_mul_f32 v[44:45], v[44:45], v[50:51] op_sel_hi:[1,0]
    v_pk_mul_f32 v[46:47], v[46:47], v[50:51] op_sel_hi:[1,0]
    v_cvt_pk_bf16_f32 v33, v32, v33
    v_cvt_pk_bf16_f32 v35, v34, v35
    v_cvt_pk_bf16_f32 v37, v36, v37
    v_cvt_pk_bf16_f32 v39, v38, v39
    v_cvt_pk_bf16_f32 v41, v40, v41
    v_cvt_pk_bf16_f32 v43, v42, v43
    v_cvt_pk_bf16_f32 v45, v44, v45
    v_cvt_pk_bf16_f32 v47, v46, v47
    v_lshlrev_b32 v32, 16, v33
    v_and_b32 v33, 0xffff0000, v33
    v_lshlrev_b32 v34, 16, v35
    v_and_b32 v35, 0xffff0000, v35
    v_lshlrev_b32 v36, 16, v37
    v_and_b32 v37, 0xffff0000, v37
    v_lshlrev_b32 v38, 16, v39
    v_and_b32 v39, 0xffff0000, v39
    v_lshlrev_b32 v40, 16, v41
    v_and_b32 v41, 0xffff0000, v41
    v_lshlrev_b32 v42, 16, v43
    v_and_b32 v43, 0xffff0000, v43
    v_lshlrev_b32 v44, 16, v45
    v_and_b32 v45, 0xffff0000, v45
    v_lshlrev_b32 v46, 16, v47
    v_and_b32 v47, 0xffff0000, v47
L_b_noownl:
    s_branch L_phaseb
L_compute:
    s_setprio 1
    s_lshr_b32 s21, s20, 1
    s_and_b32 s22, s20, 1
    v_lshrrev_b32 v3, 5, v2
    v_and_b32 v4, 31, v2
    s_lshl_b32 s12, s21, 13
    v_lshlrev_b32 v6, 7, v4
    v_add_u32 v6, s12, v6
    v_bfe_u32 v7, v2, 1, 3
    v_add_u32 v8, 0, v3
    v_xor_b32 v8, v8, v7
    v_lshl_add_u32 v20, v8, 4, v6
    v_add_u32 v8, 2, v3
    v_xor_b32 v8, v8, v7
    v_lshl_add_u32 v21, v8, 4, v6
    v_add_u32 v8, 4, v3
    v_xor_b32 v8, v8, v7
    v_lshl_add_u32 v22, v8, 4, v6
    v_add_u32 v8, 6, v3
    v_xor_b32 v8, v8, v7
    v_lshl_add_u32 v23, v8, 4, v6
    v_lshlrev_b32 v6, 10, v3
    v_bfe_u32 v7, v2, 2, 2
    v_lshl_add_u32 v6, v7, 7, v6
    v_bfe_u32 v8, v2, 3, 1
    v_xor_b32 v8, s22, v8
    v_lshl_add_u32 v6, v8, 6, v6
    v_bfe_u32 v8, v2, 4, 1
    v_lshlrev_b32 v8, 5, v8
    v_and_b32 v9, 3, v2
    v_lshl_add_u32 v8, v9, 3, v8
    v_add_u32 v6, v6, v8
    v_add_u32 v36, 16384, v6
    v_lshl_add_u32 v7, v3, 2, v7
    v_lshl_add_u32 v12, v7, 6, v8
    s_lshl_b32 s12, s22, 11
    s_add_u32 s12, s12, 155648
    v_add_u32 v12, s12, v12
    v_lshlrev_b32 v6, 14, v3
    v_lshl_add_u32 v6, v4, 4, v6
    v_lshlrev_b32 v7, 9, v3
    s_lshl_b32 s12, s22, 3
    s_lshl_b32 s13, s21, 2
    s_add_u32 s12, s12, s13
    s_lshl_b32 s13, s12, 14
    s_lshl_b32 s14, s19, 18
    s_add_u32 s13, s13, s14
    s_lshl_b32 s14, s18, 10
    s_add_u32 s13, s13, s14
    s_add_u32 s40, s13, 1048576
    s_add_u32 s41, s40, 32768
    s_lshl_b32 s13, s12, 9
    s_lshl_b32 s14, s19, 13
    s_add_u32 s13, s13, s14
    s_lshl_b32 s14, s18, 5
    s_add_u32 s13, s13, s14
    s_add_u32 s42, s13, 5242880
    s_add_u32 s43, s42, 1024
    s_lshl_b32 s13, s21, 4
    s_lshl_b32 s44, 1, s13
    s_xor_b32 s13, s13, 16
    s_lshl_b32 s45, 1, s13
    v_mov_b32 v68, 0
    v_mov_b32 v69, 0
    v_mov_b32 v70, 0
    v_mov_b32 v71, 0
    v_mov_b32 v160, 0
    v_mov_b32 v161, 0
    v_mov_b32 v162, 0
    v_mov_b32 v163, 0
    v_mov_b32 v164, 0
    v_mov_b32 v165, 0
    v_mov_b32 v166, 0
    v_mov_b32 v167, 0
    v_mov_b32 v168, 0
    v_mov_b32 v169, 0
    v_mov_b32 v170, 0
    v_mov_b32 v171, 0
    v_mov_b32 v172, 0
    v_mov_b32 v173, 0
    v_mov_b32 v174, 0
    v_mov_b32 v175, 0
    v_mov_b32 v176, 0
    v_mov_b32 v177, 0
    v_mov_b32 v178, 0
    v_mov_b32 v179, 0
    v_mov_b32 v180, 0
    v_mov_b32 v181, 0
    v_mov_b32 v182, 0
    v_mov_b32 v183, 0
    v_mov_b32 v184, 0
    v_mov_b32 v185, 0
    v_mov_b32 v186, 0
    v_mov_b32 v187, 0
    v_mov_b32 v188, 0
    v_mov_b32 v189, 0
    v_mov_b32 v190, 0
    v_mov_b32 v191, 0
    v_mov_b32 v192, 0
    v_mov_b32 v193, 0
    v_mov_b32 v194, 0
    v_mov_b32 v195, 0
    v_mov_b32 v196, 0
    v_mov_b32 v197, 0
    v_mov_b32 v198, 0
    v_mov_b32 v199, 0
    v_mov_b32 v200, 0
    v_mov_b32 v201, 0
    v_mov_b32 v202, 0
    v_mov_b32 v203, 0
    v_mov_b32 v204, 0
    v_mov_b32 v205, 0
    v_mov_b32 v206, 0
    v_mov_b32 v207, 0
    v_mov_b32 v208, 0
    v_mov_b32 v209, 0
    v_mov_b32 v210, 0
    v_mov_b32 v211, 0
    v_mov_b32 v212, 0
    v_mov_b32 v213, 0
    v_mov_b32 v214, 0
    v_mov_b32 v215, 0
    v_mov_b32 v216, 0
    v_mov_b32 v217, 0
    v_mov_b32 v218, 0
    v_mov_b32 v219, 0
    v_mov_b32 v220, 0
    v_mov_b32 v221, 0
    v_mov_b32 v222, 0
    v_mov_b32 v223, 0
    v_mov_b32 v224, 0
    v_mov_b32 v225, 0
    v_mov_b32 v226, 0
    v_mov_b32 v227, 0
    v_mov_b32 v228, 0
    v_mov_b32 v229, 0
    v_mov_b32 v230, 0
    v_mov_b32 v231, 0
    v_mov_b32 v232, 0
    v_mov_b32 v233, 0
    v_mov_b32 v234, 0
    v_mov_b32 v235, 0
    v_mov_b32 v236, 0
    v_mov_b32 v237, 0
    v_mov_b32 v238, 0
    v_mov_b32 v239, 0
    v_mov_b32 v240, 0
    v_mov_b32 v241, 0
    v_mov_b32 v242, 0
    v_mov_b32 v243, 0
    v_mov_b32 v244, 0
    v_mov_b32 v245, 0
    v_mov_b32 v246, 0
    v_mov_b32 v247, 0
    v_mov_b32 v248, 0
    v_mov_b32 v249, 0
    v_mov_b32 v250, 0
    v_mov_b32 v251, 0
    v_mov_b32 v252, 0
    v_mov_b32 v253, 0
    v_mov_b32 v254, 0
    v_mov_b32 v255, 0
    v_lshlrev_b32 v8, 2, v3
    v_sub_u32 v8, v4, v8
    v_mov_b32 v9, 0x3f80
    v_mov_b32 v10, 0x3f800000
    v_cmp_eq_u32 vcc, 0, v8
    s_nop 1
    v_cndmask_b32 v11, 0, v9, vcc
    v_cmp_eq_u32 vcc, 1, v8
    s_nop 1
    v_cndmask_b32 v48, v11, v10, vcc
    v_cmp_eq_u32 vcc, 2, v8
    s_nop 1
    v_cndmask_b32 v11, 0, v9, vcc
    v_cmp_eq_u32 vcc, 3, v8
    s_nop 1
    v_cndmask_b32 v49, v11, v10, vcc
    v_cmp_eq_u32 vcc, 8, v8
    s_nop 1
    v_cndmask_b32 v11, 0, v9, vcc
    v_cmp_eq_u32 vcc, 9, v8
    s_nop 1
    v_cndmask_b32 v50, v11, v10, vcc
    v_cmp_eq_u32 vcc, 10, v8
    s_nop 1
    v_cndmask_b32 v11, 0, v9, vcc
    v_cmp_eq_u32 vcc, 11, v8
    s_nop 1
    v_cndmask_b32 v51, v11, v10, vcc
    v_cmp_eq_u32 vcc, 16, v8
    s_nop 1
    v_cndmask_b32 v11, 0, v9, vcc
    v_cmp_eq_u32 vcc, 17, v8
    s_nop 1
    v_cndmask_b32 v52, v11, v10, vcc
    v_cmp_eq_u32 vcc, 18, v8
    s_nop 1
    v_cndmask_b32 v11, 0, v9, vcc
    v_cmp_eq_u32 vcc, 19, v8
    s_nop 1
    v_cndmask_b32 v53, v11, v10, vcc
    v_cmp_eq_u32 vcc, 24, v8
    s_nop 1
    v_cndmask_b32 v11, 0, v9, vcc
    v_cmp_eq_u32 vcc, 25, v8
    s_nop 1
    v_cndmask_b32 v54, v11, v10, vcc
    v_cmp_eq_u32 vcc, 26, v8
    s_nop 1
    v_cndmask_b32 v11, 0, v9, vcc
    v_cmp_eq_u32 vcc, 27, v8
    s_nop 1
    v_cndmask_b32 v55, v11, v10, vcc
    v_mov_b32 v9, 0x3f803f80
    v_cmp_gt_u32 vcc, 16, v4
    s_nop 1
    v_cndmask_b32 v56, 0, v9, vcc
    v_cndmask_b32 v60, v9, 0, vcc
    v_cndmask_b32 v57, 0, v9, vcc
    v_cndmask_b32 v61, v9, 0, vcc
    v_cndmask_b32 v58, 0, v9, vcc
    v_cndmask_b32 v62, v9, 0, vcc
    v_cndmask_b32 v59, 0, v9, vcc
    v_cndmask_b32 v63, v9, 0, vcc
    s_waitcnt lgkmcnt(0)
    s_mov_b32 s32, s62
    s_and_b32 s33, s63, 0xffff
    s_mov_b32 s34, 33554432
    s_mov_b32 s35, 0x00020000
    s_mov_b32 s24, s4
    s_and_b32 s25, s5, 0xffff
    s_mov_b32 s26, 4194304
    s_mov_b32 s27, 0x00020000
    s_cmp_lg_u32 s20, 0
    s_cbranch_scc1 L_c_noinit
    v_add_u32 v8, 162816, v5
    s_mov_b64 exec, 0xff
    ds_write_b128 v8, v[68:71]
    s_mov_b64 exec, -1
    s_cmp_lg_u32 s2, 0
    s_cbranch_scc1 L_c_noinit
    s_mov_b32 s72, s60
    s_and_b32 s73, s61, 0xffff
    s_mov_b32 s74, 256
    s_mov_b32 s75, 0x00020000
    s_memrealtime s[14:15]
    s_waitcnt lgkmcnt(0)
    s_mul_i32 s14, s14, 0x9e3779b1
    s_or_b32 s14, s14, 0x01010101
    v_mov_b32 v8, s14
    s_mov_b64 exec, 1
    buffer_store_dword v8, v68, s[72:75], 0 offen offset:4 sc1
    s_mov_b64 exec, -1
L_c_noinit:
    s_lshl_b32 s14, s22, 1
    s_add_u32 s15, s14, s21
    s_xor_b32 s14, s15, 1
    s_mul_i32 s14, s14, 4224
    s_mul_i32 s15, s15, 4224
    s_add_u32 s14, s14, 40960
    s_add_u32 s15, s15, 40960
    v_add_u32 v8, s14, v5
    v_add_u32 v9, s15, v5
    v_lshlrev_b32 v11, 4, v3
    v_add_u32 v10, s14, v11
    v_add_u32 v11, s15, v11
    s_lshl_b32 s14, s20, 2
    s_add_u32 s15, s14, 162832
    v_mov_b32 v13, s15
    v_xor_b32 v14, 8, v13
    v_subrev_u32 v17, 16, v13
    v_mov_b32 v15, 1
    s_waitcnt lgkmcnt(0)
    s_barrier
    ds_read_b128 v[100:103], v20
    ds_read_b64_tr_b16 v[108:109], v36 offset:0
    ds_read_b64_tr_b16 v[110:111], v36 offset:512
    ds_read_b128 v[104:107], v20 offset:4096
    ds_read_b64_tr_b16 v[112:113], v36 offset:8192
    ds_read_b64_tr_b16 v[114:115], v36 offset:8704
    ds_read_b64_tr_b16 v[116:117], v36 offset:16384
    ds_read_b64_tr_b16 v[118:119], v36 offset:16896
    s_mov_b32 s48, 0
    s_mov_b32 s49, 0
.p2align 3
L_c_loop:
    s_add_u32 s49, s49, 1
    s_cmp_eq_u32 s49, 3
    s_mov_b32 s50, 40960
    s_cselect_b32 s50, 4294885376, s50
    s_cselect_b32 s49, 0, s49
    s_waitcnt lgkmcnt(5)
    v_mfma_f32_32x32x16_bf16 v[160:175], v[108:111], v[100:103], v[160:175]
    ds_read_b128 v[120:123], v21
    ds_read_b64_tr_b16 v[128:129], v36 offset:2048
    s_waitcnt lgkmcnt(6)
    v_mfma_f32_32x32x16_bf16 v[176:191], v[108:111], v[104:107], v[176:191]
    ds_read_b64_tr_b16 v[130:131], v36 offset:2560
    s_waitcnt lgkmcnt(5)
    v_mfma_f32_32x32x16_bf16 v[192:207], v[112:115], v[100:103], v[192:207]
    ds_read_b128 v[124:127], v21 offset:4096
    v_mfma_f32_32x32x16_bf16 v[208:223], v[112:115], v[104:107], v[208:223]
    ds_read_b64_tr_b16 v[132:133], v36 offset:10240
    ds_read_b64_tr_b16 v[134:135], v36 offset:10752
    s_waitcnt lgkmcnt(6)
    v_mfma_f32_32x32x16_bf16 v[224:239], v[100:103], v[116:119], v[224:239]
    ds_read_b64_tr_b16 v[136:137], v36 offset:18432
    v_add_u32 v21, s50, v21
    v_mfma_f32_32x32x16_bf16 v[240:255], v[104:107], v[116:119], v[240:255]
    ds_read_b64_tr_b16 v[138:139], v36 offset:18944
    v_add_u32 v20, s50, v20
    s_waitcnt lgkmcnt(5)
    v_mfma_f32_32x32x16_bf16 v[160:175], v[128:131], v[120:123], v[160:175]
    ds_read_b128 v[100:103], v22
    ds_read_b64_tr_b16 v[108:109], v36 offset:4096
    s_waitcnt lgkmcnt(6)
    v_mfma_f32_32x32x16_bf16 v[176:191], v[128:131], v[124:127], v[176:191]
    ds_read_b64_tr_b16 v[110:111], v36 offset:4608
    s_waitcnt lgkmcnt(5)
    v_mfma_f32_32x32x16_bf16 v[192:207], v[132:135], v[120:123], v[192:207]
    ds_read_b128 v[104:107], v22 offset:4096
    v_mfma_f32_32x32x16_bf16 v[208:223], v[132:135], v[124:127], v[208:223]
    ds_read_b64_tr_b16 v[112:113], v36 offset:12288
    ds_read_b64_tr_b16 v[114:115], v36 offset:12800
    s_waitcnt lgkmcnt(6)
    v_mfma_f32_32x32x16_bf16 v[224:239], v[120:123], v[136:139], v[224:239]
    ds_read_b64_tr_b16 v[116:117], v36 offset:20480
    v_add_u32 v22, s50, v22
    v_mfma_f32_32x32x16_bf16 v[240:255], v[124:127], v[136:139], v[240:255]
    ds_read_b64_tr_b16 v[118:119], v36 offset:20992
    s_waitcnt lgkmcnt(5)
    v_mfma_f32_32x32x16_bf16 v[160:175], v[108:111], v[100:103], v[160:175]
    ds_read_b128 v[120:123], v23
    ds_read_b64_tr_b16 v[128:129], v36 offset:6144
    ds_read_b64_tr_b16 v[130:131], v36 offset:6656
    s_waitcnt lgkmcnt(7)
    v_mfma_f32_32x32x16_bf16 v[176:191], v[108:111], v[104:107], v[176:191]
    ds_read_b128 v[124:127], v23 offset:4096
    ds_read_b64_tr_b16 v[132:133], v36 offset:14336
    ds_read_b64_tr_b16 v[134:135], v36 offset:14848
    s_waitcnt lgkmcnt(8)
    v_mfma_f32_32x32x16_bf16 v[192:207], v[112:115], v[100:103], v[192:207]
    ds_read_b64_tr_b16 v[136:137], v36 offset:22528
    ds_read_b64_tr_b16 v[138:139], v36 offset:23040
    v_mfma_f32_32x32x16_bf16 v[208:223], v[112:115], v[104:107], v[208:223]
    s_waitcnt lgkmcnt(8)
    v_mfma_f32_32x32x16_bf16 v[224:239], v[100:103], v[116:119], v[224:239]
    v_add_u32 v23, s50, v23
    v_mfma_f32_32x32x16_bf16 v[240:255], v[104:107], v[116:119], v[240:255]
    v_add_u32 v36, s50, v36
    s_waitcnt lgkmcnt(0)
    v_mfma_f32_32x32x16_bf16 v[160:175], v[128:131], v[120:123], v[160:175]
    s_barrier
    ds_read_b128 v[100:103], v20
    ds_read_b64_tr_b16 v[108:109], v36 offset:0
    ds_read_b64_tr_b16 v[110:111], v36 offset:512
    v_mfma_f32_32x32x16_bf16 v[176:191], v[128:131], v[124:127], v[176:191]
    ds_read_b128 v[104:107], v20 offset:4096
    ds_read_b64_tr_b16 v[112:113], v36 offset:8192
    ds_read_b64_tr_b16 v[114:115], v36 offset:8704
    v_mfma_f32_32x32x16_bf16 v[192:207], v[132:135], v[120:123], v[192:207]
    ds_read_b64_tr_b16 v[116:117], v36 offset:16384
    ds_read_b64_tr_b16 v[118:119], v36 offset:16896
    v_mfma_f32_32x32x16_bf16 v[208:223], v[132:135], v[124:127], v[208:223]
    v_mfma_f32_32x32x16_bf16 v[224:239], v[120:123], v[136:139], v[224:239]
    s_add_u32 s48, s48, 1
    s_cmp_lt_u32 s48, 15
    v_mfma_f32_32x32x16_bf16 v[240:255], v[124:127], v[136:139], v[240:255]
    s_cbranch_scc1 L_c_loop
    s_waitcnt lgkmcnt(5)
    v_mfma_f32_32x32x16_bf16 v[160:175], v[108:111], v[100:103], v[160:175]
    ds_read_b128 v[120:123], v21
    ds_read_b64_tr_b16 v[128:129], v36 offset:2048
    s_waitcnt lgkmcnt(6)
    v_mfma_f32_32x32x16_bf16 v[176:191], v[108:111], v[104:107], v[176:191]
    ds_read_b64_tr_b16 v[130:131], v36 offset:2560
    s_waitcnt lgkmcnt(5)
    v_mfma_f32_32x32x16_bf16 v[192:207], v[112:115], v[100:103], v[192:207]
    ds_read_b128 v[124:127], v21 offset:4096
    v_mfma_f32_32x32x16_bf16 v[208:223], v[112:115], v[104:107], v[208:223]
    ds_read_b64_tr_b16 v[132:133], v36 offset:10240
    ds_read_b64_tr_b16 v[134:135], v36 offset:10752
    s_waitcnt lgkmcnt(6)
    v_mfma_f32_32x32x16_bf16 v[224:239], v[100:103], v[116:119], v[224:239]
    ds_read_b64_tr_b16 v[136:137], v36 offset:18432
    v_mfma_f32_32x32x16_bf16 v[240:255], v[104:107], v[116:119], v[240:255]
    ds_read_b64_tr_b16 v[138:139], v36 offset:18944
    s_waitcnt lgkmcnt(5)
    v_mfma_f32_32x32x16_bf16 v[160:175], v[128:131], v[120:123], v[160:175]
    ds_read_b128 v[100:103], v22
    ds_read_b64_tr_b16 v[108:109], v36 offset:4096
    s_waitcnt lgkmcnt(6)
    v_mfma_f32_32x32x16_bf16 v[176:191], v[128:131], v[124:127], v[176:191]
    ds_read_b64_tr_b16 v[110:111], v36 offset:4608
    s_waitcnt lgkmcnt(5)
    v_mfma_f32_32x32x16_bf16 v[192:207], v[132:135], v[120:123], v[192:207]
    ds_read_b128 v[104:107], v22 offset:4096
    v_mfma_f32_32x32x16_bf16 v[208:223], v[132:135], v[124:127], v[208:223]
    ds_read_b64_tr_b16 v[112:113], v36 offset:12288
    ds_read_b64_tr_b16 v[114:115], v36 offset:12800
    s_waitcnt lgkmcnt(6)
    v_mfma_f32_32x32x16_bf16 v[224:239], v[120:123], v[136:139], v[224:239]
    ds_read_b64_tr_b16 v[116:117], v36 offset:20480
    v_mfma_f32_32x32x16_bf16 v[240:255], v[124:127], v[136:139], v[240:255]
    ds_read_b64_tr_b16 v[118:119], v36 offset:20992
    s_waitcnt lgkmcnt(5)
    v_mfma_f32_32x32x16_bf16 v[160:175], v[108:111], v[100:103], v[160:175]
    ds_read_b128 v[120:123], v23
    ds_read_b64_tr_b16 v[128:129], v36 offset:6144
    ds_read_b64_tr_b16 v[130:131], v36 offset:6656
    s_waitcnt lgkmcnt(7)
    v_mfma_f32_32x32x16_bf16 v[176:191], v[108:111], v[104:107], v[176:191]
    ds_read_b128 v[124:127], v23 offset:4096
    ds_read_b64_tr_b16 v[132:133], v36 offset:14336
    ds_read_b64_tr_b16 v[134:135], v36 offset:14848
    s_waitcnt lgkmcnt(8)
    v_mfma_f32_32x32x16_bf16 v[192:207], v[112:115], v[100:103], v[192:207]
    ds_read_b64_tr_b16 v[136:137], v36 offset:22528
    ds_read_b64_tr_b16 v[138:139], v36 offset:23040
    v_mfma_f32_32x32x16_bf16 v[208:223], v[112:115], v[104:107], v[208:223]
    s_waitcnt lgkmcnt(8)
    v_mfma_f32_32x32x16_bf16 v[224:239], v[100:103], v[116:119], v[224:239]
    v_mfma_f32_32x32x16_bf16 v[240:255], v[104:107], v[116:119], v[240:255]
    s_waitcnt lgkmcnt(0)
    v_mfma_f32_32x32x16_bf16 v[160:175], v[128:131], v[120:123], v[160:175]
    s_mov_b64 exec, 1
    ds_write_b32 v17, v15
    s_mov_b64 exec, -1
    ds_read_b64_tr_b16 v[40:41], v12 offset:0
    ds_read_b64_tr_b16 v[42:43], v12 offset:512
    ds_read_b64_tr_b16 v[44:45], v12 offset:1024
    ds_read_b64_tr_b16 v[46:47], v12 offset:1536
    v_mov_b32 v16, 162864
    ds_read_b96 v[24:26], v16
    v_mfma_f32_32x32x16_bf16 v[176:191], v[128:131], v[124:127], v[176:191]
    v_mfma_f32_32x32x16_bf16 v[192:207], v[132:135], v[120:123], v[192:207]
    v_mfma_f32_32x32x16_bf16 v[208:223], v[132:135], v[124:127], v[208:223]
    v_mfma_f32_32x32x16_bf16 v[224:239], v[120:123], v[136:139], v[224:239]
    v_mfma_f32_32x32x16_bf16 v[240:255], v[124:127], v[136:139], v[240:255]
    s_mov_b32 s48, 0x3fb8aa3b
    s_mov_b32 s52, 0xbfb8aa3b
    s_nop 6
    v_cvt_pk_bf16_f32 v64, v192, v193
    v_cvt_pk_bf16_f32 v65, v194, v195
    v_cvt_pk_bf16_f32 v66, v196, v197
    v_cvt_pk_bf16_f32 v67, v198, v199
    v_cvt_pk_bf16_f32 v68, v200, v201
    v_cvt_pk_bf16_f32 v69, v202, v203
    v_cvt_pk_bf16_f32 v70, v204, v205
    v_cvt_pk_bf16_f32 v71, v206, v207
    s_waitcnt lgkmcnt(0)
    v_mfma_f32_32x32x16_bf16 v[192:207], v[40:43], v[64:67], 0
    v_mfma_f32_32x32x16_bf16 v[192:207], v[44:47], v[68:71], v[192:207]
    v_cvt_pk_bf16_f32 v72, v208, v209
    v_cvt_pk_bf16_f32 v73, v210, v211
    v_cvt_pk_bf16_f32 v74, v212, v213
    v_cvt_pk_bf16_f32 v75, v214, v215
    v_cvt_pk_bf16_f32 v76, v216, v217
    v_cvt_pk_bf16_f32 v77, v218, v219
    v_cvt_pk_bf16_f32 v78, v220, v221
    v_cvt_pk_bf16_f32 v79, v222, v223
    v_mfma_f32_32x32x16_bf16 v[208:223], v[40:43], v[72:75], 0
    s_nop 0
    v_mfma_f32_32x32x16_bf16 v[208:223], v[44:47], v[76:79], v[208:223]
    v_readfirstlane_b32 s72, v24
    v_readfirstlane_b32 s73, v25
    v_readfirstlane_b32 s74, v26
    v_and_b32 v27, 3, v2
    v_lshlrev_b32 v27, 3, v27
    v_bfe_u32 v27, v26, v27, 8
    v_mov_b32 v28, 0xffffff00
    s_and_b32 s76, s74, 0xff
    s_bfe_u32 s77, s74, 0x80008
    s_bfe_u32 s78, s74, 0x80010
    s_lshr_b32 s79, s74, 24
    v_cvt_pk_bf16_f32 v80, v224, v225
    v_cvt_pk_bf16_f32 v81, v226, v227
    v_cvt_pk_bf16_f32 v82, v228, v229
    v_cvt_pk_bf16_f32 v83, v230, v231
    v_cvt_pk_bf16_f32 v84, v232, v233
    v_cvt_pk_bf16_f32 v85, v234, v235
    v_cvt_pk_bf16_f32 v86, v236, v237
    v_cvt_pk_bf16_f32 v87, v238, v239
    v_cvt_pk_bf16_f32 v88, v240, v241
    v_cvt_pk_bf16_f32 v89, v242, v243
    v_cvt_pk_bf16_f32 v90, v244, v245
    v_cvt_pk_bf16_f32 v91, v246, v247
    v_cvt_pk_bf16_f32 v92, v248, v249
    v_cvt_pk_bf16_f32 v93, v250, v251
    v_cvt_pk_bf16_f32 v94, v252, v253
    v_cvt_pk_bf16_f32 v95, v254, v255
    v_cvt_pk_bf16_f32 v64, v192, v193
    v_cvt_pk_bf16_f32 v65, v194, v195
    v_cvt_pk_bf16_f32 v66, v196, v197
    v_cvt_pk_bf16_f32 v67, v198, v199
    v_cvt_pk_bf16_f32 v68, v200, v201
    v_cvt_pk_bf16_f32 v69, v202, v203
    v_cvt_pk_bf16_f32 v70, v204, v205
    v_cvt_pk_bf16_f32 v71, v206, v207
    v_lshlrev_b32 v192, 16, v64
    v_and_b32 v193, 0xffff0000, v64
    v_lshlrev_b32 v194, 16, v65
    v_and_b32 v195, 0xffff0000, v65
    v_lshlrev_b32 v196, 16, v66
    v_and_b32 v197, 0xffff0000, v66
    v_lshlrev_b32 v198, 16, v67
    v_and_b32 v199, 0xffff0000, v67
    v_lshlrev_b32 v200, 16, v68
    v_and_b32 v201, 0xffff0000, v68
    v_lshlrev_b32 v202, 16, v69
    v_and_b32 v203, 0xffff0000, v69
    v_lshlrev_b32 v204, 16, v70
    v_and_b32 v205, 0xffff0000, v70
    v_lshlrev_b32 v206, 16, v71
    v_and_b32 v207, 0xffff0000, v71
    v_cvt_pk_bf16_f32 v72, v208, v209
    v_cvt_pk_bf16_f32 v73, v210, v211
    v_cvt_pk_bf16_f32 v74, v212, v213
    v_cvt_pk_bf16_f32 v75, v214, v215
    v_cvt_pk_bf16_f32 v76, v216, v217
    v_cvt_pk_bf16_f32 v77, v218, v219
    v_cvt_pk_bf16_f32 v78, v220, v221
    v_cvt_pk_bf16_f32 v79, v222, v223
    v_lshlrev_b32 v208, 16, v72
    v_and_b32 v209, 0xffff0000, v72
    v_lshlrev_b32 v210, 16, v73
    v_and_b32 v211, 0xffff0000, v73
    v_lshlrev_b32 v212, 16, v74
    v_and_b32 v213, 0xffff0000, v74
    v_lshlrev_b32 v214, 16, v75
    v_and_b32 v215, 0xffff0000, v75
    v_lshlrev_b32 v216, 16, v76
    v_and_b32 v217, 0xffff0000, v76
    v_lshlrev_b32 v218, 16, v77
    v_and_b32 v219, 0xffff0000, v77
    v_lshlrev_b32 v220, 16, v78
    v_and_b32 v221, 0xffff0000, v78
    v_lshlrev_b32 v222, 16, v79
    v_and_b32 v223, 0xffff0000, v79
    v_max3_f32 v144, v192, v193, v194
    v_max3_f32 v145, v195, v196, v197
    v_max3_f32 v146, v198, v199, v200
    v_max3_f32 v147, v201, v202, v203
    v_max3_f32 v148, v204, v205, v206
    v_max3_f32 v144, v144, v145, v207
    v_max3_f32 v146, v146, v147, v148
    v_max_f32 v144, v144, v146
    v_min3_f32 v150, v192, v193, v194
    v_min3_f32 v151, v195, v196, v197
    v_min3_f32 v152, v198, v199, v200
    v_min3_f32 v153, v201, v202, v203
    v_min3_f32 v154, v204, v205, v206
    v_min3_f32 v150, v150, v151, v207
    v_min3_f32 v152, v152, v153, v154
    v_min_f32 v150, v150, v152
    v_mov_b32 v145, v144
    v_mov_b32 v151, v150
    s_nop 0
    v_permlane32_swap_b32 v144, v145
    v_permlane32_swap_b32 v150, v151
    v_max_f32 v144, v144, v145
    v_min_f32 v150, v150, v151
    v_mul_f32 v144, s52, v144
    v_mul_f32 v150, s48, v150
    v_pk_fma_f32 v[224:225], v[192:193], s[48:49], v[144:145] op_sel_hi:[1,0,0]
    v_pk_fma_f32 v[112:113], v[192:193], s[52:53], v[150:151] op_sel_hi:[1,0,0]
    v_pk_fma_f32 v[226:227], v[194:195], s[48:49], v[144:145] op_sel_hi:[1,0,0]
    v_pk_fma_f32 v[114:115], v[194:195], s[52:53], v[150:151] op_sel_hi:[1,0,0]
    v_pk_fma_f32 v[228:229], v[196:197], s[48:49], v[144:145] op_sel_hi:[1,0,0]
    v_pk_fma_f32 v[116:117], v[196:197], s[52:53], v[150:151] op_sel_hi:[1,0,0]
    v_pk_fma_f32 v[230:231], v[198:199], s[48:49], v[144:145] op_sel_hi:[1,0,0]
    v_pk_fma_f32 v[118:119], v[198:199], s[52:53], v[150:151] op_sel_hi:[1,0,0]
    v_pk_fma_f32 v[232:233], v[200:201], s[48:49], v[144:145] op_sel_hi:[1,0,0]
    v_pk_fma_f32 v[120:121], v[200:201], s[52:53], v[150:151] op_sel_hi:[1,0,0]
    v_pk_fma_f32 v[234:235], v[202:203], s[48:49], v[144:145] op_sel_hi:[1,0,0]
    v_pk_fma_f32 v[122:123], v[202:203], s[52:53], v[150:151] op_sel_hi:[1,0,0]
    v_pk_fma_f32 v[236:237], v[204:205], s[48:49], v[144:145] op_sel_hi:[1,0,0]
    v_pk_fma_f32 v[124:125], v[204:205], s[52:53], v[150:151] op_sel_hi:[1,0,0]
    v_pk_fma_f32 v[238:239], v[206:207], s[48:49], v[144:145] op_sel_hi:[1,0,0]
    v_pk_fma_f32 v[126:127], v[206:207], s[52:53], v[150:151] op_sel_hi:[1,0,0]
    v_exp_f32 v224, v224
    v_exp_f32 v112, v112
    v_exp_f32 v225, v225
    v_exp_f32 v113, v113
    v_exp_f32 v226, v226
    v_exp_f32 v114, v114
    v_exp_f32 v227, v227
    v_exp_f32 v115, v115
    v_exp_f32 v228, v228
    v_exp_f32 v116, v116
    v_exp_f32 v229, v229
    v_exp_f32 v117, v117
    v_exp_f32 v230, v230
    v_exp_f32 v118, v118
    v_exp_f32 v231, v231
    v_exp_f32 v119, v119
    v_exp_f32 v232, v232
    v_exp_f32 v120, v120
    v_exp_f32 v233, v233
    v_exp_f32 v121, v121
    v_exp_f32 v234, v234
    v_exp_f32 v122, v122
    v_exp_f32 v235, v235
    v_exp_f32 v123, v123
    v_exp_f32 v236, v236
    v_exp_f32 v124, v124
    v_exp_f32 v237, v237
    v_exp_f32 v125, v125
    v_exp_f32 v238, v238
    v_exp_f32 v126, v126
    v_exp_f32 v239, v239
    v_exp_f32 v127, v127
    v_pk_add_f32 v[144:145], v[224:225], v[226:227]
    v_pk_add_f32 v[146:147], v[228:229], v[230:231]
    v_pk_add_f32 v[148:149], v[232:233], v[234:235]
    v_pk_add_f32 v[150:151], v[112:113], v[114:115]
    v_pk_add_f32 v[152:153], v[116:117], v[118:119]
    v_pk_add_f32 v[154:155], v[120:121], v[122:123]
    v_pk_add_f32 v[144:145], v[144:145], v[236:237]
    v_pk_add_f32 v[146:147], v[146:147], v[238:239]
    v_pk_add_f32 v[150:151], v[150:151], v[124:125]
    v_pk_add_f32 v[152:153], v[152:153], v[126:127]
    v_pk_add_f32 v[144:145], v[144:145], v[148:149]
    v_pk_add_f32 v[150:151], v[150:151], v[154:155]
    v_pk_add_f32 v[144:145], v[144:145], v[146:147]
    v_pk_add_f32 v[150:151], v[150:151], v[152:153]
    v_add_f32 v144, v144, v145
    v_add_f32 v150, v150, v151
    v_mov_b32 v145, v144
    v_mov_b32 v151, v150
    s_nop 0
    v_permlane32_swap_b32 v144, v145
    v_permlane32_swap_b32 v150, v151
    v_add_f32 v144, v144, v145
    v_add_f32 v150, v150, v151
    v_rcp_f32 v144, v144
    v_rcp_f32 v150, v150
    v_pk_mul_f32 v[224:225], v[224:225], v[144:145] op_sel_hi:[1,0]
    v_pk_mul_f32 v[112:113], v[112:113], v[150:151] op_sel_hi:[1,0]
    v_pk_mul_f32 v[226:227], v[226:227], v[144:145] op_sel_hi:[1,0]
    v_pk_mul_f32 v[114:115], v[114:115], v[150:151] op_sel_hi:[1,0]
    v_pk_mul_f32 v[228:229], v[228:229], v[144:145] op_sel_hi:[1,0]
    v_pk_mul_f32 v[116:117], v[116:117], v[150:151] op_sel_hi:[1,0]
    v_pk_mul_f32 v[230:231], v[230:231], v[144:145] op_sel_hi:[1,0]
    v_pk_mul_f32 v[118:119], v[118:119], v[150:151] op_sel_hi:[1,0]
    v_pk_mul_f32 v[232:233], v[232:233], v[144:145] op_sel_hi:[1,0]
    v_pk_mul_f32 v[120:121], v[120:121], v[150:151] op_sel_hi:[1,0]
    v_pk_mul_f32 v[234:235], v[234:235], v[144:145] op_sel_hi:[1,0]
    v_pk_mul_f32 v[122:123], v[122:123], v[150:151] op_sel_hi:[1,0]
    v_pk_mul_f32 v[236:237], v[236:237], v[144:145] op_sel_hi:[1,0]
    v_pk_mul_f32 v[124:125], v[124:125], v[150:151] op_sel_hi:[1,0]
    v_pk_mul_f32 v[238:239], v[238:239], v[144:145] op_sel_hi:[1,0]
    v_pk_mul_f32 v[126:127], v[126:127], v[150:151] op_sel_hi:[1,0]
    v_cvt_pk_bf16_f32 v64, v224, v225
    v_cvt_pk_bf16_f32 v96, v112, v113
    v_cvt_pk_bf16_f32 v65, v226, v227
    v_cvt_pk_bf16_f32 v97, v114, v115
    v_cvt_pk_bf16_f32 v66, v228, v229
    v_cvt_pk_bf16_f32 v98, v116, v117
    v_cvt_pk_bf16_f32 v67, v230, v231
    v_cvt_pk_bf16_f32 v99, v118, v119
    v_cvt_pk_bf16_f32 v68, v232, v233
    v_cvt_pk_bf16_f32 v100, v120, v121
    v_cvt_pk_bf16_f32 v69, v234, v235
    v_cvt_pk_bf16_f32 v101, v122, v123
    v_cvt_pk_bf16_f32 v70, v236, v237
    v_cvt_pk_bf16_f32 v102, v124, v125
    v_cvt_pk_bf16_f32 v71, v238, v239
    v_cvt_pk_bf16_f32 v103, v126, v127
    v_mfma_f32_32x32x16_bf16 v[192:207], v[64:67], v[48:51], 0
    v_mfma_f32_32x32x16_bf16 v[192:207], v[68:71], v[52:55], v[192:207]
    v_mfma_f32_32x32x16_bf16 v[224:239], v[96:99], v[48:51], 0
    v_mfma_f32_32x32x16_bf16 v[224:239], v[100:103], v[52:55], v[224:239]
    v_max3_f32 v144, v208, v209, v210
    v_max3_f32 v145, v211, v212, v213
    v_max3_f32 v146, v214, v215, v216
    v_max3_f32 v147, v217, v218, v219
    v_max3_f32 v148, v220, v221, v222
    v_max3_f32 v144, v144, v145, v223
    v_max3_f32 v146, v146, v147, v148
    v_max_f32 v144, v144, v146
    v_min3_f32 v150, v208, v209, v210
    v_min3_f32 v151, v211, v212, v213
    v_min3_f32 v152, v214, v215, v216
    v_min3_f32 v153, v217, v218, v219
    v_min3_f32 v154, v220, v221, v222
    v_min3_f32 v150, v150, v151, v223
    v_min3_f32 v152, v152, v153, v154
    v_min_f32 v150, v150, v152
    v_mov_b32 v145, v144
    v_mov_b32 v151, v150
    s_nop 0
    v_permlane32_swap_b32 v144, v145
    v_permlane32_swap_b32 v150, v151
    v_max_f32 v144, v144, v145
    v_min_f32 v150, v150, v151
    v_mul_f32 v144, s52, v144
    v_mul_f32 v150, s48, v150
    v_pk_fma_f32 v[240:241], v[208:209], s[48:49], v[144:145] op_sel_hi:[1,0,0]
    v_pk_fma_f32 v[128:129], v[208:209], s[52:53], v[150:151] op_sel_hi:[1,0,0]
    v_pk_fma_f32 v[242:243], v[210:211], s[48:49], v[144:145] op_sel_hi:[1,0,0]
    v_pk_fma_f32 v[130:131], v[210:211], s[52:53], v[150:151] op_sel_hi:[1,0,0]
    v_pk_fma_f32 v[244:245], v[212:213], s[48:49], v[144:145] op_sel_hi:[1,0,0]
    v_pk_fma_f32 v[132:133], v[212:213], s[52:53], v[150:151] op_sel_hi:[1,0,0]
    v_pk_fma_f32 v[246:247], v[214:215], s[48:49], v[144:145] op_sel_hi:[1,0,0]
    v_pk_fma_f32 v[134:135], v[214:215], s[52:53], v[150:151] op_sel_hi:[1,0,0]
    v_pk_fma_f32 v[248:249], v[216:217], s[48:49], v[144:145] op_sel_hi:[1,0,0]
    v_pk_fma_f32 v[136:137], v[216:217], s[52:53], v[150:151] op_sel_hi:[1,0,0]
    v_pk_fma_f32 v[250:251], v[218:219], s[48:49], v[144:145] op_sel_hi:[1,0,0]
    v_pk_fma_f32 v[138:139], v[218:219], s[52:53], v[150:151] op_sel_hi:[1,0,0]
    v_pk_fma_f32 v[252:253], v[220:221], s[48:49], v[144:145] op_sel_hi:[1,0,0]
    v_pk_fma_f32 v[140:141], v[220:221], s[52:53], v[150:151] op_sel_hi:[1,0,0]
    v_pk_fma_f32 v[254:255], v[222:223], s[48:49], v[144:145] op_sel_hi:[1,0,0]
    v_pk_fma_f32 v[142:143], v[222:223], s[52:53], v[150:151] op_sel_hi:[1,0,0]
    v_exp_f32 v240, v240
    v_exp_f32 v128, v128
    v_exp_f32 v241, v241
    v_exp_f32 v129, v129
    v_exp_f32 v242, v242
    v_exp_f32 v130, v130
    v_exp_f32 v243, v243
    v_exp_f32 v131, v131
    v_exp_f32 v244, v244
    v_exp_f32 v132, v132
    v_exp_f32 v245, v245
    v_exp_f32 v133, v133
    v_exp_f32 v246, v246
    v_exp_f32 v134, v134
    v_exp_f32 v247, v247
    v_exp_f32 v135, v135
    v_exp_f32 v248, v248
    v_exp_f32 v136, v136
    v_exp_f32 v249, v249
    v_exp_f32 v137, v137
    v_exp_f32 v250, v250
    v_exp_f32 v138, v138
    v_exp_f32 v251, v251
    v_exp_f32 v139, v139
    v_exp_f32 v252, v252
    v_exp_f32 v140, v140
    v_exp_f32 v253, v253
    v_exp_f32 v141, v141
    v_exp_f32 v254, v254
    v_exp_f32 v142, v142
    v_exp_f32 v255, v255
    v_exp_f32 v143, v143
    v_pk_add_f32 v[144:145], v[240:241], v[242:243]
    v_pk_add_f32 v[146:147], v[244:245], v[246:247]
    v_pk_add_f32 v[148:149], v[248:249], v[250:251]
    v_pk_add_f32 v[150:151], v[128:129], v[130:131]
    v_pk_add_f32 v[152:153], v[132:133], v[134:135]
    v_pk_add_f32 v[154:155], v[136:137], v[138:139]
    v_pk_add_f32 v[144:145], v[144:145], v[252:253]
    v_pk_add_f32 v[146:147], v[146:147], v[254:255]
    v_pk_add_f32 v[150:151], v[150:151], v[140:141]
    v_pk_add_f32 v[152:153], v[152:153], v[142:143]
    v_pk_add_f32 v[144:145], v[144:145], v[148:149]
    v_pk_add_f32 v[150:151], v[150:151], v[154:155]
    v_pk_add_f32 v[144:145], v[144:145], v[146:147]
    v_pk_add_f32 v[150:151], v[150:151], v[152:153]
    v_add_f32 v144, v144, v145
    v_add_f32 v150, v150, v151
    v_mov_b32 v145, v144
    v_mov_b32 v151, v150
    s_nop 0
    v_permlane32_swap_b32 v144, v145
    v_permlane32_swap_b32 v150, v151
    v_add_f32 v144, v144, v145
    v_add_f32 v150, v150, v151
    v_rcp_f32 v144, v144
    v_rcp_f32 v150, v150
    v_pk_mul_f32 v[240:241], v[240:241], v[144:145] op_sel_hi:[1,0]
    v_pk_mul_f32 v[128:129], v[128:129], v[150:151] op_sel_hi:[1,0]
    v_pk_mul_f32 v[242:243], v[242:243], v[144:145] op_sel_hi:[1,0]
    v_pk_mul_f32 v[130:131], v[130:131], v[150:151] op_sel_hi:[1,0]
    v_pk_mul_f32 v[244:245], v[244:245], v[144:145] op_sel_hi:[1,0]
    v_pk_mul_f32 v[132:133], v[132:133], v[150:151] op_sel_hi:[1,0]
    v_pk_mul_f32 v[246:247], v[246:247], v[144:145] op_sel_hi:[1,0]
    v_pk_mul_f32 v[134:135], v[134:135], v[150:151] op_sel_hi:[1,0]
    v_pk_mul_f32 v[248:249], v[248:249], v[144:145] op_sel_hi:[1,0]
    v_pk_mul_f32 v[136:137], v[136:137], v[150:151] op_sel_hi:[1,0]
    v_pk_mul_f32 v[250:251], v[250:251], v[144:145] op_sel_hi:[1,0]
    v_pk_mul_f32 v[138:139], v[138:139], v[150:151] op_sel_hi:[1,0]
    v_pk_mul_f32 v[252:253], v[252:253], v[144:145] op_sel_hi:[1,0]
    v_pk_mul_f32 v[140:141], v[140:141], v[150:151] op_sel_hi:[1,0]
    v_pk_mul_f32 v[254:255], v[254:255], v[144:145] op_sel_hi:[1,0]
    v_pk_mul_f32 v[142:143], v[142:143], v[150:151] op_sel_hi:[1,0]
    v_cvt_pk_bf16_f32 v72, v240, v241
    v_cvt_pk_bf16_f32 v104, v128, v129
    v_cvt_pk_bf16_f32 v73, v242, v243
    v_cvt_pk_bf16_f32 v105, v130, v131
    v_cvt_pk_bf16_f32 v74, v244, v245
    v_cvt_pk_bf16_f32 v106, v132, v133
    v_cvt_pk_bf16_f32 v75, v246, v247
    v_cvt_pk_bf16_f32 v107, v134, v135
    v_cvt_pk_bf16_f32 v76, v248, v249
    v_cvt_pk_bf16_f32 v108, v136, v137
    v_cvt_pk_bf16_f32 v77, v250, v251
    v_cvt_pk_bf16_f32 v109, v138, v139
    v_cvt_pk_bf16_f32 v78, v252, v253
    v_cvt_pk_bf16_f32 v110, v140, v141
    v_cvt_pk_bf16_f32 v79, v254, v255
    v_cvt_pk_bf16_f32 v111, v142, v143
    v_mfma_f32_32x32x16_bf16 v[208:223], v[72:75], v[48:51], 0
    v_mfma_f32_32x32x16_bf16 v[208:223], v[76:79], v[52:55], v[208:223]
    v_mfma_f32_32x32x16_bf16 v[240:255], v[104:107], v[48:51], 0
    v_mfma_f32_32x32x16_bf16 v[240:255], v[108:111], v[52:55], v[240:255]
    v_cvt_pk_bf16_f32 v64, v192, v193
    v_cvt_pk_bf16_f32 v65, v194, v195
    v_cvt_pk_bf16_f32 v66, v196, v197
    v_cvt_pk_bf16_f32 v67, v198, v199
    v_cvt_pk_bf16_f32 v68, v200, v201
    v_cvt_pk_bf16_f32 v69, v202, v203
    v_cvt_pk_bf16_f32 v70, v204, v205
    v_cvt_pk_bf16_f32 v71, v206, v207
    v_cvt_pk_bf16_f32 v96, v224, v225
    v_cvt_pk_bf16_f32 v97, v226, v227
    v_cvt_pk_bf16_f32 v98, v228, v229
    v_cvt_pk_bf16_f32 v99, v230, v231
    v_cvt_pk_bf16_f32 v100, v232, v233
    v_cvt_pk_bf16_f32 v101, v234, v235
    v_cvt_pk_bf16_f32 v102, v236, v237
    v_cvt_pk_bf16_f32 v103, v238, v239
    v_mfma_f32_32x32x16_bf16 v[112:127], v[64:67], v[80:83], 0
    v_mfma_f32_32x32x16_bf16 v[112:127], v[68:71], v[84:87], v[112:127]
    v_mfma_f32_32x32x16_bf16 v[128:143], v[96:99], v[80:83], 0
    v_mfma_f32_32x32x16_bf16 v[128:143], v[100:103], v[84:87], v[128:143]
    v_mfma_f32_32x32x16_bf16 v[144:159], v[64:67], v[56:59], 0
    v_mfma_f32_32x32x16_bf16 v[144:159], v[68:71], v[56:59], v[144:159]
    v_mfma_f32_32x32x16_bf16 v[144:159], v[96:99], v[60:63], v[144:159]
    v_mfma_f32_32x32x16_bf16 v[144:159], v[100:103], v[60:63], v[144:159]
    v_cvt_pk_bf16_f32 v72, v208, v209
    v_cvt_pk_bf16_f32 v73, v210, v211
    v_cvt_pk_bf16_f32 v74, v212, v213
    v_cvt_pk_bf16_f32 v75, v214, v215
    v_cvt_pk_bf16_f32 v76, v216, v217
    v_cvt_pk_bf16_f32 v77, v218, v219
    v_cvt_pk_bf16_f32 v78, v220, v221
    v_cvt_pk_bf16_f32 v79, v222, v223
    v_cvt_pk_bf16_f32 v104, v240, v241
    v_cvt_pk_bf16_f32 v105, v242, v243
    v_cvt_pk_bf16_f32 v106, v244, v245
    v_cvt_pk_bf16_f32 v107, v246, v247
    v_cvt_pk_bf16_f32 v108, v248, v249
    v_cvt_pk_bf16_f32 v109, v250, v251
    v_cvt_pk_bf16_f32 v110, v252, v253
    v_cvt_pk_bf16_f32 v111, v254, v255
    v_mfma_f32_32x32x16_bf16 v[112:127], v[72:75], v[88:91], v[112:127]
    v_mfma_f32_32x32x16_bf16 v[112:127], v[76:79], v[92:95], v[112:127]
    v_mfma_f32_32x32x16_bf16 v[128:143], v[104:107], v[88:91], v[128:143]
    v_mfma_f32_32x32x16_bf16 v[128:143], v[108:111], v[92:95], v[128:143]
    v_mfma_f32_32x32x16_bf16 v[144:159], v[72:75], v[56:59], v[144:159]
    v_mfma_f32_32x32x16_bf16 v[144:159], v[76:79], v[56:59], v[144:159]
    v_mfma_f32_32x32x16_bf16 v[144:159], v[104:107], v[60:63], v[144:159]
    v_mfma_f32_32x32x16_bf16 v[144:159], v[108:111], v[60:63], v[144:159]
    s_cmp_eq_u32 s21, 0
    s_cbranch_scc0 L_c_rw1
    s_nop 5
    ds_write_b128 v8, v[128:131] offset:0
    ds_write_b128 v8, v[132:135] offset:1024
    ds_write_b128 v8, v[136:139] offset:2048
    ds_write_b128 v8, v[140:143] offset:3072
    s_mov_b32 exec_lo, s45
    s_mov_b32 exec_hi, s45
    ds_write_b128 v10, v[144:147] offset:4096
    ds_write_b128 v10, v[148:151] offset:4128
    ds_write_b128 v10, v[152:155] offset:4160
    ds_write_b128 v10, v[156:159] offset:4192
    ds_write_b32 v13, v15
    s_mov_b64 exec, -1
    s_mov_b32 s13, 0
L_c_x0:
    ds_read_b32 v16, v14
    ds_read_b128 v[192:195], v9 offset:0
    ds_read_b128 v[196:199], v9 offset:1024
    ds_read_b128 v[200:203], v9 offset:2048
    ds_read_b128 v[204:207], v9 offset:3072
    ds_read_b128 v[208:211], v11 offset:4096
    ds_read_b128 v[212:215], v11 offset:4128
    ds_read_b128 v[216:219], v11 offset:4160
    ds_read_b128 v[220:223], v11 offset:4192
    s_add_u32 s13, s13, 1
    s_cmp_ge_u32 s13, 262144
    s_cbranch_scc1 L_c_y0
    s_waitcnt lgkmcnt(8)
    v_cmp_eq_u32 vcc, 1, v16
    s_cbranch_vccz L_c_x0
L_c_y0:
    s_waitcnt lgkmcnt(4)
    v_pk_add_f32 v[112:113], v[112:113], v[192:193]
    v_pk_add_f32 v[114:115], v[114:115], v[194:195]
    v_pk_add_f32 v[116:117], v[116:117], v[196:197]
    v_pk_add_f32 v[118:119], v[118:119], v[198:199]
    v_pk_add_f32 v[120:121], v[120:121], v[200:201]
    v_pk_add_f32 v[122:123], v[122:123], v[202:203]
    v_pk_add_f32 v[124:125], v[124:125], v[204:205]
    v_pk_add_f32 v[126:127], v[126:127], v[206:207]
    v_and_or_b32 v112, v112, v28, v27
    buffer_store_dwordx4 v[112:115], v6, s[32:35], s40 offen offset:0 sc1
    v_and_or_b32 v116, v116, v28, v27
    buffer_store_dwordx4 v[116:119], v6, s[32:35], s40 offen offset:512 sc1
    v_and_or_b32 v120, v120, v28, v27
    buffer_store_dwordx4 v[120:123], v6, s[32:35], s41 offen offset:0 sc1
    v_and_or_b32 v124, v124, v28, v27
    buffer_store_dwordx4 v[124:127], v6, s[32:35], s41 offen offset:512 sc1
    s_branch L_c_zs
L_c_rw1:
    s_nop 7
    ds_write_b128 v8, v[112:115] offset:0
    ds_write_b128 v8, v[116:119] offset:1024
    ds_write_b128 v8, v[120:123] offset:2048
    ds_write_b128 v8, v[124:127] offset:3072
    s_mov_b32 exec_lo, s45
    s_mov_b32 exec_hi, s45
    ds_write_b128 v10, v[144:147] offset:4096
    ds_write_b128 v10, v[148:151] offset:4128
    ds_write_b128 v10, v[152:155] offset:4160
    ds_write_b128 v10, v[156:159] offset:4192
    ds_write_b32 v13, v15
    s_mov_b64 exec, -1
    s_mov_b32 s13, 0
L_c_x1:
    ds_read_b32 v16, v14
    ds_read_b128 v[192:195], v9 offset:0
    ds_read_b128 v[196:199], v9 offset:1024
    ds_read_b128 v[200:203], v9 offset:2048
    ds_read_b128 v[204:207], v9 offset:3072
    ds_read_b128 v[208:211], v11 offset:4096
    ds_read_b128 v[212:215], v11 offset:4128
    ds_read_b128 v[216:219], v11 offset:4160
    ds_read_b128 v[220:223], v11 offset:4192
    s_add_u32 s13, s13, 1
    s_cmp_ge_u32 s13, 262144
    s_cbranch_scc1 L_c_y1
    s_waitcnt lgkmcnt(8)
    v_cmp_eq_u32 vcc, 1, v16
    s_cbranch_vccz L_c_x1
L_c_y1:
    s_waitcnt lgkmcnt(4)
    v_pk_add_f32 v[128:129], v[128:129], v[192:193]
    v_pk_add_f32 v[130:131], v[130:131], v[194:195]
    v_pk_add_f32 v[132:133], v[132:133], v[196:197]
    v_pk_add_f32 v[134:135], v[134:135], v[198:199]
    v_pk_add_f32 v[136:137], v[136:137], v[200:201]
    v_pk_add_f32 v[138:139], v[138:139], v[202:203]
    v_pk_add_f32 v[140:141], v[140:141], v[204:205]
    v_pk_add_f32 v[142:143], v[142:143], v[206:207]
    v_and_or_b32 v128, v128, v28, v27
    buffer_store_dwordx4 v[128:131], v6, s[32:35], s40 offen offset:0 sc1
    v_and_or_b32 v132, v132, v28, v27
    buffer_store_dwordx4 v[132:135], v6, s[32:35], s40 offen offset:512 sc1
    v_and_or_b32 v136, v136, v28, v27
    buffer_store_dwordx4 v[136:139], v6, s[32:35], s41 offen offset:0 sc1
    v_and_or_b32 v140, v140, v28, v27
    buffer_store_dwordx4 v[140:143], v6, s[32:35], s41 offen offset:512 sc1
L_c_zs:
    s_waitcnt lgkmcnt(0)
    v_pk_add_f32 v[144:145], v[144:145], v[208:209]
    v_pk_add_f32 v[146:147], v[146:147], v[210:211]
    v_pk_add_f32 v[148:149], v[148:149], v[212:213]
    v_pk_add_f32 v[150:151], v[150:151], v[214:215]
    v_pk_add_f32 v[152:153], v[152:153], v[216:217]
    v_pk_add_f32 v[154:155], v[154:155], v[218:219]
    v_pk_add_f32 v[156:157], v[156:157], v[220:221]
    v_pk_add_f32 v[158:159], v[158:159], v[222:223]
    v_and_or_b32 v144, v144, v28, s76
    v_and_or_b32 v145, v145, v28, s77
    v_and_or_b32 v146, v146, v28, s78
    v_and_or_b32 v147, v147, v28, s79
    v_and_or_b32 v148, v148, v28, s76
    v_and_or_b32 v149, v149, v28, s77
    v_and_or_b32 v150, v150, v28, s78
    v_and_or_b32 v151, v151, v28, s79
    v_and_or_b32 v152, v152, v28, s76
    v_and_or_b32 v153, v153, v28, s77
    v_and_or_b32 v154, v154, v28, s78
    v_and_or_b32 v155, v155, v28, s79
    v_and_or_b32 v156, v156, v28, s76
    v_and_or_b32 v157, v157, v28, s77
    v_and_or_b32 v158, v158, v28, s78
    v_and_or_b32 v159, v159, v28, s79
    s_mov_b32 exec_lo, s44
    s_mov_b32 exec_hi, s44
    buffer_store_dwordx4 v[144:147], v7, s[32:35], s42 offen offset:0 sc1
    buffer_store_dwordx4 v[148:151], v7, s[32:35], s42 offen offset:16 sc1
    buffer_store_dwordx4 v[152:155], v7, s[32:35], s43 offen offset:0 sc1
    buffer_store_dwordx4 v[156:159], v7, s[32:35], s43 offen offset:16 sc1
    s_mov_b64 exec, -1
    v_cvt_pk_bf16_f32 v64, v160, v161
    v_cvt_pk_bf16_f32 v65, v162, v163
    v_cvt_pk_bf16_f32 v66, v164, v165
    v_cvt_pk_bf16_f32 v67, v166, v167
    v_cvt_pk_bf16_f32 v68, v168, v169
    v_cvt_pk_bf16_f32 v69, v170, v171
    v_cvt_pk_bf16_f32 v70, v172, v173
    v_cvt_pk_bf16_f32 v71, v174, v175
    v_mfma_f32_32x32x16_bf16 v[160:175], v[40:43], v[64:67], 0
    s_nop 0
    v_mfma_f32_32x32x16_bf16 v[160:175], v[44:47], v[68:71], v[160:175]
    v_cvt_pk_bf16_f32 v72, v176, v177
    v_cvt_pk_bf16_f32 v73, v178, v179
    v_cvt_pk_bf16_f32 v74, v180, v181
    v_cvt_pk_bf16_f32 v75, v182, v183
    v_cvt_pk_bf16_f32 v76, v184, v185
    v_cvt_pk_bf16_f32 v77, v186, v187
    v_cvt_pk_bf16_f32 v78, v188, v189
    v_cvt_pk_bf16_f32 v79, v190, v191
    v_mfma_f32_32x32x16_bf16 v[176:191], v[40:43], v[72:75], 0
    s_nop 0
    v_mfma_f32_32x32x16_bf16 v[176:191], v[44:47], v[76:79], v[176:191]
    s_nop 0
    v_cvt_pk_bf16_f32 v64, v160, v161
    v_cvt_pk_bf16_f32 v65, v162, v163
    v_cvt_pk_bf16_f32 v66, v164, v165
    v_cvt_pk_bf16_f32 v67, v166, v167
    v_cvt_pk_bf16_f32 v68, v168, v169
    v_cvt_pk_bf16_f32 v69, v170, v171
    v_cvt_pk_bf16_f32 v70, v172, v173
    v_cvt_pk_bf16_f32 v71, v174, v175
    v_lshlrev_b32 v160, 16, v64
    v_and_b32 v161, 0xffff0000, v64
    v_lshlrev_b32 v162, 16, v65
    v_and_b32 v163, 0xffff0000, v65
    v_lshlrev_b32 v164, 16, v66
    v_and_b32 v165, 0xffff0000, v66
    v_lshlrev_b32 v166, 16, v67
    v_and_b32 v167, 0xffff0000, v67
    v_lshlrev_b32 v168, 16, v68
    v_and_b32 v169, 0xffff0000, v68
    v_lshlrev_b32 v170, 16, v69
    v_and_b32 v171, 0xffff0000, v69
    v_lshlrev_b32 v172, 16, v70
    v_and_b32 v173, 0xffff0000, v70
    v_lshlrev_b32 v174, 16, v71
    v_and_b32 v175, 0xffff0000, v71
    v_cvt_pk_bf16_f32 v72, v176, v177
    v_cvt_pk_bf16_f32 v73, v178, v179
    v_cvt_pk_bf16_f32 v74, v180, v181
    v_cvt_pk_bf16_f32 v75, v182, v183
    v_cvt_pk_bf16_f32 v76, v184, v185
    v_cvt_pk_bf16_f32 v77, v186, v187
    v_cvt_pk_bf16_f32 v78, v188, v189
    v_cvt_pk_bf16_f32 v79, v190, v191
    v_lshlrev_b32 v176, 16, v72
    v_and_b32 v177, 0xffff0000, v72
    v_lshlrev_b32 v178, 16, v73
    v_and_b32 v179, 0xffff0000, v73
    v_lshlrev_b32 v180, 16, v74
    v_and_b32 v181, 0xffff0000, v74
    v_lshlrev_b32 v182, 16, v75
    v_and_b32 v183, 0xffff0000, v75
    v_lshlrev_b32 v184, 16, v76
    v_and_b32 v185, 0xffff0000, v76
    v_lshlrev_b32 v186, 16, v77
    v_and_b32 v187, 0xffff0000, v77
    v_lshlrev_b32 v188, 16, v78
    v_and_b32 v189, 0xffff0000, v78
    v_lshlrev_b32 v190, 16, v79
    v_and_b32 v191, 0xffff0000, v79
    v_max3_f32 v24, v160, v161, v162
    v_max3_f32 v25, v163, v164, v165
    v_max3_f32 v26, v166, v167, v168
    v_max3_f32 v27, v169, v170, v171
    v_max3_f32 v28, v172, v173, v174
    v_max3_f32 v24, v24, v25, v175
    v_max3_f32 v26, v26, v27, v28
    v_max_f32 v24, v24, v26
    v_min3_f32 v30, v160, v161, v162
    v_min3_f32 v31, v163, v164, v165
    v_min3_f32 v32, v166, v167, v168
    v_min3_f32 v33, v169, v170, v171
    v_min3_f32 v34, v172, v173, v174
    v_min3_f32 v30, v30, v31, v175
    v_min3_f32 v32, v32, v33, v34
    v_min_f32 v30, v30, v32
    v_mov_b32 v25, v24
    v_mov_b32 v31, v30
    s_nop 0
    v_permlane32_swap_b32 v24, v25
    v_permlane32_swap_b32 v30, v31
    v_max_f32 v24, v24, v25
    v_min_f32 v30, v30, v31
    v_mul_f32 v24, s52, v24
    v_mul_f32 v30, s48, v30
    v_pk_fma_f32 v[192:193], v[160:161], s[48:49], v[24:25] op_sel_hi:[1,0,0]
    v_pk_fma_f32 v[224:225], v[160:161], s[52:53], v[30:31] op_sel_hi:[1,0,0]
    v_pk_fma_f32 v[194:195], v[162:163], s[48:49], v[24:25] op_sel_hi:[1,0,0]
    v_pk_fma_f32 v[226:227], v[162:163], s[52:53], v[30:31] op_sel_hi:[1,0,0]
    v_pk_fma_f32 v[196:197], v[164:165], s[48:49], v[24:25] op_sel_hi:[1,0,0]
    v_pk_fma_f32 v[228:229], v[164:165], s[52:53], v[30:31] op_sel_hi:[1,0,0]
    v_pk_fma_f32 v[198:199], v[166:167], s[48:49], v[24:25] op_sel_hi:[1,0,0]
    v_pk_fma_f32 v[230:231], v[166:167], s[52:53], v[30:31] op_sel_hi:[1,0,0]
    v_pk_fma_f32 v[200:201], v[168:169], s[48:49], v[24:25] op_sel_hi:[1,0,0]
    v_pk_fma_f32 v[232:233], v[168:169], s[52:53], v[30:31] op_sel_hi:[1,0,0]
    v_pk_fma_f32 v[202:203], v[170:171], s[48:49], v[24:25] op_sel_hi:[1,0,0]
    v_pk_fma_f32 v[234:235], v[170:171], s[52:53], v[30:31] op_sel_hi:[1,0,0]
    v_pk_fma_f32 v[204:205], v[172:173], s[48:49], v[24:25] op_sel_hi:[1,0,0]
    v_pk_fma_f32 v[236:237], v[172:173], s[52:53], v[30:31] op_sel_hi:[1,0,0]
    v_pk_fma_f32 v[206:207], v[174:175], s[48:49], v[24:25] op_sel_hi:[1,0,0]
    v_pk_fma_f32 v[238:239], v[174:175], s[52:53], v[30:31] op_sel_hi:[1,0,0]
    v_exp_f32 v192, v192
    v_exp_f32 v224, v224
    v_exp_f32 v193, v193
    v_exp_f32 v225, v225
    v_exp_f32 v194, v194
    v_exp_f32 v226, v226
    v_exp_f32 v195, v195
    v_exp_f32 v227, v227
    v_exp_f32 v196, v196
    v_exp_f32 v228, v228
    v_exp_f32 v197, v197
    v_exp_f32 v229, v229
    v_exp_f32 v198, v198
    v_exp_f32 v230, v230
    v_exp_f32 v199, v199
    v_exp_f32 v231, v231
    v_exp_f32 v200, v200
    v_exp_f32 v232, v232
    v_exp_f32 v201, v201
    v_exp_f32 v233, v233
    v_exp_f32 v202, v202
    v_exp_f32 v234, v234
    v_exp_f32 v203, v203
    v_exp_f32 v235, v235
    v_exp_f32 v204, v204
    v_exp_f32 v236, v236
    v_exp_f32 v205, v205
    v_exp_f32 v237, v237
    v_exp_f32 v206, v206
    v_exp_f32 v238, v238
    v_exp_f32 v207, v207
    v_exp_f32 v239, v239
    v_pk_add_f32 v[24:25], v[192:193], v[194:195]
    v_pk_add_f32 v[26:27], v[196:197], v[198:199]
    v_pk_add_f32 v[28:29], v[200:201], v[202:203]
    v_pk_add_f32 v[30:31], v[224:225], v[226:227]
    v_pk_add_f32 v[32:33], v[228:229], v[230:231]
    v_pk_add_f32 v[34:35], v[232:233], v[234:235]
    v_pk_add_f32 v[24:25], v[24:25], v[204:205]
    v_pk_add_f32 v[26:27], v[26:27], v[206:207]
    v_pk_add_f32 v[30:31], v[30:31], v[236:237]
    v_pk_add_f32 v[32:33], v[32:33], v[238:239]
    v_pk_add_f32 v[24:25], v[24:25], v[28:29]
    v_pk_add_f32 v[30:31], v[30:31], v[34:35]
    v_pk_add_f32 v[24:25], v[24:25], v[26:27]
    v_pk_add_f32 v[30:31], v[30:31], v[32:33]
    v_add_f32 v24, v24, v25
    v_add_f32 v30, v30, v31
    v_mov_b32 v25, v24
    v_mov_b32 v31, v30
    s_nop 0
    v_permlane32_swap_b32 v24, v25
    v_permlane32_swap_b32 v30, v31
    v_add_f32 v24, v24, v25
    v_add_f32 v30, v30, v31
    v_rcp_f32 v24, v24
    v_rcp_f32 v30, v30
    v_pk_mul_f32 v[192:193], v[192:193], v[24:25] op_sel_hi:[1,0]
    v_pk_mul_f32 v[224:225], v[224:225], v[30:31] op_sel_hi:[1,0]
    v_pk_mul_f32 v[194:195], v[194:195], v[24:25] op_sel_hi:[1,0]
    v_pk_mul_f32 v[226:227], v[226:227], v[30:31] op_sel_hi:[1,0]
    v_pk_mul_f32 v[196:197], v[196:197], v[24:25] op_sel_hi:[1,0]
    v_pk_mul_f32 v[228:229], v[228:229], v[30:31] op_sel_hi:[1,0]
    v_pk_mul_f32 v[198:199], v[198:199], v[24:25] op_sel_hi:[1,0]
    v_pk_mul_f32 v[230:231], v[230:231], v[30:31] op_sel_hi:[1,0]
    v_pk_mul_f32 v[200:201], v[200:201], v[24:25] op_sel_hi:[1,0]
    v_pk_mul_f32 v[232:233], v[232:233], v[30:31] op_sel_hi:[1,0]
    v_pk_mul_f32 v[202:203], v[202:203], v[24:25] op_sel_hi:[1,0]
    v_pk_mul_f32 v[234:235], v[234:235], v[30:31] op_sel_hi:[1,0]
    v_pk_mul_f32 v[204:205], v[204:205], v[24:25] op_sel_hi:[1,0]
    v_pk_mul_f32 v[236:237], v[236:237], v[30:31] op_sel_hi:[1,0]
    v_pk_mul_f32 v[206:207], v[206:207], v[24:25] op_sel_hi:[1,0]
    v_pk_mul_f32 v[238:239], v[238:239], v[30:31] op_sel_hi:[1,0]
    v_cvt_pk_bf16_f32 v80, v192, v193
    v_cvt_pk_bf16_f32 v88, v224, v225
    v_cvt_pk_bf16_f32 v81, v194, v195
    v_cvt_pk_bf16_f32 v89, v226, v227
    v_cvt_pk_bf16_f32 v82, v196, v197
    v_cvt_pk_bf16_f32 v90, v228, v229
    v_cvt_pk_bf16_f32 v83, v198, v199
    v_cvt_pk_bf16_f32 v91, v230, v231
    v_cvt_pk_bf16_f32 v84, v200, v201
    v_cvt_pk_bf16_f32 v92, v232, v233
    v_cvt_pk_bf16_f32 v85, v202, v203
    v_cvt_pk_bf16_f32 v93, v234, v235
    v_cvt_pk_bf16_f32 v86, v204, v205
    v_cvt_pk_bf16_f32 v94, v236, v237
    v_cvt_pk_bf16_f32 v87, v206, v207
    v_cvt_pk_bf16_f32 v95, v238, v239
    v_max3_f32 v24, v176, v177, v178
    v_max3_f32 v25, v179, v180, v181
    v_max3_f32 v26, v182, v183, v184
    v_max3_f32 v27, v185, v186, v187
    v_max3_f32 v28, v188, v189, v190
    v_max3_f32 v24, v24, v25, v191
    v_max3_f32 v26, v26, v27, v28
    v_max_f32 v24, v24, v26
    v_min3_f32 v30, v176, v177, v178
    v_min3_f32 v31, v179, v180, v181
    v_min3_f32 v32, v182, v183, v184
    v_min3_f32 v33, v185, v186, v187
    v_min3_f32 v34, v188, v189, v190
    v_min3_f32 v30, v30, v31, v191
    v_min3_f32 v32, v32, v33, v34
    v_min_f32 v30, v30, v32
    v_mov_b32 v25, v24
    v_mov_b32 v31, v30
    s_nop 0
    v_permlane32_swap_b32 v24, v25
    v_permlane32_swap_b32 v30, v31
    v_max_f32 v24, v24, v25
    v_min_f32 v30, v30, v31
    v_mul_f32 v24, s52, v24
    v_mul_f32 v30, s48, v30
    v_pk_fma_f32 v[208:209], v[176:177], s[48:49], v[24:25] op_sel_hi:[1,0,0]
    v_pk_fma_f32 v[240:241], v[176:177], s[52:53], v[30:31] op_sel_hi:[1,0,0]
    v_pk_fma_f32 v[210:211], v[178:179], s[48:49], v[24:25] op_sel_hi:[1,0,0]
    v_pk_fma_f32 v[242:243], v[178:179], s[52:53], v[30:31] op_sel_hi:[1,0,0]
    v_pk_fma_f32 v[212:213], v[180:181], s[48:49], v[24:25] op_sel_hi:[1,0,0]
    v_pk_fma_f32 v[244:245], v[180:181], s[52:53], v[30:31] op_sel_hi:[1,0,0]
    v_pk_fma_f32 v[214:215], v[182:183], s[48:49], v[24:25] op_sel_hi:[1,0,0]
    v_pk_fma_f32 v[246:247], v[182:183], s[52:53], v[30:31] op_sel_hi:[1,0,0]
    v_pk_fma_f32 v[216:217], v[184:185], s[48:49], v[24:25] op_sel_hi:[1,0,0]
    v_pk_fma_f32 v[248:249], v[184:185], s[52:53], v[30:31] op_sel_hi:[1,0,0]
    v_pk_fma_f32 v[218:219], v[186:187], s[48:49], v[24:25] op_sel_hi:[1,0,0]
    v_pk_fma_f32 v[250:251], v[186:187], s[52:53], v[30:31] op_sel_hi:[1,0,0]
    v_pk_fma_f32 v[220:221], v[188:189], s[48:49], v[24:25] op_sel_hi:[1,0,0]
    v_pk_fma_f32 v[252:253], v[188:189], s[52:53], v[30:31] op_sel_hi:[1,0,0]
    v_pk_fma_f32 v[222:223], v[190:191], s[48:49], v[24:25] op_sel_hi:[1,0,0]
    v_pk_fma_f32 v[254:255], v[190:191], s[52:53], v[30:31] op_sel_hi:[1,0,0]
    v_exp_f32 v208, v208
    v_exp_f32 v240, v240
    v_exp_f32 v209, v209
    v_exp_f32 v241, v241
    v_exp_f32 v210, v210
    v_exp_f32 v242, v242
    v_exp_f32 v211, v211
    v_exp_f32 v243, v243
    v_exp_f32 v212, v212
    v_exp_f32 v244, v244
    v_exp_f32 v213, v213
    v_exp_f32 v245, v245
    v_exp_f32 v214, v214
    v_exp_f32 v246, v246
    v_exp_f32 v215, v215
    v_exp_f32 v247, v247
    v_exp_f32 v216, v216
    v_exp_f32 v248, v248
    v_exp_f32 v217, v217
    v_exp_f32 v249, v249
    v_exp_f32 v218, v218
    v_exp_f32 v250, v250
    v_exp_f32 v219, v219
    v_exp_f32 v251, v251
    v_exp_f32 v220, v220
    v_exp_f32 v252, v252
    v_exp_f32 v221, v221
    v_exp_f32 v253, v253
    v_exp_f32 v222, v222
    v_exp_f32 v254, v254
    v_exp_f32 v223, v223
    v_exp_f32 v255, v255
    v_pk_add_f32 v[24:25], v[208:209], v[210:211]
    v_pk_add_f32 v[26:27], v[212:213], v[214:215]
    v_pk_add_f32 v[28:29], v[216:217], v[218:219]
    v_pk_add_f32 v[30:31], v[240:241], v[242:243]
    v_pk_add_f32 v[32:33], v[244:245], v[246:247]
    v_pk_add_f32 v[34:35], v[248:249], v[250:251]
    v_pk_add_f32 v[24:25], v[24:25], v[220:221]
    v_pk_add_f32 v[26:27], v[26:27], v[222:223]
    v_pk_add_f32 v[30:31], v[30:31], v[252:253]
    v_pk_add_f32 v[32:33], v[32:33], v[254:255]
    v_pk_add_f32 v[24:25], v[24:25], v[28:29]
    v_pk_add_f32 v[30:31], v[30:31], v[34:35]
    v_pk_add_f32 v[24:25], v[24:25], v[26:27]
    v_pk_add_f32 v[30:31], v[30:31], v[32:33]
    v_add_f32 v24, v24, v25
    v_add_f32 v30, v30, v31
    v_mov_b32 v25, v24
    v_mov_b32 v31, v30
    s_nop 0
    v_permlane32_swap_b32 v24, v25
    v_permlane32_swap_b32 v30, v31
    v_add_f32 v24, v24, v25
    v_add_f32 v30, v30, v31
    v_rcp_f32 v24, v24
    v_rcp_f32 v30, v30
    v_pk_mul_f32 v[208:209], v[208:209], v[24:25] op_sel_hi:[1,0]
    v_pk_mul_f32 v[240:241], v[240:241], v[30:31] op_sel_hi:[1,0]
    v_pk_mul_f32 v[210:211], v[210:211], v[24:25] op_sel_hi:[1,0]
    v_pk_mul_f32 v[242:243], v[242:243], v[30:31] op_sel_hi:[1,0]
    v_pk_mul_f32 v[212:213], v[212:213], v[24:25] op_sel_hi:[1,0]
    v_pk_mul_f32 v[244:245], v[244:245], v[30:31] op_sel_hi:[1,0]
    v_pk_mul_f32 v[214:215], v[214:215], v[24:25] op_sel_hi:[1,0]
    v_pk_mul_f32 v[246:247], v[246:247], v[30:31] op_sel_hi:[1,0]
    v_pk_mul_f32 v[216:217], v[216:217], v[24:25] op_sel_hi:[1,0]
    v_pk_mul_f32 v[248:249], v[248:249], v[30:31] op_sel_hi:[1,0]
    v_pk_mul_f32 v[218:219], v[218:219], v[24:25] op_sel_hi:[1,0]
    v_pk_mul_f32 v[250:251], v[250:251], v[30:31] op_sel_hi:[1,0]
    v_pk_mul_f32 v[220:221], v[220:221], v[24:25] op_sel_hi:[1,0]
    v_pk_mul_f32 v[252:253], v[252:253], v[30:31] op_sel_hi:[1,0]
    v_pk_mul_f32 v[222:223], v[222:223], v[24:25] op_sel_hi:[1,0]
    v_pk_mul_f32 v[254:255], v[254:255], v[30:31] op_sel_hi:[1,0]
    v_cvt_pk_bf16_f32 v96, v208, v209
    v_cvt_pk_bf16_f32 v104, v240, v241
    v_cvt_pk_bf16_f32 v97, v210, v211
    v_cvt_pk_bf16_f32 v105, v242, v243
    v_cvt_pk_bf16_f32 v98, v212, v213
    v_cvt_pk_bf16_f32 v106, v244, v245
    v_cvt_pk_bf16_f32 v99, v214, v215
    v_cvt_pk_bf16_f32 v107, v246, v247
    v_cvt_pk_bf16_f32 v100, v216, v217
    v_cvt_pk_bf16_f32 v108, v248, v249
    v_cvt_pk_bf16_f32 v101, v218, v219
    v_cvt_pk_bf16_f32 v109, v250, v251
    v_cvt_pk_bf16_f32 v102, v220, v221
    v_cvt_pk_bf16_f32 v110, v252, v253
    v_cvt_pk_bf16_f32 v103, v222, v223
    v_cvt_pk_bf16_f32 v111, v254, v255
    s_lshl_b32 s12, s19, 1
    s_add_u32 s23, s12, s22
    s_lshl_b32 s12, s23, 12
    s_add_u32 s43, s12, 32768
    s_lshl_b32 s14, s23, 7
    s_add_u32 s46, s14, 163840
    v_lshlrev_b32 v52, 4, v3
    v_lshrrev_b32 v53, 2, v4
    v_lshlrev_b32 v53, 4, v53
    s_lshl_b32 s40, s18, 1
    s_add_u32 s40, s40, s21
    s_lshl_b32 s41, s40, 6
    s_add_u32 s41, s41, s23
    s_lshl_b32 s41, s41, 11
    s_add_u32 s41, s41, 8388608
    s_add_u32 s42, s41, 65536
    s_lshl_b32 s12, s18, 10
    s_lshl_b32 s40, s21, 5
    s_add_u32 s40, s40, s12
    s_add_u32 s40, s40, s23
    s_lshl_b32 s40, s40, 2
    s_add_u32 s40, s40, 524288
    s_sub_u32 s21, s72, 1
    s_mov_b32 s22, s73
    s_mov_b32 s23, s74
    s_and_b32 s88, s16, 1
    s_lshl_b32 s88, s88, 3
    s_lshr_b32 s89, s16, 1
    s_lshl_b32 s89, s89, 1
    s_add_u32 s88, s88, s89
    s_lshr_b32 s89, s17, 4
    s_add_u32 s88, s88, s89
    s_and_b32 s89, s17, 15
    s_mov_b32 s68, s58
    s_and_b32 s69, s59, 0xffff
    s_mov_b32 s70, 4194304
    s_mov_b32 s71, 0x00020000
    s_and_b32 s90, s20, 3
    s_lshr_b32 s91, s20, 2
    s_lshl_b32 s12, s88, 3
    s_lshl_b32 s13, s90, 1
    s_add_u32 s12, s12, s13
    s_add_u32 s92, s12, s91
    s_lshl_b32 s12, s92, 4
    v_and_b32 v3, 15, v2
    v_add_u32 v6, s12, v3
    v_lshlrev_b32 v8, 2, v6
    v_bfe_u32 v9, v2, 4, 1
    v_lshrrev_b32 v10, 5, v2
    v_lshlrev_b32 v7, 11, v6
    v_lshl_add_u32 v7, v9, 6, v7
    v_lshl_add_u32 v7, v10, 4, v7
    s_lshl_b32 s12, s89, 7
    v_add_u32 v7, s12, v7
    s_mov_b32 s12, 4096
    buffer_load_dwordx4 v[24:27], v7, s[24:27], 0 offen
    buffer_load_dwordx4 v[28:31], v7, s[24:27], 0 offen offset:32
    buffer_load_dword v48, v8, s[32:35], s12 offen sc1
    v_lshlrev_b32 v12, 8, v3
    v_lshl_add_u32 v12, v9, 7, v12
    v_lshl_add_u32 v12, v10, 5, v12
    v_lshlrev_b32 v10, 9, v10
    v_bfe_u32 v11, v2, 2, 2
    v_lshl_add_u32 v10, v11, 7, v10
    v_bfe_u32 v11, v2, 3, 1
    v_lshl_add_u32 v10, v11, 6, v10
    v_lshl_add_u32 v10, v9, 5, v10
    v_and_b32 v11, 3, v2
    v_lshl_add_u32 v10, v11, 3, v10
    v_xor_b32 v11, 64, v10
    s_lshl_b32 s12, s91, 8
    v_xor_b32 v17, s12, v5
    v_lshlrev_b32 v8, 2, v3
    s_lshl_b32 s12, s20, 12
    s_mov_b32 s15, 40960
    s_cmp_lt_u32 s20, 6
    s_cselect_b32 s13, s15, 131072
    s_add_u32 s12, s12, s13
    v_add_u32 v20, s12, v5
    s_xor_b32 s14, s20, 4
    s_lshl_b32 s12, s14, 12
    s_cmp_lt_u32 s14, 6
    s_cselect_b32 s13, s15, 131072
    s_add_u32 s12, s12, s13
    v_add_u32 v21, s12, v5
    s_lshl_b32 s12, s88, 2
    s_add_u32 s12, s12, s90
    s_lshl_b32 s13, s12, 16
    s_lshl_b32 s14, s91, 15
    s_add_u32 s13, s13, s14
    s_add_u32 s95, s13, 8388608
    s_lshl_b32 s12, s88, 12
    s_lshl_b32 s13, s89, 8
    s_mul_i32 s13, s13, 1
    s_add_u32 s12, s12, s13
    s_lshr_b32 s13, s90, 1
    s_lshl_b32 s13, s13, 7
    s_add_u32 s12, s12, s13
    s_lshl_b32 s13, s91, 6
    s_add_u32 s12, s12, s13
    s_add_u32 s15, s12, 524288
    s_lshl_b32 s97, s91, 4
    s_mov_b32 s93, s89
    s_waitcnt vmcnt(0)
    v_sub_f32 v50, 1.0, v48
    v_cvt_pk_bf16_f32 v50, v50, v50
    v_lshlrev_b32 v50, 16, v50
    v_lshlrev_b32 v32, 16, v24
    v_and_b32 v33, 0xffff0000, v24
    v_lshlrev_b32 v34, 16, v25
    v_and_b32 v35, 0xffff0000, v25
    v_lshlrev_b32 v36, 16, v26
    v_and_b32 v37, 0xffff0000, v26
    v_lshlrev_b32 v38, 16, v27
    v_and_b32 v39, 0xffff0000, v27
    v_lshlrev_b32 v40, 16, v28
    v_and_b32 v41, 0xffff0000, v28
    v_lshlrev_b32 v42, 16, v29
    v_and_b32 v43, 0xffff0000, v29
    v_lshlrev_b32 v44, 16, v30
    v_and_b32 v45, 0xffff0000, v30
    v_lshlrev_b32 v46, 16, v31
    v_and_b32 v47, 0xffff0000, v31
    v_pk_mul_f32 v[32:33], v[32:33], v[50:51] op_sel_hi:[1,0]
    v_pk_mul_f32 v[34:35], v[34:35], v[50:51] op_sel_hi:[1,0]
    v_pk_mul_f32 v[36:37], v[36:37], v[50:51] op_sel_hi:[1,0]
    v_pk_mul_f32 v[38:39], v[38:39], v[50:51] op_sel_hi:[1,0]
    v_pk_mul_f32 v[40:41], v[40:41], v[50:51] op_sel_hi:[1,0]
    v_pk_mul_f32 v[42:43], v[42:43], v[50:51] op_sel_hi:[1,0]
    v_pk_mul_f32 v[44:45], v[44:45], v[50:51] op_sel_hi:[1,0]
    v_pk_mul_f32 v[46:47], v[46:47], v[50:51] op_sel_hi:[1,0]
    v_cvt_pk_bf16_f32 v33, v32, v33
    v_cvt_pk_bf16_f32 v35, v34, v35
    v_cvt_pk_bf16_f32 v37, v36, v37
    v_cvt_pk_bf16_f32 v39, v38, v39
    v_cvt_pk_bf16_f32 v41, v40, v41
    v_cvt_pk_bf16_f32 v43, v42, v43
    v_cvt_pk_bf16_f32 v45, v44, v45
    v_cvt_pk_bf16_f32 v47, v46, v47
    v_lshlrev_b32 v32, 16, v33
    v_and_b32 v33, 0xffff0000, v33
    v_lshlrev_b32 v34, 16, v35
    v_and_b32 v35, 0xffff0000, v35
    v_lshlrev_b32 v36, 16, v37
    v_and_b32 v37, 0xffff0000, v37
    v_lshlrev_b32 v38, 16, v39
    v_and_b32 v39, 0xffff0000, v39
    v_lshlrev_b32 v40, 16, v41
    v_and_b32 v41, 0xffff0000, v41
    v_lshlrev_b32 v42, 16, v43
    v_and_b32 v43, 0xffff0000, v43
    v_lshlrev_b32 v44, 16, v45
    v_and_b32 v45, 0xffff0000, v45
    v_lshlrev_b32 v46, 16, v47
    v_and_b32 v47, 0xffff0000, v47
    s_mov_b32 s13, 0
    v_mov_b32 v54, 162896
L_c_kz:
    ds_read_b32 v55, v54
    s_add_u32 s13, s13, 1
    s_cmp_ge_u32 s13, 262144
    s_cbranch_scc1 L_c_kzok
    s_waitcnt lgkmcnt(0)
    v_cmp_eq_u32 vcc, 1, v55
    s_cbranch_vccz L_c_kz
L_c_kzok:
    s_mov_b32 s13, 0
L_c_kv:
    buffer_load_dwordx4 v[112:115], v5, s[32:35], s43 offen offset:0 sc1
    buffer_load_dwordx4 v[116:119], v5, s[32:35], s43 offen offset:1024 sc1
    buffer_load_dwordx4 v[120:123], v5, s[32:35], s43 offen offset:2048 sc1
    buffer_load_dwordx4 v[124:127], v5, s[32:35], s43 offen offset:3072 sc1
    buffer_load_dwordx4 v[128:131], v52, s[32:35], s46 offen offset:0 sc1
    buffer_load_dwordx4 v[132:135], v52, s[32:35], s46 offen offset:32 sc1
    buffer_load_dwordx4 v[136:139], v52, s[32:35], s46 offen offset:64 sc1
    buffer_load_dwordx4 v[140:143], v52, s[32:35], s46 offen offset:96 sc1
    s_add_u32 s13, s13, 1
    s_waitcnt vmcnt(0)
    v_max3_u32 v55, v112, v113, v114
    v_max3_u32 v55, v55, v115, v116
    v_max3_u32 v55, v55, v117, v118
    v_max3_u32 v55, v55, v119, v120
    v_max3_u32 v55, v55, v121, v122
    v_max3_u32 v55, v55, v123, v124
    v_max3_u32 v55, v55, v125, v126
    v_max3_u32 v55, v55, v127, v128
    v_max3_u32 v55, v55, v129, v130
    v_max3_u32 v55, v55, v131, v132
    v_max3_u32 v55, v55, v133, v134
    v_max3_u32 v55, v55, v135, v136
    v_max3_u32 v55, v55, v137, v138
    v_max3_u32 v55, v55, v139, v140
    v_max3_u32 v55, v55, v141, v142
    v_max_u32 v55, v55, v143
    v_cmp_eq_u32 vcc, -1, v55
    s_cbranch_vccz L_c_kvok
    s_cmp_lt_u32 s13, 16384
    s_cbranch_scc1 L_c_kv
L_c_kvok:
    v_mfma_f32_32x32x16_bf16 v[192:207], v[128:131], v[80:83], 0
    v_mfma_f32_32x32x16_bf16 v[160:175], v[112:115], v[80:83], 0
    v_mfma_f32_32x32x16_bf16 v[192:207], v[132:135], v[84:87], v[192:207]
    v_mfma_f32_32x32x16_bf16 v[160:175], v[116:119], v[84:87], v[160:175]
    v_mfma_f32_32x32x16_bf16 v[192:207], v[136:139], v[88:91], v[192:207]
    v_mfma_f32_32x32x16_bf16 v[160:175], v[120:123], v[88:91], v[160:175]
    v_mfma_f32_32x32x16_bf16 v[192:207], v[140:143], v[92:95], v[192:207]
    v_mfma_f32_32x32x16_bf16 v[160:175], v[124:127], v[92:95], v[160:175]
    v_mfma_f32_32x32x16_bf16 v[208:223], v[128:131], v[96:99], 0
    v_mfma_f32_32x32x16_bf16 v[176:191], v[112:115], v[96:99], 0
    v_mfma_f32_32x32x16_bf16 v[208:223], v[132:135], v[100:103], v[208:223]
    v_mfma_f32_32x32x16_bf16 v[176:191], v[116:119], v[100:103], v[176:191]
    v_mfma_f32_32x32x16_bf16 v[208:223], v[136:139], v[104:107], v[208:223]
    v_mfma_f32_32x32x16_bf16 v[176:191], v[120:123], v[104:107], v[176:191]
    v_mfma_f32_32x32x16_bf16 v[208:223], v[140:143], v[108:111], v[208:223]
    v_mfma_f32_32x32x16_bf16 v[176:191], v[124:127], v[108:111], v[176:191]
    s_nop 2
    v_cvt_pk_bf16_f32 v56, v192, v192
    v_lshlrev_b32 v56, 16, v56
    v_add_f32 v56, 0x358637bd, v56
    v_cvt_pk_bf16_f32 v56, v56, v56
    v_lshlrev_b32 v56, 16, v56
    v_rcp_f32 v56, v56
    v_cvt_pk_bf16_f32 v64, v160, v161
    v_cvt_pk_bf16_f32 v65, v162, v163
    v_cvt_pk_bf16_f32 v66, v164, v165
    v_cvt_pk_bf16_f32 v67, v166, v167
    v_cvt_pk_bf16_f32 v68, v168, v169
    v_cvt_pk_bf16_f32 v69, v170, v171
    v_cvt_pk_bf16_f32 v70, v172, v173
    v_cvt_pk_bf16_f32 v71, v174, v175
    v_lshlrev_b32 v160, 16, v64
    v_and_b32 v161, 0xffff0000, v64
    v_lshlrev_b32 v162, 16, v65
    v_and_b32 v163, 0xffff0000, v65
    v_lshlrev_b32 v164, 16, v66
    v_and_b32 v165, 0xffff0000, v66
    v_lshlrev_b32 v166, 16, v67
    v_and_b32 v167, 0xffff0000, v67
    v_lshlrev_b32 v168, 16, v68
    v_and_b32 v169, 0xffff0000, v68
    v_lshlrev_b32 v170, 16, v69
    v_and_b32 v171, 0xffff0000, v69
    v_lshlrev_b32 v172, 16, v70
    v_and_b32 v173, 0xffff0000, v70
    v_lshlrev_b32 v174, 16, v71
    v_and_b32 v175, 0xffff0000, v71
    v_pk_mul_f32 v[160:161], v[160:161], v[56:57] op_sel_hi:[1,0]
    v_pk_mul_f32 v[162:163], v[162:163], v[56:57] op_sel_hi:[1,0]
    v_pk_mul_f32 v[164:165], v[164:165], v[56:57] op_sel_hi:[1,0]
    v_pk_mul_f32 v[166:167], v[166:167], v[56:57] op_sel_hi:[1,0]
    v_pk_mul_f32 v[168:169], v[168:169], v[56:57] op_sel_hi:[1,0]
    v_pk_mul_f32 v[170:171], v[170:171], v[56:57] op_sel_hi:[1,0]
    v_pk_mul_f32 v[172:173], v[172:173], v[56:57] op_sel_hi:[1,0]
    v_pk_mul_f32 v[174:175], v[174:175], v[56:57] op_sel_hi:[1,0]
    v_cvt_pk_bf16_f32 v64, v160, v161
    v_cvt_pk_bf16_f32 v65, v162, v163
    v_cvt_pk_bf16_f32 v66, v164, v165
    v_cvt_pk_bf16_f32 v67, v166, v167
    v_cvt_pk_bf16_f32 v68, v168, v169
    v_cvt_pk_bf16_f32 v69, v170, v171
    v_cvt_pk_bf16_f32 v70, v172, v173
    v_cvt_pk_bf16_f32 v71, v174, v175
    buffer_store_dwordx4 v[64:67], v5, s[32:35], s41 offen sc1
    buffer_store_dwordx4 v[68:71], v5, s[32:35], s41 offen offset:1024 sc1
    v_cvt_pk_bf16_f32 v58, v208, v208
    v_lshlrev_b32 v58, 16, v58
    v_add_f32 v58, 0x358637bd, v58
    v_cvt_pk_bf16_f32 v58, v58, v58
    v_lshlrev_b32 v58, 16, v58
    v_rcp_f32 v58, v58
    v_cvt_pk_bf16_f32 v72, v176, v177
    v_cvt_pk_bf16_f32 v73, v178, v179
    v_cvt_pk_bf16_f32 v74, v180, v181
    v_cvt_pk_bf16_f32 v75, v182, v183
    v_cvt_pk_bf16_f32 v76, v184, v185
    v_cvt_pk_bf16_f32 v77, v186, v187
    v_cvt_pk_bf16_f32 v78, v188, v189
    v_cvt_pk_bf16_f32 v79, v190, v191
    v_lshlrev_b32 v176, 16, v72
    v_and_b32 v177, 0xffff0000, v72
    v_lshlrev_b32 v178, 16, v73
    v_and_b32 v179, 0xffff0000, v73
    v_lshlrev_b32 v180, 16, v74
    v_and_b32 v181, 0xffff0000, v74
    v_lshlrev_b32 v182, 16, v75
    v_and_b32 v183, 0xffff0000, v75
    v_lshlrev_b32 v184, 16, v76
    v_and_b32 v185, 0xffff0000, v76
    v_lshlrev_b32 v186, 16, v77
    v_and_b32 v187, 0xffff0000, v77
    v_lshlrev_b32 v188, 16, v78
    v_and_b32 v189, 0xffff0000, v78
    v_lshlrev_b32 v190, 16, v79
    v_and_b32 v191, 0xffff0000, v79
    v_pk_mul_f32 v[176:177], v[176:177], v[58:59] op_sel_hi:[1,0]
    v_pk_mul_f32 v[178:179], v[178:179], v[58:59] op_sel_hi:[1,0]
    v_pk_mul_f32 v[180:181], v[180:181], v[58:59] op_sel_hi:[1,0]
    v_pk_mul_f32 v[182:183], v[182:183], v[58:59] op_sel_hi:[1,0]
    v_pk_mul_f32 v[184:185], v[184:185], v[58:59] op_sel_hi:[1,0]
    v_pk_mul_f32 v[186:187], v[186:187], v[58:59] op_sel_hi:[1,0]
    v_pk_mul_f32 v[188:189], v[188:189], v[58:59] op_sel_hi:[1,0]
    v_pk_mul_f32 v[190:191], v[190:191], v[58:59] op_sel_hi:[1,0]
    v_cvt_pk_bf16_f32 v72, v176, v177
    v_cvt_pk_bf16_f32 v73, v178, v179
    v_cvt_pk_bf16_f32 v74, v180, v181
    v_cvt_pk_bf16_f32 v75, v182, v183
    v_cvt_pk_bf16_f32 v76, v184, v185
    v_cvt_pk_bf16_f32 v77, v186, v187
    v_cvt_pk_bf16_f32 v78, v188, v189
    v_cvt_pk_bf16_f32 v79, v190, v191
    buffer_store_dwordx4 v[72:75], v5, s[32:35], s42 offen sc1
    buffer_store_dwordx4 v[76:79], v5, s[32:35], s42 offen offset:1024 sc1
    v_mov_b32 v16, s23
    v_lshlrev_b32 v60, 8, v2
    s_lshr_b32 s12, s21, 4
    s_cmp_lg_u32 s12, s92
    s_cbranch_scc1 L_b_noownc1
    s_lshl_b32 s12, s89, 12
    s_add_u32 s12, s12, 458752
    buffer_load_dwordx4 v[224:227], v12, s[32:35], s12 offen offset:0 sc1
    buffer_load_dwordx4 v[228:231], v12, s[32:35], s12 offen offset:16 sc1
    buffer_load_dwordx4 v[232:235], v12, s[32:35], s12 offen offset:64 sc1
    buffer_load_dwordx4 v[236:239], v12, s[32:35], s12 offen offset:80 sc1
L_b_noownc1:
    s_waitcnt vmcnt(0)
    s_mov_b64 exec, 0xffff
    buffer_store_dword v16, v60, s[32:35], s40 offen sc1
    s_mov_b64 exec, -1
    s_lshr_b32 s12, s21, 4
    s_cmp_lg_u32 s12, s92
    s_cbranch_scc1 L_b_noownc2
    s_lshl_b32 s12, s89, 12
    s_add_u32 s12, s12, 458752
    s_mov_b32 s13, 0
L_b_yc2:
    s_waitcnt vmcnt(0)
    v_msad_u8 v240, v224, s76, 0
    v_msad_u8 v240, v225, s77, v240
    v_msad_u8 v240, v226, s78, v240
    v_msad_u8 v240, v227, s79, v240
    v_msad_u8 v240, v228, s76, v240
    v_msad_u8 v240, v229, s77, v240
    v_msad_u8 v240, v230, s78, v240
    v_msad_u8 v240, v231, s79, v240
    v_msad_u8 v240, v232, s76, v240
    v_msad_u8 v240, v233, s77, v240
    v_msad_u8 v240, v234, s78, v240
    v_msad_u8 v240, v235, s79, v240
    v_msad_u8 v240, v236, s76, v240
    v_msad_u8 v240, v237, s77, v240
    v_msad_u8 v240, v238, s78, v240
    v_msad_u8 v240, v239, s79, v240
    v_cmp_ne_u32 vcc, 0, v240
    s_cbranch_vccz L_b_yokc2
    buffer_load_dwordx4 v[224:227], v12, s[32:35], s12 offen offset:0 sc1
    buffer_load_dwordx4 v[228:231], v12, s[32:35], s12 offen offset:16 sc1
    buffer_load_dwordx4 v[232:235], v12, s[32:35], s12 offen offset:64 sc1
    buffer_load_dwordx4 v[236:239], v12, s[32:35], s12 offen offset:80 sc1
    s_add_u32 s13, s13, 1
    s_cmp_lt_u32 s13, 16384
    s_cbranch_scc1 L_b_yc2
    s_waitcnt vmcnt(0)
L_b_yokc2:
    v_add_f32_dpp v224, v224, v224 row_ror:1 row_mask:0xf bank_mask:0xf
    v_add_f32_dpp v225, v225, v225 row_ror:1 row_mask:0xf bank_mask:0xf
    v_add_f32_dpp v226, v226, v226 row_ror:1 row_mask:0xf bank_mask:0xf
    v_add_f32_dpp v227, v227, v227 row_ror:1 row_mask:0xf bank_mask:0xf
    v_add_f32_dpp v228, v228, v228 row_ror:1 row_mask:0xf bank_mask:0xf
    v_add_f32_dpp v229, v229, v229 row_ror:1 row_mask:0xf bank_mask:0xf
    v_add_f32_dpp v230, v230, v230 row_ror:1 row_mask:0xf bank_mask:0xf
    v_add_f32_dpp v231, v231, v231 row_ror:1 row_mask:0xf bank_mask:0xf
    v_add_f32_dpp v232, v232, v232 row_ror:1 row_mask:0xf bank_mask:0xf
    v_add_f32_dpp v233, v233, v233 row_ror:1 row_mask:0xf bank_mask:0xf
    v_add_f32_dpp v234, v234, v234 row_ror:1 row_mask:0xf bank_mask:0xf
    v_add_f32_dpp v235, v235, v235 row_ror:1 row_mask:0xf bank_mask:0xf
    v_add_f32_dpp v236, v236, v236 row_ror:1 row_mask:0xf bank_mask:0xf
    v_add_f32_dpp v237, v237, v237 row_ror:1 row_mask:0xf bank_mask:0xf
    v_add_f32_dpp v238, v238, v238 row_ror:1 row_mask:0xf bank_mask:0xf
    v_add_f32_dpp v239, v239, v239 row_ror:1 row_mask:0xf bank_mask:0xf
    v_add_f32_dpp v224, v224, v224 row_ror:2 row_mask:0xf bank_mask:0xf
    v_add_f32_dpp v225, v225, v225 row_ror:2 row_mask:0xf bank_mask:0xf
    v_add_f32_dpp v226, v226, v226 row_ror:2 row_mask:0xf bank_mask:0xf
    v_add_f32_dpp v227, v227, v227 row_ror:2 row_mask:0xf bank_mask:0xf
    v_add_f32_dpp v228, v228, v228 row_ror:2 row_mask:0xf bank_mask:0xf
    v_add_f32_dpp v229, v229, v229 row_ror:2 row_mask:0xf bank_mask:0xf
    v_add_f32_dpp v230, v230, v230 row_ror:2 row_mask:0xf bank_mask:0xf
    v_add_f32_dpp v231, v231, v231 row_ror:2 row_mask:0xf bank_mask:0xf
    v_add_f32_dpp v232, v232, v232 row_ror:2 row_mask:0xf bank_mask:0xf
    v_add_f32_dpp v233, v233, v233 row_ror:2 row_mask:0xf bank_mask:0xf
    v_add_f32_dpp v234, v234, v234 row_ror:2 row_mask:0xf bank_mask:0xf
    v_add_f32_dpp v235, v235, v235 row_ror:2 row_mask:0xf bank_mask:0xf
    v_add_f32_dpp v236, v236, v236 row_ror:2 row_mask:0xf bank_mask:0xf
    v_add_f32_dpp v237, v237, v237 row_ror:2 row_mask:0xf bank_mask:0xf
    v_add_f32_dpp v238, v238, v238 row_ror:2 row_mask:0xf bank_mask:0xf
    v_add_f32_dpp v239, v239, v239 row_ror:2 row_mask:0xf bank_mask:0xf
    v_add_f32_dpp v224, v224, v224 row_ror:4 row_mask:0xf bank_mask:0xf
    v_add_f32_dpp v225, v225, v225 row_ror:4 row_mask:0xf bank_mask:0xf
    v_add_f32_dpp v226, v226, v226 row_ror:4 row_mask:0xf bank_mask:0xf
    v_add_f32_dpp v227, v227, v227 row_ror:4 row_mask:0xf bank_mask:0xf
    v_add_f32_dpp v228, v228, v228 row_ror:4 row_mask:0xf bank_mask:0xf
    v_add_f32_dpp v229, v229, v229 row_ror:4 row_mask:0xf bank_mask:0xf
    v_add_f32_dpp v230, v230, v230 row_ror:4 row_mask:0xf bank_mask:0xf
    v_add_f32_dpp v231, v231, v231 row_ror:4 row_mask:0xf bank_mask:0xf
    v_add_f32_dpp v232, v232, v232 row_ror:4 row_mask:0xf bank_mask:0xf
    v_add_f32_dpp v233, v233, v233 row_ror:4 row_mask:0xf bank_mask:0xf
    v_add_f32_dpp v234, v234, v234 row_ror:4 row_mask:0xf bank_mask:0xf
    v_add_f32_dpp v235, v235, v235 row_ror:4 row_mask:0xf bank_mask:0xf
    v_add_f32_dpp v236, v236, v236 row_ror:4 row_mask:0xf bank_mask:0xf
    v_add_f32_dpp v237, v237, v237 row_ror:4 row_mask:0xf bank_mask:0xf
    v_add_f32_dpp v238, v238, v238 row_ror:4 row_mask:0xf bank_mask:0xf
    v_add_f32_dpp v239, v239, v239 row_ror:4 row_mask:0xf bank_mask:0xf
    v_add_f32_dpp v224, v224, v224 row_ror:8 row_mask:0xf bank_mask:0xf
    v_add_f32_dpp v225, v225, v225 row_ror:8 row_mask:0xf bank_mask:0xf
    v_add_f32_dpp v226, v226, v226 row_ror:8 row_mask:0xf bank_mask:0xf
    v_add_f32_dpp v227, v227, v227 row_ror:8 row_mask:0xf bank_mask:0xf
    v_add_f32_dpp v228, v228, v228 row_ror:8 row_mask:0xf bank_mask:0xf
    v_add_f32_dpp v229, v229, v229 row_ror:8 row_mask:0xf bank_mask:0xf
    v_add_f32_dpp v230, v230, v230 row_ror:8 row_mask:0xf bank_mask:0xf
    v_add_f32_dpp v231, v231, v231 row_ror:8 row_mask:0xf bank_mask:0xf
    v_add_f32_dpp v232, v232, v232 row_ror:8 row_mask:0xf bank_mask:0xf
    v_add_f32_dpp v233, v233, v233 row_ror:8 row_mask:0xf bank_mask:0xf
    v_add_f32_dpp v234, v234, v234 row_ror:8 row_mask:0xf bank_mask:0xf
    v_add_f32_dpp v235, v235, v235 row_ror:8 row_mask:0xf bank_mask:0xf
    v_add_f32_dpp v236, v236, v236 row_ror:8 row_mask:0xf bank_mask:0xf
    v_add_f32_dpp v237, v237, v237 row_ror:8 row_mask:0xf bank_mask:0xf
    v_add_f32_dpp v238, v238, v238 row_ror:8 row_mask:0xf bank_mask:0xf
    v_add_f32_dpp v239, v239, v239 row_ror:8 row_mask:0xf bank_mask:0xf
    v_cvt_pk_bf16_f32 v240, v224, v225
    v_cvt_pk_bf16_f32 v241, v226, v227
    v_cvt_pk_bf16_f32 v242, v228, v229
    v_cvt_pk_bf16_f32 v243, v230, v231
    v_cvt_pk_bf16_f32 v244, v232, v233
    v_cvt_pk_bf16_f32 v245, v234, v235
    v_cvt_pk_bf16_f32 v246, v236, v237
    v_cvt_pk_bf16_f32 v247, v238, v239
    v_lshlrev_b32 v224, 16, v240
    v_and_b32 v225, 0xffff0000, v240
    v_lshlrev_b32 v226, 16, v241
    v_and_b32 v227, 0xffff0000, v241
    v_lshlrev_b32 v228, 16, v242
    v_and_b32 v229, 0xffff0000, v242
    v_lshlrev_b32 v230, 16, v243
    v_and_b32 v231, 0xffff0000, v243
    v_lshlrev_b32 v232, 16, v244
    v_and_b32 v233, 0xffff0000, v244
    v_lshlrev_b32 v234, 16, v245
    v_and_b32 v235, 0xffff0000, v245
    v_lshlrev_b32 v236, 16, v246
    v_and_b32 v237, 0xffff0000, v246
    v_lshlrev_b32 v238, 16, v247
    v_and_b32 v239, 0xffff0000, v247
    v_mul_f32 v224, s22, v224
    v_mul_f32 v225, s22, v225
    v_mul_f32 v226, s22, v226
    v_mul_f32 v227, s22, v227
    v_mul_f32 v228, s22, v228
    v_mul_f32 v229, s22, v229
    v_mul_f32 v230, s22, v230
    v_mul_f32 v231, s22, v231
    v_mul_f32 v232, s22, v232
    v_mul_f32 v233, s22, v233
    v_mul_f32 v234, s22, v234
    v_mul_f32 v235, s22, v235
    v_mul_f32 v236, s22, v236
    v_mul_f32 v237, s22, v237
    v_mul_f32 v238, s22, v238
    v_mul_f32 v239, s22, v239
    v_cvt_pk_bf16_f32 v240, v224, v225
    v_cvt_pk_bf16_f32 v241, v226, v227
    v_cvt_pk_bf16_f32 v242, v228, v229
    v_cvt_pk_bf16_f32 v243, v230, v231
    v_cvt_pk_bf16_f32 v244, v232, v233
    v_cvt_pk_bf16_f32 v245, v234, v235
    v_cvt_pk_bf16_f32 v246, v236, v237
    v_cvt_pk_bf16_f32 v247, v238, v239
    v_lshlrev_b32 v224, 16, v240
    v_and_b32 v225, 0xffff0000, v240
    v_lshlrev_b32 v226, 16, v241
    v_and_b32 v227, 0xffff0000, v241
    v_lshlrev_b32 v228, 16, v242
    v_and_b32 v229, 0xffff0000, v242
    v_lshlrev_b32 v230, 16, v243
    v_and_b32 v231, 0xffff0000, v243
    v_lshlrev_b32 v232, 16, v244
    v_and_b32 v233, 0xffff0000, v244
    v_lshlrev_b32 v234, 16, v245
    v_and_b32 v235, 0xffff0000, v245
    v_lshlrev_b32 v236, 16, v246
    v_and_b32 v237, 0xffff0000, v246
    v_lshlrev_b32 v238, 16, v247
    v_and_b32 v239, 0xffff0000, v247
    v_lshlrev_b32 v32, 16, v24
    v_and_b32 v33, 0xffff0000, v24
    v_lshlrev_b32 v34, 16, v25
    v_and_b32 v35, 0xffff0000, v25
    v_lshlrev_b32 v36, 16, v26
    v_and_b32 v37, 0xffff0000, v26
    v_lshlrev_b32 v38, 16, v27
    v_and_b32 v39, 0xffff0000, v27
    v_lshlrev_b32 v40, 16, v28
    v_and_b32 v41, 0xffff0000, v28
    v_lshlrev_b32 v42, 16, v29
    v_and_b32 v43, 0xffff0000, v29
    v_lshlrev_b32 v44, 16, v30
    v_and_b32 v45, 0xffff0000, v30
    v_lshlrev_b32 v46, 16, v31
    v_and_b32 v47, 0xffff0000, v31
    v_add_f32 v224, v224, v32
    v_add_f32 v225, v225, v33
    v_add_f32 v226, v226, v34
    v_add_f32 v227, v227, v35
    v_add_f32 v228, v228, v36
    v_add_f32 v229, v229, v37
    v_add_f32 v230, v230, v38
    v_add_f32 v231, v231, v39
    v_add_f32 v232, v232, v40
    v_add_f32 v233, v233, v41
    v_add_f32 v234, v234, v42
    v_add_f32 v235, v235, v43
    v_add_f32 v236, v236, v44
    v_add_f32 v237, v237, v45
    v_add_f32 v238, v238, v46
    v_add_f32 v239, v239, v47
    v_cvt_pk_bf16_f32 v240, v224, v225
    v_cvt_pk_bf16_f32 v241, v226, v227
    v_cvt_pk_bf16_f32 v242, v228, v229
    v_cvt_pk_bf16_f32 v243, v230, v231
    v_cvt_pk_bf16_f32 v244, v232, v233
    v_cvt_pk_bf16_f32 v245, v234, v235
    v_cvt_pk_bf16_f32 v246, v236, v237
    v_cvt_pk_bf16_f32 v247, v238, v239
    v_cmp_eq_u32 vcc, s21, v6
    s_nop 1
    v_cndmask_b32 v24, v24, v240, vcc
    v_cndmask_b32 v25, v25, v241, vcc
    v_cndmask_b32 v26, v26, v242, vcc
    v_cndmask_b32 v27, v27, v243, vcc
    v_cndmask_b32 v28, v28, v244, vcc
    v_cndmask_b32 v29, v29, v245, vcc
    v_cndmask_b32 v30, v30, v246, vcc
    v_cndmask_b32 v31, v31, v247, vcc
    v_lshlrev_b32 v32, 16, v24
    v_and_b32 v33, 0xffff0000, v24
    v_lshlrev_b32 v34, 16, v25
    v_and_b32 v35, 0xffff0000, v25
    v_lshlrev_b32 v36, 16, v26
    v_and_b32 v37, 0xffff0000, v26
    v_lshlrev_b32 v38, 16, v27
    v_and_b32 v39, 0xffff0000, v27
    v_lshlrev_b32 v40, 16, v28
    v_and_b32 v41, 0xffff0000, v28
    v_lshlrev_b32 v42, 16, v29
    v_and_b32 v43, 0xffff0000, v29
    v_lshlrev_b32 v44, 16, v30
    v_and_b32 v45, 0xffff0000, v30
    v_lshlrev_b32 v46, 16, v31
    v_and_b32 v47, 0xffff0000, v31
    v_pk_mul_f32 v[32:33], v[32:33], v[50:51] op_sel_hi:[1,0]
    v_pk_mul_f32 v[34:35], v[34:35], v[50:51] op_sel_hi:[1,0]
    v_pk_mul_f32 v[36:37], v[36:37], v[50:51] op_sel_hi:[1,0]
    v_pk_mul_f32 v[38:39], v[38:39], v[50:51] op_sel_hi:[1,0]
    v_pk_mul_f32 v[40:41], v[40:41], v[50:51] op_sel_hi:[1,0]
    v_pk_mul_f32 v[42:43], v[42:43], v[50:51] op_sel_hi:[1,0]
    v_pk_mul_f32 v[44:45], v[44:45], v[50:51] op_sel_hi:[1,0]
    v_pk_mul_f32 v[46:47], v[46:47], v[50:51] op_sel_hi:[1,0]
    v_cvt_pk_bf16_f32 v33, v32, v33
    v_cvt_pk_bf16_f32 v35, v34, v35
    v_cvt_pk_bf16_f32 v37, v36, v37
    v_cvt_pk_bf16_f32 v39, v38, v39
    v_cvt_pk_bf16_f32 v41, v40, v41
    v_cvt_pk_bf16_f32 v43, v42, v43
    v_cvt_pk_bf16_f32 v45, v44, v45
    v_cvt_pk_bf16_f32 v47, v46, v47
    v_lshlrev_b32 v32, 16, v33
    v_and_b32 v33, 0xffff0000, v33
    v_lshlrev_b32 v34, 16, v35
    v_and_b32 v35, 0xffff0000, v35
    v_lshlrev_b32 v36, 16, v37
    v_and_b32 v37, 0xffff0000, v37
    v_lshlrev_b32 v38, 16, v39
    v_and_b32 v39, 0xffff0000, v39
    v_lshlrev_b32 v40, 16, v41
    v_and_b32 v41, 0xffff0000, v41
    v_lshlrev_b32 v42, 16, v43
    v_and_b32 v43, 0xffff0000, v43
    v_lshlrev_b32 v44, 16, v45
    v_and_b32 v45, 0xffff0000, v45
    v_lshlrev_b32 v46, 16, v47
    v_and_b32 v47, 0xffff0000, v47
L_b_noownc2:
L_phaseb:
    s_setprio 0
    s_nop 4
    s_barrier
    s_mov_b32 s14, 0xffff0000
    s_mov_b32 s47, 0
    s_mov_b32 s96, 0
    s_waitcnt vmcnt(0)
    s_cmp_lg_u32 s96, 0
    s_cbranch_scc1 L_pk0
L_pl0:
    buffer_load_dword v52, v8, s[32:35], s15 offen sc1
    s_add_u32 s47, s47, 1
    s_cmp_ge_u32 s47, 16384
    s_cselect_b32 s12, -1, 0
    s_waitcnt vmcnt(0)
    v_cmp_eq_u32 vcc, s23, v52
    s_nop 1
    s_or_b32 s12, s12, vcc_lo
    s_lshr_b32 s12, s12, s93
    s_or_b32 s96, s96, s12
    s_andn2_b32 s96, s96, s14
    s_cbranch_scc0 L_pl0
L_pk0:
    s_ff1_i32_b32 s12, s96
    s_bitset0_b32 s96, s12
    s_bitset1_b32 s14, s12
    s_add_u32 s12, s12, s93
    s_and_b32 s80, s12, 15
    s_lshl_b32 s94, s80, 11
    s_add_u32 s94, s94, s95
    buffer_load_dwordx4 v[96:99], v17, s[32:35], s94 offen
    buffer_load_dwordx4 v[100:103], v17, s[32:35], s94 offen offset:1024
    s_add_u32 s12, s80, s97
    s_lshl_b32 s13, s12, 12
    s_cmp_ge_u32 s12, 10
    s_cselect_b32 s12, 24576, 0
    s_add_u32 s13, s13, s12
    v_add_u32 v12, s13, v10
    v_add_u32 v13, s13, v11
    ds_read_b64_tr_b16 v[120:121], v12 offset:0
    ds_read_b64_tr_b16 v[122:123], v12 offset:1024
    ds_read_b64_tr_b16 v[124:125], v13 offset:0
    ds_read_b64_tr_b16 v[126:127], v13 offset:1024
    ds_read_b64_tr_b16 v[128:129], v12 offset:2048
    ds_read_b64_tr_b16 v[130:131], v12 offset:3072
    ds_read_b64_tr_b16 v[132:133], v13 offset:2048
    ds_read_b64_tr_b16 v[134:135], v13 offset:3072
    s_cmp_lg_u32 s96, 0
    s_cbranch_scc1 L_pk1
L_pl1:
    buffer_load_dword v53, v8, s[32:35], s15 offen sc1
    s_add_u32 s47, s47, 1
    s_cmp_ge_u32 s47, 16384
    s_cselect_b32 s12, -1, 0
    s_waitcnt vmcnt(0)
    v_cmp_eq_u32 vcc, s23, v53
    s_nop 1
    s_or_b32 s12, s12, vcc_lo
    s_lshr_b32 s12, s12, s93
    s_or_b32 s96, s96, s12
    s_andn2_b32 s96, s96, s14
    s_cbranch_scc0 L_pl1
L_pk1:
    s_ff1_i32_b32 s12, s96
    s_bitset0_b32 s96, s12
    s_bitset1_b32 s14, s12
    s_add_u32 s12, s12, s93
    s_and_b32 s81, s12, 15
    s_lshl_b32 s94, s81, 11
    s_add_u32 s94, s94, s95
    buffer_load_dwordx4 v[104:107], v17, s[32:35], s94 offen
    buffer_load_dwordx4 v[108:111], v17, s[32:35], s94 offen offset:1024
    s_cmp_lg_u32 s96, 0
    s_cbranch_scc1 L_pk2
L_pl2:
    buffer_load_dword v54, v8, s[32:35], s15 offen sc1
    s_add_u32 s47, s47, 1
    s_cmp_ge_u32 s47, 16384
    s_cselect_b32 s12, -1, 0
    s_waitcnt vmcnt(0)
    v_cmp_eq_u32 vcc, s23, v54
    s_nop 1
    s_or_b32 s12, s12, vcc_lo
    s_lshr_b32 s12, s12, s93
    s_or_b32 s96, s96, s12
    s_andn2_b32 s96, s96, s14
    s_cbranch_scc0 L_pl2
L_pk2:
    s_ff1_i32_b32 s12, s96
    s_bitset0_b32 s96, s12
    s_bitset1_b32 s14, s12
    s_add_u32 s12, s12, s93
    s_and_b32 s82, s12, 15
    s_lshl_b32 s94, s82, 11
    s_add_u32 s94, s94, s95
    buffer_load_dwordx4 v[112:115], v17, s[32:35], s94 offen
    buffer_load_dwordx4 v[116:119], v17, s[32:35], s94 offen offset:1024
    s_add_u32 s12, s81, s97
    s_lshl_b32 s13, s12, 12
    s_cmp_ge_u32 s12, 10
    s_cselect_b32 s12, 24576, 0
    s_add_u32 s13, s13, s12
    v_add_u32 v14, s13, v10
    v_add_u32 v15, s13, v11
    s_waitcnt vmcnt(4)
    s_waitcnt lgkmcnt(6)
    v_mfma_f32_32x32x16_bf16 v[64:79], v[120:123], v[96:99], 0
    ds_read_b64_tr_b16 v[136:137], v14 offset:0
    ds_read_b64_tr_b16 v[138:139], v14 offset:1024
    s_waitcnt lgkmcnt(6)
    v_mfma_f32_32x32x16_bf16 v[80:95], v[124:127], v[96:99], 0
    ds_read_b64_tr_b16 v[140:141], v15 offset:0
    ds_read_b64_tr_b16 v[142:143], v15 offset:1024
    s_waitcnt lgkmcnt(6)
    v_mfma_f32_32x32x16_bf16 v[64:79], v[128:131], v[100:103], v[64:79]
    ds_read_b64_tr_b16 v[144:145], v14 offset:2048
    ds_read_b64_tr_b16 v[146:147], v14 offset:3072
    s_waitcnt lgkmcnt(6)
    v_mfma_f32_32x32x16_bf16 v[80:95], v[132:135], v[100:103], v[80:95]
    ds_read_b64_tr_b16 v[148:149], v15 offset:2048
    ds_read_b64_tr_b16 v[150:151], v15 offset:3072
    s_cmp_lg_u32 s96, 0
    s_cbranch_scc1 L_pk3
L_pl3:
    buffer_load_dword v55, v8, s[32:35], s15 offen sc1
    s_add_u32 s47, s47, 1
    s_cmp_ge_u32 s47, 16384
    s_cselect_b32 s12, -1, 0
    s_waitcnt vmcnt(0)
    v_cmp_eq_u32 vcc, s23, v55
    s_nop 1
    s_or_b32 s12, s12, vcc_lo
    s_lshr_b32 s12, s12, s93
    s_or_b32 s96, s96, s12
    s_andn2_b32 s96, s96, s14
    s_cbranch_scc0 L_pl3
L_pk3:
    s_ff1_i32_b32 s12, s96
    s_bitset0_b32 s96, s12
    s_bitset1_b32 s14, s12
    s_add_u32 s12, s12, s93
    s_and_b32 s83, s12, 15
    s_lshl_b32 s94, s83, 11
    s_add_u32 s94, s94, s95
    buffer_load_dwordx4 v[96:99], v17, s[32:35], s94 offen
    buffer_load_dwordx4 v[100:103], v17, s[32:35], s94 offen offset:1024
    s_add_u32 s12, s82, s97
    s_lshl_b32 s13, s12, 12
    s_cmp_ge_u32 s12, 10
    s_cselect_b32 s12, 24576, 0
    s_add_u32 s13, s13, s12
    v_add_u32 v12, s13, v10
    v_add_u32 v13, s13, v11
    s_waitcnt vmcnt(4)
    s_waitcnt lgkmcnt(6)
    v_mfma_f32_32x32x16_bf16 v[64:79], v[136:139], v[104:107], v[64:79]
    ds_read_b64_tr_b16 v[120:121], v12 offset:0
    ds_read_b64_tr_b16 v[122:123], v12 offset:1024
    s_waitcnt lgkmcnt(6)
    v_mfma_f32_32x32x16_bf16 v[80:95], v[140:143], v[104:107], v[80:95]
    ds_read_b64_tr_b16 v[124:125], v13 offset:0
    ds_read_b64_tr_b16 v[126:127], v13 offset:1024
    s_waitcnt lgkmcnt(6)
    v_mfma_f32_32x32x16_bf16 v[64:79], v[144:147], v[108:111], v[64:79]
    ds_read_b64_tr_b16 v[128:129], v12 offset:2048
    ds_read_b64_tr_b16 v[130:131], v12 offset:3072
    s_waitcnt lgkmcnt(6)
    v_mfma_f32_32x32x16_bf16 v[80:95], v[148:151], v[108:111], v[80:95]
    ds_read_b64_tr_b16 v[132:133], v13 offset:2048
    ds_read_b64_tr_b16 v[134:135], v13 offset:3072
    s_cmp_lg_u32 s96, 0
    s_cbranch_scc1 L_pk4
L_pl4:
    buffer_load_dword v56, v8, s[32:35], s15 offen sc1
    s_add_u32 s47, s47, 1
    s_cmp_ge_u32 s47, 16384
    s_cselect_b32 s12, -1, 0
    s_waitcnt vmcnt(0)
    v_cmp_eq_u32 vcc, s23, v56
    s_nop 1
    s_or_b32 s12, s12, vcc_lo
    s_lshr_b32 s12, s12, s93
    s_or_b32 s96, s96, s12
    s_andn2_b32 s96, s96, s14
    s_cbranch_scc0 L_pl4
L_pk4:
    s_ff1_i32_b32 s12, s96
    s_bitset0_b32 s96, s12
    s_bitset1_b32 s14, s12
    s_add_u32 s12, s12, s93
    s_and_b32 s84, s12, 15
    s_lshl_b32 s94, s84, 11
    s_add_u32 s94, s94, s95
    buffer_load_dwordx4 v[104:107], v17, s[32:35], s94 offen
    buffer_load_dwordx4 v[108:111], v17, s[32:35], s94 offen offset:1024
    s_add_u32 s12, s83, s97
    s_lshl_b32 s13, s12, 12
    s_cmp_ge_u32 s12, 10
    s_cselect_b32 s12, 24576, 0
    s_add_u32 s13, s13, s12
    v_add_u32 v14, s13, v10
    v_add_u32 v15, s13, v11
    s_waitcnt vmcnt(4)
    s_waitcnt lgkmcnt(6)
    v_mfma_f32_32x32x16_bf16 v[64:79], v[120:123], v[112:115], v[64:79]
    ds_read_b64_tr_b16 v[136:137], v14 offset:0
    ds_read_b64_tr_b16 v[138:139], v14 offset:1024
    s_waitcnt lgkmcnt(6)
    v_mfma_f32_32x32x16_bf16 v[80:95], v[124:127], v[112:115], v[80:95]
    ds_read_b64_tr_b16 v[140:141], v15 offset:0
    ds_read_b64_tr_b16 v[142:143], v15 offset:1024
    s_waitcnt lgkmcnt(6)
    v_mfma_f32_32x32x16_bf16 v[64:79], v[128:131], v[116:119], v[64:79]
    ds_read_b64_tr_b16 v[144:145], v14 offset:2048
    ds_read_b64_tr_b16 v[146:147], v14 offset:3072
    s_waitcnt lgkmcnt(6)
    v_mfma_f32_32x32x16_bf16 v[80:95], v[132:135], v[116:119], v[80:95]
    ds_read_b64_tr_b16 v[148:149], v15 offset:2048
    ds_read_b64_tr_b16 v[150:151], v15 offset:3072
    s_cmp_lg_u32 s96, 0
    s_cbranch_scc1 L_pk5
L_pl5:
    buffer_load_dword v57, v8, s[32:35], s15 offen sc1
    s_add_u32 s47, s47, 1
    s_cmp_ge_u32 s47, 16384
    s_cselect_b32 s12, -1, 0
    s_waitcnt vmcnt(0)
    v_cmp_eq_u32 vcc, s23, v57
    s_nop 1
    s_or_b32 s12, s12, vcc_lo
    s_lshr_b32 s12, s12, s93
    s_or_b32 s96, s96, s12
    s_andn2_b32 s96, s96, s14
    s_cbranch_scc0 L_pl5
L_pk5:
    s_ff1_i32_b32 s12, s96
    s_bitset0_b32 s96, s12
    s_bitset1_b32 s14, s12
    s_add_u32 s12, s12, s93
    s_and_b32 s85, s12, 15
    s_lshl_b32 s94, s85, 11
    s_add_u32 s94, s94, s95
    buffer_load_dwordx4 v[112:115], v17, s[32:35], s94 offen
    buffer_load_dwordx4 v[116:119], v17, s[32:35], s94 offen offset:1024
    s_add_u32 s12, s84, s97
    s_lshl_b32 s13, s12, 12
    s_cmp_ge_u32 s12, 10
    s_cselect_b32 s12, 24576, 0
    s_add_u32 s13, s13, s12
    v_add_u32 v12, s13, v10
    v_add_u32 v13, s13, v11
    s_waitcnt vmcnt(4)
    s_waitcnt lgkmcnt(6)
    v_mfma_f32_32x32x16_bf16 v[64:79], v[136:139], v[96:99], v[64:79]
    ds_read_b64_tr_b16 v[120:121], v12 offset:0
    ds_read_b64_tr_b16 v[122:123], v12 offset:1024
    s_waitcnt lgkmcnt(6)
    v_mfma_f32_32x32x16_bf16 v[80:95], v[140:143], v[96:99], v[80:95]
    ds_read_b64_tr_b16 v[124:125], v13 offset:0
    ds_read_b64_tr_b16 v[126:127], v13 offset:1024
    s_waitcnt lgkmcnt(6)
    v_mfma_f32_32x32x16_bf16 v[64:79], v[144:147], v[100:103], v[64:79]
    ds_read_b64_tr_b16 v[128:129], v12 offset:2048
    ds_read_b64_tr_b16 v[130:131], v12 offset:3072
    s_waitcnt lgkmcnt(6)
    v_mfma_f32_32x32x16_bf16 v[80:95], v[148:151], v[100:103], v[80:95]
    ds_read_b64_tr_b16 v[132:133], v13 offset:2048
    ds_read_b64_tr_b16 v[134:135], v13 offset:3072
    s_cmp_lg_u32 s96, 0
    s_cbranch_scc1 L_pk6
L_pl6:
    buffer_load_dword v58, v8, s[32:35], s15 offen sc1
    s_add_u32 s47, s47, 1
    s_cmp_ge_u32 s47, 16384
    s_cselect_b32 s12, -1, 0
    s_waitcnt vmcnt(0)
    v_cmp_eq_u32 vcc, s23, v58
    s_nop 1
    s_or_b32 s12, s12, vcc_lo
    s_lshr_b32 s12, s12, s93
    s_or_b32 s96, s96, s12
    s_andn2_b32 s96, s96, s14
    s_cbranch_scc0 L_pl6
L_pk6:
    s_ff1_i32_b32 s12, s96
    s_bitset0_b32 s96, s12
    s_bitset1_b32 s14, s12
    s_add_u32 s12, s12, s93
    s_and_b32 s86, s12, 15
    s_lshl_b32 s94, s86, 11
    s_add_u32 s94, s94, s95
    buffer_load_dwordx4 v[96:99], v17, s[32:35], s94 offen
    buffer_load_dwordx4 v[100:103], v17, s[32:35], s94 offen offset:1024
    s_add_u32 s12, s85, s97
    s_lshl_b32 s13, s12, 12
    s_cmp_ge_u32 s12, 10
    s_cselect_b32 s12, 24576, 0
    s_add_u32 s13, s13, s12
    v_add_u32 v14, s13, v10
    v_add_u32 v15, s13, v11
    s_waitcnt vmcnt(4)
    s_waitcnt lgkmcnt(6)
    v_mfma_f32_32x32x16_bf16 v[64:79], v[120:123], v[104:107], v[64:79]
    ds_read_b64_tr_b16 v[136:137], v14 offset:0
    ds_read_b64_tr_b16 v[138:139], v14 offset:1024
    s_waitcnt lgkmcnt(6)
    v_mfma_f32_32x32x16_bf16 v[80:95], v[124:127], v[104:107], v[80:95]
    ds_read_b64_tr_b16 v[140:141], v15 offset:0
    ds_read_b64_tr_b16 v[142:143], v15 offset:1024
    s_waitcnt lgkmcnt(6)
    v_mfma_f32_32x32x16_bf16 v[64:79], v[128:131], v[108:111], v[64:79]
    ds_read_b64_tr_b16 v[144:145], v14 offset:2048
    ds_read_b64_tr_b16 v[146:147], v14 offset:3072
    s_waitcnt lgkmcnt(6)
    v_mfma_f32_32x32x16_bf16 v[80:95], v[132:135], v[108:111], v[80:95]
    ds_read_b64_tr_b16 v[148:149], v15 offset:2048
    ds_read_b64_tr_b16 v[150:151], v15 offset:3072
    s_cmp_lg_u32 s96, 0
    s_cbranch_scc1 L_pk7
L_pl7:
    buffer_load_dword v59, v8, s[32:35], s15 offen sc1
    s_add_u32 s47, s47, 1
    s_cmp_ge_u32 s47, 16384
    s_cselect_b32 s12, -1, 0
    s_waitcnt vmcnt(0)
    v_cmp_eq_u32 vcc, s23, v59
    s_nop 1
    s_or_b32 s12, s12, vcc_lo
    s_lshr_b32 s12, s12, s93
    s_or_b32 s96, s96, s12
    s_andn2_b32 s96, s96, s14
    s_cbranch_scc0 L_pl7
L_pk7:
    s_ff1_i32_b32 s12, s96
    s_bitset0_b32 s96, s12
    s_bitset1_b32 s14, s12
    s_add_u32 s12, s12, s93
    s_and_b32 s87, s12, 15
    s_lshl_b32 s94, s87, 11
    s_add_u32 s94, s94, s95
    buffer_load_dwordx4 v[104:107], v17, s[32:35], s94 offen
    buffer_load_dwordx4 v[108:111], v17, s[32:35], s94 offen offset:1024
    s_add_u32 s12, s86, s97
    s_lshl_b32 s13, s12, 12
    s_cmp_ge_u32 s12, 10
    s_cselect_b32 s12, 24576, 0
    s_add_u32 s13, s13, s12
    v_add_u32 v12, s13, v10
    v_add_u32 v13, s13, v11
    s_waitcnt vmcnt(4)
    s_waitcnt lgkmcnt(6)
    v_mfma_f32_32x32x16_bf16 v[64:79], v[136:139], v[112:115], v[64:79]
    ds_read_b64_tr_b16 v[120:121], v12 offset:0
    ds_read_b64_tr_b16 v[122:123], v12 offset:1024
    s_waitcnt lgkmcnt(6)
    v_mfma_f32_32x32x16_bf16 v[80:95], v[140:143], v[112:115], v[80:95]
    ds_read_b64_tr_b16 v[124:125], v13 offset:0
    ds_read_b64_tr_b16 v[126:127], v13 offset:1024
    s_waitcnt lgkmcnt(6)
    v_mfma_f32_32x32x16_bf16 v[64:79], v[144:147], v[116:119], v[64:79]
    ds_read_b64_tr_b16 v[128:129], v12 offset:2048
    ds_read_b64_tr_b16 v[130:131], v12 offset:3072
    s_waitcnt lgkmcnt(6)
    v_mfma_f32_32x32x16_bf16 v[80:95], v[148:151], v[116:119], v[80:95]
    ds_read_b64_tr_b16 v[132:133], v13 offset:2048
    ds_read_b64_tr_b16 v[134:135], v13 offset:3072
    s_cmp_lg_u32 s96, 0
    s_cbranch_scc1 L_pk8
L_pl8:
    buffer_load_dword v52, v8, s[32:35], s15 offen sc1
    s_add_u32 s47, s47, 1
    s_cmp_ge_u32 s47, 16384
    s_cselect_b32 s12, -1, 0
    s_waitcnt vmcnt(0)
    v_cmp_eq_u32 vcc, s23, v52
    s_nop 1
    s_or_b32 s12, s12, vcc_lo
    s_lshr_b32 s12, s12, s93
    s_or_b32 s96, s96, s12
    s_andn2_b32 s96, s96, s14
    s_cbranch_scc0 L_pl8
L_pk8:
    s_ff1_i32_b32 s12, s96
    s_bitset0_b32 s96, s12
    s_bitset1_b32 s14, s12
    s_add_u32 s12, s12, s93
    s_and_b32 s80, s12, 15
    s_lshl_b32 s94, s80, 11
    s_add_u32 s94, s94, s95
    buffer_load_dwordx4 v[112:115], v17, s[32:35], s94 offen
    buffer_load_dwordx4 v[116:119], v17, s[32:35], s94 offen offset:1024
    s_add_u32 s12, s87, s97
    s_lshl_b32 s13, s12, 12
    s_cmp_ge_u32 s12, 10
    s_cselect_b32 s12, 24576, 0
    s_add_u32 s13, s13, s12
    v_add_u32 v14, s13, v10
    v_add_u32 v15, s13, v11
    s_waitcnt vmcnt(4)
    s_waitcnt lgkmcnt(6)
    v_mfma_f32_32x32x16_bf16 v[64:79], v[120:123], v[96:99], v[64:79]
    ds_read_b64_tr_b16 v[136:137], v14 offset:0
    ds_read_b64_tr_b16 v[138:139], v14 offset:1024
    s_waitcnt lgkmcnt(6)
    v_mfma_f32_32x32x16_bf16 v[80:95], v[124:127], v[96:99], v[80:95]
    ds_read_b64_tr_b16 v[140:141], v15 offset:0
    ds_read_b64_tr_b16 v[142:143], v15 offset:1024
    s_waitcnt lgkmcnt(6)
    v_mfma_f32_32x32x16_bf16 v[64:79], v[128:131], v[100:103], v[64:79]
    ds_read_b64_tr_b16 v[144:145], v14 offset:2048
    ds_read_b64_tr_b16 v[146:147], v14 offset:3072
    s_waitcnt lgkmcnt(6)
    v_mfma_f32_32x32x16_bf16 v[80:95], v[132:135], v[100:103], v[80:95]
    ds_read_b64_tr_b16 v[148:149], v15 offset:2048
    ds_read_b64_tr_b16 v[150:151], v15 offset:3072
    s_cmp_lg_u32 s96, 0
    s_cbranch_scc1 L_pk9
L_pl9:
    buffer_load_dword v53, v8, s[32:35], s15 offen sc1
    s_add_u32 s47, s47, 1
    s_cmp_ge_u32 s47, 16384
    s_cselect_b32 s12, -1, 0
    s_waitcnt vmcnt(0)
    v_cmp_eq_u32 vcc, s23, v53
    s_nop 1
    s_or_b32 s12, s12, vcc_lo
    s_lshr_b32 s12, s12, s93
    s_or_b32 s96, s96, s12
    s_andn2_b32 s96, s96, s14
    s_cbranch_scc0 L_pl9
L_pk9:
    s_ff1_i32_b32 s12, s96
    s_bitset0_b32 s96, s12
    s_bitset1_b32 s14, s12
    s_add_u32 s12, s12, s93
    s_and_b32 s81, s12, 15
    s_lshl_b32 s94, s81, 11
    s_add_u32 s94, s94, s95
    buffer_load_dwordx4 v[96:99], v17, s[32:35], s94 offen
    buffer_load_dwordx4 v[100:103], v17, s[32:35], s94 offen offset:1024
    s_add_u32 s12, s80, s97
    s_lshl_b32 s13, s12, 12
    s_cmp_ge_u32 s12, 10
    s_cselect_b32 s12, 24576, 0
    s_add_u32 s13, s13, s12
    v_add_u32 v12, s13, v10
    v_add_u32 v13, s13, v11
    s_waitcnt vmcnt(4)
    s_waitcnt lgkmcnt(6)
    v_mfma_f32_32x32x16_bf16 v[64:79], v[136:139], v[104:107], v[64:79]
    ds_read_b64_tr_b16 v[120:121], v12 offset:0
    ds_read_b64_tr_b16 v[122:123], v12 offset:1024
    s_waitcnt lgkmcnt(6)
    v_mfma_f32_32x32x16_bf16 v[80:95], v[140:143], v[104:107], v[80:95]
    ds_read_b64_tr_b16 v[124:125], v13 offset:0
    ds_read_b64_tr_b16 v[126:127], v13 offset:1024
    s_waitcnt lgkmcnt(6)
    v_mfma_f32_32x32x16_bf16 v[64:79], v[144:147], v[108:111], v[64:79]
    ds_read_b64_tr_b16 v[128:129], v12 offset:2048
    ds_read_b64_tr_b16 v[130:131], v12 offset:3072
    s_waitcnt lgkmcnt(6)
    v_mfma_f32_32x32x16_bf16 v[80:95], v[148:151], v[108:111], v[80:95]
    ds_read_b64_tr_b16 v[132:133], v13 offset:2048
    ds_read_b64_tr_b16 v[134:135], v13 offset:3072
    s_cmp_lg_u32 s96, 0
    s_cbranch_scc1 L_pk10
L_pl10:
    buffer_load_dword v54, v8, s[32:35], s15 offen sc1
    s_add_u32 s47, s47, 1
    s_cmp_ge_u32 s47, 16384
    s_cselect_b32 s12, -1, 0
    s_waitcnt vmcnt(0)
    v_cmp_eq_u32 vcc, s23, v54
    s_nop 1
    s_or_b32 s12, s12, vcc_lo
    s_lshr_b32 s12, s12, s93
    s_or_b32 s96, s96, s12
    s_andn2_b32 s96, s96, s14
    s_cbranch_scc0 L_pl10
L_pk10:
    s_ff1_i32_b32 s12, s96
    s_bitset0_b32 s96, s12
    s_bitset1_b32 s14, s12
    s_add_u32 s12, s12, s93
    s_and_b32 s82, s12, 15
    s_lshl_b32 s94, s82, 11
    s_add_u32 s94, s94, s95
    buffer_load_dwordx4 v[104:107], v17, s[32:35], s94 offen
    buffer_load_dwordx4 v[108:111], v17, s[32:35], s94 offen offset:1024
    s_add_u32 s12, s81, s97
    s_lshl_b32 s13, s12, 12
    s_cmp_ge_u32 s12, 10
    s_cselect_b32 s12, 24576, 0
    s_add_u32 s13, s13, s12
    v_add_u32 v14, s13, v10
    v_add_u32 v15, s13, v11
    s_waitcnt vmcnt(4)
    s_waitcnt lgkmcnt(6)
    v_mfma_f32_32x32x16_bf16 v[64:79], v[120:123], v[112:115], v[64:79]
    ds_read_b64_tr_b16 v[136:137], v14 offset:0
    ds_read_b64_tr_b16 v[138:139], v14 offset:1024
    s_waitcnt lgkmcnt(6)
    v_mfma_f32_32x32x16_bf16 v[80:95], v[124:127], v[112:115], v[80:95]
    ds_read_b64_tr_b16 v[140:141], v15 offset:0
    ds_read_b64_tr_b16 v[142:143], v15 offset:1024
    s_waitcnt lgkmcnt(6)
    v_mfma_f32_32x32x16_bf16 v[64:79], v[128:131], v[116:119], v[64:79]
    ds_read_b64_tr_b16 v[144:145], v14 offset:2048
    ds_read_b64_tr_b16 v[146:147], v14 offset:3072
    s_waitcnt lgkmcnt(6)
    v_mfma_f32_32x32x16_bf16 v[80:95], v[132:135], v[116:119], v[80:95]
    ds_read_b64_tr_b16 v[148:149], v15 offset:2048
    ds_read_b64_tr_b16 v[150:151], v15 offset:3072
    s_cmp_lg_u32 s96, 0
    s_cbranch_scc1 L_pk11
L_pl11:
    buffer_load_dword v55, v8, s[32:35], s15 offen sc1
    s_add_u32 s47, s47, 1
    s_cmp_ge_u32 s47, 16384
    s_cselect_b32 s12, -1, 0
    s_waitcnt vmcnt(0)
    v_cmp_eq_u32 vcc, s23, v55
    s_nop 1
    s_or_b32 s12, s12, vcc_lo
    s_lshr_b32 s12, s12, s93
    s_or_b32 s96, s96, s12
    s_andn2_b32 s96, s96, s14
    s_cbranch_scc0 L_pl11
L_pk11:
    s_ff1_i32_b32 s12, s96
    s_bitset0_b32 s96, s12
    s_bitset1_b32 s14, s12
    s_add_u32 s12, s12, s93
    s_and_b32 s83, s12, 15
    s_lshl_b32 s94, s83, 11
    s_add_u32 s94, s94, s95
    buffer_load_dwordx4 v[112:115], v17, s[32:35], s94 offen
    buffer_load_dwordx4 v[116:119], v17, s[32:35], s94 offen offset:1024
    s_add_u32 s12, s82, s97
    s_lshl_b32 s13, s12, 12
    s_cmp_ge_u32 s12, 10
    s_cselect_b32 s12, 24576, 0
    s_add_u32 s13, s13, s12
    v_add_u32 v12, s13, v10
    v_add_u32 v13, s13, v11
    s_waitcnt vmcnt(4)
    s_waitcnt lgkmcnt(6)
    v_mfma_f32_32x32x16_bf16 v[64:79], v[136:139], v[96:99], v[64:79]
    ds_read_b64_tr_b16 v[120:121], v12 offset:0
    ds_read_b64_tr_b16 v[122:123], v12 offset:1024
    s_waitcnt lgkmcnt(6)
    v_mfma_f32_32x32x16_bf16 v[80:95], v[140:143], v[96:99], v[80:95]
    ds_read_b64_tr_b16 v[124:125], v13 offset:0
    ds_read_b64_tr_b16 v[126:127], v13 offset:1024
    s_waitcnt lgkmcnt(6)
    v_mfma_f32_32x32x16_bf16 v[64:79], v[144:147], v[100:103], v[64:79]
    ds_read_b64_tr_b16 v[128:129], v12 offset:2048
    ds_read_b64_tr_b16 v[130:131], v12 offset:3072
    s_waitcnt lgkmcnt(6)
    v_mfma_f32_32x32x16_bf16 v[80:95], v[148:151], v[100:103], v[80:95]
    ds_read_b64_tr_b16 v[132:133], v13 offset:2048
    ds_read_b64_tr_b16 v[134:135], v13 offset:3072
    s_cmp_lg_u32 s96, 0
    s_cbranch_scc1 L_pk12
L_pl12:
    buffer_load_dword v56, v8, s[32:35], s15 offen sc1
    s_add_u32 s47, s47, 1
    s_cmp_ge_u32 s47, 16384
    s_cselect_b32 s12, -1, 0
    s_waitcnt vmcnt(0)
    v_cmp_eq_u32 vcc, s23, v56
    s_nop 1
    s_or_b32 s12, s12, vcc_lo
    s_lshr_b32 s12, s12, s93
    s_or_b32 s96, s96, s12
    s_andn2_b32 s96, s96, s14
    s_cbranch_scc0 L_pl12
L_pk12:
    s_ff1_i32_b32 s12, s96
    s_bitset0_b32 s96, s12
    s_bitset1_b32 s14, s12
    s_add_u32 s12, s12, s93
    s_and_b32 s84, s12, 15
    s_lshl_b32 s94, s84, 11
    s_add_u32 s94, s94, s95
    buffer_load_dwordx4 v[96:99], v17, s[32:35], s94 offen
    buffer_load_dwordx4 v[100:103], v17, s[32:35], s94 offen offset:1024
    s_add_u32 s12, s83, s97
    s_lshl_b32 s13, s12, 12
    s_cmp_ge_u32 s12, 10
    s_cselect_b32 s12, 24576, 0
    s_add_u32 s13, s13, s12
    v_add_u32 v14, s13, v10
    v_add_u32 v15, s13, v11
    s_waitcnt vmcnt(4)
    s_waitcnt lgkmcnt(6)
    v_mfma_f32_32x32x16_bf16 v[64:79], v[120:123], v[104:107], v[64:79]
    ds_read_b64_tr_b16 v[136:137], v14 offset:0
    ds_read_b64_tr_b16 v[138:139], v14 offset:1024
    s_waitcnt lgkmcnt(6)
    v_mfma_f32_32x32x16_bf16 v[80:95], v[124:127], v[104:107], v[80:95]
    ds_read_b64_tr_b16 v[140:141], v15 offset:0
    ds_read_b64_tr_b16 v[142:143], v15 offset:1024
    s_waitcnt lgkmcnt(6)
    v_mfma_f32_32x32x16_bf16 v[64:79], v[128:131], v[108:111], v[64:79]
    ds_read_b64_tr_b16 v[144:145], v14 offset:2048
    ds_read_b64_tr_b16 v[146:147], v14 offset:3072
    s_waitcnt lgkmcnt(6)
    v_mfma_f32_32x32x16_bf16 v[80:95], v[132:135], v[108:111], v[80:95]
    ds_read_b64_tr_b16 v[148:149], v15 offset:2048
    ds_read_b64_tr_b16 v[150:151], v15 offset:3072
    s_cmp_lg_u32 s96, 0
    s_cbranch_scc1 L_pk13
L_pl13:
    buffer_load_dword v57, v8, s[32:35], s15 offen sc1
    s_add_u32 s47, s47, 1
    s_cmp_ge_u32 s47, 16384
    s_cselect_b32 s12, -1, 0
    s_waitcnt vmcnt(0)
    v_cmp_eq_u32 vcc, s23, v57
    s_nop 1
    s_or_b32 s12, s12, vcc_lo
    s_lshr_b32 s12, s12, s93
    s_or_b32 s96, s96, s12
    s_andn2_b32 s96, s96, s14
    s_cbranch_scc0 L_pl13
L_pk13:
    s_ff1_i32_b32 s12, s96
    s_bitset0_b32 s96, s12
    s_bitset1_b32 s14, s12
    s_add_u32 s12, s12, s93
    s_and_b32 s85, s12, 15
    s_lshl_b32 s94, s85, 11
    s_add_u32 s94, s94, s95
    buffer_load_dwordx4 v[104:107], v17, s[32:35], s94 offen
    buffer_load_dwordx4 v[108:111], v17, s[32:35], s94 offen offset:1024
    s_add_u32 s12, s84, s97
    s_lshl_b32 s13, s12, 12
    s_cmp_ge_u32 s12, 10
    s_cselect_b32 s12, 24576, 0
    s_add_u32 s13, s13, s12
    v_add_u32 v12, s13, v10
    v_add_u32 v13, s13, v11
    s_waitcnt vmcnt(4)
    s_waitcnt lgkmcnt(6)
    v_mfma_f32_32x32x16_bf16 v[64:79], v[136:139], v[112:115], v[64:79]
    ds_read_b64_tr_b16 v[120:121], v12 offset:0
    ds_read_b64_tr_b16 v[122:123], v12 offset:1024
    s_waitcnt lgkmcnt(6)
    v_mfma_f32_32x32x16_bf16 v[80:95], v[140:143], v[112:115], v[80:95]
    ds_read_b64_tr_b16 v[124:125], v13 offset:0
    ds_read_b64_tr_b16 v[126:127], v13 offset:1024
    s_waitcnt lgkmcnt(6)
    v_mfma_f32_32x32x16_bf16 v[64:79], v[144:147], v[116:119], v[64:79]
    ds_read_b64_tr_b16 v[128:129], v12 offset:2048
    ds_read_b64_tr_b16 v[130:131], v12 offset:3072
    s_waitcnt lgkmcnt(6)
    v_mfma_f32_32x32x16_bf16 v[80:95], v[148:151], v[116:119], v[80:95]
    ds_read_b64_tr_b16 v[132:133], v13 offset:2048
    ds_read_b64_tr_b16 v[134:135], v13 offset:3072
    s_cmp_lg_u32 s96, 0
    s_cbranch_scc1 L_pk14
L_pl14:
    buffer_load_dword v58, v8, s[32:35], s15 offen sc1
    s_add_u32 s47, s47, 1
    s_cmp_ge_u32 s47, 16384
    s_cselect_b32 s12, -1, 0
    s_waitcnt vmcnt(0)
    v_cmp_eq_u32 vcc, s23, v58
    s_nop 1
    s_or_b32 s12, s12, vcc_lo
    s_lshr_b32 s12, s12, s93
    s_or_b32 s96, s96, s12
    s_andn2_b32 s96, s96, s14
    s_cbranch_scc0 L_pl14
L_pk14:
    s_ff1_i32_b32 s12, s96
    s_bitset0_b32 s96, s12
    s_bitset1_b32 s14, s12
    s_add_u32 s12, s12, s93
    s_and_b32 s86, s12, 15
    s_lshl_b32 s94, s86, 11
    s_add_u32 s94, s94, s95
    buffer_load_dwordx4 v[112:115], v17, s[32:35], s94 offen
    buffer_load_dwordx4 v[116:119], v17, s[32:35], s94 offen offset:1024
    s_add_u32 s12, s85, s97
    s_lshl_b32 s13, s12, 12
    s_cmp_ge_u32 s12, 10
    s_cselect_b32 s12, 24576, 0
    s_add_u32 s13, s13, s12
    v_add_u32 v14, s13, v10
    v_add_u32 v15, s13, v11
    s_waitcnt vmcnt(4)
    s_waitcnt lgkmcnt(6)
    v_mfma_f32_32x32x16_bf16 v[64:79], v[120:123], v[96:99], v[64:79]
    ds_read_b64_tr_b16 v[136:137], v14 offset:0
    ds_read_b64_tr_b16 v[138:139], v14 offset:1024
    s_waitcnt lgkmcnt(6)
    v_mfma_f32_32x32x16_bf16 v[80:95], v[124:127], v[96:99], v[80:95]
    ds_read_b64_tr_b16 v[140:141], v15 offset:0
    ds_read_b64_tr_b16 v[142:143], v15 offset:1024
    s_waitcnt lgkmcnt(6)
    v_mfma_f32_32x32x16_bf16 v[64:79], v[128:131], v[100:103], v[64:79]
    ds_read_b64_tr_b16 v[144:145], v14 offset:2048
    ds_read_b64_tr_b16 v[146:147], v14 offset:3072
    s_waitcnt lgkmcnt(6)
    v_mfma_f32_32x32x16_bf16 v[80:95], v[132:135], v[100:103], v[80:95]
    ds_read_b64_tr_b16 v[148:149], v15 offset:2048
    ds_read_b64_tr_b16 v[150:151], v15 offset:3072
    s_cmp_lg_u32 s96, 0
    s_cbranch_scc1 L_pk15
L_pl15:
    buffer_load_dword v59, v8, s[32:35], s15 offen sc1
    s_add_u32 s47, s47, 1
    s_cmp_ge_u32 s47, 16384
    s_cselect_b32 s12, -1, 0
    s_waitcnt vmcnt(0)
    v_cmp_eq_u32 vcc, s23, v59
    s_nop 1
    s_or_b32 s12, s12, vcc_lo
    s_lshr_b32 s12, s12, s93
    s_or_b32 s96, s96, s12
    s_andn2_b32 s96, s96, s14
    s_cbranch_scc0 L_pl15
L_pk15:
    s_ff1_i32_b32 s12, s96
    s_bitset0_b32 s96, s12
    s_bitset1_b32 s14, s12
    s_add_u32 s12, s12, s93
    s_and_b32 s87, s12, 15
    s_lshl_b32 s94, s87, 11
    s_add_u32 s94, s94, s95
    buffer_load_dwordx4 v[96:99], v17, s[32:35], s94 offen
    buffer_load_dwordx4 v[100:103], v17, s[32:35], s94 offen offset:1024
    s_add_u32 s12, s86, s97
    s_lshl_b32 s13, s12, 12
    s_cmp_ge_u32 s12, 10
    s_cselect_b32 s12, 24576, 0
    s_add_u32 s13, s13, s12
    v_add_u32 v12, s13, v10
    v_add_u32 v13, s13, v11
    s_waitcnt vmcnt(4)
    s_waitcnt lgkmcnt(6)
    v_mfma_f32_32x32x16_bf16 v[64:79], v[136:139], v[104:107], v[64:79]
    ds_read_b64_tr_b16 v[120:121], v12 offset:0
    ds_read_b64_tr_b16 v[122:123], v12 offset:1024
    s_waitcnt lgkmcnt(6)
    v_mfma_f32_32x32x16_bf16 v[80:95], v[140:143], v[104:107], v[80:95]
    ds_read_b64_tr_b16 v[124:125], v13 offset:0
    ds_read_b64_tr_b16 v[126:127], v13 offset:1024
    s_waitcnt lgkmcnt(6)
    v_mfma_f32_32x32x16_bf16 v[64:79], v[144:147], v[108:111], v[64:79]
    ds_read_b64_tr_b16 v[128:129], v12 offset:2048
    ds_read_b64_tr_b16 v[130:131], v12 offset:3072
    s_waitcnt lgkmcnt(6)
    v_mfma_f32_32x32x16_bf16 v[80:95], v[148:151], v[108:111], v[80:95]
    ds_read_b64_tr_b16 v[132:133], v13 offset:2048
    ds_read_b64_tr_b16 v[134:135], v13 offset:3072
    s_add_u32 s12, s87, s97
    s_lshl_b32 s13, s12, 12
    s_cmp_ge_u32 s12, 10
    s_cselect_b32 s12, 24576, 0
    s_add_u32 s13, s13, s12
    v_add_u32 v14, s13, v10
    v_add_u32 v15, s13, v11
    s_waitcnt vmcnt(2)
    s_waitcnt lgkmcnt(6)
    v_mfma_f32_32x32x16_bf16 v[64:79], v[120:123], v[112:115], v[64:79]
    ds_read_b64_tr_b16 v[136:137], v14 offset:0
    ds_read_b64_tr_b16 v[138:139], v14 offset:1024
    s_waitcnt lgkmcnt(6)
    v_mfma_f32_32x32x16_bf16 v[80:95], v[124:127], v[112:115], v[80:95]
    ds_read_b64_tr_b16 v[140:141], v15 offset:0
    ds_read_b64_tr_b16 v[142:143], v15 offset:1024
    s_waitcnt lgkmcnt(6)
    v_mfma_f32_32x32x16_bf16 v[64:79], v[128:131], v[116:119], v[64:79]
    ds_read_b64_tr_b16 v[144:145], v14 offset:2048
    ds_read_b64_tr_b16 v[146:147], v14 offset:3072
    s_waitcnt lgkmcnt(6)
    v_mfma_f32_32x32x16_bf16 v[80:95], v[132:135], v[116:119], v[80:95]
    ds_read_b64_tr_b16 v[148:149], v15 offset:2048
    ds_read_b64_tr_b16 v[150:151], v15 offset:3072
    s_waitcnt vmcnt(0)
    s_waitcnt lgkmcnt(6)
    v_mfma_f32_32x32x16_bf16 v[64:79], v[136:139], v[96:99], v[64:79]
    s_waitcnt lgkmcnt(4)
    v_mfma_f32_32x32x16_bf16 v[80:95], v[140:143], v[96:99], v[80:95]
    s_waitcnt lgkmcnt(2)
    v_mfma_f32_32x32x16_bf16 v[64:79], v[144:147], v[100:103], v[64:79]
    s_waitcnt lgkmcnt(0)
    v_mfma_f32_32x32x16_bf16 v[80:95], v[148:151], v[100:103], v[80:95]
    s_nop 11
    v_permlane16_swap_b32 v64, v80
    v_permlane16_swap_b32 v65, v81
    v_permlane16_swap_b32 v66, v82
    v_permlane16_swap_b32 v67, v83
    v_permlane16_swap_b32 v68, v84
    v_permlane16_swap_b32 v69, v85
    v_permlane16_swap_b32 v70, v86
    v_permlane16_swap_b32 v71, v87
    v_permlane16_swap_b32 v72, v88
    v_permlane16_swap_b32 v73, v89
    v_permlane16_swap_b32 v74, v90
    v_permlane16_swap_b32 v75, v91
    v_permlane16_swap_b32 v76, v92
    v_permlane16_swap_b32 v77, v93
    v_permlane16_swap_b32 v78, v94
    v_permlane16_swap_b32 v79, v95
    ds_write_b128 v20, v[80:83] offset:0
    ds_write_b128 v20, v[84:87] offset:1024
    ds_write_b128 v20, v[88:91] offset:2048
    ds_write_b128 v20, v[92:95] offset:3072
    s_waitcnt lgkmcnt(0)
    v_bfe_u32 v9, v2, 3, 1
    v_mul_u32_u24 v9, 16352, v9
    v_sub_u32 v7, v7, v9
    s_mov_b32 s12, 16384
    s_barrier
    ds_read_b128 v[80:83], v21 offset:0
    ds_read_b128 v[84:87], v21 offset:1024
    ds_read_b128 v[88:91], v21 offset:2048
    ds_read_b128 v[92:95], v21 offset:3072
    s_waitcnt lgkmcnt(3)
    v_pk_add_f32 v[64:65], v[64:65], v[80:81]
    v_pk_add_f32 v[66:67], v[66:67], v[82:83]
    v_cvt_pk_bf16_f32 v96, v64, v65
    v_cvt_pk_bf16_f32 v97, v66, v67
    s_waitcnt lgkmcnt(2)
    v_pk_add_f32 v[68:69], v[68:69], v[84:85]
    v_pk_add_f32 v[70:71], v[70:71], v[86:87]
    v_cvt_pk_bf16_f32 v98, v68, v69
    v_cvt_pk_bf16_f32 v99, v70, v71
    s_waitcnt lgkmcnt(1)
    v_pk_add_f32 v[72:73], v[72:73], v[88:89]
    v_pk_add_f32 v[74:75], v[74:75], v[90:91]
    v_cvt_pk_bf16_f32 v100, v72, v73
    v_cvt_pk_bf16_f32 v101, v74, v75
    s_waitcnt lgkmcnt(0)
    v_pk_add_f32 v[76:77], v[76:77], v[92:93]
    v_pk_add_f32 v[78:79], v[78:79], v[94:95]
    v_cvt_pk_bf16_f32 v102, v76, v77
    v_cvt_pk_bf16_f32 v103, v78, v79
    v_permlane32_swap_b32 v96, v98
    v_permlane32_swap_b32 v97, v99
    v_permlane32_swap_b32 v100, v102
    v_permlane32_swap_b32 v101, v103
    v_lshlrev_b32 v104, 16, v96
    v_and_b32 v105, 0xffff0000, v96
    v_lshlrev_b32 v106, 16, v97
    v_and_b32 v107, 0xffff0000, v97
    v_lshlrev_b32 v108, 16, v98
    v_and_b32 v109, 0xffff0000, v98
    v_lshlrev_b32 v110, 16, v99
    v_and_b32 v111, 0xffff0000, v99
    v_pk_mul_f32 v[104:105], v[104:105], v[48:49] op_sel_hi:[1,0]
    v_pk_mul_f32 v[106:107], v[106:107], v[48:49] op_sel_hi:[1,0]
    v_pk_mul_f32 v[108:109], v[108:109], v[48:49] op_sel_hi:[1,0]
    v_pk_mul_f32 v[110:111], v[110:111], v[48:49] op_sel_hi:[1,0]
    v_cvt_pk_bf16_f32 v96, v104, v105
    v_cvt_pk_bf16_f32 v97, v106, v107
    v_cvt_pk_bf16_f32 v98, v108, v109
    v_cvt_pk_bf16_f32 v99, v110, v111
    v_lshlrev_b32 v104, 16, v96
    v_and_b32 v105, 0xffff0000, v96
    v_lshlrev_b32 v106, 16, v97
    v_and_b32 v107, 0xffff0000, v97
    v_lshlrev_b32 v108, 16, v98
    v_and_b32 v109, 0xffff0000, v98
    v_lshlrev_b32 v110, 16, v99
    v_and_b32 v111, 0xffff0000, v99
    v_pk_add_f32 v[104:105], v[104:105], v[32:33]
    v_pk_add_f32 v[106:107], v[106:107], v[34:35]
    v_pk_add_f32 v[108:109], v[108:109], v[36:37]
    v_pk_add_f32 v[110:111], v[110:111], v[38:39]
    v_cvt_pk_bf16_f32 v96, v104, v105
    v_cvt_pk_bf16_f32 v97, v106, v107
    v_cvt_pk_bf16_f32 v98, v108, v109
    v_cvt_pk_bf16_f32 v99, v110, v111
    v_lshlrev_b32 v112, 16, v100
    v_and_b32 v113, 0xffff0000, v100
    v_lshlrev_b32 v114, 16, v101
    v_and_b32 v115, 0xffff0000, v101
    v_lshlrev_b32 v116, 16, v102
    v_and_b32 v117, 0xffff0000, v102
    v_lshlrev_b32 v118, 16, v103
    v_and_b32 v119, 0xffff0000, v103
    v_pk_mul_f32 v[112:113], v[112:113], v[48:49] op_sel_hi:[1,0]
    v_pk_mul_f32 v[114:115], v[114:115], v[48:49] op_sel_hi:[1,0]
    v_pk_mul_f32 v[116:117], v[116:117], v[48:49] op_sel_hi:[1,0]
    v_pk_mul_f32 v[118:119], v[118:119], v[48:49] op_sel_hi:[1,0]
    v_cvt_pk_bf16_f32 v100, v112, v113
    v_cvt_pk_bf16_f32 v101, v114, v115
    v_cvt_pk_bf16_f32 v102, v116, v117
    v_cvt_pk_bf16_f32 v103, v118, v119
    v_lshlrev_b32 v112, 16, v100
    v_and_b32 v113, 0xffff0000, v100
    v_lshlrev_b32 v114, 16, v101
    v_and_b32 v115, 0xffff0000, v101
    v_lshlrev_b32 v116, 16, v102
    v_and_b32 v117, 0xffff0000, v102
    v_lshlrev_b32 v118, 16, v103
    v_and_b32 v119, 0xffff0000, v103
    v_pk_add_f32 v[112:113], v[112:113], v[40:41]
    v_pk_add_f32 v[114:115], v[114:115], v[42:43]
    v_pk_add_f32 v[116:117], v[116:117], v[44:45]
    v_pk_add_f32 v[118:119], v[118:119], v[46:47]
    v_cvt_pk_bf16_f32 v100, v112, v113
    v_cvt_pk_bf16_f32 v101, v114, v115
    v_cvt_pk_bf16_f32 v102, v116, v117
    v_cvt_pk_bf16_f32 v103, v118, v119
    v_mov_b32 v104, v100
    v_mov_b32 v105, v101
    v_mov_b32 v106, v102
    v_mov_b32 v107, v103
    v_mov_b32_dpp v100, v96 row_ror:8 row_mask:0xf bank_mask:0x3
    v_mov_b32_dpp v101, v97 row_ror:8 row_mask:0xf bank_mask:0x3
    v_mov_b32_dpp v102, v98 row_ror:8 row_mask:0xf bank_mask:0x3
    v_mov_b32_dpp v103, v99 row_ror:8 row_mask:0xf bank_mask:0x3
    v_mov_b32_dpp v96, v104 row_ror:8 row_mask:0xf bank_mask:0xc
    v_mov_b32_dpp v97, v105 row_ror:8 row_mask:0xf bank_mask:0xc
    v_mov_b32_dpp v98, v106 row_ror:8 row_mask:0xf bank_mask:0xc
    v_mov_b32_dpp v99, v107 row_ror:8 row_mask:0xf bank_mask:0xc
    buffer_store_dwordx4 v[96:99], v7, s[68:71], 0 offen sc1
    buffer_store_dwordx4 v[100:103], v7, s[68:71], s12 offen sc1
    s_endpgm
L_end:
    s_endpgm
.section .rodata,"a"
.p2align 6
.amdhsa_kernel gated_mix__linear_kernel_hedgehog__moe_arch_mod__prompt_kernel
  .amdhsa_next_free_vgpr 256
  .amdhsa_next_free_sgpr 102
  .amdhsa_accum_offset 256
  .amdhsa_group_segment_fixed_size 0
  .amdhsa_kernarg_size 104
  .amdhsa_user_sgpr_count 2
  .amdhsa_user_sgpr_kernarg_segment_ptr 1
  .amdhsa_system_sgpr_workgroup_id_x 1
.end_amdhsa_kernel
```

```asm
; @launch grid=(256,1,1) block=(512,1,1) lds=163840
.amdgcn_target "amdgcn-amd-amdhsa--gfx950"
.text
.globl gated_mix__linear_kernel_hedgehog__moe_arch_mod__prompt_kernel
.p2align 8
.type gated_mix__linear_kernel_hedgehog__moe_arch_mod__prompt_kernel,@function
gated_mix__linear_kernel_hedgehog__moe_arch_mod__prompt_kernel:
    s_cmp_ge_u32 s2, 256
    s_cbranch_scc1 L_end
    s_load_dwordx4 s[4:7], s[0:1], 0
    s_load_dwordx4 s[8:11], s[0:1], 16
    s_load_dwordx16 s[48:63], s[0:1], 40
    v_lshrrev_b32 v1, 6, v0
    v_and_b32 v2, 63, v0
    v_readfirstlane_b32 s20, v1
    s_and_b32 s16, s2, 7
    s_lshr_b32 s17, s2, 3
    s_and_b32 s18, s16, 1
    s_lshl_b32 s18, s18, 3
    s_and_b32 s19, s17, 7
    s_add_u32 s18, s18, s19
    s_lshr_b32 s19, s16, 1
    s_lshl_b32 s19, s19, 2
    s_lshr_b32 s12, s17, 3
    s_add_u32 s19, s19, s12
    v_lshlrev_b32 v5, 4, v2
    s_cmp_lt_u32 s20, 4
    s_cbranch_scc1 L_compute
    s_sub_u32 s21, s20, 4
    s_mov_b32 s68, 0x76543210
    s_mov_b32 s69, 0xfedcba98
    s_lshl_b32 s12, s16, 1
    s_mul_i32 s12, s12, 0x11111111
    s_xor_b32 s68, s68, s12
    s_xor_b32 s69, s69, s12
    v_lshrrev_b32 v4, 3, v2
    v_lshlrev_b32 v9, 11, v4
    v_and_b32 v6, 7, v2
    v_lshrrev_b32 v7, 4, v2
    v_xor_b32 v8, v6, v7
    v_lshl_add_u32 v10, v8, 4, v9
    v_xor_b32 v8, 4, v8
    v_lshl_add_u32 v11, v8, 4, v9
    v_mul_u32_u24 v12, 6144, v4
    v_and_b32 v7, 1, v7
    v_lshlrev_b32 v7, 2, v7
    v_xor_b32 v8, v6, v7
    v_lshl_add_u32 v12, v8, 4, v12
    s_lshl_b32 s12, s18, 18
    s_lshl_b32 s13, s21, 16
    s_add_u32 s12, s12, s13
    s_add_u32 s13, s12, 0
    v_add_u32 v20, s13, v10
    s_add_u32 s13, s12, 15360
    v_add_u32 v21, s13, v11
    s_add_u32 s13, s12, 30720
    v_add_u32 v22, s13, v10
    s_add_u32 s13, s12, 46080
    v_add_u32 v23, s13, v11
    s_lshl_b32 s12, s19, 7
    s_mul_i32 s14, s21, 6
    s_add_u32 s13, s14, 0
    s_and_b32 s15, s13, 7
    s_mul_i32 s15, s15, 49152
    s_lshr_b32 s13, s13, 3
    s_lshl_b32 s13, s13, 11
    s_add_u32 s13, s13, s15
    s_add_u32 s13, s13, s12
    s_sub_u32 s13, s13, 0
    v_add_u32 v24, s13, v12
    s_add_u32 s13, s14, 1
    s_and_b32 s15, s13, 7
    s_mul_i32 s15, s15, 49152
    s_lshr_b32 s13, s13, 3
    s_lshl_b32 s13, s13, 11
    s_add_u32 s13, s13, s15
    s_add_u32 s13, s13, s12
    s_sub_u32 s13, s13, 1024
    v_add_u32 v25, s13, v12
    s_add_u32 s13, s14, 2
    s_and_b32 s15, s13, 7
    s_mul_i32 s15, s15, 49152
    s_lshr_b32 s13, s13, 3
    s_lshl_b32 s13, s13, 11
    s_add_u32 s13, s13, s15
    s_add_u32 s13, s13, s12
    s_sub_u32 s13, s13, 2048
    v_add_u32 v26, s13, v12
    s_add_u32 s13, s14, 3
    s_and_b32 s15, s13, 7
    s_mul_i32 s15, s15, 49152
    s_lshr_b32 s13, s13, 3
    s_lshl_b32 s13, s13, 11
    s_add_u32 s13, s13, s15
    s_add_u32 s13, s13, s12
    s_sub_u32 s13, s13, 0
    v_add_u32 v27, s13, v12
    s_add_u32 s13, s14, 4
    s_and_b32 s15, s13, 7
    s_mul_i32 s15, s15, 49152
    s_lshr_b32 s13, s13, 3
    s_lshl_b32 s13, s13, 11
    s_add_u32 s13, s13, s15
    s_add_u32 s13, s13, s12
    s_sub_u32 s13, s13, 1024
    v_add_u32 v28, s13, v12
    s_add_u32 s13, s14, 5
    s_and_b32 s15, s13, 7
    s_mul_i32 s15, s15, 49152
    s_lshr_b32 s13, s13, 3
    s_lshl_b32 s13, s13, 11
    s_add_u32 s13, s13, s15
    s_add_u32 s13, s13, s12
    s_sub_u32 s13, s13, 2048
    v_add_u32 v29, s13, v12
    s_lshl_b32 s94, s21, 12
    s_mul_i32 s95, s21, 6144
    s_add_u32 s95, s95, 16384
    s_waitcnt lgkmcnt(0)
    s_mov_b32 s24, s4
    s_and_b32 s25, s5, 0xffff
    s_mov_b32 s26, 4194304
    s_mov_b32 s27, 0x00020000
    s_mov_b32 s28, s6
    s_and_b32 s29, s7, 0xffff
    s_mov_b32 s30, 6291456
    s_mov_b32 s31, 0x00020000
    s_bfe_u32 s91, s68, 0x40000
    s_lshl_b32 s92, s91, 7
    s_mul_i32 s93, s91, 393216
    s_add_u32 m0, s94, 0
    s_nop 0
    buffer_load_dwordx4 v20, s[24:27], s92 offen offset:0 lds
    buffer_load_dwordx4 v21, s[24:27], s92 offen offset:1024 lds
    buffer_load_dwordx4 v22, s[24:27], s92 offen offset:2048 lds
    buffer_load_dwordx4 v23, s[24:27], s92 offen offset:3072 lds
    s_add_u32 m0, s95, 0
    s_nop 0
    buffer_load_dwordx4 v24, s[28:31], s93 offen offset:0 lds
    buffer_load_dwordx4 v25, s[28:31], s93 offen offset:1024 lds
    buffer_load_dwordx4 v26, s[28:31], s93 offen offset:2048 lds
    s_add_u32 m0, s95, 3072
    s_nop 0
    buffer_load_dwordx4 v27, s[28:31], s93 offen offset:0 lds
    buffer_load_dwordx4 v28, s[28:31], s93 offen offset:1024 lds
    buffer_load_dwordx4 v29, s[28:31], s93 offen offset:2048 lds
    s_bfe_u32 s91, s68, 0x40004
    s_lshl_b32 s92, s91, 7
    s_mul_i32 s93, s91, 393216
    s_add_u32 m0, s94, 40960
    s_nop 0
    buffer_load_dwordx4 v20, s[24:27], s92 offen offset:0 lds
    buffer_load_dwordx4 v21, s[24:27], s92 offen offset:1024 lds
    buffer_load_dwordx4 v22, s[24:27], s92 offen offset:2048 lds
    buffer_load_dwordx4 v23, s[24:27], s92 offen offset:3072 lds
    s_add_u32 m0, s95, 40960
    s_nop 0
    buffer_load_dwordx4 v24, s[28:31], s93 offen offset:0 lds
    buffer_load_dwordx4 v25, s[28:31], s93 offen offset:1024 lds
    s_mov_b32 s32, s62
    s_and_b32 s33, s63, 0xffff
    s_mov_b32 s34, 33554432
    s_mov_b32 s35, 0x00020000
    s_mov_b32 s36, s10
    s_and_b32 s37, s11, 0xffff
    s_mov_b32 s38, 2097152
    s_mov_b32 s39, 0x00020000
    s_mov_b32 s40, s50
    s_and_b32 s41, s51, 0xffff
    s_mov_b32 s42, 7340032
    s_mov_b32 s43, 0x00020000
    s_mov_b32 s44, s52
    s_and_b32 s45, s53, 0xffff
    s_mov_b32 s46, 7340032
    s_mov_b32 s47, 0x00020000
    s_mov_b32 s64, s54
    s_and_b32 s65, s55, 0xffff
    s_mov_b32 s66, 7340032
    s_mov_b32 s67, 0x00020000
    s_mov_b32 s72, s60
    s_and_b32 s73, s61, 0xffff
    s_mov_b32 s74, 256
    s_mov_b32 s75, 0x00020000
    s_mov_b32 s76, s8
    s_and_b32 s77, s9, 0xffff
    s_mov_b32 s78, 65536
    s_mov_b32 s79, 0x00020000
    s_mov_b32 s80, s48
    s_and_b32 s81, s49, 0xffff
    s_mov_b32 s82, 2048
    s_mov_b32 s83, 0x00020000
    s_mov_b32 s84, s56
    s_and_b32 s85, s57, 0xffff
    s_mov_b32 s86, 2048
    s_mov_b32 s87, 0x00020000
    s_cmp_lt_u32 s2, 224
    s_cselect_b32 s42, s42, 0
    s_cselect_b32 s46, s46, 0
    s_and_b32 s88, s16, 1
    s_lshl_b32 s88, s88, 3
    s_lshr_b32 s89, s16, 1
    s_lshl_b32 s89, s89, 1
    s_add_u32 s88, s88, s89
    s_lshr_b32 s89, s17, 4
    s_add_u32 s88, s88, s89
    s_and_b32 s89, s17, 15
    v_mov_b32 v13, 0
    v_mul_u32_u24 v30, 57344, v4
    v_lshl_add_u32 v30, v6, 4, v30
    v_lshl_add_u32 v31, v6, 4, v9
    v_lshl_add_u32 v33, v8, 4, v9
    s_lshl_b32 s12, s89, 7
    v_add_u32 v33, s12, v33
    v_lshlrev_b32 v34, 4, v4
    s_and_b32 s12, s2, 3
    s_lshl_b32 s12, s12, 8
    s_lshl_b32 s13, s21, 6
    s_add_u32 s70, s12, s13
    s_mul_i32 s71, s70, 7168
    s_lshr_b32 s12, s2, 2
    s_lshl_b32 s12, s12, 7
    s_add_u32 s71, s71, s12
    s_and_b32 s12, s2, 15
    s_mul_i32 s12, s12, 224
    s_mul_i32 s13, s21, 56
    s_add_u32 s96, s12, s13
    s_lshl_b32 s97, s96, 11
    s_lshr_b32 s12, s2, 4
    s_lshl_b32 s12, s12, 7
    s_add_u32 s97, s97, s12
    s_lshl_b32 s22, s18, 7
    s_lshl_b32 s12, s19, 3
    s_add_u32 s22, s22, s12
    s_lshl_b32 s12, s21, 1
    s_add_u32 s22, s22, s12
    s_mul_i32 s12, s2, 13108
    s_lshr_b32 s12, s12, 16
    s_mul_i32 s12, s12, 5
    s_sub_u32 s3, s2, s12
    s_waitcnt vmcnt(6)
    s_barrier
    s_cmp_eq_u32 s3, 1
    s_cbranch_scc1 L_var1
    s_cmp_eq_u32 s3, 2
    s_cbranch_scc1 L_var2
    s_cmp_eq_u32 s3, 3
    s_cbranch_scc1 L_var3
    s_cmp_eq_u32 s3, 4
    s_cbranch_scc1 L_var4
L_var0:
    s_nop 0
    s_add_u32 m0, s95, 40960
    s_nop 0
    buffer_load_dwordx4 v26, s[28:31], s93 offen offset:2048 lds
    s_add_u32 m0, s95, 44032
    s_nop 0
    buffer_load_dwordx4 v27, s[28:31], s93 offen offset:0 lds
    buffer_load_dwordx4 v28, s[28:31], s93 offen offset:1024 lds
    buffer_load_dwordx4 v29, s[28:31], s93 offen offset:2048 lds
    s_bfe_u32 s91, s68, 0x40008
    s_lshl_b32 s92, s91, 7
    s_mul_i32 s93, s91, 393216
    s_add_u32 m0, s94, 81920
    s_nop 0
    buffer_load_dwordx4 v20, s[24:27], s92 offen offset:0 lds
    buffer_load_dwordx4 v21, s[24:27], s92 offen offset:1024 lds
    buffer_load_dwordx4 v22, s[24:27], s92 offen offset:2048 lds
    buffer_load_dwordx4 v23, s[24:27], s92 offen offset:3072 lds
    s_add_u32 m0, s95, 81920
    s_nop 0
    buffer_load_dwordx4 v24, s[28:31], s93 offen offset:0 lds
    buffer_load_dwordx4 v25, s[28:31], s93 offen offset:1024 lds
    buffer_load_dwordx4 v26, s[28:31], s93 offen offset:2048 lds
    s_add_u32 m0, s95, 84992
    s_nop 0
    buffer_load_dwordx4 v27, s[28:31], s93 offen offset:0 lds
    buffer_load_dwordx4 v28, s[28:31], s93 offen offset:1024 lds
    buffer_load_dwordx4 v29, s[28:31], s93 offen offset:2048 lds
    s_lshl_b32 s12, s19, 2
    s_add_u32 s12, s12, s21
    s_lshl_b32 s12, s12, 10
    s_lshl_b32 s13, s21, 10
    s_add_u32 m0, s13, 155648
    s_nop 0
    buffer_load_dwordx4 v5, s[76:79], s12 offen lds
    s_lshl_b32 s12, s22, 11
    buffer_load_dwordx4 v[40:43], v5, s[24:27], s12 offen offset:0
    buffer_load_dwordx4 v[44:47], v5, s[24:27], s12 offen offset:1024
    buffer_load_dwordx4 v[48:51], v5, s[24:27], s12 offen offset:2048
    buffer_load_dwordx4 v[52:55], v5, s[24:27], s12 offen offset:3072
    buffer_load_dwordx4 v[56:59], v5, s[80:83], 0 offen offset:0
    buffer_load_dwordx4 v[60:63], v5, s[80:83], 0 offen offset:1024
    buffer_load_dwordx4 v[64:67], v5, s[84:87], 0 offen offset:0
    buffer_load_dwordx4 v[68:71], v5, s[84:87], 0 offen offset:1024
    s_add_u32 s12, s71, 0
    buffer_load_dwordx4 v[128:131], v30, s[40:43], s12 offen nt
    s_add_u32 s12, s71, 7168
    buffer_load_dwordx4 v[132:135], v30, s[40:43], s12 offen nt
    s_add_u32 s12, s71, 14336
    buffer_load_dwordx4 v[136:139], v30, s[40:43], s12 offen nt
    s_add_u32 s12, s71, 21504
    buffer_load_dwordx4 v[140:143], v30, s[40:43], s12 offen nt
    s_add_u32 s12, s71, 28672
    buffer_load_dwordx4 v[144:147], v30, s[40:43], s12 offen nt
    s_add_u32 s12, s71, 35840
    buffer_load_dwordx4 v[148:151], v30, s[40:43], s12 offen nt
    s_add_u32 s12, s71, 43008
    buffer_load_dwordx4 v[152:155], v30, s[40:43], s12 offen nt
    s_add_u32 s12, s71, 50176
    buffer_load_dwordx4 v[156:159], v30, s[40:43], s12 offen nt
    s_waitcnt vmcnt(27)
    s_barrier
    s_bfe_u32 s91, s68, 0x4000c
    s_lshl_b32 s92, s91, 7
    s_mul_i32 s93, s91, 393216
    s_add_u32 m0, s94, 0
    s_nop 0
    buffer_load_dwordx4 v20, s[24:27], s92 offen offset:0 lds
    buffer_load_dwordx4 v21, s[24:27], s92 offen offset:1024 lds
    buffer_load_dwordx4 v22, s[24:27], s92 offen offset:2048 lds
    buffer_load_dwordx4 v23, s[24:27], s92 offen offset:3072 lds
    s_add_u32 m0, s95, 0
    s_nop 0
    buffer_load_dwordx4 v24, s[28:31], s93 offen offset:0 lds
    s_cmp_lg_u32 s21, 0
    s_cbranch_scc1 L_noclr_0
    v_mov_b32 v104, -1
    v_mov_b32 v105, -1
    v_mov_b32 v106, -1
    v_mov_b32 v107, -1
    s_lshl_b32 s12, s19, 13
    s_lshl_b32 s13, s18, 9
    s_add_u32 s12, s12, s13
    s_add_u32 s12, s12, 32768
    s_lshl_b32 s13, s19, 11
    s_lshl_b32 s90, s18, 7
    s_add_u32 s13, s13, s90
    s_add_u32 s13, s13, 163840
    s_mov_b32 exec_hi, 0
    buffer_store_dwordx4 v[104:107], v5, s[32:35], s12 offen sc1
    s_mov_b32 exec_lo, 255
    buffer_store_dwordx4 v[104:107], v5, s[32:35], s13 offen sc1
    s_mov_b64 exec, -1
L_noclr_0:
    s_waitcnt vmcnt(13)
    v_lshlrev_b32 v72, 16, v64
    v_and_b32 v73, 0xffff0000, v64
    v_lshlrev_b32 v74, 16, v65
    v_and_b32 v75, 0xffff0000, v65
    v_lshlrev_b32 v76, 16, v66
    v_and_b32 v77, 0xffff0000, v66
    v_lshlrev_b32 v78, 16, v67
    v_and_b32 v79, 0xffff0000, v67
    v_lshlrev_b32 v80, 16, v68
    v_and_b32 v81, 0xffff0000, v68
    v_lshlrev_b32 v82, 16, v69
    v_and_b32 v83, 0xffff0000, v69
    v_lshlrev_b32 v84, 16, v70
    v_and_b32 v85, 0xffff0000, v70
    v_lshlrev_b32 v86, 16, v71
    v_and_b32 v87, 0xffff0000, v71
    v_mov_b32 v90, 0
    v_mov_b32 v91, 0
    v_dot2_f32_bf16 v90, v40, v56, v90
    v_lshlrev_b32 v94, 16, v40
    v_and_b32 v95, 0xffff0000, v40
    v_mul_f32 v94, v94, v72
    v_mul_f32 v95, v95, v73
    v_cvt_pk_bf16_f32 v94, v94, v95
    v_lshlrev_b32 v95, 16, v94
    v_and_b32 v94, 0xffff0000, v94
    v_add_f32 v91, v91, v95
    v_add_f32 v91, v91, v94
    v_dot2_f32_bf16 v90, v41, v57, v90
    v_lshlrev_b32 v94, 16, v41
    v_and_b32 v95, 0xffff0000, v41
    v_mul_f32 v94, v94, v74
    v_mul_f32 v95, v95, v75
    v_cvt_pk_bf16_f32 v94, v94, v95
    v_lshlrev_b32 v95, 16, v94
    v_and_b32 v94, 0xffff0000, v94
    v_add_f32 v91, v91, v95
    v_add_f32 v91, v91, v94
    v_dot2_f32_bf16 v90, v42, v58, v90
    v_lshlrev_b32 v94, 16, v42
    v_and_b32 v95, 0xffff0000, v42
    v_mul_f32 v94, v94, v76
    v_mul_f32 v95, v95, v77
    v_cvt_pk_bf16_f32 v94, v94, v95
    v_lshlrev_b32 v95, 16, v94
    v_and_b32 v94, 0xffff0000, v94
    v_add_f32 v91, v91, v95
    v_add_f32 v91, v91, v94
    v_dot2_f32_bf16 v90, v43, v59, v90
    v_lshlrev_b32 v94, 16, v43
    v_and_b32 v95, 0xffff0000, v43
    v_mul_f32 v94, v94, v78
    v_mul_f32 v95, v95, v79
    v_cvt_pk_bf16_f32 v94, v94, v95
    v_lshlrev_b32 v95, 16, v94
    v_and_b32 v94, 0xffff0000, v94
    v_add_f32 v91, v91, v95
    v_add_f32 v91, v91, v94
    v_dot2_f32_bf16 v90, v44, v60, v90
    v_lshlrev_b32 v94, 16, v44
    v_and_b32 v95, 0xffff0000, v44
    v_mul_f32 v94, v94, v80
    v_mul_f32 v95, v95, v81
    v_cvt_pk_bf16_f32 v94, v94, v95
    v_lshlrev_b32 v95, 16, v94
    v_and_b32 v94, 0xffff0000, v94
    v_add_f32 v91, v91, v95
    v_add_f32 v91, v91, v94
    v_dot2_f32_bf16 v90, v45, v61, v90
    v_lshlrev_b32 v94, 16, v45
    v_and_b32 v95, 0xffff0000, v45
    v_mul_f32 v94, v94, v82
    v_mul_f32 v95, v95, v83
    v_cvt_pk_bf16_f32 v94, v94, v95
    v_lshlrev_b32 v95, 16, v94
    v_and_b32 v94, 0xffff0000, v94
    v_add_f32 v91, v91, v95
    v_add_f32 v91, v91, v94
    v_dot2_f32_bf16 v90, v46, v62, v90
    v_lshlrev_b32 v94, 16, v46
    v_and_b32 v95, 0xffff0000, v46
    v_mul_f32 v94, v94, v84
    v_mul_f32 v95, v95, v85
    v_cvt_pk_bf16_f32 v94, v94, v95
    v_lshlrev_b32 v95, 16, v94
    v_and_b32 v94, 0xffff0000, v94
    v_add_f32 v91, v91, v95
    v_add_f32 v91, v91, v94
    v_dot2_f32_bf16 v90, v47, v63, v90
    v_lshlrev_b32 v94, 16, v47
    v_and_b32 v95, 0xffff0000, v47
    v_mul_f32 v94, v94, v86
    v_mul_f32 v95, v95, v87
    v_cvt_pk_bf16_f32 v94, v94, v95
    v_lshlrev_b32 v95, 16, v94
    v_and_b32 v94, 0xffff0000, v94
    v_add_f32 v91, v91, v95
    v_add_f32 v91, v91, v94
    v_mov_b32 v92, 0
    v_mov_b32 v93, 0
    v_dot2_f32_bf16 v92, v48, v56, v92
    v_lshlrev_b32 v94, 16, v48
    v_and_b32 v95, 0xffff0000, v48
    v_mul_f32 v94, v94, v72
    v_mul_f32 v95, v95, v73
    v_cvt_pk_bf16_f32 v94, v94, v95
    v_lshlrev_b32 v95, 16, v94
    v_and_b32 v94, 0xffff0000, v94
    v_add_f32 v93, v93, v95
    v_add_f32 v93, v93, v94
    v_dot2_f32_bf16 v92, v49, v57, v92
    v_lshlrev_b32 v94, 16, v49
    v_and_b32 v95, 0xffff0000, v49
    v_mul_f32 v94, v94, v74
    v_mul_f32 v95, v95, v75
    v_cvt_pk_bf16_f32 v94, v94, v95
    v_lshlrev_b32 v95, 16, v94
    v_and_b32 v94, 0xffff0000, v94
    v_add_f32 v93, v93, v95
    v_add_f32 v93, v93, v94
    v_dot2_f32_bf16 v92, v50, v58, v92
    s_barrier
    s_add_u32 m0, s95, 0
    s_nop 0
    buffer_load_dwordx4 v25, s[28:31], s93 offen offset:1024 lds
    buffer_load_dwordx4 v26, s[28:31], s93 offen offset:2048 lds
    s_add_u32 m0, s95, 3072
    s_nop 0
    buffer_load_dwordx4 v27, s[28:31], s93 offen offset:0 lds
    buffer_load_dwordx4 v28, s[28:31], s93 offen offset:1024 lds
    buffer_load_dwordx4 v29, s[28:31], s93 offen offset:2048 lds
    s_bfe_u32 s91, s68, 0x40010
    s_lshl_b32 s92, s91, 7
    s_mul_i32 s93, s91, 393216
    s_add_u32 m0, s94, 40960
    s_nop 0
    buffer_load_dwordx4 v20, s[24:27], s92 offen offset:0 lds
    buffer_load_dwordx4 v21, s[24:27], s92 offen offset:1024 lds
    buffer_load_dwordx4 v22, s[24:27], s92 offen offset:2048 lds
    buffer_load_dwordx4 v23, s[24:27], s92 offen offset:3072 lds
    s_add_u32 m0, s95, 40960
    s_nop 0
    buffer_load_dwordx4 v24, s[28:31], s93 offen offset:0 lds
    buffer_load_dwordx4 v25, s[28:31], s93 offen offset:1024 lds
    buffer_load_dwordx4 v26, s[28:31], s93 offen offset:2048 lds
    v_lshlrev_b32 v94, 16, v50
    v_and_b32 v95, 0xffff0000, v50
    v_mul_f32 v94, v94, v76
    v_mul_f32 v95, v95, v77
    v_cvt_pk_bf16_f32 v94, v94, v95
    v_lshlrev_b32 v95, 16, v94
    v_and_b32 v94, 0xffff0000, v94
    v_add_f32 v93, v93, v95
    v_add_f32 v93, v93, v94
    v_dot2_f32_bf16 v92, v51, v59, v92
    v_lshlrev_b32 v94, 16, v51
    v_and_b32 v95, 0xffff0000, v51
    v_mul_f32 v94, v94, v78
    v_mul_f32 v95, v95, v79
    v_cvt_pk_bf16_f32 v94, v94, v95
    v_lshlrev_b32 v95, 16, v94
    v_and_b32 v94, 0xffff0000, v94
    v_add_f32 v93, v93, v95
    v_add_f32 v93, v93, v94
    v_dot2_f32_bf16 v92, v52, v60, v92
    v_lshlrev_b32 v94, 16, v52
    v_and_b32 v95, 0xffff0000, v52
    v_mul_f32 v94, v94, v80
    v_mul_f32 v95, v95, v81
    v_cvt_pk_bf16_f32 v94, v94, v95
    v_lshlrev_b32 v95, 16, v94
    v_and_b32 v94, 0xffff0000, v94
    v_add_f32 v93, v93, v95
    v_add_f32 v93, v93, v94
    v_dot2_f32_bf16 v92, v53, v61, v92
    v_lshlrev_b32 v94, 16, v53
    v_and_b32 v95, 0xffff0000, v53
    v_mul_f32 v94, v94, v82
    v_mul_f32 v95, v95, v83
    v_cvt_pk_bf16_f32 v94, v94, v95
    v_lshlrev_b32 v95, 16, v94
    v_and_b32 v94, 0xffff0000, v94
    v_add_f32 v93, v93, v95
    v_add_f32 v93, v93, v94
    v_dot2_f32_bf16 v92, v54, v62, v92
    v_lshlrev_b32 v94, 16, v54
    v_and_b32 v95, 0xffff0000, v54
    v_mul_f32 v94, v94, v84
    v_mul_f32 v95, v95, v85
    v_cvt_pk_bf16_f32 v94, v94, v95
    v_lshlrev_b32 v95, 16, v94
    v_and_b32 v94, 0xffff0000, v94
    v_add_f32 v93, v93, v95
    v_add_f32 v93, v93, v94
    v_dot2_f32_bf16 v92, v55, v63, v92
    v_lshlrev_b32 v94, 16, v55
    v_and_b32 v95, 0xffff0000, v55
    v_mul_f32 v94, v94, v86
    v_mul_f32 v95, v95, v87
    v_cvt_pk_bf16_f32 v94, v94, v95
    v_lshlrev_b32 v95, 16, v94
    v_and_b32 v94, 0xffff0000, v94
    v_add_f32 v93, v93, v95
    v_add_f32 v93, v93, v94
    v_add_f32_dpp v90, v90, v90 row_shr:1 row_mask:0xf bank_mask:0xf
    v_add_f32_dpp v91, v91, v91 row_shr:1 row_mask:0xf bank_mask:0xf
    v_add_f32_dpp v92, v92, v92 row_shr:1 row_mask:0xf bank_mask:0xf
    v_add_f32_dpp v93, v93, v93 row_shr:1 row_mask:0xf bank_mask:0xf
    v_add_f32_dpp v90, v90, v90 row_shr:2 row_mask:0xf bank_mask:0xf
    v_add_f32_dpp v91, v91, v91 row_shr:2 row_mask:0xf bank_mask:0xf
    v_add_f32_dpp v92, v92, v92 row_shr:2 row_mask:0xf bank_mask:0xf
    v_add_f32_dpp v93, v93, v93 row_shr:2 row_mask:0xf bank_mask:0xf
    v_add_f32_dpp v90, v90, v90 row_shr:4 row_mask:0xf bank_mask:0xf
    v_add_f32_dpp v91, v91, v91 row_shr:4 row_mask:0xf bank_mask:0xf
    v_add_f32_dpp v92, v92, v92 row_shr:4 row_mask:0xf bank_mask:0xf
    v_add_f32_dpp v93, v93, v93 row_shr:4 row_mask:0xf bank_mask:0xf
    v_add_f32_dpp v90, v90, v90 row_shr:8 row_mask:0xf bank_mask:0xf
    v_add_f32_dpp v91, v91, v91 row_shr:8 row_mask:0xf bank_mask:0xf
    v_add_f32_dpp v92, v92, v92 row_shr:8 row_mask:0xf bank_mask:0xf
    v_add_f32_dpp v93, v93, v93 row_shr:8 row_mask:0xf bank_mask:0xf
    v_add_f32_dpp v90, v90, v90 row_bcast:15 row_mask:0xa bank_mask:0xf
    v_add_f32_dpp v91, v91, v91 row_bcast:15 row_mask:0xa bank_mask:0xf
    v_add_f32_dpp v92, v92, v92 row_bcast:15 row_mask:0xa bank_mask:0xf
    v_add_f32_dpp v93, v93, v93 row_bcast:15 row_mask:0xa bank_mask:0xf
    v_add_f32_dpp v90, v90, v90 row_bcast:31 row_mask:0xc bank_mask:0xf
    v_add_f32_dpp v91, v91, v91 row_bcast:31 row_mask:0xc bank_mask:0xf
    v_add_f32_dpp v92, v92, v92 row_bcast:31 row_mask:0xc bank_mask:0xf
    v_add_f32_dpp v93, v93, v93 row_bcast:31 row_mask:0xc bank_mask:0xf
    v_cvt_pk_bf16_f32 v94, v90, v91
    v_and_b32 v95, 0xffff, v94
    v_and_b32 v96, 0x8000, v94
    v_cmp_ne_u32 vcc, 0, v96
    v_mov_b32 v97, 0x8000
    v_mov_b32 v98, 0xffff
    v_cndmask_b32 v96, v97, v98, vcc
    v_xor_b32 v95, v95, v96
    s_sub_u32 s12, 2047, s22
    v_lshlrev_b32 v95, 11, v95
    v_or_b32 v100, s12, v95
    v_and_b32 v94, 0xffff0000, v94
    v_mul_f32 v94, 0xbfb8aa3b, v94
    v_exp_f32 v94, v94
    s_nop 0
    v_add_f32 v94, 1.0, v94
    v_rcp_f32 v94, v94
    s_nop 0
    v_cvt_pk_bf16_f32 v94, v94, v94
    v_lshlrev_b32 v102, 16, v94
    v_cvt_pk_bf16_f32 v94, v92, v93
    v_and_b32 v95, 0xffff, v94
    v_and_b32 v96, 0x8000, v94
    v_cmp_ne_u32 vcc, 0, v96
    v_mov_b32 v97, 0x8000
    v_mov_b32 v98, 0xffff
    v_cndmask_b32 v96, v97, v98, vcc
    v_xor_b32 v95, v95, v96
    s_sub_u32 s12, 2046, s22
    v_lshlrev_b32 v95, 11, v95
    v_or_b32 v101, s12, v95
    v_and_b32 v94, 0xffff0000, v94
    v_mul_f32 v94, 0xbfb8aa3b, v94
    v_exp_f32 v94, v94
    s_nop 0
    v_add_f32 v94, 1.0, v94
    v_rcp_f32 v94, v94
    s_nop 0
    v_cvt_pk_bf16_f32 v94, v94, v94
    v_lshlrev_b32 v103, 16, v94
    v_max_u32 v100, v100, v101
    s_lshl_b32 s12, s22, 2
    s_add_u32 s12, s12, 4096
    s_lshl_b32 s13, s21, 2
    s_add_u32 s13, s13, 162880
    v_mov_b32 v14, s13
    s_mov_b32 exec_lo, 0
    s_mov_b32 exec_hi, 0x80000000
    buffer_store_dwordx2 v[102:103], v13, s[32:35], s12 offen sc1
    ds_write_b32 v14, v100
    s_mov_b64 exec, -1
    s_waitcnt lgkmcnt(0)
    buffer_load_dword v15, v13, s[72:75], 0 offen offset:4 sc1
    s_waitcnt vmcnt(9)
    s_barrier
    s_add_u32 m0, s95, 44032
    s_nop 0
    buffer_load_dwordx4 v27, s[28:31], s93 offen offset:0 lds
    buffer_load_dwordx4 v28, s[28:31], s93 offen offset:1024 lds
    buffer_load_dwordx4 v29, s[28:31], s93 offen offset:2048 lds
    s_bfe_u32 s91, s68, 0x40014
    s_lshl_b32 s92, s91, 7
    s_mul_i32 s93, s91, 393216
    s_add_u32 m0, s94, 81920
    s_nop 0
    buffer_load_dwordx4 v20, s[24:27], s92 offen offset:0 lds
    buffer_load_dwordx4 v21, s[24:27], s92 offen offset:1024 lds
    buffer_load_dwordx4 v22, s[24:27], s92 offen offset:2048 lds
    buffer_load_dwordx4 v23, s[24:27], s92 offen offset:3072 lds
    s_add_u32 m0, s95, 81920
    s_nop 0
    buffer_load_dwordx4 v24, s[28:31], s93 offen offset:0 lds
    buffer_load_dwordx4 v25, s[28:31], s93 offen offset:1024 lds
    buffer_load_dwordx4 v26, s[28:31], s93 offen offset:2048 lds
    s_add_u32 m0, s95, 84992
    s_nop 0
    buffer_load_dwordx4 v27, s[28:31], s93 offen offset:0 lds
    buffer_load_dwordx4 v28, s[28:31], s93 offen offset:1024 lds
    s_waitcnt vmcnt(9)
    s_barrier
    s_add_u32 m0, s95, 84992
    s_nop 0
    buffer_load_dwordx4 v29, s[28:31], s93 offen offset:2048 lds
    s_bfe_u32 s91, s68, 0x40018
    s_lshl_b32 s92, s91, 7
    s_mul_i32 s93, s91, 393216
    s_add_u32 m0, s94, 0
    s_nop 0
    buffer_load_dwordx4 v20, s[24:27], s92 offen offset:0 lds
    buffer_load_dwordx4 v21, s[24:27], s92 offen offset:1024 lds
    buffer_load_dwordx4 v22, s[24:27], s92 offen offset:2048 lds
    buffer_load_dwordx4 v23, s[24:27], s92 offen offset:3072 lds
    s_add_u32 m0, s95, 0
    s_nop 0
    buffer_load_dwordx4 v24, s[28:31], s93 offen offset:0 lds
    buffer_load_dwordx4 v25, s[28:31], s93 offen offset:1024 lds
    buffer_load_dwordx4 v26, s[28:31], s93 offen offset:2048 lds
    s_add_u32 m0, s95, 3072
    s_nop 0
    buffer_load_dwordx4 v27, s[28:31], s93 offen offset:0 lds
    buffer_load_dwordx4 v28, s[28:31], s93 offen offset:1024 lds
    buffer_load_dwordx4 v29, s[28:31], s93 offen offset:2048 lds
    s_mov_b32 s13, 0
L_tagchk_0:
    v_readfirstlane_b32 s23, v15
    s_nop 1
    s_cmp_lg_u32 s23, 0
    s_cbranch_scc1 L_tagok_0
    s_add_u32 s13, s13, 1
    s_cmp_ge_u32 s13, 16384
    s_cbranch_scc1 L_tagok_0
    buffer_load_dword v15, v13, s[72:75], 0 offen offset:4 sc1
    s_waitcnt vmcnt(0)
    s_branch L_tagchk_0
L_tagok_0:
    s_and_b32 s76, s23, 0xff
    s_bfe_u32 s77, s23, 0x80008
    s_bfe_u32 s78, s23, 0x80010
    s_lshr_b32 s79, s23, 24
    v_and_b32 v35, 3, v2
    v_lshlrev_b32 v35, 3, v35
    v_bfe_u32 v35, s23, v35, 8
    s_cmp_lg_u32 s21, 0
    s_cbranch_scc1 L_nopub_0
    v_mov_b32 v14, 162880
    ds_read_b128 v[104:107], v14
    s_lshl_b32 s12, s2, 3
    s_add_u32 s12, s12, 0
    s_waitcnt lgkmcnt(0)
    v_max3_u32 v104, v104, v105, v106
    v_max_u32 v104, v104, v107
    v_mov_b32 v105, s23
    s_mov_b64 exec, 1
    buffer_store_dwordx2 v[104:105], v13, s[32:35], s12 offen sc1
    s_mov_b64 exec, -1
L_nopub_0:
    s_waitcnt vmcnt(10)
    s_barrier
    s_bfe_u32 s91, s68, 0x4001c
    s_lshl_b32 s92, s91, 7
    s_mul_i32 s93, s91, 393216
    s_add_u32 m0, s94, 40960
    s_nop 0
    buffer_load_dwordx4 v20, s[24:27], s92 offen offset:0 lds
    buffer_load_dwordx4 v21, s[24:27], s92 offen offset:1024 lds
    buffer_load_dwordx4 v22, s[24:27], s92 offen offset:2048 lds
    buffer_load_dwordx4 v23, s[24:27], s92 offen offset:3072 lds
    s_add_u32 m0, s95, 40960
    s_nop 0
    buffer_load_dwordx4 v24, s[28:31], s93 offen offset:0 lds
    buffer_load_dwordx4 v25, s[28:31], s93 offen offset:1024 lds
    buffer_load_dwordx4 v26, s[28:31], s93 offen offset:2048 lds
    s_add_u32 m0, s95, 44032
    s_nop 0
    buffer_load_dwordx4 v27, s[28:31], s93 offen offset:0 lds
    buffer_load_dwordx4 v28, s[28:31], s93 offen offset:1024 lds
    buffer_load_dwordx4 v29, s[28:31], s93 offen offset:2048 lds
    s_add_u32 s12, s71, 0
    buffer_load_dwordx4 v[160:163], v30, s[44:47], s12 offen nt
    s_add_u32 s12, s71, 7168
    buffer_load_dwordx4 v[164:167], v30, s[44:47], s12 offen nt
    s_add_u32 s12, s71, 14336
    buffer_load_dwordx4 v[168:171], v30, s[44:47], s12 offen nt
    s_add_u32 s12, s71, 21504
    buffer_load_dwordx4 v[172:175], v30, s[44:47], s12 offen nt
    s_add_u32 s12, s71, 28672
    buffer_load_dwordx4 v[176:179], v30, s[44:47], s12 offen nt
    s_add_u32 s12, s71, 35840
    buffer_load_dwordx4 v[180:183], v30, s[44:47], s12 offen nt
    s_add_u32 s12, s71, 43008
    buffer_load_dwordx4 v[184:187], v30, s[44:47], s12 offen nt
    s_add_u32 s12, s71, 50176
    buffer_load_dwordx4 v[188:191], v30, s[44:47], s12 offen nt
    s_waitcnt vmcnt(18)
    s_barrier
    s_bfe_u32 s91, s69, 0x40000
    s_lshl_b32 s92, s91, 7
    s_mul_i32 s93, s91, 393216
    s_add_u32 m0, s94, 81920
    s_nop 0
    buffer_load_dwordx4 v20, s[24:27], s92 offen offset:0 lds
    buffer_load_dwordx4 v21, s[24:27], s92 offen offset:1024 lds
    buffer_load_dwordx4 v22, s[24:27], s92 offen offset:2048 lds
    buffer_load_dwordx4 v23, s[24:27], s92 offen offset:3072 lds
    s_add_u32 m0, s95, 81920
    s_nop 0
    buffer_load_dwordx4 v24, s[28:31], s93 offen offset:0 lds
    s_waitcnt vmcnt(13)
    s_barrier
    s_add_u32 m0, s95, 81920
    s_nop 0
    buffer_load_dwordx4 v25, s[28:31], s93 offen offset:1024 lds
    buffer_load_dwordx4 v26, s[28:31], s93 offen offset:2048 lds
    s_add_u32 m0, s95, 84992
    s_nop 0
    buffer_load_dwordx4 v27, s[28:31], s93 offen offset:0 lds
    buffer_load_dwordx4 v28, s[28:31], s93 offen offset:1024 lds
    buffer_load_dwordx4 v29, s[28:31], s93 offen offset:2048 lds
    s_bfe_u32 s91, s69, 0x40004
    s_lshl_b32 s92, s91, 7
    s_mul_i32 s93, s91, 393216
    s_add_u32 m0, s94, 0
    s_nop 0
    buffer_load_dwordx4 v20, s[24:27], s92 offen offset:0 lds
    buffer_load_dwordx4 v21, s[24:27], s92 offen offset:1024 lds
    buffer_load_dwordx4 v22, s[24:27], s92 offen offset:2048 lds
    buffer_load_dwordx4 v23, s[24:27], s92 offen offset:3072 lds
    s_add_u32 m0, s95, 0
    s_nop 0
    buffer_load_dwordx4 v24, s[28:31], s93 offen offset:0 lds
    buffer_load_dwordx4 v25, s[28:31], s93 offen offset:1024 lds
    buffer_load_dwordx4 v26, s[28:31], s93 offen offset:2048 lds
    s_waitcnt vmcnt(7)
    s_barrier
    s_add_u32 m0, s95, 3072
    s_nop 0
    buffer_load_dwordx4 v27, s[28:31], s93 offen offset:0 lds
    buffer_load_dwordx4 v28, s[28:31], s93 offen offset:1024 lds
    buffer_load_dwordx4 v29, s[28:31], s93 offen offset:2048 lds
    s_bfe_u32 s91, s69, 0x40008
    s_lshl_b32 s92, s91, 7
    s_mul_i32 s93, s91, 393216
    s_add_u32 m0, s94, 40960
    s_nop 0
    buffer_load_dwordx4 v20, s[24:27], s92 offen offset:0 lds
    buffer_load_dwordx4 v21, s[24:27], s92 offen offset:1024 lds
    buffer_load_dwordx4 v22, s[24:27], s92 offen offset:2048 lds
    buffer_load_dwordx4 v23, s[24:27], s92 offen offset:3072 lds
    s_add_u32 m0, s95, 40960
    s_nop 0
    buffer_load_dwordx4 v24, s[28:31], s93 offen offset:0 lds
    buffer_load_dwordx4 v25, s[28:31], s93 offen offset:1024 lds
    buffer_load_dwordx4 v26, s[28:31], s93 offen offset:2048 lds
    s_add_u32 m0, s95, 44032
    s_nop 0
    buffer_load_dwordx4 v27, s[28:31], s93 offen offset:0 lds
    buffer_load_dwordx4 v28, s[28:31], s93 offen offset:1024 lds
    s_waitcnt vmcnt(9)
    s_barrier
    s_add_u32 m0, s95, 44032
    s_nop 0
    buffer_load_dwordx4 v29, s[28:31], s93 offen offset:2048 lds
    s_bfe_u32 s91, s69, 0x4000c
    s_lshl_b32 s92, s91, 7
    s_mul_i32 s93, s91, 393216
    s_add_u32 m0, s94, 81920
    s_nop 0
    buffer_load_dwordx4 v20, s[24:27], s92 offen offset:0 lds
    buffer_load_dwordx4 v21, s[24:27], s92 offen offset:1024 lds
    buffer_load_dwordx4 v22, s[24:27], s92 offen offset:2048 lds
    buffer_load_dwordx4 v23, s[24:27], s92 offen offset:3072 lds
    s_add_u32 m0, s95, 81920
    s_nop 0
    buffer_load_dwordx4 v24, s[28:31], s93 offen offset:0 lds
    buffer_load_dwordx4 v25, s[28:31], s93 offen offset:1024 lds
    buffer_load_dwordx4 v26, s[28:31], s93 offen offset:2048 lds
    s_add_u32 m0, s95, 84992
    s_nop 0
    buffer_load_dwordx4 v27, s[28:31], s93 offen offset:0 lds
    buffer_load_dwordx4 v28, s[28:31], s93 offen offset:1024 lds
    buffer_load_dwordx4 v29, s[28:31], s93 offen offset:2048 lds
    s_mov_b32 s12, 0
    buffer_load_dwordx4 v[104:107], v5, s[32:35], s12 offen offset:0 sc1
    buffer_load_dwordx4 v[108:111], v5, s[32:35], s12 offen offset:1024 sc1
    s_waitcnt vmcnt(12)
    s_barrier
    s_bfe_u32 s91, s69, 0x40010
    s_lshl_b32 s92, s91, 7
    s_mul_i32 s93, s91, 393216
    s_add_u32 m0, s94, 0
    s_nop 0
    buffer_load_dwordx4 v20, s[24:27], s92 offen offset:0 lds
    buffer_load_dwordx4 v21, s[24:27], s92 offen offset:1024 lds
    buffer_load_dwordx4 v22, s[24:27], s92 offen offset:2048 lds
    buffer_load_dwordx4 v23, s[24:27], s92 offen offset:3072 lds
    s_add_u32 m0, s95, 0
    s_nop 0
    buffer_load_dwordx4 v24, s[28:31], s93 offen offset:0 lds
    buffer_load_dwordx4 v25, s[28:31], s93 offen offset:1024 lds
    buffer_load_dwordx4 v26, s[28:31], s93 offen offset:2048 lds
    s_add_u32 m0, s95, 3072
    s_nop 0
    buffer_load_dwordx4 v27, s[28:31], s93 offen offset:0 lds
    buffer_load_dwordx4 v28, s[28:31], s93 offen offset:1024 lds
    buffer_load_dwordx4 v29, s[28:31], s93 offen offset:2048 lds
    s_add_u32 s12, s97, 0
    buffer_load_dwordx4 v[192:195], v31, s[64:67], s12 offen nt
    s_add_u32 s12, s97, 16384
    buffer_load_dwordx4 v[196:199], v31, s[64:67], s12 offen nt
    s_add_u32 s12, s97, 32768
    buffer_load_dwordx4 v[200:203], v31, s[64:67], s12 offen nt
    s_add_u32 s12, s97, 49152
    buffer_load_dwordx4 v[204:207], v31, s[64:67], s12 offen nt
    s_add_u32 s12, s97, 65536
    buffer_load_dwordx4 v[208:211], v31, s[64:67], s12 offen nt
    s_add_u32 s12, s97, 81920
    buffer_load_dwordx4 v[212:215], v31, s[64:67], s12 offen nt
    s_add_u32 s12, s97, 98304
    buffer_load_dwordx4 v[216:219], v31, s[64:67], s12 offen nt
    s_waitcnt vmcnt(19)
    s_barrier
    s_bfe_u32 s91, s69, 0x40014
    s_lshl_b32 s92, s91, 7
    s_mul_i32 s93, s91, 393216
    s_add_u32 m0, s94, 40960
    s_nop 0
    buffer_load_dwordx4 v20, s[24:27], s92 offen offset:0 lds
    buffer_load_dwordx4 v21, s[24:27], s92 offen offset:1024 lds
    buffer_load_dwordx4 v22, s[24:27], s92 offen offset:2048 lds
    buffer_load_dwordx4 v23, s[24:27], s92 offen offset:3072 lds
    s_add_u32 m0, s95, 40960
    s_nop 0
    buffer_load_dwordx4 v24, s[28:31], s93 offen offset:0 lds
    s_waitcnt vmcnt(22)
    s_mov_b32 s13, 0
L_keychk_0:
    v_xor_b32 v105, s23, v105
    v_xor_b32 v107, s23, v107
    v_xor_b32 v109, s23, v109
    v_xor_b32 v111, s23, v111
    v_or3_b32 v105, v105, v107, v109
    v_or_b32 v105, v105, v111
    v_cmp_ne_u32 vcc, 0, v105
    s_cbranch_vccz L_keyok_0
    s_add_u32 s13, s13, 1
    s_cmp_ge_u32 s13, 16384
    s_cbranch_scc1 L_keyok_0
    s_mov_b32 s12, 0
    buffer_load_dwordx4 v[104:107], v5, s[32:35], s12 offen offset:0 sc1
    buffer_load_dwordx4 v[108:111], v5, s[32:35], s12 offen offset:1024 sc1
    s_waitcnt vmcnt(0)
    s_branch L_keychk_0
L_keyok_0:
    v_max3_u32 v104, v104, v106, v108
    v_max_u32 v104, v104, v110
    s_nop 1
    v_max_u32_dpp v104, v104, v104 row_shr:1 row_mask:0xf bank_mask:0xf
    s_nop 1
    v_max_u32_dpp v104, v104, v104 row_shr:2 row_mask:0xf bank_mask:0xf
    s_nop 1
    v_max_u32_dpp v104, v104, v104 row_shr:4 row_mask:0xf bank_mask:0xf
    s_nop 1
    v_max_u32_dpp v104, v104, v104 row_shr:8 row_mask:0xf bank_mask:0xf
    s_nop 1
    v_max_u32_dpp v104, v104, v104 row_bcast:15 row_mask:0xa bank_mask:0xf
    s_nop 1
    v_max_u32_dpp v104, v104, v104 row_bcast:31 row_mask:0xc bank_mask:0xf
    s_nop 0
    v_readlane_b32 s14, v104, 63
    s_nop 1
    s_and_b32 s15, s14, 2047
    s_sub_u32 s15, 2047, s15
    s_lshl_b32 s12, s15, 11
    s_lshl_b32 s13, s70, 1
    s_add_u32 s12, s12, s13
    buffer_load_dwordx4 v[36:39], v34, s[24:27], s12 offen
    s_lshr_b32 s12, s14, 11
    s_and_b32 s13, s12, 0x8000
    s_cmp_lg_u32 s13, 0
    s_mov_b32 s13, 0xffff
    s_cselect_b32 s13, 0x8000, s13
    s_xor_b32 s12, s12, s13
    s_lshl_b32 s12, s12, 16
    v_mov_b32 v105, s12
    v_mul_f32 v105, 0xbfb8aa3b, v105
    v_exp_f32 v105, v105
    s_nop 0
    v_add_f32 v105, 1.0, v105
    v_rcp_f32 v105, v105
    s_nop 0
    v_cvt_pk_bf16_f32 v105, v105, v105
    v_lshlrev_b32 v105, 16, v105
    s_nop 0
    v_readfirstlane_b32 s14, v105
    s_add_u32 s12, s15, 1
    v_mov_b32 v104, s12
    v_mov_b32 v106, s23
    v_mov_b32 v14, 162864
    s_mov_b64 exec, 1
    ds_write_b96 v14, v[104:106]
    s_mov_b64 exec, -1
    s_waitcnt lgkmcnt(0)
    s_waitcnt vmcnt(13)
    s_barrier
    s_add_u32 m0, s95, 40960
    s_nop 0
    buffer_load_dwordx4 v25, s[28:31], s93 offen offset:1024 lds
    buffer_load_dwordx4 v26, s[28:31], s93 offen offset:2048 lds
    s_add_u32 m0, s95, 44032
    s_nop 0
    buffer_load_dwordx4 v27, s[28:31], s93 offen offset:0 lds
    buffer_load_dwordx4 v28, s[28:31], s93 offen offset:1024 lds
    buffer_load_dwordx4 v29, s[28:31], s93 offen offset:2048 lds
    s_bfe_u32 s91, s69, 0x40018
    s_lshl_b32 s92, s91, 7
    s_mul_i32 s93, s91, 393216
    s_add_u32 m0, s94, 81920
    s_nop 0
    buffer_load_dwordx4 v20, s[24:27], s92 offen offset:0 lds
    buffer_load_dwordx4 v21, s[24:27], s92 offen offset:1024 lds
    buffer_load_dwordx4 v22, s[24:27], s92 offen offset:2048 lds
    buffer_load_dwordx4 v23, s[24:27], s92 offen offset:3072 lds
    s_add_u32 m0, s95, 81920
    s_nop 0
    buffer_load_dwordx4 v24, s[28:31], s93 offen offset:0 lds
    buffer_load_dwordx4 v25, s[28:31], s93 offen offset:1024 lds
    buffer_load_dwordx4 v26, s[28:31], s93 offen offset:2048 lds
    s_waitcnt vmcnt(12)
    v_and_b32 v40, 0xffff, v36
    v_lshlrev_b32 v41, 16, v36
    v_lshrrev_b32 v42, 16, v36
    v_and_b32 v43, 0xffff0000, v36
    v_and_b32 v44, 0xffff, v37
    v_lshlrev_b32 v45, 16, v37
    v_lshrrev_b32 v46, 16, v37
    v_and_b32 v47, 0xffff0000, v37
    v_and_b32 v48, 0xffff, v38
    v_lshlrev_b32 v49, 16, v38
    v_lshrrev_b32 v50, 16, v38
    v_and_b32 v51, 0xffff0000, v38
    v_and_b32 v52, 0xffff, v39
    v_lshlrev_b32 v53, 16, v39
    v_lshrrev_b32 v54, 16, v39
    v_and_b32 v55, 0xffff0000, v39
    v_dot2_f32_bf16 v220, v128, v40, 0
    v_dot2_f32_bf16 v221, v128, v41, 0
    v_dot2_f32_bf16 v222, v129, v40, 0
    v_dot2_f32_bf16 v223, v129, v41, 0
    v_dot2_f32_bf16 v224, v130, v40, 0
    v_dot2_f32_bf16 v225, v130, v41, 0
    v_dot2_f32_bf16 v226, v131, v40, 0
    v_dot2_f32_bf16 v227, v131, v41, 0
    v_dot2_f32_bf16 v228, v160, v40, 0
    v_dot2_f32_bf16 v229, v160, v41, 0
    v_dot2_f32_bf16 v230, v161, v40, 0
    v_dot2_f32_bf16 v231, v161, v41, 0
    v_dot2_f32_bf16 v232, v162, v40, 0
    v_dot2_f32_bf16 v233, v162, v41, 0
    v_dot2_f32_bf16 v234, v163, v40, 0
    v_dot2_f32_bf16 v235, v163, v41, 0
    v_dot2_f32_bf16 v220, v132, v42, v220
    v_dot2_f32_bf16 v221, v132, v43, v221
    v_dot2_f32_bf16 v222, v133, v42, v222
    v_dot2_f32_bf16 v223, v133, v43, v223
    v_dot2_f32_bf16 v224, v134, v42, v224
    v_dot2_f32_bf16 v225, v134, v43, v225
    v_dot2_f32_bf16 v226, v135, v42, v226
    v_dot2_f32_bf16 v227, v135, v43, v227
    v_dot2_f32_bf16 v228, v164, v42, v228
    v_dot2_f32_bf16 v229, v164, v43, v229
    v_dot2_f32_bf16 v230, v165, v42, v230
    v_dot2_f32_bf16 v231, v165, v43, v231
    v_dot2_f32_bf16 v232, v166, v42, v232
    v_dot2_f32_bf16 v233, v166, v43, v233
    v_dot2_f32_bf16 v234, v167, v42, v234
    v_dot2_f32_bf16 v235, v167, v43, v235
    v_dot2_f32_bf16 v220, v136, v44, v220
    v_dot2_f32_bf16 v221, v136, v45, v221
    v_dot2_f32_bf16 v222, v137, v44, v222
    v_dot2_f32_bf16 v223, v137, v45, v223
    v_dot2_f32_bf16 v224, v138, v44, v224
    v_dot2_f32_bf16 v225, v138, v45, v225
    v_dot2_f32_bf16 v226, v139, v44, v226
    v_dot2_f32_bf16 v227, v139, v45, v227
    v_dot2_f32_bf16 v228, v168, v44, v228
    v_dot2_f32_bf16 v229, v168, v45, v229
    s_waitcnt vmcnt(7)
    s_barrier
    s_add_u32 m0, s95, 84992
    s_nop 0
    buffer_load_dwordx4 v27, s[28:31], s93 offen offset:0 lds
    buffer_load_dwordx4 v28, s[28:31], s93 offen offset:1024 lds
    buffer_load_dwordx4 v29, s[28:31], s93 offen offset:2048 lds
    s_bfe_u32 s91, s69, 0x4001c
    s_lshl_b32 s92, s91, 7
    s_mul_i32 s93, s91, 393216
    s_add_u32 m0, s94, 0
    s_nop 0
    buffer_load_dwordx4 v20, s[24:27], s92 offen offset:0 lds
    buffer_load_dwordx4 v21, s[24:27], s92 offen offset:1024 lds
    buffer_load_dwordx4 v22, s[24:27], s92 offen offset:2048 lds
    buffer_load_dwordx4 v23, s[24:27], s92 offen offset:3072 lds
    s_add_u32 m0, s95, 0
    s_nop 0
    buffer_load_dwordx4 v24, s[28:31], s93 offen offset:0 lds
    buffer_load_dwordx4 v25, s[28:31], s93 offen offset:1024 lds
    buffer_load_dwordx4 v26, s[28:31], s93 offen offset:2048 lds
    s_add_u32 m0, s95, 3072
    s_nop 0
    buffer_load_dwordx4 v27, s[28:31], s93 offen offset:0 lds
    buffer_load_dwordx4 v28, s[28:31], s93 offen offset:1024 lds
    v_dot2_f32_bf16 v230, v169, v44, v230
    v_dot2_f32_bf16 v231, v169, v45, v231
    v_dot2_f32_bf16 v232, v170, v44, v232
    v_dot2_f32_bf16 v233, v170, v45, v233
    v_dot2_f32_bf16 v234, v171, v44, v234
    v_dot2_f32_bf16 v235, v171, v45, v235
    v_dot2_f32_bf16 v220, v140, v46, v220
    v_dot2_f32_bf16 v221, v140, v47, v221
    v_dot2_f32_bf16 v222, v141, v46, v222
    v_dot2_f32_bf16 v223, v141, v47, v223
    v_dot2_f32_bf16 v224, v142, v46, v224
    v_dot2_f32_bf16 v225, v142, v47, v225
    v_dot2_f32_bf16 v226, v143, v46, v226
    v_dot2_f32_bf16 v227, v143, v47, v227
    v_dot2_f32_bf16 v228, v172, v46, v228
    v_dot2_f32_bf16 v229, v172, v47, v229
    v_dot2_f32_bf16 v230, v173, v46, v230
    v_dot2_f32_bf16 v231, v173, v47, v231
    v_dot2_f32_bf16 v232, v174, v46, v232
    v_dot2_f32_bf16 v233, v174, v47, v233
    v_dot2_f32_bf16 v234, v175, v46, v234
    v_dot2_f32_bf16 v235, v175, v47, v235
    v_dot2_f32_bf16 v220, v144, v48, v220
    v_dot2_f32_bf16 v221, v144, v49, v221
    v_dot2_f32_bf16 v222, v145, v48, v222
    v_dot2_f32_bf16 v223, v145, v49, v223
    v_dot2_f32_bf16 v224, v146, v48, v224
    v_dot2_f32_bf16 v225, v146, v49, v225
    v_dot2_f32_bf16 v226, v147, v48, v226
    v_dot2_f32_bf16 v227, v147, v49, v227
    v_dot2_f32_bf16 v228, v176, v48, v228
    v_dot2_f32_bf16 v229, v176, v49, v229
    v_dot2_f32_bf16 v230, v177, v48, v230
    v_dot2_f32_bf16 v231, v177, v49, v231
    v_dot2_f32_bf16 v232, v178, v48, v232
    v_dot2_f32_bf16 v233, v178, v49, v233
    v_dot2_f32_bf16 v234, v179, v48, v234
    v_dot2_f32_bf16 v235, v179, v49, v235
    v_dot2_f32_bf16 v220, v148, v50, v220
    v_dot2_f32_bf16 v221, v148, v51, v221
    v_dot2_f32_bf16 v222, v149, v50, v222
    v_dot2_f32_bf16 v223, v149, v51, v223
    v_dot2_f32_bf16 v224, v150, v50, v224
    v_dot2_f32_bf16 v225, v150, v51, v225
    v_dot2_f32_bf16 v226, v151, v50, v226
    v_dot2_f32_bf16 v227, v151, v51, v227
    v_dot2_f32_bf16 v228, v180, v50, v228
    v_dot2_f32_bf16 v229, v180, v51, v229
    v_dot2_f32_bf16 v230, v181, v50, v230
    v_dot2_f32_bf16 v231, v181, v51, v231
    v_dot2_f32_bf16 v232, v182, v50, v232
    v_dot2_f32_bf16 v233, v182, v51, v233
    v_dot2_f32_bf16 v234, v183, v50, v234
    v_dot2_f32_bf16 v235, v183, v51, v235
    v_dot2_f32_bf16 v220, v152, v52, v220
    v_dot2_f32_bf16 v221, v152, v53, v221
    v_dot2_f32_bf16 v222, v153, v52, v222
    v_dot2_f32_bf16 v223, v153, v53, v223
    s_waitcnt vmcnt(9)
    s_barrier
    s_add_u32 m0, s95, 3072
    s_nop 0
    buffer_load_dwordx4 v29, s[28:31], s93 offen offset:2048 lds
    s_mul_i32 s12, s21, 8
    s_add_u32 s12, s12, 96
    s_lshl_b32 s13, s12, 10
    s_lshl_b32 s12, s12, 14
    s_add_u32 m0, s13, 24576
    s_add_u32 s90, s12, 0
    buffer_load_dwordx4 v33, s[36:39], s90 offen lds
    s_add_u32 m0, s13, 25600
    s_add_u32 s90, s12, 16384
    buffer_load_dwordx4 v33, s[36:39], s90 offen lds
    s_add_u32 m0, s13, 26624
    s_add_u32 s90, s12, 32768
    buffer_load_dwordx4 v33, s[36:39], s90 offen lds
    s_add_u32 m0, s13, 27648
    s_add_u32 s90, s12, 49152
    buffer_load_dwordx4 v33, s[36:39], s90 offen lds
    s_add_u32 m0, s13, 28672
    s_add_u32 s90, s12, 65536
    buffer_load_dwordx4 v33, s[36:39], s90 offen lds
    s_add_u32 m0, s13, 29696
    s_add_u32 s90, s12, 81920
    buffer_load_dwordx4 v33, s[36:39], s90 offen lds
    s_add_u32 m0, s13, 30720
    s_add_u32 s90, s12, 98304
    buffer_load_dwordx4 v33, s[36:39], s90 offen lds
    s_add_u32 m0, s13, 31744
    s_add_u32 s90, s12, 114688
    buffer_load_dwordx4 v33, s[36:39], s90 offen lds
    v_dot2_f32_bf16 v224, v154, v52, v224
    v_dot2_f32_bf16 v225, v154, v53, v225
    v_dot2_f32_bf16 v226, v155, v52, v226
    v_dot2_f32_bf16 v227, v155, v53, v227
    v_dot2_f32_bf16 v228, v184, v52, v228
    v_dot2_f32_bf16 v229, v184, v53, v229
    v_dot2_f32_bf16 v230, v185, v52, v230
    v_dot2_f32_bf16 v231, v185, v53, v231
    v_dot2_f32_bf16 v232, v186, v52, v232
    v_dot2_f32_bf16 v233, v186, v53, v233
    v_dot2_f32_bf16 v234, v187, v52, v234
    v_dot2_f32_bf16 v235, v187, v53, v235
    v_dot2_f32_bf16 v220, v156, v54, v220
    v_dot2_f32_bf16 v221, v156, v55, v221
    v_dot2_f32_bf16 v222, v157, v54, v222
    v_dot2_f32_bf16 v223, v157, v55, v223
    v_dot2_f32_bf16 v224, v158, v54, v224
    v_dot2_f32_bf16 v225, v158, v55, v225
    v_dot2_f32_bf16 v226, v159, v54, v226
    v_dot2_f32_bf16 v227, v159, v55, v227
    v_dot2_f32_bf16 v228, v188, v54, v228
    v_dot2_f32_bf16 v229, v188, v55, v229
    v_dot2_f32_bf16 v230, v189, v54, v230
    v_dot2_f32_bf16 v231, v189, v55, v231
    v_dot2_f32_bf16 v232, v190, v54, v232
    v_dot2_f32_bf16 v233, v190, v55, v233
    v_dot2_f32_bf16 v234, v191, v54, v234
    v_dot2_f32_bf16 v235, v191, v55, v235
    v_permlane32_swap_b32 v220, v228
    v_permlane32_swap_b32 v221, v229
    v_permlane32_swap_b32 v222, v230
    v_permlane32_swap_b32 v223, v231
    v_permlane32_swap_b32 v224, v232
    v_permlane32_swap_b32 v225, v233
    v_permlane32_swap_b32 v226, v234
    v_permlane32_swap_b32 v227, v235
    v_add_f32 v220, v220, v228
    v_add_f32 v221, v221, v229
    v_add_f32 v222, v222, v230
    v_add_f32 v223, v223, v231
    v_add_f32 v224, v224, v232
    v_add_f32 v225, v225, v233
    v_add_f32 v226, v226, v234
    v_add_f32 v227, v227, v235
    v_permlane16_swap_b32 v220, v224
    v_permlane16_swap_b32 v221, v225
    v_permlane16_swap_b32 v222, v226
    v_permlane16_swap_b32 v223, v227
    v_add_f32 v220, v220, v224
    v_add_f32 v221, v221, v225
    v_add_f32 v222, v222, v226
    v_add_f32 v223, v223, v227
    v_add_f32_dpp v220, v220, v220 row_ror:8 row_mask:0xf bank_mask:0xf
    v_add_f32_dpp v221, v221, v221 row_ror:8 row_mask:0xf bank_mask:0xf
    v_add_f32_dpp v222, v222, v222 row_ror:8 row_mask:0xf bank_mask:0xf
    v_add_f32_dpp v223, v223, v223 row_ror:8 row_mask:0xf bank_mask:0xf
    s_waitcnt vmcnt(8)
    s_barrier
    s_branch L_varend
L_var1:
    s_nop 0
    s_add_u32 m0, s95, 40960
    s_nop 0
    buffer_load_dwordx4 v26, s[28:31], s93 offen offset:2048 lds
    s_add_u32 m0, s95, 44032
    s_nop 0
    buffer_load_dwordx4 v27, s[28:31], s93 offen offset:0 lds
    buffer_load_dwordx4 v28, s[28:31], s93 offen offset:1024 lds
    buffer_load_dwordx4 v29, s[28:31], s93 offen offset:2048 lds
    s_bfe_u32 s91, s68, 0x40008
    s_lshl_b32 s92, s91, 7
    s_mul_i32 s93, s91, 393216
    s_add_u32 m0, s94, 81920
    s_nop 0
    buffer_load_dwordx4 v20, s[24:27], s92 offen offset:0 lds
    buffer_load_dwordx4 v21, s[24:27], s92 offen offset:1024 lds
    buffer_load_dwordx4 v22, s[24:27], s92 offen offset:2048 lds
    buffer_load_dwordx4 v23, s[24:27], s92 offen offset:3072 lds
    s_add_u32 m0, s95, 81920
    s_nop 0
    buffer_load_dwordx4 v24, s[28:31], s93 offen offset:0 lds
    buffer_load_dwordx4 v25, s[28:31], s93 offen offset:1024 lds
    buffer_load_dwordx4 v26, s[28:31], s93 offen offset:2048 lds
    s_add_u32 m0, s95, 84992
    s_nop 0
    buffer_load_dwordx4 v27, s[28:31], s93 offen offset:0 lds
    buffer_load_dwordx4 v28, s[28:31], s93 offen offset:1024 lds
    buffer_load_dwordx4 v29, s[28:31], s93 offen offset:2048 lds
    s_lshl_b32 s12, s19, 2
    s_add_u32 s12, s12, s21
    s_lshl_b32 s12, s12, 10
    s_lshl_b32 s13, s21, 10
    s_add_u32 m0, s13, 155648
    s_nop 0
    buffer_load_dwordx4 v5, s[76:79], s12 offen lds
    s_lshl_b32 s12, s22, 11
    buffer_load_dwordx4 v[40:43], v5, s[24:27], s12 offen offset:0
    buffer_load_dwordx4 v[44:47], v5, s[24:27], s12 offen offset:1024
    buffer_load_dwordx4 v[48:51], v5, s[24:27], s12 offen offset:2048
    buffer_load_dwordx4 v[52:55], v5, s[24:27], s12 offen offset:3072
    buffer_load_dwordx4 v[56:59], v5, s[80:83], 0 offen offset:0
    buffer_load_dwordx4 v[60:63], v5, s[80:83], 0 offen offset:1024
    buffer_load_dwordx4 v[64:67], v5, s[84:87], 0 offen offset:0
    buffer_load_dwordx4 v[68:71], v5, s[84:87], 0 offen offset:1024
    s_waitcnt vmcnt(19)
    s_barrier
    s_bfe_u32 s91, s68, 0x4000c
    s_lshl_b32 s92, s91, 7
    s_mul_i32 s93, s91, 393216
    s_add_u32 m0, s94, 0
    s_nop 0
    buffer_load_dwordx4 v20, s[24:27], s92 offen offset:0 lds
    buffer_load_dwordx4 v21, s[24:27], s92 offen offset:1024 lds
    buffer_load_dwordx4 v22, s[24:27], s92 offen offset:2048 lds
    buffer_load_dwordx4 v23, s[24:27], s92 offen offset:3072 lds
    s_add_u32 m0, s95, 0
    s_nop 0
    buffer_load_dwordx4 v24, s[28:31], s93 offen offset:0 lds
    buffer_load_dwordx4 v25, s[28:31], s93 offen offset:1024 lds
    buffer_load_dwordx4 v26, s[28:31], s93 offen offset:2048 lds
    s_add_u32 m0, s95, 3072
    s_nop 0
    buffer_load_dwordx4 v27, s[28:31], s93 offen offset:0 lds
    buffer_load_dwordx4 v28, s[28:31], s93 offen offset:1024 lds
    buffer_load_dwordx4 v29, s[28:31], s93 offen offset:2048 lds
    s_cmp_lg_u32 s21, 0
    s_cbranch_scc1 L_noclr_1
    v_mov_b32 v104, -1
    v_mov_b32 v105, -1
    v_mov_b32 v106, -1
    v_mov_b32 v107, -1
    s_lshl_b32 s12, s19, 13
    s_lshl_b32 s13, s18, 9
    s_add_u32 s12, s12, s13
    s_add_u32 s12, s12, 32768
    s_lshl_b32 s13, s19, 11
    s_lshl_b32 s90, s18, 7
    s_add_u32 s13, s13, s90
    s_add_u32 s13, s13, 163840
    s_mov_b32 exec_hi, 0
    buffer_store_dwordx4 v[104:107], v5, s[32:35], s12 offen sc1
    s_mov_b32 exec_lo, 255
    buffer_store_dwordx4 v[104:107], v5, s[32:35], s13 offen sc1
    s_mov_b64 exec, -1
L_noclr_1:
    s_add_u32 s12, s71, 0
    buffer_load_dwordx4 v[128:131], v30, s[40:43], s12 offen nt
    s_add_u32 s12, s71, 7168
    buffer_load_dwordx4 v[132:135], v30, s[40:43], s12 offen nt
    s_add_u32 s12, s71, 14336
    buffer_load_dwordx4 v[136:139], v30, s[40:43], s12 offen nt
    s_add_u32 s12, s71, 21504
    buffer_load_dwordx4 v[140:143], v30, s[40:43], s12 offen nt
    s_add_u32 s12, s71, 28672
    buffer_load_dwordx4 v[144:147], v30, s[40:43], s12 offen nt
    s_add_u32 s12, s71, 35840
    buffer_load_dwordx4 v[148:151], v30, s[40:43], s12 offen nt
    s_add_u32 s12, s71, 43008
    buffer_load_dwordx4 v[152:155], v30, s[40:43], s12 offen nt
    s_add_u32 s12, s71, 50176
    buffer_load_dwordx4 v[156:159], v30, s[40:43], s12 offen nt
    s_waitcnt vmcnt(18)
    v_lshlrev_b32 v72, 16, v64
    v_and_b32 v73, 0xffff0000, v64
    v_lshlrev_b32 v74, 16, v65
    v_and_b32 v75, 0xffff0000, v65
    v_lshlrev_b32 v76, 16, v66
    v_and_b32 v77, 0xffff0000, v66
    v_lshlrev_b32 v78, 16, v67
    v_and_b32 v79, 0xffff0000, v67
    v_lshlrev_b32 v80, 16, v68
    v_and_b32 v81, 0xffff0000, v68
    v_lshlrev_b32 v82, 16, v69
    v_and_b32 v83, 0xffff0000, v69
    v_lshlrev_b32 v84, 16, v70
    v_and_b32 v85, 0xffff0000, v70
    v_lshlrev_b32 v86, 16, v71
    v_and_b32 v87, 0xffff0000, v71
    v_mov_b32 v90, 0
    v_mov_b32 v91, 0
    v_dot2_f32_bf16 v90, v40, v56, v90
    v_lshlrev_b32 v94, 16, v40
    v_and_b32 v95, 0xffff0000, v40
    v_mul_f32 v94, v94, v72
    v_mul_f32 v95, v95, v73
    v_cvt_pk_bf16_f32 v94, v94, v95
    v_lshlrev_b32 v95, 16, v94
    v_and_b32 v94, 0xffff0000, v94
    v_add_f32 v91, v91, v95
    v_add_f32 v91, v91, v94
    v_dot2_f32_bf16 v90, v41, v57, v90
    v_lshlrev_b32 v94, 16, v41
    v_and_b32 v95, 0xffff0000, v41
    v_mul_f32 v94, v94, v74
    v_mul_f32 v95, v95, v75
    v_cvt_pk_bf16_f32 v94, v94, v95
    v_lshlrev_b32 v95, 16, v94
    v_and_b32 v94, 0xffff0000, v94
    v_add_f32 v91, v91, v95
    v_add_f32 v91, v91, v94
    v_dot2_f32_bf16 v90, v42, v58, v90
    v_lshlrev_b32 v94, 16, v42
    v_and_b32 v95, 0xffff0000, v42
    v_mul_f32 v94, v94, v76
    v_mul_f32 v95, v95, v77
    v_cvt_pk_bf16_f32 v94, v94, v95
    v_lshlrev_b32 v95, 16, v94
    v_and_b32 v94, 0xffff0000, v94
    v_add_f32 v91, v91, v95
    v_add_f32 v91, v91, v94
    v_dot2_f32_bf16 v90, v43, v59, v90
    v_lshlrev_b32 v94, 16, v43
    v_and_b32 v95, 0xffff0000, v43
    v_mul_f32 v94, v94, v78
    v_mul_f32 v95, v95, v79
    v_cvt_pk_bf16_f32 v94, v94, v95
    v_lshlrev_b32 v95, 16, v94
    v_and_b32 v94, 0xffff0000, v94
    v_add_f32 v91, v91, v95
    v_add_f32 v91, v91, v94
    v_dot2_f32_bf16 v90, v44, v60, v90
    v_lshlrev_b32 v94, 16, v44
    v_and_b32 v95, 0xffff0000, v44
    v_mul_f32 v94, v94, v80
    v_mul_f32 v95, v95, v81
    v_cvt_pk_bf16_f32 v94, v94, v95
    v_lshlrev_b32 v95, 16, v94
    v_and_b32 v94, 0xffff0000, v94
    v_add_f32 v91, v91, v95
    v_add_f32 v91, v91, v94
    v_dot2_f32_bf16 v90, v45, v61, v90
    v_lshlrev_b32 v94, 16, v45
    v_and_b32 v95, 0xffff0000, v45
    v_mul_f32 v94, v94, v82
    v_mul_f32 v95, v95, v83
    v_cvt_pk_bf16_f32 v94, v94, v95
    v_lshlrev_b32 v95, 16, v94
    v_and_b32 v94, 0xffff0000, v94
    v_add_f32 v91, v91, v95
    v_add_f32 v91, v91, v94
    v_dot2_f32_bf16 v90, v46, v62, v90
    v_lshlrev_b32 v94, 16, v46
    v_and_b32 v95, 0xffff0000, v46
    v_mul_f32 v94, v94, v84
    v_mul_f32 v95, v95, v85
    v_cvt_pk_bf16_f32 v94, v94, v95
    v_lshlrev_b32 v95, 16, v94
    v_and_b32 v94, 0xffff0000, v94
    v_add_f32 v91, v91, v95
    v_add_f32 v91, v91, v94
    v_dot2_f32_bf16 v90, v47, v63, v90
    v_lshlrev_b32 v94, 16, v47
    v_and_b32 v95, 0xffff0000, v47
    v_mul_f32 v94, v94, v86
    v_mul_f32 v95, v95, v87
    v_cvt_pk_bf16_f32 v94, v94, v95
    v_lshlrev_b32 v95, 16, v94
    v_and_b32 v94, 0xffff0000, v94
    v_add_f32 v91, v91, v95
    v_add_f32 v91, v91, v94
    v_mov_b32 v92, 0
    v_mov_b32 v93, 0
    v_dot2_f32_bf16 v92, v48, v56, v92
    v_lshlrev_b32 v94, 16, v48
    v_and_b32 v95, 0xffff0000, v48
    v_mul_f32 v94, v94, v72
    v_mul_f32 v95, v95, v73
    v_cvt_pk_bf16_f32 v94, v94, v95
    v_lshlrev_b32 v95, 16, v94
    v_and_b32 v94, 0xffff0000, v94
    v_add_f32 v93, v93, v95
    v_add_f32 v93, v93, v94
    v_dot2_f32_bf16 v92, v49, v57, v92
    v_lshlrev_b32 v94, 16, v49
    v_and_b32 v95, 0xffff0000, v49
    v_mul_f32 v94, v94, v74
    v_mul_f32 v95, v95, v75
    v_cvt_pk_bf16_f32 v94, v94, v95
    v_lshlrev_b32 v95, 16, v94
    v_and_b32 v94, 0xffff0000, v94
    v_add_f32 v93, v93, v95
    v_add_f32 v93, v93, v94
    v_dot2_f32_bf16 v92, v50, v58, v92
    s_barrier
    s_bfe_u32 s91, s68, 0x40010
    s_lshl_b32 s92, s91, 7
    s_mul_i32 s93, s91, 393216
    s_add_u32 m0, s94, 40960
    s_nop 0
    buffer_load_dwordx4 v20, s[24:27], s92 offen offset:0 lds
    buffer_load_dwordx4 v21, s[24:27], s92 offen offset:1024 lds
    buffer_load_dwordx4 v22, s[24:27], s92 offen offset:2048 lds
    buffer_load_dwordx4 v23, s[24:27], s92 offen offset:3072 lds
    s_add_u32 m0, s95, 40960
    s_nop 0
    buffer_load_dwordx4 v24, s[28:31], s93 offen offset:0 lds
    v_lshlrev_b32 v94, 16, v50
    v_and_b32 v95, 0xffff0000, v50
    v_mul_f32 v94, v94, v76
    v_mul_f32 v95, v95, v77
    v_cvt_pk_bf16_f32 v94, v94, v95
    v_lshlrev_b32 v95, 16, v94
    v_and_b32 v94, 0xffff0000, v94
    v_add_f32 v93, v93, v95
    v_add_f32 v93, v93, v94
    v_dot2_f32_bf16 v92, v51, v59, v92
    v_lshlrev_b32 v94, 16, v51
    v_and_b32 v95, 0xffff0000, v51
    v_mul_f32 v94, v94, v78
    v_mul_f32 v95, v95, v79
    v_cvt_pk_bf16_f32 v94, v94, v95
    v_lshlrev_b32 v95, 16, v94
    v_and_b32 v94, 0xffff0000, v94
    v_add_f32 v93, v93, v95
    v_add_f32 v93, v93, v94
    v_dot2_f32_bf16 v92, v52, v60, v92
    v_lshlrev_b32 v94, 16, v52
    v_and_b32 v95, 0xffff0000, v52
    v_mul_f32 v94, v94, v80
    v_mul_f32 v95, v95, v81
    v_cvt_pk_bf16_f32 v94, v94, v95
    v_lshlrev_b32 v95, 16, v94
    v_and_b32 v94, 0xffff0000, v94
    v_add_f32 v93, v93, v95
    v_add_f32 v93, v93, v94
    v_dot2_f32_bf16 v92, v53, v61, v92
    v_lshlrev_b32 v94, 16, v53
    v_and_b32 v95, 0xffff0000, v53
    v_mul_f32 v94, v94, v82
    v_mul_f32 v95, v95, v83
    v_cvt_pk_bf16_f32 v94, v94, v95
    v_lshlrev_b32 v95, 16, v94
    v_and_b32 v94, 0xffff0000, v94
    v_add_f32 v93, v93, v95
    v_add_f32 v93, v93, v94
    v_dot2_f32_bf16 v92, v54, v62, v92
    v_lshlrev_b32 v94, 16, v54
    v_and_b32 v95, 0xffff0000, v54
    v_mul_f32 v94, v94, v84
    v_mul_f32 v95, v95, v85
    v_cvt_pk_bf16_f32 v94, v94, v95
    v_lshlrev_b32 v95, 16, v94
    v_and_b32 v94, 0xffff0000, v94
    v_add_f32 v93, v93, v95
    v_add_f32 v93, v93, v94
    v_dot2_f32_bf16 v92, v55, v63, v92
    v_lshlrev_b32 v94, 16, v55
    v_and_b32 v95, 0xffff0000, v55
    v_mul_f32 v94, v94, v86
    v_mul_f32 v95, v95, v87
    v_cvt_pk_bf16_f32 v94, v94, v95
    v_lshlrev_b32 v95, 16, v94
    v_and_b32 v94, 0xffff0000, v94
    v_add_f32 v93, v93, v95
    v_add_f32 v93, v93, v94
    v_add_f32_dpp v90, v90, v90 row_shr:1 row_mask:0xf bank_mask:0xf
    v_add_f32_dpp v91, v91, v91 row_shr:1 row_mask:0xf bank_mask:0xf
    v_add_f32_dpp v92, v92, v92 row_shr:1 row_mask:0xf bank_mask:0xf
    v_add_f32_dpp v93, v93, v93 row_shr:1 row_mask:0xf bank_mask:0xf
    v_add_f32_dpp v90, v90, v90 row_shr:2 row_mask:0xf bank_mask:0xf
    v_add_f32_dpp v91, v91, v91 row_shr:2 row_mask:0xf bank_mask:0xf
    v_add_f32_dpp v92, v92, v92 row_shr:2 row_mask:0xf bank_mask:0xf
    v_add_f32_dpp v93, v93, v93 row_shr:2 row_mask:0xf bank_mask:0xf
    v_add_f32_dpp v90, v90, v90 row_shr:4 row_mask:0xf bank_mask:0xf
    v_add_f32_dpp v91, v91, v91 row_shr:4 row_mask:0xf bank_mask:0xf
    v_add_f32_dpp v92, v92, v92 row_shr:4 row_mask:0xf bank_mask:0xf
    v_add_f32_dpp v93, v93, v93 row_shr:4 row_mask:0xf bank_mask:0xf
    v_add_f32_dpp v90, v90, v90 row_shr:8 row_mask:0xf bank_mask:0xf
    v_add_f32_dpp v91, v91, v91 row_shr:8 row_mask:0xf bank_mask:0xf
    v_add_f32_dpp v92, v92, v92 row_shr:8 row_mask:0xf bank_mask:0xf
    v_add_f32_dpp v93, v93, v93 row_shr:8 row_mask:0xf bank_mask:0xf
    v_add_f32_dpp v90, v90, v90 row_bcast:15 row_mask:0xa bank_mask:0xf
    v_add_f32_dpp v91, v91, v91 row_bcast:15 row_mask:0xa bank_mask:0xf
    v_add_f32_dpp v92, v92, v92 row_bcast:15 row_mask:0xa bank_mask:0xf
    v_add_f32_dpp v93, v93, v93 row_bcast:15 row_mask:0xa bank_mask:0xf
    v_add_f32_dpp v90, v90, v90 row_bcast:31 row_mask:0xc bank_mask:0xf
    v_add_f32_dpp v91, v91, v91 row_bcast:31 row_mask:0xc bank_mask:0xf
    v_add_f32_dpp v92, v92, v92 row_bcast:31 row_mask:0xc bank_mask:0xf
    v_add_f32_dpp v93, v93, v93 row_bcast:31 row_mask:0xc bank_mask:0xf
    v_cvt_pk_bf16_f32 v94, v90, v91
    v_and_b32 v95, 0xffff, v94
    v_and_b32 v96, 0x8000, v94
    v_cmp_ne_u32 vcc, 0, v96
    v_mov_b32 v97, 0x8000
    v_mov_b32 v98, 0xffff
    v_cndmask_b32 v96, v97, v98, vcc
    v_xor_b32 v95, v95, v96
    s_sub_u32 s12, 2047, s22
    v_lshlrev_b32 v95, 11, v95
    v_or_b32 v100, s12, v95
    v_and_b32 v94, 0xffff0000, v94
    v_mul_f32 v94, 0xbfb8aa3b, v94
    v_exp_f32 v94, v94
    s_nop 0
    v_add_f32 v94, 1.0, v94
    v_rcp_f32 v94, v94
    s_nop 0
    v_cvt_pk_bf16_f32 v94, v94, v94
    v_lshlrev_b32 v102, 16, v94
    v_cvt_pk_bf16_f32 v94, v92, v93
    v_and_b32 v95, 0xffff, v94
    v_and_b32 v96, 0x8000, v94
    v_cmp_ne_u32 vcc, 0, v96
    v_mov_b32 v97, 0x8000
    v_mov_b32 v98, 0xffff
    v_cndmask_b32 v96, v97, v98, vcc
    v_xor_b32 v95, v95, v96
    s_sub_u32 s12, 2046, s22
    v_lshlrev_b32 v95, 11, v95
    v_or_b32 v101, s12, v95
    v_and_b32 v94, 0xffff0000, v94
    v_mul_f32 v94, 0xbfb8aa3b, v94
    v_exp_f32 v94, v94
    s_nop 0
    v_add_f32 v94, 1.0, v94
    v_rcp_f32 v94, v94
    s_nop 0
    v_cvt_pk_bf16_f32 v94, v94, v94
    v_lshlrev_b32 v103, 16, v94
    v_max_u32 v100, v100, v101
    s_lshl_b32 s12, s22, 2
    s_add_u32 s12, s12, 4096
    s_lshl_b32 s13, s21, 2
    s_add_u32 s13, s13, 162880
    v_mov_b32 v14, s13
    s_mov_b32 exec_lo, 0
    s_mov_b32 exec_hi, 0x80000000
    buffer_store_dwordx2 v[102:103], v13, s[32:35], s12 offen sc1
    ds_write_b32 v14, v100
    s_mov_b64 exec, -1
    s_waitcnt lgkmcnt(0)
    buffer_load_dword v15, v13, s[72:75], 0 offen offset:4 sc1
    s_waitcnt vmcnt(15)
    s_barrier
    s_add_u32 m0, s95, 40960
    s_nop 0
    buffer_load_dwordx4 v25, s[28:31], s93 offen offset:1024 lds
    buffer_load_dwordx4 v26, s[28:31], s93 offen offset:2048 lds
    s_add_u32 m0, s95, 44032
    s_nop 0
    buffer_load_dwordx4 v27, s[28:31], s93 offen offset:0 lds
    buffer_load_dwordx4 v28, s[28:31], s93 offen offset:1024 lds
    buffer_load_dwordx4 v29, s[28:31], s93 offen offset:2048 lds
    s_bfe_u32 s91, s68, 0x40014
    s_lshl_b32 s92, s91, 7
    s_mul_i32 s93, s91, 393216
    s_add_u32 m0, s94, 81920
    s_nop 0
    buffer_load_dwordx4 v20, s[24:27], s92 offen offset:0 lds
    buffer_load_dwordx4 v21, s[24:27], s92 offen offset:1024 lds
    buffer_load_dwordx4 v22, s[24:27], s92 offen offset:2048 lds
    buffer_load_dwordx4 v23, s[24:27], s92 offen offset:3072 lds
    s_add_u32 m0, s95, 81920
    s_nop 0
    buffer_load_dwordx4 v24, s[28:31], s93 offen offset:0 lds
    buffer_load_dwordx4 v25, s[28:31], s93 offen offset:1024 lds
    buffer_load_dwordx4 v26, s[28:31], s93 offen offset:2048 lds
    s_waitcnt vmcnt(7)
    s_barrier
    s_add_u32 m0, s95, 84992
    s_nop 0
    buffer_load_dwordx4 v27, s[28:31], s93 offen offset:0 lds
    buffer_load_dwordx4 v28, s[28:31], s93 offen offset:1024 lds
    buffer_load_dwordx4 v29, s[28:31], s93 offen offset:2048 lds
    s_bfe_u32 s91, s68, 0x40018
    s_lshl_b32 s92, s91, 7
    s_mul_i32 s93, s91, 393216
    s_add_u32 m0, s94, 0
    s_nop 0
    buffer_load_dwordx4 v20, s[24:27], s92 offen offset:0 lds
    buffer_load_dwordx4 v21, s[24:27], s92 offen offset:1024 lds
    buffer_load_dwordx4 v22, s[24:27], s92 offen offset:2048 lds
    buffer_load_dwordx4 v23, s[24:27], s92 offen offset:3072 lds
    s_add_u32 m0, s95, 0
    s_nop 0
    buffer_load_dwordx4 v24, s[28:31], s93 offen offset:0 lds
    buffer_load_dwordx4 v25, s[28:31], s93 offen offset:1024 lds
    buffer_load_dwordx4 v26, s[28:31], s93 offen offset:2048 lds
    s_add_u32 m0, s95, 3072
    s_nop 0
    buffer_load_dwordx4 v27, s[28:31], s93 offen offset:0 lds
    buffer_load_dwordx4 v28, s[28:31], s93 offen offset:1024 lds
    s_mov_b32 s13, 0
L_tagchk_1:
    v_readfirstlane_b32 s23, v15
    s_nop 1
    s_cmp_lg_u32 s23, 0
    s_cbranch_scc1 L_tagok_1
    s_add_u32 s13, s13, 1
    s_cmp_ge_u32 s13, 16384
    s_cbranch_scc1 L_tagok_1
    buffer_load_dword v15, v13, s[72:75], 0 offen offset:4 sc1
    s_waitcnt vmcnt(0)
    s_branch L_tagchk_1
L_tagok_1:
    s_and_b32 s76, s23, 0xff
    s_bfe_u32 s77, s23, 0x80008
    s_bfe_u32 s78, s23, 0x80010
    s_lshr_b32 s79, s23, 24
    v_and_b32 v35, 3, v2
    v_lshlrev_b32 v35, 3, v35
    v_bfe_u32 v35, s23, v35, 8
    s_cmp_lg_u32 s21, 0
    s_cbranch_scc1 L_nopub_1
    v_mov_b32 v14, 162880
    ds_read_b128 v[104:107], v14
    s_lshl_b32 s12, s2, 3
    s_add_u32 s12, s12, 0
    s_waitcnt lgkmcnt(0)
    v_max3_u32 v104, v104, v105, v106
    v_max_u32 v104, v104, v107
    v_mov_b32 v105, s23
    s_mov_b64 exec, 1
    buffer_store_dwordx2 v[104:105], v13, s[32:35], s12 offen sc1
    s_mov_b64 exec, -1
L_nopub_1:
    s_waitcnt vmcnt(9)
    s_barrier
    s_add_u32 m0, s95, 3072
    s_nop 0
    buffer_load_dwordx4 v29, s[28:31], s93 offen offset:2048 lds
    s_bfe_u32 s91, s68, 0x4001c
    s_lshl_b32 s92, s91, 7
    s_mul_i32 s93, s91, 393216
    s_add_u32 m0, s94, 40960
    s_nop 0
    buffer_load_dwordx4 v20, s[24:27], s92 offen offset:0 lds
    buffer_load_dwordx4 v21, s[24:27], s92 offen offset:1024 lds
    buffer_load_dwordx4 v22, s[24:27], s92 offen offset:2048 lds
    buffer_load_dwordx4 v23, s[24:27], s92 offen offset:3072 lds
    s_add_u32 m0, s95, 40960
    s_nop 0
    buffer_load_dwordx4 v24, s[28:31], s93 offen offset:0 lds
    buffer_load_dwordx4 v25, s[28:31], s93 offen offset:1024 lds
    buffer_load_dwordx4 v26, s[28:31], s93 offen offset:2048 lds
    s_add_u32 m0, s95, 44032
    s_nop 0
    buffer_load_dwordx4 v27, s[28:31], s93 offen offset:0 lds
    buffer_load_dwordx4 v28, s[28:31], s93 offen offset:1024 lds
    buffer_load_dwordx4 v29, s[28:31], s93 offen offset:2048 lds
    s_waitcnt vmcnt(10)
    s_barrier
    s_bfe_u32 s91, s69, 0x40000
    s_lshl_b32 s92, s91, 7
    s_mul_i32 s93, s91, 393216
    s_add_u32 m0, s94, 81920
    s_nop 0
    buffer_load_dwordx4 v20, s[24:27], s92 offen offset:0 lds
    buffer_load_dwordx4 v21, s[24:27], s92 offen offset:1024 lds
    buffer_load_dwordx4 v22, s[24:27], s92 offen offset:2048 lds
    buffer_load_dwordx4 v23, s[24:27], s92 offen offset:3072 lds
    s_add_u32 m0, s95, 81920
    s_nop 0
    buffer_load_dwordx4 v24, s[28:31], s93 offen offset:0 lds
    buffer_load_dwordx4 v25, s[28:31], s93 offen offset:1024 lds
    buffer_load_dwordx4 v26, s[28:31], s93 offen offset:2048 lds
    s_add_u32 m0, s95, 84992
    s_nop 0
    buffer_load_dwordx4 v27, s[28:31], s93 offen offset:0 lds
    buffer_load_dwordx4 v28, s[28:31], s93 offen offset:1024 lds
    buffer_load_dwordx4 v29, s[28:31], s93 offen offset:2048 lds
    s_add_u32 s12, s71, 0
    buffer_load_dwordx4 v[160:163], v30, s[44:47], s12 offen nt
    s_add_u32 s12, s71, 7168
    buffer_load_dwordx4 v[164:167], v30, s[44:47], s12 offen nt
    s_add_u32 s12, s71, 14336
    buffer_load_dwordx4 v[168:171], v30, s[44:47], s12 offen nt
    s_add_u32 s12, s71, 21504
    buffer_load_dwordx4 v[172:175], v30, s[44:47], s12 offen nt
    s_add_u32 s12, s71, 28672
    buffer_load_dwordx4 v[176:179], v30, s[44:47], s12 offen nt
    s_add_u32 s12, s71, 35840
    buffer_load_dwordx4 v[180:183], v30, s[44:47], s12 offen nt
    s_add_u32 s12, s71, 43008
    buffer_load_dwordx4 v[184:187], v30, s[44:47], s12 offen nt
    s_add_u32 s12, s71, 50176
    buffer_load_dwordx4 v[188:191], v30, s[44:47], s12 offen nt
    s_waitcnt vmcnt(18)
    s_barrier
    s_bfe_u32 s91, s69, 0x40004
    s_lshl_b32 s92, s91, 7
    s_mul_i32 s93, s91, 393216
    s_add_u32 m0, s94, 0
    s_nop 0
    buffer_load_dwordx4 v20, s[24:27], s92 offen offset:0 lds
    buffer_load_dwordx4 v21, s[24:27], s92 offen offset:1024 lds
    buffer_load_dwordx4 v22, s[24:27], s92 offen offset:2048 lds
    buffer_load_dwordx4 v23, s[24:27], s92 offen offset:3072 lds
    s_add_u32 m0, s95, 0
    s_nop 0
    buffer_load_dwordx4 v24, s[28:31], s93 offen offset:0 lds
    s_waitcnt vmcnt(13)
    s_barrier
    s_add_u32 m0, s95, 0
    s_nop 0
    buffer_load_dwordx4 v25, s[28:31], s93 offen offset:1024 lds
    buffer_load_dwordx4 v26, s[28:31], s93 offen offset:2048 lds
    s_add_u32 m0, s95, 3072
    s_nop 0
    buffer_load_dwordx4 v27, s[28:31], s93 offen offset:0 lds
    buffer_load_dwordx4 v28, s[28:31], s93 offen offset:1024 lds
    buffer_load_dwordx4 v29, s[28:31], s93 offen offset:2048 lds
    s_bfe_u32 s91, s69, 0x40008
    s_lshl_b32 s92, s91, 7
    s_mul_i32 s93, s91, 393216
    s_add_u32 m0, s94, 40960
    s_nop 0
    buffer_load_dwordx4 v20, s[24:27], s92 offen offset:0 lds
    buffer_load_dwordx4 v21, s[24:27], s92 offen offset:1024 lds
    buffer_load_dwordx4 v22, s[24:27], s92 offen offset:2048 lds
    buffer_load_dwordx4 v23, s[24:27], s92 offen offset:3072 lds
    s_add_u32 m0, s95, 40960
    s_nop 0
    buffer_load_dwordx4 v24, s[28:31], s93 offen offset:0 lds
    buffer_load_dwordx4 v25, s[28:31], s93 offen offset:1024 lds
    buffer_load_dwordx4 v26, s[28:31], s93 offen offset:2048 lds
    s_waitcnt vmcnt(7)
    s_barrier
    s_add_u32 m0, s95, 44032
    s_nop 0
    buffer_load_dwordx4 v27, s[28:31], s93 offen offset:0 lds
    buffer_load_dwordx4 v28, s[28:31], s93 offen offset:1024 lds
    buffer_load_dwordx4 v29, s[28:31], s93 offen offset:2048 lds
    s_bfe_u32 s91, s69, 0x4000c
    s_lshl_b32 s92, s91, 7
    s_mul_i32 s93, s91, 393216
    s_add_u32 m0, s94, 81920
    s_nop 0
    buffer_load_dwordx4 v20, s[24:27], s92 offen offset:0 lds
    buffer_load_dwordx4 v21, s[24:27], s92 offen offset:1024 lds
    buffer_load_dwordx4 v22, s[24:27], s92 offen offset:2048 lds
    buffer_load_dwordx4 v23, s[24:27], s92 offen offset:3072 lds
    s_add_u32 m0, s95, 81920
    s_nop 0
    buffer_load_dwordx4 v24, s[28:31], s93 offen offset:0 lds
    buffer_load_dwordx4 v25, s[28:31], s93 offen offset:1024 lds
    buffer_load_dwordx4 v26, s[28:31], s93 offen offset:2048 lds
    s_add_u32 m0, s95, 84992
    s_nop 0
    buffer_load_dwordx4 v27, s[28:31], s93 offen offset:0 lds
    buffer_load_dwordx4 v28, s[28:31], s93 offen offset:1024 lds
    s_mov_b32 s12, 0
    buffer_load_dwordx4 v[104:107], v5, s[32:35], s12 offen offset:0 sc1
    buffer_load_dwordx4 v[108:111], v5, s[32:35], s12 offen offset:1024 sc1
    s_waitcnt vmcnt(11)
    s_barrier
    s_add_u32 m0, s95, 84992
    s_nop 0
    buffer_load_dwordx4 v29, s[28:31], s93 offen offset:2048 lds
    s_bfe_u32 s91, s69, 0x40010
    s_lshl_b32 s92, s91, 7
    s_mul_i32 s93, s91, 393216
    s_add_u32 m0, s94, 0
    s_nop 0
    buffer_load_dwordx4 v20, s[24:27], s92 offen offset:0 lds
    buffer_load_dwordx4 v21, s[24:27], s92 offen offset:1024 lds
    buffer_load_dwordx4 v22, s[24:27], s92 offen offset:2048 lds
    buffer_load_dwordx4 v23, s[24:27], s92 offen offset:3072 lds
    s_add_u32 m0, s95, 0
    s_nop 0
    buffer_load_dwordx4 v24, s[28:31], s93 offen offset:0 lds
    buffer_load_dwordx4 v25, s[28:31], s93 offen offset:1024 lds
    buffer_load_dwordx4 v26, s[28:31], s93 offen offset:2048 lds
    s_add_u32 m0, s95, 3072
    s_nop 0
    buffer_load_dwordx4 v27, s[28:31], s93 offen offset:0 lds
    buffer_load_dwordx4 v28, s[28:31], s93 offen offset:1024 lds
    buffer_load_dwordx4 v29, s[28:31], s93 offen offset:2048 lds
    s_waitcnt vmcnt(10)
    s_barrier
    s_bfe_u32 s91, s69, 0x40014
    s_lshl_b32 s92, s91, 7
    s_mul_i32 s93, s91, 393216
    s_add_u32 m0, s94, 40960
    s_nop 0
    buffer_load_dwordx4 v20, s[24:27], s92 offen offset:0 lds
    buffer_load_dwordx4 v21, s[24:27], s92 offen offset:1024 lds
    buffer_load_dwordx4 v22, s[24:27], s92 offen offset:2048 lds
    buffer_load_dwordx4 v23, s[24:27], s92 offen offset:3072 lds
    s_add_u32 m0, s95, 40960
    s_nop 0
    buffer_load_dwordx4 v24, s[28:31], s93 offen offset:0 lds
    buffer_load_dwordx4 v25, s[28:31], s93 offen offset:1024 lds
    buffer_load_dwordx4 v26, s[28:31], s93 offen offset:2048 lds
    s_add_u32 m0, s95, 44032
    s_nop 0
    buffer_load_dwordx4 v27, s[28:31], s93 offen offset:0 lds
    buffer_load_dwordx4 v28, s[28:31], s93 offen offset:1024 lds
    buffer_load_dwordx4 v29, s[28:31], s93 offen offset:2048 lds
    s_add_u32 s12, s97, 0
    buffer_load_dwordx4 v[192:195], v31, s[64:67], s12 offen nt
    s_add_u32 s12, s97, 16384
    buffer_load_dwordx4 v[196:199], v31, s[64:67], s12 offen nt
    s_add_u32 s12, s97, 32768
    buffer_load_dwordx4 v[200:203], v31, s[64:67], s12 offen nt
    s_add_u32 s12, s97, 49152
    buffer_load_dwordx4 v[204:207], v31, s[64:67], s12 offen nt
    s_add_u32 s12, s97, 65536
    buffer_load_dwordx4 v[208:211], v31, s[64:67], s12 offen nt
    s_add_u32 s12, s97, 81920
    buffer_load_dwordx4 v[212:215], v31, s[64:67], s12 offen nt
    s_add_u32 s12, s97, 98304
    buffer_load_dwordx4 v[216:219], v31, s[64:67], s12 offen nt
    s_mov_b32 s13, 0
L_keychk_1:
    v_xor_b32 v105, s23, v105
    v_xor_b32 v107, s23, v107
    v_xor_b32 v109, s23, v109
    v_xor_b32 v111, s23, v111
    v_or3_b32 v105, v105, v107, v109
    v_or_b32 v105, v105, v111
    v_cmp_ne_u32 vcc, 0, v105
    s_cbranch_vccz L_keyok_1
    s_add_u32 s13, s13, 1
    s_cmp_ge_u32 s13, 16384
    s_cbranch_scc1 L_keyok_1
    s_mov_b32 s12, 0
    buffer_load_dwordx4 v[104:107], v5, s[32:35], s12 offen offset:0 sc1
    buffer_load_dwordx4 v[108:111], v5, s[32:35], s12 offen offset:1024 sc1
    s_waitcnt vmcnt(0)
    s_branch L_keychk_1
L_keyok_1:
    v_max3_u32 v104, v104, v106, v108
    v_max_u32 v104, v104, v110
    s_nop 1
    v_max_u32_dpp v104, v104, v104 row_shr:1 row_mask:0xf bank_mask:0xf
    s_nop 1
    v_max_u32_dpp v104, v104, v104 row_shr:2 row_mask:0xf bank_mask:0xf
    s_nop 1
    v_max_u32_dpp v104, v104, v104 row_shr:4 row_mask:0xf bank_mask:0xf
    s_nop 1
    v_max_u32_dpp v104, v104, v104 row_shr:8 row_mask:0xf bank_mask:0xf
    s_nop 1
    v_max_u32_dpp v104, v104, v104 row_bcast:15 row_mask:0xa bank_mask:0xf
    s_nop 1
    v_max_u32_dpp v104, v104, v104 row_bcast:31 row_mask:0xc bank_mask:0xf
    s_nop 0
    v_readlane_b32 s14, v104, 63
    s_nop 1
    s_and_b32 s15, s14, 2047
    s_sub_u32 s15, 2047, s15
    s_lshl_b32 s12, s15, 11
    s_lshl_b32 s13, s70, 1
    s_add_u32 s12, s12, s13
    buffer_load_dwordx4 v[36:39], v34, s[24:27], s12 offen
    s_lshr_b32 s12, s14, 11
    s_and_b32 s13, s12, 0x8000
    s_cmp_lg_u32 s13, 0
    s_mov_b32 s13, 0xffff
    s_cselect_b32 s13, 0x8000, s13
    s_xor_b32 s12, s12, s13
    s_lshl_b32 s12, s12, 16
    v_mov_b32 v105, s12
    v_mul_f32 v105, 0xbfb8aa3b, v105
    v_exp_f32 v105, v105
    s_nop 0
    v_add_f32 v105, 1.0, v105
    v_rcp_f32 v105, v105
    s_nop 0
    v_cvt_pk_bf16_f32 v105, v105, v105
    v_lshlrev_b32 v105, 16, v105
    s_nop 0
    v_readfirstlane_b32 s14, v105
    s_add_u32 s12, s15, 1
    v_mov_b32 v104, s12
    v_mov_b32 v106, s23
    v_mov_b32 v14, 162864
    s_mov_b64 exec, 1
    ds_write_b96 v14, v[104:106]
    s_mov_b64 exec, -1
    s_waitcnt lgkmcnt(0)
    s_waitcnt vmcnt(18)
    s_barrier
    s_bfe_u32 s91, s69, 0x40018
    s_lshl_b32 s92, s91, 7
    s_mul_i32 s93, s91, 393216
    s_add_u32 m0, s94, 81920
    s_nop 0
    buffer_load_dwordx4 v20, s[24:27], s92 offen offset:0 lds
    buffer_load_dwordx4 v21, s[24:27], s92 offen offset:1024 lds
    buffer_load_dwordx4 v22, s[24:27], s92 offen offset:2048 lds
    buffer_load_dwordx4 v23, s[24:27], s92 offen offset:3072 lds
    s_add_u32 m0, s95, 81920
    s_nop 0
    buffer_load_dwordx4 v24, s[28:31], s93 offen offset:0 lds
    s_waitcnt vmcnt(5)
    v_and_b32 v40, 0xffff, v36
    v_lshlrev_b32 v41, 16, v36
    v_lshrrev_b32 v42, 16, v36
    v_and_b32 v43, 0xffff0000, v36
    v_and_b32 v44, 0xffff, v37
    v_lshlrev_b32 v45, 16, v37
    v_lshrrev_b32 v46, 16, v37
    v_and_b32 v47, 0xffff0000, v37
    v_and_b32 v48, 0xffff, v38
    v_lshlrev_b32 v49, 16, v38
    v_lshrrev_b32 v50, 16, v38
    v_and_b32 v51, 0xffff0000, v38
    v_and_b32 v52, 0xffff, v39
    v_lshlrev_b32 v53, 16, v39
    v_lshrrev_b32 v54, 16, v39
    v_and_b32 v55, 0xffff0000, v39
    v_dot2_f32_bf16 v220, v128, v40, 0
    v_dot2_f32_bf16 v221, v128, v41, 0
    v_dot2_f32_bf16 v222, v129, v40, 0
    v_dot2_f32_bf16 v223, v129, v41, 0
    v_dot2_f32_bf16 v224, v130, v40, 0
    v_dot2_f32_bf16 v225, v130, v41, 0
    v_dot2_f32_bf16 v226, v131, v40, 0
    v_dot2_f32_bf16 v227, v131, v41, 0
    v_dot2_f32_bf16 v228, v160, v40, 0
    v_dot2_f32_bf16 v229, v160, v41, 0
    v_dot2_f32_bf16 v230, v161, v40, 0
    v_dot2_f32_bf16 v231, v161, v41, 0
    v_dot2_f32_bf16 v232, v162, v40, 0
    v_dot2_f32_bf16 v233, v162, v41, 0
    v_dot2_f32_bf16 v234, v163, v40, 0
    v_dot2_f32_bf16 v235, v163, v41, 0
    v_dot2_f32_bf16 v220, v132, v42, v220
    v_dot2_f32_bf16 v221, v132, v43, v221
    v_dot2_f32_bf16 v222, v133, v42, v222
    v_dot2_f32_bf16 v223, v133, v43, v223
    v_dot2_f32_bf16 v224, v134, v42, v224
    v_dot2_f32_bf16 v225, v134, v43, v225
    v_dot2_f32_bf16 v226, v135, v42, v226
    v_dot2_f32_bf16 v227, v135, v43, v227
    v_dot2_f32_bf16 v228, v164, v42, v228
    v_dot2_f32_bf16 v229, v164, v43, v229
    v_dot2_f32_bf16 v230, v165, v42, v230
    v_dot2_f32_bf16 v231, v165, v43, v231
    v_dot2_f32_bf16 v232, v166, v42, v232
    v_dot2_f32_bf16 v233, v166, v43, v233
    v_dot2_f32_bf16 v234, v167, v42, v234
    v_dot2_f32_bf16 v235, v167, v43, v235
    v_dot2_f32_bf16 v220, v136, v44, v220
    v_dot2_f32_bf16 v221, v136, v45, v221
    v_dot2_f32_bf16 v222, v137, v44, v222
    v_dot2_f32_bf16 v223, v137, v45, v223
    v_dot2_f32_bf16 v224, v138, v44, v224
    v_dot2_f32_bf16 v225, v138, v45, v225
    v_dot2_f32_bf16 v226, v139, v44, v226
    v_dot2_f32_bf16 v227, v139, v45, v227
    v_dot2_f32_bf16 v228, v168, v44, v228
    v_dot2_f32_bf16 v229, v168, v45, v229
    s_barrier
    s_add_u32 m0, s95, 81920
    s_nop 0
    buffer_load_dwordx4 v25, s[28:31], s93 offen offset:1024 lds
    buffer_load_dwordx4 v26, s[28:31], s93 offen offset:2048 lds
    s_add_u32 m0, s95, 84992
    s_nop 0
    buffer_load_dwordx4 v27, s[28:31], s93 offen offset:0 lds
    buffer_load_dwordx4 v28, s[28:31], s93 offen offset:1024 lds
    buffer_load_dwordx4 v29, s[28:31], s93 offen offset:2048 lds
    s_bfe_u32 s91, s69, 0x4001c
    s_lshl_b32 s92, s91, 7
    s_mul_i32 s93, s91, 393216
    s_add_u32 m0, s94, 0
    s_nop 0
    buffer_load_dwordx4 v20, s[24:27], s92 offen offset:0 lds
    buffer_load_dwordx4 v21, s[24:27], s92 offen offset:1024 lds
    buffer_load_dwordx4 v22, s[24:27], s92 offen offset:2048 lds
    buffer_load_dwordx4 v23, s[24:27], s92 offen offset:3072 lds
    s_add_u32 m0, s95, 0
    s_nop 0
    buffer_load_dwordx4 v24, s[28:31], s93 offen offset:0 lds
    buffer_load_dwordx4 v25, s[28:31], s93 offen offset:1024 lds
    buffer_load_dwordx4 v26, s[28:31], s93 offen offset:2048 lds
    v_dot2_f32_bf16 v230, v169, v44, v230
    v_dot2_f32_bf16 v231, v169, v45, v231
    v_dot2_f32_bf16 v232, v170, v44, v232
    v_dot2_f32_bf16 v233, v170, v45, v233
    v_dot2_f32_bf16 v234, v171, v44, v234
    v_dot2_f32_bf16 v235, v171, v45, v235
    v_dot2_f32_bf16 v220, v140, v46, v220
    v_dot2_f32_bf16 v221, v140, v47, v221
    v_dot2_f32_bf16 v222, v141, v46, v222
    v_dot2_f32_bf16 v223, v141, v47, v223
    v_dot2_f32_bf16 v224, v142, v46, v224
    v_dot2_f32_bf16 v225, v142, v47, v225
    v_dot2_f32_bf16 v226, v143, v46, v226
    v_dot2_f32_bf16 v227, v143, v47, v227
    v_dot2_f32_bf16 v228, v172, v46, v228
    v_dot2_f32_bf16 v229, v172, v47, v229
    v_dot2_f32_bf16 v230, v173, v46, v230
    v_dot2_f32_bf16 v231, v173, v47, v231
    v_dot2_f32_bf16 v232, v174, v46, v232
    v_dot2_f32_bf16 v233, v174, v47, v233
    v_dot2_f32_bf16 v234, v175, v46, v234
    v_dot2_f32_bf16 v235, v175, v47, v235
    v_dot2_f32_bf16 v220, v144, v48, v220
    v_dot2_f32_bf16 v221, v144, v49, v221
    v_dot2_f32_bf16 v222, v145, v48, v222
    v_dot2_f32_bf16 v223, v145, v49, v223
    v_dot2_f32_bf16 v224, v146, v48, v224
    v_dot2_f32_bf16 v225, v146, v49, v225
    v_dot2_f32_bf16 v226, v147, v48, v226
    v_dot2_f32_bf16 v227, v147, v49, v227
    v_dot2_f32_bf16 v228, v176, v48, v228
    v_dot2_f32_bf16 v229, v176, v49, v229
    v_dot2_f32_bf16 v230, v177, v48, v230
    v_dot2_f32_bf16 v231, v177, v49, v231
    v_dot2_f32_bf16 v232, v178, v48, v232
    v_dot2_f32_bf16 v233, v178, v49, v233
    v_dot2_f32_bf16 v234, v179, v48, v234
    v_dot2_f32_bf16 v235, v179, v49, v235
    v_dot2_f32_bf16 v220, v148, v50, v220
    v_dot2_f32_bf16 v221, v148, v51, v221
    v_dot2_f32_bf16 v222, v149, v50, v222
    v_dot2_f32_bf16 v223, v149, v51, v223
    v_dot2_f32_bf16 v224, v150, v50, v224
    v_dot2_f32_bf16 v225, v150, v51, v225
    v_dot2_f32_bf16 v226, v151, v50, v226
    v_dot2_f32_bf16 v227, v151, v51, v227
    v_dot2_f32_bf16 v228, v180, v50, v228
    v_dot2_f32_bf16 v229, v180, v51, v229
    v_dot2_f32_bf16 v230, v181, v50, v230
    v_dot2_f32_bf16 v231, v181, v51, v231
    v_dot2_f32_bf16 v232, v182, v50, v232
    v_dot2_f32_bf16 v233, v182, v51, v233
    v_dot2_f32_bf16 v234, v183, v50, v234
    v_dot2_f32_bf16 v235, v183, v51, v235
    v_dot2_f32_bf16 v220, v152, v52, v220
    v_dot2_f32_bf16 v221, v152, v53, v221
    v_dot2_f32_bf16 v222, v153, v52, v222
    v_dot2_f32_bf16 v223, v153, v53, v223
    s_waitcnt vmcnt(7)
    s_barrier
    s_add_u32 m0, s95, 3072
    s_nop 0
    buffer_load_dwordx4 v27, s[28:31], s93 offen offset:0 lds
    buffer_load_dwordx4 v28, s[28:31], s93 offen offset:1024 lds
    buffer_load_dwordx4 v29, s[28:31], s93 offen offset:2048 lds
    s_mul_i32 s12, s21, 8
    s_add_u32 s12, s12, 96
    s_lshl_b32 s13, s12, 10
    s_lshl_b32 s12, s12, 14
    s_add_u32 m0, s13, 24576
    s_add_u32 s90, s12, 0
    buffer_load_dwordx4 v33, s[36:39], s90 offen lds
    s_add_u32 m0, s13, 25600
    s_add_u32 s90, s12, 16384
    buffer_load_dwordx4 v33, s[36:39], s90 offen lds
    s_add_u32 m0, s13, 26624
    s_add_u32 s90, s12, 32768
    buffer_load_dwordx4 v33, s[36:39], s90 offen lds
    s_add_u32 m0, s13, 27648
    s_add_u32 s90, s12, 49152
    buffer_load_dwordx4 v33, s[36:39], s90 offen lds
    s_add_u32 m0, s13, 28672
    s_add_u32 s90, s12, 65536
    buffer_load_dwordx4 v33, s[36:39], s90 offen lds
    s_add_u32 m0, s13, 29696
    s_add_u32 s90, s12, 81920
    buffer_load_dwordx4 v33, s[36:39], s90 offen lds
    s_add_u32 m0, s13, 30720
    s_add_u32 s90, s12, 98304
    buffer_load_dwordx4 v33, s[36:39], s90 offen lds
    s_add_u32 m0, s13, 31744
    s_add_u32 s90, s12, 114688
    buffer_load_dwordx4 v33, s[36:39], s90 offen lds
    v_dot2_f32_bf16 v224, v154, v52, v224
    v_dot2_f32_bf16 v225, v154, v53, v225
    v_dot2_f32_bf16 v226, v155, v52, v226
    v_dot2_f32_bf16 v227, v155, v53, v227
    v_dot2_f32_bf16 v228, v184, v52, v228
    v_dot2_f32_bf16 v229, v184, v53, v229
    v_dot2_f32_bf16 v230, v185, v52, v230
    v_dot2_f32_bf16 v231, v185, v53, v231
    v_dot2_f32_bf16 v232, v186, v52, v232
    v_dot2_f32_bf16 v233, v186, v53, v233
    v_dot2_f32_bf16 v234, v187, v52, v234
    v_dot2_f32_bf16 v235, v187, v53, v235
    v_dot2_f32_bf16 v220, v156, v54, v220
    v_dot2_f32_bf16 v221, v156, v55, v221
    v_dot2_f32_bf16 v222, v157, v54, v222
    v_dot2_f32_bf16 v223, v157, v55, v223
    v_dot2_f32_bf16 v224, v158, v54, v224
    v_dot2_f32_bf16 v225, v158, v55, v225
    v_dot2_f32_bf16 v226, v159, v54, v226
    v_dot2_f32_bf16 v227, v159, v55, v227
    v_dot2_f32_bf16 v228, v188, v54, v228
    v_dot2_f32_bf16 v229, v188, v55, v229
    v_dot2_f32_bf16 v230, v189, v54, v230
    v_dot2_f32_bf16 v231, v189, v55, v231
    v_dot2_f32_bf16 v232, v190, v54, v232
    v_dot2_f32_bf16 v233, v190, v55, v233
    v_dot2_f32_bf16 v234, v191, v54, v234
    v_dot2_f32_bf16 v235, v191, v55, v235
    v_permlane32_swap_b32 v220, v228
    v_permlane32_swap_b32 v221, v229
    v_permlane32_swap_b32 v222, v230
    v_permlane32_swap_b32 v223, v231
    v_permlane32_swap_b32 v224, v232
    v_permlane32_swap_b32 v225, v233
    v_permlane32_swap_b32 v226, v234
    v_permlane32_swap_b32 v227, v235
    v_add_f32 v220, v220, v228
    v_add_f32 v221, v221, v229
    v_add_f32 v222, v222, v230
    v_add_f32 v223, v223, v231
    v_add_f32 v224, v224, v232
    v_add_f32 v225, v225, v233
    v_add_f32 v226, v226, v234
    v_add_f32 v227, v227, v235
    v_permlane16_swap_b32 v220, v224
    v_permlane16_swap_b32 v221, v225
    v_permlane16_swap_b32 v222, v226
    v_permlane16_swap_b32 v223, v227
    v_add_f32 v220, v220, v224
    v_add_f32 v221, v221, v225
    v_add_f32 v222, v222, v226
    v_add_f32 v223, v223, v227
    v_add_f32_dpp v220, v220, v220 row_ror:8 row_mask:0xf bank_mask:0xf
    v_add_f32_dpp v221, v221, v221 row_ror:8 row_mask:0xf bank_mask:0xf
    v_add_f32_dpp v222, v222, v222 row_ror:8 row_mask:0xf bank_mask:0xf
    v_add_f32_dpp v223, v223, v223 row_ror:8 row_mask:0xf bank_mask:0xf
    s_waitcnt vmcnt(8)
    s_barrier
    s_branch L_varend
L_var2:
    s_nop 0
    s_add_u32 m0, s95, 40960
    s_nop 0
    buffer_load_dwordx4 v26, s[28:31], s93 offen offset:2048 lds
    s_add_u32 m0, s95, 44032
    s_nop 0
    buffer_load_dwordx4 v27, s[28:31], s93 offen offset:0 lds
    buffer_load_dwordx4 v28, s[28:31], s93 offen offset:1024 lds
    buffer_load_dwordx4 v29, s[28:31], s93 offen offset:2048 lds
    s_bfe_u32 s91, s68, 0x40008
    s_lshl_b32 s92, s91, 7
    s_mul_i32 s93, s91, 393216
    s_add_u32 m0, s94, 81920
    s_nop 0
    buffer_load_dwordx4 v20, s[24:27], s92 offen offset:0 lds
    buffer_load_dwordx4 v21, s[24:27], s92 offen offset:1024 lds
    buffer_load_dwordx4 v22, s[24:27], s92 offen offset:2048 lds
    buffer_load_dwordx4 v23, s[24:27], s92 offen offset:3072 lds
    s_add_u32 m0, s95, 81920
    s_nop 0
    buffer_load_dwordx4 v24, s[28:31], s93 offen offset:0 lds
    buffer_load_dwordx4 v25, s[28:31], s93 offen offset:1024 lds
    buffer_load_dwordx4 v26, s[28:31], s93 offen offset:2048 lds
    s_add_u32 m0, s95, 84992
    s_nop 0
    buffer_load_dwordx4 v27, s[28:31], s93 offen offset:0 lds
    buffer_load_dwordx4 v28, s[28:31], s93 offen offset:1024 lds
    buffer_load_dwordx4 v29, s[28:31], s93 offen offset:2048 lds
    s_lshl_b32 s12, s19, 2
    s_add_u32 s12, s12, s21
    s_lshl_b32 s12, s12, 10
    s_lshl_b32 s13, s21, 10
    s_add_u32 m0, s13, 155648
    s_nop 0
    buffer_load_dwordx4 v5, s[76:79], s12 offen lds
    s_lshl_b32 s12, s22, 11
    buffer_load_dwordx4 v[40:43], v5, s[24:27], s12 offen offset:0
    buffer_load_dwordx4 v[44:47], v5, s[24:27], s12 offen offset:1024
    buffer_load_dwordx4 v[48:51], v5, s[24:27], s12 offen offset:2048
    buffer_load_dwordx4 v[52:55], v5, s[24:27], s12 offen offset:3072
    buffer_load_dwordx4 v[56:59], v5, s[80:83], 0 offen offset:0
    buffer_load_dwordx4 v[60:63], v5, s[80:83], 0 offen offset:1024
    buffer_load_dwordx4 v[64:67], v5, s[84:87], 0 offen offset:0
    buffer_load_dwordx4 v[68:71], v5, s[84:87], 0 offen offset:1024
    s_waitcnt vmcnt(19)
    s_barrier
    s_bfe_u32 s91, s68, 0x4000c
    s_lshl_b32 s92, s91, 7
    s_mul_i32 s93, s91, 393216
    s_add_u32 m0, s94, 0
    s_nop 0
    buffer_load_dwordx4 v20, s[24:27], s92 offen offset:0 lds
    buffer_load_dwordx4 v21, s[24:27], s92 offen offset:1024 lds
    buffer_load_dwordx4 v22, s[24:27], s92 offen offset:2048 lds
    buffer_load_dwordx4 v23, s[24:27], s92 offen offset:3072 lds
    s_add_u32 m0, s95, 0
    s_nop 0
    buffer_load_dwordx4 v24, s[28:31], s93 offen offset:0 lds
    buffer_load_dwordx4 v25, s[28:31], s93 offen offset:1024 lds
    buffer_load_dwordx4 v26, s[28:31], s93 offen offset:2048 lds
    s_add_u32 m0, s95, 3072
    s_nop 0
    buffer_load_dwordx4 v27, s[28:31], s93 offen offset:0 lds
    buffer_load_dwordx4 v28, s[28:31], s93 offen offset:1024 lds
    buffer_load_dwordx4 v29, s[28:31], s93 offen offset:2048 lds
    s_cmp_lg_u32 s21, 0
    s_cbranch_scc1 L_noclr_2
    v_mov_b32 v104, -1
    v_mov_b32 v105, -1
    v_mov_b32 v106, -1
    v_mov_b32 v107, -1
    s_lshl_b32 s12, s19, 13
    s_lshl_b32 s13, s18, 9
    s_add_u32 s12, s12, s13
    s_add_u32 s12, s12, 32768
    s_lshl_b32 s13, s19, 11
    s_lshl_b32 s90, s18, 7
    s_add_u32 s13, s13, s90
    s_add_u32 s13, s13, 163840
    s_mov_b32 exec_hi, 0
    buffer_store_dwordx4 v[104:107], v5, s[32:35], s12 offen sc1
    s_mov_b32 exec_lo, 255
    buffer_store_dwordx4 v[104:107], v5, s[32:35], s13 offen sc1
    s_mov_b64 exec, -1
L_noclr_2:
    s_waitcnt vmcnt(10)
    v_lshlrev_b32 v72, 16, v64
    v_and_b32 v73, 0xffff0000, v64
    v_lshlrev_b32 v74, 16, v65
    v_and_b32 v75, 0xffff0000, v65
    v_lshlrev_b32 v76, 16, v66
    v_and_b32 v77, 0xffff0000, v66
    v_lshlrev_b32 v78, 16, v67
    v_and_b32 v79, 0xffff0000, v67
    v_lshlrev_b32 v80, 16, v68
    v_and_b32 v81, 0xffff0000, v68
    v_lshlrev_b32 v82, 16, v69
    v_and_b32 v83, 0xffff0000, v69
    v_lshlrev_b32 v84, 16, v70
    v_and_b32 v85, 0xffff0000, v70
    v_lshlrev_b32 v86, 16, v71
    v_and_b32 v87, 0xffff0000, v71
    v_mov_b32 v90, 0
    v_mov_b32 v91, 0
    v_dot2_f32_bf16 v90, v40, v56, v90
    v_lshlrev_b32 v94, 16, v40
    v_and_b32 v95, 0xffff0000, v40
    v_mul_f32 v94, v94, v72
    v_mul_f32 v95, v95, v73
    v_cvt_pk_bf16_f32 v94, v94, v95
    v_lshlrev_b32 v95, 16, v94
    v_and_b32 v94, 0xffff0000, v94
    v_add_f32 v91, v91, v95
    v_add_f32 v91, v91, v94
    v_dot2_f32_bf16 v90, v41, v57, v90
    v_lshlrev_b32 v94, 16, v41
    v_and_b32 v95, 0xffff0000, v41
    v_mul_f32 v94, v94, v74
    v_mul_f32 v95, v95, v75
    v_cvt_pk_bf16_f32 v94, v94, v95
    v_lshlrev_b32 v95, 16, v94
    v_and_b32 v94, 0xffff0000, v94
    v_add_f32 v91, v91, v95
    v_add_f32 v91, v91, v94
    v_dot2_f32_bf16 v90, v42, v58, v90
    v_lshlrev_b32 v94, 16, v42
    v_and_b32 v95, 0xffff0000, v42
    v_mul_f32 v94, v94, v76
    v_mul_f32 v95, v95, v77
    v_cvt_pk_bf16_f32 v94, v94, v95
    v_lshlrev_b32 v95, 16, v94
    v_and_b32 v94, 0xffff0000, v94
    v_add_f32 v91, v91, v95
    v_add_f32 v91, v91, v94
    v_dot2_f32_bf16 v90, v43, v59, v90
    v_lshlrev_b32 v94, 16, v43
    v_and_b32 v95, 0xffff0000, v43
    v_mul_f32 v94, v94, v78
    v_mul_f32 v95, v95, v79
    v_cvt_pk_bf16_f32 v94, v94, v95
    v_lshlrev_b32 v95, 16, v94
    v_and_b32 v94, 0xffff0000, v94
    v_add_f32 v91, v91, v95
    v_add_f32 v91, v91, v94
    v_dot2_f32_bf16 v90, v44, v60, v90
    v_lshlrev_b32 v94, 16, v44
    v_and_b32 v95, 0xffff0000, v44
    v_mul_f32 v94, v94, v80
    v_mul_f32 v95, v95, v81
    v_cvt_pk_bf16_f32 v94, v94, v95
    v_lshlrev_b32 v95, 16, v94
    v_and_b32 v94, 0xffff0000, v94
    v_add_f32 v91, v91, v95
    v_add_f32 v91, v91, v94
    v_dot2_f32_bf16 v90, v45, v61, v90
    v_lshlrev_b32 v94, 16, v45
    v_and_b32 v95, 0xffff0000, v45
    v_mul_f32 v94, v94, v82
    v_mul_f32 v95, v95, v83
    v_cvt_pk_bf16_f32 v94, v94, v95
    v_lshlrev_b32 v95, 16, v94
    v_and_b32 v94, 0xffff0000, v94
    v_add_f32 v91, v91, v95
    v_add_f32 v91, v91, v94
    v_dot2_f32_bf16 v90, v46, v62, v90
    v_lshlrev_b32 v94, 16, v46
    v_and_b32 v95, 0xffff0000, v46
    v_mul_f32 v94, v94, v84
    v_mul_f32 v95, v95, v85
    v_cvt_pk_bf16_f32 v94, v94, v95
    v_lshlrev_b32 v95, 16, v94
    v_and_b32 v94, 0xffff0000, v94
    v_add_f32 v91, v91, v95
    v_add_f32 v91, v91, v94
    v_dot2_f32_bf16 v90, v47, v63, v90
    v_lshlrev_b32 v94, 16, v47
    v_and_b32 v95, 0xffff0000, v47
    v_mul_f32 v94, v94, v86
    v_mul_f32 v95, v95, v87
    v_cvt_pk_bf16_f32 v94, v94, v95
    v_lshlrev_b32 v95, 16, v94
    v_and_b32 v94, 0xffff0000, v94
    v_add_f32 v91, v91, v95
    v_add_f32 v91, v91, v94
    v_mov_b32 v92, 0
    v_mov_b32 v93, 0
    v_dot2_f32_bf16 v92, v48, v56, v92
    v_lshlrev_b32 v94, 16, v48
    v_and_b32 v95, 0xffff0000, v48
    v_mul_f32 v94, v94, v72
    v_mul_f32 v95, v95, v73
    v_cvt_pk_bf16_f32 v94, v94, v95
    v_lshlrev_b32 v95, 16, v94
    v_and_b32 v94, 0xffff0000, v94
    v_add_f32 v93, v93, v95
    v_add_f32 v93, v93, v94
    v_dot2_f32_bf16 v92, v49, v57, v92
    v_lshlrev_b32 v94, 16, v49
    v_and_b32 v95, 0xffff0000, v49
    v_mul_f32 v94, v94, v74
    v_mul_f32 v95, v95, v75
    v_cvt_pk_bf16_f32 v94, v94, v95
    v_lshlrev_b32 v95, 16, v94
    v_and_b32 v94, 0xffff0000, v94
    v_add_f32 v93, v93, v95
    v_add_f32 v93, v93, v94
    v_dot2_f32_bf16 v92, v50, v58, v92
    s_barrier
    s_bfe_u32 s91, s68, 0x40010
    s_lshl_b32 s92, s91, 7
    s_mul_i32 s93, s91, 393216
    s_add_u32 m0, s94, 40960
    s_nop 0
    buffer_load_dwordx4 v20, s[24:27], s92 offen offset:0 lds
    buffer_load_dwordx4 v21, s[24:27], s92 offen offset:1024 lds
    buffer_load_dwordx4 v22, s[24:27], s92 offen offset:2048 lds
    buffer_load_dwordx4 v23, s[24:27], s92 offen offset:3072 lds
    s_add_u32 m0, s95, 40960
    s_nop 0
    buffer_load_dwordx4 v24, s[28:31], s93 offen offset:0 lds
    buffer_load_dwordx4 v25, s[28:31], s93 offen offset:1024 lds
    buffer_load_dwordx4 v26, s[28:31], s93 offen offset:2048 lds
    s_add_u32 m0, s95, 44032
    s_nop 0
    buffer_load_dwordx4 v27, s[28:31], s93 offen offset:0 lds
    buffer_load_dwordx4 v28, s[28:31], s93 offen offset:1024 lds
    buffer_load_dwordx4 v29, s[28:31], s93 offen offset:2048 lds
    s_add_u32 s12, s71, 0
    buffer_load_dwordx4 v[128:131], v30, s[40:43], s12 offen nt
    s_add_u32 s12, s71, 7168
    buffer_load_dwordx4 v[132:135], v30, s[40:43], s12 offen nt
    s_add_u32 s12, s71, 14336
    buffer_load_dwordx4 v[136:139], v30, s[40:43], s12 offen nt
    s_add_u32 s12, s71, 21504
    buffer_load_dwordx4 v[140:143], v30, s[40:43], s12 offen nt
    s_add_u32 s12, s71, 28672
    buffer_load_dwordx4 v[144:147], v30, s[40:43], s12 offen nt
    s_add_u32 s12, s71, 35840
    buffer_load_dwordx4 v[148:151], v30, s[40:43], s12 offen nt
    s_add_u32 s12, s71, 43008
    buffer_load_dwordx4 v[152:155], v30, s[40:43], s12 offen nt
    s_add_u32 s12, s71, 50176
    buffer_load_dwordx4 v[156:159], v30, s[40:43], s12 offen nt
    v_lshlrev_b32 v94, 16, v50
    v_and_b32 v95, 0xffff0000, v50
    v_mul_f32 v94, v94, v76
    v_mul_f32 v95, v95, v77
    v_cvt_pk_bf16_f32 v94, v94, v95
    v_lshlrev_b32 v95, 16, v94
    v_and_b32 v94, 0xffff0000, v94
    v_add_f32 v93, v93, v95
    v_add_f32 v93, v93, v94
    v_dot2_f32_bf16 v92, v51, v59, v92
    v_lshlrev_b32 v94, 16, v51
    v_and_b32 v95, 0xffff0000, v51
    v_mul_f32 v94, v94, v78
    v_mul_f32 v95, v95, v79
    v_cvt_pk_bf16_f32 v94, v94, v95
    v_lshlrev_b32 v95, 16, v94
    v_and_b32 v94, 0xffff0000, v94
    v_add_f32 v93, v93, v95
    v_add_f32 v93, v93, v94
    v_dot2_f32_bf16 v92, v52, v60, v92
    v_lshlrev_b32 v94, 16, v52
    v_and_b32 v95, 0xffff0000, v52
    v_mul_f32 v94, v94, v80
    v_mul_f32 v95, v95, v81
    v_cvt_pk_bf16_f32 v94, v94, v95
    v_lshlrev_b32 v95, 16, v94
    v_and_b32 v94, 0xffff0000, v94
    v_add_f32 v93, v93, v95
    v_add_f32 v93, v93, v94
    v_dot2_f32_bf16 v92, v53, v61, v92
    v_lshlrev_b32 v94, 16, v53
    v_and_b32 v95, 0xffff0000, v53
    v_mul_f32 v94, v94, v82
    v_mul_f32 v95, v95, v83
    v_cvt_pk_bf16_f32 v94, v94, v95
    v_lshlrev_b32 v95, 16, v94
    v_and_b32 v94, 0xffff0000, v94
    v_add_f32 v93, v93, v95
    v_add_f32 v93, v93, v94
    v_dot2_f32_bf16 v92, v54, v62, v92
    v_lshlrev_b32 v94, 16, v54
    v_and_b32 v95, 0xffff0000, v54
    v_mul_f32 v94, v94, v84
    v_mul_f32 v95, v95, v85
    v_cvt_pk_bf16_f32 v94, v94, v95
    v_lshlrev_b32 v95, 16, v94
    v_and_b32 v94, 0xffff0000, v94
    v_add_f32 v93, v93, v95
    v_add_f32 v93, v93, v94
    v_dot2_f32_bf16 v92, v55, v63, v92
    v_lshlrev_b32 v94, 16, v55
    v_and_b32 v95, 0xffff0000, v55
    v_mul_f32 v94, v94, v86
    v_mul_f32 v95, v95, v87
    v_cvt_pk_bf16_f32 v94, v94, v95
    v_lshlrev_b32 v95, 16, v94
    v_and_b32 v94, 0xffff0000, v94
    v_add_f32 v93, v93, v95
    v_add_f32 v93, v93, v94
    v_add_f32_dpp v90, v90, v90 row_shr:1 row_mask:0xf bank_mask:0xf
    v_add_f32_dpp v91, v91, v91 row_shr:1 row_mask:0xf bank_mask:0xf
    v_add_f32_dpp v92, v92, v92 row_shr:1 row_mask:0xf bank_mask:0xf
    v_add_f32_dpp v93, v93, v93 row_shr:1 row_mask:0xf bank_mask:0xf
    v_add_f32_dpp v90, v90, v90 row_shr:2 row_mask:0xf bank_mask:0xf
    v_add_f32_dpp v91, v91, v91 row_shr:2 row_mask:0xf bank_mask:0xf
    v_add_f32_dpp v92, v92, v92 row_shr:2 row_mask:0xf bank_mask:0xf
    v_add_f32_dpp v93, v93, v93 row_shr:2 row_mask:0xf bank_mask:0xf
    v_add_f32_dpp v90, v90, v90 row_shr:4 row_mask:0xf bank_mask:0xf
    v_add_f32_dpp v91, v91, v91 row_shr:4 row_mask:0xf bank_mask:0xf
    v_add_f32_dpp v92, v92, v92 row_shr:4 row_mask:0xf bank_mask:0xf
    v_add_f32_dpp v93, v93, v93 row_shr:4 row_mask:0xf bank_mask:0xf
    v_add_f32_dpp v90, v90, v90 row_shr:8 row_mask:0xf bank_mask:0xf
    v_add_f32_dpp v91, v91, v91 row_shr:8 row_mask:0xf bank_mask:0xf
    v_add_f32_dpp v92, v92, v92 row_shr:8 row_mask:0xf bank_mask:0xf
    v_add_f32_dpp v93, v93, v93 row_shr:8 row_mask:0xf bank_mask:0xf
    v_add_f32_dpp v90, v90, v90 row_bcast:15 row_mask:0xa bank_mask:0xf
    v_add_f32_dpp v91, v91, v91 row_bcast:15 row_mask:0xa bank_mask:0xf
    v_add_f32_dpp v92, v92, v92 row_bcast:15 row_mask:0xa bank_mask:0xf
    v_add_f32_dpp v93, v93, v93 row_bcast:15 row_mask:0xa bank_mask:0xf
    v_add_f32_dpp v90, v90, v90 row_bcast:31 row_mask:0xc bank_mask:0xf
    v_add_f32_dpp v91, v91, v91 row_bcast:31 row_mask:0xc bank_mask:0xf
    v_add_f32_dpp v92, v92, v92 row_bcast:31 row_mask:0xc bank_mask:0xf
    v_add_f32_dpp v93, v93, v93 row_bcast:31 row_mask:0xc bank_mask:0xf
    v_cvt_pk_bf16_f32 v94, v90, v91
    v_and_b32 v95, 0xffff, v94
    v_and_b32 v96, 0x8000, v94
    v_cmp_ne_u32 vcc, 0, v96
    v_mov_b32 v97, 0x8000
    v_mov_b32 v98, 0xffff
    v_cndmask_b32 v96, v97, v98, vcc
    v_xor_b32 v95, v95, v96
    s_sub_u32 s12, 2047, s22
    v_lshlrev_b32 v95, 11, v95
    v_or_b32 v100, s12, v95
    v_and_b32 v94, 0xffff0000, v94
    v_mul_f32 v94, 0xbfb8aa3b, v94
    v_exp_f32 v94, v94
    s_nop 0
    v_add_f32 v94, 1.0, v94
    v_rcp_f32 v94, v94
    s_nop 0
    v_cvt_pk_bf16_f32 v94, v94, v94
    v_lshlrev_b32 v102, 16, v94
    v_cvt_pk_bf16_f32 v94, v92, v93
    v_and_b32 v95, 0xffff, v94
    v_and_b32 v96, 0x8000, v94
    v_cmp_ne_u32 vcc, 0, v96
    v_mov_b32 v97, 0x8000
    v_mov_b32 v98, 0xffff
    v_cndmask_b32 v96, v97, v98, vcc
    v_xor_b32 v95, v95, v96
    s_sub_u32 s12, 2046, s22
    v_lshlrev_b32 v95, 11, v95
    v_or_b32 v101, s12, v95
    v_and_b32 v94, 0xffff0000, v94
    v_mul_f32 v94, 0xbfb8aa3b, v94
    v_exp_f32 v94, v94
    s_nop 0
    v_add_f32 v94, 1.0, v94
    v_rcp_f32 v94, v94
    s_nop 0
    v_cvt_pk_bf16_f32 v94, v94, v94
    v_lshlrev_b32 v103, 16, v94
    v_max_u32 v100, v100, v101
    s_lshl_b32 s12, s22, 2
    s_add_u32 s12, s12, 4096
    s_lshl_b32 s13, s21, 2
    s_add_u32 s13, s13, 162880
    v_mov_b32 v14, s13
    s_mov_b32 exec_lo, 0
    s_mov_b32 exec_hi, 0x80000000
    buffer_store_dwordx2 v[102:103], v13, s[32:35], s12 offen sc1
    ds_write_b32 v14, v100
    s_mov_b64 exec, -1
    s_waitcnt lgkmcnt(0)
    buffer_load_dword v15, v13, s[72:75], 0 offen offset:4 sc1
    s_waitcnt vmcnt(20)
    s_barrier
    s_bfe_u32 s91, s68, 0x40014
    s_lshl_b32 s92, s91, 7
    s_mul_i32 s93, s91, 393216
    s_add_u32 m0, s94, 81920
    s_nop 0
    buffer_load_dwordx4 v20, s[24:27], s92 offen offset:0 lds
    buffer_load_dwordx4 v21, s[24:27], s92 offen offset:1024 lds
    buffer_load_dwordx4 v22, s[24:27], s92 offen offset:2048 lds
    buffer_load_dwordx4 v23, s[24:27], s92 offen offset:3072 lds
    s_add_u32 m0, s95, 81920
    s_nop 0
    buffer_load_dwordx4 v24, s[28:31], s93 offen offset:0 lds
    s_waitcnt vmcnt(15)
    s_barrier
    s_add_u32 m0, s95, 81920
    s_nop 0
    buffer_load_dwordx4 v25, s[28:31], s93 offen offset:1024 lds
    buffer_load_dwordx4 v26, s[28:31], s93 offen offset:2048 lds
    s_add_u32 m0, s95, 84992
    s_nop 0
    buffer_load_dwordx4 v27, s[28:31], s93 offen offset:0 lds
    buffer_load_dwordx4 v28, s[28:31], s93 offen offset:1024 lds
    buffer_load_dwordx4 v29, s[28:31], s93 offen offset:2048 lds
    s_bfe_u32 s91, s68, 0x40018
    s_lshl_b32 s92, s91, 7
    s_mul_i32 s93, s91, 393216
    s_add_u32 m0, s94, 0
    s_nop 0
    buffer_load_dwordx4 v20, s[24:27], s92 offen offset:0 lds
    buffer_load_dwordx4 v21, s[24:27], s92 offen offset:1024 lds
    buffer_load_dwordx4 v22, s[24:27], s92 offen offset:2048 lds
    buffer_load_dwordx4 v23, s[24:27], s92 offen offset:3072 lds
    s_add_u32 m0, s95, 0
    s_nop 0
    buffer_load_dwordx4 v24, s[28:31], s93 offen offset:0 lds
    buffer_load_dwordx4 v25, s[28:31], s93 offen offset:1024 lds
    buffer_load_dwordx4 v26, s[28:31], s93 offen offset:2048 lds
    s_waitcnt vmcnt(17)
    s_mov_b32 s13, 0
L_tagchk_2:
    v_readfirstlane_b32 s23, v15
    s_nop 1
    s_cmp_lg_u32 s23, 0
    s_cbranch_scc1 L_tagok_2
    s_add_u32 s13, s13, 1
    s_cmp_ge_u32 s13, 16384
    s_cbranch_scc1 L_tagok_2
    buffer_load_dword v15, v13, s[72:75], 0 offen offset:4 sc1
    s_waitcnt vmcnt(0)
    s_branch L_tagchk_2
L_tagok_2:
    s_and_b32 s76, s23, 0xff
    s_bfe_u32 s77, s23, 0x80008
    s_bfe_u32 s78, s23, 0x80010
    s_lshr_b32 s79, s23, 24
    v_and_b32 v35, 3, v2
    v_lshlrev_b32 v35, 3, v35
    v_bfe_u32 v35, s23, v35, 8
    s_cmp_lg_u32 s21, 0
    s_cbranch_scc1 L_nopub_2
    v_mov_b32 v14, 162880
    ds_read_b128 v[104:107], v14
    s_lshl_b32 s12, s2, 3
    s_add_u32 s12, s12, 0
    s_waitcnt lgkmcnt(0)
    v_max3_u32 v104, v104, v105, v106
    v_max_u32 v104, v104, v107
    v_mov_b32 v105, s23
    s_mov_b64 exec, 1
    buffer_store_dwordx2 v[104:105], v13, s[32:35], s12 offen sc1
    s_mov_b64 exec, -1
L_nopub_2:
    s_waitcnt vmcnt(7)
    s_barrier
    s_add_u32 m0, s95, 3072
    s_nop 0
    buffer_load_dwordx4 v27, s[28:31], s93 offen offset:0 lds
    buffer_load_dwordx4 v28, s[28:31], s93 offen offset:1024 lds
    buffer_load_dwordx4 v29, s[28:31], s93 offen offset:2048 lds
    s_bfe_u32 s91, s68, 0x4001c
    s_lshl_b32 s92, s91, 7
    s_mul_i32 s93, s91, 393216
    s_add_u32 m0, s94, 40960
    s_nop 0
    buffer_load_dwordx4 v20, s[24:27], s92 offen offset:0 lds
    buffer_load_dwordx4 v21, s[24:27], s92 offen offset:1024 lds
    buffer_load_dwordx4 v22, s[24:27], s92 offen offset:2048 lds
    buffer_load_dwordx4 v23, s[24:27], s92 offen offset:3072 lds
    s_add_u32 m0, s95, 40960
    s_nop 0
    buffer_load_dwordx4 v24, s[28:31], s93 offen offset:0 lds
    buffer_load_dwordx4 v25, s[28:31], s93 offen offset:1024 lds
    buffer_load_dwordx4 v26, s[28:31], s93 offen offset:2048 lds
    s_add_u32 m0, s95, 44032
    s_nop 0
    buffer_load_dwordx4 v27, s[28:31], s93 offen offset:0 lds
    buffer_load_dwordx4 v28, s[28:31], s93 offen offset:1024 lds
    s_waitcnt vmcnt(9)
    s_barrier
    s_add_u32 m0, s95, 44032
    s_nop 0
    buffer_load_dwordx4 v29, s[28:31], s93 offen offset:2048 lds
    s_bfe_u32 s91, s69, 0x40000
    s_lshl_b32 s92, s91, 7
    s_mul_i32 s93, s91, 393216
    s_add_u32 m0, s94, 81920
    s_nop 0
    buffer_load_dwordx4 v20, s[24:27], s92 offen offset:0 lds
    buffer_load_dwordx4 v21, s[24:27], s92 offen offset:1024 lds
    buffer_load_dwordx4 v22, s[24:27], s92 offen offset:2048 lds
    buffer_load_dwordx4 v23, s[24:27], s92 offen offset:3072 lds
    s_add_u32 m0, s95, 81920
    s_nop 0
    buffer_load_dwordx4 v24, s[28:31], s93 offen offset:0 lds
    buffer_load_dwordx4 v25, s[28:31], s93 offen offset:1024 lds
    buffer_load_dwordx4 v26, s[28:31], s93 offen offset:2048 lds
    s_add_u32 m0, s95, 84992
    s_nop 0
    buffer_load_dwordx4 v27, s[28:31], s93 offen offset:0 lds
    buffer_load_dwordx4 v28, s[28:31], s93 offen offset:1024 lds
    buffer_load_dwordx4 v29, s[28:31], s93 offen offset:2048 lds
    s_waitcnt vmcnt(10)
    s_barrier
    s_bfe_u32 s91, s69, 0x40004
    s_lshl_b32 s92, s91, 7
    s_mul_i32 s93, s91, 393216
    s_add_u32 m0, s94, 0
    s_nop 0
    buffer_load_dwordx4 v20, s[24:27], s92 offen offset:0 lds
    buffer_load_dwordx4 v21, s[24:27], s92 offen offset:1024 lds
    buffer_load_dwordx4 v22, s[24:27], s92 offen offset:2048 lds
    buffer_load_dwordx4 v23, s[24:27], s92 offen offset:3072 lds
    s_add_u32 m0, s95, 0
    s_nop 0
    buffer_load_dwordx4 v24, s[28:31], s93 offen offset:0 lds
    buffer_load_dwordx4 v25, s[28:31], s93 offen offset:1024 lds
    buffer_load_dwordx4 v26, s[28:31], s93 offen offset:2048 lds
    s_add_u32 m0, s95, 3072
    s_nop 0
    buffer_load_dwordx4 v27, s[28:31], s93 offen offset:0 lds
    buffer_load_dwordx4 v28, s[28:31], s93 offen offset:1024 lds
    buffer_load_dwordx4 v29, s[28:31], s93 offen offset:2048 lds
    s_add_u32 s12, s71, 0
    buffer_load_dwordx4 v[160:163], v30, s[44:47], s12 offen nt
    s_add_u32 s12, s71, 7168
    buffer_load_dwordx4 v[164:167], v30, s[44:47], s12 offen nt
    s_add_u32 s12, s71, 14336
    buffer_load_dwordx4 v[168:171], v30, s[44:47], s12 offen nt
    s_add_u32 s12, s71, 21504
    buffer_load_dwordx4 v[172:175], v30, s[44:47], s12 offen nt
    s_add_u32 s12, s71, 28672
    buffer_load_dwordx4 v[176:179], v30, s[44:47], s12 offen nt
    s_add_u32 s12, s71, 35840
    buffer_load_dwordx4 v[180:183], v30, s[44:47], s12 offen nt
    s_add_u32 s12, s71, 43008
    buffer_load_dwordx4 v[184:187], v30, s[44:47], s12 offen nt
    s_add_u32 s12, s71, 50176
    buffer_load_dwordx4 v[188:191], v30, s[44:47], s12 offen nt
    s_waitcnt vmcnt(18)
    s_barrier
    s_bfe_u32 s91, s69, 0x40008
    s_lshl_b32 s92, s91, 7
    s_mul_i32 s93, s91, 393216
    s_add_u32 m0, s94, 40960
    s_nop 0
    buffer_load_dwordx4 v20, s[24:27], s92 offen offset:0 lds
    buffer_load_dwordx4 v21, s[24:27], s92 offen offset:1024 lds
    buffer_load_dwordx4 v22, s[24:27], s92 offen offset:2048 lds
    buffer_load_dwordx4 v23, s[24:27], s92 offen offset:3072 lds
    s_add_u32 m0, s95, 40960
    s_nop 0
    buffer_load_dwordx4 v24, s[28:31], s93 offen offset:0 lds
    s_waitcnt vmcnt(13)
    s_barrier
    s_add_u32 m0, s95, 40960
    s_nop 0
    buffer_load_dwordx4 v25, s[28:31], s93 offen offset:1024 lds
    buffer_load_dwordx4 v26, s[28:31], s93 offen offset:2048 lds
    s_add_u32 m0, s95, 44032
    s_nop 0
    buffer_load_dwordx4 v27, s[28:31], s93 offen offset:0 lds
    buffer_load_dwordx4 v28, s[28:31], s93 offen offset:1024 lds
    buffer_load_dwordx4 v29, s[28:31], s93 offen offset:2048 lds
    s_bfe_u32 s91, s69, 0x4000c
    s_lshl_b32 s92, s91, 7
    s_mul_i32 s93, s91, 393216
    s_add_u32 m0, s94, 81920
    s_nop 0
    buffer_load_dwordx4 v20, s[24:27], s92 offen offset:0 lds
    buffer_load_dwordx4 v21, s[24:27], s92 offen offset:1024 lds
    buffer_load_dwordx4 v22, s[24:27], s92 offen offset:2048 lds
    buffer_load_dwordx4 v23, s[24:27], s92 offen offset:3072 lds
    s_add_u32 m0, s95, 81920
    s_nop 0
    buffer_load_dwordx4 v24, s[28:31], s93 offen offset:0 lds
    buffer_load_dwordx4 v25, s[28:31], s93 offen offset:1024 lds
    buffer_load_dwordx4 v26, s[28:31], s93 offen offset:2048 lds
    s_mov_b32 s12, 0
    buffer_load_dwordx4 v[104:107], v5, s[32:35], s12 offen offset:0 sc1
    buffer_load_dwordx4 v[108:111], v5, s[32:35], s12 offen offset:1024 sc1
    s_waitcnt vmcnt(9)
    s_barrier
    s_add_u32 m0, s95, 84992
    s_nop 0
    buffer_load_dwordx4 v27, s[28:31], s93 offen offset:0 lds
    buffer_load_dwordx4 v28, s[28:31], s93 offen offset:1024 lds
    buffer_load_dwordx4 v29, s[28:31], s93 offen offset:2048 lds
    s_bfe_u32 s91, s69, 0x40010
    s_lshl_b32 s92, s91, 7
    s_mul_i32 s93, s91, 393216
    s_add_u32 m0, s94, 0
    s_nop 0
    buffer_load_dwordx4 v20, s[24:27], s92 offen offset:0 lds
    buffer_load_dwordx4 v21, s[24:27], s92 offen offset:1024 lds
    buffer_load_dwordx4 v22, s[24:27], s92 offen offset:2048 lds
    buffer_load_dwordx4 v23, s[24:27], s92 offen offset:3072 lds
    s_add_u32 m0, s95, 0
    s_nop 0
    buffer_load_dwordx4 v24, s[28:31], s93 offen offset:0 lds
    buffer_load_dwordx4 v25, s[28:31], s93 offen offset:1024 lds
    buffer_load_dwordx4 v26, s[28:31], s93 offen offset:2048 lds
    s_add_u32 m0, s95, 3072
    s_nop 0
    buffer_load_dwordx4 v27, s[28:31], s93 offen offset:0 lds
    buffer_load_dwordx4 v28, s[28:31], s93 offen offset:1024 lds
    s_waitcnt vmcnt(9)
    s_barrier
    s_add_u32 m0, s95, 3072
    s_nop 0
    buffer_load_dwordx4 v29, s[28:31], s93 offen offset:2048 lds
    s_bfe_u32 s91, s69, 0x40014
    s_lshl_b32 s92, s91, 7
    s_mul_i32 s93, s91, 393216
    s_add_u32 m0, s94, 40960
    s_nop 0
    buffer_load_dwordx4 v20, s[24:27], s92 offen offset:0 lds
    buffer_load_dwordx4 v21, s[24:27], s92 offen offset:1024 lds
    buffer_load_dwordx4 v22, s[24:27], s92 offen offset:2048 lds
    buffer_load_dwordx4 v23, s[24:27], s92 offen offset:3072 lds
    s_add_u32 m0, s95, 40960
    s_nop 0
    buffer_load_dwordx4 v24, s[28:31], s93 offen offset:0 lds
    buffer_load_dwordx4 v25, s[28:31], s93 offen offset:1024 lds
    buffer_load_dwordx4 v26, s[28:31], s93 offen offset:2048 lds
    s_add_u32 m0, s95, 44032
    s_nop 0
    buffer_load_dwordx4 v27, s[28:31], s93 offen offset:0 lds
    buffer_load_dwordx4 v28, s[28:31], s93 offen offset:1024 lds
    buffer_load_dwordx4 v29, s[28:31], s93 offen offset:2048 lds
    s_mov_b32 s13, 0
L_keychk_2:
    v_xor_b32 v105, s23, v105
    v_xor_b32 v107, s23, v107
    v_xor_b32 v109, s23, v109
    v_xor_b32 v111, s23, v111
    v_or3_b32 v105, v105, v107, v109
    v_or_b32 v105, v105, v111
    v_cmp_ne_u32 vcc, 0, v105
    s_cbranch_vccz L_keyok_2
    s_add_u32 s13, s13, 1
    s_cmp_ge_u32 s13, 16384
    s_cbranch_scc1 L_keyok_2
    s_mov_b32 s12, 0
    buffer_load_dwordx4 v[104:107], v5, s[32:35], s12 offen offset:0 sc1
    buffer_load_dwordx4 v[108:111], v5, s[32:35], s12 offen offset:1024 sc1
    s_waitcnt vmcnt(0)
    s_branch L_keychk_2
L_keyok_2:
    v_max3_u32 v104, v104, v106, v108
    v_max_u32 v104, v104, v110
    s_nop 1
    v_max_u32_dpp v104, v104, v104 row_shr:1 row_mask:0xf bank_mask:0xf
    s_nop 1
    v_max_u32_dpp v104, v104, v104 row_shr:2 row_mask:0xf bank_mask:0xf
    s_nop 1
    v_max_u32_dpp v104, v104, v104 row_shr:4 row_mask:0xf bank_mask:0xf
    s_nop 1
    v_max_u32_dpp v104, v104, v104 row_shr:8 row_mask:0xf bank_mask:0xf
    s_nop 1
    v_max_u32_dpp v104, v104, v104 row_bcast:15 row_mask:0xa bank_mask:0xf
    s_nop 1
    v_max_u32_dpp v104, v104, v104 row_bcast:31 row_mask:0xc bank_mask:0xf
    s_nop 0
    v_readlane_b32 s14, v104, 63
    s_nop 1
    s_and_b32 s15, s14, 2047
    s_sub_u32 s15, 2047, s15
    s_lshl_b32 s12, s15, 11
    s_lshl_b32 s13, s70, 1
    s_add_u32 s12, s12, s13
    buffer_load_dwordx4 v[36:39], v34, s[24:27], s12 offen
    s_lshr_b32 s12, s14, 11
    s_and_b32 s13, s12, 0x8000
    s_cmp_lg_u32 s13, 0
    s_mov_b32 s13, 0xffff
    s_cselect_b32 s13, 0x8000, s13
    s_xor_b32 s12, s12, s13
    s_lshl_b32 s12, s12, 16
    v_mov_b32 v105, s12
    v_mul_f32 v105, 0xbfb8aa3b, v105
    v_exp_f32 v105, v105
    s_nop 0
    v_add_f32 v105, 1.0, v105
    v_rcp_f32 v105, v105
    s_nop 0
    v_cvt_pk_bf16_f32 v105, v105, v105
    v_lshlrev_b32 v105, 16, v105
    s_nop 0
    v_readfirstlane_b32 s14, v105
    s_add_u32 s12, s15, 1
    v_mov_b32 v104, s12
    v_mov_b32 v106, s23
    v_mov_b32 v14, 162864
    s_mov_b64 exec, 1
    ds_write_b96 v14, v[104:106]
    s_mov_b64 exec, -1
    s_waitcnt lgkmcnt(0)
    s_waitcnt vmcnt(11)
    s_barrier
    s_bfe_u32 s91, s69, 0x40018
    s_lshl_b32 s92, s91, 7
    s_mul_i32 s93, s91, 393216
    s_add_u32 m0, s94, 81920
    s_nop 0
    buffer_load_dwordx4 v20, s[24:27], s92 offen offset:0 lds
    buffer_load_dwordx4 v21, s[24:27], s92 offen offset:1024 lds
    buffer_load_dwordx4 v22, s[24:27], s92 offen offset:2048 lds
    buffer_load_dwordx4 v23, s[24:27], s92 offen offset:3072 lds
    s_add_u32 m0, s95, 81920
    s_nop 0
    buffer_load_dwordx4 v24, s[28:31], s93 offen offset:0 lds
    buffer_load_dwordx4 v25, s[28:31], s93 offen offset:1024 lds
    buffer_load_dwordx4 v26, s[28:31], s93 offen offset:2048 lds
    s_add_u32 m0, s95, 84992
    s_nop 0
    buffer_load_dwordx4 v27, s[28:31], s93 offen offset:0 lds
    buffer_load_dwordx4 v28, s[28:31], s93 offen offset:1024 lds
    buffer_load_dwordx4 v29, s[28:31], s93 offen offset:2048 lds
    s_add_u32 s12, s97, 0
    buffer_load_dwordx4 v[192:195], v31, s[64:67], s12 offen nt
    s_add_u32 s12, s97, 16384
    buffer_load_dwordx4 v[196:199], v31, s[64:67], s12 offen nt
    s_add_u32 s12, s97, 32768
    buffer_load_dwordx4 v[200:203], v31, s[64:67], s12 offen nt
    s_add_u32 s12, s97, 49152
    buffer_load_dwordx4 v[204:207], v31, s[64:67], s12 offen nt
    s_add_u32 s12, s97, 65536
    buffer_load_dwordx4 v[208:211], v31, s[64:67], s12 offen nt
    s_add_u32 s12, s97, 81920
    buffer_load_dwordx4 v[212:215], v31, s[64:67], s12 offen nt
    s_add_u32 s12, s97, 98304
    buffer_load_dwordx4 v[216:219], v31, s[64:67], s12 offen nt
    s_waitcnt vmcnt(17)
    v_and_b32 v40, 0xffff, v36
    v_lshlrev_b32 v41, 16, v36
    v_lshrrev_b32 v42, 16, v36
    v_and_b32 v43, 0xffff0000, v36
    v_and_b32 v44, 0xffff, v37
    v_lshlrev_b32 v45, 16, v37
    v_lshrrev_b32 v46, 16, v37
    v_and_b32 v47, 0xffff0000, v37
    v_and_b32 v48, 0xffff, v38
    v_lshlrev_b32 v49, 16, v38
    v_lshrrev_b32 v50, 16, v38
    v_and_b32 v51, 0xffff0000, v38
    v_and_b32 v52, 0xffff, v39
    v_lshlrev_b32 v53, 16, v39
    v_lshrrev_b32 v54, 16, v39
    v_and_b32 v55, 0xffff0000, v39
    v_dot2_f32_bf16 v220, v128, v40, 0
    v_dot2_f32_bf16 v221, v128, v41, 0
    v_dot2_f32_bf16 v222, v129, v40, 0
    v_dot2_f32_bf16 v223, v129, v41, 0
    v_dot2_f32_bf16 v224, v130, v40, 0
    v_dot2_f32_bf16 v225, v130, v41, 0
    v_dot2_f32_bf16 v226, v131, v40, 0
    v_dot2_f32_bf16 v227, v131, v41, 0
    v_dot2_f32_bf16 v228, v160, v40, 0
    v_dot2_f32_bf16 v229, v160, v41, 0
    v_dot2_f32_bf16 v230, v161, v40, 0
    v_dot2_f32_bf16 v231, v161, v41, 0
    v_dot2_f32_bf16 v232, v162, v40, 0
    v_dot2_f32_bf16 v233, v162, v41, 0
    v_dot2_f32_bf16 v234, v163, v40, 0
    v_dot2_f32_bf16 v235, v163, v41, 0
    v_dot2_f32_bf16 v220, v132, v42, v220
    v_dot2_f32_bf16 v221, v132, v43, v221
    v_dot2_f32_bf16 v222, v133, v42, v222
    v_dot2_f32_bf16 v223, v133, v43, v223
    v_dot2_f32_bf16 v224, v134, v42, v224
    v_dot2_f32_bf16 v225, v134, v43, v225
    v_dot2_f32_bf16 v226, v135, v42, v226
    v_dot2_f32_bf16 v227, v135, v43, v227
    v_dot2_f32_bf16 v228, v164, v42, v228
    v_dot2_f32_bf16 v229, v164, v43, v229
    v_dot2_f32_bf16 v230, v165, v42, v230
    v_dot2_f32_bf16 v231, v165, v43, v231
    v_dot2_f32_bf16 v232, v166, v42, v232
    v_dot2_f32_bf16 v233, v166, v43, v233
    v_dot2_f32_bf16 v234, v167, v42, v234
    v_dot2_f32_bf16 v235, v167, v43, v235
    v_dot2_f32_bf16 v220, v136, v44, v220
    v_dot2_f32_bf16 v221, v136, v45, v221
    v_dot2_f32_bf16 v222, v137, v44, v222
    v_dot2_f32_bf16 v223, v137, v45, v223
    v_dot2_f32_bf16 v224, v138, v44, v224
    v_dot2_f32_bf16 v225, v138, v45, v225
    v_dot2_f32_bf16 v226, v139, v44, v226
    v_dot2_f32_bf16 v227, v139, v45, v227
    v_dot2_f32_bf16 v228, v168, v44, v228
    v_dot2_f32_bf16 v229, v168, v45, v229
    s_barrier
    s_bfe_u32 s91, s69, 0x4001c
    s_lshl_b32 s92, s91, 7
    s_mul_i32 s93, s91, 393216
    s_add_u32 m0, s94, 0
    s_nop 0
    buffer_load_dwordx4 v20, s[24:27], s92 offen offset:0 lds
    buffer_load_dwordx4 v21, s[24:27], s92 offen offset:1024 lds
    buffer_load_dwordx4 v22, s[24:27], s92 offen offset:2048 lds
    buffer_load_dwordx4 v23, s[24:27], s92 offen offset:3072 lds
    s_add_u32 m0, s95, 0
    s_nop 0
    buffer_load_dwordx4 v24, s[28:31], s93 offen offset:0 lds
    v_dot2_f32_bf16 v230, v169, v44, v230
    v_dot2_f32_bf16 v231, v169, v45, v231
    v_dot2_f32_bf16 v232, v170, v44, v232
    v_dot2_f32_bf16 v233, v170, v45, v233
    v_dot2_f32_bf16 v234, v171, v44, v234
    v_dot2_f32_bf16 v235, v171, v45, v235
    v_dot2_f32_bf16 v220, v140, v46, v220
    v_dot2_f32_bf16 v221, v140, v47, v221
    v_dot2_f32_bf16 v222, v141, v46, v222
    v_dot2_f32_bf16 v223, v141, v47, v223
    v_dot2_f32_bf16 v224, v142, v46, v224
    v_dot2_f32_bf16 v225, v142, v47, v225
    v_dot2_f32_bf16 v226, v143, v46, v226
    v_dot2_f32_bf16 v227, v143, v47, v227
    v_dot2_f32_bf16 v228, v172, v46, v228
    v_dot2_f32_bf16 v229, v172, v47, v229
    v_dot2_f32_bf16 v230, v173, v46, v230
    v_dot2_f32_bf16 v231, v173, v47, v231
    v_dot2_f32_bf16 v232, v174, v46, v232
    v_dot2_f32_bf16 v233, v174, v47, v233
    v_dot2_f32_bf16 v234, v175, v46, v234
    v_dot2_f32_bf16 v235, v175, v47, v235
    v_dot2_f32_bf16 v220, v144, v48, v220
    v_dot2_f32_bf16 v221, v144, v49, v221
    v_dot2_f32_bf16 v222, v145, v48, v222
    v_dot2_f32_bf16 v223, v145, v49, v223
    v_dot2_f32_bf16 v224, v146, v48, v224
    v_dot2_f32_bf16 v225, v146, v49, v225
    v_dot2_f32_bf16 v226, v147, v48, v226
    v_dot2_f32_bf16 v227, v147, v49, v227
    v_dot2_f32_bf16 v228, v176, v48, v228
    v_dot2_f32_bf16 v229, v176, v49, v229
    v_dot2_f32_bf16 v230, v177, v48, v230
    v_dot2_f32_bf16 v231, v177, v49, v231
    v_dot2_f32_bf16 v232, v178, v48, v232
    v_dot2_f32_bf16 v233, v178, v49, v233
    v_dot2_f32_bf16 v234, v179, v48, v234
    v_dot2_f32_bf16 v235, v179, v49, v235
    v_dot2_f32_bf16 v220, v148, v50, v220
    v_dot2_f32_bf16 v221, v148, v51, v221
    v_dot2_f32_bf16 v222, v149, v50, v222
    v_dot2_f32_bf16 v223, v149, v51, v223
    v_dot2_f32_bf16 v224, v150, v50, v224
    v_dot2_f32_bf16 v225, v150, v51, v225
    v_dot2_f32_bf16 v226, v151, v50, v226
    v_dot2_f32_bf16 v227, v151, v51, v227
    v_dot2_f32_bf16 v228, v180, v50, v228
    v_dot2_f32_bf16 v229, v180, v51, v229
    v_dot2_f32_bf16 v230, v181, v50, v230
    v_dot2_f32_bf16 v231, v181, v51, v231
    v_dot2_f32_bf16 v232, v182, v50, v232
    v_dot2_f32_bf16 v233, v182, v51, v233
    v_dot2_f32_bf16 v234, v183, v50, v234
    v_dot2_f32_bf16 v235, v183, v51, v235
    v_dot2_f32_bf16 v220, v152, v52, v220
    v_dot2_f32_bf16 v221, v152, v53, v221
    v_dot2_f32_bf16 v222, v153, v52, v222
    v_dot2_f32_bf16 v223, v153, v53, v223
    s_waitcnt vmcnt(12)
    s_barrier
    s_add_u32 m0, s95, 0
    s_nop 0
    buffer_load_dwordx4 v25, s[28:31], s93 offen offset:1024 lds
    buffer_load_dwordx4 v26, s[28:31], s93 offen offset:2048 lds
    s_add_u32 m0, s95, 3072
    s_nop 0
    buffer_load_dwordx4 v27, s[28:31], s93 offen offset:0 lds
    buffer_load_dwordx4 v28, s[28:31], s93 offen offset:1024 lds
    buffer_load_dwordx4 v29, s[28:31], s93 offen offset:2048 lds
    s_mul_i32 s12, s21, 8
    s_add_u32 s12, s12, 96
    s_lshl_b32 s13, s12, 10
    s_lshl_b32 s12, s12, 14
    s_add_u32 m0, s13, 24576
    s_add_u32 s90, s12, 0
    buffer_load_dwordx4 v33, s[36:39], s90 offen lds
    s_add_u32 m0, s13, 25600
    s_add_u32 s90, s12, 16384
    buffer_load_dwordx4 v33, s[36:39], s90 offen lds
    s_add_u32 m0, s13, 26624
    s_add_u32 s90, s12, 32768
    buffer_load_dwordx4 v33, s[36:39], s90 offen lds
    s_add_u32 m0, s13, 27648
    s_add_u32 s90, s12, 49152
    buffer_load_dwordx4 v33, s[36:39], s90 offen lds
    s_add_u32 m0, s13, 28672
    s_add_u32 s90, s12, 65536
    buffer_load_dwordx4 v33, s[36:39], s90 offen lds
    s_add_u32 m0, s13, 29696
    s_add_u32 s90, s12, 81920
    buffer_load_dwordx4 v33, s[36:39], s90 offen lds
    s_add_u32 m0, s13, 30720
    s_add_u32 s90, s12, 98304
    buffer_load_dwordx4 v33, s[36:39], s90 offen lds
    s_add_u32 m0, s13, 31744
    s_add_u32 s90, s12, 114688
    buffer_load_dwordx4 v33, s[36:39], s90 offen lds
    v_dot2_f32_bf16 v224, v154, v52, v224
    v_dot2_f32_bf16 v225, v154, v53, v225
    v_dot2_f32_bf16 v226, v155, v52, v226
    v_dot2_f32_bf16 v227, v155, v53, v227
    v_dot2_f32_bf16 v228, v184, v52, v228
    v_dot2_f32_bf16 v229, v184, v53, v229
    v_dot2_f32_bf16 v230, v185, v52, v230
    v_dot2_f32_bf16 v231, v185, v53, v231
    v_dot2_f32_bf16 v232, v186, v52, v232
    v_dot2_f32_bf16 v233, v186, v53, v233
    v_dot2_f32_bf16 v234, v187, v52, v234
    v_dot2_f32_bf16 v235, v187, v53, v235
    v_dot2_f32_bf16 v220, v156, v54, v220
    v_dot2_f32_bf16 v221, v156, v55, v221
    v_dot2_f32_bf16 v222, v157, v54, v222
    v_dot2_f32_bf16 v223, v157, v55, v223
    v_dot2_f32_bf16 v224, v158, v54, v224
    v_dot2_f32_bf16 v225, v158, v55, v225
    v_dot2_f32_bf16 v226, v159, v54, v226
    v_dot2_f32_bf16 v227, v159, v55, v227
    v_dot2_f32_bf16 v228, v188, v54, v228
    v_dot2_f32_bf16 v229, v188, v55, v229
    v_dot2_f32_bf16 v230, v189, v54, v230
    v_dot2_f32_bf16 v231, v189, v55, v231
    v_dot2_f32_bf16 v232, v190, v54, v232
    v_dot2_f32_bf16 v233, v190, v55, v233
    v_dot2_f32_bf16 v234, v191, v54, v234
    v_dot2_f32_bf16 v235, v191, v55, v235
    v_permlane32_swap_b32 v220, v228
    v_permlane32_swap_b32 v221, v229
    v_permlane32_swap_b32 v222, v230
    v_permlane32_swap_b32 v223, v231
    v_permlane32_swap_b32 v224, v232
    v_permlane32_swap_b32 v225, v233
    v_permlane32_swap_b32 v226, v234
    v_permlane32_swap_b32 v227, v235
    v_add_f32 v220, v220, v228
    v_add_f32 v221, v221, v229
    v_add_f32 v222, v222, v230
    v_add_f32 v223, v223, v231
    v_add_f32 v224, v224, v232
    v_add_f32 v225, v225, v233
    v_add_f32 v226, v226, v234
    v_add_f32 v227, v227, v235
    v_permlane16_swap_b32 v220, v224
    v_permlane16_swap_b32 v221, v225
    v_permlane16_swap_b32 v222, v226
    v_permlane16_swap_b32 v223, v227
    v_add_f32 v220, v220, v224
    v_add_f32 v221, v221, v225
    v_add_f32 v222, v222, v226
    v_add_f32 v223, v223, v227
    v_add_f32_dpp v220, v220, v220 row_ror:8 row_mask:0xf bank_mask:0xf
    v_add_f32_dpp v221, v221, v221 row_ror:8 row_mask:0xf bank_mask:0xf
    v_add_f32_dpp v222, v222, v222 row_ror:8 row_mask:0xf bank_mask:0xf
    v_add_f32_dpp v223, v223, v223 row_ror:8 row_mask:0xf bank_mask:0xf
    s_waitcnt vmcnt(8)
    s_barrier
    s_branch L_varend
L_var3:
    s_nop 0
    s_add_u32 m0, s95, 40960
    s_nop 0
    buffer_load_dwordx4 v26, s[28:31], s93 offen offset:2048 lds
    s_add_u32 m0, s95, 44032
    s_nop 0
    buffer_load_dwordx4 v27, s[28:31], s93 offen offset:0 lds
    buffer_load_dwordx4 v28, s[28:31], s93 offen offset:1024 lds
    buffer_load_dwordx4 v29, s[28:31], s93 offen offset:2048 lds
    s_bfe_u32 s91, s68, 0x40008
    s_lshl_b32 s92, s91, 7
    s_mul_i32 s93, s91, 393216
    s_add_u32 m0, s94, 81920
    s_nop 0
    buffer_load_dwordx4 v20, s[24:27], s92 offen offset:0 lds
    buffer_load_dwordx4 v21, s[24:27], s92 offen offset:1024 lds
    buffer_load_dwordx4 v22, s[24:27], s92 offen offset:2048 lds
    buffer_load_dwordx4 v23, s[24:27], s92 offen offset:3072 lds
    s_add_u32 m0, s95, 81920
    s_nop 0
    buffer_load_dwordx4 v24, s[28:31], s93 offen offset:0 lds
    buffer_load_dwordx4 v25, s[28:31], s93 offen offset:1024 lds
    buffer_load_dwordx4 v26, s[28:31], s93 offen offset:2048 lds
    s_add_u32 m0, s95, 84992
    s_nop 0
    buffer_load_dwordx4 v27, s[28:31], s93 offen offset:0 lds
    buffer_load_dwordx4 v28, s[28:31], s93 offen offset:1024 lds
    buffer_load_dwordx4 v29, s[28:31], s93 offen offset:2048 lds
    s_lshl_b32 s12, s19, 2
    s_add_u32 s12, s12, s21
    s_lshl_b32 s12, s12, 10
    s_lshl_b32 s13, s21, 10
    s_add_u32 m0, s13, 155648
    s_nop 0
    buffer_load_dwordx4 v5, s[76:79], s12 offen lds
    s_lshl_b32 s12, s22, 11
    buffer_load_dwordx4 v[40:43], v5, s[24:27], s12 offen offset:0
    buffer_load_dwordx4 v[44:47], v5, s[24:27], s12 offen offset:1024
    buffer_load_dwordx4 v[48:51], v5, s[24:27], s12 offen offset:2048
    buffer_load_dwordx4 v[52:55], v5, s[24:27], s12 offen offset:3072
    buffer_load_dwordx4 v[56:59], v5, s[80:83], 0 offen offset:0
    buffer_load_dwordx4 v[60:63], v5, s[80:83], 0 offen offset:1024
    buffer_load_dwordx4 v[64:67], v5, s[84:87], 0 offen offset:0
    buffer_load_dwordx4 v[68:71], v5, s[84:87], 0 offen offset:1024
    s_waitcnt vmcnt(19)
    s_barrier
    s_bfe_u32 s91, s68, 0x4000c
    s_lshl_b32 s92, s91, 7
    s_mul_i32 s93, s91, 393216
    s_add_u32 m0, s94, 0
    s_nop 0
    buffer_load_dwordx4 v20, s[24:27], s92 offen offset:0 lds
    buffer_load_dwordx4 v21, s[24:27], s92 offen offset:1024 lds
    buffer_load_dwordx4 v22, s[24:27], s92 offen offset:2048 lds
    buffer_load_dwordx4 v23, s[24:27], s92 offen offset:3072 lds
    s_add_u32 m0, s95, 0
    s_nop 0
    buffer_load_dwordx4 v24, s[28:31], s93 offen offset:0 lds
    buffer_load_dwordx4 v25, s[28:31], s93 offen offset:1024 lds
    buffer_load_dwordx4 v26, s[28:31], s93 offen offset:2048 lds
    s_add_u32 m0, s95, 3072
    s_nop 0
    buffer_load_dwordx4 v27, s[28:31], s93 offen offset:0 lds
    buffer_load_dwordx4 v28, s[28:31], s93 offen offset:1024 lds
    buffer_load_dwordx4 v29, s[28:31], s93 offen offset:2048 lds
    s_cmp_lg_u32 s21, 0
    s_cbranch_scc1 L_noclr_3
    v_mov_b32 v104, -1
    v_mov_b32 v105, -1
    v_mov_b32 v106, -1
    v_mov_b32 v107, -1
    s_lshl_b32 s12, s19, 13
    s_lshl_b32 s13, s18, 9
    s_add_u32 s12, s12, s13
    s_add_u32 s12, s12, 32768
    s_lshl_b32 s13, s19, 11
    s_lshl_b32 s90, s18, 7
    s_add_u32 s13, s13, s90
    s_add_u32 s13, s13, 163840
    s_mov_b32 exec_hi, 0
    buffer_store_dwordx4 v[104:107], v5, s[32:35], s12 offen sc1
    s_mov_b32 exec_lo, 255
    buffer_store_dwordx4 v[104:107], v5, s[32:35], s13 offen sc1
    s_mov_b64 exec, -1
L_noclr_3:
    s_waitcnt vmcnt(10)
    v_lshlrev_b32 v72, 16, v64
    v_and_b32 v73, 0xffff0000, v64
    v_lshlrev_b32 v74, 16, v65
    v_and_b32 v75, 0xffff0000, v65
    v_lshlrev_b32 v76, 16, v66
    v_and_b32 v77, 0xffff0000, v66
    v_lshlrev_b32 v78, 16, v67
    v_and_b32 v79, 0xffff0000, v67
    v_lshlrev_b32 v80, 16, v68
    v_and_b32 v81, 0xffff0000, v68
    v_lshlrev_b32 v82, 16, v69
    v_and_b32 v83, 0xffff0000, v69
    v_lshlrev_b32 v84, 16, v70
    v_and_b32 v85, 0xffff0000, v70
    v_lshlrev_b32 v86, 16, v71
    v_and_b32 v87, 0xffff0000, v71
    v_mov_b32 v90, 0
    v_mov_b32 v91, 0
    v_dot2_f32_bf16 v90, v40, v56, v90
    v_lshlrev_b32 v94, 16, v40
    v_and_b32 v95, 0xffff0000, v40
    v_mul_f32 v94, v94, v72
    v_mul_f32 v95, v95, v73
    v_cvt_pk_bf16_f32 v94, v94, v95
    v_lshlrev_b32 v95, 16, v94
    v_and_b32 v94, 0xffff0000, v94
    v_add_f32 v91, v91, v95
    v_add_f32 v91, v91, v94
    v_dot2_f32_bf16 v90, v41, v57, v90
    v_lshlrev_b32 v94, 16, v41
    v_and_b32 v95, 0xffff0000, v41
    v_mul_f32 v94, v94, v74
    v_mul_f32 v95, v95, v75
    v_cvt_pk_bf16_f32 v94, v94, v95
    v_lshlrev_b32 v95, 16, v94
    v_and_b32 v94, 0xffff0000, v94
    v_add_f32 v91, v91, v95
    v_add_f32 v91, v91, v94
    v_dot2_f32_bf16 v90, v42, v58, v90
    v_lshlrev_b32 v94, 16, v42
    v_and_b32 v95, 0xffff0000, v42
    v_mul_f32 v94, v94, v76
    v_mul_f32 v95, v95, v77
    v_cvt_pk_bf16_f32 v94, v94, v95
    v_lshlrev_b32 v95, 16, v94
    v_and_b32 v94, 0xffff0000, v94
    v_add_f32 v91, v91, v95
    v_add_f32 v91, v91, v94
    v_dot2_f32_bf16 v90, v43, v59, v90
    v_lshlrev_b32 v94, 16, v43
    v_and_b32 v95, 0xffff0000, v43
    v_mul_f32 v94, v94, v78
    v_mul_f32 v95, v95, v79
    v_cvt_pk_bf16_f32 v94, v94, v95
    v_lshlrev_b32 v95, 16, v94
    v_and_b32 v94, 0xffff0000, v94
    v_add_f32 v91, v91, v95
    v_add_f32 v91, v91, v94
    v_dot2_f32_bf16 v90, v44, v60, v90
    v_lshlrev_b32 v94, 16, v44
    v_and_b32 v95, 0xffff0000, v44
    v_mul_f32 v94, v94, v80
    v_mul_f32 v95, v95, v81
    v_cvt_pk_bf16_f32 v94, v94, v95
    v_lshlrev_b32 v95, 16, v94
    v_and_b32 v94, 0xffff0000, v94
    v_add_f32 v91, v91, v95
    v_add_f32 v91, v91, v94
    v_dot2_f32_bf16 v90, v45, v61, v90
    v_lshlrev_b32 v94, 16, v45
    v_and_b32 v95, 0xffff0000, v45
    v_mul_f32 v94, v94, v82
    v_mul_f32 v95, v95, v83
    v_cvt_pk_bf16_f32 v94, v94, v95
    v_lshlrev_b32 v95, 16, v94
    v_and_b32 v94, 0xffff0000, v94
    v_add_f32 v91, v91, v95
    v_add_f32 v91, v91, v94
    v_dot2_f32_bf16 v90, v46, v62, v90
    v_lshlrev_b32 v94, 16, v46
    v_and_b32 v95, 0xffff0000, v46
    v_mul_f32 v94, v94, v84
    v_mul_f32 v95, v95, v85
    v_cvt_pk_bf16_f32 v94, v94, v95
    v_lshlrev_b32 v95, 16, v94
    v_and_b32 v94, 0xffff0000, v94
    v_add_f32 v91, v91, v95
    v_add_f32 v91, v91, v94
    v_dot2_f32_bf16 v90, v47, v63, v90
    v_lshlrev_b32 v94, 16, v47
    v_and_b32 v95, 0xffff0000, v47
    v_mul_f32 v94, v94, v86
    v_mul_f32 v95, v95, v87
    v_cvt_pk_bf16_f32 v94, v94, v95
    v_lshlrev_b32 v95, 16, v94
    v_and_b32 v94, 0xffff0000, v94
    v_add_f32 v91, v91, v95
    v_add_f32 v91, v91, v94
    v_mov_b32 v92, 0
    v_mov_b32 v93, 0
    v_dot2_f32_bf16 v92, v48, v56, v92
    v_lshlrev_b32 v94, 16, v48
    v_and_b32 v95, 0xffff0000, v48
    v_mul_f32 v94, v94, v72
    v_mul_f32 v95, v95, v73
    v_cvt_pk_bf16_f32 v94, v94, v95
    v_lshlrev_b32 v95, 16, v94
    v_and_b32 v94, 0xffff0000, v94
    v_add_f32 v93, v93, v95
    v_add_f32 v93, v93, v94
    v_dot2_f32_bf16 v92, v49, v57, v92
    v_lshlrev_b32 v94, 16, v49
    v_and_b32 v95, 0xffff0000, v49
    v_mul_f32 v94, v94, v74
    v_mul_f32 v95, v95, v75
    v_cvt_pk_bf16_f32 v94, v94, v95
    v_lshlrev_b32 v95, 16, v94
    v_and_b32 v94, 0xffff0000, v94
    v_add_f32 v93, v93, v95
    v_add_f32 v93, v93, v94
    v_dot2_f32_bf16 v92, v50, v58, v92
    s_barrier
    s_bfe_u32 s91, s68, 0x40010
    s_lshl_b32 s92, s91, 7
    s_mul_i32 s93, s91, 393216
    s_add_u32 m0, s94, 40960
    s_nop 0
    buffer_load_dwordx4 v20, s[24:27], s92 offen offset:0 lds
    buffer_load_dwordx4 v21, s[24:27], s92 offen offset:1024 lds
    buffer_load_dwordx4 v22, s[24:27], s92 offen offset:2048 lds
    buffer_load_dwordx4 v23, s[24:27], s92 offen offset:3072 lds
    s_add_u32 m0, s95, 40960
    s_nop 0
    buffer_load_dwordx4 v24, s[28:31], s93 offen offset:0 lds
    buffer_load_dwordx4 v25, s[28:31], s93 offen offset:1024 lds
    buffer_load_dwordx4 v26, s[28:31], s93 offen offset:2048 lds
    s_add_u32 m0, s95, 44032
    s_nop 0
    buffer_load_dwordx4 v27, s[28:31], s93 offen offset:0 lds
    buffer_load_dwordx4 v28, s[28:31], s93 offen offset:1024 lds
    buffer_load_dwordx4 v29, s[28:31], s93 offen offset:2048 lds
    v_lshlrev_b32 v94, 16, v50
    v_and_b32 v95, 0xffff0000, v50
    v_mul_f32 v94, v94, v76
    v_mul_f32 v95, v95, v77
    v_cvt_pk_bf16_f32 v94, v94, v95
    v_lshlrev_b32 v95, 16, v94
    v_and_b32 v94, 0xffff0000, v94
    v_add_f32 v93, v93, v95
    v_add_f32 v93, v93, v94
    v_dot2_f32_bf16 v92, v51, v59, v92
    v_lshlrev_b32 v94, 16, v51
    v_and_b32 v95, 0xffff0000, v51
    v_mul_f32 v94, v94, v78
    v_mul_f32 v95, v95, v79
    v_cvt_pk_bf16_f32 v94, v94, v95
    v_lshlrev_b32 v95, 16, v94
    v_and_b32 v94, 0xffff0000, v94
    v_add_f32 v93, v93, v95
    v_add_f32 v93, v93, v94
    v_dot2_f32_bf16 v92, v52, v60, v92
    v_lshlrev_b32 v94, 16, v52
    v_and_b32 v95, 0xffff0000, v52
    v_mul_f32 v94, v94, v80
    v_mul_f32 v95, v95, v81
    v_cvt_pk_bf16_f32 v94, v94, v95
    v_lshlrev_b32 v95, 16, v94
    v_and_b32 v94, 0xffff0000, v94
    v_add_f32 v93, v93, v95
    v_add_f32 v93, v93, v94
    v_dot2_f32_bf16 v92, v53, v61, v92
    v_lshlrev_b32 v94, 16, v53
    v_and_b32 v95, 0xffff0000, v53
    v_mul_f32 v94, v94, v82
    v_mul_f32 v95, v95, v83
    v_cvt_pk_bf16_f32 v94, v94, v95
    v_lshlrev_b32 v95, 16, v94
    v_and_b32 v94, 0xffff0000, v94
    v_add_f32 v93, v93, v95
    v_add_f32 v93, v93, v94
    v_dot2_f32_bf16 v92, v54, v62, v92
    v_lshlrev_b32 v94, 16, v54
    v_and_b32 v95, 0xffff0000, v54
    v_mul_f32 v94, v94, v84
    v_mul_f32 v95, v95, v85
    v_cvt_pk_bf16_f32 v94, v94, v95
    v_lshlrev_b32 v95, 16, v94
    v_and_b32 v94, 0xffff0000, v94
    v_add_f32 v93, v93, v95
    v_add_f32 v93, v93, v94
    v_dot2_f32_bf16 v92, v55, v63, v92
    v_lshlrev_b32 v94, 16, v55
    v_and_b32 v95, 0xffff0000, v55
    v_mul_f32 v94, v94, v86
    v_mul_f32 v95, v95, v87
    v_cvt_pk_bf16_f32 v94, v94, v95
    v_lshlrev_b32 v95, 16, v94
    v_and_b32 v94, 0xffff0000, v94
    v_add_f32 v93, v93, v95
    v_add_f32 v93, v93, v94
    v_add_f32_dpp v90, v90, v90 row_shr:1 row_mask:0xf bank_mask:0xf
    v_add_f32_dpp v91, v91, v91 row_shr:1 row_mask:0xf bank_mask:0xf
    v_add_f32_dpp v92, v92, v92 row_shr:1 row_mask:0xf bank_mask:0xf
    v_add_f32_dpp v93, v93, v93 row_shr:1 row_mask:0xf bank_mask:0xf
    v_add_f32_dpp v90, v90, v90 row_shr:2 row_mask:0xf bank_mask:0xf
    v_add_f32_dpp v91, v91, v91 row_shr:2 row_mask:0xf bank_mask:0xf
    v_add_f32_dpp v92, v92, v92 row_shr:2 row_mask:0xf bank_mask:0xf
    v_add_f32_dpp v93, v93, v93 row_shr:2 row_mask:0xf bank_mask:0xf
    v_add_f32_dpp v90, v90, v90 row_shr:4 row_mask:0xf bank_mask:0xf
    v_add_f32_dpp v91, v91, v91 row_shr:4 row_mask:0xf bank_mask:0xf
    v_add_f32_dpp v92, v92, v92 row_shr:4 row_mask:0xf bank_mask:0xf
    v_add_f32_dpp v93, v93, v93 row_shr:4 row_mask:0xf bank_mask:0xf
    v_add_f32_dpp v90, v90, v90 row_shr:8 row_mask:0xf bank_mask:0xf
    v_add_f32_dpp v91, v91, v91 row_shr:8 row_mask:0xf bank_mask:0xf
    v_add_f32_dpp v92, v92, v92 row_shr:8 row_mask:0xf bank_mask:0xf
    v_add_f32_dpp v93, v93, v93 row_shr:8 row_mask:0xf bank_mask:0xf
    v_add_f32_dpp v90, v90, v90 row_bcast:15 row_mask:0xa bank_mask:0xf
    v_add_f32_dpp v91, v91, v91 row_bcast:15 row_mask:0xa bank_mask:0xf
    v_add_f32_dpp v92, v92, v92 row_bcast:15 row_mask:0xa bank_mask:0xf
    v_add_f32_dpp v93, v93, v93 row_bcast:15 row_mask:0xa bank_mask:0xf
    v_add_f32_dpp v90, v90, v90 row_bcast:31 row_mask:0xc bank_mask:0xf
    v_add_f32_dpp v91, v91, v91 row_bcast:31 row_mask:0xc bank_mask:0xf
    v_add_f32_dpp v92, v92, v92 row_bcast:31 row_mask:0xc bank_mask:0xf
    v_add_f32_dpp v93, v93, v93 row_bcast:31 row_mask:0xc bank_mask:0xf
    v_cvt_pk_bf16_f32 v94, v90, v91
    v_and_b32 v95, 0xffff, v94
    v_and_b32 v96, 0x8000, v94
    v_cmp_ne_u32 vcc, 0, v96
    v_mov_b32 v97, 0x8000
    v_mov_b32 v98, 0xffff
    v_cndmask_b32 v96, v97, v98, vcc
    v_xor_b32 v95, v95, v96
    s_sub_u32 s12, 2047, s22
    v_lshlrev_b32 v95, 11, v95
    v_or_b32 v100, s12, v95
    v_and_b32 v94, 0xffff0000, v94
    v_mul_f32 v94, 0xbfb8aa3b, v94
    v_exp_f32 v94, v94
    s_nop 0
    v_add_f32 v94, 1.0, v94
    v_rcp_f32 v94, v94
    s_nop 0
    v_cvt_pk_bf16_f32 v94, v94, v94
    v_lshlrev_b32 v102, 16, v94
    v_cvt_pk_bf16_f32 v94, v92, v93
    v_and_b32 v95, 0xffff, v94
    v_and_b32 v96, 0x8000, v94
    v_cmp_ne_u32 vcc, 0, v96
    v_mov_b32 v97, 0x8000
    v_mov_b32 v98, 0xffff
    v_cndmask_b32 v96, v97, v98, vcc
    v_xor_b32 v95, v95, v96
    s_sub_u32 s12, 2046, s22
    v_lshlrev_b32 v95, 11, v95
    v_or_b32 v101, s12, v95
    v_and_b32 v94, 0xffff0000, v94
    v_mul_f32 v94, 0xbfb8aa3b, v94
    v_exp_f32 v94, v94
    s_nop 0
    v_add_f32 v94, 1.0, v94
    v_rcp_f32 v94, v94
    s_nop 0
    v_cvt_pk_bf16_f32 v94, v94, v94
    v_lshlrev_b32 v103, 16, v94
    v_max_u32 v100, v100, v101
    s_lshl_b32 s12, s22, 2
    s_add_u32 s12, s12, 4096
    s_lshl_b32 s13, s21, 2
    s_add_u32 s13, s13, 162880
    v_mov_b32 v14, s13
    s_mov_b32 exec_lo, 0
    s_mov_b32 exec_hi, 0x80000000
    buffer_store_dwordx2 v[102:103], v13, s[32:35], s12 offen sc1
    ds_write_b32 v14, v100
    s_mov_b64 exec, -1
    s_waitcnt lgkmcnt(0)
    buffer_load_dword v15, v13, s[72:75], 0 offen offset:4 sc1
    s_waitcnt vmcnt(12)
    s_barrier
    s_bfe_u32 s91, s68, 0x40014
    s_lshl_b32 s92, s91, 7
    s_mul_i32 s93, s91, 393216
    s_add_u32 m0, s94, 81920
    s_nop 0
    buffer_load_dwordx4 v20, s[24:27], s92 offen offset:0 lds
    buffer_load_dwordx4 v21, s[24:27], s92 offen offset:1024 lds
    buffer_load_dwordx4 v22, s[24:27], s92 offen offset:2048 lds
    buffer_load_dwordx4 v23, s[24:27], s92 offen offset:3072 lds
    s_add_u32 m0, s95, 81920
    s_nop 0
    buffer_load_dwordx4 v24, s[28:31], s93 offen offset:0 lds
    buffer_load_dwordx4 v25, s[28:31], s93 offen offset:1024 lds
    buffer_load_dwordx4 v26, s[28:31], s93 offen offset:2048 lds
    s_add_u32 m0, s95, 84992
    s_nop 0
    buffer_load_dwordx4 v27, s[28:31], s93 offen offset:0 lds
    buffer_load_dwordx4 v28, s[28:31], s93 offen offset:1024 lds
    buffer_load_dwordx4 v29, s[28:31], s93 offen offset:2048 lds
    s_add_u32 s12, s71, 0
    buffer_load_dwordx4 v[128:131], v30, s[40:43], s12 offen nt
    s_add_u32 s12, s71, 7168
    buffer_load_dwordx4 v[132:135], v30, s[40:43], s12 offen nt
    s_add_u32 s12, s71, 14336
    buffer_load_dwordx4 v[136:139], v30, s[40:43], s12 offen nt
    s_add_u32 s12, s71, 21504
    buffer_load_dwordx4 v[140:143], v30, s[40:43], s12 offen nt
    s_add_u32 s12, s71, 28672
    buffer_load_dwordx4 v[144:147], v30, s[40:43], s12 offen nt
    s_add_u32 s12, s71, 35840
    buffer_load_dwordx4 v[148:151], v30, s[40:43], s12 offen nt
    s_add_u32 s12, s71, 43008
    buffer_load_dwordx4 v[152:155], v30, s[40:43], s12 offen nt
    s_add_u32 s12, s71, 50176
    buffer_load_dwordx4 v[156:159], v30, s[40:43], s12 offen nt
    s_waitcnt vmcnt(20)
    s_barrier
    s_bfe_u32 s91, s68, 0x40018
    s_lshl_b32 s92, s91, 7
    s_mul_i32 s93, s91, 393216
    s_add_u32 m0, s94, 0
    s_nop 0
    buffer_load_dwordx4 v20, s[24:27], s92 offen offset:0 lds
    buffer_load_dwordx4 v21, s[24:27], s92 offen offset:1024 lds
    buffer_load_dwordx4 v22, s[24:27], s92 offen offset:2048 lds
    buffer_load_dwordx4 v23, s[24:27], s92 offen offset:3072 lds
    s_add_u32 m0, s95, 0
    s_nop 0
    buffer_load_dwordx4 v24, s[28:31], s93 offen offset:0 lds
    s_waitcnt vmcnt(23)
    s_mov_b32 s13, 0
L_tagchk_3:
    v_readfirstlane_b32 s23, v15
    s_nop 1
    s_cmp_lg_u32 s23, 0
    s_cbranch_scc1 L_tagok_3
    s_add_u32 s13, s13, 1
    s_cmp_ge_u32 s13, 16384
    s_cbranch_scc1 L_tagok_3
    buffer_load_dword v15, v13, s[72:75], 0 offen offset:4 sc1
    s_waitcnt vmcnt(0)
    s_branch L_tagchk_3
L_tagok_3:
    s_and_b32 s76, s23, 0xff
    s_bfe_u32 s77, s23, 0x80008
    s_bfe_u32 s78, s23, 0x80010
    s_lshr_b32 s79, s23, 24
    v_and_b32 v35, 3, v2
    v_lshlrev_b32 v35, 3, v35
    v_bfe_u32 v35, s23, v35, 8
    s_cmp_lg_u32 s21, 0
    s_cbranch_scc1 L_nopub_3
    v_mov_b32 v14, 162880
    ds_read_b128 v[104:107], v14
    s_lshl_b32 s12, s2, 3
    s_add_u32 s12, s12, 0
    s_waitcnt lgkmcnt(0)
    v_max3_u32 v104, v104, v105, v106
    v_max_u32 v104, v104, v107
    v_mov_b32 v105, s23
    s_mov_b64 exec, 1
    buffer_store_dwordx2 v[104:105], v13, s[32:35], s12 offen sc1
    s_mov_b64 exec, -1
L_nopub_3:
    s_waitcnt vmcnt(13)
    s_barrier
    s_add_u32 m0, s95, 0
    s_nop 0
    buffer_load_dwordx4 v25, s[28:31], s93 offen offset:1024 lds
    buffer_load_dwordx4 v26, s[28:31], s93 offen offset:2048 lds
    s_add_u32 m0, s95, 3072
    s_nop 0
    buffer_load_dwordx4 v27, s[28:31], s93 offen offset:0 lds
    buffer_load_dwordx4 v28, s[28:31], s93 offen offset:1024 lds
    buffer_load_dwordx4 v29, s[28:31], s93 offen offset:2048 lds
    s_bfe_u32 s91, s68, 0x4001c
    s_lshl_b32 s92, s91, 7
    s_mul_i32 s93, s91, 393216
    s_add_u32 m0, s94, 40960
    s_nop 0
    buffer_load_dwordx4 v20, s[24:27], s92 offen offset:0 lds
    buffer_load_dwordx4 v21, s[24:27], s92 offen offset:1024 lds
    buffer_load_dwordx4 v22, s[24:27], s92 offen offset:2048 lds
    buffer_load_dwordx4 v23, s[24:27], s92 offen offset:3072 lds
    s_add_u32 m0, s95, 40960
    s_nop 0
    buffer_load_dwordx4 v24, s[28:31], s93 offen offset:0 lds
    buffer_load_dwordx4 v25, s[28:31], s93 offen offset:1024 lds
    buffer_load_dwordx4 v26, s[28:31], s93 offen offset:2048 lds
    s_waitcnt vmcnt(7)
    s_barrier
    s_add_u32 m0, s95, 44032
    s_nop 0
    buffer_load_dwordx4 v27, s[28:31], s93 offen offset:0 lds
    buffer_load_dwordx4 v28, s[28:31], s93 offen offset:1024 lds
    buffer_load_dwordx4 v29, s[28:31], s93 offen offset:2048 lds
    s_bfe_u32 s91, s69, 0x40000
    s_lshl_b32 s92, s91, 7
    s_mul_i32 s93, s91, 393216
    s_add_u32 m0, s94, 81920
    s_nop 0
    buffer_load_dwordx4 v20, s[24:27], s92 offen offset:0 lds
    buffer_load_dwordx4 v21, s[24:27], s92 offen offset:1024 lds
    buffer_load_dwordx4 v22, s[24:27], s92 offen offset:2048 lds
    buffer_load_dwordx4 v23, s[24:27], s92 offen offset:3072 lds
    s_add_u32 m0, s95, 81920
    s_nop 0
    buffer_load_dwordx4 v24, s[28:31], s93 offen offset:0 lds
    buffer_load_dwordx4 v25, s[28:31], s93 offen offset:1024 lds
    buffer_load_dwordx4 v26, s[28:31], s93 offen offset:2048 lds
    s_add_u32 m0, s95, 84992
    s_nop 0
    buffer_load_dwordx4 v27, s[28:31], s93 offen offset:0 lds
    buffer_load_dwordx4 v28, s[28:31], s93 offen offset:1024 lds
    s_waitcnt vmcnt(9)
    s_barrier
    s_add_u32 m0, s95, 84992
    s_nop 0
    buffer_load_dwordx4 v29, s[28:31], s93 offen offset:2048 lds
    s_bfe_u32 s91, s69, 0x40004
    s_lshl_b32 s92, s91, 7
    s_mul_i32 s93, s91, 393216
    s_add_u32 m0, s94, 0
    s_nop 0
    buffer_load_dwordx4 v20, s[24:27], s92 offen offset:0 lds
    buffer_load_dwordx4 v21, s[24:27], s92 offen offset:1024 lds
    buffer_load_dwordx4 v22, s[24:27], s92 offen offset:2048 lds
    buffer_load_dwordx4 v23, s[24:27], s92 offen offset:3072 lds
    s_add_u32 m0, s95, 0
    s_nop 0
    buffer_load_dwordx4 v24, s[28:31], s93 offen offset:0 lds
    buffer_load_dwordx4 v25, s[28:31], s93 offen offset:1024 lds
    buffer_load_dwordx4 v26, s[28:31], s93 offen offset:2048 lds
    s_add_u32 m0, s95, 3072
    s_nop 0
    buffer_load_dwordx4 v27, s[28:31], s93 offen offset:0 lds
    buffer_load_dwordx4 v28, s[28:31], s93 offen offset:1024 lds
    buffer_load_dwordx4 v29, s[28:31], s93 offen offset:2048 lds
    s_waitcnt vmcnt(10)
    s_barrier
    s_bfe_u32 s91, s69, 0x40008
    s_lshl_b32 s92, s91, 7
    s_mul_i32 s93, s91, 393216
    s_add_u32 m0, s94, 40960
    s_nop 0
    buffer_load_dwordx4 v20, s[24:27], s92 offen offset:0 lds
    buffer_load_dwordx4 v21, s[24:27], s92 offen offset:1024 lds
    buffer_load_dwordx4 v22, s[24:27], s92 offen offset:2048 lds
    buffer_load_dwordx4 v23, s[24:27], s92 offen offset:3072 lds
    s_add_u32 m0, s95, 40960
    s_nop 0
    buffer_load_dwordx4 v24, s[28:31], s93 offen offset:0 lds
    buffer_load_dwordx4 v25, s[28:31], s93 offen offset:1024 lds
    buffer_load_dwordx4 v26, s[28:31], s93 offen offset:2048 lds
    s_add_u32 m0, s95, 44032
    s_nop 0
    buffer_load_dwordx4 v27, s[28:31], s93 offen offset:0 lds
    buffer_load_dwordx4 v28, s[28:31], s93 offen offset:1024 lds
    buffer_load_dwordx4 v29, s[28:31], s93 offen offset:2048 lds
    s_add_u32 s12, s71, 0
    buffer_load_dwordx4 v[160:163], v30, s[44:47], s12 offen nt
    s_add_u32 s12, s71, 7168
    buffer_load_dwordx4 v[164:167], v30, s[44:47], s12 offen nt
    s_add_u32 s12, s71, 14336
    buffer_load_dwordx4 v[168:171], v30, s[44:47], s12 offen nt
    s_add_u32 s12, s71, 21504
    buffer_load_dwordx4 v[172:175], v30, s[44:47], s12 offen nt
    s_add_u32 s12, s71, 28672
    buffer_load_dwordx4 v[176:179], v30, s[44:47], s12 offen nt
    s_add_u32 s12, s71, 35840
    buffer_load_dwordx4 v[180:183], v30, s[44:47], s12 offen nt
    s_add_u32 s12, s71, 43008
    buffer_load_dwordx4 v[184:187], v30, s[44:47], s12 offen nt
    s_add_u32 s12, s71, 50176
    buffer_load_dwordx4 v[188:191], v30, s[44:47], s12 offen nt
    s_waitcnt vmcnt(18)
    s_barrier
    s_bfe_u32 s91, s69, 0x4000c
    s_lshl_b32 s92, s91, 7
    s_mul_i32 s93, s91, 393216
    s_add_u32 m0, s94, 81920
    s_nop 0
    buffer_load_dwordx4 v20, s[24:27], s92 offen offset:0 lds
    buffer_load_dwordx4 v21, s[24:27], s92 offen offset:1024 lds
    buffer_load_dwordx4 v22, s[24:27], s92 offen offset:2048 lds
    buffer_load_dwordx4 v23, s[24:27], s92 offen offset:3072 lds
    s_add_u32 m0, s95, 81920
    s_nop 0
    buffer_load_dwordx4 v24, s[28:31], s93 offen offset:0 lds
    s_mov_b32 s12, 0
    buffer_load_dwordx4 v[104:107], v5, s[32:35], s12 offen offset:0 sc1
    buffer_load_dwordx4 v[108:111], v5, s[32:35], s12 offen offset:1024 sc1
    s_waitcnt vmcnt(15)
    s_barrier
    s_add_u32 m0, s95, 81920
    s_nop 0
    buffer_load_dwordx4 v25, s[28:31], s93 offen offset:1024 lds
    buffer_load_dwordx4 v26, s[28:31], s93 offen offset:2048 lds
    s_add_u32 m0, s95, 84992
    s_nop 0
    buffer_load_dwordx4 v27, s[28:31], s93 offen offset:0 lds
    buffer_load_dwordx4 v28, s[28:31], s93 offen offset:1024 lds
    buffer_load_dwordx4 v29, s[28:31], s93 offen offset:2048 lds
    s_bfe_u32 s91, s69, 0x40010
    s_lshl_b32 s92, s91, 7
    s_mul_i32 s93, s91, 393216
    s_add_u32 m0, s94, 0
    s_nop 0
    buffer_load_dwordx4 v20, s[24:27], s92 offen offset:0 lds
    buffer_load_dwordx4 v21, s[24:27], s92 offen offset:1024 lds
    buffer_load_dwordx4 v22, s[24:27], s92 offen offset:2048 lds
    buffer_load_dwordx4 v23, s[24:27], s92 offen offset:3072 lds
    s_add_u32 m0, s95, 0
    s_nop 0
    buffer_load_dwordx4 v24, s[28:31], s93 offen offset:0 lds
    buffer_load_dwordx4 v25, s[28:31], s93 offen offset:1024 lds
    buffer_load_dwordx4 v26, s[28:31], s93 offen offset:2048 lds
    s_waitcnt vmcnt(7)
    s_barrier
    s_add_u32 m0, s95, 3072
    s_nop 0
    buffer_load_dwordx4 v27, s[28:31], s93 offen offset:0 lds
    buffer_load_dwordx4 v28, s[28:31], s93 offen offset:1024 lds
    buffer_load_dwordx4 v29, s[28:31], s93 offen offset:2048 lds
    s_bfe_u32 s91, s69, 0x40014
    s_lshl_b32 s92, s91, 7
    s_mul_i32 s93, s91, 393216
    s_add_u32 m0, s94, 40960
    s_nop 0
    buffer_load_dwordx4 v20, s[24:27], s92 offen offset:0 lds
    buffer_load_dwordx4 v21, s[24:27], s92 offen offset:1024 lds
    buffer_load_dwordx4 v22, s[24:27], s92 offen offset:2048 lds
    buffer_load_dwordx4 v23, s[24:27], s92 offen offset:3072 lds
    s_add_u32 m0, s95, 40960
    s_nop 0
    buffer_load_dwordx4 v24, s[28:31], s93 offen offset:0 lds
    buffer_load_dwordx4 v25, s[28:31], s93 offen offset:1024 lds
    buffer_load_dwordx4 v26, s[28:31], s93 offen offset:2048 lds
    s_add_u32 m0, s95, 44032
    s_nop 0
    buffer_load_dwordx4 v27, s[28:31], s93 offen offset:0 lds
    buffer_load_dwordx4 v28, s[28:31], s93 offen offset:1024 lds
    s_mov_b32 s13, 0
L_keychk_3:
    v_xor_b32 v105, s23, v105
    v_xor_b32 v107, s23, v107
    v_xor_b32 v109, s23, v109
    v_xor_b32 v111, s23, v111
    v_or3_b32 v105, v105, v107, v109
    v_or_b32 v105, v105, v111
    v_cmp_ne_u32 vcc, 0, v105
    s_cbranch_vccz L_keyok_3
    s_add_u32 s13, s13, 1
    s_cmp_ge_u32 s13, 16384
    s_cbranch_scc1 L_keyok_3
    s_mov_b32 s12, 0
    buffer_load_dwordx4 v[104:107], v5, s[32:35], s12 offen offset:0 sc1
    buffer_load_dwordx4 v[108:111], v5, s[32:35], s12 offen offset:1024 sc1
    s_waitcnt vmcnt(0)
    s_branch L_keychk_3
L_keyok_3:
    v_max3_u32 v104, v104, v106, v108
    v_max_u32 v104, v104, v110
    s_nop 1
    v_max_u32_dpp v104, v104, v104 row_shr:1 row_mask:0xf bank_mask:0xf
    s_nop 1
    v_max_u32_dpp v104, v104, v104 row_shr:2 row_mask:0xf bank_mask:0xf
    s_nop 1
    v_max_u32_dpp v104, v104, v104 row_shr:4 row_mask:0xf bank_mask:0xf
    s_nop 1
    v_max_u32_dpp v104, v104, v104 row_shr:8 row_mask:0xf bank_mask:0xf
    s_nop 1
    v_max_u32_dpp v104, v104, v104 row_bcast:15 row_mask:0xa bank_mask:0xf
    s_nop 1
    v_max_u32_dpp v104, v104, v104 row_bcast:31 row_mask:0xc bank_mask:0xf
    s_nop 0
    v_readlane_b32 s14, v104, 63
    s_nop 1
    s_and_b32 s15, s14, 2047
    s_sub_u32 s15, 2047, s15
    s_lshl_b32 s12, s15, 11
    s_lshl_b32 s13, s70, 1
    s_add_u32 s12, s12, s13
    buffer_load_dwordx4 v[36:39], v34, s[24:27], s12 offen
    s_lshr_b32 s12, s14, 11
    s_and_b32 s13, s12, 0x8000
    s_cmp_lg_u32 s13, 0
    s_mov_b32 s13, 0xffff
    s_cselect_b32 s13, 0x8000, s13
    s_xor_b32 s12, s12, s13
    s_lshl_b32 s12, s12, 16
    v_mov_b32 v105, s12
    v_mul_f32 v105, 0xbfb8aa3b, v105
    v_exp_f32 v105, v105
    s_nop 0
    v_add_f32 v105, 1.0, v105
    v_rcp_f32 v105, v105
    s_nop 0
    v_cvt_pk_bf16_f32 v105, v105, v105
    v_lshlrev_b32 v105, 16, v105
    s_nop 0
    v_readfirstlane_b32 s14, v105
    s_add_u32 s12, s15, 1
    v_mov_b32 v104, s12
    v_mov_b32 v106, s23
    v_mov_b32 v14, 162864
    s_mov_b64 exec, 1
    ds_write_b96 v14, v[104:106]
    s_mov_b64 exec, -1
    s_waitcnt lgkmcnt(0)
    s_waitcnt vmcnt(10)
    s_barrier
    s_add_u32 m0, s95, 44032
    s_nop 0
    buffer_load_dwordx4 v29, s[28:31], s93 offen offset:2048 lds
    s_bfe_u32 s91, s69, 0x40018
    s_lshl_b32 s92, s91, 7
    s_mul_i32 s93, s91, 393216
    s_add_u32 m0, s94, 81920
    s_nop 0
    buffer_load_dwordx4 v20, s[24:27], s92 offen offset:0 lds
    buffer_load_dwordx4 v21, s[24:27], s92 offen offset:1024 lds
    buffer_load_dwordx4 v22, s[24:27], s92 offen offset:2048 lds
    buffer_load_dwordx4 v23, s[24:27], s92 offen offset:3072 lds
    s_add_u32 m0, s95, 81920
    s_nop 0
    buffer_load_dwordx4 v24, s[28:31], s93 offen offset:0 lds
    buffer_load_dwordx4 v25, s[28:31], s93 offen offset:1024 lds
    buffer_load_dwordx4 v26, s[28:31], s93 offen offset:2048 lds
    s_add_u32 m0, s95, 84992
    s_nop 0
    buffer_load_dwordx4 v27, s[28:31], s93 offen offset:0 lds
    buffer_load_dwordx4 v28, s[28:31], s93 offen offset:1024 lds
    buffer_load_dwordx4 v29, s[28:31], s93 offen offset:2048 lds
    s_waitcnt vmcnt(11)
    v_and_b32 v40, 0xffff, v36
    v_lshlrev_b32 v41, 16, v36
    v_lshrrev_b32 v42, 16, v36
    v_and_b32 v43, 0xffff0000, v36
    v_and_b32 v44, 0xffff, v37
    v_lshlrev_b32 v45, 16, v37
    v_lshrrev_b32 v46, 16, v37
    v_and_b32 v47, 0xffff0000, v37
    v_and_b32 v48, 0xffff, v38
    v_lshlrev_b32 v49, 16, v38
    v_lshrrev_b32 v50, 16, v38
    v_and_b32 v51, 0xffff0000, v38
    v_and_b32 v52, 0xffff, v39
    v_lshlrev_b32 v53, 16, v39
    v_lshrrev_b32 v54, 16, v39
    v_and_b32 v55, 0xffff0000, v39
    v_dot2_f32_bf16 v220, v128, v40, 0
    v_dot2_f32_bf16 v221, v128, v41, 0
    v_dot2_f32_bf16 v222, v129, v40, 0
    v_dot2_f32_bf16 v223, v129, v41, 0
    v_dot2_f32_bf16 v224, v130, v40, 0
    v_dot2_f32_bf16 v225, v130, v41, 0
    v_dot2_f32_bf16 v226, v131, v40, 0
    v_dot2_f32_bf16 v227, v131, v41, 0
    v_dot2_f32_bf16 v228, v160, v40, 0
    v_dot2_f32_bf16 v229, v160, v41, 0
    v_dot2_f32_bf16 v230, v161, v40, 0
    v_dot2_f32_bf16 v231, v161, v41, 0
    v_dot2_f32_bf16 v232, v162, v40, 0
    v_dot2_f32_bf16 v233, v162, v41, 0
    v_dot2_f32_bf16 v234, v163, v40, 0
    v_dot2_f32_bf16 v235, v163, v41, 0
    v_dot2_f32_bf16 v220, v132, v42, v220
    v_dot2_f32_bf16 v221, v132, v43, v221
    v_dot2_f32_bf16 v222, v133, v42, v222
    v_dot2_f32_bf16 v223, v133, v43, v223
    v_dot2_f32_bf16 v224, v134, v42, v224
    v_dot2_f32_bf16 v225, v134, v43, v225
    v_dot2_f32_bf16 v226, v135, v42, v226
    v_dot2_f32_bf16 v227, v135, v43, v227
    v_dot2_f32_bf16 v228, v164, v42, v228
    v_dot2_f32_bf16 v229, v164, v43, v229
    v_dot2_f32_bf16 v230, v165, v42, v230
    v_dot2_f32_bf16 v231, v165, v43, v231
    v_dot2_f32_bf16 v232, v166, v42, v232
    v_dot2_f32_bf16 v233, v166, v43, v233
    v_dot2_f32_bf16 v234, v167, v42, v234
    v_dot2_f32_bf16 v235, v167, v43, v235
    v_dot2_f32_bf16 v220, v136, v44, v220
    v_dot2_f32_bf16 v221, v136, v45, v221
    v_dot2_f32_bf16 v222, v137, v44, v222
    v_dot2_f32_bf16 v223, v137, v45, v223
    v_dot2_f32_bf16 v224, v138, v44, v224
    v_dot2_f32_bf16 v225, v138, v45, v225
    v_dot2_f32_bf16 v226, v139, v44, v226
    v_dot2_f32_bf16 v227, v139, v45, v227
    v_dot2_f32_bf16 v228, v168, v44, v228
    v_dot2_f32_bf16 v229, v168, v45, v229
    s_waitcnt vmcnt(10)
    s_barrier
    s_bfe_u32 s91, s69, 0x4001c
    s_lshl_b32 s92, s91, 7
    s_mul_i32 s93, s91, 393216
    s_add_u32 m0, s94, 0
    s_nop 0
    buffer_load_dwordx4 v20, s[24:27], s92 offen offset:0 lds
    buffer_load_dwordx4 v21, s[24:27], s92 offen offset:1024 lds
    buffer_load_dwordx4 v22, s[24:27], s92 offen offset:2048 lds
    buffer_load_dwordx4 v23, s[24:27], s92 offen offset:3072 lds
    s_add_u32 m0, s95, 0
    s_nop 0
    buffer_load_dwordx4 v24, s[28:31], s93 offen offset:0 lds
    buffer_load_dwordx4 v25, s[28:31], s93 offen offset:1024 lds
    buffer_load_dwordx4 v26, s[28:31], s93 offen offset:2048 lds
    s_add_u32 m0, s95, 3072
    s_nop 0
    buffer_load_dwordx4 v27, s[28:31], s93 offen offset:0 lds
    buffer_load_dwordx4 v28, s[28:31], s93 offen offset:1024 lds
    buffer_load_dwordx4 v29, s[28:31], s93 offen offset:2048 lds
    s_add_u32 s12, s97, 0
    buffer_load_dwordx4 v[192:195], v31, s[64:67], s12 offen nt
    s_add_u32 s12, s97, 16384
    buffer_load_dwordx4 v[196:199], v31, s[64:67], s12 offen nt
    s_add_u32 s12, s97, 32768
    buffer_load_dwordx4 v[200:203], v31, s[64:67], s12 offen nt
    s_add_u32 s12, s97, 49152
    buffer_load_dwordx4 v[204:207], v31, s[64:67], s12 offen nt
    s_add_u32 s12, s97, 65536
    buffer_load_dwordx4 v[208:211], v31, s[64:67], s12 offen nt
    s_add_u32 s12, s97, 81920
    buffer_load_dwordx4 v[212:215], v31, s[64:67], s12 offen nt
    s_add_u32 s12, s97, 98304
    buffer_load_dwordx4 v[216:219], v31, s[64:67], s12 offen nt
    v_dot2_f32_bf16 v230, v169, v44, v230
    v_dot2_f32_bf16 v231, v169, v45, v231
    v_dot2_f32_bf16 v232, v170, v44, v232
    v_dot2_f32_bf16 v233, v170, v45, v233
    v_dot2_f32_bf16 v234, v171, v44, v234
    v_dot2_f32_bf16 v235, v171, v45, v235
    v_dot2_f32_bf16 v220, v140, v46, v220
    v_dot2_f32_bf16 v221, v140, v47, v221
    v_dot2_f32_bf16 v222, v141, v46, v222
    v_dot2_f32_bf16 v223, v141, v47, v223
    v_dot2_f32_bf16 v224, v142, v46, v224
    v_dot2_f32_bf16 v225, v142, v47, v225
    v_dot2_f32_bf16 v226, v143, v46, v226
    v_dot2_f32_bf16 v227, v143, v47, v227
    v_dot2_f32_bf16 v228, v172, v46, v228
    v_dot2_f32_bf16 v229, v172, v47, v229
    v_dot2_f32_bf16 v230, v173, v46, v230
    v_dot2_f32_bf16 v231, v173, v47, v231
    v_dot2_f32_bf16 v232, v174, v46, v232
    v_dot2_f32_bf16 v233, v174, v47, v233
    v_dot2_f32_bf16 v234, v175, v46, v234
    v_dot2_f32_bf16 v235, v175, v47, v235
    v_dot2_f32_bf16 v220, v144, v48, v220
    v_dot2_f32_bf16 v221, v144, v49, v221
    v_dot2_f32_bf16 v222, v145, v48, v222
    v_dot2_f32_bf16 v223, v145, v49, v223
    v_dot2_f32_bf16 v224, v146, v48, v224
    v_dot2_f32_bf16 v225, v146, v49, v225
    v_dot2_f32_bf16 v226, v147, v48, v226
    v_dot2_f32_bf16 v227, v147, v49, v227
    v_dot2_f32_bf16 v228, v176, v48, v228
    v_dot2_f32_bf16 v229, v176, v49, v229
    v_dot2_f32_bf16 v230, v177, v48, v230
    v_dot2_f32_bf16 v231, v177, v49, v231
    v_dot2_f32_bf16 v232, v178, v48, v232
    v_dot2_f32_bf16 v233, v178, v49, v233
    v_dot2_f32_bf16 v234, v179, v48, v234
    v_dot2_f32_bf16 v235, v179, v49, v235
    v_dot2_f32_bf16 v220, v148, v50, v220
    v_dot2_f32_bf16 v221, v148, v51, v221
    v_dot2_f32_bf16 v222, v149, v50, v222
    v_dot2_f32_bf16 v223, v149, v51, v223
    v_dot2_f32_bf16 v224, v150, v50, v224
    v_dot2_f32_bf16 v225, v150, v51, v225
    v_dot2_f32_bf16 v226, v151, v50, v226
    v_dot2_f32_bf16 v227, v151, v51, v227
    v_dot2_f32_bf16 v228, v180, v50, v228
    v_dot2_f32_bf16 v229, v180, v51, v229
    v_dot2_f32_bf16 v230, v181, v50, v230
    v_dot2_f32_bf16 v231, v181, v51, v231
    v_dot2_f32_bf16 v232, v182, v50, v232
    v_dot2_f32_bf16 v233, v182, v51, v233
    v_dot2_f32_bf16 v234, v183, v50, v234
    v_dot2_f32_bf16 v235, v183, v51, v235
    v_dot2_f32_bf16 v220, v152, v52, v220
    v_dot2_f32_bf16 v221, v152, v53, v221
    v_dot2_f32_bf16 v222, v153, v52, v222
    v_dot2_f32_bf16 v223, v153, v53, v223
    s_waitcnt vmcnt(17)
    s_barrier
    s_mul_i32 s12, s21, 8
    s_add_u32 s12, s12, 96
    s_lshl_b32 s13, s12, 10
    s_lshl_b32 s12, s12, 14
    s_add_u32 m0, s13, 24576
    s_add_u32 s90, s12, 0
    buffer_load_dwordx4 v33, s[36:39], s90 offen lds
    s_add_u32 m0, s13, 25600
    s_add_u32 s90, s12, 16384
    buffer_load_dwordx4 v33, s[36:39], s90 offen lds
    s_add_u32 m0, s13, 26624
    s_add_u32 s90, s12, 32768
    buffer_load_dwordx4 v33, s[36:39], s90 offen lds
    s_add_u32 m0, s13, 27648
    s_add_u32 s90, s12, 49152
    buffer_load_dwordx4 v33, s[36:39], s90 offen lds
    s_add_u32 m0, s13, 28672
    s_add_u32 s90, s12, 65536
    buffer_load_dwordx4 v33, s[36:39], s90 offen lds
    s_add_u32 m0, s13, 29696
    s_add_u32 s90, s12, 81920
    buffer_load_dwordx4 v33, s[36:39], s90 offen lds
    s_add_u32 m0, s13, 30720
    s_add_u32 s90, s12, 98304
    buffer_load_dwordx4 v33, s[36:39], s90 offen lds
    s_add_u32 m0, s13, 31744
    s_add_u32 s90, s12, 114688
    buffer_load_dwordx4 v33, s[36:39], s90 offen lds
    v_dot2_f32_bf16 v224, v154, v52, v224
    v_dot2_f32_bf16 v225, v154, v53, v225
    v_dot2_f32_bf16 v226, v155, v52, v226
    v_dot2_f32_bf16 v227, v155, v53, v227
    v_dot2_f32_bf16 v228, v184, v52, v228
    v_dot2_f32_bf16 v229, v184, v53, v229
    v_dot2_f32_bf16 v230, v185, v52, v230
    v_dot2_f32_bf16 v231, v185, v53, v231
    v_dot2_f32_bf16 v232, v186, v52, v232
    v_dot2_f32_bf16 v233, v186, v53, v233
    v_dot2_f32_bf16 v234, v187, v52, v234
    v_dot2_f32_bf16 v235, v187, v53, v235
    v_dot2_f32_bf16 v220, v156, v54, v220
    v_dot2_f32_bf16 v221, v156, v55, v221
    v_dot2_f32_bf16 v222, v157, v54, v222
    v_dot2_f32_bf16 v223, v157, v55, v223
    v_dot2_f32_bf16 v224, v158, v54, v224
    v_dot2_f32_bf16 v225, v158, v55, v225
    v_dot2_f32_bf16 v226, v159, v54, v226
    v_dot2_f32_bf16 v227, v159, v55, v227
    v_dot2_f32_bf16 v228, v188, v54, v228
    v_dot2_f32_bf16 v229, v188, v55, v229
    v_dot2_f32_bf16 v230, v189, v54, v230
    v_dot2_f32_bf16 v231, v189, v55, v231
    v_dot2_f32_bf16 v232, v190, v54, v232
    v_dot2_f32_bf16 v233, v190, v55, v233
    v_dot2_f32_bf16 v234, v191, v54, v234
    v_dot2_f32_bf16 v235, v191, v55, v235
    v_permlane32_swap_b32 v220, v228
    v_permlane32_swap_b32 v221, v229
    v_permlane32_swap_b32 v222, v230
    v_permlane32_swap_b32 v223, v231
    v_permlane32_swap_b32 v224, v232
    v_permlane32_swap_b32 v225, v233
    v_permlane32_swap_b32 v226, v234
    v_permlane32_swap_b32 v227, v235
    v_add_f32 v220, v220, v228
    v_add_f32 v221, v221, v229
    v_add_f32 v222, v222, v230
    v_add_f32 v223, v223, v231
    v_add_f32 v224, v224, v232
    v_add_f32 v225, v225, v233
    v_add_f32 v226, v226, v234
    v_add_f32 v227, v227, v235
    v_permlane16_swap_b32 v220, v224
    v_permlane16_swap_b32 v221, v225
    v_permlane16_swap_b32 v222, v226
    v_permlane16_swap_b32 v223, v227
    v_add_f32 v220, v220, v224
    v_add_f32 v221, v221, v225
    v_add_f32 v222, v222, v226
    v_add_f32 v223, v223, v227
    v_add_f32_dpp v220, v220, v220 row_ror:8 row_mask:0xf bank_mask:0xf
    v_add_f32_dpp v221, v221, v221 row_ror:8 row_mask:0xf bank_mask:0xf
    v_add_f32_dpp v222, v222, v222 row_ror:8 row_mask:0xf bank_mask:0xf
    v_add_f32_dpp v223, v223, v223 row_ror:8 row_mask:0xf bank_mask:0xf
    s_waitcnt vmcnt(15)
    s_barrier
    s_branch L_varend
L_var4:
    s_nop 0
    s_add_u32 m0, s95, 40960
    s_nop 0
    buffer_load_dwordx4 v26, s[28:31], s93 offen offset:2048 lds
    s_add_u32 m0, s95, 44032
    s_nop 0
    buffer_load_dwordx4 v27, s[28:31], s93 offen offset:0 lds
    buffer_load_dwordx4 v28, s[28:31], s93 offen offset:1024 lds
    buffer_load_dwordx4 v29, s[28:31], s93 offen offset:2048 lds
    s_bfe_u32 s91, s68, 0x40008
    s_lshl_b32 s92, s91, 7
    s_mul_i32 s93, s91, 393216
    s_add_u32 m0, s94, 81920
    s_nop 0
    buffer_load_dwordx4 v20, s[24:27], s92 offen offset:0 lds
    buffer_load_dwordx4 v21, s[24:27], s92 offen offset:1024 lds
    buffer_load_dwordx4 v22, s[24:27], s92 offen offset:2048 lds
    buffer_load_dwordx4 v23, s[24:27], s92 offen offset:3072 lds
    s_add_u32 m0, s95, 81920
    s_nop 0
    buffer_load_dwordx4 v24, s[28:31], s93 offen offset:0 lds
    buffer_load_dwordx4 v25, s[28:31], s93 offen offset:1024 lds
    buffer_load_dwordx4 v26, s[28:31], s93 offen offset:2048 lds
    s_add_u32 m0, s95, 84992
    s_nop 0
    buffer_load_dwordx4 v27, s[28:31], s93 offen offset:0 lds
    buffer_load_dwordx4 v28, s[28:31], s93 offen offset:1024 lds
    buffer_load_dwordx4 v29, s[28:31], s93 offen offset:2048 lds
    s_lshl_b32 s12, s19, 2
    s_add_u32 s12, s12, s21
    s_lshl_b32 s12, s12, 10
    s_lshl_b32 s13, s21, 10
    s_add_u32 m0, s13, 155648
    s_nop 0
    buffer_load_dwordx4 v5, s[76:79], s12 offen lds
    s_lshl_b32 s12, s22, 11
    buffer_load_dwordx4 v[40:43], v5, s[24:27], s12 offen offset:0
    buffer_load_dwordx4 v[44:47], v5, s[24:27], s12 offen offset:1024
    buffer_load_dwordx4 v[48:51], v5, s[24:27], s12 offen offset:2048
    buffer_load_dwordx4 v[52:55], v5, s[24:27], s12 offen offset:3072
    buffer_load_dwordx4 v[56:59], v5, s[80:83], 0 offen offset:0
    buffer_load_dwordx4 v[60:63], v5, s[80:83], 0 offen offset:1024
    buffer_load_dwordx4 v[64:67], v5, s[84:87], 0 offen offset:0
    buffer_load_dwordx4 v[68:71], v5, s[84:87], 0 offen offset:1024
    s_waitcnt vmcnt(19)
    s_barrier
    s_bfe_u32 s91, s68, 0x4000c
    s_lshl_b32 s92, s91, 7
    s_mul_i32 s93, s91, 393216
    s_add_u32 m0, s94, 0
    s_nop 0
    buffer_load_dwordx4 v20, s[24:27], s92 offen offset:0 lds
    buffer_load_dwordx4 v21, s[24:27], s92 offen offset:1024 lds
    buffer_load_dwordx4 v22, s[24:27], s92 offen offset:2048 lds
    buffer_load_dwordx4 v23, s[24:27], s92 offen offset:3072 lds
    s_add_u32 m0, s95, 0
    s_nop 0
    buffer_load_dwordx4 v24, s[28:31], s93 offen offset:0 lds
    buffer_load_dwordx4 v25, s[28:31], s93 offen offset:1024 lds
    buffer_load_dwordx4 v26, s[28:31], s93 offen offset:2048 lds
    s_add_u32 m0, s95, 3072
    s_nop 0
    buffer_load_dwordx4 v27, s[28:31], s93 offen offset:0 lds
    buffer_load_dwordx4 v28, s[28:31], s93 offen offset:1024 lds
    buffer_load_dwordx4 v29, s[28:31], s93 offen offset:2048 lds
    s_cmp_lg_u32 s21, 0
    s_cbranch_scc1 L_noclr_4
    v_mov_b32 v104, -1
    v_mov_b32 v105, -1
    v_mov_b32 v106, -1
    v_mov_b32 v107, -1
    s_lshl_b32 s12, s19, 13
    s_lshl_b32 s13, s18, 9
    s_add_u32 s12, s12, s13
    s_add_u32 s12, s12, 32768
    s_lshl_b32 s13, s19, 11
    s_lshl_b32 s90, s18, 7
    s_add_u32 s13, s13, s90
    s_add_u32 s13, s13, 163840
    s_mov_b32 exec_hi, 0
    buffer_store_dwordx4 v[104:107], v5, s[32:35], s12 offen sc1
    s_mov_b32 exec_lo, 255
    buffer_store_dwordx4 v[104:107], v5, s[32:35], s13 offen sc1
    s_mov_b64 exec, -1
L_noclr_4:
    s_waitcnt vmcnt(10)
    v_lshlrev_b32 v72, 16, v64
    v_and_b32 v73, 0xffff0000, v64
    v_lshlrev_b32 v74, 16, v65
    v_and_b32 v75, 0xffff0000, v65
    v_lshlrev_b32 v76, 16, v66
    v_and_b32 v77, 0xffff0000, v66
    v_lshlrev_b32 v78, 16, v67
    v_and_b32 v79, 0xffff0000, v67
    v_lshlrev_b32 v80, 16, v68
    v_and_b32 v81, 0xffff0000, v68
    v_lshlrev_b32 v82, 16, v69
    v_and_b32 v83, 0xffff0000, v69
    v_lshlrev_b32 v84, 16, v70
    v_and_b32 v85, 0xffff0000, v70
    v_lshlrev_b32 v86, 16, v71
    v_and_b32 v87, 0xffff0000, v71
    v_mov_b32 v90, 0
    v_mov_b32 v91, 0
    v_dot2_f32_bf16 v90, v40, v56, v90
    v_lshlrev_b32 v94, 16, v40
    v_and_b32 v95, 0xffff0000, v40
    v_mul_f32 v94, v94, v72
    v_mul_f32 v95, v95, v73
    v_cvt_pk_bf16_f32 v94, v94, v95
    v_lshlrev_b32 v95, 16, v94
    v_and_b32 v94, 0xffff0000, v94
    v_add_f32 v91, v91, v95
    v_add_f32 v91, v91, v94
    v_dot2_f32_bf16 v90, v41, v57, v90
    v_lshlrev_b32 v94, 16, v41
    v_and_b32 v95, 0xffff0000, v41
    v_mul_f32 v94, v94, v74
    v_mul_f32 v95, v95, v75
    v_cvt_pk_bf16_f32 v94, v94, v95
    v_lshlrev_b32 v95, 16, v94
    v_and_b32 v94, 0xffff0000, v94
    v_add_f32 v91, v91, v95
    v_add_f32 v91, v91, v94
    v_dot2_f32_bf16 v90, v42, v58, v90
    v_lshlrev_b32 v94, 16, v42
    v_and_b32 v95, 0xffff0000, v42
    v_mul_f32 v94, v94, v76
    v_mul_f32 v95, v95, v77
    v_cvt_pk_bf16_f32 v94, v94, v95
    v_lshlrev_b32 v95, 16, v94
    v_and_b32 v94, 0xffff0000, v94
    v_add_f32 v91, v91, v95
    v_add_f32 v91, v91, v94
    v_dot2_f32_bf16 v90, v43, v59, v90
    v_lshlrev_b32 v94, 16, v43
    v_and_b32 v95, 0xffff0000, v43
    v_mul_f32 v94, v94, v78
    v_mul_f32 v95, v95, v79
    v_cvt_pk_bf16_f32 v94, v94, v95
    v_lshlrev_b32 v95, 16, v94
    v_and_b32 v94, 0xffff0000, v94
    v_add_f32 v91, v91, v95
    v_add_f32 v91, v91, v94
    v_dot2_f32_bf16 v90, v44, v60, v90
    v_lshlrev_b32 v94, 16, v44
    v_and_b32 v95, 0xffff0000, v44
    v_mul_f32 v94, v94, v80
    v_mul_f32 v95, v95, v81
    v_cvt_pk_bf16_f32 v94, v94, v95
    v_lshlrev_b32 v95, 16, v94
    v_and_b32 v94, 0xffff0000, v94
    v_add_f32 v91, v91, v95
    v_add_f32 v91, v91, v94
    v_dot2_f32_bf16 v90, v45, v61, v90
    v_lshlrev_b32 v94, 16, v45
    v_and_b32 v95, 0xffff0000, v45
    v_mul_f32 v94, v94, v82
    v_mul_f32 v95, v95, v83
    v_cvt_pk_bf16_f32 v94, v94, v95
    v_lshlrev_b32 v95, 16, v94
    v_and_b32 v94, 0xffff0000, v94
    v_add_f32 v91, v91, v95
    v_add_f32 v91, v91, v94
    v_dot2_f32_bf16 v90, v46, v62, v90
    v_lshlrev_b32 v94, 16, v46
    v_and_b32 v95, 0xffff0000, v46
    v_mul_f32 v94, v94, v84
    v_mul_f32 v95, v95, v85
    v_cvt_pk_bf16_f32 v94, v94, v95
    v_lshlrev_b32 v95, 16, v94
    v_and_b32 v94, 0xffff0000, v94
    v_add_f32 v91, v91, v95
    v_add_f32 v91, v91, v94
    v_dot2_f32_bf16 v90, v47, v63, v90
    v_lshlrev_b32 v94, 16, v47
    v_and_b32 v95, 0xffff0000, v47
    v_mul_f32 v94, v94, v86
    v_mul_f32 v95, v95, v87
    v_cvt_pk_bf16_f32 v94, v94, v95
    v_lshlrev_b32 v95, 16, v94
    v_and_b32 v94, 0xffff0000, v94
    v_add_f32 v91, v91, v95
    v_add_f32 v91, v91, v94
    v_mov_b32 v92, 0
    v_mov_b32 v93, 0
    v_dot2_f32_bf16 v92, v48, v56, v92
    v_lshlrev_b32 v94, 16, v48
    v_and_b32 v95, 0xffff0000, v48
    v_mul_f32 v94, v94, v72
    v_mul_f32 v95, v95, v73
    v_cvt_pk_bf16_f32 v94, v94, v95
    v_lshlrev_b32 v95, 16, v94
    v_and_b32 v94, 0xffff0000, v94
    v_add_f32 v93, v93, v95
    v_add_f32 v93, v93, v94
    v_dot2_f32_bf16 v92, v49, v57, v92
    v_lshlrev_b32 v94, 16, v49
    v_and_b32 v95, 0xffff0000, v49
    v_mul_f32 v94, v94, v74
    v_mul_f32 v95, v95, v75
    v_cvt_pk_bf16_f32 v94, v94, v95
    v_lshlrev_b32 v95, 16, v94
    v_and_b32 v94, 0xffff0000, v94
    v_add_f32 v93, v93, v95
    v_add_f32 v93, v93, v94
    v_dot2_f32_bf16 v92, v50, v58, v92
    s_barrier
    s_bfe_u32 s91, s68, 0x40010
    s_lshl_b32 s92, s91, 7
    s_mul_i32 s93, s91, 393216
    s_add_u32 m0, s94, 40960
    s_nop 0
    buffer_load_dwordx4 v20, s[24:27], s92 offen offset:0 lds
    buffer_load_dwordx4 v21, s[24:27], s92 offen offset:1024 lds
    buffer_load_dwordx4 v22, s[24:27], s92 offen offset:2048 lds
    buffer_load_dwordx4 v23, s[24:27], s92 offen offset:3072 lds
    s_add_u32 m0, s95, 40960
    s_nop 0
    buffer_load_dwordx4 v24, s[28:31], s93 offen offset:0 lds
    buffer_load_dwordx4 v25, s[28:31], s93 offen offset:1024 lds
    buffer_load_dwordx4 v26, s[28:31], s93 offen offset:2048 lds
    s_add_u32 m0, s95, 44032
    s_nop 0
    buffer_load_dwordx4 v27, s[28:31], s93 offen offset:0 lds
    buffer_load_dwordx4 v28, s[28:31], s93 offen offset:1024 lds
    buffer_load_dwordx4 v29, s[28:31], s93 offen offset:2048 lds
    v_lshlrev_b32 v94, 16, v50
    v_and_b32 v95, 0xffff0000, v50
    v_mul_f32 v94, v94, v76
    v_mul_f32 v95, v95, v77
    v_cvt_pk_bf16_f32 v94, v94, v95
    v_lshlrev_b32 v95, 16, v94
    v_and_b32 v94, 0xffff0000, v94
    v_add_f32 v93, v93, v95
    v_add_f32 v93, v93, v94
    v_dot2_f32_bf16 v92, v51, v59, v92
    v_lshlrev_b32 v94, 16, v51
    v_and_b32 v95, 0xffff0000, v51
    v_mul_f32 v94, v94, v78
    v_mul_f32 v95, v95, v79
    v_cvt_pk_bf16_f32 v94, v94, v95
    v_lshlrev_b32 v95, 16, v94
    v_and_b32 v94, 0xffff0000, v94
    v_add_f32 v93, v93, v95
    v_add_f32 v93, v93, v94
    v_dot2_f32_bf16 v92, v52, v60, v92
    v_lshlrev_b32 v94, 16, v52
    v_and_b32 v95, 0xffff0000, v52
    v_mul_f32 v94, v94, v80
    v_mul_f32 v95, v95, v81
    v_cvt_pk_bf16_f32 v94, v94, v95
    v_lshlrev_b32 v95, 16, v94
    v_and_b32 v94, 0xffff0000, v94
    v_add_f32 v93, v93, v95
    v_add_f32 v93, v93, v94
    v_dot2_f32_bf16 v92, v53, v61, v92
    v_lshlrev_b32 v94, 16, v53
    v_and_b32 v95, 0xffff0000, v53
    v_mul_f32 v94, v94, v82
    v_mul_f32 v95, v95, v83
    v_cvt_pk_bf16_f32 v94, v94, v95
    v_lshlrev_b32 v95, 16, v94
    v_and_b32 v94, 0xffff0000, v94
    v_add_f32 v93, v93, v95
    v_add_f32 v93, v93, v94
    v_dot2_f32_bf16 v92, v54, v62, v92
    v_lshlrev_b32 v94, 16, v54
    v_and_b32 v95, 0xffff0000, v54
    v_mul_f32 v94, v94, v84
    v_mul_f32 v95, v95, v85
    v_cvt_pk_bf16_f32 v94, v94, v95
    v_lshlrev_b32 v95, 16, v94
    v_and_b32 v94, 0xffff0000, v94
    v_add_f32 v93, v93, v95
    v_add_f32 v93, v93, v94
    v_dot2_f32_bf16 v92, v55, v63, v92
    v_lshlrev_b32 v94, 16, v55
    v_and_b32 v95, 0xffff0000, v55
    v_mul_f32 v94, v94, v86
    v_mul_f32 v95, v95, v87
    v_cvt_pk_bf16_f32 v94, v94, v95
    v_lshlrev_b32 v95, 16, v94
    v_and_b32 v94, 0xffff0000, v94
    v_add_f32 v93, v93, v95
    v_add_f32 v93, v93, v94
    v_add_f32_dpp v90, v90, v90 row_shr:1 row_mask:0xf bank_mask:0xf
    v_add_f32_dpp v91, v91, v91 row_shr:1 row_mask:0xf bank_mask:0xf
    v_add_f32_dpp v92, v92, v92 row_shr:1 row_mask:0xf bank_mask:0xf
    v_add_f32_dpp v93, v93, v93 row_shr:1 row_mask:0xf bank_mask:0xf
    v_add_f32_dpp v90, v90, v90 row_shr:2 row_mask:0xf bank_mask:0xf
    v_add_f32_dpp v91, v91, v91 row_shr:2 row_mask:0xf bank_mask:0xf
    v_add_f32_dpp v92, v92, v92 row_shr:2 row_mask:0xf bank_mask:0xf
    v_add_f32_dpp v93, v93, v93 row_shr:2 row_mask:0xf bank_mask:0xf
    v_add_f32_dpp v90, v90, v90 row_shr:4 row_mask:0xf bank_mask:0xf
    v_add_f32_dpp v91, v91, v91 row_shr:4 row_mask:0xf bank_mask:0xf
    v_add_f32_dpp v92, v92, v92 row_shr:4 row_mask:0xf bank_mask:0xf
    v_add_f32_dpp v93, v93, v93 row_shr:4 row_mask:0xf bank_mask:0xf
    v_add_f32_dpp v90, v90, v90 row_shr:8 row_mask:0xf bank_mask:0xf
    v_add_f32_dpp v91, v91, v91 row_shr:8 row_mask:0xf bank_mask:0xf
    v_add_f32_dpp v92, v92, v92 row_shr:8 row_mask:0xf bank_mask:0xf
    v_add_f32_dpp v93, v93, v93 row_shr:8 row_mask:0xf bank_mask:0xf
    v_add_f32_dpp v90, v90, v90 row_bcast:15 row_mask:0xa bank_mask:0xf
    v_add_f32_dpp v91, v91, v91 row_bcast:15 row_mask:0xa bank_mask:0xf
    v_add_f32_dpp v92, v92, v92 row_bcast:15 row_mask:0xa bank_mask:0xf
    v_add_f32_dpp v93, v93, v93 row_bcast:15 row_mask:0xa bank_mask:0xf
    v_add_f32_dpp v90, v90, v90 row_bcast:31 row_mask:0xc bank_mask:0xf
    v_add_f32_dpp v91, v91, v91 row_bcast:31 row_mask:0xc bank_mask:0xf
    v_add_f32_dpp v92, v92, v92 row_bcast:31 row_mask:0xc bank_mask:0xf
    v_add_f32_dpp v93, v93, v93 row_bcast:31 row_mask:0xc bank_mask:0xf
    v_cvt_pk_bf16_f32 v94, v90, v91
    v_and_b32 v95, 0xffff, v94
    v_and_b32 v96, 0x8000, v94
    v_cmp_ne_u32 vcc, 0, v96
    v_mov_b32 v97, 0x8000
    v_mov_b32 v98, 0xffff
    v_cndmask_b32 v96, v97, v98, vcc
    v_xor_b32 v95, v95, v96
    s_sub_u32 s12, 2047, s22
    v_lshlrev_b32 v95, 11, v95
    v_or_b32 v100, s12, v95
    v_and_b32 v94, 0xffff0000, v94
    v_mul_f32 v94, 0xbfb8aa3b, v94
    v_exp_f32 v94, v94
    s_nop 0
    v_add_f32 v94, 1.0, v94
    v_rcp_f32 v94, v94
    s_nop 0
    v_cvt_pk_bf16_f32 v94, v94, v94
    v_lshlrev_b32 v102, 16, v94
    v_cvt_pk_bf16_f32 v94, v92, v93
    v_and_b32 v95, 0xffff, v94
    v_and_b32 v96, 0x8000, v94
    v_cmp_ne_u32 vcc, 0, v96
    v_mov_b32 v97, 0x8000
    v_mov_b32 v98, 0xffff
    v_cndmask_b32 v96, v97, v98, vcc
    v_xor_b32 v95, v95, v96
    s_sub_u32 s12, 2046, s22
    v_lshlrev_b32 v95, 11, v95
    v_or_b32 v101, s12, v95
    v_and_b32 v94, 0xffff0000, v94
    v_mul_f32 v94, 0xbfb8aa3b, v94
    v_exp_f32 v94, v94
    s_nop 0
    v_add_f32 v94, 1.0, v94
    v_rcp_f32 v94, v94
    s_nop 0
    v_cvt_pk_bf16_f32 v94, v94, v94
    v_lshlrev_b32 v103, 16, v94
    v_max_u32 v100, v100, v101
    s_lshl_b32 s12, s22, 2
    s_add_u32 s12, s12, 4096
    s_lshl_b32 s13, s21, 2
    s_add_u32 s13, s13, 162880
    v_mov_b32 v14, s13
    s_mov_b32 exec_lo, 0
    s_mov_b32 exec_hi, 0x80000000
    buffer_store_dwordx2 v[102:103], v13, s[32:35], s12 offen sc1
    ds_write_b32 v14, v100
    s_mov_b64 exec, -1
    s_waitcnt lgkmcnt(0)
    buffer_load_dword v15, v13, s[72:75], 0 offen offset:4 sc1
    s_waitcnt vmcnt(12)
    s_barrier
    s_bfe_u32 s91, s68, 0x40014
    s_lshl_b32 s92, s91, 7
    s_mul_i32 s93, s91, 393216
    s_add_u32 m0, s94, 81920
    s_nop 0
    buffer_load_dwordx4 v20, s[24:27], s92 offen offset:0 lds
    buffer_load_dwordx4 v21, s[24:27], s92 offen offset:1024 lds
    buffer_load_dwordx4 v22, s[24:27], s92 offen offset:2048 lds
    buffer_load_dwordx4 v23, s[24:27], s92 offen offset:3072 lds
    s_add_u32 m0, s95, 81920
    s_nop 0
    buffer_load_dwordx4 v24, s[28:31], s93 offen offset:0 lds
    buffer_load_dwordx4 v25, s[28:31], s93 offen offset:1024 lds
    buffer_load_dwordx4 v26, s[28:31], s93 offen offset:2048 lds
    s_add_u32 m0, s95, 84992
    s_nop 0
    buffer_load_dwordx4 v27, s[28:31], s93 offen offset:0 lds
    buffer_load_dwordx4 v28, s[28:31], s93 offen offset:1024 lds
    buffer_load_dwordx4 v29, s[28:31], s93 offen offset:2048 lds
    s_waitcnt vmcnt(12)
    s_barrier
    s_bfe_u32 s91, s68, 0x40018
    s_lshl_b32 s92, s91, 7
    s_mul_i32 s93, s91, 393216
    s_add_u32 m0, s94, 0
    s_nop 0
    buffer_load_dwordx4 v20, s[24:27], s92 offen offset:0 lds
    buffer_load_dwordx4 v21, s[24:27], s92 offen offset:1024 lds
    buffer_load_dwordx4 v22, s[24:27], s92 offen offset:2048 lds
    buffer_load_dwordx4 v23, s[24:27], s92 offen offset:3072 lds
    s_add_u32 m0, s95, 0
    s_nop 0
    buffer_load_dwordx4 v24, s[28:31], s93 offen offset:0 lds
    buffer_load_dwordx4 v25, s[28:31], s93 offen offset:1024 lds
    buffer_load_dwordx4 v26, s[28:31], s93 offen offset:2048 lds
    s_add_u32 m0, s95, 3072
    s_nop 0
    buffer_load_dwordx4 v27, s[28:31], s93 offen offset:0 lds
    buffer_load_dwordx4 v28, s[28:31], s93 offen offset:1024 lds
    buffer_load_dwordx4 v29, s[28:31], s93 offen offset:2048 lds
    s_add_u32 s12, s71, 0
    buffer_load_dwordx4 v[128:131], v30, s[40:43], s12 offen nt
    s_add_u32 s12, s71, 7168
    buffer_load_dwordx4 v[132:135], v30, s[40:43], s12 offen nt
    s_add_u32 s12, s71, 14336
    buffer_load_dwordx4 v[136:139], v30, s[40:43], s12 offen nt
    s_add_u32 s12, s71, 21504
    buffer_load_dwordx4 v[140:143], v30, s[40:43], s12 offen nt
    s_add_u32 s12, s71, 28672
    buffer_load_dwordx4 v[144:147], v30, s[40:43], s12 offen nt
    s_add_u32 s12, s71, 35840
    buffer_load_dwordx4 v[148:151], v30, s[40:43], s12 offen nt
    s_add_u32 s12, s71, 43008
    buffer_load_dwordx4 v[152:155], v30, s[40:43], s12 offen nt
    s_add_u32 s12, s71, 50176
    buffer_load_dwordx4 v[156:159], v30, s[40:43], s12 offen nt
    s_waitcnt vmcnt(28)
    s_mov_b32 s13, 0
L_tagchk_4:
    v_readfirstlane_b32 s23, v15
    s_nop 1
    s_cmp_lg_u32 s23, 0
    s_cbranch_scc1 L_tagok_4
    s_add_u32 s13, s13, 1
    s_cmp_ge_u32 s13, 16384
    s_cbranch_scc1 L_tagok_4
    buffer_load_dword v15, v13, s[72:75], 0 offen offset:4 sc1
    s_waitcnt vmcnt(0)
    s_branch L_tagchk_4
L_tagok_4:
    s_and_b32 s76, s23, 0xff
    s_bfe_u32 s77, s23, 0x80008
    s_bfe_u32 s78, s23, 0x80010
    s_lshr_b32 s79, s23, 24
    v_and_b32 v35, 3, v2
    v_lshlrev_b32 v35, 3, v35
    v_bfe_u32 v35, s23, v35, 8
    s_cmp_lg_u32 s21, 0
    s_cbranch_scc1 L_nopub_4
    v_mov_b32 v14, 162880
    ds_read_b128 v[104:107], v14
    s_lshl_b32 s12, s2, 3
    s_add_u32 s12, s12, 0
    s_waitcnt lgkmcnt(0)
    v_max3_u32 v104, v104, v105, v106
    v_max_u32 v104, v104, v107
    v_mov_b32 v105, s23
    s_mov_b64 exec, 1
    buffer_store_dwordx2 v[104:105], v13, s[32:35], s12 offen sc1
    s_mov_b64 exec, -1
L_nopub_4:
    s_waitcnt vmcnt(18)
    s_barrier
    s_bfe_u32 s91, s68, 0x4001c
    s_lshl_b32 s92, s91, 7
    s_mul_i32 s93, s91, 393216
    s_add_u32 m0, s94, 40960
    s_nop 0
    buffer_load_dwordx4 v20, s[24:27], s92 offen offset:0 lds
    buffer_load_dwordx4 v21, s[24:27], s92 offen offset:1024 lds
    buffer_load_dwordx4 v22, s[24:27], s92 offen offset:2048 lds
    buffer_load_dwordx4 v23, s[24:27], s92 offen offset:3072 lds
    s_add_u32 m0, s95, 40960
    s_nop 0
    buffer_load_dwordx4 v24, s[28:31], s93 offen offset:0 lds
    s_waitcnt vmcnt(13)
    s_barrier
    s_add_u32 m0, s95, 40960
    s_nop 0
    buffer_load_dwordx4 v25, s[28:31], s93 offen offset:1024 lds
    buffer_load_dwordx4 v26, s[28:31], s93 offen offset:2048 lds
    s_add_u32 m0, s95, 44032
    s_nop 0
    buffer_load_dwordx4 v27, s[28:31], s93 offen offset:0 lds
    buffer_load_dwordx4 v28, s[28:31], s93 offen offset:1024 lds
    buffer_load_dwordx4 v29, s[28:31], s93 offen offset:2048 lds
    s_bfe_u32 s91, s69, 0x40000
    s_lshl_b32 s92, s91, 7
    s_mul_i32 s93, s91, 393216
    s_add_u32 m0, s94, 81920
    s_nop 0
    buffer_load_dwordx4 v20, s[24:27], s92 offen offset:0 lds
    buffer_load_dwordx4 v21, s[24:27], s92 offen offset:1024 lds
    buffer_load_dwordx4 v22, s[24:27], s92 offen offset:2048 lds
    buffer_load_dwordx4 v23, s[24:27], s92 offen offset:3072 lds
    s_add_u32 m0, s95, 81920
    s_nop 0
    buffer_load_dwordx4 v24, s[28:31], s93 offen offset:0 lds
    buffer_load_dwordx4 v25, s[28:31], s93 offen offset:1024 lds
    buffer_load_dwordx4 v26, s[28:31], s93 offen offset:2048 lds
    s_waitcnt vmcnt(7)
    s_barrier
    s_add_u32 m0, s95, 84992
    s_nop 0
    buffer_load_dwordx4 v27, s[28:31], s93 offen offset:0 lds
    buffer_load_dwordx4 v28, s[28:31], s93 offen offset:1024 lds
    buffer_load_dwordx4 v29, s[28:31], s93 offen offset:2048 lds
    s_bfe_u32 s91, s69, 0x40004
    s_lshl_b32 s92, s91, 7
    s_mul_i32 s93, s91, 393216
    s_add_u32 m0, s94, 0
    s_nop 0
    buffer_load_dwordx4 v20, s[24:27], s92 offen offset:0 lds
    buffer_load_dwordx4 v21, s[24:27], s92 offen offset:1024 lds
    buffer_load_dwordx4 v22, s[24:27], s92 offen offset:2048 lds
    buffer_load_dwordx4 v23, s[24:27], s92 offen offset:3072 lds
    s_add_u32 m0, s95, 0
    s_nop 0
    buffer_load_dwordx4 v24, s[28:31], s93 offen offset:0 lds
    buffer_load_dwordx4 v25, s[28:31], s93 offen offset:1024 lds
    buffer_load_dwordx4 v26, s[28:31], s93 offen offset:2048 lds
    s_add_u32 m0, s95, 3072
    s_nop 0
    buffer_load_dwordx4 v27, s[28:31], s93 offen offset:0 lds
    buffer_load_dwordx4 v28, s[28:31], s93 offen offset:1024 lds
    s_waitcnt vmcnt(9)
    s_barrier
    s_add_u32 m0, s95, 3072
    s_nop 0
    buffer_load_dwordx4 v29, s[28:31], s93 offen offset:2048 lds
    s_bfe_u32 s91, s69, 0x40008
    s_lshl_b32 s92, s91, 7
    s_mul_i32 s93, s91, 393216
    s_add_u32 m0, s94, 40960
    s_nop 0
    buffer_load_dwordx4 v20, s[24:27], s92 offen offset:0 lds
    buffer_load_dwordx4 v21, s[24:27], s92 offen offset:1024 lds
    buffer_load_dwordx4 v22, s[24:27], s92 offen offset:2048 lds
    buffer_load_dwordx4 v23, s[24:27], s92 offen offset:3072 lds
    s_add_u32 m0, s95, 40960
    s_nop 0
    buffer_load_dwordx4 v24, s[28:31], s93 offen offset:0 lds
    buffer_load_dwordx4 v25, s[28:31], s93 offen offset:1024 lds
    buffer_load_dwordx4 v26, s[28:31], s93 offen offset:2048 lds
    s_add_u32 m0, s95, 44032
    s_nop 0
    buffer_load_dwordx4 v27, s[28:31], s93 offen offset:0 lds
    buffer_load_dwordx4 v28, s[28:31], s93 offen offset:1024 lds
    buffer_load_dwordx4 v29, s[28:31], s93 offen offset:2048 lds
    s_waitcnt vmcnt(10)
    s_barrier
    s_bfe_u32 s91, s69, 0x4000c
    s_lshl_b32 s92, s91, 7
    s_mul_i32 s93, s91, 393216
    s_add_u32 m0, s94, 81920
    s_nop 0
    buffer_load_dwordx4 v20, s[24:27], s92 offen offset:0 lds
    buffer_load_dwordx4 v21, s[24:27], s92 offen offset:1024 lds
    buffer_load_dwordx4 v22, s[24:27], s92 offen offset:2048 lds
    buffer_load_dwordx4 v23, s[24:27], s92 offen offset:3072 lds
    s_add_u32 m0, s95, 81920
    s_nop 0
    buffer_load_dwordx4 v24, s[28:31], s93 offen offset:0 lds
    buffer_load_dwordx4 v25, s[28:31], s93 offen offset:1024 lds
    buffer_load_dwordx4 v26, s[28:31], s93 offen offset:2048 lds
    s_add_u32 m0, s95, 84992
    s_nop 0
    buffer_load_dwordx4 v27, s[28:31], s93 offen offset:0 lds
    buffer_load_dwordx4 v28, s[28:31], s93 offen offset:1024 lds
    buffer_load_dwordx4 v29, s[28:31], s93 offen offset:2048 lds
    s_add_u32 s12, s71, 0
    buffer_load_dwordx4 v[160:163], v30, s[44:47], s12 offen nt
    s_add_u32 s12, s71, 7168
    buffer_load_dwordx4 v[164:167], v30, s[44:47], s12 offen nt
    s_add_u32 s12, s71, 14336
    buffer_load_dwordx4 v[168:171], v30, s[44:47], s12 offen nt
    s_add_u32 s12, s71, 21504
    buffer_load_dwordx4 v[172:175], v30, s[44:47], s12 offen nt
    s_add_u32 s12, s71, 28672
    buffer_load_dwordx4 v[176:179], v30, s[44:47], s12 offen nt
    s_add_u32 s12, s71, 35840
    buffer_load_dwordx4 v[180:183], v30, s[44:47], s12 offen nt
    s_add_u32 s12, s71, 43008
    buffer_load_dwordx4 v[184:187], v30, s[44:47], s12 offen nt
    s_add_u32 s12, s71, 50176
    buffer_load_dwordx4 v[188:191], v30, s[44:47], s12 offen nt
    s_mov_b32 s12, 0
    buffer_load_dwordx4 v[104:107], v5, s[32:35], s12 offen offset:0 sc1
    buffer_load_dwordx4 v[108:111], v5, s[32:35], s12 offen offset:1024 sc1
    s_waitcnt vmcnt(20)
    s_barrier
    s_bfe_u32 s91, s69, 0x40010
    s_lshl_b32 s92, s91, 7
    s_mul_i32 s93, s91, 393216
    s_add_u32 m0, s94, 0
    s_nop 0
    buffer_load_dwordx4 v20, s[24:27], s92 offen offset:0 lds
    buffer_load_dwordx4 v21, s[24:27], s92 offen offset:1024 lds
    buffer_load_dwordx4 v22, s[24:27], s92 offen offset:2048 lds
    buffer_load_dwordx4 v23, s[24:27], s92 offen offset:3072 lds
    s_add_u32 m0, s95, 0
    s_nop 0
    buffer_load_dwordx4 v24, s[28:31], s93 offen offset:0 lds
    s_waitcnt vmcnt(15)
    s_barrier
    s_add_u32 m0, s95, 0
    s_nop 0
    buffer_load_dwordx4 v25, s[28:31], s93 offen offset:1024 lds
    buffer_load_dwordx4 v26, s[28:31], s93 offen offset:2048 lds
    s_add_u32 m0, s95, 3072
    s_nop 0
    buffer_load_dwordx4 v27, s[28:31], s93 offen offset:0 lds
    buffer_load_dwordx4 v28, s[28:31], s93 offen offset:1024 lds
    buffer_load_dwordx4 v29, s[28:31], s93 offen offset:2048 lds
    s_bfe_u32 s91, s69, 0x40014
    s_lshl_b32 s92, s91, 7
    s_mul_i32 s93, s91, 393216
    s_add_u32 m0, s94, 40960
    s_nop 0
    buffer_load_dwordx4 v20, s[24:27], s92 offen offset:0 lds
    buffer_load_dwordx4 v21, s[24:27], s92 offen offset:1024 lds
    buffer_load_dwordx4 v22, s[24:27], s92 offen offset:2048 lds
    buffer_load_dwordx4 v23, s[24:27], s92 offen offset:3072 lds
    s_add_u32 m0, s95, 40960
    s_nop 0
    buffer_load_dwordx4 v24, s[28:31], s93 offen offset:0 lds
    buffer_load_dwordx4 v25, s[28:31], s93 offen offset:1024 lds
    buffer_load_dwordx4 v26, s[28:31], s93 offen offset:2048 lds
    s_waitcnt vmcnt(17)
    s_mov_b32 s13, 0
L_keychk_4:
    v_xor_b32 v105, s23, v105
    v_xor_b32 v107, s23, v107
    v_xor_b32 v109, s23, v109
    v_xor_b32 v111, s23, v111
    v_or3_b32 v105, v105, v107, v109
    v_or_b32 v105, v105, v111
    v_cmp_ne_u32 vcc, 0, v105
    s_cbranch_vccz L_keyok_4
    s_add_u32 s13, s13, 1
    s_cmp_ge_u32 s13, 16384
    s_cbranch_scc1 L_keyok_4
    s_mov_b32 s12, 0
    buffer_load_dwordx4 v[104:107], v5, s[32:35], s12 offen offset:0 sc1
    buffer_load_dwordx4 v[108:111], v5, s[32:35], s12 offen offset:1024 sc1
    s_waitcnt vmcnt(0)
    s_branch L_keychk_4
L_keyok_4:
    v_max3_u32 v104, v104, v106, v108
    v_max_u32 v104, v104, v110
    s_nop 1
    v_max_u32_dpp v104, v104, v104 row_shr:1 row_mask:0xf bank_mask:0xf
    s_nop 1
    v_max_u32_dpp v104, v104, v104 row_shr:2 row_mask:0xf bank_mask:0xf
    s_nop 1
    v_max_u32_dpp v104, v104, v104 row_shr:4 row_mask:0xf bank_mask:0xf
    s_nop 1
    v_max_u32_dpp v104, v104, v104 row_shr:8 row_mask:0xf bank_mask:0xf
    s_nop 1
    v_max_u32_dpp v104, v104, v104 row_bcast:15 row_mask:0xa bank_mask:0xf
    s_nop 1
    v_max_u32_dpp v104, v104, v104 row_bcast:31 row_mask:0xc bank_mask:0xf
    s_nop 0
    v_readlane_b32 s14, v104, 63
    s_nop 1
    s_and_b32 s15, s14, 2047
    s_sub_u32 s15, 2047, s15
    s_lshl_b32 s12, s15, 11
    s_lshl_b32 s13, s70, 1
    s_add_u32 s12, s12, s13
    buffer_load_dwordx4 v[36:39], v34, s[24:27], s12 offen
    s_lshr_b32 s12, s14, 11
    s_and_b32 s13, s12, 0x8000
    s_cmp_lg_u32 s13, 0
    s_mov_b32 s13, 0xffff
    s_cselect_b32 s13, 0x8000, s13
    s_xor_b32 s12, s12, s13
    s_lshl_b32 s12, s12, 16
    v_mov_b32 v105, s12
    v_mul_f32 v105, 0xbfb8aa3b, v105
    v_exp_f32 v105, v105
    s_nop 0
    v_add_f32 v105, 1.0, v105
    v_rcp_f32 v105, v105
    s_nop 0
    v_cvt_pk_bf16_f32 v105, v105, v105
    v_lshlrev_b32 v105, 16, v105
    s_nop 0
    v_readfirstlane_b32 s14, v105
    s_add_u32 s12, s15, 1
    v_mov_b32 v104, s12
    v_mov_b32 v106, s23
    v_mov_b32 v14, 162864
    s_mov_b64 exec, 1
    ds_write_b96 v14, v[104:106]
    s_mov_b64 exec, -1
    s_waitcnt lgkmcnt(0)
    s_waitcnt vmcnt(8)
    s_barrier
    s_add_u32 m0, s95, 44032
    s_nop 0
    buffer_load_dwordx4 v27, s[28:31], s93 offen offset:0 lds
    buffer_load_dwordx4 v28, s[28:31], s93 offen offset:1024 lds
    buffer_load_dwordx4 v29, s[28:31], s93 offen offset:2048 lds
    s_bfe_u32 s91, s69, 0x40018
    s_lshl_b32 s92, s91, 7
    s_mul_i32 s93, s91, 393216
    s_add_u32 m0, s94, 81920
    s_nop 0
    buffer_load_dwordx4 v20, s[24:27], s92 offen offset:0 lds
    buffer_load_dwordx4 v21, s[24:27], s92 offen offset:1024 lds
    buffer_load_dwordx4 v22, s[24:27], s92 offen offset:2048 lds
    buffer_load_dwordx4 v23, s[24:27], s92 offen offset:3072 lds
    s_add_u32 m0, s95, 81920
    s_nop 0
    buffer_load_dwordx4 v24, s[28:31], s93 offen offset:0 lds
    buffer_load_dwordx4 v25, s[28:31], s93 offen offset:1024 lds
    buffer_load_dwordx4 v26, s[28:31], s93 offen offset:2048 lds
    s_add_u32 m0, s95, 84992
    s_nop 0
    buffer_load_dwordx4 v27, s[28:31], s93 offen offset:0 lds
    buffer_load_dwordx4 v28, s[28:31], s93 offen offset:1024 lds
    s_waitcnt vmcnt(12)
    v_and_b32 v40, 0xffff, v36
    v_lshlrev_b32 v41, 16, v36
    v_lshrrev_b32 v42, 16, v36
    v_and_b32 v43, 0xffff0000, v36
    v_and_b32 v44, 0xffff, v37
    v_lshlrev_b32 v45, 16, v37
    v_lshrrev_b32 v46, 16, v37
    v_and_b32 v47, 0xffff0000, v37
    v_and_b32 v48, 0xffff, v38
    v_lshlrev_b32 v49, 16, v38
    v_lshrrev_b32 v50, 16, v38
    v_and_b32 v51, 0xffff0000, v38
    v_and_b32 v52, 0xffff, v39
    v_lshlrev_b32 v53, 16, v39
    v_lshrrev_b32 v54, 16, v39
    v_and_b32 v55, 0xffff0000, v39
    v_dot2_f32_bf16 v220, v128, v40, 0
    v_dot2_f32_bf16 v221, v128, v41, 0
    v_dot2_f32_bf16 v222, v129, v40, 0
    v_dot2_f32_bf16 v223, v129, v41, 0
    v_dot2_f32_bf16 v224, v130, v40, 0
    v_dot2_f32_bf16 v225, v130, v41, 0
    v_dot2_f32_bf16 v226, v131, v40, 0
    v_dot2_f32_bf16 v227, v131, v41, 0
    v_dot2_f32_bf16 v228, v160, v40, 0
    v_dot2_f32_bf16 v229, v160, v41, 0
    v_dot2_f32_bf16 v230, v161, v40, 0
    v_dot2_f32_bf16 v231, v161, v41, 0
    v_dot2_f32_bf16 v232, v162, v40, 0
    v_dot2_f32_bf16 v233, v162, v41, 0
    v_dot2_f32_bf16 v234, v163, v40, 0
    v_dot2_f32_bf16 v235, v163, v41, 0
    v_dot2_f32_bf16 v220, v132, v42, v220
    v_dot2_f32_bf16 v221, v132, v43, v221
    v_dot2_f32_bf16 v222, v133, v42, v222
    v_dot2_f32_bf16 v223, v133, v43, v223
    v_dot2_f32_bf16 v224, v134, v42, v224
    v_dot2_f32_bf16 v225, v134, v43, v225
    v_dot2_f32_bf16 v226, v135, v42, v226
    v_dot2_f32_bf16 v227, v135, v43, v227
    v_dot2_f32_bf16 v228, v164, v42, v228
    v_dot2_f32_bf16 v229, v164, v43, v229
    v_dot2_f32_bf16 v230, v165, v42, v230
    v_dot2_f32_bf16 v231, v165, v43, v231
    v_dot2_f32_bf16 v232, v166, v42, v232
    v_dot2_f32_bf16 v233, v166, v43, v233
    v_dot2_f32_bf16 v234, v167, v42, v234
    v_dot2_f32_bf16 v235, v167, v43, v235
    v_dot2_f32_bf16 v220, v136, v44, v220
    v_dot2_f32_bf16 v221, v136, v45, v221
    v_dot2_f32_bf16 v222, v137, v44, v222
    v_dot2_f32_bf16 v223, v137, v45, v223
    v_dot2_f32_bf16 v224, v138, v44, v224
    v_dot2_f32_bf16 v225, v138, v45, v225
    v_dot2_f32_bf16 v226, v139, v44, v226
    v_dot2_f32_bf16 v227, v139, v45, v227
    v_dot2_f32_bf16 v228, v168, v44, v228
    v_dot2_f32_bf16 v229, v168, v45, v229
    s_waitcnt vmcnt(9)
    s_barrier
    s_add_u32 m0, s95, 84992
    s_nop 0
    buffer_load_dwordx4 v29, s[28:31], s93 offen offset:2048 lds
    s_bfe_u32 s91, s69, 0x4001c
    s_lshl_b32 s92, s91, 7
    s_mul_i32 s93, s91, 393216
    s_add_u32 m0, s94, 0
    s_nop 0
    buffer_load_dwordx4 v20, s[24:27], s92 offen offset:0 lds
    buffer_load_dwordx4 v21, s[24:27], s92 offen offset:1024 lds
    buffer_load_dwordx4 v22, s[24:27], s92 offen offset:2048 lds
    buffer_load_dwordx4 v23, s[24:27], s92 offen offset:3072 lds
    s_add_u32 m0, s95, 0
    s_nop 0
    buffer_load_dwordx4 v24, s[28:31], s93 offen offset:0 lds
    buffer_load_dwordx4 v25, s[28:31], s93 offen offset:1024 lds
    buffer_load_dwordx4 v26, s[28:31], s93 offen offset:2048 lds
    s_add_u32 m0, s95, 3072
    s_nop 0
    buffer_load_dwordx4 v27, s[28:31], s93 offen offset:0 lds
    buffer_load_dwordx4 v28, s[28:31], s93 offen offset:1024 lds
    buffer_load_dwordx4 v29, s[28:31], s93 offen offset:2048 lds
    v_dot2_f32_bf16 v230, v169, v44, v230
    v_dot2_f32_bf16 v231, v169, v45, v231
    v_dot2_f32_bf16 v232, v170, v44, v232
    v_dot2_f32_bf16 v233, v170, v45, v233
    v_dot2_f32_bf16 v234, v171, v44, v234
    v_dot2_f32_bf16 v235, v171, v45, v235
    v_dot2_f32_bf16 v220, v140, v46, v220
    v_dot2_f32_bf16 v221, v140, v47, v221
    v_dot2_f32_bf16 v222, v141, v46, v222
    v_dot2_f32_bf16 v223, v141, v47, v223
    v_dot2_f32_bf16 v224, v142, v46, v224
    v_dot2_f32_bf16 v225, v142, v47, v225
    v_dot2_f32_bf16 v226, v143, v46, v226
    v_dot2_f32_bf16 v227, v143, v47, v227
    v_dot2_f32_bf16 v228, v172, v46, v228
    v_dot2_f32_bf16 v229, v172, v47, v229
    v_dot2_f32_bf16 v230, v173, v46, v230
    v_dot2_f32_bf16 v231, v173, v47, v231
    v_dot2_f32_bf16 v232, v174, v46, v232
    v_dot2_f32_bf16 v233, v174, v47, v233
    v_dot2_f32_bf16 v234, v175, v46, v234
    v_dot2_f32_bf16 v235, v175, v47, v235
    v_dot2_f32_bf16 v220, v144, v48, v220
    v_dot2_f32_bf16 v221, v144, v49, v221
    v_dot2_f32_bf16 v222, v145, v48, v222
    v_dot2_f32_bf16 v223, v145, v49, v223
    v_dot2_f32_bf16 v224, v146, v48, v224
    v_dot2_f32_bf16 v225, v146, v49, v225
    v_dot2_f32_bf16 v226, v147, v48, v226
    v_dot2_f32_bf16 v227, v147, v49, v227
    v_dot2_f32_bf16 v228, v176, v48, v228
    v_dot2_f32_bf16 v229, v176, v49, v229
    v_dot2_f32_bf16 v230, v177, v48, v230
    v_dot2_f32_bf16 v231, v177, v49, v231
    v_dot2_f32_bf16 v232, v178, v48, v232
    v_dot2_f32_bf16 v233, v178, v49, v233
    v_dot2_f32_bf16 v234, v179, v48, v234
    v_dot2_f32_bf16 v235, v179, v49, v235
    v_dot2_f32_bf16 v220, v148, v50, v220
    v_dot2_f32_bf16 v221, v148, v51, v221
    v_dot2_f32_bf16 v222, v149, v50, v222
    v_dot2_f32_bf16 v223, v149, v51, v223
    v_dot2_f32_bf16 v224, v150, v50, v224
    v_dot2_f32_bf16 v225, v150, v51, v225
    v_dot2_f32_bf16 v226, v151, v50, v226
    v_dot2_f32_bf16 v227, v151, v51, v227
    v_dot2_f32_bf16 v228, v180, v50, v228
    v_dot2_f32_bf16 v229, v180, v51, v229
    v_dot2_f32_bf16 v230, v181, v50, v230
    v_dot2_f32_bf16 v231, v181, v51, v231
    v_dot2_f32_bf16 v232, v182, v50, v232
    v_dot2_f32_bf16 v233, v182, v51, v233
    v_dot2_f32_bf16 v234, v183, v50, v234
    v_dot2_f32_bf16 v235, v183, v51, v235
    v_dot2_f32_bf16 v220, v152, v52, v220
    v_dot2_f32_bf16 v221, v152, v53, v221
    v_dot2_f32_bf16 v222, v153, v52, v222
    v_dot2_f32_bf16 v223, v153, v53, v223
    s_waitcnt vmcnt(10)
    s_barrier
    s_add_u32 s12, s97, 0
    buffer_load_dwordx4 v[192:195], v31, s[64:67], s12 offen nt
    s_add_u32 s12, s97, 16384
    buffer_load_dwordx4 v[196:199], v31, s[64:67], s12 offen nt
    s_add_u32 s12, s97, 32768
    buffer_load_dwordx4 v[200:203], v31, s[64:67], s12 offen nt
    s_add_u32 s12, s97, 49152
    buffer_load_dwordx4 v[204:207], v31, s[64:67], s12 offen nt
    s_add_u32 s12, s97, 65536
    buffer_load_dwordx4 v[208:211], v31, s[64:67], s12 offen nt
    s_add_u32 s12, s97, 81920
    buffer_load_dwordx4 v[212:215], v31, s[64:67], s12 offen nt
    s_add_u32 s12, s97, 98304
    buffer_load_dwordx4 v[216:219], v31, s[64:67], s12 offen nt
    s_mul_i32 s12, s21, 8
    s_add_u32 s12, s12, 96
    s_lshl_b32 s13, s12, 10
    s_lshl_b32 s12, s12, 14
    s_add_u32 m0, s13, 24576
    s_add_u32 s90, s12, 0
    buffer_load_dwordx4 v33, s[36:39], s90 offen lds
    s_add_u32 m0, s13, 25600
    s_add_u32 s90, s12, 16384
    buffer_load_dwordx4 v33, s[36:39], s90 offen lds
    s_add_u32 m0, s13, 26624
    s_add_u32 s90, s12, 32768
    buffer_load_dwordx4 v33, s[36:39], s90 offen lds
    s_add_u32 m0, s13, 27648
    s_add_u32 s90, s12, 49152
    buffer_load_dwordx4 v33, s[36:39], s90 offen lds
    s_add_u32 m0, s13, 28672
    s_add_u32 s90, s12, 65536
    buffer_load_dwordx4 v33, s[36:39], s90 offen lds
    s_add_u32 m0, s13, 29696
    s_add_u32 s90, s12, 81920
    buffer_load_dwordx4 v33, s[36:39], s90 offen lds
    s_add_u32 m0, s13, 30720
    s_add_u32 s90, s12, 98304
    buffer_load_dwordx4 v33, s[36:39], s90 offen lds
    s_add_u32 m0, s13, 31744
    s_add_u32 s90, s12, 114688
    buffer_load_dwordx4 v33, s[36:39], s90 offen lds
    v_dot2_f32_bf16 v224, v154, v52, v224
    v_dot2_f32_bf16 v225, v154, v53, v225
    v_dot2_f32_bf16 v226, v155, v52, v226
    v_dot2_f32_bf16 v227, v155, v53, v227
    v_dot2_f32_bf16 v228, v184, v52, v228
    v_dot2_f32_bf16 v229, v184, v53, v229
    v_dot2_f32_bf16 v230, v185, v52, v230
    v_dot2_f32_bf16 v231, v185, v53, v231
    v_dot2_f32_bf16 v232, v186, v52, v232
    v_dot2_f32_bf16 v233, v186, v53, v233
    v_dot2_f32_bf16 v234, v187, v52, v234
    v_dot2_f32_bf16 v235, v187, v53, v235
    v_dot2_f32_bf16 v220, v156, v54, v220
    v_dot2_f32_bf16 v221, v156, v55, v221
    v_dot2_f32_bf16 v222, v157, v54, v222
    v_dot2_f32_bf16 v223, v157, v55, v223
    v_dot2_f32_bf16 v224, v158, v54, v224
    v_dot2_f32_bf16 v225, v158, v55, v225
    v_dot2_f32_bf16 v226, v159, v54, v226
    v_dot2_f32_bf16 v227, v159, v55, v227
    v_dot2_f32_bf16 v228, v188, v54, v228
    v_dot2_f32_bf16 v229, v188, v55, v229
    v_dot2_f32_bf16 v230, v189, v54, v230
    v_dot2_f32_bf16 v231, v189, v55, v231
    v_dot2_f32_bf16 v232, v190, v54, v232
    v_dot2_f32_bf16 v233, v190, v55, v233
    v_dot2_f32_bf16 v234, v191, v54, v234
    v_dot2_f32_bf16 v235, v191, v55, v235
    v_permlane32_swap_b32 v220, v228
    v_permlane32_swap_b32 v221, v229
    v_permlane32_swap_b32 v222, v230
    v_permlane32_swap_b32 v223, v231
    v_permlane32_swap_b32 v224, v232
    v_permlane32_swap_b32 v225, v233
    v_permlane32_swap_b32 v226, v234
    v_permlane32_swap_b32 v227, v235
    v_add_f32 v220, v220, v228
    v_add_f32 v221, v221, v229
    v_add_f32 v222, v222, v230
    v_add_f32 v223, v223, v231
    v_add_f32 v224, v224, v232
    v_add_f32 v225, v225, v233
    v_add_f32 v226, v226, v234
    v_add_f32 v227, v227, v235
    v_permlane16_swap_b32 v220, v224
    v_permlane16_swap_b32 v221, v225
    v_permlane16_swap_b32 v222, v226
    v_permlane16_swap_b32 v223, v227
    v_add_f32 v220, v220, v224
    v_add_f32 v221, v221, v225
    v_add_f32 v222, v222, v226
    v_add_f32 v223, v223, v227
    v_add_f32_dpp v220, v220, v220 row_ror:8 row_mask:0xf bank_mask:0xf
    v_add_f32_dpp v221, v221, v221 row_ror:8 row_mask:0xf bank_mask:0xf
    v_add_f32_dpp v222, v222, v222 row_ror:8 row_mask:0xf bank_mask:0xf
    v_add_f32_dpp v223, v223, v223 row_ror:8 row_mask:0xf bank_mask:0xf
    s_waitcnt vmcnt(15)
    s_barrier
L_varend:
    s_nop 0
    v_lshrrev_b32 v14, 5, v2
    v_lshlrev_b32 v14, 8, v14
    v_lshl_add_u32 v14, v6, 5, v14
    v_and_b32 v16, 16, v2
    v_add_u32 v14, v14, v16
    s_lshl_b32 s12, s21, 9
    s_add_u32 s12, s12, 159744
    v_add_u32 v14, s12, v14
    ds_write_b128 v14, v[220:223]
    v_mov_b32 v14, 162848
    v_mov_b32 v16, 1
    s_mov_b64 exec, 1
    ds_add_rtn_u32 v17, v14, v16
    s_mov_b64 exec, -1
    s_waitcnt lgkmcnt(0)
    v_readfirstlane_b32 s12, v17
    s_nop 1
    s_cmp_lg_u32 s12, 3
    s_cbranch_scc1 L_nogu
    s_cmp_ge_u32 s2, 224
    s_cbranch_scc1 L_nogu
    v_lshlrev_b32 v14, 2, v2
    v_add_u32 v14, 159744, v14
    ds_read2st64_b32 v[220:221], v14 offset0:0 offset1:1
    ds_read2st64_b32 v[222:223], v14 offset0:2 offset1:3
    ds_read2st64_b32 v[224:225], v14 offset0:4 offset1:5
    ds_read2st64_b32 v[226:227], v14 offset0:6 offset1:7
    s_and_b32 s12, s2, 3
    s_mul_i32 s12, s12, 28672
    s_lshr_b32 s13, s2, 2
    s_lshl_b32 s13, s13, 9
    s_add_u32 s12, s12, s13
    s_add_u32 s12, s12, 327680
    v_lshlrev_b32 v14, 3, v2
    v_and_b32 v16, 1, v2
    v_lshlrev_b32 v16, 4, v16
    v_lshrrev_b32 v16, v16, s23
    v_bfe_u32 v17, v16, 8, 8
    v_and_b32 v16, 0xff, v16
    s_mov_b32 s13, 0xffffff00
    s_waitcnt lgkmcnt(0)
    v_pk_add_f32 v[220:221], v[220:221], v[222:223]
    v_pk_add_f32 v[224:225], v[224:225], v[226:227]
    v_pk_add_f32 v[220:221], v[220:221], v[224:225]
    v_and_or_b32 v220, v220, s13, v16
    v_and_or_b32 v221, v221, s13, v17
    buffer_store_dwordx2 v[220:221], v14, s[32:35], s12 offen sc1
L_nogu:
    s_mul_i32 s12, s21, 4
    s_add_u32 s12, s12, 40
    s_lshl_b32 s13, s12, 10
    s_lshl_b32 s12, s12, 14
    s_add_u32 m0, s13, 24576
    s_add_u32 s90, s12, 0
    buffer_load_dwordx4 v33, s[36:39], s90 offen lds
    s_add_u32 m0, s13, 25600
    s_add_u32 s90, s12, 16384
    buffer_load_dwordx4 v33, s[36:39], s90 offen lds
    s_add_u32 m0, s13, 26624
    s_add_u32 s90, s12, 32768
    buffer_load_dwordx4 v33, s[36:39], s90 offen lds
    s_add_u32 m0, s13, 27648
    s_add_u32 s90, s12, 49152
    buffer_load_dwordx4 v33, s[36:39], s90 offen lds
    s_mul_i32 s12, s21, 10
    s_add_u32 s12, s12, 56
    s_lshl_b32 s13, s12, 10
    s_lshl_b32 s12, s12, 14
    s_add_u32 m0, s13, 24576
    s_add_u32 s90, s12, 0
    buffer_load_dwordx4 v33, s[36:39], s90 offen lds
    s_add_u32 m0, s13, 25600
    s_add_u32 s90, s12, 16384
    buffer_load_dwordx4 v33, s[36:39], s90 offen lds
    s_add_u32 m0, s13, 26624
    s_add_u32 s90, s12, 32768
    buffer_load_dwordx4 v33, s[36:39], s90 offen lds
    s_add_u32 m0, s13, 27648
    s_add_u32 s90, s12, 49152
    buffer_load_dwordx4 v33, s[36:39], s90 offen lds
    s_add_u32 m0, s13, 28672
    s_add_u32 s90, s12, 65536
    buffer_load_dwordx4 v33, s[36:39], s90 offen lds
    s_add_u32 m0, s13, 29696
    s_add_u32 s90, s12, 81920
    buffer_load_dwordx4 v33, s[36:39], s90 offen lds
    s_add_u32 m0, s13, 30720
    s_add_u32 s90, s12, 98304
    buffer_load_dwordx4 v33, s[36:39], s90 offen lds
    s_add_u32 m0, s13, 31744
    s_add_u32 s90, s12, 114688
    buffer_load_dwordx4 v33, s[36:39], s90 offen lds
    s_add_u32 m0, s13, 32768
    s_add_u32 s90, s12, 131072
    buffer_load_dwordx4 v33, s[36:39], s90 offen lds
    s_add_u32 m0, s13, 33792
    s_add_u32 s90, s12, 147456
    buffer_load_dwordx4 v33, s[36:39], s90 offen lds
    v_mov_b32 v14, 162816
    s_mov_b32 s13, 0
L_dspin_g:
    ds_read_b128 v[104:107], v14
    s_add_u32 s13, s13, 1
    s_cmp_ge_u32 s13, 262144
    s_cbranch_scc1 L_dok_g
    s_waitcnt lgkmcnt(0)
    v_and_b32 v104, v104, v105
    v_and_b32 v106, v106, v107
    v_and_b32 v104, v104, v106
    v_cmp_eq_u32 vcc, 1, v104
    s_cbranch_vccz L_dspin_g
L_dok_g:
    s_waitcnt lgkmcnt(0)
    s_mul_i32 s12, s21, 10
    s_add_u32 s12, s12, 0
    s_lshl_b32 s13, s12, 10
    s_lshl_b32 s12, s12, 14
    s_add_u32 m0, s13, 0
    s_add_u32 s90, s12, 0
    buffer_load_dwordx4 v33, s[36:39], s90 offen lds
    s_add_u32 m0, s13, 1024
    s_add_u32 s90, s12, 16384
    buffer_load_dwordx4 v33, s[36:39], s90 offen lds
    s_add_u32 m0, s13, 2048
    s_add_u32 s90, s12, 32768
    buffer_load_dwordx4 v33, s[36:39], s90 offen lds
    s_add_u32 m0, s13, 3072
    s_add_u32 s90, s12, 49152
    buffer_load_dwordx4 v33, s[36:39], s90 offen lds
    s_add_u32 m0, s13, 4096
    s_add_u32 s90, s12, 65536
    buffer_load_dwordx4 v33, s[36:39], s90 offen lds
    s_add_u32 m0, s13, 5120
    s_add_u32 s90, s12, 81920
    buffer_load_dwordx4 v33, s[36:39], s90 offen lds
    s_add_u32 m0, s13, 6144
    s_add_u32 s90, s12, 98304
    buffer_load_dwordx4 v33, s[36:39], s90 offen lds
    s_add_u32 m0, s13, 7168
    s_add_u32 s90, s12, 114688
    buffer_load_dwordx4 v33, s[36:39], s90 offen lds
    s_add_u32 m0, s13, 8192
    s_add_u32 s90, s12, 131072
    buffer_load_dwordx4 v33, s[36:39], s90 offen lds
    s_add_u32 m0, s13, 9216
    s_add_u32 s90, s12, 147456
    buffer_load_dwordx4 v33, s[36:39], s90 offen lds
    v_mov_b32 v62, v6
    v_mov_b32 v63, v35
    s_mov_b32 s86, s96
    s_mov_b32 s4, s15
    s_mov_b32 s5, s14
    v_mov_b32 v61, v33
    s_mov_b32 s68, s58
    s_and_b32 s69, s59, 0xffff
    s_mov_b32 s70, 4194304
    s_mov_b32 s71, 0x00020000
    s_and_b32 s90, s20, 3
    s_lshr_b32 s91, s20, 2
    s_lshl_b32 s12, s88, 3
    s_lshl_b32 s13, s90, 1
    s_add_u32 s12, s12, s13
    s_add_u32 s92, s12, s91
    s_lshl_b32 s12, s92, 4
    v_and_b32 v3, 15, v2
    v_add_u32 v6, s12, v3
    v_lshlrev_b32 v8, 2, v6
    v_bfe_u32 v9, v2, 4, 1
    v_lshrrev_b32 v10, 5, v2
    v_lshlrev_b32 v7, 11, v6
    v_lshl_add_u32 v7, v9, 6, v7
    v_lshl_add_u32 v7, v10, 4, v7
    s_lshl_b32 s12, s89, 7
    v_add_u32 v7, s12, v7
    s_mov_b32 s12, 4096
    buffer_load_dwordx4 v[24:27], v7, s[24:27], 0 offen
    buffer_load_dwordx4 v[28:31], v7, s[24:27], 0 offen offset:32
    buffer_load_dword v48, v8, s[32:35], s12 offen sc1
    v_lshlrev_b32 v22, 8, v3
    v_lshl_add_u32 v22, v9, 7, v22
    v_lshl_add_u32 v22, v10, 5, v22
    v_lshlrev_b32 v10, 9, v10
    v_bfe_u32 v11, v2, 2, 2
    v_lshl_add_u32 v10, v11, 7, v10
    v_bfe_u32 v11, v2, 3, 1
    v_lshl_add_u32 v10, v11, 6, v10
    v_lshl_add_u32 v10, v9, 5, v10
    v_and_b32 v11, 3, v2
    v_lshl_add_u32 v10, v11, 3, v10
    v_xor_b32 v11, 64, v10
    s_lshl_b32 s12, s91, 8
    v_xor_b32 v17, s12, v5
    v_lshlrev_b32 v8, 2, v3
    s_lshl_b32 s12, s20, 12
    s_mov_b32 s15, 40960
    s_cmp_lt_u32 s20, 6
    s_cselect_b32 s13, s15, 131072
    s_add_u32 s12, s12, s13
    v_add_u32 v20, s12, v5
    s_xor_b32 s14, s20, 4
    s_lshl_b32 s12, s14, 12
    s_cmp_lt_u32 s14, 6
    s_cselect_b32 s13, s15, 131072
    s_add_u32 s12, s12, s13
    v_add_u32 v21, s12, v5
    s_lshl_b32 s12, s88, 2
    s_add_u32 s12, s12, s90
    s_lshl_b32 s13, s12, 16
    s_lshl_b32 s14, s91, 15
    s_add_u32 s13, s13, s14
    s_add_u32 s95, s13, 8388608
    s_lshl_b32 s12, s88, 12
    s_lshl_b32 s13, s89, 8
    s_mul_i32 s13, s13, 1
    s_add_u32 s12, s12, s13
    s_lshr_b32 s13, s90, 1
    s_lshl_b32 s13, s13, 7
    s_add_u32 s12, s12, s13
    s_lshl_b32 s13, s91, 6
    s_add_u32 s12, s12, s13
    s_add_u32 s15, s12, 524288
    s_lshl_b32 s97, s91, 4
    v_lshlrev_b32 v8, 7, v3
    s_lshl_b32 s12, s88, 1
    s_lshr_b32 s13, s90, 1
    s_add_u32 s12, s12, s13
    s_lshl_b32 s12, s12, 12
    s_lshl_b32 s13, s91, 11
    s_add_u32 s12, s12, s13
    s_and_b32 s13, s89, 0
    s_lshl_b32 s13, s13, 17
    s_add_u32 s12, s12, s13
    s_add_u32 s15, s12, 6291456
    s_mov_b32 s93, s89
    s_cmp_lg_u32 s21, 0
    s_cbranch_scc0 L_hop
    s_waitcnt vmcnt(0)
    v_sub_f32 v50, 1.0, v48
    v_cvt_pk_bf16_f32 v50, v50, v50
    v_lshlrev_b32 v50, 16, v50
    v_lshlrev_b32 v32, 16, v24
    v_and_b32 v33, 0xffff0000, v24
    v_lshlrev_b32 v34, 16, v25
    v_and_b32 v35, 0xffff0000, v25
    v_lshlrev_b32 v36, 16, v26
    v_and_b32 v37, 0xffff0000, v26
    v_lshlrev_b32 v38, 16, v27
    v_and_b32 v39, 0xffff0000, v27
    v_lshlrev_b32 v40, 16, v28
    v_and_b32 v41, 0xffff0000, v28
    v_lshlrev_b32 v42, 16, v29
    v_and_b32 v43, 0xffff0000, v29
    v_lshlrev_b32 v44, 16, v30
    v_and_b32 v45, 0xffff0000, v30
    v_lshlrev_b32 v46, 16, v31
    v_and_b32 v47, 0xffff0000, v31
    v_pk_mul_f32 v[32:33], v[32:33], v[50:51] op_sel_hi:[1,0]
    v_pk_mul_f32 v[34:35], v[34:35], v[50:51] op_sel_hi:[1,0]
    v_pk_mul_f32 v[36:37], v[36:37], v[50:51] op_sel_hi:[1,0]
    v_pk_mul_f32 v[38:39], v[38:39], v[50:51] op_sel_hi:[1,0]
    v_pk_mul_f32 v[40:41], v[40:41], v[50:51] op_sel_hi:[1,0]
    v_pk_mul_f32 v[42:43], v[42:43], v[50:51] op_sel_hi:[1,0]
    v_pk_mul_f32 v[44:45], v[44:45], v[50:51] op_sel_hi:[1,0]
    v_pk_mul_f32 v[46:47], v[46:47], v[50:51] op_sel_hi:[1,0]
    v_cvt_pk_bf16_f32 v33, v32, v33
    v_cvt_pk_bf16_f32 v35, v34, v35
    v_cvt_pk_bf16_f32 v37, v36, v37
    v_cvt_pk_bf16_f32 v39, v38, v39
    v_cvt_pk_bf16_f32 v41, v40, v41
    v_cvt_pk_bf16_f32 v43, v42, v43
    v_cvt_pk_bf16_f32 v45, v44, v45
    v_cvt_pk_bf16_f32 v47, v46, v47
    v_lshlrev_b32 v32, 16, v33
    v_and_b32 v33, 0xffff0000, v33
    v_lshlrev_b32 v34, 16, v35
    v_and_b32 v35, 0xffff0000, v35
    v_lshlrev_b32 v36, 16, v37
    v_and_b32 v37, 0xffff0000, v37
    v_lshlrev_b32 v38, 16, v39
    v_and_b32 v39, 0xffff0000, v39
    v_lshlrev_b32 v40, 16, v41
    v_and_b32 v41, 0xffff0000, v41
    v_lshlrev_b32 v42, 16, v43
    v_and_b32 v43, 0xffff0000, v43
    v_lshlrev_b32 v44, 16, v45
    v_and_b32 v45, 0xffff0000, v45
    v_lshlrev_b32 v46, 16, v47
    v_and_b32 v47, 0xffff0000, v47
    v_mov_b32 v78, 162928
    s_mov_b32 s13, 0
L_gtu:
    ds_read_b128 v[104:107], v78
    s_add_u32 s13, s13, 1
    s_cmp_ge_u32 s13, 262144
    s_cbranch_scc1 L_gxu
    s_waitcnt lgkmcnt(0)
    v_and_b32 v104, v104, v105
    v_and_b32 v106, v106, v107
    v_and_b32 v104, v104, v106
    v_cmp_eq_u32 vcc, 1, v104
    s_cbranch_vccz L_gtu
L_gxu:
    s_waitcnt lgkmcnt(0)
    s_branch L_nohop
L_hop:
    v_mov_b32 v78, 162928
    s_mov_b32 s13, 0
L_gth:
    ds_read_b128 v[104:107], v78
    s_add_u32 s13, s13, 1
    s_cmp_ge_u32 s13, 262144
    s_cbranch_scc1 L_gxh
    s_waitcnt lgkmcnt(0)
    v_and_b32 v104, v104, v105
    v_and_b32 v106, v106, v107
    v_and_b32 v104, v104, v106
    v_cmp_eq_u32 vcc, 1, v104
    s_cbranch_vccz L_gth
L_gxh:
    s_waitcnt lgkmcnt(0)
    s_lshl_b32 s12, s19, 18
    s_lshl_b32 s13, s18, 14
    s_add_u32 s12, s12, s13
    s_add_u32 s80, s12, 1048576
    s_add_u32 s81, s80, 4096
    s_add_u32 s82, s80, 8192
    s_add_u32 s83, s80, 12288
    s_mov_b32 s13, 0
    s_lshl_b32 s12, s19, 13
    s_lshr_b32 s84, s18, 2
    s_lshl_b32 s84, s84, 11
    s_add_u32 s12, s12, s84
    s_bfe_u32 s84, s18, 0x10001
    s_lshl_b32 s84, s84, 6
    s_add_u32 s12, s12, s84
    s_and_b32 s84, s18, 1
    s_lshl_b32 s84, s84, 4
    s_add_u32 s12, s12, s84
    s_add_u32 s84, s12, 5242880
    v_and_b32 v80, 15, v2
    v_lshlrev_b32 v80, 7, v80
    v_lshrrev_b32 v78, 5, v2
    v_lshl_add_u32 v80, v78, 5, v80
    s_mov_b32 s87, 0
    s_mov_b32 s85, 0xffff
L_h1:
    buffer_load_dwordx4 v[104:107], v80, s[32:35], s84 offen sc1
    s_add_u32 s13, s13, 1
    s_cmp_ge_u32 s13, 16384
    s_cbranch_scc1 L_h1ok
    s_cmp_lg_u32 s87, 0
    s_cbranch_scc1 L_h1d
    s_waitcnt vmcnt(0)
    v_msad_u8 v108, v104, s76, 0
    v_msad_u8 v108, v105, s77, v108
    v_msad_u8 v108, v106, s78, v108
    v_msad_u8 v108, v107, s79, v108
    v_cmp_ne_u32 vcc, 0, v108
    s_nop 1
    s_or_b32 s12, vcc_lo, vcc_hi
    s_and_b32 s12, s12, 0xffff
    s_bcnt1_i32_b32 s12, s12
    s_cmp_le_u32 s12, 6
    s_cselect_b32 s87, 1, 0
    s_branch L_h1
L_h1d:
    s_bitcmp1_b32 s85, 0
    s_cselect_b64 exec, -1, 0
    buffer_load_dwordx4 v[128:131], v5, s[32:35], s80 offen offset:0 sc1
    s_bitcmp1_b32 s85, 1
    s_cselect_b64 exec, -1, 0
    buffer_load_dwordx4 v[132:135], v5, s[32:35], s80 offen offset:1024 sc1
    s_bitcmp1_b32 s85, 2
    s_cselect_b64 exec, -1, 0
    buffer_load_dwordx4 v[136:139], v5, s[32:35], s80 offen offset:2048 sc1
    s_bitcmp1_b32 s85, 3
    s_cselect_b64 exec, -1, 0
    buffer_load_dwordx4 v[140:143], v5, s[32:35], s80 offen offset:3072 sc1
    s_bitcmp1_b32 s85, 4
    s_cselect_b64 exec, -1, 0
    buffer_load_dwordx4 v[144:147], v5, s[32:35], s81 offen offset:0 sc1
    s_bitcmp1_b32 s85, 5
    s_cselect_b64 exec, -1, 0
    buffer_load_dwordx4 v[148:151], v5, s[32:35], s81 offen offset:1024 sc1
    s_bitcmp1_b32 s85, 6
    s_cselect_b64 exec, -1, 0
    buffer_load_dwordx4 v[152:155], v5, s[32:35], s81 offen offset:2048 sc1
    s_bitcmp1_b32 s85, 7
    s_cselect_b64 exec, -1, 0
    buffer_load_dwordx4 v[156:159], v5, s[32:35], s81 offen offset:3072 sc1
    s_bitcmp1_b32 s85, 8
    s_cselect_b64 exec, -1, 0
    buffer_load_dwordx4 v[160:163], v5, s[32:35], s82 offen offset:0 sc1
    s_bitcmp1_b32 s85, 9
    s_cselect_b64 exec, -1, 0
    buffer_load_dwordx4 v[164:167], v5, s[32:35], s82 offen offset:1024 sc1
    s_bitcmp1_b32 s85, 10
    s_cselect_b64 exec, -1, 0
    buffer_load_dwordx4 v[168:171], v5, s[32:35], s82 offen offset:2048 sc1
    s_bitcmp1_b32 s85, 11
    s_cselect_b64 exec, -1, 0
    buffer_load_dwordx4 v[172:175], v5, s[32:35], s82 offen offset:3072 sc1
    s_bitcmp1_b32 s85, 12
    s_cselect_b64 exec, -1, 0
    buffer_load_dwordx4 v[176:179], v5, s[32:35], s83 offen offset:0 sc1
    s_bitcmp1_b32 s85, 13
    s_cselect_b64 exec, -1, 0
    buffer_load_dwordx4 v[180:183], v5, s[32:35], s83 offen offset:1024 sc1
    s_bitcmp1_b32 s85, 14
    s_cselect_b64 exec, -1, 0
    buffer_load_dwordx4 v[184:187], v5, s[32:35], s83 offen offset:2048 sc1
    s_bitcmp1_b32 s85, 15
    s_cselect_b64 exec, -1, 0
    buffer_load_dwordx4 v[188:191], v5, s[32:35], s83 offen offset:3072 sc1
    s_mov_b64 exec, -1
    s_waitcnt vmcnt(16)
    v_msad_u8 v108, v104, s76, 0
    v_msad_u8 v108, v105, s77, v108
    v_msad_u8 v108, v106, s78, v108
    v_msad_u8 v108, v107, s79, v108
    v_cmp_ne_u32 vcc, 0, v108
    s_nop 1
    s_or_b32 s85, vcc_lo, vcc_hi
    s_and_b32 s85, s85, 0xffff
    s_bcnt1_i32_b32 s12, s85
    s_cmp_le_u32 s12, 6
    s_cselect_b32 s87, 1, 0
    s_cmp_lg_u32 s85, 0
    s_waitcnt vmcnt(0)
    s_cbranch_scc1 L_h1
    v_msad_u8 v108, v128, v63, 0
    v_msad_u8 v109, v132, v63, 0
    v_msad_u8 v108, v136, v63, v108
    v_msad_u8 v109, v140, v63, v109
    v_msad_u8 v108, v144, v63, v108
    v_msad_u8 v109, v148, v63, v109
    v_msad_u8 v108, v152, v63, v108
    v_msad_u8 v109, v156, v63, v109
    v_msad_u8 v108, v160, v63, v108
    v_msad_u8 v109, v164, v63, v109
    v_msad_u8 v108, v168, v63, v108
    v_msad_u8 v109, v172, v63, v109
    v_msad_u8 v108, v176, v63, v108
    v_msad_u8 v109, v180, v63, v109
    v_msad_u8 v108, v184, v63, v108
    v_msad_u8 v109, v188, v63, v109
    v_or_b32 v108, v108, v109
    v_cmp_ne_u32 vcc, 0, v108
    s_mov_b32 s85, 0xffff
    s_cbranch_vccnz L_h1
L_h1ok:
    s_waitcnt vmcnt(0)
    v_pk_add_f32 v[128:129], v[128:129], v[160:161]
    v_pk_add_f32 v[130:131], v[130:131], v[162:163]
    v_pk_add_f32 v[132:133], v[132:133], v[164:165]
    v_pk_add_f32 v[134:135], v[134:135], v[166:167]
    v_pk_add_f32 v[136:137], v[136:137], v[168:169]
    v_pk_add_f32 v[138:139], v[138:139], v[170:171]
    v_pk_add_f32 v[140:141], v[140:141], v[172:173]
    v_pk_add_f32 v[142:143], v[142:143], v[174:175]
    v_pk_add_f32 v[144:145], v[144:145], v[176:177]
    v_pk_add_f32 v[146:147], v[146:147], v[178:179]
    v_pk_add_f32 v[148:149], v[148:149], v[180:181]
    v_pk_add_f32 v[150:151], v[150:151], v[182:183]
    v_pk_add_f32 v[152:153], v[152:153], v[184:185]
    v_pk_add_f32 v[154:155], v[154:155], v[186:187]
    v_pk_add_f32 v[156:157], v[156:157], v[188:189]
    v_pk_add_f32 v[158:159], v[158:159], v[190:191]
    v_pk_add_f32 v[128:129], v[128:129], v[144:145]
    v_pk_add_f32 v[130:131], v[130:131], v[146:147]
    v_pk_add_f32 v[132:133], v[132:133], v[148:149]
    v_pk_add_f32 v[134:135], v[134:135], v[150:151]
    v_pk_add_f32 v[136:137], v[136:137], v[152:153]
    v_pk_add_f32 v[138:139], v[138:139], v[154:155]
    v_pk_add_f32 v[140:141], v[140:141], v[156:157]
    v_pk_add_f32 v[142:143], v[142:143], v[158:159]
    v_pk_add_f32 v[128:129], v[128:129], v[136:137]
    v_pk_add_f32 v[130:131], v[130:131], v[138:139]
    v_pk_add_f32 v[132:133], v[132:133], v[140:141]
    v_pk_add_f32 v[134:135], v[134:135], v[142:143]
    v_pk_add_f32 v[128:129], v[128:129], v[132:133]
    v_pk_add_f32 v[130:131], v[130:131], v[134:135]
    v_add_f32_dpp v104, v104, v104 row_ror:1 row_mask:0xf bank_mask:0xf
    v_add_f32_dpp v105, v105, v105 row_ror:1 row_mask:0xf bank_mask:0xf
    v_add_f32_dpp v106, v106, v106 row_ror:1 row_mask:0xf bank_mask:0xf
    v_add_f32_dpp v107, v107, v107 row_ror:1 row_mask:0xf bank_mask:0xf
    v_add_f32_dpp v104, v104, v104 row_ror:2 row_mask:0xf bank_mask:0xf
    v_add_f32_dpp v105, v105, v105 row_ror:2 row_mask:0xf bank_mask:0xf
    v_add_f32_dpp v106, v106, v106 row_ror:2 row_mask:0xf bank_mask:0xf
    v_add_f32_dpp v107, v107, v107 row_ror:2 row_mask:0xf bank_mask:0xf
    v_add_f32_dpp v104, v104, v104 row_ror:4 row_mask:0xf bank_mask:0xf
    v_add_f32_dpp v105, v105, v105 row_ror:4 row_mask:0xf bank_mask:0xf
    v_add_f32_dpp v106, v106, v106 row_ror:4 row_mask:0xf bank_mask:0xf
    v_add_f32_dpp v107, v107, v107 row_ror:4 row_mask:0xf bank_mask:0xf
    v_add_f32_dpp v104, v104, v104 row_ror:8 row_mask:0xf bank_mask:0xf
    v_add_f32_dpp v105, v105, v105 row_ror:8 row_mask:0xf bank_mask:0xf
    v_add_f32_dpp v106, v106, v106 row_ror:8 row_mask:0xf bank_mask:0xf
    v_add_f32_dpp v107, v107, v107 row_ror:8 row_mask:0xf bank_mask:0xf
    v_cvt_pk_bf16_f32 v108, v128, v129
    v_cvt_pk_bf16_f32 v109, v130, v131
    v_cvt_pk_bf16_f32 v112, v104, v105
    v_cvt_pk_bf16_f32 v113, v106, v107
    v_mov_b32 v110, v108
    v_mov_b32 v111, v109
    v_mov_b32 v114, v112
    v_mov_b32 v115, v113
    s_lshl_b32 s12, s19, 13
    s_lshl_b32 s13, s18, 9
    s_add_u32 s12, s12, s13
    s_add_u32 s12, s12, 32768
    s_lshl_b32 s13, s19, 11
    s_lshl_b32 s80, s18, 7
    s_add_u32 s13, s13, s80
    s_add_u32 s13, s13, 163840
    v_permlane32_swap_b32 v108, v110
    v_permlane32_swap_b32 v109, v111
    v_permlane32_swap_b32 v112, v114
    v_permlane32_swap_b32 v113, v115
    s_mov_b32 exec_hi, 0
    buffer_store_dwordx4 v[108:111], v5, s[32:35], s12 offen sc1
    s_mov_b32 exec_lo, 255
    buffer_store_dwordx4 v[112:115], v5, s[32:35], s13 offen sc1
    s_mov_b64 exec, -1
L_nohop:
    v_min_u32 v80, 6, v62
    v_lshl_add_u32 v80, v80, 3, v4
    v_lshlrev_b32 v80, 3, v80
    s_lshl_b32 s12, s86, 3
    s_add_u32 s80, s12, 327680
    s_add_u32 s81, s80, 28672
    s_add_u32 s82, s80, 57344
    s_add_u32 s83, s80, 86016
    v_and_b32 v78, 1, v4
    v_lshlrev_b32 v78, 4, v78
    v_lshrrev_b32 v78, v78, s23
    v_bfe_u32 v79, v78, 8, 8
    v_and_b32 v78, 0xff, v78
    s_mov_b32 s13, 0
L_gu:
    buffer_load_dwordx2 v[104:105], v80, s[32:35], s80 offen sc1
    buffer_load_dwordx2 v[106:107], v80, s[32:35], s81 offen sc1
    buffer_load_dwordx2 v[108:109], v80, s[32:35], s82 offen sc1
    buffer_load_dwordx2 v[110:111], v80, s[32:35], s83 offen sc1
    s_add_u32 s13, s13, 1
    s_cmp_lg_u32 s21, 0
    s_cbranch_scc1 L_nofl
    s_waitcnt vmcnt(4)
    v_mov_b32 v112, 162896
    v_mov_b32 v113, 1
    s_mov_b64 exec, 1
    ds_write_b32 v112, v113
    s_mov_b64 exec, -1
L_nofl:
    s_waitcnt vmcnt(0)
    v_msad_u8 v112, v104, v78, 0
    v_msad_u8 v112, v105, v79, v112
    v_msad_u8 v112, v106, v78, v112
    v_msad_u8 v112, v107, v79, v112
    v_msad_u8 v112, v108, v78, v112
    v_msad_u8 v112, v109, v79, v112
    v_msad_u8 v112, v110, v78, v112
    v_msad_u8 v112, v111, v79, v112
    v_cmp_ne_u32 vcc, 0, v112
    s_cbranch_vccz L_guok
    s_cmp_lt_u32 s13, 16384
    s_cbranch_scc1 L_gu
L_guok:
    v_pk_add_f32 v[104:105], v[104:105], v[106:107]
    v_pk_add_f32 v[108:109], v[108:109], v[110:111]
    v_pk_add_f32 v[104:105], v[104:105], v[108:109]
    v_cvt_pk_bf16_f32 v104, v104, v105
    v_and_b32 v105, 0xffff0000, v104
    v_lshlrev_b32 v104, 16, v104
    v_mul_f32 v106, 0xbfb8aa3b, v104
    v_exp_f32 v106, v106
    s_nop 0
    v_add_f32 v106, 1.0, v106
    v_rcp_f32 v106, v106
    s_nop 0
    v_mul_f32 v106, v106, v104
    v_cvt_pk_bf16_f32 v106, v106, v106
    v_lshlrev_b32 v106, 16, v106
    v_mul_f32 v106, v106, v105
    v_cvt_pk_bf16_f32 v106, v106, v106
    ds_swizzle_b32 v64, v106 offset:0x18
    ds_swizzle_b32 v66, v106 offset:0x38
    ds_swizzle_b32 v68, v106 offset:0x58
    ds_swizzle_b32 v70, v106 offset:0x78
    ds_swizzle_b32 v72, v106 offset:0x98
    ds_swizzle_b32 v74, v106 offset:0xb8
    ds_swizzle_b32 v76, v106 offset:0xd8
    s_waitcnt lgkmcnt(0)
    v_and_b32 v65, 0xffff0000, v64
    v_and_b32 v64, 0xffff, v64
    v_and_b32 v67, 0xffff0000, v66
    v_and_b32 v66, 0xffff, v66
    v_and_b32 v69, 0xffff0000, v68
    v_and_b32 v68, 0xffff, v68
    v_and_b32 v71, 0xffff0000, v70
    v_and_b32 v70, 0xffff, v70
    v_and_b32 v73, 0xffff0000, v72
    v_and_b32 v72, 0xffff, v72
    v_and_b32 v75, 0xffff0000, v74
    v_and_b32 v74, 0xffff, v74
    v_and_b32 v77, 0xffff0000, v76
    v_and_b32 v76, 0xffff, v76
    v_dot2_f32_bf16 v220, v192, v64, 0
    v_dot2_f32_bf16 v221, v192, v65, 0
    v_dot2_f32_bf16 v222, v193, v64, 0
    v_dot2_f32_bf16 v223, v193, v65, 0
    v_dot2_f32_bf16 v224, v194, v64, 0
    v_dot2_f32_bf16 v225, v194, v65, 0
    v_dot2_f32_bf16 v226, v195, v64, 0
    v_dot2_f32_bf16 v227, v195, v65, 0
    v_dot2_f32_bf16 v220, v196, v66, v220
    v_dot2_f32_bf16 v221, v196, v67, v221
    v_dot2_f32_bf16 v222, v197, v66, v222
    v_dot2_f32_bf16 v223, v197, v67, v223
    v_dot2_f32_bf16 v224, v198, v66, v224
    v_dot2_f32_bf16 v225, v198, v67, v225
    v_dot2_f32_bf16 v226, v199, v66, v226
    v_dot2_f32_bf16 v227, v199, v67, v227
    v_dot2_f32_bf16 v220, v200, v68, v220
    v_dot2_f32_bf16 v221, v200, v69, v221
    v_dot2_f32_bf16 v222, v201, v68, v222
    v_dot2_f32_bf16 v223, v201, v69, v223
    v_dot2_f32_bf16 v224, v202, v68, v224
    v_dot2_f32_bf16 v225, v202, v69, v225
    v_dot2_f32_bf16 v226, v203, v68, v226
    v_dot2_f32_bf16 v227, v203, v69, v227
    v_dot2_f32_bf16 v220, v204, v70, v220
    v_dot2_f32_bf16 v221, v204, v71, v221
    v_dot2_f32_bf16 v222, v205, v70, v222
    v_dot2_f32_bf16 v223, v205, v71, v223
    v_dot2_f32_bf16 v224, v206, v70, v224
    v_dot2_f32_bf16 v225, v206, v71, v225
    v_dot2_f32_bf16 v226, v207, v70, v226
    v_dot2_f32_bf16 v227, v207, v71, v227
    v_dot2_f32_bf16 v220, v208, v72, v220
    v_dot2_f32_bf16 v221, v208, v73, v221
    v_dot2_f32_bf16 v222, v209, v72, v222
    v_dot2_f32_bf16 v223, v209, v73, v223
    v_dot2_f32_bf16 v224, v210, v72, v224
    v_dot2_f32_bf16 v225, v210, v73, v225
    v_dot2_f32_bf16 v226, v211, v72, v226
    v_dot2_f32_bf16 v227, v211, v73, v227
    v_dot2_f32_bf16 v220, v212, v74, v220
    v_dot2_f32_bf16 v221, v212, v75, v221
    v_dot2_f32_bf16 v222, v213, v74, v222
    v_dot2_f32_bf16 v223, v213, v75, v223
    v_dot2_f32_bf16 v224, v214, v74, v224
    v_dot2_f32_bf16 v225, v214, v75, v225
    v_dot2_f32_bf16 v226, v215, v74, v226
    v_dot2_f32_bf16 v227, v215, v75, v227
    v_dot2_f32_bf16 v220, v216, v76, v220
    v_dot2_f32_bf16 v221, v216, v77, v221
    v_dot2_f32_bf16 v222, v217, v76, v222
    v_dot2_f32_bf16 v223, v217, v77, v223
    v_dot2_f32_bf16 v224, v218, v76, v224
    v_dot2_f32_bf16 v225, v218, v77, v225
    v_dot2_f32_bf16 v226, v219, v76, v226
    v_dot2_f32_bf16 v227, v219, v77, v227
    v_permlane32_swap_b32 v220, v224
    v_permlane32_swap_b32 v221, v225
    v_permlane32_swap_b32 v222, v226
    v_permlane32_swap_b32 v223, v227
    v_add_f32 v220, v220, v224
    v_add_f32 v221, v221, v225
    v_add_f32 v222, v222, v226
    v_add_f32 v223, v223, v227
    s_nop 0
    v_permlane16_swap_b32 v220, v222
    v_permlane16_swap_b32 v221, v223
    v_add_f32 v220, v220, v222
    v_add_f32 v221, v221, v223
    s_nop 0
    v_add_f32_dpp v220, v220, v220 row_ror:8 row_mask:0xf bank_mask:0xf
    v_add_f32_dpp v221, v221, v221 row_ror:8 row_mask:0xf bank_mask:0xf
    v_lshrrev_b32 v80, 4, v2
    v_lshlrev_b32 v80, 3, v80
    v_lshl_add_u32 v80, v62, 5, v80
    s_lshl_b32 s12, s21, 8
    s_add_u32 s12, s12, 161792
    v_add_u32 v80, s12, v80
    ds_write_b64 v80, v[220:221]
    v_mov_b32 v80, 162848
    v_mov_b32 v78, 1
    s_mov_b64 exec, 1
    ds_add_rtn_u32 v79, v80, v78 offset:4
    s_mov_b64 exec, -1
    s_waitcnt lgkmcnt(0)
    v_readfirstlane_b32 s12, v79
    s_nop 1
    s_cmp_lg_u32 s12, 3
    s_cbranch_scc1 L_noy
    v_lshlrev_b32 v78, 2, v2
    v_add_u32 v80, 161792, v78
    ds_read2st64_b32 v[220:221], v80 offset0:0 offset1:1
    ds_read2st64_b32 v[222:223], v80 offset0:2 offset1:3
    s_lshr_b32 s12, s2, 4
    s_lshl_b32 s12, s12, 4
    s_and_b32 s13, s2, 15
    s_add_u32 s12, s12, s13
    s_lshl_b32 s12, s12, 8
    s_add_u32 s12, s12, 458752
    s_mov_b32 s13, 0xffffff00
    s_waitcnt lgkmcnt(0)
    v_pk_add_f32 v[220:221], v[220:221], v[222:223]
    v_add_f32 v220, v220, v221
    v_and_or_b32 v220, v220, s13, v63
    buffer_store_dword v220, v78, s[32:35], s12 offen sc1
L_noy:
    s_cmp_lg_u32 s21, 0
    s_cbranch_scc1 L_prepd
    s_waitcnt vmcnt(0)
    v_sub_f32 v50, 1.0, v48
    v_cvt_pk_bf16_f32 v50, v50, v50
    v_lshlrev_b32 v50, 16, v50
    v_lshlrev_b32 v32, 16, v24
    v_and_b32 v33, 0xffff0000, v24
    v_lshlrev_b32 v34, 16, v25
    v_and_b32 v35, 0xffff0000, v25
    v_lshlrev_b32 v36, 16, v26
    v_and_b32 v37, 0xffff0000, v26
    v_lshlrev_b32 v38, 16, v27
    v_and_b32 v39, 0xffff0000, v27
    v_lshlrev_b32 v40, 16, v28
    v_and_b32 v41, 0xffff0000, v28
    v_lshlrev_b32 v42, 16, v29
    v_and_b32 v43, 0xffff0000, v29
    v_lshlrev_b32 v44, 16, v30
    v_and_b32 v45, 0xffff0000, v30
    v_lshlrev_b32 v46, 16, v31
    v_and_b32 v47, 0xffff0000, v31
    v_pk_mul_f32 v[32:33], v[32:33], v[50:51] op_sel_hi:[1,0]
    v_pk_mul_f32 v[34:35], v[34:35], v[50:51] op_sel_hi:[1,0]
    v_pk_mul_f32 v[36:37], v[36:37], v[50:51] op_sel_hi:[1,0]
    v_pk_mul_f32 v[38:39], v[38:39], v[50:51] op_sel_hi:[1,0]
    v_pk_mul_f32 v[40:41], v[40:41], v[50:51] op_sel_hi:[1,0]
    v_pk_mul_f32 v[42:43], v[42:43], v[50:51] op_sel_hi:[1,0]
    v_pk_mul_f32 v[44:45], v[44:45], v[50:51] op_sel_hi:[1,0]
    v_pk_mul_f32 v[46:47], v[46:47], v[50:51] op_sel_hi:[1,0]
    v_cvt_pk_bf16_f32 v33, v32, v33
    v_cvt_pk_bf16_f32 v35, v34, v35
    v_cvt_pk_bf16_f32 v37, v36, v37
    v_cvt_pk_bf16_f32 v39, v38, v39
    v_cvt_pk_bf16_f32 v41, v40, v41
    v_cvt_pk_bf16_f32 v43, v42, v43
    v_cvt_pk_bf16_f32 v45, v44, v45
    v_cvt_pk_bf16_f32 v47, v46, v47
    v_lshlrev_b32 v32, 16, v33
    v_and_b32 v33, 0xffff0000, v33
    v_lshlrev_b32 v34, 16, v35
    v_and_b32 v35, 0xffff0000, v35
    v_lshlrev_b32 v36, 16, v37
    v_and_b32 v37, 0xffff0000, v37
    v_lshlrev_b32 v38, 16, v39
    v_and_b32 v39, 0xffff0000, v39
    v_lshlrev_b32 v40, 16, v41
    v_and_b32 v41, 0xffff0000, v41
    v_lshlrev_b32 v42, 16, v43
    v_and_b32 v43, 0xffff0000, v43
    v_lshlrev_b32 v44, 16, v45
    v_and_b32 v45, 0xffff0000, v45
    v_lshlrev_b32 v46, 16, v47
    v_and_b32 v47, 0xffff0000, v47
L_prepd:
    s_mov_b32 s21, s4
    s_mov_b32 s22, s5
    s_mov_b32 s45, 0
    s_lshr_b32 s12, s21, 4
    s_cmp_eq_u32 s12, s92
    s_cselect_b32 s46, 1, 0
    s_cbranch_scc0 L_b_noownl
    s_lshl_b32 s12, s89, 12
    s_add_u32 s12, s12, 458752
    buffer_load_dwordx4 v[224:227], v22, s[32:35], s12 offen offset:0 sc1
    buffer_load_dwordx4 v[228:231], v22, s[32:35], s12 offen offset:16 sc1
    buffer_load_dwordx4 v[232:235], v22, s[32:35], s12 offen offset:64 sc1
    buffer_load_dwordx4 v[236:239], v22, s[32:35], s12 offen offset:80 sc1
L_b_noownl:
    s_branch L_phaseb
L_compute:
    s_setprio 1
    s_lshr_b32 s21, s20, 1
    s_and_b32 s22, s20, 1
    v_lshrrev_b32 v3, 5, v2
    v_and_b32 v4, 31, v2
    s_lshl_b32 s12, s21, 13
    v_lshlrev_b32 v6, 7, v4
    v_add_u32 v6, s12, v6
    v_bfe_u32 v7, v2, 1, 3
    v_add_u32 v8, 0, v3
    v_xor_b32 v8, v8, v7
    v_lshl_add_u32 v20, v8, 4, v6
    v_add_u32 v8, 2, v3
    v_xor_b32 v8, v8, v7
    v_lshl_add_u32 v21, v8, 4, v6
    v_add_u32 v8, 4, v3
    v_xor_b32 v8, v8, v7
    v_lshl_add_u32 v22, v8, 4, v6
    v_add_u32 v8, 6, v3
    v_xor_b32 v8, v8, v7
    v_lshl_add_u32 v23, v8, 4, v6
    v_lshlrev_b32 v6, 10, v3
    v_bfe_u32 v7, v2, 2, 2
    v_lshl_add_u32 v6, v7, 7, v6
    v_bfe_u32 v8, v2, 3, 1
    v_xor_b32 v8, s22, v8
    v_lshl_add_u32 v6, v8, 6, v6
    v_bfe_u32 v8, v2, 4, 1
    v_lshlrev_b32 v8, 5, v8
    v_and_b32 v9, 3, v2
    v_lshl_add_u32 v8, v9, 3, v8
    v_add_u32 v6, v6, v8
    v_add_u32 v36, 16384, v6
    v_lshl_add_u32 v7, v3, 2, v7
    v_lshl_add_u32 v12, v7, 6, v8
    s_lshl_b32 s12, s22, 11
    s_add_u32 s12, s12, 155648
    v_add_u32 v12, s12, v12
    v_lshlrev_b32 v6, 14, v3
    v_lshl_add_u32 v6, v4, 4, v6
    v_lshlrev_b32 v7, 9, v3
    s_lshl_b32 s12, s22, 3
    s_lshl_b32 s13, s21, 2
    s_add_u32 s12, s12, s13
    s_lshl_b32 s13, s12, 14
    s_lshl_b32 s14, s19, 18
    s_add_u32 s13, s13, s14
    s_lshl_b32 s14, s18, 10
    s_add_u32 s13, s13, s14
    s_add_u32 s40, s13, 1048576
    s_add_u32 s41, s40, 32768
    s_lshl_b32 s13, s12, 9
    s_lshl_b32 s14, s19, 13
    s_add_u32 s13, s13, s14
    s_lshl_b32 s14, s18, 5
    s_add_u32 s13, s13, s14
    s_add_u32 s42, s13, 5242880
    s_add_u32 s43, s42, 1024
    s_lshl_b32 s13, s21, 4
    s_lshl_b32 s44, 1, s13
    s_xor_b32 s13, s13, 16
    s_lshl_b32 s45, 1, s13
    s_lshl_b32 s13, s22, 1
    s_add_u32 s13, s13, s21
    s_lshl_b32 s13, s13, 11
    s_lshl_b32 s14, s19, 13
    s_add_u32 s13, s13, s14
    s_lshl_b32 s14, s18, 7
    s_add_u32 s13, s13, s14
    s_add_u32 s42, s13, 5242880
    s_mov_b32 s45, 0x10001
    v_lshlrev_b32 v7, 2, v2
    v_mov_b32 v68, 0
    v_mov_b32 v69, 0
    v_mov_b32 v70, 0
    v_mov_b32 v71, 0
    v_mov_b32 v160, 0
    v_mov_b32 v161, 0
    v_mov_b32 v162, 0
    v_mov_b32 v163, 0
    v_mov_b32 v164, 0
    v_mov_b32 v165, 0
    v_mov_b32 v166, 0
    v_mov_b32 v167, 0
    v_mov_b32 v168, 0
    v_mov_b32 v169, 0
    v_mov_b32 v170, 0
    v_mov_b32 v171, 0
    v_mov_b32 v172, 0
    v_mov_b32 v173, 0
    v_mov_b32 v174, 0
    v_mov_b32 v175, 0
    v_mov_b32 v176, 0
    v_mov_b32 v177, 0
    v_mov_b32 v178, 0
    v_mov_b32 v179, 0
    v_mov_b32 v180, 0
    v_mov_b32 v181, 0
    v_mov_b32 v182, 0
    v_mov_b32 v183, 0
    v_mov_b32 v184, 0
    v_mov_b32 v185, 0
    v_mov_b32 v186, 0
    v_mov_b32 v187, 0
    v_mov_b32 v188, 0
    v_mov_b32 v189, 0
    v_mov_b32 v190, 0
    v_mov_b32 v191, 0
    v_mov_b32 v192, 0
    v_mov_b32 v193, 0
    v_mov_b32 v194, 0
    v_mov_b32 v195, 0
    v_mov_b32 v196, 0
    v_mov_b32 v197, 0
    v_mov_b32 v198, 0
    v_mov_b32 v199, 0
    v_mov_b32 v200, 0
    v_mov_b32 v201, 0
    v_mov_b32 v202, 0
    v_mov_b32 v203, 0
    v_mov_b32 v204, 0
    v_mov_b32 v205, 0
    v_mov_b32 v206, 0
    v_mov_b32 v207, 0
    v_mov_b32 v208, 0
    v_mov_b32 v209, 0
    v_mov_b32 v210, 0
    v_mov_b32 v211, 0
    v_mov_b32 v212, 0
    v_mov_b32 v213, 0
    v_mov_b32 v214, 0
    v_mov_b32 v215, 0
    v_mov_b32 v216, 0
    v_mov_b32 v217, 0
    v_mov_b32 v218, 0
    v_mov_b32 v219, 0
    v_mov_b32 v220, 0
    v_mov_b32 v221, 0
    v_mov_b32 v222, 0
    v_mov_b32 v223, 0
    v_mov_b32 v224, 0
    v_mov_b32 v225, 0
    v_mov_b32 v226, 0
    v_mov_b32 v227, 0
    v_mov_b32 v228, 0
    v_mov_b32 v229, 0
    v_mov_b32 v230, 0
    v_mov_b32 v231, 0
    v_mov_b32 v232, 0
    v_mov_b32 v233, 0
    v_mov_b32 v234, 0
    v_mov_b32 v235, 0
    v_mov_b32 v236, 0
    v_mov_b32 v237, 0
    v_mov_b32 v238, 0
    v_mov_b32 v239, 0
    v_mov_b32 v240, 0
    v_mov_b32 v241, 0
    v_mov_b32 v242, 0
    v_mov_b32 v243, 0
    v_mov_b32 v244, 0
    v_mov_b32 v245, 0
    v_mov_b32 v246, 0
    v_mov_b32 v247, 0
    v_mov_b32 v248, 0
    v_mov_b32 v249, 0
    v_mov_b32 v250, 0
    v_mov_b32 v251, 0
    v_mov_b32 v252, 0
    v_mov_b32 v253, 0
    v_mov_b32 v254, 0
    v_mov_b32 v255, 0
    v_lshlrev_b32 v8, 2, v3
    v_sub_u32 v8, v4, v8
    v_mov_b32 v9, 0x3f80
    v_mov_b32 v10, 0x3f800000
    v_cmp_eq_u32 vcc, 0, v8
    s_nop 1
    v_cndmask_b32 v11, 0, v9, vcc
    v_cmp_eq_u32 vcc, 1, v8
    s_nop 1
    v_cndmask_b32 v48, v11, v10, vcc
    v_cmp_eq_u32 vcc, 2, v8
    s_nop 1
    v_cndmask_b32 v11, 0, v9, vcc
    v_cmp_eq_u32 vcc, 3, v8
    s_nop 1
    v_cndmask_b32 v49, v11, v10, vcc
    v_cmp_eq_u32 vcc, 8, v8
    s_nop 1
    v_cndmask_b32 v11, 0, v9, vcc
    v_cmp_eq_u32 vcc, 9, v8
    s_nop 1
    v_cndmask_b32 v50, v11, v10, vcc
    v_cmp_eq_u32 vcc, 10, v8
    s_nop 1
    v_cndmask_b32 v11, 0, v9, vcc
    v_cmp_eq_u32 vcc, 11, v8
    s_nop 1
    v_cndmask_b32 v51, v11, v10, vcc
    v_cmp_eq_u32 vcc, 16, v8
    s_nop 1
    v_cndmask_b32 v11, 0, v9, vcc
    v_cmp_eq_u32 vcc, 17, v8
    s_nop 1
    v_cndmask_b32 v52, v11, v10, vcc
    v_cmp_eq_u32 vcc, 18, v8
    s_nop 1
    v_cndmask_b32 v11, 0, v9, vcc
    v_cmp_eq_u32 vcc, 19, v8
    s_nop 1
    v_cndmask_b32 v53, v11, v10, vcc
    v_cmp_eq_u32 vcc, 24, v8
    s_nop 1
    v_cndmask_b32 v11, 0, v9, vcc
    v_cmp_eq_u32 vcc, 25, v8
    s_nop 1
    v_cndmask_b32 v54, v11, v10, vcc
    v_cmp_eq_u32 vcc, 26, v8
    s_nop 1
    v_cndmask_b32 v11, 0, v9, vcc
    v_cmp_eq_u32 vcc, 27, v8
    s_nop 1
    v_cndmask_b32 v55, v11, v10, vcc
    v_mov_b32 v9, 0x3f803f80
    v_cmp_gt_u32 vcc, 16, v4
    s_nop 1
    v_cndmask_b32 v56, 0, v9, vcc
    v_cndmask_b32 v60, v9, 0, vcc
    v_cndmask_b32 v57, 0, v9, vcc
    v_cndmask_b32 v61, v9, 0, vcc
    v_cndmask_b32 v58, 0, v9, vcc
    v_cndmask_b32 v62, v9, 0, vcc
    v_cndmask_b32 v59, 0, v9, vcc
    v_cndmask_b32 v63, v9, 0, vcc
    s_waitcnt lgkmcnt(0)
    s_mov_b32 s32, s62
    s_and_b32 s33, s63, 0xffff
    s_mov_b32 s34, 33554432
    s_mov_b32 s35, 0x00020000
    s_mov_b32 s24, s4
    s_and_b32 s25, s5, 0xffff
    s_mov_b32 s26, 4194304
    s_mov_b32 s27, 0x00020000
    s_cmp_lg_u32 s20, 0
    s_cbranch_scc1 L_c_noinit
    v_add_u32 v8, 162816, v5
    s_mov_b64 exec, 0xff
    ds_write_b128 v8, v[68:71]
    s_mov_b64 exec, -1
    s_cmp_lg_u32 s2, 0
    s_cbranch_scc1 L_c_noinit
    s_mov_b32 s72, s60
    s_and_b32 s73, s61, 0xffff
    s_mov_b32 s74, 256
    s_mov_b32 s75, 0x00020000
    s_memrealtime s[14:15]
    s_waitcnt lgkmcnt(0)
    s_mul_i32 s14, s14, 0x9e3779b1
    s_or_b32 s14, s14, 0x01010101
    v_mov_b32 v8, s14
    s_mov_b64 exec, 1
    buffer_store_dword v8, v68, s[72:75], 0 offen offset:4 sc1
    s_mov_b64 exec, -1
L_c_noinit:
    s_lshl_b32 s14, s22, 1
    s_add_u32 s15, s14, s21
    s_xor_b32 s14, s15, 1
    s_mul_i32 s14, s14, 4352
    s_mul_i32 s15, s15, 4352
    s_add_u32 s14, s14, 40960
    s_add_u32 s15, s15, 40960
    v_add_u32 v8, s14, v5
    v_add_u32 v9, s15, v5
    v_lshlrev_b32 v11, 4, v3
    v_add_u32 v10, s14, v11
    v_add_u32 v11, s15, v11
    s_lshl_b32 s14, s20, 2
    s_add_u32 s15, s14, 162832
    v_mov_b32 v13, s15
    v_xor_b32 v14, 8, v13
    v_subrev_u32 v17, 16, v13
    v_mov_b32 v15, 1
    v_bfe_u32 v16, v2, 4, 1
    v_cmp_eq_u32 vcc, s21, v16
    s_nop 1
    v_cndmask_b32 v10, v10, v11, vcc
    s_lshl_b32 s14, s21, 7
    v_add_u32 v10, s14, v10
    v_lshrrev_b32 v11, 2, v5
    v_sub_u32 v16, v9, v5
    v_add_u32 v11, v16, v11
    s_waitcnt lgkmcnt(0)
    s_barrier
    ds_read_b128 v[100:103], v20
    ds_read_b64_tr_b16 v[108:109], v36 offset:0
    ds_read_b64_tr_b16 v[110:111], v36 offset:512
    ds_read_b128 v[104:107], v20 offset:4096
    ds_read_b64_tr_b16 v[112:113], v36 offset:8192
    ds_read_b64_tr_b16 v[114:115], v36 offset:8704
    ds_read_b64_tr_b16 v[116:117], v36 offset:16384
    ds_read_b64_tr_b16 v[118:119], v36 offset:16896
    s_mov_b32 s48, 0
    s_mov_b32 s49, 0
.p2align 3
L_c_loop:
    s_add_u32 s49, s49, 1
    s_cmp_eq_u32 s49, 3
    s_mov_b32 s50, 40960
    s_cselect_b32 s50, 4294885376, s50
    s_cselect_b32 s49, 0, s49
    s_waitcnt lgkmcnt(5)
    v_mfma_f32_32x32x16_bf16 v[160:175], v[108:111], v[100:103], v[160:175]
    ds_read_b128 v[120:123], v21
    ds_read_b64_tr_b16 v[128:129], v36 offset:2048
    s_waitcnt lgkmcnt(6)
    v_mfma_f32_32x32x16_bf16 v[176:191], v[108:111], v[104:107], v[176:191]
    ds_read_b64_tr_b16 v[130:131], v36 offset:2560
    s_waitcnt lgkmcnt(5)
    v_mfma_f32_32x32x16_bf16 v[192:207], v[112:115], v[100:103], v[192:207]
    ds_read_b128 v[124:127], v21 offset:4096
    v_mfma_f32_32x32x16_bf16 v[208:223], v[112:115], v[104:107], v[208:223]
    ds_read_b64_tr_b16 v[132:133], v36 offset:10240
    ds_read_b64_tr_b16 v[134:135], v36 offset:10752
    s_waitcnt lgkmcnt(6)
    v_mfma_f32_32x32x16_bf16 v[224:239], v[100:103], v[116:119], v[224:239]
    ds_read_b64_tr_b16 v[136:137], v36 offset:18432
    v_add_u32 v21, s50, v21
    v_mfma_f32_32x32x16_bf16 v[240:255], v[104:107], v[116:119], v[240:255]
    ds_read_b64_tr_b16 v[138:139], v36 offset:18944
    v_add_u32 v20, s50, v20
    s_waitcnt lgkmcnt(5)
    v_mfma_f32_32x32x16_bf16 v[160:175], v[128:131], v[120:123], v[160:175]
    ds_read_b128 v[100:103], v22
    ds_read_b64_tr_b16 v[108:109], v36 offset:4096
    s_waitcnt lgkmcnt(6)
    v_mfma_f32_32x32x16_bf16 v[176:191], v[128:131], v[124:127], v[176:191]
    ds_read_b64_tr_b16 v[110:111], v36 offset:4608
    s_waitcnt lgkmcnt(5)
    v_mfma_f32_32x32x16_bf16 v[192:207], v[132:135], v[120:123], v[192:207]
    ds_read_b128 v[104:107], v22 offset:4096
    v_mfma_f32_32x32x16_bf16 v[208:223], v[132:135], v[124:127], v[208:223]
    ds_read_b64_tr_b16 v[112:113], v36 offset:12288
    ds_read_b64_tr_b16 v[114:115], v36 offset:12800
    s_waitcnt lgkmcnt(6)
    v_mfma_f32_32x32x16_bf16 v[224:239], v[120:123], v[136:139], v[224:239]
    ds_read_b64_tr_b16 v[116:117], v36 offset:20480
    v_add_u32 v22, s50, v22
    v_mfma_f32_32x32x16_bf16 v[240:255], v[124:127], v[136:139], v[240:255]
    ds_read_b64_tr_b16 v[118:119], v36 offset:20992
    s_waitcnt lgkmcnt(5)
    v_mfma_f32_32x32x16_bf16 v[160:175], v[108:111], v[100:103], v[160:175]
    ds_read_b128 v[120:123], v23
    ds_read_b64_tr_b16 v[128:129], v36 offset:6144
    ds_read_b64_tr_b16 v[130:131], v36 offset:6656
    s_waitcnt lgkmcnt(7)
    v_mfma_f32_32x32x16_bf16 v[176:191], v[108:111], v[104:107], v[176:191]
    ds_read_b128 v[124:127], v23 offset:4096
    ds_read_b64_tr_b16 v[132:133], v36 offset:14336
    ds_read_b64_tr_b16 v[134:135], v36 offset:14848
    s_waitcnt lgkmcnt(8)
    v_mfma_f32_32x32x16_bf16 v[192:207], v[112:115], v[100:103], v[192:207]
    ds_read_b64_tr_b16 v[136:137], v36 offset:22528
    ds_read_b64_tr_b16 v[138:139], v36 offset:23040
    v_mfma_f32_32x32x16_bf16 v[208:223], v[112:115], v[104:107], v[208:223]
    s_waitcnt lgkmcnt(8)
    v_mfma_f32_32x32x16_bf16 v[224:239], v[100:103], v[116:119], v[224:239]
    v_add_u32 v23, s50, v23
    v_mfma_f32_32x32x16_bf16 v[240:255], v[104:107], v[116:119], v[240:255]
    v_add_u32 v36, s50, v36
    s_waitcnt lgkmcnt(0)
    v_mfma_f32_32x32x16_bf16 v[160:175], v[128:131], v[120:123], v[160:175]
    s_barrier
    ds_read_b128 v[100:103], v20
    ds_read_b64_tr_b16 v[108:109], v36 offset:0
    ds_read_b64_tr_b16 v[110:111], v36 offset:512
    v_mfma_f32_32x32x16_bf16 v[176:191], v[128:131], v[124:127], v[176:191]
    ds_read_b128 v[104:107], v20 offset:4096
    ds_read_b64_tr_b16 v[112:113], v36 offset:8192
    ds_read_b64_tr_b16 v[114:115], v36 offset:8704
    v_mfma_f32_32x32x16_bf16 v[192:207], v[132:135], v[120:123], v[192:207]
    ds_read_b64_tr_b16 v[116:117], v36 offset:16384
    ds_read_b64_tr_b16 v[118:119], v36 offset:16896
    v_mfma_f32_32x32x16_bf16 v[208:223], v[132:135], v[124:127], v[208:223]
    v_mfma_f32_32x32x16_bf16 v[224:239], v[120:123], v[136:139], v[224:239]
    s_add_u32 s48, s48, 1
    s_cmp_lt_u32 s48, 15
    v_mfma_f32_32x32x16_bf16 v[240:255], v[124:127], v[136:139], v[240:255]
    s_cbranch_scc1 L_c_loop
    s_waitcnt lgkmcnt(5)
    v_mfma_f32_32x32x16_bf16 v[160:175], v[108:111], v[100:103], v[160:175]
    ds_read_b128 v[120:123], v21
    ds_read_b64_tr_b16 v[128:129], v36 offset:2048
    s_waitcnt lgkmcnt(6)
    v_mfma_f32_32x32x16_bf16 v[176:191], v[108:111], v[104:107], v[176:191]
    ds_read_b64_tr_b16 v[130:131], v36 offset:2560
    s_waitcnt lgkmcnt(5)
    v_mfma_f32_32x32x16_bf16 v[192:207], v[112:115], v[100:103], v[192:207]
    ds_read_b128 v[124:127], v21 offset:4096
    v_mfma_f32_32x32x16_bf16 v[208:223], v[112:115], v[104:107], v[208:223]
    ds_read_b64_tr_b16 v[132:133], v36 offset:10240
    ds_read_b64_tr_b16 v[134:135], v36 offset:10752
    s_waitcnt lgkmcnt(6)
    v_mfma_f32_32x32x16_bf16 v[224:239], v[100:103], v[116:119], v[224:239]
    ds_read_b64_tr_b16 v[136:137], v36 offset:18432
    v_mfma_f32_32x32x16_bf16 v[240:255], v[104:107], v[116:119], v[240:255]
    ds_read_b64_tr_b16 v[138:139], v36 offset:18944
    s_waitcnt lgkmcnt(5)
    v_mfma_f32_32x32x16_bf16 v[160:175], v[128:131], v[120:123], v[160:175]
    ds_read_b128 v[100:103], v22
    ds_read_b64_tr_b16 v[108:109], v36 offset:4096
    s_waitcnt lgkmcnt(6)
    v_mfma_f32_32x32x16_bf16 v[176:191], v[128:131], v[124:127], v[176:191]
    ds_read_b64_tr_b16 v[110:111], v36 offset:4608
    s_waitcnt lgkmcnt(5)
    v_mfma_f32_32x32x16_bf16 v[192:207], v[132:135], v[120:123], v[192:207]
    ds_read_b128 v[104:107], v22 offset:4096
    v_mfma_f32_32x32x16_bf16 v[208:223], v[132:135], v[124:127], v[208:223]
    ds_read_b64_tr_b16 v[112:113], v36 offset:12288
    ds_read_b64_tr_b16 v[114:115], v36 offset:12800
    s_waitcnt lgkmcnt(6)
    v_mfma_f32_32x32x16_bf16 v[224:239], v[120:123], v[136:139], v[224:239]
    ds_read_b64_tr_b16 v[116:117], v36 offset:20480
    v_mfma_f32_32x32x16_bf16 v[240:255], v[124:127], v[136:139], v[240:255]
    ds_read_b64_tr_b16 v[118:119], v36 offset:20992
    s_waitcnt lgkmcnt(5)
    v_mfma_f32_32x32x16_bf16 v[160:175], v[108:111], v[100:103], v[160:175]
    ds_read_b128 v[120:123], v23
    ds_read_b64_tr_b16 v[128:129], v36 offset:6144
    ds_read_b64_tr_b16 v[130:131], v36 offset:6656
    s_waitcnt lgkmcnt(7)
    v_mfma_f32_32x32x16_bf16 v[176:191], v[108:111], v[104:107], v[176:191]
    ds_read_b128 v[124:127], v23 offset:4096
    ds_read_b64_tr_b16 v[132:133], v36 offset:14336
    ds_read_b64_tr_b16 v[134:135], v36 offset:14848
    s_waitcnt lgkmcnt(8)
    v_mfma_f32_32x32x16_bf16 v[192:207], v[112:115], v[100:103], v[192:207]
    ds_read_b64_tr_b16 v[136:137], v36 offset:22528
    ds_read_b64_tr_b16 v[138:139], v36 offset:23040
    v_mfma_f32_32x32x16_bf16 v[208:223], v[112:115], v[104:107], v[208:223]
    s_waitcnt lgkmcnt(8)
    v_mfma_f32_32x32x16_bf16 v[224:239], v[100:103], v[116:119], v[224:239]
    v_mfma_f32_32x32x16_bf16 v[240:255], v[104:107], v[116:119], v[240:255]
    s_waitcnt lgkmcnt(0)
    v_mfma_f32_32x32x16_bf16 v[160:175], v[128:131], v[120:123], v[160:175]
    s_mov_b64 exec, 1
    ds_write_b32 v17, v15
    s_mov_b64 exec, -1
    ds_read_b64_tr_b16 v[40:41], v12 offset:0
    ds_read_b64_tr_b16 v[42:43], v12 offset:512
    ds_read_b64_tr_b16 v[44:45], v12 offset:1024
    ds_read_b64_tr_b16 v[46:47], v12 offset:1536
    v_mov_b32 v16, 162864
    ds_read_b96 v[24:26], v16
    v_mfma_f32_32x32x16_bf16 v[176:191], v[128:131], v[124:127], v[176:191]
    v_mfma_f32_32x32x16_bf16 v[192:207], v[132:135], v[120:123], v[192:207]
    v_mfma_f32_32x32x16_bf16 v[208:223], v[132:135], v[124:127], v[208:223]
    v_mfma_f32_32x32x16_bf16 v[224:239], v[120:123], v[136:139], v[224:239]
    v_mfma_f32_32x32x16_bf16 v[240:255], v[124:127], v[136:139], v[240:255]
    s_mov_b32 s48, 0x3fb8aa3b
    s_mov_b32 s52, 0xbfb8aa3b
    s_nop 6
    v_cvt_pk_bf16_f32 v64, v192, v193
    v_cvt_pk_bf16_f32 v65, v194, v195
    v_cvt_pk_bf16_f32 v66, v196, v197
    v_cvt_pk_bf16_f32 v67, v198, v199
    v_cvt_pk_bf16_f32 v68, v200, v201
    v_cvt_pk_bf16_f32 v69, v202, v203
    v_cvt_pk_bf16_f32 v70, v204, v205
    v_cvt_pk_bf16_f32 v71, v206, v207
    s_waitcnt lgkmcnt(0)
    v_mfma_f32_32x32x16_bf16 v[192:207], v[40:43], v[64:67], 0
    v_mfma_f32_32x32x16_bf16 v[192:207], v[44:47], v[68:71], v[192:207]
    v_cvt_pk_bf16_f32 v72, v208, v209
    v_cvt_pk_bf16_f32 v73, v210, v211
    v_cvt_pk_bf16_f32 v74, v212, v213
    v_cvt_pk_bf16_f32 v75, v214, v215
    v_cvt_pk_bf16_f32 v76, v216, v217
    v_cvt_pk_bf16_f32 v77, v218, v219
    v_cvt_pk_bf16_f32 v78, v220, v221
    v_cvt_pk_bf16_f32 v79, v222, v223
    v_mfma_f32_32x32x16_bf16 v[208:223], v[40:43], v[72:75], 0
    s_nop 0
    v_mfma_f32_32x32x16_bf16 v[208:223], v[44:47], v[76:79], v[208:223]
    v_readfirstlane_b32 s72, v24
    v_readfirstlane_b32 s73, v25
    v_readfirstlane_b32 s74, v26
    v_and_b32 v27, 3, v2
    v_lshlrev_b32 v27, 3, v27
    v_bfe_u32 v27, v26, v27, 8
    v_mov_b32 v28, 0xffffff00
    s_and_b32 s76, s74, 0xff
    s_bfe_u32 s77, s74, 0x80008
    s_bfe_u32 s78, s74, 0x80010
    s_lshr_b32 s79, s74, 24
    v_cvt_pk_bf16_f32 v80, v224, v225
    v_cvt_pk_bf16_f32 v81, v226, v227
    v_cvt_pk_bf16_f32 v82, v228, v229
    v_cvt_pk_bf16_f32 v83, v230, v231
    v_cvt_pk_bf16_f32 v84, v232, v233
    v_cvt_pk_bf16_f32 v85, v234, v235
    v_cvt_pk_bf16_f32 v86, v236, v237
    v_cvt_pk_bf16_f32 v87, v238, v239
    v_cvt_pk_bf16_f32 v88, v240, v241
    v_cvt_pk_bf16_f32 v89, v242, v243
    v_cvt_pk_bf16_f32 v90, v244, v245
    v_cvt_pk_bf16_f32 v91, v246, v247
    v_cvt_pk_bf16_f32 v92, v248, v249
    v_cvt_pk_bf16_f32 v93, v250, v251
    v_cvt_pk_bf16_f32 v94, v252, v253
    v_cvt_pk_bf16_f32 v95, v254, v255
    v_cvt_pk_bf16_f32 v64, v192, v193
    v_cvt_pk_bf16_f32 v65, v194, v195
    v_cvt_pk_bf16_f32 v66, v196, v197
    v_cvt_pk_bf16_f32 v67, v198, v199
    v_cvt_pk_bf16_f32 v68, v200, v201
    v_cvt_pk_bf16_f32 v69, v202, v203
    v_cvt_pk_bf16_f32 v70, v204, v205
    v_cvt_pk_bf16_f32 v71, v206, v207
    v_lshlrev_b32 v192, 16, v64
    v_and_b32 v193, 0xffff0000, v64
    v_lshlrev_b32 v194, 16, v65
    v_and_b32 v195, 0xffff0000, v65
    v_lshlrev_b32 v196, 16, v66
    v_and_b32 v197, 0xffff0000, v66
    v_lshlrev_b32 v198, 16, v67
    v_and_b32 v199, 0xffff0000, v67
    v_lshlrev_b32 v200, 16, v68
    v_and_b32 v201, 0xffff0000, v68
    v_lshlrev_b32 v202, 16, v69
    v_and_b32 v203, 0xffff0000, v69
    v_lshlrev_b32 v204, 16, v70
    v_and_b32 v205, 0xffff0000, v70
    v_lshlrev_b32 v206, 16, v71
    v_and_b32 v207, 0xffff0000, v71
    v_cvt_pk_bf16_f32 v72, v208, v209
    v_cvt_pk_bf16_f32 v73, v210, v211
    v_cvt_pk_bf16_f32 v74, v212, v213
    v_cvt_pk_bf16_f32 v75, v214, v215
    v_cvt_pk_bf16_f32 v76, v216, v217
    v_cvt_pk_bf16_f32 v77, v218, v219
    v_cvt_pk_bf16_f32 v78, v220, v221
    v_cvt_pk_bf16_f32 v79, v222, v223
    v_lshlrev_b32 v208, 16, v72
    v_and_b32 v209, 0xffff0000, v72
    v_lshlrev_b32 v210, 16, v73
    v_and_b32 v211, 0xffff0000, v73
    v_lshlrev_b32 v212, 16, v74
    v_and_b32 v213, 0xffff0000, v74
    v_lshlrev_b32 v214, 16, v75
    v_and_b32 v215, 0xffff0000, v75
    v_lshlrev_b32 v216, 16, v76
    v_and_b32 v217, 0xffff0000, v76
    v_lshlrev_b32 v218, 16, v77
    v_and_b32 v219, 0xffff0000, v77
    v_lshlrev_b32 v220, 16, v78
    v_and_b32 v221, 0xffff0000, v78
    v_lshlrev_b32 v222, 16, v79
    v_and_b32 v223, 0xffff0000, v79
    v_max3_f32 v144, v192, v193, v194
    v_max3_f32 v145, v195, v196, v197
    v_max3_f32 v146, v198, v199, v200
    v_max3_f32 v147, v201, v202, v203
    v_max3_f32 v148, v204, v205, v206
    v_max3_f32 v144, v144, v145, v207
    v_max3_f32 v146, v146, v147, v148
    v_max_f32 v144, v144, v146
    v_min3_f32 v150, v192, v193, v194
    v_min3_f32 v151, v195, v196, v197
    v_min3_f32 v152, v198, v199, v200
    v_min3_f32 v153, v201, v202, v203
    v_min3_f32 v154, v204, v205, v206
    v_min3_f32 v150, v150, v151, v207
    v_min3_f32 v152, v152, v153, v154
    v_min_f32 v150, v150, v152
    v_mov_b32 v145, v144
    v_mov_b32 v151, v150
    s_nop 0
    v_permlane32_swap_b32 v144, v145
    v_permlane32_swap_b32 v150, v151
    v_max_f32 v144, v144, v145
    v_min_f32 v150, v150, v151
    v_mul_f32 v144, s52, v144
    v_mul_f32 v150, s48, v150
    v_pk_fma_f32 v[224:225], v[192:193], s[48:49], v[144:145] op_sel_hi:[1,0,0]
    v_pk_fma_f32 v[112:113], v[192:193], s[52:53], v[150:151] op_sel_hi:[1,0,0]
    v_pk_fma_f32 v[226:227], v[194:195], s[48:49], v[144:145] op_sel_hi:[1,0,0]
    v_pk_fma_f32 v[114:115], v[194:195], s[52:53], v[150:151] op_sel_hi:[1,0,0]
    v_pk_fma_f32 v[228:229], v[196:197], s[48:49], v[144:145] op_sel_hi:[1,0,0]
    v_pk_fma_f32 v[116:117], v[196:197], s[52:53], v[150:151] op_sel_hi:[1,0,0]
    v_pk_fma_f32 v[230:231], v[198:199], s[48:49], v[144:145] op_sel_hi:[1,0,0]
    v_pk_fma_f32 v[118:119], v[198:199], s[52:53], v[150:151] op_sel_hi:[1,0,0]
    v_pk_fma_f32 v[232:233], v[200:201], s[48:49], v[144:145] op_sel_hi:[1,0,0]
    v_pk_fma_f32 v[120:121], v[200:201], s[52:53], v[150:151] op_sel_hi:[1,0,0]
    v_pk_fma_f32 v[234:235], v[202:203], s[48:49], v[144:145] op_sel_hi:[1,0,0]
    v_pk_fma_f32 v[122:123], v[202:203], s[52:53], v[150:151] op_sel_hi:[1,0,0]
    v_pk_fma_f32 v[236:237], v[204:205], s[48:49], v[144:145] op_sel_hi:[1,0,0]
    v_pk_fma_f32 v[124:125], v[204:205], s[52:53], v[150:151] op_sel_hi:[1,0,0]
    v_pk_fma_f32 v[238:239], v[206:207], s[48:49], v[144:145] op_sel_hi:[1,0,0]
    v_pk_fma_f32 v[126:127], v[206:207], s[52:53], v[150:151] op_sel_hi:[1,0,0]
    v_exp_f32 v224, v224
    v_exp_f32 v112, v112
    v_exp_f32 v225, v225
    v_exp_f32 v113, v113
    v_exp_f32 v226, v226
    v_exp_f32 v114, v114
    v_exp_f32 v227, v227
    v_exp_f32 v115, v115
    v_exp_f32 v228, v228
    v_exp_f32 v116, v116
    v_exp_f32 v229, v229
    v_exp_f32 v117, v117
    v_exp_f32 v230, v230
    v_exp_f32 v118, v118
    v_exp_f32 v231, v231
    v_exp_f32 v119, v119
    v_exp_f32 v232, v232
    v_exp_f32 v120, v120
    v_exp_f32 v233, v233
    v_exp_f32 v121, v121
    v_exp_f32 v234, v234
    v_exp_f32 v122, v122
    v_exp_f32 v235, v235
    v_exp_f32 v123, v123
    v_exp_f32 v236, v236
    v_exp_f32 v124, v124
    v_exp_f32 v237, v237
    v_exp_f32 v125, v125
    v_exp_f32 v238, v238
    v_exp_f32 v126, v126
    v_exp_f32 v239, v239
    v_exp_f32 v127, v127
    v_pk_add_f32 v[144:145], v[224:225], v[226:227]
    v_pk_add_f32 v[146:147], v[228:229], v[230:231]
    v_pk_add_f32 v[148:149], v[232:233], v[234:235]
    v_pk_add_f32 v[150:151], v[112:113], v[114:115]
    v_pk_add_f32 v[152:153], v[116:117], v[118:119]
    v_pk_add_f32 v[154:155], v[120:121], v[122:123]
    v_pk_add_f32 v[144:145], v[144:145], v[236:237]
    v_pk_add_f32 v[146:147], v[146:147], v[238:239]
    v_pk_add_f32 v[150:151], v[150:151], v[124:125]
    v_pk_add_f32 v[152:153], v[152:153], v[126:127]
    v_pk_add_f32 v[144:145], v[144:145], v[148:149]
    v_pk_add_f32 v[150:151], v[150:151], v[154:155]
    v_pk_add_f32 v[144:145], v[144:145], v[146:147]
    v_pk_add_f32 v[150:151], v[150:151], v[152:153]
    v_add_f32 v144, v144, v145
    v_add_f32 v150, v150, v151
    v_mov_b32 v145, v144
    v_mov_b32 v151, v150
    s_nop 0
    v_permlane32_swap_b32 v144, v145
    v_permlane32_swap_b32 v150, v151
    v_add_f32 v144, v144, v145
    v_add_f32 v150, v150, v151
    v_rcp_f32 v144, v144
    v_rcp_f32 v150, v150
    v_pk_mul_f32 v[224:225], v[224:225], v[144:145] op_sel_hi:[1,0]
    v_pk_mul_f32 v[112:113], v[112:113], v[150:151] op_sel_hi:[1,0]
    v_pk_mul_f32 v[226:227], v[226:227], v[144:145] op_sel_hi:[1,0]
    v_pk_mul_f32 v[114:115], v[114:115], v[150:151] op_sel_hi:[1,0]
    v_pk_mul_f32 v[228:229], v[228:229], v[144:145] op_sel_hi:[1,0]
    v_pk_mul_f32 v[116:117], v[116:117], v[150:151] op_sel_hi:[1,0]
    v_pk_mul_f32 v[230:231], v[230:231], v[144:145] op_sel_hi:[1,0]
    v_pk_mul_f32 v[118:119], v[118:119], v[150:151] op_sel_hi:[1,0]
    v_pk_mul_f32 v[232:233], v[232:233], v[144:145] op_sel_hi:[1,0]
    v_pk_mul_f32 v[120:121], v[120:121], v[150:151] op_sel_hi:[1,0]
    v_pk_mul_f32 v[234:235], v[234:235], v[144:145] op_sel_hi:[1,0]
    v_pk_mul_f32 v[122:123], v[122:123], v[150:151] op_sel_hi:[1,0]
    v_pk_mul_f32 v[236:237], v[236:237], v[144:145] op_sel_hi:[1,0]
    v_pk_mul_f32 v[124:125], v[124:125], v[150:151] op_sel_hi:[1,0]
    v_pk_mul_f32 v[238:239], v[238:239], v[144:145] op_sel_hi:[1,0]
    v_pk_mul_f32 v[126:127], v[126:127], v[150:151] op_sel_hi:[1,0]
    v_cvt_pk_bf16_f32 v64, v224, v225
    v_cvt_pk_bf16_f32 v96, v112, v113
    v_cvt_pk_bf16_f32 v65, v226, v227
    v_cvt_pk_bf16_f32 v97, v114, v115
    v_cvt_pk_bf16_f32 v66, v228, v229
    v_cvt_pk_bf16_f32 v98, v116, v117
    v_cvt_pk_bf16_f32 v67, v230, v231
    v_cvt_pk_bf16_f32 v99, v118, v119
    v_cvt_pk_bf16_f32 v68, v232, v233
    v_cvt_pk_bf16_f32 v100, v120, v121
    v_cvt_pk_bf16_f32 v69, v234, v235
    v_cvt_pk_bf16_f32 v101, v122, v123
    v_cvt_pk_bf16_f32 v70, v236, v237
    v_cvt_pk_bf16_f32 v102, v124, v125
    v_cvt_pk_bf16_f32 v71, v238, v239
    v_cvt_pk_bf16_f32 v103, v126, v127
    v_mfma_f32_32x32x16_bf16 v[192:207], v[64:67], v[48:51], 0
    v_mfma_f32_32x32x16_bf16 v[192:207], v[68:71], v[52:55], v[192:207]
    v_mfma_f32_32x32x16_bf16 v[224:239], v[96:99], v[48:51], 0
    v_mfma_f32_32x32x16_bf16 v[224:239], v[100:103], v[52:55], v[224:239]
    v_max3_f32 v144, v208, v209, v210
    v_max3_f32 v145, v211, v212, v213
    v_max3_f32 v146, v214, v215, v216
    v_max3_f32 v147, v217, v218, v219
    v_max3_f32 v148, v220, v221, v222
    v_max3_f32 v144, v144, v145, v223
    v_max3_f32 v146, v146, v147, v148
    v_max_f32 v144, v144, v146
    v_min3_f32 v150, v208, v209, v210
    v_min3_f32 v151, v211, v212, v213
    v_min3_f32 v152, v214, v215, v216
    v_min3_f32 v153, v217, v218, v219
    v_min3_f32 v154, v220, v221, v222
    v_min3_f32 v150, v150, v151, v223
    v_min3_f32 v152, v152, v153, v154
    v_min_f32 v150, v150, v152
    v_mov_b32 v145, v144
    v_mov_b32 v151, v150
    s_nop 0
    v_permlane32_swap_b32 v144, v145
    v_permlane32_swap_b32 v150, v151
    v_max_f32 v144, v144, v145
    v_min_f32 v150, v150, v151
    v_mul_f32 v144, s52, v144
    v_mul_f32 v150, s48, v150
    v_pk_fma_f32 v[240:241], v[208:209], s[48:49], v[144:145] op_sel_hi:[1,0,0]
    v_pk_fma_f32 v[128:129], v[208:209], s[52:53], v[150:151] op_sel_hi:[1,0,0]
    v_pk_fma_f32 v[242:243], v[210:211], s[48:49], v[144:145] op_sel_hi:[1,0,0]
    v_pk_fma_f32 v[130:131], v[210:211], s[52:53], v[150:151] op_sel_hi:[1,0,0]
    v_pk_fma_f32 v[244:245], v[212:213], s[48:49], v[144:145] op_sel_hi:[1,0,0]
    v_pk_fma_f32 v[132:133], v[212:213], s[52:53], v[150:151] op_sel_hi:[1,0,0]
    v_pk_fma_f32 v[246:247], v[214:215], s[48:49], v[144:145] op_sel_hi:[1,0,0]
    v_pk_fma_f32 v[134:135], v[214:215], s[52:53], v[150:151] op_sel_hi:[1,0,0]
    v_pk_fma_f32 v[248:249], v[216:217], s[48:49], v[144:145] op_sel_hi:[1,0,0]
    v_pk_fma_f32 v[136:137], v[216:217], s[52:53], v[150:151] op_sel_hi:[1,0,0]
    v_pk_fma_f32 v[250:251], v[218:219], s[48:49], v[144:145] op_sel_hi:[1,0,0]
    v_pk_fma_f32 v[138:139], v[218:219], s[52:53], v[150:151] op_sel_hi:[1,0,0]
    v_pk_fma_f32 v[252:253], v[220:221], s[48:49], v[144:145] op_sel_hi:[1,0,0]
    v_pk_fma_f32 v[140:141], v[220:221], s[52:53], v[150:151] op_sel_hi:[1,0,0]
    v_pk_fma_f32 v[254:255], v[222:223], s[48:49], v[144:145] op_sel_hi:[1,0,0]
    v_pk_fma_f32 v[142:143], v[222:223], s[52:53], v[150:151] op_sel_hi:[1,0,0]
    v_exp_f32 v240, v240
    v_exp_f32 v128, v128
    v_exp_f32 v241, v241
    v_exp_f32 v129, v129
    v_exp_f32 v242, v242
    v_exp_f32 v130, v130
    v_exp_f32 v243, v243
    v_exp_f32 v131, v131
    v_exp_f32 v244, v244
    v_exp_f32 v132, v132
    v_exp_f32 v245, v245
    v_exp_f32 v133, v133
    v_exp_f32 v246, v246
    v_exp_f32 v134, v134
    v_exp_f32 v247, v247
    v_exp_f32 v135, v135
    v_exp_f32 v248, v248
    v_exp_f32 v136, v136
    v_exp_f32 v249, v249
    v_exp_f32 v137, v137
    v_exp_f32 v250, v250
    v_exp_f32 v138, v138
    v_exp_f32 v251, v251
    v_exp_f32 v139, v139
    v_exp_f32 v252, v252
    v_exp_f32 v140, v140
    v_exp_f32 v253, v253
    v_exp_f32 v141, v141
    v_exp_f32 v254, v254
    v_exp_f32 v142, v142
    v_exp_f32 v255, v255
    v_exp_f32 v143, v143
    v_pk_add_f32 v[144:145], v[240:241], v[242:243]
    v_pk_add_f32 v[146:147], v[244:245], v[246:247]
    v_pk_add_f32 v[148:149], v[248:249], v[250:251]
    v_pk_add_f32 v[150:151], v[128:129], v[130:131]
    v_pk_add_f32 v[152:153], v[132:133], v[134:135]
    v_pk_add_f32 v[154:155], v[136:137], v[138:139]
    v_pk_add_f32 v[144:145], v[144:145], v[252:253]
    v_pk_add_f32 v[146:147], v[146:147], v[254:255]
    v_pk_add_f32 v[150:151], v[150:151], v[140:141]
    v_pk_add_f32 v[152:153], v[152:153], v[142:143]
    v_pk_add_f32 v[144:145], v[144:145], v[148:149]
    v_pk_add_f32 v[150:151], v[150:151], v[154:155]
    v_pk_add_f32 v[144:145], v[144:145], v[146:147]
    v_pk_add_f32 v[150:151], v[150:151], v[152:153]
    v_add_f32 v144, v144, v145
    v_add_f32 v150, v150, v151
    v_mov_b32 v145, v144
    v_mov_b32 v151, v150
    s_nop 0
    v_permlane32_swap_b32 v144, v145
    v_permlane32_swap_b32 v150, v151
    v_add_f32 v144, v144, v145
    v_add_f32 v150, v150, v151
    v_rcp_f32 v144, v144
    v_rcp_f32 v150, v150
    v_pk_mul_f32 v[240:241], v[240:241], v[144:145] op_sel_hi:[1,0]
    v_pk_mul_f32 v[128:129], v[128:129], v[150:151] op_sel_hi:[1,0]
    v_pk_mul_f32 v[242:243], v[242:243], v[144:145] op_sel_hi:[1,0]
    v_pk_mul_f32 v[130:131], v[130:131], v[150:151] op_sel_hi:[1,0]
    v_pk_mul_f32 v[244:245], v[244:245], v[144:145] op_sel_hi:[1,0]
    v_pk_mul_f32 v[132:133], v[132:133], v[150:151] op_sel_hi:[1,0]
    v_pk_mul_f32 v[246:247], v[246:247], v[144:145] op_sel_hi:[1,0]
    v_pk_mul_f32 v[134:135], v[134:135], v[150:151] op_sel_hi:[1,0]
    v_pk_mul_f32 v[248:249], v[248:249], v[144:145] op_sel_hi:[1,0]
    v_pk_mul_f32 v[136:137], v[136:137], v[150:151] op_sel_hi:[1,0]
    v_pk_mul_f32 v[250:251], v[250:251], v[144:145] op_sel_hi:[1,0]
    v_pk_mul_f32 v[138:139], v[138:139], v[150:151] op_sel_hi:[1,0]
    v_pk_mul_f32 v[252:253], v[252:253], v[144:145] op_sel_hi:[1,0]
    v_pk_mul_f32 v[140:141], v[140:141], v[150:151] op_sel_hi:[1,0]
    v_pk_mul_f32 v[254:255], v[254:255], v[144:145] op_sel_hi:[1,0]
    v_pk_mul_f32 v[142:143], v[142:143], v[150:151] op_sel_hi:[1,0]
    v_cvt_pk_bf16_f32 v72, v240, v241
    v_cvt_pk_bf16_f32 v104, v128, v129
    v_cvt_pk_bf16_f32 v73, v242, v243
    v_cvt_pk_bf16_f32 v105, v130, v131
    v_cvt_pk_bf16_f32 v74, v244, v245
    v_cvt_pk_bf16_f32 v106, v132, v133
    v_cvt_pk_bf16_f32 v75, v246, v247
    v_cvt_pk_bf16_f32 v107, v134, v135
    v_cvt_pk_bf16_f32 v76, v248, v249
    v_cvt_pk_bf16_f32 v108, v136, v137
    v_cvt_pk_bf16_f32 v77, v250, v251
    v_cvt_pk_bf16_f32 v109, v138, v139
    v_cvt_pk_bf16_f32 v78, v252, v253
    v_cvt_pk_bf16_f32 v110, v140, v141
    v_cvt_pk_bf16_f32 v79, v254, v255
    v_cvt_pk_bf16_f32 v111, v142, v143
    v_mfma_f32_32x32x16_bf16 v[208:223], v[72:75], v[48:51], 0
    v_mfma_f32_32x32x16_bf16 v[208:223], v[76:79], v[52:55], v[208:223]
    v_mfma_f32_32x32x16_bf16 v[240:255], v[104:107], v[48:51], 0
    v_mfma_f32_32x32x16_bf16 v[240:255], v[108:111], v[52:55], v[240:255]
    v_cvt_pk_bf16_f32 v64, v192, v193
    v_cvt_pk_bf16_f32 v65, v194, v195
    v_cvt_pk_bf16_f32 v66, v196, v197
    v_cvt_pk_bf16_f32 v67, v198, v199
    v_cvt_pk_bf16_f32 v68, v200, v201
    v_cvt_pk_bf16_f32 v69, v202, v203
    v_cvt_pk_bf16_f32 v70, v204, v205
    v_cvt_pk_bf16_f32 v71, v206, v207
    v_cvt_pk_bf16_f32 v96, v224, v225
    v_cvt_pk_bf16_f32 v97, v226, v227
    v_cvt_pk_bf16_f32 v98, v228, v229
    v_cvt_pk_bf16_f32 v99, v230, v231
    v_cvt_pk_bf16_f32 v100, v232, v233
    v_cvt_pk_bf16_f32 v101, v234, v235
    v_cvt_pk_bf16_f32 v102, v236, v237
    v_cvt_pk_bf16_f32 v103, v238, v239
    v_mfma_f32_32x32x16_bf16 v[112:127], v[64:67], v[80:83], 0
    v_mfma_f32_32x32x16_bf16 v[112:127], v[68:71], v[84:87], v[112:127]
    v_mfma_f32_32x32x16_bf16 v[128:143], v[96:99], v[80:83], 0
    v_mfma_f32_32x32x16_bf16 v[128:143], v[100:103], v[84:87], v[128:143]
    v_mfma_f32_32x32x16_bf16 v[144:159], v[64:67], v[56:59], 0
    v_mfma_f32_32x32x16_bf16 v[144:159], v[68:71], v[56:59], v[144:159]
    v_mfma_f32_32x32x16_bf16 v[144:159], v[96:99], v[60:63], v[144:159]
    v_mfma_f32_32x32x16_bf16 v[144:159], v[100:103], v[60:63], v[144:159]
    v_cvt_pk_bf16_f32 v72, v208, v209
    v_cvt_pk_bf16_f32 v73, v210, v211
    v_cvt_pk_bf16_f32 v74, v212, v213
    v_cvt_pk_bf16_f32 v75, v214, v215
    v_cvt_pk_bf16_f32 v76, v216, v217
    v_cvt_pk_bf16_f32 v77, v218, v219
    v_cvt_pk_bf16_f32 v78, v220, v221
    v_cvt_pk_bf16_f32 v79, v222, v223
    v_cvt_pk_bf16_f32 v104, v240, v241
    v_cvt_pk_bf16_f32 v105, v242, v243
    v_cvt_pk_bf16_f32 v106, v244, v245
    v_cvt_pk_bf16_f32 v107, v246, v247
    v_cvt_pk_bf16_f32 v108, v248, v249
    v_cvt_pk_bf16_f32 v109, v250, v251
    v_cvt_pk_bf16_f32 v110, v252, v253
    v_cvt_pk_bf16_f32 v111, v254, v255
    v_mfma_f32_32x32x16_bf16 v[112:127], v[72:75], v[88:91], v[112:127]
    v_mfma_f32_32x32x16_bf16 v[112:127], v[76:79], v[92:95], v[112:127]
    v_mfma_f32_32x32x16_bf16 v[128:143], v[104:107], v[88:91], v[128:143]
    v_mfma_f32_32x32x16_bf16 v[128:143], v[108:111], v[92:95], v[128:143]
    v_mfma_f32_32x32x16_bf16 v[144:159], v[72:75], v[56:59], v[144:159]
    v_mfma_f32_32x32x16_bf16 v[144:159], v[76:79], v[56:59], v[144:159]
    v_mfma_f32_32x32x16_bf16 v[144:159], v[104:107], v[60:63], v[144:159]
    v_mfma_f32_32x32x16_bf16 v[144:159], v[108:111], v[60:63], v[144:159]
    s_cmp_eq_u32 s21, 0
    s_cbranch_scc0 L_c_rw1
    s_nop 5
    ds_write_b128 v8, v[128:131] offset:0
    ds_write_b128 v8, v[132:135] offset:1024
    ds_write_b128 v8, v[136:139] offset:2048
    ds_write_b128 v8, v[140:143] offset:3072
    s_mov_b32 exec_lo, s45
    s_mov_b32 exec_hi, s45
    ds_write_b128 v10, v[144:147] offset:4096
    ds_write_b128 v10, v[148:151] offset:4128
    ds_write_b128 v10, v[152:155] offset:4160
    ds_write_b128 v10, v[156:159] offset:4192
    ds_write_b32 v13, v15
    s_mov_b64 exec, -1
    s_mov_b32 s13, 0
L_c_x0:
    ds_read_b32 v16, v14
    ds_read_b128 v[192:195], v9 offset:0
    ds_read_b128 v[196:199], v9 offset:1024
    ds_read_b128 v[200:203], v9 offset:2048
    ds_read_b128 v[204:207], v9 offset:3072
    ds_read_b32 v208, v11 offset:4096
    ds_read_b32 v209, v11 offset:4224
    s_add_u32 s13, s13, 1
    s_cmp_ge_u32 s13, 262144
    s_cbranch_scc1 L_c_y0
    s_waitcnt lgkmcnt(6)
    v_cmp_eq_u32 vcc, 1, v16
    s_cbranch_vccz L_c_x0
L_c_y0:
    s_waitcnt lgkmcnt(2)
    v_pk_add_f32 v[112:113], v[112:113], v[192:193]
    v_pk_add_f32 v[114:115], v[114:115], v[194:195]
    v_pk_add_f32 v[116:117], v[116:117], v[196:197]
    v_pk_add_f32 v[118:119], v[118:119], v[198:199]
    v_pk_add_f32 v[120:121], v[120:121], v[200:201]
    v_pk_add_f32 v[122:123], v[122:123], v[202:203]
    v_pk_add_f32 v[124:125], v[124:125], v[204:205]
    v_pk_add_f32 v[126:127], v[126:127], v[206:207]
    v_and_or_b32 v112, v112, v28, v27
    buffer_store_dwordx4 v[112:115], v6, s[32:35], s40 offen offset:0 sc1
    v_and_or_b32 v116, v116, v28, v27
    buffer_store_dwordx4 v[116:119], v6, s[32:35], s40 offen offset:512 sc1
    v_and_or_b32 v120, v120, v28, v27
    buffer_store_dwordx4 v[120:123], v6, s[32:35], s41 offen offset:0 sc1
    v_and_or_b32 v124, v124, v28, v27
    buffer_store_dwordx4 v[124:127], v6, s[32:35], s41 offen offset:512 sc1
    s_branch L_c_zs
L_c_rw1:
    s_nop 7
    ds_write_b128 v8, v[112:115] offset:0
    ds_write_b128 v8, v[116:119] offset:1024
    ds_write_b128 v8, v[120:123] offset:2048
    ds_write_b128 v8, v[124:127] offset:3072
    s_mov_b32 exec_lo, s45
    s_mov_b32 exec_hi, s45
    ds_write_b128 v10, v[144:147] offset:4096
    ds_write_b128 v10, v[148:151] offset:4128
    ds_write_b128 v10, v[152:155] offset:4160
    ds_write_b128 v10, v[156:159] offset:4192
    ds_write_b32 v13, v15
    s_mov_b64 exec, -1
    s_mov_b32 s13, 0
L_c_x1:
    ds_read_b32 v16, v14
    ds_read_b128 v[192:195], v9 offset:0
    ds_read_b128 v[196:199], v9 offset:1024
    ds_read_b128 v[200:203], v9 offset:2048
    ds_read_b128 v[204:207], v9 offset:3072
    ds_read_b32 v208, v11 offset:4096
    ds_read_b32 v209, v11 offset:4224
    s_add_u32 s13, s13, 1
    s_cmp_ge_u32 s13, 262144
    s_cbranch_scc1 L_c_y1
    s_waitcnt lgkmcnt(6)
    v_cmp_eq_u32 vcc, 1, v16
    s_cbranch_vccz L_c_x1
L_c_y1:
    s_waitcnt lgkmcnt(2)
    v_pk_add_f32 v[128:129], v[128:129], v[192:193]
    v_pk_add_f32 v[130:131], v[130:131], v[194:195]
    v_pk_add_f32 v[132:133], v[132:133], v[196:197]
    v_pk_add_f32 v[134:135], v[134:135], v[198:199]
    v_pk_add_f32 v[136:137], v[136:137], v[200:201]
    v_pk_add_f32 v[138:139], v[138:139], v[202:203]
    v_pk_add_f32 v[140:141], v[140:141], v[204:205]
    v_pk_add_f32 v[142:143], v[142:143], v[206:207]
    v_and_or_b32 v128, v128, v28, v27
    buffer_store_dwordx4 v[128:131], v6, s[32:35], s40 offen offset:0 sc1
    v_and_or_b32 v132, v132, v28, v27
    buffer_store_dwordx4 v[132:135], v6, s[32:35], s40 offen offset:512 sc1
    v_and_or_b32 v136, v136, v28, v27
    buffer_store_dwordx4 v[136:139], v6, s[32:35], s41 offen offset:0 sc1
    v_and_or_b32 v140, v140, v28, v27
    buffer_store_dwordx4 v[140:143], v6, s[32:35], s41 offen offset:512 sc1
L_c_zs:
    s_waitcnt lgkmcnt(0)
    v_add_f32 v208, v208, v209
    v_and_or_b32 v208, v208, v28, v27
    s_mov_b32 exec_hi, 0
    buffer_store_dword v208, v7, s[32:35], s42 offen sc1
    s_mov_b32 exec_lo, 1
    ds_write_b32 v13, v15 offset:96
    s_mov_b64 exec, -1
    v_cvt_pk_bf16_f32 v64, v160, v161
    v_cvt_pk_bf16_f32 v65, v162, v163
    v_cvt_pk_bf16_f32 v66, v164, v165
    v_cvt_pk_bf16_f32 v67, v166, v167
    v_cvt_pk_bf16_f32 v68, v168, v169
    v_cvt_pk_bf16_f32 v69, v170, v171
    v_cvt_pk_bf16_f32 v70, v172, v173
    v_cvt_pk_bf16_f32 v71, v174, v175
    v_mfma_f32_32x32x16_bf16 v[160:175], v[40:43], v[64:67], 0
    s_nop 0
    v_mfma_f32_32x32x16_bf16 v[160:175], v[44:47], v[68:71], v[160:175]
    v_cvt_pk_bf16_f32 v72, v176, v177
    v_cvt_pk_bf16_f32 v73, v178, v179
    v_cvt_pk_bf16_f32 v74, v180, v181
    v_cvt_pk_bf16_f32 v75, v182, v183
    v_cvt_pk_bf16_f32 v76, v184, v185
    v_cvt_pk_bf16_f32 v77, v186, v187
    v_cvt_pk_bf16_f32 v78, v188, v189
    v_cvt_pk_bf16_f32 v79, v190, v191
    v_mfma_f32_32x32x16_bf16 v[176:191], v[40:43], v[72:75], 0
    s_nop 0
    v_mfma_f32_32x32x16_bf16 v[176:191], v[44:47], v[76:79], v[176:191]
    s_nop 0
    v_cvt_pk_bf16_f32 v64, v160, v161
    v_cvt_pk_bf16_f32 v65, v162, v163
    v_cvt_pk_bf16_f32 v66, v164, v165
    v_cvt_pk_bf16_f32 v67, v166, v167
    v_cvt_pk_bf16_f32 v68, v168, v169
    v_cvt_pk_bf16_f32 v69, v170, v171
    v_cvt_pk_bf16_f32 v70, v172, v173
    v_cvt_pk_bf16_f32 v71, v174, v175
    v_lshlrev_b32 v160, 16, v64
    v_and_b32 v161, 0xffff0000, v64
    v_lshlrev_b32 v162, 16, v65
    v_and_b32 v163, 0xffff0000, v65
    v_lshlrev_b32 v164, 16, v66
    v_and_b32 v165, 0xffff0000, v66
    v_lshlrev_b32 v166, 16, v67
    v_and_b32 v167, 0xffff0000, v67
    v_lshlrev_b32 v168, 16, v68
    v_and_b32 v169, 0xffff0000, v68
    v_lshlrev_b32 v170, 16, v69
    v_and_b32 v171, 0xffff0000, v69
    v_lshlrev_b32 v172, 16, v70
    v_and_b32 v173, 0xffff0000, v70
    v_lshlrev_b32 v174, 16, v71
    v_and_b32 v175, 0xffff0000, v71
    v_cvt_pk_bf16_f32 v72, v176, v177
    v_cvt_pk_bf16_f32 v73, v178, v179
    v_cvt_pk_bf16_f32 v74, v180, v181
    v_cvt_pk_bf16_f32 v75, v182, v183
    v_cvt_pk_bf16_f32 v76, v184, v185
    v_cvt_pk_bf16_f32 v77, v186, v187
    v_cvt_pk_bf16_f32 v78, v188, v189
    v_cvt_pk_bf16_f32 v79, v190, v191
    v_lshlrev_b32 v176, 16, v72
    v_and_b32 v177, 0xffff0000, v72
    v_lshlrev_b32 v178, 16, v73
    v_and_b32 v179, 0xffff0000, v73
    v_lshlrev_b32 v180, 16, v74
    v_and_b32 v181, 0xffff0000, v74
    v_lshlrev_b32 v182, 16, v75
    v_and_b32 v183, 0xffff0000, v75
    v_lshlrev_b32 v184, 16, v76
    v_and_b32 v185, 0xffff0000, v76
    v_lshlrev_b32 v186, 16, v77
    v_and_b32 v187, 0xffff0000, v77
    v_lshlrev_b32 v188, 16, v78
    v_and_b32 v189, 0xffff0000, v78
    v_lshlrev_b32 v190, 16, v79
    v_and_b32 v191, 0xffff0000, v79
    v_max3_f32 v24, v160, v161, v162
    v_max3_f32 v25, v163, v164, v165
    v_max3_f32 v26, v166, v167, v168
    v_max3_f32 v27, v169, v170, v171
    v_max3_f32 v28, v172, v173, v174
    v_max3_f32 v24, v24, v25, v175
    v_max3_f32 v26, v26, v27, v28
    v_max_f32 v24, v24, v26
    v_min3_f32 v30, v160, v161, v162
    v_min3_f32 v31, v163, v164, v165
    v_min3_f32 v32, v166, v167, v168
    v_min3_f32 v33, v169, v170, v171
    v_min3_f32 v34, v172, v173, v174
    v_min3_f32 v30, v30, v31, v175
    v_min3_f32 v32, v32, v33, v34
    v_min_f32 v30, v30, v32
    v_mov_b32 v25, v24
    v_mov_b32 v31, v30
    s_nop 0
    v_permlane32_swap_b32 v24, v25
    v_permlane32_swap_b32 v30, v31
    v_max_f32 v24, v24, v25
    v_min_f32 v30, v30, v31
    v_mul_f32 v24, s52, v24
    v_mul_f32 v30, s48, v30
    v_pk_fma_f32 v[192:193], v[160:161], s[48:49], v[24:25] op_sel_hi:[1,0,0]
    v_pk_fma_f32 v[224:225], v[160:161], s[52:53], v[30:31] op_sel_hi:[1,0,0]
    v_pk_fma_f32 v[194:195], v[162:163], s[48:49], v[24:25] op_sel_hi:[1,0,0]
    v_pk_fma_f32 v[226:227], v[162:163], s[52:53], v[30:31] op_sel_hi:[1,0,0]
    v_pk_fma_f32 v[196:197], v[164:165], s[48:49], v[24:25] op_sel_hi:[1,0,0]
    v_pk_fma_f32 v[228:229], v[164:165], s[52:53], v[30:31] op_sel_hi:[1,0,0]
    v_pk_fma_f32 v[198:199], v[166:167], s[48:49], v[24:25] op_sel_hi:[1,0,0]
    v_pk_fma_f32 v[230:231], v[166:167], s[52:53], v[30:31] op_sel_hi:[1,0,0]
    v_pk_fma_f32 v[200:201], v[168:169], s[48:49], v[24:25] op_sel_hi:[1,0,0]
    v_pk_fma_f32 v[232:233], v[168:169], s[52:53], v[30:31] op_sel_hi:[1,0,0]
    v_pk_fma_f32 v[202:203], v[170:171], s[48:49], v[24:25] op_sel_hi:[1,0,0]
    v_pk_fma_f32 v[234:235], v[170:171], s[52:53], v[30:31] op_sel_hi:[1,0,0]
    v_pk_fma_f32 v[204:205], v[172:173], s[48:49], v[24:25] op_sel_hi:[1,0,0]
    v_pk_fma_f32 v[236:237], v[172:173], s[52:53], v[30:31] op_sel_hi:[1,0,0]
    v_pk_fma_f32 v[206:207], v[174:175], s[48:49], v[24:25] op_sel_hi:[1,0,0]
    v_pk_fma_f32 v[238:239], v[174:175], s[52:53], v[30:31] op_sel_hi:[1,0,0]
    v_exp_f32 v192, v192
    v_exp_f32 v224, v224
    v_exp_f32 v193, v193
    v_exp_f32 v225, v225
    v_exp_f32 v194, v194
    v_exp_f32 v226, v226
    v_exp_f32 v195, v195
    v_exp_f32 v227, v227
    v_exp_f32 v196, v196
    v_exp_f32 v228, v228
    v_exp_f32 v197, v197
    v_exp_f32 v229, v229
    v_exp_f32 v198, v198
    v_exp_f32 v230, v230
    v_exp_f32 v199, v199
    v_exp_f32 v231, v231
    v_exp_f32 v200, v200
    v_exp_f32 v232, v232
    v_exp_f32 v201, v201
    v_exp_f32 v233, v233
    v_exp_f32 v202, v202
    v_exp_f32 v234, v234
    v_exp_f32 v203, v203
    v_exp_f32 v235, v235
    v_exp_f32 v204, v204
    v_exp_f32 v236, v236
    v_exp_f32 v205, v205
    v_exp_f32 v237, v237
    v_exp_f32 v206, v206
    v_exp_f32 v238, v238
    v_exp_f32 v207, v207
    v_exp_f32 v239, v239
    v_pk_add_f32 v[24:25], v[192:193], v[194:195]
    v_pk_add_f32 v[26:27], v[196:197], v[198:199]
    v_pk_add_f32 v[28:29], v[200:201], v[202:203]
    v_pk_add_f32 v[30:31], v[224:225], v[226:227]
    v_pk_add_f32 v[32:33], v[228:229], v[230:231]
    v_pk_add_f32 v[34:35], v[232:233], v[234:235]
    v_pk_add_f32 v[24:25], v[24:25], v[204:205]
    v_pk_add_f32 v[26:27], v[26:27], v[206:207]
    v_pk_add_f32 v[30:31], v[30:31], v[236:237]
    v_pk_add_f32 v[32:33], v[32:33], v[238:239]
    v_pk_add_f32 v[24:25], v[24:25], v[28:29]
    v_pk_add_f32 v[30:31], v[30:31], v[34:35]
    v_pk_add_f32 v[24:25], v[24:25], v[26:27]
    v_pk_add_f32 v[30:31], v[30:31], v[32:33]
    v_add_f32 v24, v24, v25
    v_add_f32 v30, v30, v31
    v_mov_b32 v25, v24
    v_mov_b32 v31, v30
    s_nop 0
    v_permlane32_swap_b32 v24, v25
    v_permlane32_swap_b32 v30, v31
    v_add_f32 v24, v24, v25
    v_add_f32 v30, v30, v31
    v_rcp_f32 v24, v24
    v_rcp_f32 v30, v30
    v_pk_mul_f32 v[192:193], v[192:193], v[24:25] op_sel_hi:[1,0]
    v_pk_mul_f32 v[224:225], v[224:225], v[30:31] op_sel_hi:[1,0]
    v_pk_mul_f32 v[194:195], v[194:195], v[24:25] op_sel_hi:[1,0]
    v_pk_mul_f32 v[226:227], v[226:227], v[30:31] op_sel_hi:[1,0]
    v_pk_mul_f32 v[196:197], v[196:197], v[24:25] op_sel_hi:[1,0]
    v_pk_mul_f32 v[228:229], v[228:229], v[30:31] op_sel_hi:[1,0]
    v_pk_mul_f32 v[198:199], v[198:199], v[24:25] op_sel_hi:[1,0]
    v_pk_mul_f32 v[230:231], v[230:231], v[30:31] op_sel_hi:[1,0]
    v_pk_mul_f32 v[200:201], v[200:201], v[24:25] op_sel_hi:[1,0]
    v_pk_mul_f32 v[232:233], v[232:233], v[30:31] op_sel_hi:[1,0]
    v_pk_mul_f32 v[202:203], v[202:203], v[24:25] op_sel_hi:[1,0]
    v_pk_mul_f32 v[234:235], v[234:235], v[30:31] op_sel_hi:[1,0]
    v_pk_mul_f32 v[204:205], v[204:205], v[24:25] op_sel_hi:[1,0]
    v_pk_mul_f32 v[236:237], v[236:237], v[30:31] op_sel_hi:[1,0]
    v_pk_mul_f32 v[206:207], v[206:207], v[24:25] op_sel_hi:[1,0]
    v_pk_mul_f32 v[238:239], v[238:239], v[30:31] op_sel_hi:[1,0]
    v_cvt_pk_bf16_f32 v80, v192, v193
    v_cvt_pk_bf16_f32 v88, v224, v225
    v_cvt_pk_bf16_f32 v81, v194, v195
    v_cvt_pk_bf16_f32 v89, v226, v227
    v_cvt_pk_bf16_f32 v82, v196, v197
    v_cvt_pk_bf16_f32 v90, v228, v229
    v_cvt_pk_bf16_f32 v83, v198, v199
    v_cvt_pk_bf16_f32 v91, v230, v231
    v_cvt_pk_bf16_f32 v84, v200, v201
    v_cvt_pk_bf16_f32 v92, v232, v233
    v_cvt_pk_bf16_f32 v85, v202, v203
    v_cvt_pk_bf16_f32 v93, v234, v235
    v_cvt_pk_bf16_f32 v86, v204, v205
    v_cvt_pk_bf16_f32 v94, v236, v237
    v_cvt_pk_bf16_f32 v87, v206, v207
    v_cvt_pk_bf16_f32 v95, v238, v239
    v_max3_f32 v24, v176, v177, v178
    v_max3_f32 v25, v179, v180, v181
    v_max3_f32 v26, v182, v183, v184
    v_max3_f32 v27, v185, v186, v187
    v_max3_f32 v28, v188, v189, v190
    v_max3_f32 v24, v24, v25, v191
    v_max3_f32 v26, v26, v27, v28
    v_max_f32 v24, v24, v26
    v_min3_f32 v30, v176, v177, v178
    v_min3_f32 v31, v179, v180, v181
    v_min3_f32 v32, v182, v183, v184
    v_min3_f32 v33, v185, v186, v187
    v_min3_f32 v34, v188, v189, v190
    v_min3_f32 v30, v30, v31, v191
    v_min3_f32 v32, v32, v33, v34
    v_min_f32 v30, v30, v32
    v_mov_b32 v25, v24
    v_mov_b32 v31, v30
    s_nop 0
    v_permlane32_swap_b32 v24, v25
    v_permlane32_swap_b32 v30, v31
    v_max_f32 v24, v24, v25
    v_min_f32 v30, v30, v31
    v_mul_f32 v24, s52, v24
    v_mul_f32 v30, s48, v30
    v_pk_fma_f32 v[208:209], v[176:177], s[48:49], v[24:25] op_sel_hi:[1,0,0]
    v_pk_fma_f32 v[240:241], v[176:177], s[52:53], v[30:31] op_sel_hi:[1,0,0]
    v_pk_fma_f32 v[210:211], v[178:179], s[48:49], v[24:25] op_sel_hi:[1,0,0]
    v_pk_fma_f32 v[242:243], v[178:179], s[52:53], v[30:31] op_sel_hi:[1,0,0]
    v_pk_fma_f32 v[212:213], v[180:181], s[48:49], v[24:25] op_sel_hi:[1,0,0]
    v_pk_fma_f32 v[244:245], v[180:181], s[52:53], v[30:31] op_sel_hi:[1,0,0]
    v_pk_fma_f32 v[214:215], v[182:183], s[48:49], v[24:25] op_sel_hi:[1,0,0]
    v_pk_fma_f32 v[246:247], v[182:183], s[52:53], v[30:31] op_sel_hi:[1,0,0]
    v_pk_fma_f32 v[216:217], v[184:185], s[48:49], v[24:25] op_sel_hi:[1,0,0]
    v_pk_fma_f32 v[248:249], v[184:185], s[52:53], v[30:31] op_sel_hi:[1,0,0]
    v_pk_fma_f32 v[218:219], v[186:187], s[48:49], v[24:25] op_sel_hi:[1,0,0]
    v_pk_fma_f32 v[250:251], v[186:187], s[52:53], v[30:31] op_sel_hi:[1,0,0]
    v_pk_fma_f32 v[220:221], v[188:189], s[48:49], v[24:25] op_sel_hi:[1,0,0]
    v_pk_fma_f32 v[252:253], v[188:189], s[52:53], v[30:31] op_sel_hi:[1,0,0]
    v_pk_fma_f32 v[222:223], v[190:191], s[48:49], v[24:25] op_sel_hi:[1,0,0]
    v_pk_fma_f32 v[254:255], v[190:191], s[52:53], v[30:31] op_sel_hi:[1,0,0]
    v_exp_f32 v208, v208
    v_exp_f32 v240, v240
    v_exp_f32 v209, v209
    v_exp_f32 v241, v241
    v_exp_f32 v210, v210
    v_exp_f32 v242, v242
    v_exp_f32 v211, v211
    v_exp_f32 v243, v243
    v_exp_f32 v212, v212
    v_exp_f32 v244, v244
    v_exp_f32 v213, v213
    v_exp_f32 v245, v245
    v_exp_f32 v214, v214
    v_exp_f32 v246, v246
    v_exp_f32 v215, v215
    v_exp_f32 v247, v247
    v_exp_f32 v216, v216
    v_exp_f32 v248, v248
    v_exp_f32 v217, v217
    v_exp_f32 v249, v249
    v_exp_f32 v218, v218
    v_exp_f32 v250, v250
    v_exp_f32 v219, v219
    v_exp_f32 v251, v251
    v_exp_f32 v220, v220
    v_exp_f32 v252, v252
    v_exp_f32 v221, v221
    v_exp_f32 v253, v253
    v_exp_f32 v222, v222
    v_exp_f32 v254, v254
    v_exp_f32 v223, v223
    v_exp_f32 v255, v255
    v_pk_add_f32 v[24:25], v[208:209], v[210:211]
    v_pk_add_f32 v[26:27], v[212:213], v[214:215]
    v_pk_add_f32 v[28:29], v[216:217], v[218:219]
    v_pk_add_f32 v[30:31], v[240:241], v[242:243]
    v_pk_add_f32 v[32:33], v[244:245], v[246:247]
    v_pk_add_f32 v[34:35], v[248:249], v[250:251]
    v_pk_add_f32 v[24:25], v[24:25], v[220:221]
    v_pk_add_f32 v[26:27], v[26:27], v[222:223]
    v_pk_add_f32 v[30:31], v[30:31], v[252:253]
    v_pk_add_f32 v[32:33], v[32:33], v[254:255]
    v_pk_add_f32 v[24:25], v[24:25], v[28:29]
    v_pk_add_f32 v[30:31], v[30:31], v[34:35]
    v_pk_add_f32 v[24:25], v[24:25], v[26:27]
    v_pk_add_f32 v[30:31], v[30:31], v[32:33]
    v_add_f32 v24, v24, v25
    v_add_f32 v30, v30, v31
    v_mov_b32 v25, v24
    v_mov_b32 v31, v30
    s_nop 0
    v_permlane32_swap_b32 v24, v25
    v_permlane32_swap_b32 v30, v31
    v_add_f32 v24, v24, v25
    v_add_f32 v30, v30, v31
    v_rcp_f32 v24, v24
    v_rcp_f32 v30, v30
    v_pk_mul_f32 v[208:209], v[208:209], v[24:25] op_sel_hi:[1,0]
    v_pk_mul_f32 v[240:241], v[240:241], v[30:31] op_sel_hi:[1,0]
    v_pk_mul_f32 v[210:211], v[210:211], v[24:25] op_sel_hi:[1,0]
    v_pk_mul_f32 v[242:243], v[242:243], v[30:31] op_sel_hi:[1,0]
    v_pk_mul_f32 v[212:213], v[212:213], v[24:25] op_sel_hi:[1,0]
    v_pk_mul_f32 v[244:245], v[244:245], v[30:31] op_sel_hi:[1,0]
    v_pk_mul_f32 v[214:215], v[214:215], v[24:25] op_sel_hi:[1,0]
    v_pk_mul_f32 v[246:247], v[246:247], v[30:31] op_sel_hi:[1,0]
    v_pk_mul_f32 v[216:217], v[216:217], v[24:25] op_sel_hi:[1,0]
    v_pk_mul_f32 v[248:249], v[248:249], v[30:31] op_sel_hi:[1,0]
    v_pk_mul_f32 v[218:219], v[218:219], v[24:25] op_sel_hi:[1,0]
    v_pk_mul_f32 v[250:251], v[250:251], v[30:31] op_sel_hi:[1,0]
    v_pk_mul_f32 v[220:221], v[220:221], v[24:25] op_sel_hi:[1,0]
    v_pk_mul_f32 v[252:253], v[252:253], v[30:31] op_sel_hi:[1,0]
    v_pk_mul_f32 v[222:223], v[222:223], v[24:25] op_sel_hi:[1,0]
    v_pk_mul_f32 v[254:255], v[254:255], v[30:31] op_sel_hi:[1,0]
    v_cvt_pk_bf16_f32 v96, v208, v209
    v_cvt_pk_bf16_f32 v104, v240, v241
    v_cvt_pk_bf16_f32 v97, v210, v211
    v_cvt_pk_bf16_f32 v105, v242, v243
    v_cvt_pk_bf16_f32 v98, v212, v213
    v_cvt_pk_bf16_f32 v106, v244, v245
    v_cvt_pk_bf16_f32 v99, v214, v215
    v_cvt_pk_bf16_f32 v107, v246, v247
    v_cvt_pk_bf16_f32 v100, v216, v217
    v_cvt_pk_bf16_f32 v108, v248, v249
    v_cvt_pk_bf16_f32 v101, v218, v219
    v_cvt_pk_bf16_f32 v109, v250, v251
    v_cvt_pk_bf16_f32 v102, v220, v221
    v_cvt_pk_bf16_f32 v110, v252, v253
    v_cvt_pk_bf16_f32 v103, v222, v223
    v_cvt_pk_bf16_f32 v111, v254, v255
    s_lshl_b32 s12, s19, 1
    s_add_u32 s23, s12, s22
    s_lshl_b32 s12, s23, 12
    s_add_u32 s43, s12, 32768
    s_lshl_b32 s14, s23, 10
    s_add_u32 s46, s14, 163840
    v_lshlrev_b32 v52, 7, v3
    v_lshrrev_b32 v53, 2, v4
    v_lshlrev_b32 v53, 7, v53
    s_lshl_b32 s40, s18, 1
    s_add_u32 s40, s40, s21
    s_lshl_b32 s41, s40, 6
    s_add_u32 s41, s41, s23
    s_lshl_b32 s41, s41, 11
    s_add_u32 s41, s41, 8388608
    s_add_u32 s42, s41, 65536
    s_lshl_b32 s12, s18, 10
    s_lshl_b32 s40, s21, 5
    s_add_u32 s40, s40, s12
    s_add_u32 s40, s40, s23
    s_lshl_b32 s40, s40, 2
    s_add_u32 s40, s40, 524288
    s_sub_u32 s21, s72, 1
    s_mov_b32 s22, s73
    s_mov_b32 s23, s74
    s_lshl_b32 s40, s18, 1
    s_lshr_b32 s12, s20, 1
    s_add_u32 s40, s40, s12
    s_lshl_b32 s40, s40, 5
    s_lshl_b32 s12, s19, 1
    s_add_u32 s40, s40, s12
    s_and_b32 s12, s20, 1
    s_add_u32 s40, s40, s12
    s_lshl_b32 s40, s40, 7
    s_add_u32 s40, s40, 6291456
    s_and_b32 s88, s16, 1
    s_lshl_b32 s88, s88, 3
    s_lshr_b32 s89, s16, 1
    s_lshl_b32 s89, s89, 1
    s_add_u32 s88, s88, s89
    s_lshr_b32 s89, s17, 4
    s_add_u32 s88, s88, s89
    s_and_b32 s89, s17, 15
    s_mov_b32 s68, s58
    s_and_b32 s69, s59, 0xffff
    s_mov_b32 s70, 4194304
    s_mov_b32 s71, 0x00020000
    s_and_b32 s90, s20, 3
    s_lshr_b32 s91, s20, 2
    s_lshl_b32 s12, s88, 3
    s_lshl_b32 s13, s90, 1
    s_add_u32 s12, s12, s13
    s_add_u32 s92, s12, s91
    s_lshl_b32 s12, s92, 4
    v_and_b32 v3, 15, v2
    v_add_u32 v6, s12, v3
    v_lshlrev_b32 v8, 2, v6
    v_bfe_u32 v9, v2, 4, 1
    v_lshrrev_b32 v10, 5, v2
    v_lshlrev_b32 v7, 11, v6
    v_lshl_add_u32 v7, v9, 6, v7
    v_lshl_add_u32 v7, v10, 4, v7
    s_lshl_b32 s12, s89, 7
    v_add_u32 v7, s12, v7
    s_mov_b32 s12, 4096
    buffer_load_dwordx4 v[24:27], v7, s[24:27], 0 offen
    buffer_load_dwordx4 v[28:31], v7, s[24:27], 0 offen offset:32
    buffer_load_dword v48, v8, s[32:35], s12 offen sc1
    v_lshlrev_b32 v22, 8, v3
    v_lshl_add_u32 v22, v9, 7, v22
    v_lshl_add_u32 v22, v10, 5, v22
    v_lshlrev_b32 v10, 9, v10
    v_bfe_u32 v11, v2, 2, 2
    v_lshl_add_u32 v10, v11, 7, v10
    v_bfe_u32 v11, v2, 3, 1
    v_lshl_add_u32 v10, v11, 6, v10
    v_lshl_add_u32 v10, v9, 5, v10
    v_and_b32 v11, 3, v2
    v_lshl_add_u32 v10, v11, 3, v10
    v_xor_b32 v11, 64, v10
    s_lshl_b32 s12, s91, 8
    v_xor_b32 v17, s12, v5
    v_lshlrev_b32 v8, 2, v3
    s_lshl_b32 s12, s20, 12
    s_mov_b32 s15, 40960
    s_cmp_lt_u32 s20, 6
    s_cselect_b32 s13, s15, 131072
    s_add_u32 s12, s12, s13
    v_add_u32 v20, s12, v5
    s_xor_b32 s14, s20, 4
    s_lshl_b32 s12, s14, 12
    s_cmp_lt_u32 s14, 6
    s_cselect_b32 s13, s15, 131072
    s_add_u32 s12, s12, s13
    v_add_u32 v21, s12, v5
    s_lshl_b32 s12, s88, 2
    s_add_u32 s12, s12, s90
    s_lshl_b32 s13, s12, 16
    s_lshl_b32 s14, s91, 15
    s_add_u32 s13, s13, s14
    s_add_u32 s95, s13, 8388608
    s_lshl_b32 s12, s88, 12
    s_lshl_b32 s13, s89, 8
    s_mul_i32 s13, s13, 1
    s_add_u32 s12, s12, s13
    s_lshr_b32 s13, s90, 1
    s_lshl_b32 s13, s13, 7
    s_add_u32 s12, s12, s13
    s_lshl_b32 s13, s91, 6
    s_add_u32 s12, s12, s13
    s_add_u32 s15, s12, 524288
    s_lshl_b32 s97, s91, 4
    v_lshlrev_b32 v8, 7, v3
    s_lshl_b32 s12, s88, 1
    s_lshr_b32 s13, s90, 1
    s_add_u32 s12, s12, s13
    s_lshl_b32 s12, s12, 12
    s_lshl_b32 s13, s91, 11
    s_add_u32 s12, s12, s13
    s_and_b32 s13, s89, 0
    s_lshl_b32 s13, s13, 17
    s_add_u32 s12, s12, s13
    s_add_u32 s15, s12, 6291456
    s_mov_b32 s93, s89
    s_waitcnt vmcnt(0)
    v_sub_f32 v50, 1.0, v48
    v_cvt_pk_bf16_f32 v50, v50, v50
    v_lshlrev_b32 v50, 16, v50
    v_lshlrev_b32 v32, 16, v24
    v_and_b32 v33, 0xffff0000, v24
    v_lshlrev_b32 v34, 16, v25
    v_and_b32 v35, 0xffff0000, v25
    v_lshlrev_b32 v36, 16, v26
    v_and_b32 v37, 0xffff0000, v26
    v_lshlrev_b32 v38, 16, v27
    v_and_b32 v39, 0xffff0000, v27
    v_lshlrev_b32 v40, 16, v28
    v_and_b32 v41, 0xffff0000, v28
    v_lshlrev_b32 v42, 16, v29
    v_and_b32 v43, 0xffff0000, v29
    v_lshlrev_b32 v44, 16, v30
    v_and_b32 v45, 0xffff0000, v30
    v_lshlrev_b32 v46, 16, v31
    v_and_b32 v47, 0xffff0000, v31
    v_pk_mul_f32 v[32:33], v[32:33], v[50:51] op_sel_hi:[1,0]
    v_pk_mul_f32 v[34:35], v[34:35], v[50:51] op_sel_hi:[1,0]
    v_pk_mul_f32 v[36:37], v[36:37], v[50:51] op_sel_hi:[1,0]
    v_pk_mul_f32 v[38:39], v[38:39], v[50:51] op_sel_hi:[1,0]
    v_pk_mul_f32 v[40:41], v[40:41], v[50:51] op_sel_hi:[1,0]
    v_pk_mul_f32 v[42:43], v[42:43], v[50:51] op_sel_hi:[1,0]
    v_pk_mul_f32 v[44:45], v[44:45], v[50:51] op_sel_hi:[1,0]
    v_pk_mul_f32 v[46:47], v[46:47], v[50:51] op_sel_hi:[1,0]
    v_cvt_pk_bf16_f32 v33, v32, v33
    v_cvt_pk_bf16_f32 v35, v34, v35
    v_cvt_pk_bf16_f32 v37, v36, v37
    v_cvt_pk_bf16_f32 v39, v38, v39
    v_cvt_pk_bf16_f32 v41, v40, v41
    v_cvt_pk_bf16_f32 v43, v42, v43
    v_cvt_pk_bf16_f32 v45, v44, v45
    v_cvt_pk_bf16_f32 v47, v46, v47
    v_lshlrev_b32 v32, 16, v33
    v_and_b32 v33, 0xffff0000, v33
    v_lshlrev_b32 v34, 16, v35
    v_and_b32 v35, 0xffff0000, v35
    v_lshlrev_b32 v36, 16, v37
    v_and_b32 v37, 0xffff0000, v37
    v_lshlrev_b32 v38, 16, v39
    v_and_b32 v39, 0xffff0000, v39
    v_lshlrev_b32 v40, 16, v41
    v_and_b32 v41, 0xffff0000, v41
    v_lshlrev_b32 v42, 16, v43
    v_and_b32 v43, 0xffff0000, v43
    v_lshlrev_b32 v44, 16, v45
    v_and_b32 v45, 0xffff0000, v45
    v_lshlrev_b32 v46, 16, v47
    v_and_b32 v47, 0xffff0000, v47
    s_mov_b32 s13, 0
    v_mov_b32 v54, 162896
L_c_kz:
    ds_read_b32 v55, v54
    s_add_u32 s13, s13, 1
    s_cmp_ge_u32 s13, 262144
    s_cbranch_scc1 L_c_kzok
    s_waitcnt lgkmcnt(0)
    v_cmp_eq_u32 vcc, 1, v55
    s_cbranch_vccz L_c_kz
L_c_kzok:
    s_mov_b32 s13, 0
L_c_kv:
    buffer_load_dwordx4 v[112:115], v5, s[32:35], s43 offen offset:0 sc1
    buffer_load_dwordx4 v[116:119], v5, s[32:35], s43 offen offset:1024 sc1
    buffer_load_dwordx4 v[120:123], v5, s[32:35], s43 offen offset:2048 sc1
    buffer_load_dwordx4 v[124:127], v5, s[32:35], s43 offen offset:3072 sc1
    buffer_load_dwordx4 v[128:131], v52, s[32:35], s46 offen offset:0 sc1
    buffer_load_dwordx4 v[132:135], v52, s[32:35], s46 offen offset:256 sc1
    buffer_load_dwordx4 v[136:139], v52, s[32:35], s46 offen offset:512 sc1
    buffer_load_dwordx4 v[140:143], v52, s[32:35], s46 offen offset:768 sc1
    s_add_u32 s13, s13, 1
    s_waitcnt vmcnt(0)
    v_max3_u32 v55, v112, v113, v114
    v_max3_u32 v55, v55, v115, v116
    v_max3_u32 v55, v55, v117, v118
    v_max3_u32 v55, v55, v119, v120
    v_max3_u32 v55, v55, v121, v122
    v_max3_u32 v55, v55, v123, v124
    v_max3_u32 v55, v55, v125, v126
    v_max3_u32 v55, v55, v127, v128
    v_max3_u32 v55, v55, v129, v130
    v_max3_u32 v55, v55, v131, v132
    v_max3_u32 v55, v55, v133, v134
    v_max3_u32 v55, v55, v135, v136
    v_max3_u32 v55, v55, v137, v138
    v_max3_u32 v55, v55, v139, v140
    v_max3_u32 v55, v55, v141, v142
    v_max_u32 v55, v55, v143
    v_cmp_eq_u32 vcc, -1, v55
    s_cbranch_vccz L_c_kvok
    s_cmp_lt_u32 s13, 16384
    s_cbranch_scc1 L_c_kv
L_c_kvok:
    v_mfma_f32_32x32x16_bf16 v[192:207], v[128:131], v[80:83], 0
    v_mfma_f32_32x32x16_bf16 v[160:175], v[112:115], v[80:83], 0
    v_mfma_f32_32x32x16_bf16 v[192:207], v[132:135], v[84:87], v[192:207]
    v_mfma_f32_32x32x16_bf16 v[160:175], v[116:119], v[84:87], v[160:175]
    v_mfma_f32_32x32x16_bf16 v[192:207], v[136:139], v[88:91], v[192:207]
    v_mfma_f32_32x32x16_bf16 v[160:175], v[120:123], v[88:91], v[160:175]
    v_mfma_f32_32x32x16_bf16 v[192:207], v[140:143], v[92:95], v[192:207]
    v_mfma_f32_32x32x16_bf16 v[160:175], v[124:127], v[92:95], v[160:175]
    v_mfma_f32_32x32x16_bf16 v[208:223], v[128:131], v[96:99], 0
    v_mfma_f32_32x32x16_bf16 v[176:191], v[112:115], v[96:99], 0
    v_mfma_f32_32x32x16_bf16 v[208:223], v[132:135], v[100:103], v[208:223]
    v_mfma_f32_32x32x16_bf16 v[176:191], v[116:119], v[100:103], v[176:191]
    v_mfma_f32_32x32x16_bf16 v[208:223], v[136:139], v[104:107], v[208:223]
    v_mfma_f32_32x32x16_bf16 v[176:191], v[120:123], v[104:107], v[176:191]
    v_mfma_f32_32x32x16_bf16 v[208:223], v[140:143], v[108:111], v[208:223]
    v_mfma_f32_32x32x16_bf16 v[176:191], v[124:127], v[108:111], v[176:191]
    s_nop 2
    v_cvt_pk_bf16_f32 v56, v192, v192
    v_lshlrev_b32 v56, 16, v56
    v_add_f32 v56, 0x358637bd, v56
    v_cvt_pk_bf16_f32 v56, v56, v56
    v_lshlrev_b32 v56, 16, v56
    v_rcp_f32 v56, v56
    v_cvt_pk_bf16_f32 v64, v160, v161
    v_cvt_pk_bf16_f32 v65, v162, v163
    v_cvt_pk_bf16_f32 v66, v164, v165
    v_cvt_pk_bf16_f32 v67, v166, v167
    v_cvt_pk_bf16_f32 v68, v168, v169
    v_cvt_pk_bf16_f32 v69, v170, v171
    v_cvt_pk_bf16_f32 v70, v172, v173
    v_cvt_pk_bf16_f32 v71, v174, v175
    v_lshlrev_b32 v160, 16, v64
    v_and_b32 v161, 0xffff0000, v64
    v_lshlrev_b32 v162, 16, v65
    v_and_b32 v163, 0xffff0000, v65
    v_lshlrev_b32 v164, 16, v66
    v_and_b32 v165, 0xffff0000, v66
    v_lshlrev_b32 v166, 16, v67
    v_and_b32 v167, 0xffff0000, v67
    v_lshlrev_b32 v168, 16, v68
    v_and_b32 v169, 0xffff0000, v68
    v_lshlrev_b32 v170, 16, v69
    v_and_b32 v171, 0xffff0000, v69
    v_lshlrev_b32 v172, 16, v70
    v_and_b32 v173, 0xffff0000, v70
    v_lshlrev_b32 v174, 16, v71
    v_and_b32 v175, 0xffff0000, v71
    v_pk_mul_f32 v[160:161], v[160:161], v[56:57] op_sel_hi:[1,0]
    v_pk_mul_f32 v[162:163], v[162:163], v[56:57] op_sel_hi:[1,0]
    v_pk_mul_f32 v[164:165], v[164:165], v[56:57] op_sel_hi:[1,0]
    v_pk_mul_f32 v[166:167], v[166:167], v[56:57] op_sel_hi:[1,0]
    v_pk_mul_f32 v[168:169], v[168:169], v[56:57] op_sel_hi:[1,0]
    v_pk_mul_f32 v[170:171], v[170:171], v[56:57] op_sel_hi:[1,0]
    v_pk_mul_f32 v[172:173], v[172:173], v[56:57] op_sel_hi:[1,0]
    v_pk_mul_f32 v[174:175], v[174:175], v[56:57] op_sel_hi:[1,0]
    v_cvt_pk_bf16_f32 v64, v160, v161
    v_cvt_pk_bf16_f32 v65, v162, v163
    v_cvt_pk_bf16_f32 v66, v164, v165
    v_cvt_pk_bf16_f32 v67, v166, v167
    v_cvt_pk_bf16_f32 v68, v168, v169
    v_cvt_pk_bf16_f32 v69, v170, v171
    v_cvt_pk_bf16_f32 v70, v172, v173
    v_cvt_pk_bf16_f32 v71, v174, v175
    buffer_store_dwordx4 v[64:67], v5, s[32:35], s41 offen sc1
    buffer_store_dwordx4 v[68:71], v5, s[32:35], s41 offen offset:1024 sc1
    v_cvt_pk_bf16_f32 v58, v208, v208
    v_lshlrev_b32 v58, 16, v58
    v_add_f32 v58, 0x358637bd, v58
    v_cvt_pk_bf16_f32 v58, v58, v58
    v_lshlrev_b32 v58, 16, v58
    v_rcp_f32 v58, v58
    v_cvt_pk_bf16_f32 v72, v176, v177
    v_cvt_pk_bf16_f32 v73, v178, v179
    v_cvt_pk_bf16_f32 v74, v180, v181
    v_cvt_pk_bf16_f32 v75, v182, v183
    v_cvt_pk_bf16_f32 v76, v184, v185
    v_cvt_pk_bf16_f32 v77, v186, v187
    v_cvt_pk_bf16_f32 v78, v188, v189
    v_cvt_pk_bf16_f32 v79, v190, v191
    v_lshlrev_b32 v176, 16, v72
    v_and_b32 v177, 0xffff0000, v72
    v_lshlrev_b32 v178, 16, v73
    v_and_b32 v179, 0xffff0000, v73
    v_lshlrev_b32 v180, 16, v74
    v_and_b32 v181, 0xffff0000, v74
    v_lshlrev_b32 v182, 16, v75
    v_and_b32 v183, 0xffff0000, v75
    v_lshlrev_b32 v184, 16, v76
    v_and_b32 v185, 0xffff0000, v76
    v_lshlrev_b32 v186, 16, v77
    v_and_b32 v187, 0xffff0000, v77
    v_lshlrev_b32 v188, 16, v78
    v_and_b32 v189, 0xffff0000, v78
    v_lshlrev_b32 v190, 16, v79
    v_and_b32 v191, 0xffff0000, v79
    v_pk_mul_f32 v[176:177], v[176:177], v[58:59] op_sel_hi:[1,0]
    v_pk_mul_f32 v[178:179], v[178:179], v[58:59] op_sel_hi:[1,0]
    v_pk_mul_f32 v[180:181], v[180:181], v[58:59] op_sel_hi:[1,0]
    v_pk_mul_f32 v[182:183], v[182:183], v[58:59] op_sel_hi:[1,0]
    v_pk_mul_f32 v[184:185], v[184:185], v[58:59] op_sel_hi:[1,0]
    v_pk_mul_f32 v[186:187], v[186:187], v[58:59] op_sel_hi:[1,0]
    v_pk_mul_f32 v[188:189], v[188:189], v[58:59] op_sel_hi:[1,0]
    v_pk_mul_f32 v[190:191], v[190:191], v[58:59] op_sel_hi:[1,0]
    v_cvt_pk_bf16_f32 v72, v176, v177
    v_cvt_pk_bf16_f32 v73, v178, v179
    v_cvt_pk_bf16_f32 v74, v180, v181
    v_cvt_pk_bf16_f32 v75, v182, v183
    v_cvt_pk_bf16_f32 v76, v184, v185
    v_cvt_pk_bf16_f32 v77, v186, v187
    v_cvt_pk_bf16_f32 v78, v188, v189
    v_cvt_pk_bf16_f32 v79, v190, v191
    buffer_store_dwordx4 v[72:75], v5, s[32:35], s42 offen sc1
    buffer_store_dwordx4 v[76:79], v5, s[32:35], s42 offen offset:1024 sc1
    v_mov_b32 v56, s23
    v_mov_b32 v57, s23
    v_mov_b32 v58, s23
    v_mov_b32 v59, s23
    v_lshrrev_b32 v60, 3, v2
    v_lshlrev_b32 v60, 17, v60
    v_and_b32 v61, 0x70, v5
    v_add_u32 v60, v60, v61
    s_mov_b32 s45, 0
    s_lshr_b32 s12, s21, 4
    s_cmp_eq_u32 s12, s92
    s_cselect_b32 s46, 1, 0
    s_cbranch_scc0 L_b_noownc
    s_lshl_b32 s12, s89, 12
    s_add_u32 s12, s12, 458752
    buffer_load_dwordx4 v[224:227], v22, s[32:35], s12 offen offset:0 sc1
    buffer_load_dwordx4 v[228:231], v22, s[32:35], s12 offen offset:16 sc1
    buffer_load_dwordx4 v[232:235], v22, s[32:35], s12 offen offset:64 sc1
    buffer_load_dwordx4 v[236:239], v22, s[32:35], s12 offen offset:80 sc1
L_b_noownc:
    s_waitcnt vmcnt(0)
    s_mov_b32 exec_lo, 0xff
    s_mov_b32 exec_hi, 0
    buffer_store_dwordx4 v[56:59], v60, s[32:35], s40 offen sc1
    s_mov_b64 exec, -1
L_phaseb:
    s_setprio 0
    s_nop 4
    s_cmp_lg_u32 s46, 0
    s_cbranch_scc1 L_own
L_own_r0:
    s_nop 0
    s_barrier
    s_mov_b32 s14, 0xffff0000
    s_mov_b32 s47, 0
    s_mov_b32 s96, 0
    s_waitcnt vmcnt(0)
    s_cmp_lg_u32 s96, 0
    s_cbranch_scc1 L_pk0
L_pl0:
    buffer_load_dword v52, v8, s[32:35], s15 offen sc1
    s_add_u32 s47, s47, 1
    s_cmp_ge_u32 s47, 16384
    s_cselect_b32 s12, -1, 0
    s_waitcnt vmcnt(0)
    v_cmp_eq_u32 vcc, s23, v52
    s_nop 1
    s_or_b32 s12, s12, vcc_lo
    s_lshr_b32 s12, s12, s93
    s_or_b32 s96, s96, s12
    s_andn2_b32 s96, s96, s14
    s_cbranch_scc0 L_pl0
L_pk0:
    s_ff1_i32_b32 s12, s96
    s_bitset0_b32 s96, s12
    s_bitset1_b32 s14, s12
    s_add_u32 s12, s12, s93
    s_and_b32 s80, s12, 15
    s_lshl_b32 s94, s80, 11
    s_add_u32 s94, s94, s95
    buffer_load_dwordx4 v[96:99], v17, s[32:35], s94 offen
    buffer_load_dwordx4 v[100:103], v17, s[32:35], s94 offen offset:1024
    s_add_u32 s12, s80, s97
    s_lshl_b32 s13, s12, 12
    s_cmp_ge_u32 s12, 10
    s_cselect_b32 s12, 24576, 0
    s_add_u32 s13, s13, s12
    v_add_u32 v12, s13, v10
    v_add_u32 v13, s13, v11
    ds_read_b64_tr_b16 v[120:121], v12 offset:0
    ds_read_b64_tr_b16 v[122:123], v12 offset:1024
    ds_read_b64_tr_b16 v[124:125], v13 offset:0
    ds_read_b64_tr_b16 v[126:127], v13 offset:1024
    ds_read_b64_tr_b16 v[128:129], v12 offset:2048
    ds_read_b64_tr_b16 v[130:131], v12 offset:3072
    ds_read_b64_tr_b16 v[132:133], v13 offset:2048
    ds_read_b64_tr_b16 v[134:135], v13 offset:3072
    s_cmp_lg_u32 s96, 0
    s_cbranch_scc1 L_pk1
L_pl1:
    buffer_load_dword v53, v8, s[32:35], s15 offen sc1
    s_add_u32 s47, s47, 1
    s_cmp_ge_u32 s47, 16384
    s_cselect_b32 s12, -1, 0
    s_waitcnt vmcnt(0)
    v_cmp_eq_u32 vcc, s23, v53
    s_nop 1
    s_or_b32 s12, s12, vcc_lo
    s_lshr_b32 s12, s12, s93
    s_or_b32 s96, s96, s12
    s_andn2_b32 s96, s96, s14
    s_cbranch_scc0 L_pl1
L_pk1:
    s_ff1_i32_b32 s12, s96
    s_bitset0_b32 s96, s12
    s_bitset1_b32 s14, s12
    s_add_u32 s12, s12, s93
    s_and_b32 s81, s12, 15
    s_lshl_b32 s94, s81, 11
    s_add_u32 s94, s94, s95
    buffer_load_dwordx4 v[104:107], v17, s[32:35], s94 offen
    buffer_load_dwordx4 v[108:111], v17, s[32:35], s94 offen offset:1024
    s_cmp_lg_u32 s96, 0
    s_cbranch_scc1 L_pk2
L_pl2:
    buffer_load_dword v54, v8, s[32:35], s15 offen sc1
    s_add_u32 s47, s47, 1
    s_cmp_ge_u32 s47, 16384
    s_cselect_b32 s12, -1, 0
    s_waitcnt vmcnt(0)
    v_cmp_eq_u32 vcc, s23, v54
    s_nop 1
    s_or_b32 s12, s12, vcc_lo
    s_lshr_b32 s12, s12, s93
    s_or_b32 s96, s96, s12
    s_andn2_b32 s96, s96, s14
    s_cbranch_scc0 L_pl2
L_pk2:
    s_ff1_i32_b32 s12, s96
    s_bitset0_b32 s96, s12
    s_bitset1_b32 s14, s12
    s_add_u32 s12, s12, s93
    s_and_b32 s82, s12, 15
    s_lshl_b32 s94, s82, 11
    s_add_u32 s94, s94, s95
    buffer_load_dwordx4 v[112:115], v17, s[32:35], s94 offen
    buffer_load_dwordx4 v[116:119], v17, s[32:35], s94 offen offset:1024
    s_add_u32 s12, s81, s97
    s_lshl_b32 s13, s12, 12
    s_cmp_ge_u32 s12, 10
    s_cselect_b32 s12, 24576, 0
    s_add_u32 s13, s13, s12
    v_add_u32 v14, s13, v10
    v_add_u32 v15, s13, v11
    s_waitcnt vmcnt(4)
    s_waitcnt lgkmcnt(6)
    v_mfma_f32_32x32x16_bf16 v[64:79], v[120:123], v[96:99], 0
    ds_read_b64_tr_b16 v[136:137], v14 offset:0
    ds_read_b64_tr_b16 v[138:139], v14 offset:1024
    s_waitcnt lgkmcnt(6)
    v_mfma_f32_32x32x16_bf16 v[80:95], v[124:127], v[96:99], 0
    ds_read_b64_tr_b16 v[140:141], v15 offset:0
    ds_read_b64_tr_b16 v[142:143], v15 offset:1024
    s_waitcnt lgkmcnt(6)
    v_mfma_f32_32x32x16_bf16 v[64:79], v[128:131], v[100:103], v[64:79]
    ds_read_b64_tr_b16 v[144:145], v14 offset:2048
    ds_read_b64_tr_b16 v[146:147], v14 offset:3072
    s_waitcnt lgkmcnt(6)
    v_mfma_f32_32x32x16_bf16 v[80:95], v[132:135], v[100:103], v[80:95]
    ds_read_b64_tr_b16 v[148:149], v15 offset:2048
    ds_read_b64_tr_b16 v[150:151], v15 offset:3072
    s_cmp_lg_u32 s96, 0
    s_cbranch_scc1 L_pk3
L_pl3:
    buffer_load_dword v55, v8, s[32:35], s15 offen sc1
    s_add_u32 s47, s47, 1
    s_cmp_ge_u32 s47, 16384
    s_cselect_b32 s12, -1, 0
    s_waitcnt vmcnt(0)
    v_cmp_eq_u32 vcc, s23, v55
    s_nop 1
    s_or_b32 s12, s12, vcc_lo
    s_lshr_b32 s12, s12, s93
    s_or_b32 s96, s96, s12
    s_andn2_b32 s96, s96, s14
    s_cbranch_scc0 L_pl3
L_pk3:
    s_ff1_i32_b32 s12, s96
    s_bitset0_b32 s96, s12
    s_bitset1_b32 s14, s12
    s_add_u32 s12, s12, s93
    s_and_b32 s83, s12, 15
    s_lshl_b32 s94, s83, 11
    s_add_u32 s94, s94, s95
    buffer_load_dwordx4 v[96:99], v17, s[32:35], s94 offen
    buffer_load_dwordx4 v[100:103], v17, s[32:35], s94 offen offset:1024
    s_add_u32 s12, s82, s97
    s_lshl_b32 s13, s12, 12
    s_cmp_ge_u32 s12, 10
    s_cselect_b32 s12, 24576, 0
    s_add_u32 s13, s13, s12
    v_add_u32 v12, s13, v10
    v_add_u32 v13, s13, v11
    s_waitcnt vmcnt(4)
    s_waitcnt lgkmcnt(6)
    v_mfma_f32_32x32x16_bf16 v[64:79], v[136:139], v[104:107], v[64:79]
    ds_read_b64_tr_b16 v[120:121], v12 offset:0
    ds_read_b64_tr_b16 v[122:123], v12 offset:1024
    s_waitcnt lgkmcnt(6)
    v_mfma_f32_32x32x16_bf16 v[80:95], v[140:143], v[104:107], v[80:95]
    ds_read_b64_tr_b16 v[124:125], v13 offset:0
    ds_read_b64_tr_b16 v[126:127], v13 offset:1024
    s_waitcnt lgkmcnt(6)
    v_mfma_f32_32x32x16_bf16 v[64:79], v[144:147], v[108:111], v[64:79]
    ds_read_b64_tr_b16 v[128:129], v12 offset:2048
    ds_read_b64_tr_b16 v[130:131], v12 offset:3072
    s_waitcnt lgkmcnt(6)
    v_mfma_f32_32x32x16_bf16 v[80:95], v[148:151], v[108:111], v[80:95]
    ds_read_b64_tr_b16 v[132:133], v13 offset:2048
    ds_read_b64_tr_b16 v[134:135], v13 offset:3072
    s_cmp_lg_u32 s96, 0
    s_cbranch_scc1 L_pk4
L_pl4:
    buffer_load_dword v56, v8, s[32:35], s15 offen sc1
    s_add_u32 s47, s47, 1
    s_cmp_ge_u32 s47, 16384
    s_cselect_b32 s12, -1, 0
    s_waitcnt vmcnt(0)
    v_cmp_eq_u32 vcc, s23, v56
    s_nop 1
    s_or_b32 s12, s12, vcc_lo
    s_lshr_b32 s12, s12, s93
    s_or_b32 s96, s96, s12
    s_andn2_b32 s96, s96, s14
    s_cbranch_scc0 L_pl4
L_pk4:
    s_ff1_i32_b32 s12, s96
    s_bitset0_b32 s96, s12
    s_bitset1_b32 s14, s12
    s_add_u32 s12, s12, s93
    s_and_b32 s84, s12, 15
    s_lshl_b32 s94, s84, 11
    s_add_u32 s94, s94, s95
    buffer_load_dwordx4 v[104:107], v17, s[32:35], s94 offen
    buffer_load_dwordx4 v[108:111], v17, s[32:35], s94 offen offset:1024
    s_add_u32 s12, s83, s97
    s_lshl_b32 s13, s12, 12
    s_cmp_ge_u32 s12, 10
    s_cselect_b32 s12, 24576, 0
    s_add_u32 s13, s13, s12
    v_add_u32 v14, s13, v10
    v_add_u32 v15, s13, v11
    s_waitcnt vmcnt(4)
    s_waitcnt lgkmcnt(6)
    v_mfma_f32_32x32x16_bf16 v[64:79], v[120:123], v[112:115], v[64:79]
    ds_read_b64_tr_b16 v[136:137], v14 offset:0
    ds_read_b64_tr_b16 v[138:139], v14 offset:1024
    s_waitcnt lgkmcnt(6)
    v_mfma_f32_32x32x16_bf16 v[80:95], v[124:127], v[112:115], v[80:95]
    ds_read_b64_tr_b16 v[140:141], v15 offset:0
    ds_read_b64_tr_b16 v[142:143], v15 offset:1024
    s_waitcnt lgkmcnt(6)
    v_mfma_f32_32x32x16_bf16 v[64:79], v[128:131], v[116:119], v[64:79]
    ds_read_b64_tr_b16 v[144:145], v14 offset:2048
    ds_read_b64_tr_b16 v[146:147], v14 offset:3072
    s_waitcnt lgkmcnt(6)
    v_mfma_f32_32x32x16_bf16 v[80:95], v[132:135], v[116:119], v[80:95]
    ds_read_b64_tr_b16 v[148:149], v15 offset:2048
    ds_read_b64_tr_b16 v[150:151], v15 offset:3072
    s_cmp_lg_u32 s96, 0
    s_cbranch_scc1 L_pk5
L_pl5:
    buffer_load_dword v57, v8, s[32:35], s15 offen sc1
    s_add_u32 s47, s47, 1
    s_cmp_ge_u32 s47, 16384
    s_cselect_b32 s12, -1, 0
    s_waitcnt vmcnt(0)
    v_cmp_eq_u32 vcc, s23, v57
    s_nop 1
    s_or_b32 s12, s12, vcc_lo
    s_lshr_b32 s12, s12, s93
    s_or_b32 s96, s96, s12
    s_andn2_b32 s96, s96, s14
    s_cbranch_scc0 L_pl5
L_pk5:
    s_ff1_i32_b32 s12, s96
    s_bitset0_b32 s96, s12
    s_bitset1_b32 s14, s12
    s_add_u32 s12, s12, s93
    s_and_b32 s85, s12, 15
    s_lshl_b32 s94, s85, 11
    s_add_u32 s94, s94, s95
    buffer_load_dwordx4 v[112:115], v17, s[32:35], s94 offen
    buffer_load_dwordx4 v[116:119], v17, s[32:35], s94 offen offset:1024
    s_add_u32 s12, s84, s97
    s_lshl_b32 s13, s12, 12
    s_cmp_ge_u32 s12, 10
    s_cselect_b32 s12, 24576, 0
    s_add_u32 s13, s13, s12
    v_add_u32 v12, s13, v10
    v_add_u32 v13, s13, v11
    s_waitcnt vmcnt(4)
    s_waitcnt lgkmcnt(6)
    v_mfma_f32_32x32x16_bf16 v[64:79], v[136:139], v[96:99], v[64:79]
    ds_read_b64_tr_b16 v[120:121], v12 offset:0
    ds_read_b64_tr_b16 v[122:123], v12 offset:1024
    s_waitcnt lgkmcnt(6)
    v_mfma_f32_32x32x16_bf16 v[80:95], v[140:143], v[96:99], v[80:95]
    ds_read_b64_tr_b16 v[124:125], v13 offset:0
    ds_read_b64_tr_b16 v[126:127], v13 offset:1024
    s_waitcnt lgkmcnt(6)
    v_mfma_f32_32x32x16_bf16 v[64:79], v[144:147], v[100:103], v[64:79]
    ds_read_b64_tr_b16 v[128:129], v12 offset:2048
    ds_read_b64_tr_b16 v[130:131], v12 offset:3072
    s_waitcnt lgkmcnt(6)
    v_mfma_f32_32x32x16_bf16 v[80:95], v[148:151], v[100:103], v[80:95]
    ds_read_b64_tr_b16 v[132:133], v13 offset:2048
    ds_read_b64_tr_b16 v[134:135], v13 offset:3072
    s_cmp_lg_u32 s96, 0
    s_cbranch_scc1 L_pk6
L_pl6:
    buffer_load_dword v58, v8, s[32:35], s15 offen sc1
    s_add_u32 s47, s47, 1
    s_cmp_ge_u32 s47, 16384
    s_cselect_b32 s12, -1, 0
    s_waitcnt vmcnt(0)
    v_cmp_eq_u32 vcc, s23, v58
    s_nop 1
    s_or_b32 s12, s12, vcc_lo
    s_lshr_b32 s12, s12, s93
    s_or_b32 s96, s96, s12
    s_andn2_b32 s96, s96, s14
    s_cbranch_scc0 L_pl6
L_pk6:
    s_ff1_i32_b32 s12, s96
    s_bitset0_b32 s96, s12
    s_bitset1_b32 s14, s12
    s_add_u32 s12, s12, s93
    s_and_b32 s86, s12, 15
    s_lshl_b32 s94, s86, 11
    s_add_u32 s94, s94, s95
    buffer_load_dwordx4 v[96:99], v17, s[32:35], s94 offen
    buffer_load_dwordx4 v[100:103], v17, s[32:35], s94 offen offset:1024
    s_add_u32 s12, s85, s97
    s_lshl_b32 s13, s12, 12
    s_cmp_ge_u32 s12, 10
    s_cselect_b32 s12, 24576, 0
    s_add_u32 s13, s13, s12
    v_add_u32 v14, s13, v10
    v_add_u32 v15, s13, v11
    s_waitcnt vmcnt(4)
    s_waitcnt lgkmcnt(6)
    v_mfma_f32_32x32x16_bf16 v[64:79], v[120:123], v[104:107], v[64:79]
    ds_read_b64_tr_b16 v[136:137], v14 offset:0
    ds_read_b64_tr_b16 v[138:139], v14 offset:1024
    s_waitcnt lgkmcnt(6)
    v_mfma_f32_32x32x16_bf16 v[80:95], v[124:127], v[104:107], v[80:95]
    ds_read_b64_tr_b16 v[140:141], v15 offset:0
    ds_read_b64_tr_b16 v[142:143], v15 offset:1024
    s_waitcnt lgkmcnt(6)
    v_mfma_f32_32x32x16_bf16 v[64:79], v[128:131], v[108:111], v[64:79]
    ds_read_b64_tr_b16 v[144:145], v14 offset:2048
    ds_read_b64_tr_b16 v[146:147], v14 offset:3072
    s_waitcnt lgkmcnt(6)
    v_mfma_f32_32x32x16_bf16 v[80:95], v[132:135], v[108:111], v[80:95]
    ds_read_b64_tr_b16 v[148:149], v15 offset:2048
    ds_read_b64_tr_b16 v[150:151], v15 offset:3072
    s_cmp_lg_u32 s96, 0
    s_cbranch_scc1 L_pk7
L_pl7:
    buffer_load_dword v59, v8, s[32:35], s15 offen sc1
    s_add_u32 s47, s47, 1
    s_cmp_ge_u32 s47, 16384
    s_cselect_b32 s12, -1, 0
    s_waitcnt vmcnt(0)
    v_cmp_eq_u32 vcc, s23, v59
    s_nop 1
    s_or_b32 s12, s12, vcc_lo
    s_lshr_b32 s12, s12, s93
    s_or_b32 s96, s96, s12
    s_andn2_b32 s96, s96, s14
    s_cbranch_scc0 L_pl7
L_pk7:
    s_ff1_i32_b32 s12, s96
    s_bitset0_b32 s96, s12
    s_bitset1_b32 s14, s12
    s_add_u32 s12, s12, s93
    s_and_b32 s87, s12, 15
    s_lshl_b32 s94, s87, 11
    s_add_u32 s94, s94, s95
    buffer_load_dwordx4 v[104:107], v17, s[32:35], s94 offen
    buffer_load_dwordx4 v[108:111], v17, s[32:35], s94 offen offset:1024
    s_add_u32 s12, s86, s97
    s_lshl_b32 s13, s12, 12
    s_cmp_ge_u32 s12, 10
    s_cselect_b32 s12, 24576, 0
    s_add_u32 s13, s13, s12
    v_add_u32 v12, s13, v10
    v_add_u32 v13, s13, v11
    s_waitcnt vmcnt(4)
    s_waitcnt lgkmcnt(6)
    v_mfma_f32_32x32x16_bf16 v[64:79], v[136:139], v[112:115], v[64:79]
    ds_read_b64_tr_b16 v[120:121], v12 offset:0
    ds_read_b64_tr_b16 v[122:123], v12 offset:1024
    s_waitcnt lgkmcnt(6)
    v_mfma_f32_32x32x16_bf16 v[80:95], v[140:143], v[112:115], v[80:95]
    ds_read_b64_tr_b16 v[124:125], v13 offset:0
    ds_read_b64_tr_b16 v[126:127], v13 offset:1024
    s_waitcnt lgkmcnt(6)
    v_mfma_f32_32x32x16_bf16 v[64:79], v[144:147], v[116:119], v[64:79]
    ds_read_b64_tr_b16 v[128:129], v12 offset:2048
    ds_read_b64_tr_b16 v[130:131], v12 offset:3072
    s_waitcnt lgkmcnt(6)
    v_mfma_f32_32x32x16_bf16 v[80:95], v[148:151], v[116:119], v[80:95]
    ds_read_b64_tr_b16 v[132:133], v13 offset:2048
    ds_read_b64_tr_b16 v[134:135], v13 offset:3072
    s_cmp_lg_u32 s96, 0
    s_cbranch_scc1 L_pk8
L_pl8:
    buffer_load_dword v52, v8, s[32:35], s15 offen sc1
    s_add_u32 s47, s47, 1
    s_cmp_ge_u32 s47, 16384
    s_cselect_b32 s12, -1, 0
    s_waitcnt vmcnt(0)
    v_cmp_eq_u32 vcc, s23, v52
    s_nop 1
    s_or_b32 s12, s12, vcc_lo
    s_lshr_b32 s12, s12, s93
    s_or_b32 s96, s96, s12
    s_andn2_b32 s96, s96, s14
    s_cbranch_scc0 L_pl8
L_pk8:
    s_ff1_i32_b32 s12, s96
    s_bitset0_b32 s96, s12
    s_bitset1_b32 s14, s12
    s_add_u32 s12, s12, s93
    s_and_b32 s80, s12, 15
    s_lshl_b32 s94, s80, 11
    s_add_u32 s94, s94, s95
    buffer_load_dwordx4 v[112:115], v17, s[32:35], s94 offen
    buffer_load_dwordx4 v[116:119], v17, s[32:35], s94 offen offset:1024
    s_add_u32 s12, s87, s97
    s_lshl_b32 s13, s12, 12
    s_cmp_ge_u32 s12, 10
    s_cselect_b32 s12, 24576, 0
    s_add_u32 s13, s13, s12
    v_add_u32 v14, s13, v10
    v_add_u32 v15, s13, v11
    s_waitcnt vmcnt(4)
    s_waitcnt lgkmcnt(6)
    v_mfma_f32_32x32x16_bf16 v[64:79], v[120:123], v[96:99], v[64:79]
    ds_read_b64_tr_b16 v[136:137], v14 offset:0
    ds_read_b64_tr_b16 v[138:139], v14 offset:1024
    s_waitcnt lgkmcnt(6)
    v_mfma_f32_32x32x16_bf16 v[80:95], v[124:127], v[96:99], v[80:95]
    ds_read_b64_tr_b16 v[140:141], v15 offset:0
    ds_read_b64_tr_b16 v[142:143], v15 offset:1024
    s_waitcnt lgkmcnt(6)
    v_mfma_f32_32x32x16_bf16 v[64:79], v[128:131], v[100:103], v[64:79]
    ds_read_b64_tr_b16 v[144:145], v14 offset:2048
    ds_read_b64_tr_b16 v[146:147], v14 offset:3072
    s_waitcnt lgkmcnt(6)
    v_mfma_f32_32x32x16_bf16 v[80:95], v[132:135], v[100:103], v[80:95]
    ds_read_b64_tr_b16 v[148:149], v15 offset:2048
    ds_read_b64_tr_b16 v[150:151], v15 offset:3072
    s_cmp_lg_u32 s96, 0
    s_cbranch_scc1 L_pk9
L_pl9:
    buffer_load_dword v53, v8, s[32:35], s15 offen sc1
    s_add_u32 s47, s47, 1
    s_cmp_ge_u32 s47, 16384
    s_cselect_b32 s12, -1, 0
    s_waitcnt vmcnt(0)
    v_cmp_eq_u32 vcc, s23, v53
    s_nop 1
    s_or_b32 s12, s12, vcc_lo
    s_lshr_b32 s12, s12, s93
    s_or_b32 s96, s96, s12
    s_andn2_b32 s96, s96, s14
    s_cbranch_scc0 L_pl9
L_pk9:
    s_ff1_i32_b32 s12, s96
    s_bitset0_b32 s96, s12
    s_bitset1_b32 s14, s12
    s_add_u32 s12, s12, s93
    s_and_b32 s81, s12, 15
    s_lshl_b32 s94, s81, 11
    s_add_u32 s94, s94, s95
    buffer_load_dwordx4 v[96:99], v17, s[32:35], s94 offen
    buffer_load_dwordx4 v[100:103], v17, s[32:35], s94 offen offset:1024
    s_add_u32 s12, s80, s97
    s_lshl_b32 s13, s12, 12
    s_cmp_ge_u32 s12, 10
    s_cselect_b32 s12, 24576, 0
    s_add_u32 s13, s13, s12
    v_add_u32 v12, s13, v10
    v_add_u32 v13, s13, v11
    s_waitcnt vmcnt(4)
    s_waitcnt lgkmcnt(6)
    v_mfma_f32_32x32x16_bf16 v[64:79], v[136:139], v[104:107], v[64:79]
    ds_read_b64_tr_b16 v[120:121], v12 offset:0
    ds_read_b64_tr_b16 v[122:123], v12 offset:1024
    s_waitcnt lgkmcnt(6)
    v_mfma_f32_32x32x16_bf16 v[80:95], v[140:143], v[104:107], v[80:95]
    ds_read_b64_tr_b16 v[124:125], v13 offset:0
    ds_read_b64_tr_b16 v[126:127], v13 offset:1024
    s_waitcnt lgkmcnt(6)
    v_mfma_f32_32x32x16_bf16 v[64:79], v[144:147], v[108:111], v[64:79]
    ds_read_b64_tr_b16 v[128:129], v12 offset:2048
    ds_read_b64_tr_b16 v[130:131], v12 offset:3072
    s_waitcnt lgkmcnt(6)
    v_mfma_f32_32x32x16_bf16 v[80:95], v[148:151], v[108:111], v[80:95]
    ds_read_b64_tr_b16 v[132:133], v13 offset:2048
    ds_read_b64_tr_b16 v[134:135], v13 offset:3072
    s_cmp_lg_u32 s96, 0
    s_cbranch_scc1 L_pk10
L_pl10:
    buffer_load_dword v54, v8, s[32:35], s15 offen sc1
    s_add_u32 s47, s47, 1
    s_cmp_ge_u32 s47, 16384
    s_cselect_b32 s12, -1, 0
    s_waitcnt vmcnt(0)
    v_cmp_eq_u32 vcc, s23, v54
    s_nop 1
    s_or_b32 s12, s12, vcc_lo
    s_lshr_b32 s12, s12, s93
    s_or_b32 s96, s96, s12
    s_andn2_b32 s96, s96, s14
    s_cbranch_scc0 L_pl10
L_pk10:
    s_ff1_i32_b32 s12, s96
    s_bitset0_b32 s96, s12
    s_bitset1_b32 s14, s12
    s_add_u32 s12, s12, s93
    s_and_b32 s82, s12, 15
    s_lshl_b32 s94, s82, 11
    s_add_u32 s94, s94, s95
    buffer_load_dwordx4 v[104:107], v17, s[32:35], s94 offen
    buffer_load_dwordx4 v[108:111], v17, s[32:35], s94 offen offset:1024
    s_add_u32 s12, s81, s97
    s_lshl_b32 s13, s12, 12
    s_cmp_ge_u32 s12, 10
    s_cselect_b32 s12, 24576, 0
    s_add_u32 s13, s13, s12
    v_add_u32 v14, s13, v10
    v_add_u32 v15, s13, v11
    s_waitcnt vmcnt(4)
    s_waitcnt lgkmcnt(6)
    v_mfma_f32_32x32x16_bf16 v[64:79], v[120:123], v[112:115], v[64:79]
    ds_read_b64_tr_b16 v[136:137], v14 offset:0
    ds_read_b64_tr_b16 v[138:139], v14 offset:1024
    s_waitcnt lgkmcnt(6)
    v_mfma_f32_32x32x16_bf16 v[80:95], v[124:127], v[112:115], v[80:95]
    ds_read_b64_tr_b16 v[140:141], v15 offset:0
    ds_read_b64_tr_b16 v[142:143], v15 offset:1024
    s_waitcnt lgkmcnt(6)
    v_mfma_f32_32x32x16_bf16 v[64:79], v[128:131], v[116:119], v[64:79]
    ds_read_b64_tr_b16 v[144:145], v14 offset:2048
    ds_read_b64_tr_b16 v[146:147], v14 offset:3072
    s_waitcnt lgkmcnt(6)
    v_mfma_f32_32x32x16_bf16 v[80:95], v[132:135], v[116:119], v[80:95]
    ds_read_b64_tr_b16 v[148:149], v15 offset:2048
    ds_read_b64_tr_b16 v[150:151], v15 offset:3072
    s_cmp_lg_u32 s96, 0
    s_cbranch_scc1 L_pk11
L_pl11:
    buffer_load_dword v55, v8, s[32:35], s15 offen sc1
    s_add_u32 s47, s47, 1
    s_cmp_ge_u32 s47, 16384
    s_cselect_b32 s12, -1, 0
    s_waitcnt vmcnt(0)
    v_cmp_eq_u32 vcc, s23, v55
    s_nop 1
    s_or_b32 s12, s12, vcc_lo
    s_lshr_b32 s12, s12, s93
    s_or_b32 s96, s96, s12
    s_andn2_b32 s96, s96, s14
    s_cbranch_scc0 L_pl11
L_pk11:
    s_ff1_i32_b32 s12, s96
    s_bitset0_b32 s96, s12
    s_bitset1_b32 s14, s12
    s_add_u32 s12, s12, s93
    s_and_b32 s83, s12, 15
    s_lshl_b32 s94, s83, 11
    s_add_u32 s94, s94, s95
    buffer_load_dwordx4 v[112:115], v17, s[32:35], s94 offen
    buffer_load_dwordx4 v[116:119], v17, s[32:35], s94 offen offset:1024
    s_add_u32 s12, s82, s97
    s_lshl_b32 s13, s12, 12
    s_cmp_ge_u32 s12, 10
    s_cselect_b32 s12, 24576, 0
    s_add_u32 s13, s13, s12
    v_add_u32 v12, s13, v10
    v_add_u32 v13, s13, v11
    s_waitcnt vmcnt(4)
    s_waitcnt lgkmcnt(6)
    v_mfma_f32_32x32x16_bf16 v[64:79], v[136:139], v[96:99], v[64:79]
    ds_read_b64_tr_b16 v[120:121], v12 offset:0
    ds_read_b64_tr_b16 v[122:123], v12 offset:1024
    s_waitcnt lgkmcnt(6)
    v_mfma_f32_32x32x16_bf16 v[80:95], v[140:143], v[96:99], v[80:95]
    ds_read_b64_tr_b16 v[124:125], v13 offset:0
    ds_read_b64_tr_b16 v[126:127], v13 offset:1024
    s_waitcnt lgkmcnt(6)
    v_mfma_f32_32x32x16_bf16 v[64:79], v[144:147], v[100:103], v[64:79]
    ds_read_b64_tr_b16 v[128:129], v12 offset:2048
    ds_read_b64_tr_b16 v[130:131], v12 offset:3072
    s_waitcnt lgkmcnt(6)
    v_mfma_f32_32x32x16_bf16 v[80:95], v[148:151], v[100:103], v[80:95]
    ds_read_b64_tr_b16 v[132:133], v13 offset:2048
    ds_read_b64_tr_b16 v[134:135], v13 offset:3072
    s_cmp_lg_u32 s96, 0
    s_cbranch_scc1 L_pk12
L_pl12:
    buffer_load_dword v56, v8, s[32:35], s15 offen sc1
    s_add_u32 s47, s47, 1
    s_cmp_ge_u32 s47, 16384
    s_cselect_b32 s12, -1, 0
    s_waitcnt vmcnt(0)
    v_cmp_eq_u32 vcc, s23, v56
    s_nop 1
    s_or_b32 s12, s12, vcc_lo
    s_lshr_b32 s12, s12, s93
    s_or_b32 s96, s96, s12
    s_andn2_b32 s96, s96, s14
    s_cbranch_scc0 L_pl12
L_pk12:
    s_ff1_i32_b32 s12, s96
    s_bitset0_b32 s96, s12
    s_bitset1_b32 s14, s12
    s_add_u32 s12, s12, s93
    s_and_b32 s84, s12, 15
    s_lshl_b32 s94, s84, 11
    s_add_u32 s94, s94, s95
    buffer_load_dwordx4 v[96:99], v17, s[32:35], s94 offen
    buffer_load_dwordx4 v[100:103], v17, s[32:35], s94 offen offset:1024
    s_add_u32 s12, s83, s97
    s_lshl_b32 s13, s12, 12
    s_cmp_ge_u32 s12, 10
    s_cselect_b32 s12, 24576, 0
    s_add_u32 s13, s13, s12
    v_add_u32 v14, s13, v10
    v_add_u32 v15, s13, v11
    s_waitcnt vmcnt(4)
    s_waitcnt lgkmcnt(6)
    v_mfma_f32_32x32x16_bf16 v[64:79], v[120:123], v[104:107], v[64:79]
    ds_read_b64_tr_b16 v[136:137], v14 offset:0
    ds_read_b64_tr_b16 v[138:139], v14 offset:1024
    s_waitcnt lgkmcnt(6)
    v_mfma_f32_32x32x16_bf16 v[80:95], v[124:127], v[104:107], v[80:95]
    ds_read_b64_tr_b16 v[140:141], v15 offset:0
    ds_read_b64_tr_b16 v[142:143], v15 offset:1024
    s_waitcnt lgkmcnt(6)
    v_mfma_f32_32x32x16_bf16 v[64:79], v[128:131], v[108:111], v[64:79]
    ds_read_b64_tr_b16 v[144:145], v14 offset:2048
    ds_read_b64_tr_b16 v[146:147], v14 offset:3072
    s_waitcnt lgkmcnt(6)
    v_mfma_f32_32x32x16_bf16 v[80:95], v[132:135], v[108:111], v[80:95]
    ds_read_b64_tr_b16 v[148:149], v15 offset:2048
    ds_read_b64_tr_b16 v[150:151], v15 offset:3072
    s_cmp_lg_u32 s96, 0
    s_cbranch_scc1 L_pk13
L_pl13:
    buffer_load_dword v57, v8, s[32:35], s15 offen sc1
    s_add_u32 s47, s47, 1
    s_cmp_ge_u32 s47, 16384
    s_cselect_b32 s12, -1, 0
    s_waitcnt vmcnt(0)
    v_cmp_eq_u32 vcc, s23, v57
    s_nop 1
    s_or_b32 s12, s12, vcc_lo
    s_lshr_b32 s12, s12, s93
    s_or_b32 s96, s96, s12
    s_andn2_b32 s96, s96, s14
    s_cbranch_scc0 L_pl13
L_pk13:
    s_ff1_i32_b32 s12, s96
    s_bitset0_b32 s96, s12
    s_bitset1_b32 s14, s12
    s_add_u32 s12, s12, s93
    s_and_b32 s85, s12, 15
    s_lshl_b32 s94, s85, 11
    s_add_u32 s94, s94, s95
    buffer_load_dwordx4 v[104:107], v17, s[32:35], s94 offen
    buffer_load_dwordx4 v[108:111], v17, s[32:35], s94 offen offset:1024
    s_add_u32 s12, s84, s97
    s_lshl_b32 s13, s12, 12
    s_cmp_ge_u32 s12, 10
    s_cselect_b32 s12, 24576, 0
    s_add_u32 s13, s13, s12
    v_add_u32 v12, s13, v10
    v_add_u32 v13, s13, v11
    s_waitcnt vmcnt(4)
    s_waitcnt lgkmcnt(6)
    v_mfma_f32_32x32x16_bf16 v[64:79], v[136:139], v[112:115], v[64:79]
    ds_read_b64_tr_b16 v[120:121], v12 offset:0
    ds_read_b64_tr_b16 v[122:123], v12 offset:1024
    s_waitcnt lgkmcnt(6)
    v_mfma_f32_32x32x16_bf16 v[80:95], v[140:143], v[112:115], v[80:95]
    ds_read_b64_tr_b16 v[124:125], v13 offset:0
    ds_read_b64_tr_b16 v[126:127], v13 offset:1024
    s_waitcnt lgkmcnt(6)
    v_mfma_f32_32x32x16_bf16 v[64:79], v[144:147], v[116:119], v[64:79]
    ds_read_b64_tr_b16 v[128:129], v12 offset:2048
    ds_read_b64_tr_b16 v[130:131], v12 offset:3072
    s_waitcnt lgkmcnt(6)
    v_mfma_f32_32x32x16_bf16 v[80:95], v[148:151], v[116:119], v[80:95]
    ds_read_b64_tr_b16 v[132:133], v13 offset:2048
    ds_read_b64_tr_b16 v[134:135], v13 offset:3072
    s_cmp_lg_u32 s96, 0
    s_cbranch_scc1 L_pk14
L_pl14:
    buffer_load_dword v58, v8, s[32:35], s15 offen sc1
    s_add_u32 s47, s47, 1
    s_cmp_ge_u32 s47, 16384
    s_cselect_b32 s12, -1, 0
    s_waitcnt vmcnt(0)
    v_cmp_eq_u32 vcc, s23, v58
    s_nop 1
    s_or_b32 s12, s12, vcc_lo
    s_lshr_b32 s12, s12, s93
    s_or_b32 s96, s96, s12
    s_andn2_b32 s96, s96, s14
    s_cbranch_scc0 L_pl14
L_pk14:
    s_ff1_i32_b32 s12, s96
    s_bitset0_b32 s96, s12
    s_bitset1_b32 s14, s12
    s_add_u32 s12, s12, s93
    s_and_b32 s86, s12, 15
    s_lshl_b32 s94, s86, 11
    s_add_u32 s94, s94, s95
    buffer_load_dwordx4 v[112:115], v17, s[32:35], s94 offen
    buffer_load_dwordx4 v[116:119], v17, s[32:35], s94 offen offset:1024
    s_add_u32 s12, s85, s97
    s_lshl_b32 s13, s12, 12
    s_cmp_ge_u32 s12, 10
    s_cselect_b32 s12, 24576, 0
    s_add_u32 s13, s13, s12
    v_add_u32 v14, s13, v10
    v_add_u32 v15, s13, v11
    s_waitcnt vmcnt(4)
    s_waitcnt lgkmcnt(6)
    v_mfma_f32_32x32x16_bf16 v[64:79], v[120:123], v[96:99], v[64:79]
    ds_read_b64_tr_b16 v[136:137], v14 offset:0
    ds_read_b64_tr_b16 v[138:139], v14 offset:1024
    s_waitcnt lgkmcnt(6)
    v_mfma_f32_32x32x16_bf16 v[80:95], v[124:127], v[96:99], v[80:95]
    ds_read_b64_tr_b16 v[140:141], v15 offset:0
    ds_read_b64_tr_b16 v[142:143], v15 offset:1024
    s_waitcnt lgkmcnt(6)
    v_mfma_f32_32x32x16_bf16 v[64:79], v[128:131], v[100:103], v[64:79]
    ds_read_b64_tr_b16 v[144:145], v14 offset:2048
    ds_read_b64_tr_b16 v[146:147], v14 offset:3072
    s_waitcnt lgkmcnt(6)
    v_mfma_f32_32x32x16_bf16 v[80:95], v[132:135], v[100:103], v[80:95]
    ds_read_b64_tr_b16 v[148:149], v15 offset:2048
    ds_read_b64_tr_b16 v[150:151], v15 offset:3072
    s_cmp_lg_u32 s96, 0
    s_cbranch_scc1 L_pk15
L_pl15:
    buffer_load_dword v59, v8, s[32:35], s15 offen sc1
    s_add_u32 s47, s47, 1
    s_cmp_ge_u32 s47, 16384
    s_cselect_b32 s12, -1, 0
    s_waitcnt vmcnt(0)
    v_cmp_eq_u32 vcc, s23, v59
    s_nop 1
    s_or_b32 s12, s12, vcc_lo
    s_lshr_b32 s12, s12, s93
    s_or_b32 s96, s96, s12
    s_andn2_b32 s96, s96, s14
    s_cbranch_scc0 L_pl15
L_pk15:
    s_ff1_i32_b32 s12, s96
    s_bitset0_b32 s96, s12
    s_bitset1_b32 s14, s12
    s_add_u32 s12, s12, s93
    s_and_b32 s87, s12, 15
    s_lshl_b32 s94, s87, 11
    s_add_u32 s94, s94, s95
    buffer_load_dwordx4 v[96:99], v17, s[32:35], s94 offen
    buffer_load_dwordx4 v[100:103], v17, s[32:35], s94 offen offset:1024
    s_mov_b32 s45, 1
    s_cmp_eq_u32 s46, 0
    s_cbranch_scc1 L_b_nold
    s_lshl_b32 s12, s89, 12
    s_add_u32 s12, s12, 458752
    buffer_load_dwordx4 v[224:227], v22, s[32:35], s12 offen offset:0 sc1
    buffer_load_dwordx4 v[228:231], v22, s[32:35], s12 offen offset:16 sc1
    buffer_load_dwordx4 v[232:235], v22, s[32:35], s12 offen offset:64 sc1
    buffer_load_dwordx4 v[236:239], v22, s[32:35], s12 offen offset:80 sc1
L_b_nold:
    s_add_u32 s12, s86, s97
    s_lshl_b32 s13, s12, 12
    s_cmp_ge_u32 s12, 10
    s_cselect_b32 s12, 24576, 0
    s_add_u32 s13, s13, s12
    v_add_u32 v12, s13, v10
    v_add_u32 v13, s13, v11
    s_waitcnt vmcnt(4)
    s_waitcnt lgkmcnt(6)
    v_mfma_f32_32x32x16_bf16 v[64:79], v[136:139], v[104:107], v[64:79]
    ds_read_b64_tr_b16 v[120:121], v12 offset:0
    ds_read_b64_tr_b16 v[122:123], v12 offset:1024
    s_waitcnt lgkmcnt(6)
    v_mfma_f32_32x32x16_bf16 v[80:95], v[140:143], v[104:107], v[80:95]
    ds_read_b64_tr_b16 v[124:125], v13 offset:0
    ds_read_b64_tr_b16 v[126:127], v13 offset:1024
    s_waitcnt lgkmcnt(6)
    v_mfma_f32_32x32x16_bf16 v[64:79], v[144:147], v[108:111], v[64:79]
    ds_read_b64_tr_b16 v[128:129], v12 offset:2048
    ds_read_b64_tr_b16 v[130:131], v12 offset:3072
    s_waitcnt lgkmcnt(6)
    v_mfma_f32_32x32x16_bf16 v[80:95], v[148:151], v[108:111], v[80:95]
    ds_read_b64_tr_b16 v[132:133], v13 offset:2048
    ds_read_b64_tr_b16 v[134:135], v13 offset:3072
    s_add_u32 s12, s87, s97
    s_lshl_b32 s13, s12, 12
    s_cmp_ge_u32 s12, 10
    s_cselect_b32 s12, 24576, 0
    s_add_u32 s13, s13, s12
    v_add_u32 v14, s13, v10
    v_add_u32 v15, s13, v11
    s_waitcnt vmcnt(2)
    s_waitcnt lgkmcnt(6)
    v_mfma_f32_32x32x16_bf16 v[64:79], v[120:123], v[112:115], v[64:79]
    ds_read_b64_tr_b16 v[136:137], v14 offset:0
    ds_read_b64_tr_b16 v[138:139], v14 offset:1024
    s_waitcnt lgkmcnt(6)
    v_mfma_f32_32x32x16_bf16 v[80:95], v[124:127], v[112:115], v[80:95]
    ds_read_b64_tr_b16 v[140:141], v15 offset:0
    ds_read_b64_tr_b16 v[142:143], v15 offset:1024
    s_waitcnt lgkmcnt(6)
    v_mfma_f32_32x32x16_bf16 v[64:79], v[128:131], v[116:119], v[64:79]
    ds_read_b64_tr_b16 v[144:145], v14 offset:2048
    ds_read_b64_tr_b16 v[146:147], v14 offset:3072
    s_waitcnt lgkmcnt(6)
    v_mfma_f32_32x32x16_bf16 v[80:95], v[132:135], v[116:119], v[80:95]
    ds_read_b64_tr_b16 v[148:149], v15 offset:2048
    ds_read_b64_tr_b16 v[150:151], v15 offset:3072
    s_waitcnt vmcnt(0)
    s_waitcnt lgkmcnt(6)
    v_mfma_f32_32x32x16_bf16 v[64:79], v[136:139], v[96:99], v[64:79]
    s_waitcnt lgkmcnt(4)
    v_mfma_f32_32x32x16_bf16 v[80:95], v[140:143], v[96:99], v[80:95]
    s_waitcnt lgkmcnt(2)
    v_mfma_f32_32x32x16_bf16 v[64:79], v[144:147], v[100:103], v[64:79]
    s_waitcnt lgkmcnt(0)
    v_mfma_f32_32x32x16_bf16 v[80:95], v[148:151], v[100:103], v[80:95]
    s_cmp_lg_u32 s46, 0
    s_cbranch_scc1 L_own
L_own_r1:
    s_nop 0
    s_nop 8
    v_permlane16_swap_b32 v64, v80
    v_permlane16_swap_b32 v65, v81
    v_permlane16_swap_b32 v66, v82
    v_permlane16_swap_b32 v67, v83
    v_permlane16_swap_b32 v68, v84
    v_permlane16_swap_b32 v69, v85
    v_permlane16_swap_b32 v70, v86
    v_permlane16_swap_b32 v71, v87
    v_permlane16_swap_b32 v72, v88
    v_permlane16_swap_b32 v73, v89
    v_permlane16_swap_b32 v74, v90
    v_permlane16_swap_b32 v75, v91
    v_permlane16_swap_b32 v76, v92
    v_permlane16_swap_b32 v77, v93
    v_permlane16_swap_b32 v78, v94
    v_permlane16_swap_b32 v79, v95
    ds_write_b128 v20, v[80:83] offset:0
    ds_write_b128 v20, v[84:87] offset:1024
    ds_write_b128 v20, v[88:91] offset:2048
    ds_write_b128 v20, v[92:95] offset:3072
    s_waitcnt lgkmcnt(0)
    v_bfe_u32 v9, v2, 3, 1
    v_mul_u32_u24 v9, 16352, v9
    v_sub_u32 v7, v7, v9
    s_mov_b32 s12, 16384
    s_barrier
    ds_read_b128 v[80:83], v21 offset:0
    ds_read_b128 v[84:87], v21 offset:1024
    ds_read_b128 v[88:91], v21 offset:2048
    ds_read_b128 v[92:95], v21 offset:3072
    s_waitcnt lgkmcnt(3)
    v_pk_add_f32 v[64:65], v[64:65], v[80:81]
    v_pk_add_f32 v[66:67], v[66:67], v[82:83]
    v_cvt_pk_bf16_f32 v96, v64, v65
    v_cvt_pk_bf16_f32 v97, v66, v67
    s_waitcnt lgkmcnt(2)
    v_pk_add_f32 v[68:69], v[68:69], v[84:85]
    v_pk_add_f32 v[70:71], v[70:71], v[86:87]
    v_cvt_pk_bf16_f32 v98, v68, v69
    v_cvt_pk_bf16_f32 v99, v70, v71
    s_waitcnt lgkmcnt(1)
    v_pk_add_f32 v[72:73], v[72:73], v[88:89]
    v_pk_add_f32 v[74:75], v[74:75], v[90:91]
    v_cvt_pk_bf16_f32 v100, v72, v73
    v_cvt_pk_bf16_f32 v101, v74, v75
    s_waitcnt lgkmcnt(0)
    v_pk_add_f32 v[76:77], v[76:77], v[92:93]
    v_pk_add_f32 v[78:79], v[78:79], v[94:95]
    v_cvt_pk_bf16_f32 v102, v76, v77
    v_cvt_pk_bf16_f32 v103, v78, v79
    v_permlane32_swap_b32 v96, v98
    v_permlane32_swap_b32 v97, v99
    v_permlane32_swap_b32 v100, v102
    v_permlane32_swap_b32 v101, v103
    v_lshlrev_b32 v104, 16, v96
    v_and_b32 v105, 0xffff0000, v96
    v_lshlrev_b32 v106, 16, v97
    v_and_b32 v107, 0xffff0000, v97
    v_lshlrev_b32 v108, 16, v98
    v_and_b32 v109, 0xffff0000, v98
    v_lshlrev_b32 v110, 16, v99
    v_and_b32 v111, 0xffff0000, v99
    v_pk_mul_f32 v[104:105], v[104:105], v[48:49] op_sel_hi:[1,0]
    v_pk_mul_f32 v[106:107], v[106:107], v[48:49] op_sel_hi:[1,0]
    v_pk_mul_f32 v[108:109], v[108:109], v[48:49] op_sel_hi:[1,0]
    v_pk_mul_f32 v[110:111], v[110:111], v[48:49] op_sel_hi:[1,0]
    v_cvt_pk_bf16_f32 v96, v104, v105
    v_cvt_pk_bf16_f32 v97, v106, v107
    v_cvt_pk_bf16_f32 v98, v108, v109
    v_cvt_pk_bf16_f32 v99, v110, v111
    v_lshlrev_b32 v104, 16, v96
    v_and_b32 v105, 0xffff0000, v96
    v_lshlrev_b32 v106, 16, v97
    v_and_b32 v107, 0xffff0000, v97
    v_lshlrev_b32 v108, 16, v98
    v_and_b32 v109, 0xffff0000, v98
    v_lshlrev_b32 v110, 16, v99
    v_and_b32 v111, 0xffff0000, v99
    v_pk_add_f32 v[104:105], v[104:105], v[32:33]
    v_pk_add_f32 v[106:107], v[106:107], v[34:35]
    v_pk_add_f32 v[108:109], v[108:109], v[36:37]
    v_pk_add_f32 v[110:111], v[110:111], v[38:39]
    v_cvt_pk_bf16_f32 v96, v104, v105
    v_cvt_pk_bf16_f32 v97, v106, v107
    v_cvt_pk_bf16_f32 v98, v108, v109
    v_cvt_pk_bf16_f32 v99, v110, v111
    v_lshlrev_b32 v112, 16, v100
    v_and_b32 v113, 0xffff0000, v100
    v_lshlrev_b32 v114, 16, v101
    v_and_b32 v115, 0xffff0000, v101
    v_lshlrev_b32 v116, 16, v102
    v_and_b32 v117, 0xffff0000, v102
    v_lshlrev_b32 v118, 16, v103
    v_and_b32 v119, 0xffff0000, v103
    v_pk_mul_f32 v[112:113], v[112:113], v[48:49] op_sel_hi:[1,0]
    v_pk_mul_f32 v[114:115], v[114:115], v[48:49] op_sel_hi:[1,0]
    v_pk_mul_f32 v[116:117], v[116:117], v[48:49] op_sel_hi:[1,0]
    v_pk_mul_f32 v[118:119], v[118:119], v[48:49] op_sel_hi:[1,0]
    v_cvt_pk_bf16_f32 v100, v112, v113
    v_cvt_pk_bf16_f32 v101, v114, v115
    v_cvt_pk_bf16_f32 v102, v116, v117
    v_cvt_pk_bf16_f32 v103, v118, v119
    v_lshlrev_b32 v112, 16, v100
    v_and_b32 v113, 0xffff0000, v100
    v_lshlrev_b32 v114, 16, v101
    v_and_b32 v115, 0xffff0000, v101
    v_lshlrev_b32 v116, 16, v102
    v_and_b32 v117, 0xffff0000, v102
    v_lshlrev_b32 v118, 16, v103
    v_and_b32 v119, 0xffff0000, v103
    v_pk_add_f32 v[112:113], v[112:113], v[40:41]
    v_pk_add_f32 v[114:115], v[114:115], v[42:43]
    v_pk_add_f32 v[116:117], v[116:117], v[44:45]
    v_pk_add_f32 v[118:119], v[118:119], v[46:47]
    v_cvt_pk_bf16_f32 v100, v112, v113
    v_cvt_pk_bf16_f32 v101, v114, v115
    v_cvt_pk_bf16_f32 v102, v116, v117
    v_cvt_pk_bf16_f32 v103, v118, v119
    v_mov_b32 v104, v100
    v_mov_b32 v105, v101
    v_mov_b32 v106, v102
    v_mov_b32 v107, v103
    v_mov_b32_dpp v100, v96 row_ror:8 row_mask:0xf bank_mask:0x3
    v_mov_b32_dpp v101, v97 row_ror:8 row_mask:0xf bank_mask:0x3
    v_mov_b32_dpp v102, v98 row_ror:8 row_mask:0xf bank_mask:0x3
    v_mov_b32_dpp v103, v99 row_ror:8 row_mask:0xf bank_mask:0x3
    v_mov_b32_dpp v96, v104 row_ror:8 row_mask:0xf bank_mask:0xc
    v_mov_b32_dpp v97, v105 row_ror:8 row_mask:0xf bank_mask:0xc
    v_mov_b32_dpp v98, v106 row_ror:8 row_mask:0xf bank_mask:0xc
    v_mov_b32_dpp v99, v107 row_ror:8 row_mask:0xf bank_mask:0xc
    buffer_store_dwordx4 v[96:99], v7, s[68:71], 0 offen sc1
    buffer_store_dwordx4 v[100:103], v7, s[68:71], s12 offen sc1
    s_endpgm
L_own:
    s_mov_b32 s13, 0
L_b_y:
    s_waitcnt vmcnt(0)
    v_msad_u8 v240, v224, s76, 0
    v_msad_u8 v240, v225, s77, v240
    v_msad_u8 v240, v226, s78, v240
    v_msad_u8 v240, v227, s79, v240
    v_msad_u8 v240, v228, s76, v240
    v_msad_u8 v240, v229, s77, v240
    v_msad_u8 v240, v230, s78, v240
    v_msad_u8 v240, v231, s79, v240
    v_msad_u8 v240, v232, s76, v240
    v_msad_u8 v240, v233, s77, v240
    v_msad_u8 v240, v234, s78, v240
    v_msad_u8 v240, v235, s79, v240
    v_msad_u8 v240, v236, s76, v240
    v_msad_u8 v240, v237, s77, v240
    v_msad_u8 v240, v238, s78, v240
    v_msad_u8 v240, v239, s79, v240
    v_cmp_ne_u32 vcc, 0, v240
    s_nop 1
    s_or_b32 s46, vcc_lo, vcc_hi
    s_cbranch_scc0 L_b_yok
    s_cmp_eq_u32 s45, 0
    s_cbranch_scc1 L_b_yok
    s_lshl_b32 s12, s89, 12
    s_add_u32 s12, s12, 458752
    buffer_load_dwordx4 v[224:227], v22, s[32:35], s12 offen offset:0 sc1
    buffer_load_dwordx4 v[228:231], v22, s[32:35], s12 offen offset:16 sc1
    buffer_load_dwordx4 v[232:235], v22, s[32:35], s12 offen offset:64 sc1
    buffer_load_dwordx4 v[236:239], v22, s[32:35], s12 offen offset:80 sc1
    s_add_u32 s13, s13, 1
    s_cmp_lt_u32 s13, 16384
    s_cbranch_scc1 L_b_y
    s_waitcnt vmcnt(0)
    s_mov_b32 s46, 0
L_b_yok:
    v_add_f32_dpp v224, v224, v224 row_ror:1 row_mask:0xf bank_mask:0xf
    v_add_f32_dpp v225, v225, v225 row_ror:1 row_mask:0xf bank_mask:0xf
    v_add_f32_dpp v226, v226, v226 row_ror:1 row_mask:0xf bank_mask:0xf
    v_add_f32_dpp v227, v227, v227 row_ror:1 row_mask:0xf bank_mask:0xf
    v_add_f32_dpp v228, v228, v228 row_ror:1 row_mask:0xf bank_mask:0xf
    v_add_f32_dpp v229, v229, v229 row_ror:1 row_mask:0xf bank_mask:0xf
    v_add_f32_dpp v230, v230, v230 row_ror:1 row_mask:0xf bank_mask:0xf
    v_add_f32_dpp v231, v231, v231 row_ror:1 row_mask:0xf bank_mask:0xf
    v_add_f32_dpp v232, v232, v232 row_ror:1 row_mask:0xf bank_mask:0xf
    v_add_f32_dpp v233, v233, v233 row_ror:1 row_mask:0xf bank_mask:0xf
    v_add_f32_dpp v234, v234, v234 row_ror:1 row_mask:0xf bank_mask:0xf
    v_add_f32_dpp v235, v235, v235 row_ror:1 row_mask:0xf bank_mask:0xf
    v_add_f32_dpp v236, v236, v236 row_ror:1 row_mask:0xf bank_mask:0xf
    v_add_f32_dpp v237, v237, v237 row_ror:1 row_mask:0xf bank_mask:0xf
    v_add_f32_dpp v238, v238, v238 row_ror:1 row_mask:0xf bank_mask:0xf
    v_add_f32_dpp v239, v239, v239 row_ror:1 row_mask:0xf bank_mask:0xf
    v_add_f32_dpp v224, v224, v224 row_ror:2 row_mask:0xf bank_mask:0xf
    v_add_f32_dpp v225, v225, v225 row_ror:2 row_mask:0xf bank_mask:0xf
    v_add_f32_dpp v226, v226, v226 row_ror:2 row_mask:0xf bank_mask:0xf
    v_add_f32_dpp v227, v227, v227 row_ror:2 row_mask:0xf bank_mask:0xf
    v_add_f32_dpp v228, v228, v228 row_ror:2 row_mask:0xf bank_mask:0xf
    v_add_f32_dpp v229, v229, v229 row_ror:2 row_mask:0xf bank_mask:0xf
    v_add_f32_dpp v230, v230, v230 row_ror:2 row_mask:0xf bank_mask:0xf
    v_add_f32_dpp v231, v231, v231 row_ror:2 row_mask:0xf bank_mask:0xf
    v_add_f32_dpp v232, v232, v232 row_ror:2 row_mask:0xf bank_mask:0xf
    v_add_f32_dpp v233, v233, v233 row_ror:2 row_mask:0xf bank_mask:0xf
    v_add_f32_dpp v234, v234, v234 row_ror:2 row_mask:0xf bank_mask:0xf
    v_add_f32_dpp v235, v235, v235 row_ror:2 row_mask:0xf bank_mask:0xf
    v_add_f32_dpp v236, v236, v236 row_ror:2 row_mask:0xf bank_mask:0xf
    v_add_f32_dpp v237, v237, v237 row_ror:2 row_mask:0xf bank_mask:0xf
    v_add_f32_dpp v238, v238, v238 row_ror:2 row_mask:0xf bank_mask:0xf
    v_add_f32_dpp v239, v239, v239 row_ror:2 row_mask:0xf bank_mask:0xf
    v_add_f32_dpp v224, v224, v224 row_ror:4 row_mask:0xf bank_mask:0xf
    v_add_f32_dpp v225, v225, v225 row_ror:4 row_mask:0xf bank_mask:0xf
    v_add_f32_dpp v226, v226, v226 row_ror:4 row_mask:0xf bank_mask:0xf
    v_add_f32_dpp v227, v227, v227 row_ror:4 row_mask:0xf bank_mask:0xf
    v_add_f32_dpp v228, v228, v228 row_ror:4 row_mask:0xf bank_mask:0xf
    v_add_f32_dpp v229, v229, v229 row_ror:4 row_mask:0xf bank_mask:0xf
    v_add_f32_dpp v230, v230, v230 row_ror:4 row_mask:0xf bank_mask:0xf
    v_add_f32_dpp v231, v231, v231 row_ror:4 row_mask:0xf bank_mask:0xf
    v_add_f32_dpp v232, v232, v232 row_ror:4 row_mask:0xf bank_mask:0xf
    v_add_f32_dpp v233, v233, v233 row_ror:4 row_mask:0xf bank_mask:0xf
    v_add_f32_dpp v234, v234, v234 row_ror:4 row_mask:0xf bank_mask:0xf
    v_add_f32_dpp v235, v235, v235 row_ror:4 row_mask:0xf bank_mask:0xf
    v_add_f32_dpp v236, v236, v236 row_ror:4 row_mask:0xf bank_mask:0xf
    v_add_f32_dpp v237, v237, v237 row_ror:4 row_mask:0xf bank_mask:0xf
    v_add_f32_dpp v238, v238, v238 row_ror:4 row_mask:0xf bank_mask:0xf
    v_add_f32_dpp v239, v239, v239 row_ror:4 row_mask:0xf bank_mask:0xf
    v_add_f32_dpp v224, v224, v224 row_ror:8 row_mask:0xf bank_mask:0xf
    v_add_f32_dpp v225, v225, v225 row_ror:8 row_mask:0xf bank_mask:0xf
    v_add_f32_dpp v226, v226, v226 row_ror:8 row_mask:0xf bank_mask:0xf
    v_add_f32_dpp v227, v227, v227 row_ror:8 row_mask:0xf bank_mask:0xf
    v_add_f32_dpp v228, v228, v228 row_ror:8 row_mask:0xf bank_mask:0xf
    v_add_f32_dpp v229, v229, v229 row_ror:8 row_mask:0xf bank_mask:0xf
    v_add_f32_dpp v230, v230, v230 row_ror:8 row_mask:0xf bank_mask:0xf
    v_add_f32_dpp v231, v231, v231 row_ror:8 row_mask:0xf bank_mask:0xf
    v_add_f32_dpp v232, v232, v232 row_ror:8 row_mask:0xf bank_mask:0xf
    v_add_f32_dpp v233, v233, v233 row_ror:8 row_mask:0xf bank_mask:0xf
    v_add_f32_dpp v234, v234, v234 row_ror:8 row_mask:0xf bank_mask:0xf
    v_add_f32_dpp v235, v235, v235 row_ror:8 row_mask:0xf bank_mask:0xf
    v_add_f32_dpp v236, v236, v236 row_ror:8 row_mask:0xf bank_mask:0xf
    v_add_f32_dpp v237, v237, v237 row_ror:8 row_mask:0xf bank_mask:0xf
    v_add_f32_dpp v238, v238, v238 row_ror:8 row_mask:0xf bank_mask:0xf
    v_add_f32_dpp v239, v239, v239 row_ror:8 row_mask:0xf bank_mask:0xf
    v_cvt_pk_bf16_f32 v240, v224, v225
    v_cvt_pk_bf16_f32 v241, v226, v227
    v_cvt_pk_bf16_f32 v242, v228, v229
    v_cvt_pk_bf16_f32 v243, v230, v231
    v_cvt_pk_bf16_f32 v244, v232, v233
    v_cvt_pk_bf16_f32 v245, v234, v235
    v_cvt_pk_bf16_f32 v246, v236, v237
    v_cvt_pk_bf16_f32 v247, v238, v239
    v_lshlrev_b32 v224, 16, v240
    v_and_b32 v225, 0xffff0000, v240
    v_lshlrev_b32 v226, 16, v241
    v_and_b32 v227, 0xffff0000, v241
    v_lshlrev_b32 v228, 16, v242
    v_and_b32 v229, 0xffff0000, v242
    v_lshlrev_b32 v230, 16, v243
    v_and_b32 v231, 0xffff0000, v243
    v_lshlrev_b32 v232, 16, v244
    v_and_b32 v233, 0xffff0000, v244
    v_lshlrev_b32 v234, 16, v245
    v_and_b32 v235, 0xffff0000, v245
    v_lshlrev_b32 v236, 16, v246
    v_and_b32 v237, 0xffff0000, v246
    v_lshlrev_b32 v238, 16, v247
    v_and_b32 v239, 0xffff0000, v247
    v_pk_mul_f32 v[224:225], v[224:225], s[22:23] op_sel_hi:[1,0]
    v_pk_mul_f32 v[226:227], v[226:227], s[22:23] op_sel_hi:[1,0]
    v_pk_mul_f32 v[228:229], v[228:229], s[22:23] op_sel_hi:[1,0]
    v_pk_mul_f32 v[230:231], v[230:231], s[22:23] op_sel_hi:[1,0]
    v_pk_mul_f32 v[232:233], v[232:233], s[22:23] op_sel_hi:[1,0]
    v_pk_mul_f32 v[234:235], v[234:235], s[22:23] op_sel_hi:[1,0]
    v_pk_mul_f32 v[236:237], v[236:237], s[22:23] op_sel_hi:[1,0]
    v_pk_mul_f32 v[238:239], v[238:239], s[22:23] op_sel_hi:[1,0]
    v_cvt_pk_bf16_f32 v240, v224, v225
    v_cvt_pk_bf16_f32 v241, v226, v227
    v_cvt_pk_bf16_f32 v242, v228, v229
    v_cvt_pk_bf16_f32 v243, v230, v231
    v_cvt_pk_bf16_f32 v244, v232, v233
    v_cvt_pk_bf16_f32 v245, v234, v235
    v_cvt_pk_bf16_f32 v246, v236, v237
    v_cvt_pk_bf16_f32 v247, v238, v239
    v_lshlrev_b32 v224, 16, v240
    v_and_b32 v225, 0xffff0000, v240
    v_lshlrev_b32 v226, 16, v241
    v_and_b32 v227, 0xffff0000, v241
    v_lshlrev_b32 v228, 16, v242
    v_and_b32 v229, 0xffff0000, v242
    v_lshlrev_b32 v230, 16, v243
    v_and_b32 v231, 0xffff0000, v243
    v_lshlrev_b32 v232, 16, v244
    v_and_b32 v233, 0xffff0000, v244
    v_lshlrev_b32 v234, 16, v245
    v_and_b32 v235, 0xffff0000, v245
    v_lshlrev_b32 v236, 16, v246
    v_and_b32 v237, 0xffff0000, v246
    v_lshlrev_b32 v238, 16, v247
    v_and_b32 v239, 0xffff0000, v247
    v_lshlrev_b32 v32, 16, v24
    v_and_b32 v33, 0xffff0000, v24
    v_lshlrev_b32 v34, 16, v25
    v_and_b32 v35, 0xffff0000, v25
    v_lshlrev_b32 v36, 16, v26
    v_and_b32 v37, 0xffff0000, v26
    v_lshlrev_b32 v38, 16, v27
    v_and_b32 v39, 0xffff0000, v27
    v_lshlrev_b32 v40, 16, v28
    v_and_b32 v41, 0xffff0000, v28
    v_lshlrev_b32 v42, 16, v29
    v_and_b32 v43, 0xffff0000, v29
    v_lshlrev_b32 v44, 16, v30
    v_and_b32 v45, 0xffff0000, v30
    v_lshlrev_b32 v46, 16, v31
    v_and_b32 v47, 0xffff0000, v31
    v_pk_add_f32 v[224:225], v[224:225], v[32:33]
    v_pk_add_f32 v[226:227], v[226:227], v[34:35]
    v_pk_add_f32 v[228:229], v[228:229], v[36:37]
    v_pk_add_f32 v[230:231], v[230:231], v[38:39]
    v_pk_add_f32 v[232:233], v[232:233], v[40:41]
    v_pk_add_f32 v[234:235], v[234:235], v[42:43]
    v_pk_add_f32 v[236:237], v[236:237], v[44:45]
    v_pk_add_f32 v[238:239], v[238:239], v[46:47]
    v_cvt_pk_bf16_f32 v240, v224, v225
    v_cvt_pk_bf16_f32 v241, v226, v227
    v_cvt_pk_bf16_f32 v242, v228, v229
    v_cvt_pk_bf16_f32 v243, v230, v231
    v_cvt_pk_bf16_f32 v244, v232, v233
    v_cvt_pk_bf16_f32 v245, v234, v235
    v_cvt_pk_bf16_f32 v246, v236, v237
    v_cvt_pk_bf16_f32 v247, v238, v239
    s_cmp_eq_u32 s46, 0
    s_cselect_b32 s12, s21, -1
    v_cmp_eq_u32 vcc, s12, v6
    s_nop 1
    v_cndmask_b32 v24, v24, v240, vcc
    v_cndmask_b32 v25, v25, v241, vcc
    v_cndmask_b32 v26, v26, v242, vcc
    v_cndmask_b32 v27, v27, v243, vcc
    v_cndmask_b32 v28, v28, v244, vcc
    v_cndmask_b32 v29, v29, v245, vcc
    v_cndmask_b32 v30, v30, v246, vcc
    v_cndmask_b32 v31, v31, v247, vcc
    v_lshlrev_b32 v32, 16, v24
    v_and_b32 v33, 0xffff0000, v24
    v_lshlrev_b32 v34, 16, v25
    v_and_b32 v35, 0xffff0000, v25
    v_lshlrev_b32 v36, 16, v26
    v_and_b32 v37, 0xffff0000, v26
    v_lshlrev_b32 v38, 16, v27
    v_and_b32 v39, 0xffff0000, v27
    v_lshlrev_b32 v40, 16, v28
    v_and_b32 v41, 0xffff0000, v28
    v_lshlrev_b32 v42, 16, v29
    v_and_b32 v43, 0xffff0000, v29
    v_lshlrev_b32 v44, 16, v30
    v_and_b32 v45, 0xffff0000, v30
    v_lshlrev_b32 v46, 16, v31
    v_and_b32 v47, 0xffff0000, v31
    v_pk_mul_f32 v[32:33], v[32:33], v[50:51] op_sel_hi:[1,0]
    v_pk_mul_f32 v[34:35], v[34:35], v[50:51] op_sel_hi:[1,0]
    v_pk_mul_f32 v[36:37], v[36:37], v[50:51] op_sel_hi:[1,0]
    v_pk_mul_f32 v[38:39], v[38:39], v[50:51] op_sel_hi:[1,0]
    v_pk_mul_f32 v[40:41], v[40:41], v[50:51] op_sel_hi:[1,0]
    v_pk_mul_f32 v[42:43], v[42:43], v[50:51] op_sel_hi:[1,0]
    v_pk_mul_f32 v[44:45], v[44:45], v[50:51] op_sel_hi:[1,0]
    v_pk_mul_f32 v[46:47], v[46:47], v[50:51] op_sel_hi:[1,0]
    v_cvt_pk_bf16_f32 v33, v32, v33
    v_cvt_pk_bf16_f32 v35, v34, v35
    v_cvt_pk_bf16_f32 v37, v36, v37
    v_cvt_pk_bf16_f32 v39, v38, v39
    v_cvt_pk_bf16_f32 v41, v40, v41
    v_cvt_pk_bf16_f32 v43, v42, v43
    v_cvt_pk_bf16_f32 v45, v44, v45
    v_cvt_pk_bf16_f32 v47, v46, v47
    v_lshlrev_b32 v32, 16, v33
    v_and_b32 v33, 0xffff0000, v33
    v_lshlrev_b32 v34, 16, v35
    v_and_b32 v35, 0xffff0000, v35
    v_lshlrev_b32 v36, 16, v37
    v_and_b32 v37, 0xffff0000, v37
    v_lshlrev_b32 v38, 16, v39
    v_and_b32 v39, 0xffff0000, v39
    v_lshlrev_b32 v40, 16, v41
    v_and_b32 v41, 0xffff0000, v41
    v_lshlrev_b32 v42, 16, v43
    v_and_b32 v43, 0xffff0000, v43
    v_lshlrev_b32 v44, 16, v45
    v_and_b32 v45, 0xffff0000, v45
    v_lshlrev_b32 v46, 16, v47
    v_and_b32 v47, 0xffff0000, v47
    s_cmp_eq_u32 s45, 0
    s_cbranch_scc1 L_own_r0
    s_branch L_own_r1
L_end:
    s_endpgm
.section .rodata,"a"
.p2align 6
.amdhsa_kernel gated_mix__linear_kernel_hedgehog__moe_arch_mod__prompt_kernel
  .amdhsa_next_free_vgpr 256
  .amdhsa_next_free_sgpr 102
  .amdhsa_accum_offset 256
  .amdhsa_group_segment_fixed_size 0
  .amdhsa_kernarg_size 104
  .amdhsa_user_sgpr_count 2
  .amdhsa_user_sgpr_kernarg_segment_ptr 1
  .amdhsa_system_sgpr_workgroup_id_x 1
.end_amdhsa_kernel
```

```asm
; @launch grid=(256,1,1) block=(512,1,1) lds=163840
.amdgcn_target "amdgcn-amd-amdhsa--gfx950"
.text
.globl gated_mix__linear_kernel_hedgehog__moe_arch_mod__prompt_kernel
.p2align 8
.type gated_mix__linear_kernel_hedgehog__moe_arch_mod__prompt_kernel,@function
gated_mix__linear_kernel_hedgehog__moe_arch_mod__prompt_kernel:
    s_cmp_ge_u32 s2, 256
    s_cbranch_scc1 L_end
    s_load_dwordx4 s[4:7], s[0:1], 0
    s_load_dwordx4 s[8:11], s[0:1], 16
    s_load_dwordx16 s[48:63], s[0:1], 40
    v_lshrrev_b32 v1, 6, v0
    v_and_b32 v2, 63, v0
    v_readfirstlane_b32 s20, v1
    s_and_b32 s16, s2, 7
    s_lshr_b32 s17, s2, 3
    s_and_b32 s18, s16, 1
    s_lshl_b32 s18, s18, 3
    s_and_b32 s19, s17, 7
    s_add_u32 s18, s18, s19
    s_lshr_b32 s19, s16, 1
    s_lshl_b32 s19, s19, 2
    s_lshr_b32 s12, s17, 3
    s_add_u32 s19, s19, s12
    v_lshlrev_b32 v5, 4, v2
    s_cmp_lt_u32 s20, 4
    s_cbranch_scc1 L_compute
    s_sub_u32 s21, s20, 4
    s_mov_b32 s68, 0x76543210
    s_mov_b32 s69, 0xfedcba98
    s_lshl_b32 s12, s16, 1
    s_mul_i32 s12, s12, 0x11111111
    s_xor_b32 s68, s68, s12
    s_xor_b32 s69, s69, s12
    v_lshrrev_b32 v4, 3, v2
    v_lshlrev_b32 v9, 11, v4
    v_and_b32 v6, 7, v2
    v_lshrrev_b32 v7, 4, v2
    v_xor_b32 v8, v6, v7
    v_lshl_add_u32 v10, v8, 4, v9
    v_xor_b32 v8, 4, v8
    v_lshl_add_u32 v11, v8, 4, v9
    v_mul_u32_u24 v12, 6144, v4
    v_and_b32 v7, 1, v7
    v_lshlrev_b32 v7, 2, v7
    v_xor_b32 v8, v6, v7
    v_lshl_add_u32 v12, v8, 4, v12
    s_lshl_b32 s12, s18, 18
    s_lshl_b32 s13, s21, 16
    s_add_u32 s12, s12, s13
    s_add_u32 s13, s12, 0
    v_add_u32 v20, s13, v10
    s_add_u32 s13, s12, 15360
    v_add_u32 v21, s13, v11
    s_add_u32 s13, s12, 30720
    v_add_u32 v22, s13, v10
    s_add_u32 s13, s12, 46080
    v_add_u32 v23, s13, v11
    s_lshl_b32 s12, s19, 7
    s_mul_i32 s14, s21, 6
    s_add_u32 s13, s14, 0
    s_and_b32 s15, s13, 7
    s_mul_i32 s15, s15, 49152
    s_lshr_b32 s13, s13, 3
    s_lshl_b32 s13, s13, 11
    s_add_u32 s13, s13, s15
    s_add_u32 s13, s13, s12
    s_sub_u32 s13, s13, 0
    v_add_u32 v24, s13, v12
    s_add_u32 s13, s14, 1
    s_and_b32 s15, s13, 7
    s_mul_i32 s15, s15, 49152
    s_lshr_b32 s13, s13, 3
    s_lshl_b32 s13, s13, 11
    s_add_u32 s13, s13, s15
    s_add_u32 s13, s13, s12
    s_sub_u32 s13, s13, 1024
    v_add_u32 v25, s13, v12
    s_add_u32 s13, s14, 2
    s_and_b32 s15, s13, 7
    s_mul_i32 s15, s15, 49152
    s_lshr_b32 s13, s13, 3
    s_lshl_b32 s13, s13, 11
    s_add_u32 s13, s13, s15
    s_add_u32 s13, s13, s12
    s_sub_u32 s13, s13, 2048
    v_add_u32 v26, s13, v12
    s_add_u32 s13, s14, 3
    s_and_b32 s15, s13, 7
    s_mul_i32 s15, s15, 49152
    s_lshr_b32 s13, s13, 3
    s_lshl_b32 s13, s13, 11
    s_add_u32 s13, s13, s15
    s_add_u32 s13, s13, s12
    s_sub_u32 s13, s13, 0
    v_add_u32 v27, s13, v12
    s_add_u32 s13, s14, 4
    s_and_b32 s15, s13, 7
    s_mul_i32 s15, s15, 49152
    s_lshr_b32 s13, s13, 3
    s_lshl_b32 s13, s13, 11
    s_add_u32 s13, s13, s15
    s_add_u32 s13, s13, s12
    s_sub_u32 s13, s13, 1024
    v_add_u32 v28, s13, v12
    s_add_u32 s13, s14, 5
    s_and_b32 s15, s13, 7
    s_mul_i32 s15, s15, 49152
    s_lshr_b32 s13, s13, 3
    s_lshl_b32 s13, s13, 11
    s_add_u32 s13, s13, s15
    s_add_u32 s13, s13, s12
    s_sub_u32 s13, s13, 2048
    v_add_u32 v29, s13, v12
    s_lshl_b32 s94, s21, 12
    s_mul_i32 s95, s21, 6144
    s_add_u32 s95, s95, 16384
    s_waitcnt lgkmcnt(0)
    s_mov_b32 s24, s4
    s_and_b32 s25, s5, 0xffff
    s_mov_b32 s26, 4194304
    s_mov_b32 s27, 0x00020000
    s_mov_b32 s28, s6
    s_and_b32 s29, s7, 0xffff
    s_mov_b32 s30, 6291456
    s_mov_b32 s31, 0x00020000
    s_bfe_u32 s91, s68, 0x40000
    s_lshl_b32 s92, s91, 7
    s_mul_i32 s93, s91, 393216
    s_add_u32 m0, s94, 0
    s_nop 0
    buffer_load_dwordx4 v20, s[24:27], s92 offen offset:0 lds
    buffer_load_dwordx4 v21, s[24:27], s92 offen offset:1024 lds
    buffer_load_dwordx4 v22, s[24:27], s92 offen offset:2048 lds
    buffer_load_dwordx4 v23, s[24:27], s92 offen offset:3072 lds
    s_add_u32 m0, s95, 0
    s_nop 0
    buffer_load_dwordx4 v24, s[28:31], s93 offen offset:0 lds
    buffer_load_dwordx4 v25, s[28:31], s93 offen offset:1024 lds
    buffer_load_dwordx4 v26, s[28:31], s93 offen offset:2048 lds
    s_add_u32 m0, s95, 3072
    s_nop 0
    buffer_load_dwordx4 v27, s[28:31], s93 offen offset:0 lds
    buffer_load_dwordx4 v28, s[28:31], s93 offen offset:1024 lds
    buffer_load_dwordx4 v29, s[28:31], s93 offen offset:2048 lds
    s_bfe_u32 s91, s68, 0x40004
    s_lshl_b32 s92, s91, 7
    s_mul_i32 s93, s91, 393216
    s_add_u32 m0, s94, 40960
    s_nop 0
    buffer_load_dwordx4 v20, s[24:27], s92 offen offset:0 lds
    buffer_load_dwordx4 v21, s[24:27], s92 offen offset:1024 lds
    buffer_load_dwordx4 v22, s[24:27], s92 offen offset:2048 lds
    buffer_load_dwordx4 v23, s[24:27], s92 offen offset:3072 lds
    s_add_u32 m0, s95, 40960
    s_nop 0
    buffer_load_dwordx4 v24, s[28:31], s93 offen offset:0 lds
    buffer_load_dwordx4 v25, s[28:31], s93 offen offset:1024 lds
    s_mov_b32 s32, s62
    s_and_b32 s33, s63, 0xffff
    s_mov_b32 s34, 33554432
    s_mov_b32 s35, 0x00020000
    s_mov_b32 s36, s10
    s_and_b32 s37, s11, 0xffff
    s_mov_b32 s38, 2097152
    s_mov_b32 s39, 0x00020000
    s_mov_b32 s40, s50
    s_and_b32 s41, s51, 0xffff
    s_mov_b32 s42, 7340032
    s_mov_b32 s43, 0x00020000
    s_mov_b32 s44, s52
    s_and_b32 s45, s53, 0xffff
    s_mov_b32 s46, 7340032
    s_mov_b32 s47, 0x00020000
    s_mov_b32 s64, s54
    s_and_b32 s65, s55, 0xffff
    s_mov_b32 s66, 7340032
    s_mov_b32 s67, 0x00020000
    s_mov_b32 s72, s60
    s_and_b32 s73, s61, 0xffff
    s_mov_b32 s74, 256
    s_mov_b32 s75, 0x00020000
    s_mov_b32 s76, s8
    s_and_b32 s77, s9, 0xffff
    s_mov_b32 s78, 65536
    s_mov_b32 s79, 0x00020000
    s_mov_b32 s80, s48
    s_and_b32 s81, s49, 0xffff
    s_mov_b32 s82, 2048
    s_mov_b32 s83, 0x00020000
    s_mov_b32 s84, s56
    s_and_b32 s85, s57, 0xffff
    s_mov_b32 s86, 2048
    s_mov_b32 s87, 0x00020000
    s_cmp_gt_u32 s19, 3
    s_subb_u32 s10, s19, 0
    s_cmp_gt_u32 s19, 11
    s_subb_u32 s10, s10, 0
    s_lshl_b32 s10, s10, 4
    s_add_u32 s10, s10, s18
    s_and_b32 s12, s19, 7
    s_cmp_eq_u32 s12, 3
    s_cselect_b32 s10, 224, s10
    s_xor_b32 s11, s18, 2
    s_lshl_b32 s11, s11, 4
    s_add_u32 s11, s11, s19
    s_lshl_b32 s11, s19, 4
    s_add_u32 s11, s11, s18
    s_cmp_lt_u32 s10, 224
    s_cselect_b32 s42, s42, 0
    s_cselect_b32 s46, s46, 0
    s_and_b32 s88, s16, 1
    s_lshl_b32 s88, s88, 3
    s_lshr_b32 s89, s16, 1
    s_lshl_b32 s89, s89, 1
    s_add_u32 s88, s88, s89
    s_lshr_b32 s89, s17, 4
    s_add_u32 s88, s88, s89
    s_and_b32 s89, s17, 15
    v_mov_b32 v13, 0
    v_mul_u32_u24 v30, 57344, v4
    v_lshl_add_u32 v30, v6, 4, v30
    v_lshl_add_u32 v31, v6, 4, v9
    v_lshl_add_u32 v33, v8, 4, v9
    s_lshl_b32 s12, s89, 7
    v_add_u32 v33, s12, v33
    v_lshlrev_b32 v34, 4, v4
    s_and_b32 s12, s10, 3
    s_lshl_b32 s12, s12, 8
    s_lshl_b32 s13, s21, 6
    s_add_u32 s70, s12, s13
    s_mul_i32 s71, s70, 7168
    s_lshr_b32 s12, s10, 2
    s_lshl_b32 s12, s12, 7
    s_add_u32 s71, s71, s12
    s_and_b32 s12, s11, 15
    s_mul_i32 s12, s12, 224
    s_mul_i32 s13, s21, 56
    s_add_u32 s96, s12, s13
    s_lshl_b32 s97, s96, 11
    s_lshr_b32 s12, s11, 4
    s_lshl_b32 s12, s12, 7
    s_add_u32 s97, s97, s12
    s_lshl_b32 s22, s18, 7
    s_lshl_b32 s12, s19, 3
    s_add_u32 s22, s22, s12
    s_lshl_b32 s12, s21, 1
    s_add_u32 s22, s22, s12
    s_xor_b32 s9, s71, 512
    s_and_b32 s12, s18, 7
    s_lshl_b32 s12, s12, 2
    s_add_u32 s12, s12, s21
    s_mul_i32 s12, s12, 6
    v_add_u32 v32, s12, v2
    v_lshrrev_b32 v11, 6, v32
    v_and_b32 v32, 63, v32
    v_mul_u32_u24 v32, 6144, v32
    v_lshl_add_u32 v32, v11, 11, v32
    s_lshl_b32 s12, s19, 7
    v_add_u32 v32, s12, v32
    s_lshl_b32 s12, s2, 6
    s_lshl_b32 s13, s21, 4
    s_add_u32 s12, s12, s13
    v_add_u32 v10, s12, v2
    v_lshlrev_b32 v10, 7, v10
    s_lshl_b32 s12, s17, 6
    s_add_u32 s12, s12, s13
    s_sub_u32 s12, s12, 16
    v_add_u32 v11, s12, v2
    v_and_b32 v12, 1, v11
    v_lshrrev_b32 v11, 1, v11
    v_lshlrev_b32 v11, 11, v11
    v_lshl_add_u32 v11, v12, 10, v11
    v_add_u32 v11, 384, v11
    v_cmp_gt_u32 vcc, 16, v2
    s_nop 1
    v_cndmask_b32 v10, v11, v10, vcc
    s_mul_i32 s12, s2, 13108
    s_lshr_b32 s12, s12, 16
    s_mul_i32 s12, s12, 5
    s_sub_u32 s3, s2, s12
    s_cmp_ge_u32 s10, 224
    s_cselect_b32 s3, 0, s3
    s_waitcnt vmcnt(6)
    s_barrier
    s_cmp_eq_u32 s3, 1
    s_cbranch_scc1 L_var1
    s_cmp_eq_u32 s3, 2
    s_cbranch_scc1 L_var2
    s_cmp_eq_u32 s3, 3
    s_cbranch_scc1 L_var3
    s_cmp_eq_u32 s3, 4
    s_cbranch_scc1 L_var4
L_var0:
    s_nop 0
    s_add_u32 m0, s95, 40960
    s_nop 0
    buffer_load_dwordx4 v26, s[28:31], s93 offen offset:2048 lds
    s_add_u32 m0, s95, 44032
    s_nop 0
    buffer_load_dwordx4 v27, s[28:31], s93 offen offset:0 lds
    buffer_load_dwordx4 v28, s[28:31], s93 offen offset:1024 lds
    buffer_load_dwordx4 v29, s[28:31], s93 offen offset:2048 lds
    s_bfe_u32 s91, s68, 0x40008
    s_lshl_b32 s92, s91, 7
    s_mul_i32 s93, s91, 393216
    s_add_u32 m0, s94, 81920
    s_nop 0
    buffer_load_dwordx4 v20, s[24:27], s92 offen offset:0 lds
    buffer_load_dwordx4 v21, s[24:27], s92 offen offset:1024 lds
    buffer_load_dwordx4 v22, s[24:27], s92 offen offset:2048 lds
    buffer_load_dwordx4 v23, s[24:27], s92 offen offset:3072 lds
    s_add_u32 m0, s95, 81920
    s_nop 0
    buffer_load_dwordx4 v24, s[28:31], s93 offen offset:0 lds
    buffer_load_dwordx4 v25, s[28:31], s93 offen offset:1024 lds
    buffer_load_dwordx4 v26, s[28:31], s93 offen offset:2048 lds
    s_add_u32 m0, s95, 84992
    s_nop 0
    buffer_load_dwordx4 v27, s[28:31], s93 offen offset:0 lds
    buffer_load_dwordx4 v28, s[28:31], s93 offen offset:1024 lds
    buffer_load_dwordx4 v29, s[28:31], s93 offen offset:2048 lds
    s_lshl_b32 s12, s19, 2
    s_add_u32 s12, s12, s21
    s_lshl_b32 s12, s12, 10
    s_lshl_b32 s13, s21, 10
    s_add_u32 m0, s13, 155648
    s_nop 0
    buffer_load_dwordx4 v5, s[76:79], s12 offen lds
    s_lshl_b32 s12, s22, 11
    buffer_load_dwordx4 v[40:43], v5, s[24:27], s12 offen offset:0
    buffer_load_dwordx4 v[44:47], v5, s[24:27], s12 offen offset:1024
    buffer_load_dwordx4 v[48:51], v5, s[24:27], s12 offen offset:2048
    buffer_load_dwordx4 v[52:55], v5, s[24:27], s12 offen offset:3072
    buffer_load_dwordx4 v[56:59], v5, s[80:83], 0 offen offset:0
    buffer_load_dwordx4 v[60:63], v5, s[80:83], 0 offen offset:1024
    buffer_load_dwordx4 v[64:67], v5, s[84:87], 0 offen offset:0
    buffer_load_dwordx4 v[68:71], v5, s[84:87], 0 offen offset:1024
    s_cmp_ge_u32 s10, 224
    s_cbranch_scc1 L_p30_0
    s_add_u32 s12, s71, 0
    buffer_load_dwordx4 v[128:131], v30, s[40:43], s12 offen nt
    s_add_u32 s12, s71, 7168
    buffer_load_dwordx4 v[132:135], v30, s[40:43], s12 offen nt
    s_add_u32 s12, s71, 14336
    buffer_load_dwordx4 v[136:139], v30, s[40:43], s12 offen nt
    s_add_u32 s12, s71, 21504
    buffer_load_dwordx4 v[140:143], v30, s[40:43], s12 offen nt
    s_add_u32 s12, s71, 28672
    buffer_load_dwordx4 v[144:147], v30, s[40:43], s12 offen nt
    s_add_u32 s12, s71, 35840
    buffer_load_dwordx4 v[148:151], v30, s[40:43], s12 offen nt
    s_add_u32 s12, s71, 43008
    buffer_load_dwordx4 v[152:155], v30, s[40:43], s12 offen nt
    s_add_u32 s12, s71, 50176
    buffer_load_dwordx4 v[156:159], v30, s[40:43], s12 offen nt
    s_branch L_p3e0_0
L_p30_0:
    s_mov_b64 exec, 63
    s_bfe_u32 s12, s68, 0x4000c
    s_mul_i32 s12, s12, 393216
    buffer_load_dword v128, v32, s[28:31], s12 offen
    s_bfe_u32 s12, s68, 0x40010
    s_mul_i32 s12, s12, 393216
    buffer_load_dword v132, v32, s[28:31], s12 offen
    s_bfe_u32 s12, s68, 0x40014
    s_mul_i32 s12, s12, 393216
    buffer_load_dword v136, v32, s[28:31], s12 offen
    s_bfe_u32 s12, s68, 0x40018
    s_mul_i32 s12, s12, 393216
    buffer_load_dword v140, v32, s[28:31], s12 offen
    s_bfe_u32 s12, s68, 0x4001c
    s_mul_i32 s12, s12, 393216
    buffer_load_dword v144, v32, s[28:31], s12 offen
    s_bfe_u32 s12, s69, 0x40000
    s_mul_i32 s12, s12, 393216
    buffer_load_dword v148, v32, s[28:31], s12 offen
    s_bfe_u32 s12, s69, 0x40004
    s_mul_i32 s12, s12, 393216
    buffer_load_dword v152, v32, s[28:31], s12 offen
    s_bfe_u32 s12, s69, 0x40008
    s_mul_i32 s12, s12, 393216
    buffer_load_dword v156, v32, s[28:31], s12 offen
    s_mov_b64 exec, -1
L_p3e0_0:
    s_waitcnt vmcnt(27)
    s_barrier
    s_bfe_u32 s91, s68, 0x4000c
    s_lshl_b32 s92, s91, 7
    s_mul_i32 s93, s91, 393216
    s_add_u32 m0, s94, 0
    s_nop 0
    buffer_load_dwordx4 v20, s[24:27], s92 offen offset:0 lds
    buffer_load_dwordx4 v21, s[24:27], s92 offen offset:1024 lds
    buffer_load_dwordx4 v22, s[24:27], s92 offen offset:2048 lds
    buffer_load_dwordx4 v23, s[24:27], s92 offen offset:3072 lds
    s_add_u32 m0, s95, 0
    s_nop 0
    buffer_load_dwordx4 v24, s[28:31], s93 offen offset:0 lds
    s_cmp_lg_u32 s21, 0
    s_cbranch_scc1 L_noclr_0
    v_mov_b32 v104, -1
    v_mov_b32 v105, -1
    v_mov_b32 v106, -1
    v_mov_b32 v107, -1
    s_lshl_b32 s12, s19, 13
    s_lshl_b32 s13, s18, 9
    s_add_u32 s12, s12, s13
    s_add_u32 s12, s12, 32768
    s_lshl_b32 s13, s19, 11
    s_lshl_b32 s90, s18, 7
    s_add_u32 s13, s13, s90
    s_add_u32 s13, s13, 163840
    s_mov_b32 exec_hi, 0
    buffer_store_dwordx4 v[104:107], v5, s[32:35], s12 offen sc1
    s_mov_b32 exec_lo, 255
    buffer_store_dwordx4 v[104:107], v5, s[32:35], s13 offen sc1
    s_mov_b64 exec, -1
L_noclr_0:
    s_waitcnt vmcnt(13)
    v_lshlrev_b32 v72, 16, v64
    v_and_b32 v73, 0xffff0000, v64
    v_lshlrev_b32 v74, 16, v65
    v_and_b32 v75, 0xffff0000, v65
    v_lshlrev_b32 v76, 16, v66
    v_and_b32 v77, 0xffff0000, v66
    v_lshlrev_b32 v78, 16, v67
    v_and_b32 v79, 0xffff0000, v67
    v_lshlrev_b32 v80, 16, v68
    v_and_b32 v81, 0xffff0000, v68
    v_lshlrev_b32 v82, 16, v69
    v_and_b32 v83, 0xffff0000, v69
    v_lshlrev_b32 v84, 16, v70
    v_and_b32 v85, 0xffff0000, v70
    v_lshlrev_b32 v86, 16, v71
    v_and_b32 v87, 0xffff0000, v71
    v_mov_b32 v90, 0
    v_mov_b32 v91, 0
    v_dot2_f32_bf16 v90, v40, v56, v90
    v_lshlrev_b32 v94, 16, v40
    v_and_b32 v95, 0xffff0000, v40
    v_mul_f32 v94, v94, v72
    v_mul_f32 v95, v95, v73
    v_cvt_pk_bf16_f32 v94, v94, v95
    v_lshlrev_b32 v95, 16, v94
    v_and_b32 v94, 0xffff0000, v94
    v_add_f32 v91, v91, v95
    v_add_f32 v91, v91, v94
    v_dot2_f32_bf16 v90, v41, v57, v90
    v_lshlrev_b32 v94, 16, v41
    v_and_b32 v95, 0xffff0000, v41
    v_mul_f32 v94, v94, v74
    v_mul_f32 v95, v95, v75
    v_cvt_pk_bf16_f32 v94, v94, v95
    v_lshlrev_b32 v95, 16, v94
    v_and_b32 v94, 0xffff0000, v94
    v_add_f32 v91, v91, v95
    v_add_f32 v91, v91, v94
    v_dot2_f32_bf16 v90, v42, v58, v90
    v_lshlrev_b32 v94, 16, v42
    v_and_b32 v95, 0xffff0000, v42
    v_mul_f32 v94, v94, v76
    v_mul_f32 v95, v95, v77
    v_cvt_pk_bf16_f32 v94, v94, v95
    v_lshlrev_b32 v95, 16, v94
    v_and_b32 v94, 0xffff0000, v94
    v_add_f32 v91, v91, v95
    v_add_f32 v91, v91, v94
    v_dot2_f32_bf16 v90, v43, v59, v90
    v_lshlrev_b32 v94, 16, v43
    v_and_b32 v95, 0xffff0000, v43
    v_mul_f32 v94, v94, v78
    v_mul_f32 v95, v95, v79
    v_cvt_pk_bf16_f32 v94, v94, v95
    v_lshlrev_b32 v95, 16, v94
    v_and_b32 v94, 0xffff0000, v94
    v_add_f32 v91, v91, v95
    v_add_f32 v91, v91, v94
    v_dot2_f32_bf16 v90, v44, v60, v90
    v_lshlrev_b32 v94, 16, v44
    v_and_b32 v95, 0xffff0000, v44
    v_mul_f32 v94, v94, v80
    v_mul_f32 v95, v95, v81
    v_cvt_pk_bf16_f32 v94, v94, v95
    v_lshlrev_b32 v95, 16, v94
    v_and_b32 v94, 0xffff0000, v94
    v_add_f32 v91, v91, v95
    v_add_f32 v91, v91, v94
    v_dot2_f32_bf16 v90, v45, v61, v90
    v_lshlrev_b32 v94, 16, v45
    v_and_b32 v95, 0xffff0000, v45
    v_mul_f32 v94, v94, v82
    v_mul_f32 v95, v95, v83
    v_cvt_pk_bf16_f32 v94, v94, v95
    v_lshlrev_b32 v95, 16, v94
    v_and_b32 v94, 0xffff0000, v94
    v_add_f32 v91, v91, v95
    v_add_f32 v91, v91, v94
    v_dot2_f32_bf16 v90, v46, v62, v90
    v_lshlrev_b32 v94, 16, v46
    v_and_b32 v95, 0xffff0000, v46
    v_mul_f32 v94, v94, v84
    v_mul_f32 v95, v95, v85
    v_cvt_pk_bf16_f32 v94, v94, v95
    v_lshlrev_b32 v95, 16, v94
    v_and_b32 v94, 0xffff0000, v94
    v_add_f32 v91, v91, v95
    v_add_f32 v91, v91, v94
    v_dot2_f32_bf16 v90, v47, v63, v90
    v_lshlrev_b32 v94, 16, v47
    v_and_b32 v95, 0xffff0000, v47
    v_mul_f32 v94, v94, v86
    v_mul_f32 v95, v95, v87
    v_cvt_pk_bf16_f32 v94, v94, v95
    v_lshlrev_b32 v95, 16, v94
    v_and_b32 v94, 0xffff0000, v94
    v_add_f32 v91, v91, v95
    v_add_f32 v91, v91, v94
    v_mov_b32 v92, 0
    v_mov_b32 v93, 0
    v_dot2_f32_bf16 v92, v48, v56, v92
    v_lshlrev_b32 v94, 16, v48
    v_and_b32 v95, 0xffff0000, v48
    v_mul_f32 v94, v94, v72
    v_mul_f32 v95, v95, v73
    v_cvt_pk_bf16_f32 v94, v94, v95
    v_lshlrev_b32 v95, 16, v94
    v_and_b32 v94, 0xffff0000, v94
    v_add_f32 v93, v93, v95
    v_add_f32 v93, v93, v94
    v_dot2_f32_bf16 v92, v49, v57, v92
    v_lshlrev_b32 v94, 16, v49
    v_and_b32 v95, 0xffff0000, v49
    v_mul_f32 v94, v94, v74
    v_mul_f32 v95, v95, v75
    v_cvt_pk_bf16_f32 v94, v94, v95
    v_lshlrev_b32 v95, 16, v94
    v_and_b32 v94, 0xffff0000, v94
    v_add_f32 v93, v93, v95
    v_add_f32 v93, v93, v94
    v_dot2_f32_bf16 v92, v50, v58, v92
    s_barrier
    s_add_u32 m0, s95, 0
    s_nop 0
    buffer_load_dwordx4 v25, s[28:31], s93 offen offset:1024 lds
    buffer_load_dwordx4 v26, s[28:31], s93 offen offset:2048 lds
    s_add_u32 m0, s95, 3072
    s_nop 0
    buffer_load_dwordx4 v27, s[28:31], s93 offen offset:0 lds
    buffer_load_dwordx4 v28, s[28:31], s93 offen offset:1024 lds
    buffer_load_dwordx4 v29, s[28:31], s93 offen offset:2048 lds
    s_bfe_u32 s91, s68, 0x40010
    s_lshl_b32 s92, s91, 7
    s_mul_i32 s93, s91, 393216
    s_add_u32 m0, s94, 40960
    s_nop 0
    buffer_load_dwordx4 v20, s[24:27], s92 offen offset:0 lds
    buffer_load_dwordx4 v21, s[24:27], s92 offen offset:1024 lds
    buffer_load_dwordx4 v22, s[24:27], s92 offen offset:2048 lds
    buffer_load_dwordx4 v23, s[24:27], s92 offen offset:3072 lds
    s_add_u32 m0, s95, 40960
    s_nop 0
    buffer_load_dwordx4 v24, s[28:31], s93 offen offset:0 lds
    buffer_load_dwordx4 v25, s[28:31], s93 offen offset:1024 lds
    buffer_load_dwordx4 v26, s[28:31], s93 offen offset:2048 lds
    v_lshlrev_b32 v94, 16, v50
    v_and_b32 v95, 0xffff0000, v50
    v_mul_f32 v94, v94, v76
    v_mul_f32 v95, v95, v77
    v_cvt_pk_bf16_f32 v94, v94, v95
    v_lshlrev_b32 v95, 16, v94
    v_and_b32 v94, 0xffff0000, v94
    v_add_f32 v93, v93, v95
    v_add_f32 v93, v93, v94
    v_dot2_f32_bf16 v92, v51, v59, v92
    v_lshlrev_b32 v94, 16, v51
    v_and_b32 v95, 0xffff0000, v51
    v_mul_f32 v94, v94, v78
    v_mul_f32 v95, v95, v79
    v_cvt_pk_bf16_f32 v94, v94, v95
    v_lshlrev_b32 v95, 16, v94
    v_and_b32 v94, 0xffff0000, v94
    v_add_f32 v93, v93, v95
    v_add_f32 v93, v93, v94
    v_dot2_f32_bf16 v92, v52, v60, v92
    v_lshlrev_b32 v94, 16, v52
    v_and_b32 v95, 0xffff0000, v52
    v_mul_f32 v94, v94, v80
    v_mul_f32 v95, v95, v81
    v_cvt_pk_bf16_f32 v94, v94, v95
    v_lshlrev_b32 v95, 16, v94
    v_and_b32 v94, 0xffff0000, v94
    v_add_f32 v93, v93, v95
    v_add_f32 v93, v93, v94
    v_dot2_f32_bf16 v92, v53, v61, v92
    v_lshlrev_b32 v94, 16, v53
    v_and_b32 v95, 0xffff0000, v53
    v_mul_f32 v94, v94, v82
    v_mul_f32 v95, v95, v83
    v_cvt_pk_bf16_f32 v94, v94, v95
    v_lshlrev_b32 v95, 16, v94
    v_and_b32 v94, 0xffff0000, v94
    v_add_f32 v93, v93, v95
    v_add_f32 v93, v93, v94
    v_dot2_f32_bf16 v92, v54, v62, v92
    v_lshlrev_b32 v94, 16, v54
    v_and_b32 v95, 0xffff0000, v54
    v_mul_f32 v94, v94, v84
    v_mul_f32 v95, v95, v85
    v_cvt_pk_bf16_f32 v94, v94, v95
    v_lshlrev_b32 v95, 16, v94
    v_and_b32 v94, 0xffff0000, v94
    v_add_f32 v93, v93, v95
    v_add_f32 v93, v93, v94
    v_dot2_f32_bf16 v92, v55, v63, v92
    v_lshlrev_b32 v94, 16, v55
    v_and_b32 v95, 0xffff0000, v55
    v_mul_f32 v94, v94, v86
    v_mul_f32 v95, v95, v87
    v_cvt_pk_bf16_f32 v94, v94, v95
    v_lshlrev_b32 v95, 16, v94
    v_and_b32 v94, 0xffff0000, v94
    v_add_f32 v93, v93, v95
    v_add_f32 v93, v93, v94
    v_add_f32_dpp v90, v90, v90 row_shr:1 row_mask:0xf bank_mask:0xf
    v_add_f32_dpp v91, v91, v91 row_shr:1 row_mask:0xf bank_mask:0xf
    v_add_f32_dpp v92, v92, v92 row_shr:1 row_mask:0xf bank_mask:0xf
    v_add_f32_dpp v93, v93, v93 row_shr:1 row_mask:0xf bank_mask:0xf
    v_add_f32_dpp v90, v90, v90 row_shr:2 row_mask:0xf bank_mask:0xf
    v_add_f32_dpp v91, v91, v91 row_shr:2 row_mask:0xf bank_mask:0xf
    v_add_f32_dpp v92, v92, v92 row_shr:2 row_mask:0xf bank_mask:0xf
    v_add_f32_dpp v93, v93, v93 row_shr:2 row_mask:0xf bank_mask:0xf
    v_add_f32_dpp v90, v90, v90 row_shr:4 row_mask:0xf bank_mask:0xf
    v_add_f32_dpp v91, v91, v91 row_shr:4 row_mask:0xf bank_mask:0xf
    v_add_f32_dpp v92, v92, v92 row_shr:4 row_mask:0xf bank_mask:0xf
    v_add_f32_dpp v93, v93, v93 row_shr:4 row_mask:0xf bank_mask:0xf
    v_add_f32_dpp v90, v90, v90 row_shr:8 row_mask:0xf bank_mask:0xf
    v_add_f32_dpp v91, v91, v91 row_shr:8 row_mask:0xf bank_mask:0xf
    v_add_f32_dpp v92, v92, v92 row_shr:8 row_mask:0xf bank_mask:0xf
    v_add_f32_dpp v93, v93, v93 row_shr:8 row_mask:0xf bank_mask:0xf
    v_add_f32_dpp v90, v90, v90 row_bcast:15 row_mask:0xa bank_mask:0xf
    v_add_f32_dpp v91, v91, v91 row_bcast:15 row_mask:0xa bank_mask:0xf
    v_add_f32_dpp v92, v92, v92 row_bcast:15 row_mask:0xa bank_mask:0xf
    v_add_f32_dpp v93, v93, v93 row_bcast:15 row_mask:0xa bank_mask:0xf
    v_add_f32_dpp v90, v90, v90 row_bcast:31 row_mask:0xc bank_mask:0xf
    v_add_f32_dpp v91, v91, v91 row_bcast:31 row_mask:0xc bank_mask:0xf
    v_add_f32_dpp v92, v92, v92 row_bcast:31 row_mask:0xc bank_mask:0xf
    v_add_f32_dpp v93, v93, v93 row_bcast:31 row_mask:0xc bank_mask:0xf
    v_cvt_pk_bf16_f32 v94, v90, v91
    v_and_b32 v95, 0xffff, v94
    v_and_b32 v96, 0x8000, v94
    v_cmp_ne_u32 vcc, 0, v96
    v_mov_b32 v97, 0x8000
    v_mov_b32 v98, 0xffff
    v_cndmask_b32 v96, v97, v98, vcc
    v_xor_b32 v95, v95, v96
    s_sub_u32 s12, 2047, s22
    v_lshlrev_b32 v95, 11, v95
    v_or_b32 v100, s12, v95
    v_and_b32 v94, 0xffff0000, v94
    v_mul_f32 v94, 0xbfb8aa3b, v94
    v_exp_f32 v94, v94
    s_nop 0
    v_add_f32 v94, 1.0, v94
    v_rcp_f32 v94, v94
    s_nop 0
    v_cvt_pk_bf16_f32 v94, v94, v94
    v_lshlrev_b32 v102, 16, v94
    v_cvt_pk_bf16_f32 v94, v92, v93
    v_and_b32 v95, 0xffff, v94
    v_and_b32 v96, 0x8000, v94
    v_cmp_ne_u32 vcc, 0, v96
    v_mov_b32 v97, 0x8000
    v_mov_b32 v98, 0xffff
    v_cndmask_b32 v96, v97, v98, vcc
    v_xor_b32 v95, v95, v96
    s_sub_u32 s12, 2046, s22
    v_lshlrev_b32 v95, 11, v95
    v_or_b32 v101, s12, v95
    v_and_b32 v94, 0xffff0000, v94
    v_mul_f32 v94, 0xbfb8aa3b, v94
    v_exp_f32 v94, v94
    s_nop 0
    v_add_f32 v94, 1.0, v94
    v_rcp_f32 v94, v94
    s_nop 0
    v_cvt_pk_bf16_f32 v94, v94, v94
    v_lshlrev_b32 v103, 16, v94
    v_max_u32 v100, v100, v101
    s_lshl_b32 s12, s22, 2
    s_add_u32 s12, s12, 4096
    s_lshl_b32 s13, s21, 2
    s_add_u32 s13, s13, 162880
    v_mov_b32 v14, s13
    s_mov_b32 exec_lo, 0
    s_mov_b32 exec_hi, 0x80000000
    buffer_store_dwordx2 v[102:103], v13, s[32:35], s12 offen sc1
    ds_write_b32 v14, v100
    s_mov_b64 exec, -1
    s_waitcnt lgkmcnt(0)
    buffer_load_dword v15, v13, s[72:75], 0 offen offset:4 sc1
    s_waitcnt vmcnt(9)
    s_barrier
    s_add_u32 m0, s95, 44032
    s_nop 0
    buffer_load_dwordx4 v27, s[28:31], s93 offen offset:0 lds
    buffer_load_dwordx4 v28, s[28:31], s93 offen offset:1024 lds
    buffer_load_dwordx4 v29, s[28:31], s93 offen offset:2048 lds
    s_bfe_u32 s91, s68, 0x40014
    s_lshl_b32 s92, s91, 7
    s_mul_i32 s93, s91, 393216
    s_add_u32 m0, s94, 81920
    s_nop 0
    buffer_load_dwordx4 v20, s[24:27], s92 offen offset:0 lds
    buffer_load_dwordx4 v21, s[24:27], s92 offen offset:1024 lds
    buffer_load_dwordx4 v22, s[24:27], s92 offen offset:2048 lds
    buffer_load_dwordx4 v23, s[24:27], s92 offen offset:3072 lds
    s_add_u32 m0, s95, 81920
    s_nop 0
    buffer_load_dwordx4 v24, s[28:31], s93 offen offset:0 lds
    buffer_load_dwordx4 v25, s[28:31], s93 offen offset:1024 lds
    buffer_load_dwordx4 v26, s[28:31], s93 offen offset:2048 lds
    s_add_u32 m0, s95, 84992
    s_nop 0
    buffer_load_dwordx4 v27, s[28:31], s93 offen offset:0 lds
    buffer_load_dwordx4 v28, s[28:31], s93 offen offset:1024 lds
    s_waitcnt vmcnt(9)
    s_barrier
    s_add_u32 m0, s95, 84992
    s_nop 0
    buffer_load_dwordx4 v29, s[28:31], s93 offen offset:2048 lds
    s_bfe_u32 s91, s68, 0x40018
    s_lshl_b32 s92, s91, 7
    s_mul_i32 s93, s91, 393216
    s_add_u32 m0, s94, 0
    s_nop 0
    buffer_load_dwordx4 v20, s[24:27], s92 offen offset:0 lds
    buffer_load_dwordx4 v21, s[24:27], s92 offen offset:1024 lds
    buffer_load_dwordx4 v22, s[24:27], s92 offen offset:2048 lds
    buffer_load_dwordx4 v23, s[24:27], s92 offen offset:3072 lds
    s_add_u32 m0, s95, 0
    s_nop 0
    buffer_load_dwordx4 v24, s[28:31], s93 offen offset:0 lds
    buffer_load_dwordx4 v25, s[28:31], s93 offen offset:1024 lds
    buffer_load_dwordx4 v26, s[28:31], s93 offen offset:2048 lds
    s_add_u32 m0, s95, 3072
    s_nop 0
    buffer_load_dwordx4 v27, s[28:31], s93 offen offset:0 lds
    buffer_load_dwordx4 v28, s[28:31], s93 offen offset:1024 lds
    buffer_load_dwordx4 v29, s[28:31], s93 offen offset:2048 lds
    s_mov_b32 s13, 0
L_tagchk_0:
    v_readfirstlane_b32 s23, v15
    s_nop 1
    s_cmp_lg_u32 s23, 0
    s_cbranch_scc1 L_tagok_0
    s_add_u32 s13, s13, 1
    s_cmp_ge_u32 s13, 16384
    s_cbranch_scc1 L_tagok_0
    buffer_load_dword v15, v13, s[72:75], 0 offen offset:4 sc1
    s_waitcnt vmcnt(0)
    s_branch L_tagchk_0
L_tagok_0:
    s_and_b32 s76, s23, 0xff
    s_bfe_u32 s77, s23, 0x80008
    s_bfe_u32 s78, s23, 0x80010
    s_lshr_b32 s79, s23, 24
    v_and_b32 v35, 3, v2
    v_lshlrev_b32 v35, 3, v35
    v_bfe_u32 v35, s23, v35, 8
    s_cmp_lg_u32 s21, 0
    s_cbranch_scc1 L_nopub_0
    v_mov_b32 v14, 162880
    ds_read_b128 v[104:107], v14
    s_lshl_b32 s12, s2, 3
    s_add_u32 s12, s12, 0
    s_waitcnt lgkmcnt(0)
    v_max3_u32 v104, v104, v105, v106
    v_max_u32 v104, v104, v107
    v_mov_b32 v105, s23
    s_mov_b64 exec, 1
    buffer_store_dwordx2 v[104:105], v13, s[32:35], s12 offen sc1
    s_mov_b64 exec, -1
L_nopub_0:
    s_waitcnt vmcnt(10)
    s_barrier
    s_bfe_u32 s91, s68, 0x4001c
    s_lshl_b32 s92, s91, 7
    s_mul_i32 s93, s91, 393216
    s_add_u32 m0, s94, 40960
    s_nop 0
    buffer_load_dwordx4 v20, s[24:27], s92 offen offset:0 lds
    buffer_load_dwordx4 v21, s[24:27], s92 offen offset:1024 lds
    buffer_load_dwordx4 v22, s[24:27], s92 offen offset:2048 lds
    buffer_load_dwordx4 v23, s[24:27], s92 offen offset:3072 lds
    s_add_u32 m0, s95, 40960
    s_nop 0
    buffer_load_dwordx4 v24, s[28:31], s93 offen offset:0 lds
    buffer_load_dwordx4 v25, s[28:31], s93 offen offset:1024 lds
    buffer_load_dwordx4 v26, s[28:31], s93 offen offset:2048 lds
    s_add_u32 m0, s95, 44032
    s_nop 0
    buffer_load_dwordx4 v27, s[28:31], s93 offen offset:0 lds
    buffer_load_dwordx4 v28, s[28:31], s93 offen offset:1024 lds
    buffer_load_dwordx4 v29, s[28:31], s93 offen offset:2048 lds
    s_cmp_ge_u32 s10, 224
    s_cbranch_scc1 L_p31_0
    s_add_u32 s12, s9, 0
    buffer_load_dwordx4 v[160:163], v30, s[44:47], s12 offen nt
    s_add_u32 s12, s9, 7168
    buffer_load_dwordx4 v[164:167], v30, s[44:47], s12 offen nt
    s_add_u32 s12, s9, 14336
    buffer_load_dwordx4 v[168:171], v30, s[44:47], s12 offen nt
    s_add_u32 s12, s9, 21504
    buffer_load_dwordx4 v[172:175], v30, s[44:47], s12 offen nt
    s_add_u32 s12, s9, 28672
    buffer_load_dwordx4 v[176:179], v30, s[44:47], s12 offen nt
    s_add_u32 s12, s9, 35840
    buffer_load_dwordx4 v[180:183], v30, s[44:47], s12 offen nt
    s_add_u32 s12, s9, 43008
    buffer_load_dwordx4 v[184:187], v30, s[44:47], s12 offen nt
    s_add_u32 s12, s9, 50176
    buffer_load_dwordx4 v[188:191], v30, s[44:47], s12 offen nt
    s_branch L_p3e1_0
L_p31_0:
    s_mov_b64 exec, 63
    s_bfe_u32 s12, s69, 0x4000c
    s_mul_i32 s12, s12, 393216
    buffer_load_dword v160, v32, s[28:31], s12 offen
    s_bfe_u32 s12, s69, 0x40010
    s_mul_i32 s12, s12, 393216
    buffer_load_dword v164, v32, s[28:31], s12 offen
    s_bfe_u32 s12, s69, 0x40014
    s_mul_i32 s12, s12, 393216
    buffer_load_dword v168, v32, s[28:31], s12 offen
    s_bfe_u32 s12, s69, 0x40018
    s_mul_i32 s12, s12, 393216
    buffer_load_dword v172, v32, s[28:31], s12 offen
    s_bfe_u32 s12, s69, 0x4001c
    s_mul_i32 s12, s12, 393216
    buffer_load_dword v176, v32, s[28:31], s12 offen
    s_mov_b64 exec, 1
    s_bfe_u32 s12, s69, 0x4001c
    s_mul_i32 s12, s12, 393216
    buffer_load_dword v180, v32, s[28:31], s12 offen
    s_bfe_u32 s12, s69, 0x4001c
    s_mul_i32 s12, s12, 393216
    buffer_load_dword v184, v32, s[28:31], s12 offen
    s_bfe_u32 s12, s69, 0x4001c
    s_mul_i32 s12, s12, 393216
    buffer_load_dword v188, v32, s[28:31], s12 offen
    s_mov_b64 exec, -1
L_p3e1_0:
    s_mov_b32 exec_lo, 0xffff0000
    s_mov_b32 exec_hi, 0
    buffer_load_dword v19, v10, s[36:39], 0 offen
    s_mov_b64 exec, -1
    s_waitcnt vmcnt(19)
    s_barrier
    s_bfe_u32 s91, s69, 0x40000
    s_lshl_b32 s92, s91, 7
    s_mul_i32 s93, s91, 393216
    s_add_u32 m0, s94, 81920
    s_nop 0
    buffer_load_dwordx4 v20, s[24:27], s92 offen offset:0 lds
    buffer_load_dwordx4 v21, s[24:27], s92 offen offset:1024 lds
    buffer_load_dwordx4 v22, s[24:27], s92 offen offset:2048 lds
    buffer_load_dwordx4 v23, s[24:27], s92 offen offset:3072 lds
    s_add_u32 m0, s95, 81920
    s_nop 0
    buffer_load_dwordx4 v24, s[28:31], s93 offen offset:0 lds
    s_waitcnt vmcnt(14)
    s_barrier
    s_add_u32 m0, s95, 81920
    s_nop 0
    buffer_load_dwordx4 v25, s[28:31], s93 offen offset:1024 lds
    buffer_load_dwordx4 v26, s[28:31], s93 offen offset:2048 lds
    s_add_u32 m0, s95, 84992
    s_nop 0
    buffer_load_dwordx4 v27, s[28:31], s93 offen offset:0 lds
    buffer_load_dwordx4 v28, s[28:31], s93 offen offset:1024 lds
    buffer_load_dwordx4 v29, s[28:31], s93 offen offset:2048 lds
    s_bfe_u32 s91, s69, 0x40004
    s_lshl_b32 s92, s91, 7
    s_mul_i32 s93, s91, 393216
    s_add_u32 m0, s94, 0
    s_nop 0
    buffer_load_dwordx4 v20, s[24:27], s92 offen offset:0 lds
    buffer_load_dwordx4 v21, s[24:27], s92 offen offset:1024 lds
    buffer_load_dwordx4 v22, s[24:27], s92 offen offset:2048 lds
    buffer_load_dwordx4 v23, s[24:27], s92 offen offset:3072 lds
    s_add_u32 m0, s95, 0
    s_nop 0
    buffer_load_dwordx4 v24, s[28:31], s93 offen offset:0 lds
    buffer_load_dwordx4 v25, s[28:31], s93 offen offset:1024 lds
    buffer_load_dwordx4 v26, s[28:31], s93 offen offset:2048 lds
    s_waitcnt vmcnt(7)
    s_barrier
    s_add_u32 m0, s95, 3072
    s_nop 0
    buffer_load_dwordx4 v27, s[28:31], s93 offen offset:0 lds
    buffer_load_dwordx4 v28, s[28:31], s93 offen offset:1024 lds
    buffer_load_dwordx4 v29, s[28:31], s93 offen offset:2048 lds
    s_bfe_u32 s91, s69, 0x40008
    s_lshl_b32 s92, s91, 7
    s_mul_i32 s93, s91, 393216
    s_add_u32 m0, s94, 40960
    s_nop 0
    buffer_load_dwordx4 v20, s[24:27], s92 offen offset:0 lds
    buffer_load_dwordx4 v21, s[24:27], s92 offen offset:1024 lds
    buffer_load_dwordx4 v22, s[24:27], s92 offen offset:2048 lds
    buffer_load_dwordx4 v23, s[24:27], s92 offen offset:3072 lds
    s_add_u32 m0, s95, 40960
    s_nop 0
    buffer_load_dwordx4 v24, s[28:31], s93 offen offset:0 lds
    buffer_load_dwordx4 v25, s[28:31], s93 offen offset:1024 lds
    buffer_load_dwordx4 v26, s[28:31], s93 offen offset:2048 lds
    s_add_u32 m0, s95, 44032
    s_nop 0
    buffer_load_dwordx4 v27, s[28:31], s93 offen offset:0 lds
    buffer_load_dwordx4 v28, s[28:31], s93 offen offset:1024 lds
    s_waitcnt vmcnt(9)
    s_barrier
    s_add_u32 m0, s95, 44032
    s_nop 0
    buffer_load_dwordx4 v29, s[28:31], s93 offen offset:2048 lds
    s_bfe_u32 s91, s69, 0x4000c
    s_lshl_b32 s92, s91, 7
    s_mul_i32 s93, s91, 393216
    s_add_u32 m0, s94, 81920
    s_nop 0
    buffer_load_dwordx4 v20, s[24:27], s92 offen offset:0 lds
    buffer_load_dwordx4 v21, s[24:27], s92 offen offset:1024 lds
    buffer_load_dwordx4 v22, s[24:27], s92 offen offset:2048 lds
    buffer_load_dwordx4 v23, s[24:27], s92 offen offset:3072 lds
    s_add_u32 m0, s95, 81920
    s_nop 0
    buffer_load_dwordx4 v24, s[28:31], s93 offen offset:0 lds
    buffer_load_dwordx4 v25, s[28:31], s93 offen offset:1024 lds
    buffer_load_dwordx4 v26, s[28:31], s93 offen offset:2048 lds
    s_add_u32 m0, s95, 84992
    s_nop 0
    buffer_load_dwordx4 v27, s[28:31], s93 offen offset:0 lds
    buffer_load_dwordx4 v28, s[28:31], s93 offen offset:1024 lds
    buffer_load_dwordx4 v29, s[28:31], s93 offen offset:2048 lds
    s_mov_b32 s12, 0
    buffer_load_dwordx4 v[104:107], v5, s[32:35], s12 offen offset:0 sc1
    buffer_load_dwordx4 v[108:111], v5, s[32:35], s12 offen offset:1024 sc1
    s_waitcnt vmcnt(12)
    s_barrier
    s_bfe_u32 s91, s69, 0x40010
    s_lshl_b32 s92, s91, 7
    s_mul_i32 s93, s91, 393216
    s_add_u32 m0, s94, 0
    s_nop 0
    buffer_load_dwordx4 v20, s[24:27], s92 offen offset:0 lds
    buffer_load_dwordx4 v21, s[24:27], s92 offen offset:1024 lds
    buffer_load_dwordx4 v22, s[24:27], s92 offen offset:2048 lds
    buffer_load_dwordx4 v23, s[24:27], s92 offen offset:3072 lds
    s_add_u32 m0, s95, 0
    s_nop 0
    buffer_load_dwordx4 v24, s[28:31], s93 offen offset:0 lds
    buffer_load_dwordx4 v25, s[28:31], s93 offen offset:1024 lds
    buffer_load_dwordx4 v26, s[28:31], s93 offen offset:2048 lds
    s_add_u32 m0, s95, 3072
    s_nop 0
    buffer_load_dwordx4 v27, s[28:31], s93 offen offset:0 lds
    buffer_load_dwordx4 v28, s[28:31], s93 offen offset:1024 lds
    buffer_load_dwordx4 v29, s[28:31], s93 offen offset:2048 lds
    s_add_u32 s12, s97, 0
    buffer_load_dwordx4 v[192:195], v31, s[64:67], s12 offen nt
    s_add_u32 s12, s97, 16384
    buffer_load_dwordx4 v[196:199], v31, s[64:67], s12 offen nt
    s_add_u32 s12, s97, 32768
    buffer_load_dwordx4 v[200:203], v31, s[64:67], s12 offen nt
    s_add_u32 s12, s97, 49152
    buffer_load_dwordx4 v[204:207], v31, s[64:67], s12 offen nt
    s_add_u32 s12, s97, 65536
    buffer_load_dwordx4 v[208:211], v31, s[64:67], s12 offen nt
    s_add_u32 s12, s97, 81920
    buffer_load_dwordx4 v[212:215], v31, s[64:67], s12 offen nt
    s_add_u32 s12, s97, 98304
    buffer_load_dwordx4 v[216:219], v31, s[64:67], s12 offen nt
    s_waitcnt vmcnt(19)
    s_barrier
    s_bfe_u32 s91, s69, 0x40014
    s_lshl_b32 s92, s91, 7
    s_mul_i32 s93, s91, 393216
    s_add_u32 m0, s94, 40960
    s_nop 0
    buffer_load_dwordx4 v20, s[24:27], s92 offen offset:0 lds
    buffer_load_dwordx4 v21, s[24:27], s92 offen offset:1024 lds
    buffer_load_dwordx4 v22, s[24:27], s92 offen offset:2048 lds
    buffer_load_dwordx4 v23, s[24:27], s92 offen offset:3072 lds
    s_add_u32 m0, s95, 40960
    s_nop 0
    buffer_load_dwordx4 v24, s[28:31], s93 offen offset:0 lds
    s_waitcnt vmcnt(22)
    s_mov_b32 s13, 0
L_keychk_0:
    v_xor_b32 v105, s23, v105
    v_xor_b32 v107, s23, v107
    v_xor_b32 v109, s23, v109
    v_xor_b32 v111, s23, v111
    v_or3_b32 v105, v105, v107, v109
    v_or_b32 v105, v105, v111
    v_cmp_ne_u32 vcc, 0, v105
    s_cbranch_vccz L_keyok_0
    s_add_u32 s13, s13, 1
    s_cmp_ge_u32 s13, 16384
    s_cbranch_scc1 L_keyok_0
    s_mov_b32 s12, 0
    buffer_load_dwordx4 v[104:107], v5, s[32:35], s12 offen offset:0 sc1
    buffer_load_dwordx4 v[108:111], v5, s[32:35], s12 offen offset:1024 sc1
    s_waitcnt vmcnt(0)
    s_branch L_keychk_0
L_keyok_0:
    v_max3_u32 v104, v104, v106, v108
    v_max_u32 v104, v104, v110
    s_nop 1
    v_max_u32_dpp v104, v104, v104 row_shr:1 row_mask:0xf bank_mask:0xf
    s_nop 1
    v_max_u32_dpp v104, v104, v104 row_shr:2 row_mask:0xf bank_mask:0xf
    s_nop 1
    v_max_u32_dpp v104, v104, v104 row_shr:4 row_mask:0xf bank_mask:0xf
    s_nop 1
    v_max_u32_dpp v104, v104, v104 row_shr:8 row_mask:0xf bank_mask:0xf
    s_nop 1
    v_max_u32_dpp v104, v104, v104 row_bcast:15 row_mask:0xa bank_mask:0xf
    s_nop 1
    v_max_u32_dpp v104, v104, v104 row_bcast:31 row_mask:0xc bank_mask:0xf
    s_nop 0
    v_readlane_b32 s14, v104, 63
    s_nop 1
    s_and_b32 s15, s14, 2047
    s_sub_u32 s15, 2047, s15
    s_lshl_b32 s12, s15, 11
    s_lshl_b32 s13, s70, 1
    s_add_u32 s12, s12, s13
    buffer_load_dwordx4 v[36:39], v34, s[24:27], s12 offen
    s_lshr_b32 s12, s14, 11
    s_and_b32 s13, s12, 0x8000
    s_cmp_lg_u32 s13, 0
    s_mov_b32 s13, 0xffff
    s_cselect_b32 s13, 0x8000, s13
    s_xor_b32 s12, s12, s13
    s_lshl_b32 s12, s12, 16
    v_mov_b32 v105, s12
    v_mul_f32 v105, 0xbfb8aa3b, v105
    v_exp_f32 v105, v105
    s_nop 0
    v_add_f32 v105, 1.0, v105
    v_rcp_f32 v105, v105
    s_nop 0
    v_cvt_pk_bf16_f32 v105, v105, v105
    v_lshlrev_b32 v105, 16, v105
    s_nop 0
    v_readfirstlane_b32 s14, v105
    s_add_u32 s12, s15, 1
    v_mov_b32 v104, s12
    v_mov_b32 v106, s23
    v_mov_b32 v14, 162864
    s_mov_b64 exec, 1
    ds_write_b96 v14, v[104:106]
    s_mov_b64 exec, -1
    s_waitcnt lgkmcnt(0)
    s_waitcnt vmcnt(13)
    s_barrier
    s_add_u32 m0, s95, 40960
    s_nop 0
    buffer_load_dwordx4 v25, s[28:31], s93 offen offset:1024 lds
    buffer_load_dwordx4 v26, s[28:31], s93 offen offset:2048 lds
    s_add_u32 m0, s95, 44032
    s_nop 0
    buffer_load_dwordx4 v27, s[28:31], s93 offen offset:0 lds
    buffer_load_dwordx4 v28, s[28:31], s93 offen offset:1024 lds
    buffer_load_dwordx4 v29, s[28:31], s93 offen offset:2048 lds
    s_bfe_u32 s91, s69, 0x40018
    s_lshl_b32 s92, s91, 7
    s_mul_i32 s93, s91, 393216
    s_add_u32 m0, s94, 81920
    s_nop 0
    buffer_load_dwordx4 v20, s[24:27], s92 offen offset:0 lds
    buffer_load_dwordx4 v21, s[24:27], s92 offen offset:1024 lds
    buffer_load_dwordx4 v22, s[24:27], s92 offen offset:2048 lds
    buffer_load_dwordx4 v23, s[24:27], s92 offen offset:3072 lds
    s_add_u32 m0, s95, 81920
    s_nop 0
    buffer_load_dwordx4 v24, s[28:31], s93 offen offset:0 lds
    buffer_load_dwordx4 v25, s[28:31], s93 offen offset:1024 lds
    buffer_load_dwordx4 v26, s[28:31], s93 offen offset:2048 lds
    s_waitcnt vmcnt(12)
    v_and_b32 v40, 0xffff, v36
    v_lshlrev_b32 v41, 16, v36
    v_lshrrev_b32 v42, 16, v36
    v_and_b32 v43, 0xffff0000, v36
    v_and_b32 v44, 0xffff, v37
    v_lshlrev_b32 v45, 16, v37
    v_lshrrev_b32 v46, 16, v37
    v_and_b32 v47, 0xffff0000, v37
    v_and_b32 v48, 0xffff, v38
    v_lshlrev_b32 v49, 16, v38
    v_lshrrev_b32 v50, 16, v38
    v_and_b32 v51, 0xffff0000, v38
    v_and_b32 v52, 0xffff, v39
    v_lshlrev_b32 v53, 16, v39
    v_lshrrev_b32 v54, 16, v39
    v_and_b32 v55, 0xffff0000, v39
    v_dot2_f32_bf16 v220, v128, v40, 0
    v_dot2_f32_bf16 v221, v128, v41, 0
    v_dot2_f32_bf16 v222, v129, v40, 0
    v_dot2_f32_bf16 v223, v129, v41, 0
    v_dot2_f32_bf16 v224, v130, v40, 0
    v_dot2_f32_bf16 v225, v130, v41, 0
    v_dot2_f32_bf16 v226, v131, v40, 0
    v_dot2_f32_bf16 v227, v131, v41, 0
    v_dot2_f32_bf16 v228, v160, v40, 0
    v_dot2_f32_bf16 v229, v160, v41, 0
    v_dot2_f32_bf16 v230, v161, v40, 0
    v_dot2_f32_bf16 v231, v161, v41, 0
    v_dot2_f32_bf16 v232, v162, v40, 0
    v_dot2_f32_bf16 v233, v162, v41, 0
    v_dot2_f32_bf16 v234, v163, v40, 0
    v_dot2_f32_bf16 v235, v163, v41, 0
    v_dot2_f32_bf16 v220, v132, v42, v220
    v_dot2_f32_bf16 v221, v132, v43, v221
    v_dot2_f32_bf16 v222, v133, v42, v222
    v_dot2_f32_bf16 v223, v133, v43, v223
    v_dot2_f32_bf16 v224, v134, v42, v224
    v_dot2_f32_bf16 v225, v134, v43, v225
    v_dot2_f32_bf16 v226, v135, v42, v226
    v_dot2_f32_bf16 v227, v135, v43, v227
    v_dot2_f32_bf16 v228, v164, v42, v228
    v_dot2_f32_bf16 v229, v164, v43, v229
    v_dot2_f32_bf16 v230, v165, v42, v230
    v_dot2_f32_bf16 v231, v165, v43, v231
    v_dot2_f32_bf16 v232, v166, v42, v232
    v_dot2_f32_bf16 v233, v166, v43, v233
    v_dot2_f32_bf16 v234, v167, v42, v234
    v_dot2_f32_bf16 v235, v167, v43, v235
    v_dot2_f32_bf16 v220, v136, v44, v220
    v_dot2_f32_bf16 v221, v136, v45, v221
    v_dot2_f32_bf16 v222, v137, v44, v222
    v_dot2_f32_bf16 v223, v137, v45, v223
    v_dot2_f32_bf16 v224, v138, v44, v224
    v_dot2_f32_bf16 v225, v138, v45, v225
    v_dot2_f32_bf16 v226, v139, v44, v226
    v_dot2_f32_bf16 v227, v139, v45, v227
    v_dot2_f32_bf16 v228, v168, v44, v228
    v_dot2_f32_bf16 v229, v168, v45, v229
    s_waitcnt vmcnt(7)
    s_barrier
    s_add_u32 m0, s95, 84992
    s_nop 0
    buffer_load_dwordx4 v27, s[28:31], s93 offen offset:0 lds
    buffer_load_dwordx4 v28, s[28:31], s93 offen offset:1024 lds
    buffer_load_dwordx4 v29, s[28:31], s93 offen offset:2048 lds
    s_bfe_u32 s91, s69, 0x4001c
    s_lshl_b32 s92, s91, 7
    s_mul_i32 s93, s91, 393216
    s_add_u32 m0, s94, 0
    s_nop 0
    buffer_load_dwordx4 v20, s[24:27], s92 offen offset:0 lds
    buffer_load_dwordx4 v21, s[24:27], s92 offen offset:1024 lds
    buffer_load_dwordx4 v22, s[24:27], s92 offen offset:2048 lds
    buffer_load_dwordx4 v23, s[24:27], s92 offen offset:3072 lds
    s_add_u32 m0, s95, 0
    s_nop 0
    buffer_load_dwordx4 v24, s[28:31], s93 offen offset:0 lds
    buffer_load_dwordx4 v25, s[28:31], s93 offen offset:1024 lds
    buffer_load_dwordx4 v26, s[28:31], s93 offen offset:2048 lds
    s_add_u32 m0, s95, 3072
    s_nop 0
    buffer_load_dwordx4 v27, s[28:31], s93 offen offset:0 lds
    buffer_load_dwordx4 v28, s[28:31], s93 offen offset:1024 lds
    v_dot2_f32_bf16 v230, v169, v44, v230
    v_dot2_f32_bf16 v231, v169, v45, v231
    v_dot2_f32_bf16 v232, v170, v44, v232
    v_dot2_f32_bf16 v233, v170, v45, v233
    v_dot2_f32_bf16 v234, v171, v44, v234
    v_dot2_f32_bf16 v235, v171, v45, v235
    v_dot2_f32_bf16 v220, v140, v46, v220
    v_dot2_f32_bf16 v221, v140, v47, v221
    v_dot2_f32_bf16 v222, v141, v46, v222
    v_dot2_f32_bf16 v223, v141, v47, v223
    v_dot2_f32_bf16 v224, v142, v46, v224
    v_dot2_f32_bf16 v225, v142, v47, v225
    v_dot2_f32_bf16 v226, v143, v46, v226
    v_dot2_f32_bf16 v227, v143, v47, v227
    v_dot2_f32_bf16 v228, v172, v46, v228
    v_dot2_f32_bf16 v229, v172, v47, v229
    v_dot2_f32_bf16 v230, v173, v46, v230
    v_dot2_f32_bf16 v231, v173, v47, v231
    v_dot2_f32_bf16 v232, v174, v46, v232
    v_dot2_f32_bf16 v233, v174, v47, v233
    v_dot2_f32_bf16 v234, v175, v46, v234
    v_dot2_f32_bf16 v235, v175, v47, v235
    v_dot2_f32_bf16 v220, v144, v48, v220
    v_dot2_f32_bf16 v221, v144, v49, v221
    v_dot2_f32_bf16 v222, v145, v48, v222
    v_dot2_f32_bf16 v223, v145, v49, v223
    v_dot2_f32_bf16 v224, v146, v48, v224
    v_dot2_f32_bf16 v225, v146, v49, v225
    v_dot2_f32_bf16 v226, v147, v48, v226
    v_dot2_f32_bf16 v227, v147, v49, v227
    v_dot2_f32_bf16 v228, v176, v48, v228
    v_dot2_f32_bf16 v229, v176, v49, v229
    v_dot2_f32_bf16 v230, v177, v48, v230
    v_dot2_f32_bf16 v231, v177, v49, v231
    v_dot2_f32_bf16 v232, v178, v48, v232
    v_dot2_f32_bf16 v233, v178, v49, v233
    v_dot2_f32_bf16 v234, v179, v48, v234
    v_dot2_f32_bf16 v235, v179, v49, v235
    v_dot2_f32_bf16 v220, v148, v50, v220
    v_dot2_f32_bf16 v221, v148, v51, v221
    v_dot2_f32_bf16 v222, v149, v50, v222
    v_dot2_f32_bf16 v223, v149, v51, v223
    v_dot2_f32_bf16 v224, v150, v50, v224
    v_dot2_f32_bf16 v225, v150, v51, v225
    v_dot2_f32_bf16 v226, v151, v50, v226
    v_dot2_f32_bf16 v227, v151, v51, v227
    v_dot2_f32_bf16 v228, v180, v50, v228
    v_dot2_f32_bf16 v229, v180, v51, v229
    v_dot2_f32_bf16 v230, v181, v50, v230
    v_dot2_f32_bf16 v231, v181, v51, v231
    v_dot2_f32_bf16 v232, v182, v50, v232
    v_dot2_f32_bf16 v233, v182, v51, v233
    v_dot2_f32_bf16 v234, v183, v50, v234
    v_dot2_f32_bf16 v235, v183, v51, v235
    v_dot2_f32_bf16 v220, v152, v52, v220
    v_dot2_f32_bf16 v221, v152, v53, v221
    v_dot2_f32_bf16 v222, v153, v52, v222
    v_dot2_f32_bf16 v223, v153, v53, v223
    s_waitcnt vmcnt(9)
    s_barrier
    s_add_u32 m0, s95, 3072
    s_nop 0
    buffer_load_dwordx4 v29, s[28:31], s93 offen offset:2048 lds
    s_mul_i32 s12, s21, 8
    s_add_u32 s12, s12, 96
    s_lshl_b32 s13, s12, 10
    s_lshl_b32 s12, s12, 14
    s_add_u32 m0, s13, 24576
    s_add_u32 s90, s12, 0
    buffer_load_dwordx4 v33, s[36:39], s90 offen lds
    s_add_u32 m0, s13, 25600
    s_add_u32 s90, s12, 16384
    buffer_load_dwordx4 v33, s[36:39], s90 offen lds
    s_add_u32 m0, s13, 26624
    s_add_u32 s90, s12, 32768
    buffer_load_dwordx4 v33, s[36:39], s90 offen lds
    s_add_u32 m0, s13, 27648
    s_add_u32 s90, s12, 49152
    buffer_load_dwordx4 v33, s[36:39], s90 offen lds
    s_add_u32 m0, s13, 28672
    s_add_u32 s90, s12, 65536
    buffer_load_dwordx4 v33, s[36:39], s90 offen lds
    s_add_u32 m0, s13, 29696
    s_add_u32 s90, s12, 81920
    buffer_load_dwordx4 v33, s[36:39], s90 offen lds
    s_add_u32 m0, s13, 30720
    s_add_u32 s90, s12, 98304
    buffer_load_dwordx4 v33, s[36:39], s90 offen lds
    s_add_u32 m0, s13, 31744
    s_add_u32 s90, s12, 114688
    buffer_load_dwordx4 v33, s[36:39], s90 offen lds
    v_dot2_f32_bf16 v224, v154, v52, v224
    v_dot2_f32_bf16 v225, v154, v53, v225
    v_dot2_f32_bf16 v226, v155, v52, v226
    v_dot2_f32_bf16 v227, v155, v53, v227
    v_dot2_f32_bf16 v228, v184, v52, v228
    v_dot2_f32_bf16 v229, v184, v53, v229
    v_dot2_f32_bf16 v230, v185, v52, v230
    v_dot2_f32_bf16 v231, v185, v53, v231
    v_dot2_f32_bf16 v232, v186, v52, v232
    v_dot2_f32_bf16 v233, v186, v53, v233
    v_dot2_f32_bf16 v234, v187, v52, v234
    v_dot2_f32_bf16 v235, v187, v53, v235
    v_dot2_f32_bf16 v220, v156, v54, v220
    v_dot2_f32_bf16 v221, v156, v55, v221
    v_dot2_f32_bf16 v222, v157, v54, v222
    v_dot2_f32_bf16 v223, v157, v55, v223
    v_dot2_f32_bf16 v224, v158, v54, v224
    v_dot2_f32_bf16 v225, v158, v55, v225
    v_dot2_f32_bf16 v226, v159, v54, v226
    v_dot2_f32_bf16 v227, v159, v55, v227
    v_dot2_f32_bf16 v228, v188, v54, v228
    v_dot2_f32_bf16 v229, v188, v55, v229
    v_dot2_f32_bf16 v230, v189, v54, v230
    v_dot2_f32_bf16 v231, v189, v55, v231
    v_dot2_f32_bf16 v232, v190, v54, v232
    v_dot2_f32_bf16 v233, v190, v55, v233
    v_dot2_f32_bf16 v234, v191, v54, v234
    v_dot2_f32_bf16 v235, v191, v55, v235
    v_permlane32_swap_b32 v220, v228
    v_permlane32_swap_b32 v221, v229
    v_permlane32_swap_b32 v222, v230
    v_permlane32_swap_b32 v223, v231
    v_permlane32_swap_b32 v224, v232
    v_permlane32_swap_b32 v225, v233
    v_permlane32_swap_b32 v226, v234
    v_permlane32_swap_b32 v227, v235
    v_add_f32 v220, v220, v228
    v_add_f32 v221, v221, v229
    v_add_f32 v222, v222, v230
    v_add_f32 v223, v223, v231
    v_add_f32 v224, v224, v232
    v_add_f32 v225, v225, v233
    v_add_f32 v226, v226, v234
    v_add_f32 v227, v227, v235
    v_permlane16_swap_b32 v220, v224
    v_permlane16_swap_b32 v221, v225
    v_permlane16_swap_b32 v222, v226
    v_permlane16_swap_b32 v223, v227
    v_add_f32 v220, v220, v224
    v_add_f32 v221, v221, v225
    v_add_f32 v222, v222, v226
    v_add_f32 v223, v223, v227
    v_add_f32_dpp v220, v220, v220 row_ror:8 row_mask:0xf bank_mask:0xf
    v_add_f32_dpp v221, v221, v221 row_ror:8 row_mask:0xf bank_mask:0xf
    v_add_f32_dpp v222, v222, v222 row_ror:8 row_mask:0xf bank_mask:0xf
    v_add_f32_dpp v223, v223, v223 row_ror:8 row_mask:0xf bank_mask:0xf
    s_waitcnt vmcnt(8)
    s_barrier
    s_branch L_varend
L_var1:
    s_nop 0
    s_add_u32 m0, s95, 40960
    s_nop 0
    buffer_load_dwordx4 v26, s[28:31], s93 offen offset:2048 lds
    s_add_u32 m0, s95, 44032
    s_nop 0
    buffer_load_dwordx4 v27, s[28:31], s93 offen offset:0 lds
    buffer_load_dwordx4 v28, s[28:31], s93 offen offset:1024 lds
    buffer_load_dwordx4 v29, s[28:31], s93 offen offset:2048 lds
    s_bfe_u32 s91, s68, 0x40008
    s_lshl_b32 s92, s91, 7
    s_mul_i32 s93, s91, 393216
    s_add_u32 m0, s94, 81920
    s_nop 0
    buffer_load_dwordx4 v20, s[24:27], s92 offen offset:0 lds
    buffer_load_dwordx4 v21, s[24:27], s92 offen offset:1024 lds
    buffer_load_dwordx4 v22, s[24:27], s92 offen offset:2048 lds
    buffer_load_dwordx4 v23, s[24:27], s92 offen offset:3072 lds
    s_add_u32 m0, s95, 81920
    s_nop 0
    buffer_load_dwordx4 v24, s[28:31], s93 offen offset:0 lds
    buffer_load_dwordx4 v25, s[28:31], s93 offen offset:1024 lds
    buffer_load_dwordx4 v26, s[28:31], s93 offen offset:2048 lds
    s_add_u32 m0, s95, 84992
    s_nop 0
    buffer_load_dwordx4 v27, s[28:31], s93 offen offset:0 lds
    buffer_load_dwordx4 v28, s[28:31], s93 offen offset:1024 lds
    buffer_load_dwordx4 v29, s[28:31], s93 offen offset:2048 lds
    s_lshl_b32 s12, s19, 2
    s_add_u32 s12, s12, s21
    s_lshl_b32 s12, s12, 10
    s_lshl_b32 s13, s21, 10
    s_add_u32 m0, s13, 155648
    s_nop 0
    buffer_load_dwordx4 v5, s[76:79], s12 offen lds
    s_lshl_b32 s12, s22, 11
    buffer_load_dwordx4 v[40:43], v5, s[24:27], s12 offen offset:0
    buffer_load_dwordx4 v[44:47], v5, s[24:27], s12 offen offset:1024
    buffer_load_dwordx4 v[48:51], v5, s[24:27], s12 offen offset:2048
    buffer_load_dwordx4 v[52:55], v5, s[24:27], s12 offen offset:3072
    buffer_load_dwordx4 v[56:59], v5, s[80:83], 0 offen offset:0
    buffer_load_dwordx4 v[60:63], v5, s[80:83], 0 offen offset:1024
    buffer_load_dwordx4 v[64:67], v5, s[84:87], 0 offen offset:0
    buffer_load_dwordx4 v[68:71], v5, s[84:87], 0 offen offset:1024
    s_waitcnt vmcnt(19)
    s_barrier
    s_bfe_u32 s91, s68, 0x4000c
    s_lshl_b32 s92, s91, 7
    s_mul_i32 s93, s91, 393216
    s_add_u32 m0, s94, 0
    s_nop 0
    buffer_load_dwordx4 v20, s[24:27], s92 offen offset:0 lds
    buffer_load_dwordx4 v21, s[24:27], s92 offen offset:1024 lds
    buffer_load_dwordx4 v22, s[24:27], s92 offen offset:2048 lds
    buffer_load_dwordx4 v23, s[24:27], s92 offen offset:3072 lds
    s_add_u32 m0, s95, 0
    s_nop 0
    buffer_load_dwordx4 v24, s[28:31], s93 offen offset:0 lds
    buffer_load_dwordx4 v25, s[28:31], s93 offen offset:1024 lds
    buffer_load_dwordx4 v26, s[28:31], s93 offen offset:2048 lds
    s_add_u32 m0, s95, 3072
    s_nop 0
    buffer_load_dwordx4 v27, s[28:31], s93 offen offset:0 lds
    buffer_load_dwordx4 v28, s[28:31], s93 offen offset:1024 lds
    buffer_load_dwordx4 v29, s[28:31], s93 offen offset:2048 lds
    s_cmp_lg_u32 s21, 0
    s_cbranch_scc1 L_noclr_1
    v_mov_b32 v104, -1
    v_mov_b32 v105, -1
    v_mov_b32 v106, -1
    v_mov_b32 v107, -1
    s_lshl_b32 s12, s19, 13
    s_lshl_b32 s13, s18, 9
    s_add_u32 s12, s12, s13
    s_add_u32 s12, s12, 32768
    s_lshl_b32 s13, s19, 11
    s_lshl_b32 s90, s18, 7
    s_add_u32 s13, s13, s90
    s_add_u32 s13, s13, 163840
    s_mov_b32 exec_hi, 0
    buffer_store_dwordx4 v[104:107], v5, s[32:35], s12 offen sc1
    s_mov_b32 exec_lo, 255
    buffer_store_dwordx4 v[104:107], v5, s[32:35], s13 offen sc1
    s_mov_b64 exec, -1
L_noclr_1:
    s_cmp_ge_u32 s10, 224
    s_cbranch_scc1 L_p30_1
    s_add_u32 s12, s71, 0
    buffer_load_dwordx4 v[128:131], v30, s[40:43], s12 offen nt
    s_add_u32 s12, s71, 7168
    buffer_load_dwordx4 v[132:135], v30, s[40:43], s12 offen nt
    s_add_u32 s12, s71, 14336
    buffer_load_dwordx4 v[136:139], v30, s[40:43], s12 offen nt
    s_add_u32 s12, s71, 21504
    buffer_load_dwordx4 v[140:143], v30, s[40:43], s12 offen nt
    s_add_u32 s12, s71, 28672
    buffer_load_dwordx4 v[144:147], v30, s[40:43], s12 offen nt
    s_add_u32 s12, s71, 35840
    buffer_load_dwordx4 v[148:151], v30, s[40:43], s12 offen nt
    s_add_u32 s12, s71, 43008
    buffer_load_dwordx4 v[152:155], v30, s[40:43], s12 offen nt
    s_add_u32 s12, s71, 50176
    buffer_load_dwordx4 v[156:159], v30, s[40:43], s12 offen nt
    s_branch L_p3e0_1
L_p30_1:
    s_mov_b64 exec, 63
    s_bfe_u32 s12, s68, 0x4000c
    s_mul_i32 s12, s12, 393216
    buffer_load_dword v128, v32, s[28:31], s12 offen
    s_bfe_u32 s12, s68, 0x40010
    s_mul_i32 s12, s12, 393216
    buffer_load_dword v132, v32, s[28:31], s12 offen
    s_bfe_u32 s12, s68, 0x40014
    s_mul_i32 s12, s12, 393216
    buffer_load_dword v136, v32, s[28:31], s12 offen
    s_bfe_u32 s12, s68, 0x40018
    s_mul_i32 s12, s12, 393216
    buffer_load_dword v140, v32, s[28:31], s12 offen
    s_bfe_u32 s12, s68, 0x4001c
    s_mul_i32 s12, s12, 393216
    buffer_load_dword v144, v32, s[28:31], s12 offen
    s_bfe_u32 s12, s69, 0x40000
    s_mul_i32 s12, s12, 393216
    buffer_load_dword v148, v32, s[28:31], s12 offen
    s_bfe_u32 s12, s69, 0x40004
    s_mul_i32 s12, s12, 393216
    buffer_load_dword v152, v32, s[28:31], s12 offen
    s_bfe_u32 s12, s69, 0x40008
    s_mul_i32 s12, s12, 393216
    buffer_load_dword v156, v32, s[28:31], s12 offen
    s_mov_b64 exec, -1
L_p3e0_1:
    s_waitcnt vmcnt(18)
    v_lshlrev_b32 v72, 16, v64
    v_and_b32 v73, 0xffff0000, v64
    v_lshlrev_b32 v74, 16, v65
    v_and_b32 v75, 0xffff0000, v65
    v_lshlrev_b32 v76, 16, v66
    v_and_b32 v77, 0xffff0000, v66
    v_lshlrev_b32 v78, 16, v67
    v_and_b32 v79, 0xffff0000, v67
    v_lshlrev_b32 v80, 16, v68
    v_and_b32 v81, 0xffff0000, v68
    v_lshlrev_b32 v82, 16, v69
    v_and_b32 v83, 0xffff0000, v69
    v_lshlrev_b32 v84, 16, v70
    v_and_b32 v85, 0xffff0000, v70
    v_lshlrev_b32 v86, 16, v71
    v_and_b32 v87, 0xffff0000, v71
    v_mov_b32 v90, 0
    v_mov_b32 v91, 0
    v_dot2_f32_bf16 v90, v40, v56, v90
    v_lshlrev_b32 v94, 16, v40
    v_and_b32 v95, 0xffff0000, v40
    v_mul_f32 v94, v94, v72
    v_mul_f32 v95, v95, v73
    v_cvt_pk_bf16_f32 v94, v94, v95
    v_lshlrev_b32 v95, 16, v94
    v_and_b32 v94, 0xffff0000, v94
    v_add_f32 v91, v91, v95
    v_add_f32 v91, v91, v94
    v_dot2_f32_bf16 v90, v41, v57, v90
    v_lshlrev_b32 v94, 16, v41
    v_and_b32 v95, 0xffff0000, v41
    v_mul_f32 v94, v94, v74
    v_mul_f32 v95, v95, v75
    v_cvt_pk_bf16_f32 v94, v94, v95
    v_lshlrev_b32 v95, 16, v94
    v_and_b32 v94, 0xffff0000, v94
    v_add_f32 v91, v91, v95
    v_add_f32 v91, v91, v94
    v_dot2_f32_bf16 v90, v42, v58, v90
    v_lshlrev_b32 v94, 16, v42
    v_and_b32 v95, 0xffff0000, v42
    v_mul_f32 v94, v94, v76
    v_mul_f32 v95, v95, v77
    v_cvt_pk_bf16_f32 v94, v94, v95
    v_lshlrev_b32 v95, 16, v94
    v_and_b32 v94, 0xffff0000, v94
    v_add_f32 v91, v91, v95
    v_add_f32 v91, v91, v94
    v_dot2_f32_bf16 v90, v43, v59, v90
    v_lshlrev_b32 v94, 16, v43
    v_and_b32 v95, 0xffff0000, v43
    v_mul_f32 v94, v94, v78
    v_mul_f32 v95, v95, v79
    v_cvt_pk_bf16_f32 v94, v94, v95
    v_lshlrev_b32 v95, 16, v94
    v_and_b32 v94, 0xffff0000, v94
    v_add_f32 v91, v91, v95
    v_add_f32 v91, v91, v94
    v_dot2_f32_bf16 v90, v44, v60, v90
    v_lshlrev_b32 v94, 16, v44
    v_and_b32 v95, 0xffff0000, v44
    v_mul_f32 v94, v94, v80
    v_mul_f32 v95, v95, v81
    v_cvt_pk_bf16_f32 v94, v94, v95
    v_lshlrev_b32 v95, 16, v94
    v_and_b32 v94, 0xffff0000, v94
    v_add_f32 v91, v91, v95
    v_add_f32 v91, v91, v94
    v_dot2_f32_bf16 v90, v45, v61, v90
    v_lshlrev_b32 v94, 16, v45
    v_and_b32 v95, 0xffff0000, v45
    v_mul_f32 v94, v94, v82
    v_mul_f32 v95, v95, v83
    v_cvt_pk_bf16_f32 v94, v94, v95
    v_lshlrev_b32 v95, 16, v94
    v_and_b32 v94, 0xffff0000, v94
    v_add_f32 v91, v91, v95
    v_add_f32 v91, v91, v94
    v_dot2_f32_bf16 v90, v46, v62, v90
    v_lshlrev_b32 v94, 16, v46
    v_and_b32 v95, 0xffff0000, v46
    v_mul_f32 v94, v94, v84
    v_mul_f32 v95, v95, v85
    v_cvt_pk_bf16_f32 v94, v94, v95
    v_lshlrev_b32 v95, 16, v94
    v_and_b32 v94, 0xffff0000, v94
    v_add_f32 v91, v91, v95
    v_add_f32 v91, v91, v94
    v_dot2_f32_bf16 v90, v47, v63, v90
    v_lshlrev_b32 v94, 16, v47
    v_and_b32 v95, 0xffff0000, v47
    v_mul_f32 v94, v94, v86
    v_mul_f32 v95, v95, v87
    v_cvt_pk_bf16_f32 v94, v94, v95
    v_lshlrev_b32 v95, 16, v94
    v_and_b32 v94, 0xffff0000, v94
    v_add_f32 v91, v91, v95
    v_add_f32 v91, v91, v94
    v_mov_b32 v92, 0
    v_mov_b32 v93, 0
    v_dot2_f32_bf16 v92, v48, v56, v92
    v_lshlrev_b32 v94, 16, v48
    v_and_b32 v95, 0xffff0000, v48
    v_mul_f32 v94, v94, v72
    v_mul_f32 v95, v95, v73
    v_cvt_pk_bf16_f32 v94, v94, v95
    v_lshlrev_b32 v95, 16, v94
    v_and_b32 v94, 0xffff0000, v94
    v_add_f32 v93, v93, v95
    v_add_f32 v93, v93, v94
    v_dot2_f32_bf16 v92, v49, v57, v92
    v_lshlrev_b32 v94, 16, v49
    v_and_b32 v95, 0xffff0000, v49
    v_mul_f32 v94, v94, v74
    v_mul_f32 v95, v95, v75
    v_cvt_pk_bf16_f32 v94, v94, v95
    v_lshlrev_b32 v95, 16, v94
    v_and_b32 v94, 0xffff0000, v94
    v_add_f32 v93, v93, v95
    v_add_f32 v93, v93, v94
    v_dot2_f32_bf16 v92, v50, v58, v92
    s_barrier
    s_bfe_u32 s91, s68, 0x40010
    s_lshl_b32 s92, s91, 7
    s_mul_i32 s93, s91, 393216
    s_add_u32 m0, s94, 40960
    s_nop 0
    buffer_load_dwordx4 v20, s[24:27], s92 offen offset:0 lds
    buffer_load_dwordx4 v21, s[24:27], s92 offen offset:1024 lds
    buffer_load_dwordx4 v22, s[24:27], s92 offen offset:2048 lds
    buffer_load_dwordx4 v23, s[24:27], s92 offen offset:3072 lds
    s_add_u32 m0, s95, 40960
    s_nop 0
    buffer_load_dwordx4 v24, s[28:31], s93 offen offset:0 lds
    v_lshlrev_b32 v94, 16, v50
    v_and_b32 v95, 0xffff0000, v50
    v_mul_f32 v94, v94, v76
    v_mul_f32 v95, v95, v77
    v_cvt_pk_bf16_f32 v94, v94, v95
    v_lshlrev_b32 v95, 16, v94
    v_and_b32 v94, 0xffff0000, v94
    v_add_f32 v93, v93, v95
    v_add_f32 v93, v93, v94
    v_dot2_f32_bf16 v92, v51, v59, v92
    v_lshlrev_b32 v94, 16, v51
    v_and_b32 v95, 0xffff0000, v51
    v_mul_f32 v94, v94, v78
    v_mul_f32 v95, v95, v79
    v_cvt_pk_bf16_f32 v94, v94, v95
    v_lshlrev_b32 v95, 16, v94
    v_and_b32 v94, 0xffff0000, v94
    v_add_f32 v93, v93, v95
    v_add_f32 v93, v93, v94
    v_dot2_f32_bf16 v92, v52, v60, v92
    v_lshlrev_b32 v94, 16, v52
    v_and_b32 v95, 0xffff0000, v52
    v_mul_f32 v94, v94, v80
    v_mul_f32 v95, v95, v81
    v_cvt_pk_bf16_f32 v94, v94, v95
    v_lshlrev_b32 v95, 16, v94
    v_and_b32 v94, 0xffff0000, v94
    v_add_f32 v93, v93, v95
    v_add_f32 v93, v93, v94
    v_dot2_f32_bf16 v92, v53, v61, v92
    v_lshlrev_b32 v94, 16, v53
    v_and_b32 v95, 0xffff0000, v53
    v_mul_f32 v94, v94, v82
    v_mul_f32 v95, v95, v83
    v_cvt_pk_bf16_f32 v94, v94, v95
    v_lshlrev_b32 v95, 16, v94
    v_and_b32 v94, 0xffff0000, v94
    v_add_f32 v93, v93, v95
    v_add_f32 v93, v93, v94
    v_dot2_f32_bf16 v92, v54, v62, v92
    v_lshlrev_b32 v94, 16, v54
    v_and_b32 v95, 0xffff0000, v54
    v_mul_f32 v94, v94, v84
    v_mul_f32 v95, v95, v85
    v_cvt_pk_bf16_f32 v94, v94, v95
    v_lshlrev_b32 v95, 16, v94
    v_and_b32 v94, 0xffff0000, v94
    v_add_f32 v93, v93, v95
    v_add_f32 v93, v93, v94
    v_dot2_f32_bf16 v92, v55, v63, v92
    v_lshlrev_b32 v94, 16, v55
    v_and_b32 v95, 0xffff0000, v55
    v_mul_f32 v94, v94, v86
    v_mul_f32 v95, v95, v87
    v_cvt_pk_bf16_f32 v94, v94, v95
    v_lshlrev_b32 v95, 16, v94
    v_and_b32 v94, 0xffff0000, v94
    v_add_f32 v93, v93, v95
    v_add_f32 v93, v93, v94
    v_add_f32_dpp v90, v90, v90 row_shr:1 row_mask:0xf bank_mask:0xf
    v_add_f32_dpp v91, v91, v91 row_shr:1 row_mask:0xf bank_mask:0xf
    v_add_f32_dpp v92, v92, v92 row_shr:1 row_mask:0xf bank_mask:0xf
    v_add_f32_dpp v93, v93, v93 row_shr:1 row_mask:0xf bank_mask:0xf
    v_add_f32_dpp v90, v90, v90 row_shr:2 row_mask:0xf bank_mask:0xf
    v_add_f32_dpp v91, v91, v91 row_shr:2 row_mask:0xf bank_mask:0xf
    v_add_f32_dpp v92, v92, v92 row_shr:2 row_mask:0xf bank_mask:0xf
    v_add_f32_dpp v93, v93, v93 row_shr:2 row_mask:0xf bank_mask:0xf
    v_add_f32_dpp v90, v90, v90 row_shr:4 row_mask:0xf bank_mask:0xf
    v_add_f32_dpp v91, v91, v91 row_shr:4 row_mask:0xf bank_mask:0xf
    v_add_f32_dpp v92, v92, v92 row_shr:4 row_mask:0xf bank_mask:0xf
    v_add_f32_dpp v93, v93, v93 row_shr:4 row_mask:0xf bank_mask:0xf
    v_add_f32_dpp v90, v90, v90 row_shr:8 row_mask:0xf bank_mask:0xf
    v_add_f32_dpp v91, v91, v91 row_shr:8 row_mask:0xf bank_mask:0xf
    v_add_f32_dpp v92, v92, v92 row_shr:8 row_mask:0xf bank_mask:0xf
    v_add_f32_dpp v93, v93, v93 row_shr:8 row_mask:0xf bank_mask:0xf
    v_add_f32_dpp v90, v90, v90 row_bcast:15 row_mask:0xa bank_mask:0xf
    v_add_f32_dpp v91, v91, v91 row_bcast:15 row_mask:0xa bank_mask:0xf
    v_add_f32_dpp v92, v92, v92 row_bcast:15 row_mask:0xa bank_mask:0xf
    v_add_f32_dpp v93, v93, v93 row_bcast:15 row_mask:0xa bank_mask:0xf
    v_add_f32_dpp v90, v90, v90 row_bcast:31 row_mask:0xc bank_mask:0xf
    v_add_f32_dpp v91, v91, v91 row_bcast:31 row_mask:0xc bank_mask:0xf
    v_add_f32_dpp v92, v92, v92 row_bcast:31 row_mask:0xc bank_mask:0xf
    v_add_f32_dpp v93, v93, v93 row_bcast:31 row_mask:0xc bank_mask:0xf
    v_cvt_pk_bf16_f32 v94, v90, v91
    v_and_b32 v95, 0xffff, v94
    v_and_b32 v96, 0x8000, v94
    v_cmp_ne_u32 vcc, 0, v96
    v_mov_b32 v97, 0x8000
    v_mov_b32 v98, 0xffff
    v_cndmask_b32 v96, v97, v98, vcc
    v_xor_b32 v95, v95, v96
    s_sub_u32 s12, 2047, s22
    v_lshlrev_b32 v95, 11, v95
    v_or_b32 v100, s12, v95
    v_and_b32 v94, 0xffff0000, v94
    v_mul_f32 v94, 0xbfb8aa3b, v94
    v_exp_f32 v94, v94
    s_nop 0
    v_add_f32 v94, 1.0, v94
    v_rcp_f32 v94, v94
    s_nop 0
    v_cvt_pk_bf16_f32 v94, v94, v94
    v_lshlrev_b32 v102, 16, v94
    v_cvt_pk_bf16_f32 v94, v92, v93
    v_and_b32 v95, 0xffff, v94
    v_and_b32 v96, 0x8000, v94
    v_cmp_ne_u32 vcc, 0, v96
    v_mov_b32 v97, 0x8000
    v_mov_b32 v98, 0xffff
    v_cndmask_b32 v96, v97, v98, vcc
    v_xor_b32 v95, v95, v96
    s_sub_u32 s12, 2046, s22
    v_lshlrev_b32 v95, 11, v95
    v_or_b32 v101, s12, v95
    v_and_b32 v94, 0xffff0000, v94
    v_mul_f32 v94, 0xbfb8aa3b, v94
    v_exp_f32 v94, v94
    s_nop 0
    v_add_f32 v94, 1.0, v94
    v_rcp_f32 v94, v94
    s_nop 0
    v_cvt_pk_bf16_f32 v94, v94, v94
    v_lshlrev_b32 v103, 16, v94
    v_max_u32 v100, v100, v101
    s_lshl_b32 s12, s22, 2
    s_add_u32 s12, s12, 4096
    s_lshl_b32 s13, s21, 2
    s_add_u32 s13, s13, 162880
    v_mov_b32 v14, s13
    s_mov_b32 exec_lo, 0
    s_mov_b32 exec_hi, 0x80000000
    buffer_store_dwordx2 v[102:103], v13, s[32:35], s12 offen sc1
    ds_write_b32 v14, v100
    s_mov_b64 exec, -1
    s_waitcnt lgkmcnt(0)
    buffer_load_dword v15, v13, s[72:75], 0 offen offset:4 sc1
    s_waitcnt vmcnt(15)
    s_barrier
    s_add_u32 m0, s95, 40960
    s_nop 0
    buffer_load_dwordx4 v25, s[28:31], s93 offen offset:1024 lds
    buffer_load_dwordx4 v26, s[28:31], s93 offen offset:2048 lds
    s_add_u32 m0, s95, 44032
    s_nop 0
    buffer_load_dwordx4 v27, s[28:31], s93 offen offset:0 lds
    buffer_load_dwordx4 v28, s[28:31], s93 offen offset:1024 lds
    buffer_load_dwordx4 v29, s[28:31], s93 offen offset:2048 lds
    s_bfe_u32 s91, s68, 0x40014
    s_lshl_b32 s92, s91, 7
    s_mul_i32 s93, s91, 393216
    s_add_u32 m0, s94, 81920
    s_nop 0
    buffer_load_dwordx4 v20, s[24:27], s92 offen offset:0 lds
    buffer_load_dwordx4 v21, s[24:27], s92 offen offset:1024 lds
    buffer_load_dwordx4 v22, s[24:27], s92 offen offset:2048 lds
    buffer_load_dwordx4 v23, s[24:27], s92 offen offset:3072 lds
    s_add_u32 m0, s95, 81920
    s_nop 0
    buffer_load_dwordx4 v24, s[28:31], s93 offen offset:0 lds
    buffer_load_dwordx4 v25, s[28:31], s93 offen offset:1024 lds
    buffer_load_dwordx4 v26, s[28:31], s93 offen offset:2048 lds
    s_waitcnt vmcnt(7)
    s_barrier
    s_add_u32 m0, s95, 84992
    s_nop 0
    buffer_load_dwordx4 v27, s[28:31], s93 offen offset:0 lds
    buffer_load_dwordx4 v28, s[28:31], s93 offen offset:1024 lds
    buffer_load_dwordx4 v29, s[28:31], s93 offen offset:2048 lds
    s_bfe_u32 s91, s68, 0x40018
    s_lshl_b32 s92, s91, 7
    s_mul_i32 s93, s91, 393216
    s_add_u32 m0, s94, 0
    s_nop 0
    buffer_load_dwordx4 v20, s[24:27], s92 offen offset:0 lds
    buffer_load_dwordx4 v21, s[24:27], s92 offen offset:1024 lds
    buffer_load_dwordx4 v22, s[24:27], s92 offen offset:2048 lds
    buffer_load_dwordx4 v23, s[24:27], s92 offen offset:3072 lds
    s_add_u32 m0, s95, 0
    s_nop 0
    buffer_load_dwordx4 v24, s[28:31], s93 offen offset:0 lds
    buffer_load_dwordx4 v25, s[28:31], s93 offen offset:1024 lds
    buffer_load_dwordx4 v26, s[28:31], s93 offen offset:2048 lds
    s_add_u32 m0, s95, 3072
    s_nop 0
    buffer_load_dwordx4 v27, s[28:31], s93 offen offset:0 lds
    buffer_load_dwordx4 v28, s[28:31], s93 offen offset:1024 lds
    s_mov_b32 s13, 0
L_tagchk_1:
    v_readfirstlane_b32 s23, v15
    s_nop 1
    s_cmp_lg_u32 s23, 0
    s_cbranch_scc1 L_tagok_1
    s_add_u32 s13, s13, 1
    s_cmp_ge_u32 s13, 16384
    s_cbranch_scc1 L_tagok_1
    buffer_load_dword v15, v13, s[72:75], 0 offen offset:4 sc1
    s_waitcnt vmcnt(0)
    s_branch L_tagchk_1
L_tagok_1:
    s_and_b32 s76, s23, 0xff
    s_bfe_u32 s77, s23, 0x80008
    s_bfe_u32 s78, s23, 0x80010
    s_lshr_b32 s79, s23, 24
    v_and_b32 v35, 3, v2
    v_lshlrev_b32 v35, 3, v35
    v_bfe_u32 v35, s23, v35, 8
    s_cmp_lg_u32 s21, 0
    s_cbranch_scc1 L_nopub_1
    v_mov_b32 v14, 162880
    ds_read_b128 v[104:107], v14
    s_lshl_b32 s12, s2, 3
    s_add_u32 s12, s12, 0
    s_waitcnt lgkmcnt(0)
    v_max3_u32 v104, v104, v105, v106
    v_max_u32 v104, v104, v107
    v_mov_b32 v105, s23
    s_mov_b64 exec, 1
    buffer_store_dwordx2 v[104:105], v13, s[32:35], s12 offen sc1
    s_mov_b64 exec, -1
L_nopub_1:
    s_waitcnt vmcnt(9)
    s_barrier
    s_add_u32 m0, s95, 3072
    s_nop 0
    buffer_load_dwordx4 v29, s[28:31], s93 offen offset:2048 lds
    s_bfe_u32 s91, s68, 0x4001c
    s_lshl_b32 s92, s91, 7
    s_mul_i32 s93, s91, 393216
    s_add_u32 m0, s94, 40960
    s_nop 0
    buffer_load_dwordx4 v20, s[24:27], s92 offen offset:0 lds
    buffer_load_dwordx4 v21, s[24:27], s92 offen offset:1024 lds
    buffer_load_dwordx4 v22, s[24:27], s92 offen offset:2048 lds
    buffer_load_dwordx4 v23, s[24:27], s92 offen offset:3072 lds
    s_add_u32 m0, s95, 40960
    s_nop 0
    buffer_load_dwordx4 v24, s[28:31], s93 offen offset:0 lds
    buffer_load_dwordx4 v25, s[28:31], s93 offen offset:1024 lds
    buffer_load_dwordx4 v26, s[28:31], s93 offen offset:2048 lds
    s_add_u32 m0, s95, 44032
    s_nop 0
    buffer_load_dwordx4 v27, s[28:31], s93 offen offset:0 lds
    buffer_load_dwordx4 v28, s[28:31], s93 offen offset:1024 lds
    buffer_load_dwordx4 v29, s[28:31], s93 offen offset:2048 lds
    s_waitcnt vmcnt(10)
    s_barrier
    s_bfe_u32 s91, s69, 0x40000
    s_lshl_b32 s92, s91, 7
    s_mul_i32 s93, s91, 393216
    s_add_u32 m0, s94, 81920
    s_nop 0
    buffer_load_dwordx4 v20, s[24:27], s92 offen offset:0 lds
    buffer_load_dwordx4 v21, s[24:27], s92 offen offset:1024 lds
    buffer_load_dwordx4 v22, s[24:27], s92 offen offset:2048 lds
    buffer_load_dwordx4 v23, s[24:27], s92 offen offset:3072 lds
    s_add_u32 m0, s95, 81920
    s_nop 0
    buffer_load_dwordx4 v24, s[28:31], s93 offen offset:0 lds
    buffer_load_dwordx4 v25, s[28:31], s93 offen offset:1024 lds
    buffer_load_dwordx4 v26, s[28:31], s93 offen offset:2048 lds
    s_add_u32 m0, s95, 84992
    s_nop 0
    buffer_load_dwordx4 v27, s[28:31], s93 offen offset:0 lds
    buffer_load_dwordx4 v28, s[28:31], s93 offen offset:1024 lds
    buffer_load_dwordx4 v29, s[28:31], s93 offen offset:2048 lds
    s_cmp_ge_u32 s10, 224
    s_cbranch_scc1 L_p31_1
    s_add_u32 s12, s9, 0
    buffer_load_dwordx4 v[160:163], v30, s[44:47], s12 offen nt
    s_add_u32 s12, s9, 7168
    buffer_load_dwordx4 v[164:167], v30, s[44:47], s12 offen nt
    s_add_u32 s12, s9, 14336
    buffer_load_dwordx4 v[168:171], v30, s[44:47], s12 offen nt
    s_add_u32 s12, s9, 21504
    buffer_load_dwordx4 v[172:175], v30, s[44:47], s12 offen nt
    s_add_u32 s12, s9, 28672
    buffer_load_dwordx4 v[176:179], v30, s[44:47], s12 offen nt
    s_add_u32 s12, s9, 35840
    buffer_load_dwordx4 v[180:183], v30, s[44:47], s12 offen nt
    s_add_u32 s12, s9, 43008
    buffer_load_dwordx4 v[184:187], v30, s[44:47], s12 offen nt
    s_add_u32 s12, s9, 50176
    buffer_load_dwordx4 v[188:191], v30, s[44:47], s12 offen nt
    s_branch L_p3e1_1
L_p31_1:
    s_mov_b64 exec, 63
    s_bfe_u32 s12, s69, 0x4000c
    s_mul_i32 s12, s12, 393216
    buffer_load_dword v160, v32, s[28:31], s12 offen
    s_bfe_u32 s12, s69, 0x40010
    s_mul_i32 s12, s12, 393216
    buffer_load_dword v164, v32, s[28:31], s12 offen
    s_bfe_u32 s12, s69, 0x40014
    s_mul_i32 s12, s12, 393216
    buffer_load_dword v168, v32, s[28:31], s12 offen
    s_bfe_u32 s12, s69, 0x40018
    s_mul_i32 s12, s12, 393216
    buffer_load_dword v172, v32, s[28:31], s12 offen
    s_bfe_u32 s12, s69, 0x4001c
    s_mul_i32 s12, s12, 393216
    buffer_load_dword v176, v32, s[28:31], s12 offen
    s_mov_b64 exec, 1
    s_bfe_u32 s12, s69, 0x4001c
    s_mul_i32 s12, s12, 393216
    buffer_load_dword v180, v32, s[28:31], s12 offen
    s_bfe_u32 s12, s69, 0x4001c
    s_mul_i32 s12, s12, 393216
    buffer_load_dword v184, v32, s[28:31], s12 offen
    s_bfe_u32 s12, s69, 0x4001c
    s_mul_i32 s12, s12, 393216
    buffer_load_dword v188, v32, s[28:31], s12 offen
    s_mov_b64 exec, -1
L_p3e1_1:
    s_mov_b32 exec_lo, 0xffff0000
    s_mov_b32 exec_hi, 0
    buffer_load_dword v19, v10, s[36:39], 0 offen
    s_mov_b64 exec, -1
    s_waitcnt vmcnt(19)
    s_barrier
    s_bfe_u32 s91, s69, 0x40004
    s_lshl_b32 s92, s91, 7
    s_mul_i32 s93, s91, 393216
    s_add_u32 m0, s94, 0
    s_nop 0
    buffer_load_dwordx4 v20, s[24:27], s92 offen offset:0 lds
    buffer_load_dwordx4 v21, s[24:27], s92 offen offset:1024 lds
    buffer_load_dwordx4 v22, s[24:27], s92 offen offset:2048 lds
    buffer_load_dwordx4 v23, s[24:27], s92 offen offset:3072 lds
    s_add_u32 m0, s95, 0
    s_nop 0
    buffer_load_dwordx4 v24, s[28:31], s93 offen offset:0 lds
    s_waitcnt vmcnt(14)
    s_barrier
    s_add_u32 m0, s95, 0
    s_nop 0
    buffer_load_dwordx4 v25, s[28:31], s93 offen offset:1024 lds
    buffer_load_dwordx4 v26, s[28:31], s93 offen offset:2048 lds
    s_add_u32 m0, s95, 3072
    s_nop 0
    buffer_load_dwordx4 v27, s[28:31], s93 offen offset:0 lds
    buffer_load_dwordx4 v28, s[28:31], s93 offen offset:1024 lds
    buffer_load_dwordx4 v29, s[28:31], s93 offen offset:2048 lds
    s_bfe_u32 s91, s69, 0x40008
    s_lshl_b32 s92, s91, 7
    s_mul_i32 s93, s91, 393216
    s_add_u32 m0, s94, 40960
    s_nop 0
    buffer_load_dwordx4 v20, s[24:27], s92 offen offset:0 lds
    buffer_load_dwordx4 v21, s[24:27], s92 offen offset:1024 lds
    buffer_load_dwordx4 v22, s[24:27], s92 offen offset:2048 lds
    buffer_load_dwordx4 v23, s[24:27], s92 offen offset:3072 lds
    s_add_u32 m0, s95, 40960
    s_nop 0
    buffer_load_dwordx4 v24, s[28:31], s93 offen offset:0 lds
    buffer_load_dwordx4 v25, s[28:31], s93 offen offset:1024 lds
    buffer_load_dwordx4 v26, s[28:31], s93 offen offset:2048 lds
    s_waitcnt vmcnt(7)
    s_barrier
    s_add_u32 m0, s95, 44032
    s_nop 0
    buffer_load_dwordx4 v27, s[28:31], s93 offen offset:0 lds
    buffer_load_dwordx4 v28, s[28:31], s93 offen offset:1024 lds
    buffer_load_dwordx4 v29, s[28:31], s93 offen offset:2048 lds
    s_bfe_u32 s91, s69, 0x4000c
    s_lshl_b32 s92, s91, 7
    s_mul_i32 s93, s91, 393216
    s_add_u32 m0, s94, 81920
    s_nop 0
    buffer_load_dwordx4 v20, s[24:27], s92 offen offset:0 lds
    buffer_load_dwordx4 v21, s[24:27], s92 offen offset:1024 lds
    buffer_load_dwordx4 v22, s[24:27], s92 offen offset:2048 lds
    buffer_load_dwordx4 v23, s[24:27], s92 offen offset:3072 lds
    s_add_u32 m0, s95, 81920
    s_nop 0
    buffer_load_dwordx4 v24, s[28:31], s93 offen offset:0 lds
    buffer_load_dwordx4 v25, s[28:31], s93 offen offset:1024 lds
    buffer_load_dwordx4 v26, s[28:31], s93 offen offset:2048 lds
    s_add_u32 m0, s95, 84992
    s_nop 0
    buffer_load_dwordx4 v27, s[28:31], s93 offen offset:0 lds
    buffer_load_dwordx4 v28, s[28:31], s93 offen offset:1024 lds
    s_mov_b32 s12, 0
    buffer_load_dwordx4 v[104:107], v5, s[32:35], s12 offen offset:0 sc1
    buffer_load_dwordx4 v[108:111], v5, s[32:35], s12 offen offset:1024 sc1
    s_waitcnt vmcnt(11)
    s_barrier
    s_add_u32 m0, s95, 84992
    s_nop 0
    buffer_load_dwordx4 v29, s[28:31], s93 offen offset:2048 lds
    s_bfe_u32 s91, s69, 0x40010
    s_lshl_b32 s92, s91, 7
    s_mul_i32 s93, s91, 393216
    s_add_u32 m0, s94, 0
    s_nop 0
    buffer_load_dwordx4 v20, s[24:27], s92 offen offset:0 lds
    buffer_load_dwordx4 v21, s[24:27], s92 offen offset:1024 lds
    buffer_load_dwordx4 v22, s[24:27], s92 offen offset:2048 lds
    buffer_load_dwordx4 v23, s[24:27], s92 offen offset:3072 lds
    s_add_u32 m0, s95, 0
    s_nop 0
    buffer_load_dwordx4 v24, s[28:31], s93 offen offset:0 lds
    buffer_load_dwordx4 v25, s[28:31], s93 offen offset:1024 lds
    buffer_load_dwordx4 v26, s[28:31], s93 offen offset:2048 lds
    s_add_u32 m0, s95, 3072
    s_nop 0
    buffer_load_dwordx4 v27, s[28:31], s93 offen offset:0 lds
    buffer_load_dwordx4 v28, s[28:31], s93 offen offset:1024 lds
    buffer_load_dwordx4 v29, s[28:31], s93 offen offset:2048 lds
    s_waitcnt vmcnt(10)
    s_barrier
    s_bfe_u32 s91, s69, 0x40014
    s_lshl_b32 s92, s91, 7
    s_mul_i32 s93, s91, 393216
    s_add_u32 m0, s94, 40960
    s_nop 0
    buffer_load_dwordx4 v20, s[24:27], s92 offen offset:0 lds
    buffer_load_dwordx4 v21, s[24:27], s92 offen offset:1024 lds
    buffer_load_dwordx4 v22, s[24:27], s92 offen offset:2048 lds
    buffer_load_dwordx4 v23, s[24:27], s92 offen offset:3072 lds
    s_add_u32 m0, s95, 40960
    s_nop 0
    buffer_load_dwordx4 v24, s[28:31], s93 offen offset:0 lds
    buffer_load_dwordx4 v25, s[28:31], s93 offen offset:1024 lds
    buffer_load_dwordx4 v26, s[28:31], s93 offen offset:2048 lds
    s_add_u32 m0, s95, 44032
    s_nop 0
    buffer_load_dwordx4 v27, s[28:31], s93 offen offset:0 lds
    buffer_load_dwordx4 v28, s[28:31], s93 offen offset:1024 lds
    buffer_load_dwordx4 v29, s[28:31], s93 offen offset:2048 lds
    s_add_u32 s12, s97, 0
    buffer_load_dwordx4 v[192:195], v31, s[64:67], s12 offen nt
    s_add_u32 s12, s97, 16384
    buffer_load_dwordx4 v[196:199], v31, s[64:67], s12 offen nt
    s_add_u32 s12, s97, 32768
    buffer_load_dwordx4 v[200:203], v31, s[64:67], s12 offen nt
    s_add_u32 s12, s97, 49152
    buffer_load_dwordx4 v[204:207], v31, s[64:67], s12 offen nt
    s_add_u32 s12, s97, 65536
    buffer_load_dwordx4 v[208:211], v31, s[64:67], s12 offen nt
    s_add_u32 s12, s97, 81920
    buffer_load_dwordx4 v[212:215], v31, s[64:67], s12 offen nt
    s_add_u32 s12, s97, 98304
    buffer_load_dwordx4 v[216:219], v31, s[64:67], s12 offen nt
    s_mov_b32 s13, 0
L_keychk_1:
    v_xor_b32 v105, s23, v105
    v_xor_b32 v107, s23, v107
    v_xor_b32 v109, s23, v109
    v_xor_b32 v111, s23, v111
    v_or3_b32 v105, v105, v107, v109
    v_or_b32 v105, v105, v111
    v_cmp_ne_u32 vcc, 0, v105
    s_cbranch_vccz L_keyok_1
    s_add_u32 s13, s13, 1
    s_cmp_ge_u32 s13, 16384
    s_cbranch_scc1 L_keyok_1
    s_mov_b32 s12, 0
    buffer_load_dwordx4 v[104:107], v5, s[32:35], s12 offen offset:0 sc1
    buffer_load_dwordx4 v[108:111], v5, s[32:35], s12 offen offset:1024 sc1
    s_waitcnt vmcnt(0)
    s_branch L_keychk_1
L_keyok_1:
    v_max3_u32 v104, v104, v106, v108
    v_max_u32 v104, v104, v110
    s_nop 1
    v_max_u32_dpp v104, v104, v104 row_shr:1 row_mask:0xf bank_mask:0xf
    s_nop 1
    v_max_u32_dpp v104, v104, v104 row_shr:2 row_mask:0xf bank_mask:0xf
    s_nop 1
    v_max_u32_dpp v104, v104, v104 row_shr:4 row_mask:0xf bank_mask:0xf
    s_nop 1
    v_max_u32_dpp v104, v104, v104 row_shr:8 row_mask:0xf bank_mask:0xf
    s_nop 1
    v_max_u32_dpp v104, v104, v104 row_bcast:15 row_mask:0xa bank_mask:0xf
    s_nop 1
    v_max_u32_dpp v104, v104, v104 row_bcast:31 row_mask:0xc bank_mask:0xf
    s_nop 0
    v_readlane_b32 s14, v104, 63
    s_nop 1
    s_and_b32 s15, s14, 2047
    s_sub_u32 s15, 2047, s15
    s_lshl_b32 s12, s15, 11
    s_lshl_b32 s13, s70, 1
    s_add_u32 s12, s12, s13
    buffer_load_dwordx4 v[36:39], v34, s[24:27], s12 offen
    s_lshr_b32 s12, s14, 11
    s_and_b32 s13, s12, 0x8000
    s_cmp_lg_u32 s13, 0
    s_mov_b32 s13, 0xffff
    s_cselect_b32 s13, 0x8000, s13
    s_xor_b32 s12, s12, s13
    s_lshl_b32 s12, s12, 16
    v_mov_b32 v105, s12
    v_mul_f32 v105, 0xbfb8aa3b, v105
    v_exp_f32 v105, v105
    s_nop 0
    v_add_f32 v105, 1.0, v105
    v_rcp_f32 v105, v105
    s_nop 0
    v_cvt_pk_bf16_f32 v105, v105, v105
    v_lshlrev_b32 v105, 16, v105
    s_nop 0
    v_readfirstlane_b32 s14, v105
    s_add_u32 s12, s15, 1
    v_mov_b32 v104, s12
    v_mov_b32 v106, s23
    v_mov_b32 v14, 162864
    s_mov_b64 exec, 1
    ds_write_b96 v14, v[104:106]
    s_mov_b64 exec, -1
    s_waitcnt lgkmcnt(0)
    s_waitcnt vmcnt(18)
    s_barrier
    s_bfe_u32 s91, s69, 0x40018
    s_lshl_b32 s92, s91, 7
    s_mul_i32 s93, s91, 393216
    s_add_u32 m0, s94, 81920
    s_nop 0
    buffer_load_dwordx4 v20, s[24:27], s92 offen offset:0 lds
    buffer_load_dwordx4 v21, s[24:27], s92 offen offset:1024 lds
    buffer_load_dwordx4 v22, s[24:27], s92 offen offset:2048 lds
    buffer_load_dwordx4 v23, s[24:27], s92 offen offset:3072 lds
    s_add_u32 m0, s95, 81920
    s_nop 0
    buffer_load_dwordx4 v24, s[28:31], s93 offen offset:0 lds
    s_waitcnt vmcnt(5)
    v_and_b32 v40, 0xffff, v36
    v_lshlrev_b32 v41, 16, v36
    v_lshrrev_b32 v42, 16, v36
    v_and_b32 v43, 0xffff0000, v36
    v_and_b32 v44, 0xffff, v37
    v_lshlrev_b32 v45, 16, v37
    v_lshrrev_b32 v46, 16, v37
    v_and_b32 v47, 0xffff0000, v37
    v_and_b32 v48, 0xffff, v38
    v_lshlrev_b32 v49, 16, v38
    v_lshrrev_b32 v50, 16, v38
    v_and_b32 v51, 0xffff0000, v38
    v_and_b32 v52, 0xffff, v39
    v_lshlrev_b32 v53, 16, v39
    v_lshrrev_b32 v54, 16, v39
    v_and_b32 v55, 0xffff0000, v39
    v_dot2_f32_bf16 v220, v128, v40, 0
    v_dot2_f32_bf16 v221, v128, v41, 0
    v_dot2_f32_bf16 v222, v129, v40, 0
    v_dot2_f32_bf16 v223, v129, v41, 0
    v_dot2_f32_bf16 v224, v130, v40, 0
    v_dot2_f32_bf16 v225, v130, v41, 0
    v_dot2_f32_bf16 v226, v131, v40, 0
    v_dot2_f32_bf16 v227, v131, v41, 0
    v_dot2_f32_bf16 v228, v160, v40, 0
    v_dot2_f32_bf16 v229, v160, v41, 0
    v_dot2_f32_bf16 v230, v161, v40, 0
    v_dot2_f32_bf16 v231, v161, v41, 0
    v_dot2_f32_bf16 v232, v162, v40, 0
    v_dot2_f32_bf16 v233, v162, v41, 0
    v_dot2_f32_bf16 v234, v163, v40, 0
    v_dot2_f32_bf16 v235, v163, v41, 0
    v_dot2_f32_bf16 v220, v132, v42, v220
    v_dot2_f32_bf16 v221, v132, v43, v221
    v_dot2_f32_bf16 v222, v133, v42, v222
    v_dot2_f32_bf16 v223, v133, v43, v223
    v_dot2_f32_bf16 v224, v134, v42, v224
    v_dot2_f32_bf16 v225, v134, v43, v225
    v_dot2_f32_bf16 v226, v135, v42, v226
    v_dot2_f32_bf16 v227, v135, v43, v227
    v_dot2_f32_bf16 v228, v164, v42, v228
    v_dot2_f32_bf16 v229, v164, v43, v229
    v_dot2_f32_bf16 v230, v165, v42, v230
    v_dot2_f32_bf16 v231, v165, v43, v231
    v_dot2_f32_bf16 v232, v166, v42, v232
    v_dot2_f32_bf16 v233, v166, v43, v233
    v_dot2_f32_bf16 v234, v167, v42, v234
    v_dot2_f32_bf16 v235, v167, v43, v235
    v_dot2_f32_bf16 v220, v136, v44, v220
    v_dot2_f32_bf16 v221, v136, v45, v221
    v_dot2_f32_bf16 v222, v137, v44, v222
    v_dot2_f32_bf16 v223, v137, v45, v223
    v_dot2_f32_bf16 v224, v138, v44, v224
    v_dot2_f32_bf16 v225, v138, v45, v225
    v_dot2_f32_bf16 v226, v139, v44, v226
    v_dot2_f32_bf16 v227, v139, v45, v227
    v_dot2_f32_bf16 v228, v168, v44, v228
    v_dot2_f32_bf16 v229, v168, v45, v229
    s_barrier
    s_add_u32 m0, s95, 81920
    s_nop 0
    buffer_load_dwordx4 v25, s[28:31], s93 offen offset:1024 lds
    buffer_load_dwordx4 v26, s[28:31], s93 offen offset:2048 lds
    s_add_u32 m0, s95, 84992
    s_nop 0
    buffer_load_dwordx4 v27, s[28:31], s93 offen offset:0 lds
    buffer_load_dwordx4 v28, s[28:31], s93 offen offset:1024 lds
    buffer_load_dwordx4 v29, s[28:31], s93 offen offset:2048 lds
    s_bfe_u32 s91, s69, 0x4001c
    s_lshl_b32 s92, s91, 7
    s_mul_i32 s93, s91, 393216
    s_add_u32 m0, s94, 0
    s_nop 0
    buffer_load_dwordx4 v20, s[24:27], s92 offen offset:0 lds
    buffer_load_dwordx4 v21, s[24:27], s92 offen offset:1024 lds
    buffer_load_dwordx4 v22, s[24:27], s92 offen offset:2048 lds
    buffer_load_dwordx4 v23, s[24:27], s92 offen offset:3072 lds
    s_add_u32 m0, s95, 0
    s_nop 0
    buffer_load_dwordx4 v24, s[28:31], s93 offen offset:0 lds
    buffer_load_dwordx4 v25, s[28:31], s93 offen offset:1024 lds
    buffer_load_dwordx4 v26, s[28:31], s93 offen offset:2048 lds
    v_dot2_f32_bf16 v230, v169, v44, v230
    v_dot2_f32_bf16 v231, v169, v45, v231
    v_dot2_f32_bf16 v232, v170, v44, v232
    v_dot2_f32_bf16 v233, v170, v45, v233
    v_dot2_f32_bf16 v234, v171, v44, v234
    v_dot2_f32_bf16 v235, v171, v45, v235
    v_dot2_f32_bf16 v220, v140, v46, v220
    v_dot2_f32_bf16 v221, v140, v47, v221
    v_dot2_f32_bf16 v222, v141, v46, v222
    v_dot2_f32_bf16 v223, v141, v47, v223
    v_dot2_f32_bf16 v224, v142, v46, v224
    v_dot2_f32_bf16 v225, v142, v47, v225
    v_dot2_f32_bf16 v226, v143, v46, v226
    v_dot2_f32_bf16 v227, v143, v47, v227
    v_dot2_f32_bf16 v228, v172, v46, v228
    v_dot2_f32_bf16 v229, v172, v47, v229
    v_dot2_f32_bf16 v230, v173, v46, v230
    v_dot2_f32_bf16 v231, v173, v47, v231
    v_dot2_f32_bf16 v232, v174, v46, v232
    v_dot2_f32_bf16 v233, v174, v47, v233
    v_dot2_f32_bf16 v234, v175, v46, v234
    v_dot2_f32_bf16 v235, v175, v47, v235
    v_dot2_f32_bf16 v220, v144, v48, v220
    v_dot2_f32_bf16 v221, v144, v49, v221
    v_dot2_f32_bf16 v222, v145, v48, v222
    v_dot2_f32_bf16 v223, v145, v49, v223
    v_dot2_f32_bf16 v224, v146, v48, v224
    v_dot2_f32_bf16 v225, v146, v49, v225
    v_dot2_f32_bf16 v226, v147, v48, v226
    v_dot2_f32_bf16 v227, v147, v49, v227
    v_dot2_f32_bf16 v228, v176, v48, v228
    v_dot2_f32_bf16 v229, v176, v49, v229
    v_dot2_f32_bf16 v230, v177, v48, v230
    v_dot2_f32_bf16 v231, v177, v49, v231
    v_dot2_f32_bf16 v232, v178, v48, v232
    v_dot2_f32_bf16 v233, v178, v49, v233
    v_dot2_f32_bf16 v234, v179, v48, v234
    v_dot2_f32_bf16 v235, v179, v49, v235
    v_dot2_f32_bf16 v220, v148, v50, v220
    v_dot2_f32_bf16 v221, v148, v51, v221
    v_dot2_f32_bf16 v222, v149, v50, v222
    v_dot2_f32_bf16 v223, v149, v51, v223
    v_dot2_f32_bf16 v224, v150, v50, v224
    v_dot2_f32_bf16 v225, v150, v51, v225
    v_dot2_f32_bf16 v226, v151, v50, v226
    v_dot2_f32_bf16 v227, v151, v51, v227
    v_dot2_f32_bf16 v228, v180, v50, v228
    v_dot2_f32_bf16 v229, v180, v51, v229
    v_dot2_f32_bf16 v230, v181, v50, v230
    v_dot2_f32_bf16 v231, v181, v51, v231
    v_dot2_f32_bf16 v232, v182, v50, v232
    v_dot2_f32_bf16 v233, v182, v51, v233
    v_dot2_f32_bf16 v234, v183, v50, v234
    v_dot2_f32_bf16 v235, v183, v51, v235
    v_dot2_f32_bf16 v220, v152, v52, v220
    v_dot2_f32_bf16 v221, v152, v53, v221
    v_dot2_f32_bf16 v222, v153, v52, v222
    v_dot2_f32_bf16 v223, v153, v53, v223
    s_waitcnt vmcnt(7)
    s_barrier
    s_add_u32 m0, s95, 3072
    s_nop 0
    buffer_load_dwordx4 v27, s[28:31], s93 offen offset:0 lds
    buffer_load_dwordx4 v28, s[28:31], s93 offen offset:1024 lds
    buffer_load_dwordx4 v29, s[28:31], s93 offen offset:2048 lds
    s_mul_i32 s12, s21, 8
    s_add_u32 s12, s12, 96
    s_lshl_b32 s13, s12, 10
    s_lshl_b32 s12, s12, 14
    s_add_u32 m0, s13, 24576
    s_add_u32 s90, s12, 0
    buffer_load_dwordx4 v33, s[36:39], s90 offen lds
    s_add_u32 m0, s13, 25600
    s_add_u32 s90, s12, 16384
    buffer_load_dwordx4 v33, s[36:39], s90 offen lds
    s_add_u32 m0, s13, 26624
    s_add_u32 s90, s12, 32768
    buffer_load_dwordx4 v33, s[36:39], s90 offen lds
    s_add_u32 m0, s13, 27648
    s_add_u32 s90, s12, 49152
    buffer_load_dwordx4 v33, s[36:39], s90 offen lds
    s_add_u32 m0, s13, 28672
    s_add_u32 s90, s12, 65536
    buffer_load_dwordx4 v33, s[36:39], s90 offen lds
    s_add_u32 m0, s13, 29696
    s_add_u32 s90, s12, 81920
    buffer_load_dwordx4 v33, s[36:39], s90 offen lds
    s_add_u32 m0, s13, 30720
    s_add_u32 s90, s12, 98304
    buffer_load_dwordx4 v33, s[36:39], s90 offen lds
    s_add_u32 m0, s13, 31744
    s_add_u32 s90, s12, 114688
    buffer_load_dwordx4 v33, s[36:39], s90 offen lds
    v_dot2_f32_bf16 v224, v154, v52, v224
    v_dot2_f32_bf16 v225, v154, v53, v225
    v_dot2_f32_bf16 v226, v155, v52, v226
    v_dot2_f32_bf16 v227, v155, v53, v227
    v_dot2_f32_bf16 v228, v184, v52, v228
    v_dot2_f32_bf16 v229, v184, v53, v229
    v_dot2_f32_bf16 v230, v185, v52, v230
    v_dot2_f32_bf16 v231, v185, v53, v231
    v_dot2_f32_bf16 v232, v186, v52, v232
    v_dot2_f32_bf16 v233, v186, v53, v233
    v_dot2_f32_bf16 v234, v187, v52, v234
    v_dot2_f32_bf16 v235, v187, v53, v235
    v_dot2_f32_bf16 v220, v156, v54, v220
    v_dot2_f32_bf16 v221, v156, v55, v221
    v_dot2_f32_bf16 v222, v157, v54, v222
    v_dot2_f32_bf16 v223, v157, v55, v223
    v_dot2_f32_bf16 v224, v158, v54, v224
    v_dot2_f32_bf16 v225, v158, v55, v225
    v_dot2_f32_bf16 v226, v159, v54, v226
    v_dot2_f32_bf16 v227, v159, v55, v227
    v_dot2_f32_bf16 v228, v188, v54, v228
    v_dot2_f32_bf16 v229, v188, v55, v229
    v_dot2_f32_bf16 v230, v189, v54, v230
    v_dot2_f32_bf16 v231, v189, v55, v231
    v_dot2_f32_bf16 v232, v190, v54, v232
    v_dot2_f32_bf16 v233, v190, v55, v233
    v_dot2_f32_bf16 v234, v191, v54, v234
    v_dot2_f32_bf16 v235, v191, v55, v235
    v_permlane32_swap_b32 v220, v228
    v_permlane32_swap_b32 v221, v229
    v_permlane32_swap_b32 v222, v230
    v_permlane32_swap_b32 v223, v231
    v_permlane32_swap_b32 v224, v232
    v_permlane32_swap_b32 v225, v233
    v_permlane32_swap_b32 v226, v234
    v_permlane32_swap_b32 v227, v235
    v_add_f32 v220, v220, v228
    v_add_f32 v221, v221, v229
    v_add_f32 v222, v222, v230
    v_add_f32 v223, v223, v231
    v_add_f32 v224, v224, v232
    v_add_f32 v225, v225, v233
    v_add_f32 v226, v226, v234
    v_add_f32 v227, v227, v235
    v_permlane16_swap_b32 v220, v224
    v_permlane16_swap_b32 v221, v225
    v_permlane16_swap_b32 v222, v226
    v_permlane16_swap_b32 v223, v227
    v_add_f32 v220, v220, v224
    v_add_f32 v221, v221, v225
    v_add_f32 v222, v222, v226
    v_add_f32 v223, v223, v227
    v_add_f32_dpp v220, v220, v220 row_ror:8 row_mask:0xf bank_mask:0xf
    v_add_f32_dpp v221, v221, v221 row_ror:8 row_mask:0xf bank_mask:0xf
    v_add_f32_dpp v222, v222, v222 row_ror:8 row_mask:0xf bank_mask:0xf
    v_add_f32_dpp v223, v223, v223 row_ror:8 row_mask:0xf bank_mask:0xf
    s_waitcnt vmcnt(8)
    s_barrier
    s_branch L_varend
L_var2:
    s_nop 0
    s_add_u32 m0, s95, 40960
    s_nop 0
    buffer_load_dwordx4 v26, s[28:31], s93 offen offset:2048 lds
    s_add_u32 m0, s95, 44032
    s_nop 0
    buffer_load_dwordx4 v27, s[28:31], s93 offen offset:0 lds
    buffer_load_dwordx4 v28, s[28:31], s93 offen offset:1024 lds
    buffer_load_dwordx4 v29, s[28:31], s93 offen offset:2048 lds
    s_bfe_u32 s91, s68, 0x40008
    s_lshl_b32 s92, s91, 7
    s_mul_i32 s93, s91, 393216
    s_add_u32 m0, s94, 81920
    s_nop 0
    buffer_load_dwordx4 v20, s[24:27], s92 offen offset:0 lds
    buffer_load_dwordx4 v21, s[24:27], s92 offen offset:1024 lds
    buffer_load_dwordx4 v22, s[24:27], s92 offen offset:2048 lds
    buffer_load_dwordx4 v23, s[24:27], s92 offen offset:3072 lds
    s_add_u32 m0, s95, 81920
    s_nop 0
    buffer_load_dwordx4 v24, s[28:31], s93 offen offset:0 lds
    buffer_load_dwordx4 v25, s[28:31], s93 offen offset:1024 lds
    buffer_load_dwordx4 v26, s[28:31], s93 offen offset:2048 lds
    s_add_u32 m0, s95, 84992
    s_nop 0
    buffer_load_dwordx4 v27, s[28:31], s93 offen offset:0 lds
    buffer_load_dwordx4 v28, s[28:31], s93 offen offset:1024 lds
    buffer_load_dwordx4 v29, s[28:31], s93 offen offset:2048 lds
    s_lshl_b32 s12, s19, 2
    s_add_u32 s12, s12, s21
    s_lshl_b32 s12, s12, 10
    s_lshl_b32 s13, s21, 10
    s_add_u32 m0, s13, 155648
    s_nop 0
    buffer_load_dwordx4 v5, s[76:79], s12 offen lds
    s_lshl_b32 s12, s22, 11
    buffer_load_dwordx4 v[40:43], v5, s[24:27], s12 offen offset:0
    buffer_load_dwordx4 v[44:47], v5, s[24:27], s12 offen offset:1024
    buffer_load_dwordx4 v[48:51], v5, s[24:27], s12 offen offset:2048
    buffer_load_dwordx4 v[52:55], v5, s[24:27], s12 offen offset:3072
    buffer_load_dwordx4 v[56:59], v5, s[80:83], 0 offen offset:0
    buffer_load_dwordx4 v[60:63], v5, s[80:83], 0 offen offset:1024
    buffer_load_dwordx4 v[64:67], v5, s[84:87], 0 offen offset:0
    buffer_load_dwordx4 v[68:71], v5, s[84:87], 0 offen offset:1024
    s_waitcnt vmcnt(19)
    s_barrier
    s_bfe_u32 s91, s68, 0x4000c
    s_lshl_b32 s92, s91, 7
    s_mul_i32 s93, s91, 393216
    s_add_u32 m0, s94, 0
    s_nop 0
    buffer_load_dwordx4 v20, s[24:27], s92 offen offset:0 lds
    buffer_load_dwordx4 v21, s[24:27], s92 offen offset:1024 lds
    buffer_load_dwordx4 v22, s[24:27], s92 offen offset:2048 lds
    buffer_load_dwordx4 v23, s[24:27], s92 offen offset:3072 lds
    s_add_u32 m0, s95, 0
    s_nop 0
    buffer_load_dwordx4 v24, s[28:31], s93 offen offset:0 lds
    buffer_load_dwordx4 v25, s[28:31], s93 offen offset:1024 lds
    buffer_load_dwordx4 v26, s[28:31], s93 offen offset:2048 lds
    s_add_u32 m0, s95, 3072
    s_nop 0
    buffer_load_dwordx4 v27, s[28:31], s93 offen offset:0 lds
    buffer_load_dwordx4 v28, s[28:31], s93 offen offset:1024 lds
    buffer_load_dwordx4 v29, s[28:31], s93 offen offset:2048 lds
    s_cmp_lg_u32 s21, 0
    s_cbranch_scc1 L_noclr_2
    v_mov_b32 v104, -1
    v_mov_b32 v105, -1
    v_mov_b32 v106, -1
    v_mov_b32 v107, -1
    s_lshl_b32 s12, s19, 13
    s_lshl_b32 s13, s18, 9
    s_add_u32 s12, s12, s13
    s_add_u32 s12, s12, 32768
    s_lshl_b32 s13, s19, 11
    s_lshl_b32 s90, s18, 7
    s_add_u32 s13, s13, s90
    s_add_u32 s13, s13, 163840
    s_mov_b32 exec_hi, 0
    buffer_store_dwordx4 v[104:107], v5, s[32:35], s12 offen sc1
    s_mov_b32 exec_lo, 255
    buffer_store_dwordx4 v[104:107], v5, s[32:35], s13 offen sc1
    s_mov_b64 exec, -1
L_noclr_2:
    s_waitcnt vmcnt(10)
    v_lshlrev_b32 v72, 16, v64
    v_and_b32 v73, 0xffff0000, v64
    v_lshlrev_b32 v74, 16, v65
    v_and_b32 v75, 0xffff0000, v65
    v_lshlrev_b32 v76, 16, v66
    v_and_b32 v77, 0xffff0000, v66
    v_lshlrev_b32 v78, 16, v67
    v_and_b32 v79, 0xffff0000, v67
    v_lshlrev_b32 v80, 16, v68
    v_and_b32 v81, 0xffff0000, v68
    v_lshlrev_b32 v82, 16, v69
    v_and_b32 v83, 0xffff0000, v69
    v_lshlrev_b32 v84, 16, v70
    v_and_b32 v85, 0xffff0000, v70
    v_lshlrev_b32 v86, 16, v71
    v_and_b32 v87, 0xffff0000, v71
    v_mov_b32 v90, 0
    v_mov_b32 v91, 0
    v_dot2_f32_bf16 v90, v40, v56, v90
    v_lshlrev_b32 v94, 16, v40
    v_and_b32 v95, 0xffff0000, v40
    v_mul_f32 v94, v94, v72
    v_mul_f32 v95, v95, v73
    v_cvt_pk_bf16_f32 v94, v94, v95
    v_lshlrev_b32 v95, 16, v94
    v_and_b32 v94, 0xffff0000, v94
    v_add_f32 v91, v91, v95
    v_add_f32 v91, v91, v94
    v_dot2_f32_bf16 v90, v41, v57, v90
    v_lshlrev_b32 v94, 16, v41
    v_and_b32 v95, 0xffff0000, v41
    v_mul_f32 v94, v94, v74
    v_mul_f32 v95, v95, v75
    v_cvt_pk_bf16_f32 v94, v94, v95
    v_lshlrev_b32 v95, 16, v94
    v_and_b32 v94, 0xffff0000, v94
    v_add_f32 v91, v91, v95
    v_add_f32 v91, v91, v94
    v_dot2_f32_bf16 v90, v42, v58, v90
    v_lshlrev_b32 v94, 16, v42
    v_and_b32 v95, 0xffff0000, v42
    v_mul_f32 v94, v94, v76
    v_mul_f32 v95, v95, v77
    v_cvt_pk_bf16_f32 v94, v94, v95
    v_lshlrev_b32 v95, 16, v94
    v_and_b32 v94, 0xffff0000, v94
    v_add_f32 v91, v91, v95
    v_add_f32 v91, v91, v94
    v_dot2_f32_bf16 v90, v43, v59, v90
    v_lshlrev_b32 v94, 16, v43
    v_and_b32 v95, 0xffff0000, v43
    v_mul_f32 v94, v94, v78
    v_mul_f32 v95, v95, v79
    v_cvt_pk_bf16_f32 v94, v94, v95
    v_lshlrev_b32 v95, 16, v94
    v_and_b32 v94, 0xffff0000, v94
    v_add_f32 v91, v91, v95
    v_add_f32 v91, v91, v94
    v_dot2_f32_bf16 v90, v44, v60, v90
    v_lshlrev_b32 v94, 16, v44
    v_and_b32 v95, 0xffff0000, v44
    v_mul_f32 v94, v94, v80
    v_mul_f32 v95, v95, v81
    v_cvt_pk_bf16_f32 v94, v94, v95
    v_lshlrev_b32 v95, 16, v94
    v_and_b32 v94, 0xffff0000, v94
    v_add_f32 v91, v91, v95
    v_add_f32 v91, v91, v94
    v_dot2_f32_bf16 v90, v45, v61, v90
    v_lshlrev_b32 v94, 16, v45
    v_and_b32 v95, 0xffff0000, v45
    v_mul_f32 v94, v94, v82
    v_mul_f32 v95, v95, v83
    v_cvt_pk_bf16_f32 v94, v94, v95
    v_lshlrev_b32 v95, 16, v94
    v_and_b32 v94, 0xffff0000, v94
    v_add_f32 v91, v91, v95
    v_add_f32 v91, v91, v94
    v_dot2_f32_bf16 v90, v46, v62, v90
    v_lshlrev_b32 v94, 16, v46
    v_and_b32 v95, 0xffff0000, v46
    v_mul_f32 v94, v94, v84
    v_mul_f32 v95, v95, v85
    v_cvt_pk_bf16_f32 v94, v94, v95
    v_lshlrev_b32 v95, 16, v94
    v_and_b32 v94, 0xffff0000, v94
    v_add_f32 v91, v91, v95
    v_add_f32 v91, v91, v94
    v_dot2_f32_bf16 v90, v47, v63, v90
    v_lshlrev_b32 v94, 16, v47
    v_and_b32 v95, 0xffff0000, v47
    v_mul_f32 v94, v94, v86
    v_mul_f32 v95, v95, v87
    v_cvt_pk_bf16_f32 v94, v94, v95
    v_lshlrev_b32 v95, 16, v94
    v_and_b32 v94, 0xffff0000, v94
    v_add_f32 v91, v91, v95
    v_add_f32 v91, v91, v94
    v_mov_b32 v92, 0
    v_mov_b32 v93, 0
    v_dot2_f32_bf16 v92, v48, v56, v92
    v_lshlrev_b32 v94, 16, v48
    v_and_b32 v95, 0xffff0000, v48
    v_mul_f32 v94, v94, v72
    v_mul_f32 v95, v95, v73
    v_cvt_pk_bf16_f32 v94, v94, v95
    v_lshlrev_b32 v95, 16, v94
    v_and_b32 v94, 0xffff0000, v94
    v_add_f32 v93, v93, v95
    v_add_f32 v93, v93, v94
    v_dot2_f32_bf16 v92, v49, v57, v92
    v_lshlrev_b32 v94, 16, v49
    v_and_b32 v95, 0xffff0000, v49
    v_mul_f32 v94, v94, v74
    v_mul_f32 v95, v95, v75
    v_cvt_pk_bf16_f32 v94, v94, v95
    v_lshlrev_b32 v95, 16, v94
    v_and_b32 v94, 0xffff0000, v94
    v_add_f32 v93, v93, v95
    v_add_f32 v93, v93, v94
    v_dot2_f32_bf16 v92, v50, v58, v92
    s_barrier
    s_bfe_u32 s91, s68, 0x40010
    s_lshl_b32 s92, s91, 7
    s_mul_i32 s93, s91, 393216
    s_add_u32 m0, s94, 40960
    s_nop 0
    buffer_load_dwordx4 v20, s[24:27], s92 offen offset:0 lds
    buffer_load_dwordx4 v21, s[24:27], s92 offen offset:1024 lds
    buffer_load_dwordx4 v22, s[24:27], s92 offen offset:2048 lds
    buffer_load_dwordx4 v23, s[24:27], s92 offen offset:3072 lds
    s_add_u32 m0, s95, 40960
    s_nop 0
    buffer_load_dwordx4 v24, s[28:31], s93 offen offset:0 lds
    buffer_load_dwordx4 v25, s[28:31], s93 offen offset:1024 lds
    buffer_load_dwordx4 v26, s[28:31], s93 offen offset:2048 lds
    s_add_u32 m0, s95, 44032
    s_nop 0
    buffer_load_dwordx4 v27, s[28:31], s93 offen offset:0 lds
    buffer_load_dwordx4 v28, s[28:31], s93 offen offset:1024 lds
    buffer_load_dwordx4 v29, s[28:31], s93 offen offset:2048 lds
    s_cmp_ge_u32 s10, 224
    s_cbranch_scc1 L_p30_2
    s_add_u32 s12, s71, 0
    buffer_load_dwordx4 v[128:131], v30, s[40:43], s12 offen nt
    s_add_u32 s12, s71, 7168
    buffer_load_dwordx4 v[132:135], v30, s[40:43], s12 offen nt
    s_add_u32 s12, s71, 14336
    buffer_load_dwordx4 v[136:139], v30, s[40:43], s12 offen nt
    s_add_u32 s12, s71, 21504
    buffer_load_dwordx4 v[140:143], v30, s[40:43], s12 offen nt
    s_add_u32 s12, s71, 28672
    buffer_load_dwordx4 v[144:147], v30, s[40:43], s12 offen nt
    s_add_u32 s12, s71, 35840
    buffer_load_dwordx4 v[148:151], v30, s[40:43], s12 offen nt
    s_add_u32 s12, s71, 43008
    buffer_load_dwordx4 v[152:155], v30, s[40:43], s12 offen nt
    s_add_u32 s12, s71, 50176
    buffer_load_dwordx4 v[156:159], v30, s[40:43], s12 offen nt
    s_branch L_p3e0_2
L_p30_2:
    s_mov_b64 exec, 63
    s_bfe_u32 s12, s68, 0x4000c
    s_mul_i32 s12, s12, 393216
    buffer_load_dword v128, v32, s[28:31], s12 offen
    s_bfe_u32 s12, s68, 0x40010
    s_mul_i32 s12, s12, 393216
    buffer_load_dword v132, v32, s[28:31], s12 offen
    s_bfe_u32 s12, s68, 0x40014
    s_mul_i32 s12, s12, 393216
    buffer_load_dword v136, v32, s[28:31], s12 offen
    s_bfe_u32 s12, s68, 0x40018
    s_mul_i32 s12, s12, 393216
    buffer_load_dword v140, v32, s[28:31], s12 offen
    s_bfe_u32 s12, s68, 0x4001c
    s_mul_i32 s12, s12, 393216
    buffer_load_dword v144, v32, s[28:31], s12 offen
    s_bfe_u32 s12, s69, 0x40000
    s_mul_i32 s12, s12, 393216
    buffer_load_dword v148, v32, s[28:31], s12 offen
    s_bfe_u32 s12, s69, 0x40004
    s_mul_i32 s12, s12, 393216
    buffer_load_dword v152, v32, s[28:31], s12 offen
    s_bfe_u32 s12, s69, 0x40008
    s_mul_i32 s12, s12, 393216
    buffer_load_dword v156, v32, s[28:31], s12 offen
    s_mov_b64 exec, -1
L_p3e0_2:
    v_lshlrev_b32 v94, 16, v50
    v_and_b32 v95, 0xffff0000, v50
    v_mul_f32 v94, v94, v76
    v_mul_f32 v95, v95, v77
    v_cvt_pk_bf16_f32 v94, v94, v95
    v_lshlrev_b32 v95, 16, v94
    v_and_b32 v94, 0xffff0000, v94
    v_add_f32 v93, v93, v95
    v_add_f32 v93, v93, v94
    v_dot2_f32_bf16 v92, v51, v59, v92
    v_lshlrev_b32 v94, 16, v51
    v_and_b32 v95, 0xffff0000, v51
    v_mul_f32 v94, v94, v78
    v_mul_f32 v95, v95, v79
    v_cvt_pk_bf16_f32 v94, v94, v95
    v_lshlrev_b32 v95, 16, v94
    v_and_b32 v94, 0xffff0000, v94
    v_add_f32 v93, v93, v95
    v_add_f32 v93, v93, v94
    v_dot2_f32_bf16 v92, v52, v60, v92
    v_lshlrev_b32 v94, 16, v52
    v_and_b32 v95, 0xffff0000, v52
    v_mul_f32 v94, v94, v80
    v_mul_f32 v95, v95, v81
    v_cvt_pk_bf16_f32 v94, v94, v95
    v_lshlrev_b32 v95, 16, v94
    v_and_b32 v94, 0xffff0000, v94
    v_add_f32 v93, v93, v95
    v_add_f32 v93, v93, v94
    v_dot2_f32_bf16 v92, v53, v61, v92
    v_lshlrev_b32 v94, 16, v53
    v_and_b32 v95, 0xffff0000, v53
    v_mul_f32 v94, v94, v82
    v_mul_f32 v95, v95, v83
    v_cvt_pk_bf16_f32 v94, v94, v95
    v_lshlrev_b32 v95, 16, v94
    v_and_b32 v94, 0xffff0000, v94
    v_add_f32 v93, v93, v95
    v_add_f32 v93, v93, v94
    v_dot2_f32_bf16 v92, v54, v62, v92
    v_lshlrev_b32 v94, 16, v54
    v_and_b32 v95, 0xffff0000, v54
    v_mul_f32 v94, v94, v84
    v_mul_f32 v95, v95, v85
    v_cvt_pk_bf16_f32 v94, v94, v95
    v_lshlrev_b32 v95, 16, v94
    v_and_b32 v94, 0xffff0000, v94
    v_add_f32 v93, v93, v95
    v_add_f32 v93, v93, v94
    v_dot2_f32_bf16 v92, v55, v63, v92
    v_lshlrev_b32 v94, 16, v55
    v_and_b32 v95, 0xffff0000, v55
    v_mul_f32 v94, v94, v86
    v_mul_f32 v95, v95, v87
    v_cvt_pk_bf16_f32 v94, v94, v95
    v_lshlrev_b32 v95, 16, v94
    v_and_b32 v94, 0xffff0000, v94
    v_add_f32 v93, v93, v95
    v_add_f32 v93, v93, v94
    v_add_f32_dpp v90, v90, v90 row_shr:1 row_mask:0xf bank_mask:0xf
    v_add_f32_dpp v91, v91, v91 row_shr:1 row_mask:0xf bank_mask:0xf
    v_add_f32_dpp v92, v92, v92 row_shr:1 row_mask:0xf bank_mask:0xf
    v_add_f32_dpp v93, v93, v93 row_shr:1 row_mask:0xf bank_mask:0xf
    v_add_f32_dpp v90, v90, v90 row_shr:2 row_mask:0xf bank_mask:0xf
    v_add_f32_dpp v91, v91, v91 row_shr:2 row_mask:0xf bank_mask:0xf
    v_add_f32_dpp v92, v92, v92 row_shr:2 row_mask:0xf bank_mask:0xf
    v_add_f32_dpp v93, v93, v93 row_shr:2 row_mask:0xf bank_mask:0xf
    v_add_f32_dpp v90, v90, v90 row_shr:4 row_mask:0xf bank_mask:0xf
    v_add_f32_dpp v91, v91, v91 row_shr:4 row_mask:0xf bank_mask:0xf
    v_add_f32_dpp v92, v92, v92 row_shr:4 row_mask:0xf bank_mask:0xf
    v_add_f32_dpp v93, v93, v93 row_shr:4 row_mask:0xf bank_mask:0xf
    v_add_f32_dpp v90, v90, v90 row_shr:8 row_mask:0xf bank_mask:0xf
    v_add_f32_dpp v91, v91, v91 row_shr:8 row_mask:0xf bank_mask:0xf
    v_add_f32_dpp v92, v92, v92 row_shr:8 row_mask:0xf bank_mask:0xf
    v_add_f32_dpp v93, v93, v93 row_shr:8 row_mask:0xf bank_mask:0xf
    v_add_f32_dpp v90, v90, v90 row_bcast:15 row_mask:0xa bank_mask:0xf
    v_add_f32_dpp v91, v91, v91 row_bcast:15 row_mask:0xa bank_mask:0xf
    v_add_f32_dpp v92, v92, v92 row_bcast:15 row_mask:0xa bank_mask:0xf
    v_add_f32_dpp v93, v93, v93 row_bcast:15 row_mask:0xa bank_mask:0xf
    v_add_f32_dpp v90, v90, v90 row_bcast:31 row_mask:0xc bank_mask:0xf
    v_add_f32_dpp v91, v91, v91 row_bcast:31 row_mask:0xc bank_mask:0xf
    v_add_f32_dpp v92, v92, v92 row_bcast:31 row_mask:0xc bank_mask:0xf
    v_add_f32_dpp v93, v93, v93 row_bcast:31 row_mask:0xc bank_mask:0xf
    v_cvt_pk_bf16_f32 v94, v90, v91
    v_and_b32 v95, 0xffff, v94
    v_and_b32 v96, 0x8000, v94
    v_cmp_ne_u32 vcc, 0, v96
    v_mov_b32 v97, 0x8000
    v_mov_b32 v98, 0xffff
    v_cndmask_b32 v96, v97, v98, vcc
    v_xor_b32 v95, v95, v96
    s_sub_u32 s12, 2047, s22
    v_lshlrev_b32 v95, 11, v95
    v_or_b32 v100, s12, v95
    v_and_b32 v94, 0xffff0000, v94
    v_mul_f32 v94, 0xbfb8aa3b, v94
    v_exp_f32 v94, v94
    s_nop 0
    v_add_f32 v94, 1.0, v94
    v_rcp_f32 v94, v94
    s_nop 0
    v_cvt_pk_bf16_f32 v94, v94, v94
    v_lshlrev_b32 v102, 16, v94
    v_cvt_pk_bf16_f32 v94, v92, v93
    v_and_b32 v95, 0xffff, v94
    v_and_b32 v96, 0x8000, v94
    v_cmp_ne_u32 vcc, 0, v96
    v_mov_b32 v97, 0x8000
    v_mov_b32 v98, 0xffff
    v_cndmask_b32 v96, v97, v98, vcc
    v_xor_b32 v95, v95, v96
    s_sub_u32 s12, 2046, s22
    v_lshlrev_b32 v95, 11, v95
    v_or_b32 v101, s12, v95
    v_and_b32 v94, 0xffff0000, v94
    v_mul_f32 v94, 0xbfb8aa3b, v94
    v_exp_f32 v94, v94
    s_nop 0
    v_add_f32 v94, 1.0, v94
    v_rcp_f32 v94, v94
    s_nop 0
    v_cvt_pk_bf16_f32 v94, v94, v94
    v_lshlrev_b32 v103, 16, v94
    v_max_u32 v100, v100, v101
    s_lshl_b32 s12, s22, 2
    s_add_u32 s12, s12, 4096
    s_lshl_b32 s13, s21, 2
    s_add_u32 s13, s13, 162880
    v_mov_b32 v14, s13
    s_mov_b32 exec_lo, 0
    s_mov_b32 exec_hi, 0x80000000
    buffer_store_dwordx2 v[102:103], v13, s[32:35], s12 offen sc1
    ds_write_b32 v14, v100
    s_mov_b64 exec, -1
    s_waitcnt lgkmcnt(0)
    buffer_load_dword v15, v13, s[72:75], 0 offen offset:4 sc1
    s_waitcnt vmcnt(20)
    s_barrier
    s_bfe_u32 s91, s68, 0x40014
    s_lshl_b32 s92, s91, 7
    s_mul_i32 s93, s91, 393216
    s_add_u32 m0, s94, 81920
    s_nop 0
    buffer_load_dwordx4 v20, s[24:27], s92 offen offset:0 lds
    buffer_load_dwordx4 v21, s[24:27], s92 offen offset:1024 lds
    buffer_load_dwordx4 v22, s[24:27], s92 offen offset:2048 lds
    buffer_load_dwordx4 v23, s[24:27], s92 offen offset:3072 lds
    s_add_u32 m0, s95, 81920
    s_nop 0
    buffer_load_dwordx4 v24, s[28:31], s93 offen offset:0 lds
    s_waitcnt vmcnt(15)
    s_barrier
    s_add_u32 m0, s95, 81920
    s_nop 0
    buffer_load_dwordx4 v25, s[28:31], s93 offen offset:1024 lds
    buffer_load_dwordx4 v26, s[28:31], s93 offen offset:2048 lds
    s_add_u32 m0, s95, 84992
    s_nop 0
    buffer_load_dwordx4 v27, s[28:31], s93 offen offset:0 lds
    buffer_load_dwordx4 v28, s[28:31], s93 offen offset:1024 lds
    buffer_load_dwordx4 v29, s[28:31], s93 offen offset:2048 lds
    s_bfe_u32 s91, s68, 0x40018
    s_lshl_b32 s92, s91, 7
    s_mul_i32 s93, s91, 393216
    s_add_u32 m0, s94, 0
    s_nop 0
    buffer_load_dwordx4 v20, s[24:27], s92 offen offset:0 lds
    buffer_load_dwordx4 v21, s[24:27], s92 offen offset:1024 lds
    buffer_load_dwordx4 v22, s[24:27], s92 offen offset:2048 lds
    buffer_load_dwordx4 v23, s[24:27], s92 offen offset:3072 lds
    s_add_u32 m0, s95, 0
    s_nop 0
    buffer_load_dwordx4 v24, s[28:31], s93 offen offset:0 lds
    buffer_load_dwordx4 v25, s[28:31], s93 offen offset:1024 lds
    buffer_load_dwordx4 v26, s[28:31], s93 offen offset:2048 lds
    s_waitcnt vmcnt(17)
    s_mov_b32 s13, 0
L_tagchk_2:
    v_readfirstlane_b32 s23, v15
    s_nop 1
    s_cmp_lg_u32 s23, 0
    s_cbranch_scc1 L_tagok_2
    s_add_u32 s13, s13, 1
    s_cmp_ge_u32 s13, 16384
    s_cbranch_scc1 L_tagok_2
    buffer_load_dword v15, v13, s[72:75], 0 offen offset:4 sc1
    s_waitcnt vmcnt(0)
    s_branch L_tagchk_2
L_tagok_2:
    s_and_b32 s76, s23, 0xff
    s_bfe_u32 s77, s23, 0x80008
    s_bfe_u32 s78, s23, 0x80010
    s_lshr_b32 s79, s23, 24
    v_and_b32 v35, 3, v2
    v_lshlrev_b32 v35, 3, v35
    v_bfe_u32 v35, s23, v35, 8
    s_cmp_lg_u32 s21, 0
    s_cbranch_scc1 L_nopub_2
    v_mov_b32 v14, 162880
    ds_read_b128 v[104:107], v14
    s_lshl_b32 s12, s2, 3
    s_add_u32 s12, s12, 0
    s_waitcnt lgkmcnt(0)
    v_max3_u32 v104, v104, v105, v106
    v_max_u32 v104, v104, v107
    v_mov_b32 v105, s23
    s_mov_b64 exec, 1
    buffer_store_dwordx2 v[104:105], v13, s[32:35], s12 offen sc1
    s_mov_b64 exec, -1
L_nopub_2:
    s_waitcnt vmcnt(7)
    s_barrier
    s_add_u32 m0, s95, 3072
    s_nop 0
    buffer_load_dwordx4 v27, s[28:31], s93 offen offset:0 lds
    buffer_load_dwordx4 v28, s[28:31], s93 offen offset:1024 lds
    buffer_load_dwordx4 v29, s[28:31], s93 offen offset:2048 lds
    s_bfe_u32 s91, s68, 0x4001c
    s_lshl_b32 s92, s91, 7
    s_mul_i32 s93, s91, 393216
    s_add_u32 m0, s94, 40960
    s_nop 0
    buffer_load_dwordx4 v20, s[24:27], s92 offen offset:0 lds
    buffer_load_dwordx4 v21, s[24:27], s92 offen offset:1024 lds
    buffer_load_dwordx4 v22, s[24:27], s92 offen offset:2048 lds
    buffer_load_dwordx4 v23, s[24:27], s92 offen offset:3072 lds
    s_add_u32 m0, s95, 40960
    s_nop 0
    buffer_load_dwordx4 v24, s[28:31], s93 offen offset:0 lds
    buffer_load_dwordx4 v25, s[28:31], s93 offen offset:1024 lds
    buffer_load_dwordx4 v26, s[28:31], s93 offen offset:2048 lds
    s_add_u32 m0, s95, 44032
    s_nop 0
    buffer_load_dwordx4 v27, s[28:31], s93 offen offset:0 lds
    buffer_load_dwordx4 v28, s[28:31], s93 offen offset:1024 lds
    s_waitcnt vmcnt(9)
    s_barrier
    s_add_u32 m0, s95, 44032
    s_nop 0
    buffer_load_dwordx4 v29, s[28:31], s93 offen offset:2048 lds
    s_bfe_u32 s91, s69, 0x40000
    s_lshl_b32 s92, s91, 7
    s_mul_i32 s93, s91, 393216
    s_add_u32 m0, s94, 81920
    s_nop 0
    buffer_load_dwordx4 v20, s[24:27], s92 offen offset:0 lds
    buffer_load_dwordx4 v21, s[24:27], s92 offen offset:1024 lds
    buffer_load_dwordx4 v22, s[24:27], s92 offen offset:2048 lds
    buffer_load_dwordx4 v23, s[24:27], s92 offen offset:3072 lds
    s_add_u32 m0, s95, 81920
    s_nop 0
    buffer_load_dwordx4 v24, s[28:31], s93 offen offset:0 lds
    buffer_load_dwordx4 v25, s[28:31], s93 offen offset:1024 lds
    buffer_load_dwordx4 v26, s[28:31], s93 offen offset:2048 lds
    s_add_u32 m0, s95, 84992
    s_nop 0
    buffer_load_dwordx4 v27, s[28:31], s93 offen offset:0 lds
    buffer_load_dwordx4 v28, s[28:31], s93 offen offset:1024 lds
    buffer_load_dwordx4 v29, s[28:31], s93 offen offset:2048 lds
    s_waitcnt vmcnt(10)
    s_barrier
    s_bfe_u32 s91, s69, 0x40004
    s_lshl_b32 s92, s91, 7
    s_mul_i32 s93, s91, 393216
    s_add_u32 m0, s94, 0
    s_nop 0
    buffer_load_dwordx4 v20, s[24:27], s92 offen offset:0 lds
    buffer_load_dwordx4 v21, s[24:27], s92 offen offset:1024 lds
    buffer_load_dwordx4 v22, s[24:27], s92 offen offset:2048 lds
    buffer_load_dwordx4 v23, s[24:27], s92 offen offset:3072 lds
    s_add_u32 m0, s95, 0
    s_nop 0
    buffer_load_dwordx4 v24, s[28:31], s93 offen offset:0 lds
    buffer_load_dwordx4 v25, s[28:31], s93 offen offset:1024 lds
    buffer_load_dwordx4 v26, s[28:31], s93 offen offset:2048 lds
    s_add_u32 m0, s95, 3072
    s_nop 0
    buffer_load_dwordx4 v27, s[28:31], s93 offen offset:0 lds
    buffer_load_dwordx4 v28, s[28:31], s93 offen offset:1024 lds
    buffer_load_dwordx4 v29, s[28:31], s93 offen offset:2048 lds
    s_cmp_ge_u32 s10, 224
    s_cbranch_scc1 L_p31_2
    s_add_u32 s12, s9, 0
    buffer_load_dwordx4 v[160:163], v30, s[44:47], s12 offen nt
    s_add_u32 s12, s9, 7168
    buffer_load_dwordx4 v[164:167], v30, s[44:47], s12 offen nt
    s_add_u32 s12, s9, 14336
    buffer_load_dwordx4 v[168:171], v30, s[44:47], s12 offen nt
    s_add_u32 s12, s9, 21504
    buffer_load_dwordx4 v[172:175], v30, s[44:47], s12 offen nt
    s_add_u32 s12, s9, 28672
    buffer_load_dwordx4 v[176:179], v30, s[44:47], s12 offen nt
    s_add_u32 s12, s9, 35840
    buffer_load_dwordx4 v[180:183], v30, s[44:47], s12 offen nt
    s_add_u32 s12, s9, 43008
    buffer_load_dwordx4 v[184:187], v30, s[44:47], s12 offen nt
    s_add_u32 s12, s9, 50176
    buffer_load_dwordx4 v[188:191], v30, s[44:47], s12 offen nt
    s_branch L_p3e1_2
L_p31_2:
    s_mov_b64 exec, 63
    s_bfe_u32 s12, s69, 0x4000c
    s_mul_i32 s12, s12, 393216
    buffer_load_dword v160, v32, s[28:31], s12 offen
    s_bfe_u32 s12, s69, 0x40010
    s_mul_i32 s12, s12, 393216
    buffer_load_dword v164, v32, s[28:31], s12 offen
    s_bfe_u32 s12, s69, 0x40014
    s_mul_i32 s12, s12, 393216
    buffer_load_dword v168, v32, s[28:31], s12 offen
    s_bfe_u32 s12, s69, 0x40018
    s_mul_i32 s12, s12, 393216
    buffer_load_dword v172, v32, s[28:31], s12 offen
    s_bfe_u32 s12, s69, 0x4001c
    s_mul_i32 s12, s12, 393216
    buffer_load_dword v176, v32, s[28:31], s12 offen
    s_mov_b64 exec, 1
    s_bfe_u32 s12, s69, 0x4001c
    s_mul_i32 s12, s12, 393216
    buffer_load_dword v180, v32, s[28:31], s12 offen
    s_bfe_u32 s12, s69, 0x4001c
    s_mul_i32 s12, s12, 393216
    buffer_load_dword v184, v32, s[28:31], s12 offen
    s_bfe_u32 s12, s69, 0x4001c
    s_mul_i32 s12, s12, 393216
    buffer_load_dword v188, v32, s[28:31], s12 offen
    s_mov_b64 exec, -1
L_p3e1_2:
    s_mov_b32 exec_lo, 0xffff0000
    s_mov_b32 exec_hi, 0
    buffer_load_dword v19, v10, s[36:39], 0 offen
    s_mov_b64 exec, -1
    s_waitcnt vmcnt(19)
    s_barrier
    s_bfe_u32 s91, s69, 0x40008
    s_lshl_b32 s92, s91, 7
    s_mul_i32 s93, s91, 393216
    s_add_u32 m0, s94, 40960
    s_nop 0
    buffer_load_dwordx4 v20, s[24:27], s92 offen offset:0 lds
    buffer_load_dwordx4 v21, s[24:27], s92 offen offset:1024 lds
    buffer_load_dwordx4 v22, s[24:27], s92 offen offset:2048 lds
    buffer_load_dwordx4 v23, s[24:27], s92 offen offset:3072 lds
    s_add_u32 m0, s95, 40960
    s_nop 0
    buffer_load_dwordx4 v24, s[28:31], s93 offen offset:0 lds
    s_waitcnt vmcnt(14)
    s_barrier
    s_add_u32 m0, s95, 40960
    s_nop 0
    buffer_load_dwordx4 v25, s[28:31], s93 offen offset:1024 lds
    buffer_load_dwordx4 v26, s[28:31], s93 offen offset:2048 lds
    s_add_u32 m0, s95, 44032
    s_nop 0
    buffer_load_dwordx4 v27, s[28:31], s93 offen offset:0 lds
    buffer_load_dwordx4 v28, s[28:31], s93 offen offset:1024 lds
    buffer_load_dwordx4 v29, s[28:31], s93 offen offset:2048 lds
    s_bfe_u32 s91, s69, 0x4000c
    s_lshl_b32 s92, s91, 7
    s_mul_i32 s93, s91, 393216
    s_add_u32 m0, s94, 81920
    s_nop 0
    buffer_load_dwordx4 v20, s[24:27], s92 offen offset:0 lds
    buffer_load_dwordx4 v21, s[24:27], s92 offen offset:1024 lds
    buffer_load_dwordx4 v22, s[24:27], s92 offen offset:2048 lds
    buffer_load_dwordx4 v23, s[24:27], s92 offen offset:3072 lds
    s_add_u32 m0, s95, 81920
    s_nop 0
    buffer_load_dwordx4 v24, s[28:31], s93 offen offset:0 lds
    buffer_load_dwordx4 v25, s[28:31], s93 offen offset:1024 lds
    buffer_load_dwordx4 v26, s[28:31], s93 offen offset:2048 lds
    s_mov_b32 s12, 0
    buffer_load_dwordx4 v[104:107], v5, s[32:35], s12 offen offset:0 sc1
    buffer_load_dwordx4 v[108:111], v5, s[32:35], s12 offen offset:1024 sc1
    s_waitcnt vmcnt(9)
    s_barrier
    s_add_u32 m0, s95, 84992
    s_nop 0
    buffer_load_dwordx4 v27, s[28:31], s93 offen offset:0 lds
    buffer_load_dwordx4 v28, s[28:31], s93 offen offset:1024 lds
    buffer_load_dwordx4 v29, s[28:31], s93 offen offset:2048 lds
    s_bfe_u32 s91, s69, 0x40010
    s_lshl_b32 s92, s91, 7
    s_mul_i32 s93, s91, 393216
    s_add_u32 m0, s94, 0
    s_nop 0
    buffer_load_dwordx4 v20, s[24:27], s92 offen offset:0 lds
    buffer_load_dwordx4 v21, s[24:27], s92 offen offset:1024 lds
    buffer_load_dwordx4 v22, s[24:27], s92 offen offset:2048 lds
    buffer_load_dwordx4 v23, s[24:27], s92 offen offset:3072 lds
    s_add_u32 m0, s95, 0
    s_nop 0
    buffer_load_dwordx4 v24, s[28:31], s93 offen offset:0 lds
    buffer_load_dwordx4 v25, s[28:31], s93 offen offset:1024 lds
    buffer_load_dwordx4 v26, s[28:31], s93 offen offset:2048 lds
    s_add_u32 m0, s95, 3072
    s_nop 0
    buffer_load_dwordx4 v27, s[28:31], s93 offen offset:0 lds
    buffer_load_dwordx4 v28, s[28:31], s93 offen offset:1024 lds
    s_waitcnt vmcnt(9)
    s_barrier
    s_add_u32 m0, s95, 3072
    s_nop 0
    buffer_load_dwordx4 v29, s[28:31], s93 offen offset:2048 lds
    s_bfe_u32 s91, s69, 0x40014
    s_lshl_b32 s92, s91, 7
    s_mul_i32 s93, s91, 393216
    s_add_u32 m0, s94, 40960
    s_nop 0
    buffer_load_dwordx4 v20, s[24:27], s92 offen offset:0 lds
    buffer_load_dwordx4 v21, s[24:27], s92 offen offset:1024 lds
    buffer_load_dwordx4 v22, s[24:27], s92 offen offset:2048 lds
    buffer_load_dwordx4 v23, s[24:27], s92 offen offset:3072 lds
    s_add_u32 m0, s95, 40960
    s_nop 0
    buffer_load_dwordx4 v24, s[28:31], s93 offen offset:0 lds
    buffer_load_dwordx4 v25, s[28:31], s93 offen offset:1024 lds
    buffer_load_dwordx4 v26, s[28:31], s93 offen offset:2048 lds
    s_add_u32 m0, s95, 44032
    s_nop 0
    buffer_load_dwordx4 v27, s[28:31], s93 offen offset:0 lds
    buffer_load_dwordx4 v28, s[28:31], s93 offen offset:1024 lds
    buffer_load_dwordx4 v29, s[28:31], s93 offen offset:2048 lds
    s_mov_b32 s13, 0
L_keychk_2:
    v_xor_b32 v105, s23, v105
    v_xor_b32 v107, s23, v107
    v_xor_b32 v109, s23, v109
    v_xor_b32 v111, s23, v111
    v_or3_b32 v105, v105, v107, v109
    v_or_b32 v105, v105, v111
    v_cmp_ne_u32 vcc, 0, v105
    s_cbranch_vccz L_keyok_2
    s_add_u32 s13, s13, 1
    s_cmp_ge_u32 s13, 16384
    s_cbranch_scc1 L_keyok_2
    s_mov_b32 s12, 0
    buffer_load_dwordx4 v[104:107], v5, s[32:35], s12 offen offset:0 sc1
    buffer_load_dwordx4 v[108:111], v5, s[32:35], s12 offen offset:1024 sc1
    s_waitcnt vmcnt(0)
    s_branch L_keychk_2
L_keyok_2:
    v_max3_u32 v104, v104, v106, v108
    v_max_u32 v104, v104, v110
    s_nop 1
    v_max_u32_dpp v104, v104, v104 row_shr:1 row_mask:0xf bank_mask:0xf
    s_nop 1
    v_max_u32_dpp v104, v104, v104 row_shr:2 row_mask:0xf bank_mask:0xf
    s_nop 1
    v_max_u32_dpp v104, v104, v104 row_shr:4 row_mask:0xf bank_mask:0xf
    s_nop 1
    v_max_u32_dpp v104, v104, v104 row_shr:8 row_mask:0xf bank_mask:0xf
    s_nop 1
    v_max_u32_dpp v104, v104, v104 row_bcast:15 row_mask:0xa bank_mask:0xf
    s_nop 1
    v_max_u32_dpp v104, v104, v104 row_bcast:31 row_mask:0xc bank_mask:0xf
    s_nop 0
    v_readlane_b32 s14, v104, 63
    s_nop 1
    s_and_b32 s15, s14, 2047
    s_sub_u32 s15, 2047, s15
    s_lshl_b32 s12, s15, 11
    s_lshl_b32 s13, s70, 1
    s_add_u32 s12, s12, s13
    buffer_load_dwordx4 v[36:39], v34, s[24:27], s12 offen
    s_lshr_b32 s12, s14, 11
    s_and_b32 s13, s12, 0x8000
    s_cmp_lg_u32 s13, 0
    s_mov_b32 s13, 0xffff
    s_cselect_b32 s13, 0x8000, s13
    s_xor_b32 s12, s12, s13
    s_lshl_b32 s12, s12, 16
    v_mov_b32 v105, s12
    v_mul_f32 v105, 0xbfb8aa3b, v105
    v_exp_f32 v105, v105
    s_nop 0
    v_add_f32 v105, 1.0, v105
    v_rcp_f32 v105, v105
    s_nop 0
    v_cvt_pk_bf16_f32 v105, v105, v105
    v_lshlrev_b32 v105, 16, v105
    s_nop 0
    v_readfirstlane_b32 s14, v105
    s_add_u32 s12, s15, 1
    v_mov_b32 v104, s12
    v_mov_b32 v106, s23
    v_mov_b32 v14, 162864
    s_mov_b64 exec, 1
    ds_write_b96 v14, v[104:106]
    s_mov_b64 exec, -1
    s_waitcnt lgkmcnt(0)
    s_waitcnt vmcnt(11)
    s_barrier
    s_bfe_u32 s91, s69, 0x40018
    s_lshl_b32 s92, s91, 7
    s_mul_i32 s93, s91, 393216
    s_add_u32 m0, s94, 81920
    s_nop 0
    buffer_load_dwordx4 v20, s[24:27], s92 offen offset:0 lds
    buffer_load_dwordx4 v21, s[24:27], s92 offen offset:1024 lds
    buffer_load_dwordx4 v22, s[24:27], s92 offen offset:2048 lds
    buffer_load_dwordx4 v23, s[24:27], s92 offen offset:3072 lds
    s_add_u32 m0, s95, 81920
    s_nop 0
    buffer_load_dwordx4 v24, s[28:31], s93 offen offset:0 lds
    buffer_load_dwordx4 v25, s[28:31], s93 offen offset:1024 lds
    buffer_load_dwordx4 v26, s[28:31], s93 offen offset:2048 lds
    s_add_u32 m0, s95, 84992
    s_nop 0
    buffer_load_dwordx4 v27, s[28:31], s93 offen offset:0 lds
    buffer_load_dwordx4 v28, s[28:31], s93 offen offset:1024 lds
    buffer_load_dwordx4 v29, s[28:31], s93 offen offset:2048 lds
    s_add_u32 s12, s97, 0
    buffer_load_dwordx4 v[192:195], v31, s[64:67], s12 offen nt
    s_add_u32 s12, s97, 16384
    buffer_load_dwordx4 v[196:199], v31, s[64:67], s12 offen nt
    s_add_u32 s12, s97, 32768
    buffer_load_dwordx4 v[200:203], v31, s[64:67], s12 offen nt
    s_add_u32 s12, s97, 49152
    buffer_load_dwordx4 v[204:207], v31, s[64:67], s12 offen nt
    s_add_u32 s12, s97, 65536
    buffer_load_dwordx4 v[208:211], v31, s[64:67], s12 offen nt
    s_add_u32 s12, s97, 81920
    buffer_load_dwordx4 v[212:215], v31, s[64:67], s12 offen nt
    s_add_u32 s12, s97, 98304
    buffer_load_dwordx4 v[216:219], v31, s[64:67], s12 offen nt
    s_waitcnt vmcnt(17)
    v_and_b32 v40, 0xffff, v36
    v_lshlrev_b32 v41, 16, v36
    v_lshrrev_b32 v42, 16, v36
    v_and_b32 v43, 0xffff0000, v36
    v_and_b32 v44, 0xffff, v37
    v_lshlrev_b32 v45, 16, v37
    v_lshrrev_b32 v46, 16, v37
    v_and_b32 v47, 0xffff0000, v37
    v_and_b32 v48, 0xffff, v38
    v_lshlrev_b32 v49, 16, v38
    v_lshrrev_b32 v50, 16, v38
    v_and_b32 v51, 0xffff0000, v38
    v_and_b32 v52, 0xffff, v39
    v_lshlrev_b32 v53, 16, v39
    v_lshrrev_b32 v54, 16, v39
    v_and_b32 v55, 0xffff0000, v39
    v_dot2_f32_bf16 v220, v128, v40, 0
    v_dot2_f32_bf16 v221, v128, v41, 0
    v_dot2_f32_bf16 v222, v129, v40, 0
    v_dot2_f32_bf16 v223, v129, v41, 0
    v_dot2_f32_bf16 v224, v130, v40, 0
    v_dot2_f32_bf16 v225, v130, v41, 0
    v_dot2_f32_bf16 v226, v131, v40, 0
    v_dot2_f32_bf16 v227, v131, v41, 0
    v_dot2_f32_bf16 v228, v160, v40, 0
    v_dot2_f32_bf16 v229, v160, v41, 0
    v_dot2_f32_bf16 v230, v161, v40, 0
    v_dot2_f32_bf16 v231, v161, v41, 0
    v_dot2_f32_bf16 v232, v162, v40, 0
    v_dot2_f32_bf16 v233, v162, v41, 0
    v_dot2_f32_bf16 v234, v163, v40, 0
    v_dot2_f32_bf16 v235, v163, v41, 0
    v_dot2_f32_bf16 v220, v132, v42, v220
    v_dot2_f32_bf16 v221, v132, v43, v221
    v_dot2_f32_bf16 v222, v133, v42, v222
    v_dot2_f32_bf16 v223, v133, v43, v223
    v_dot2_f32_bf16 v224, v134, v42, v224
    v_dot2_f32_bf16 v225, v134, v43, v225
    v_dot2_f32_bf16 v226, v135, v42, v226
    v_dot2_f32_bf16 v227, v135, v43, v227
    v_dot2_f32_bf16 v228, v164, v42, v228
    v_dot2_f32_bf16 v229, v164, v43, v229
    v_dot2_f32_bf16 v230, v165, v42, v230
    v_dot2_f32_bf16 v231, v165, v43, v231
    v_dot2_f32_bf16 v232, v166, v42, v232
    v_dot2_f32_bf16 v233, v166, v43, v233
    v_dot2_f32_bf16 v234, v167, v42, v234
    v_dot2_f32_bf16 v235, v167, v43, v235
    v_dot2_f32_bf16 v220, v136, v44, v220
    v_dot2_f32_bf16 v221, v136, v45, v221
    v_dot2_f32_bf16 v222, v137, v44, v222
    v_dot2_f32_bf16 v223, v137, v45, v223
    v_dot2_f32_bf16 v224, v138, v44, v224
    v_dot2_f32_bf16 v225, v138, v45, v225
    v_dot2_f32_bf16 v226, v139, v44, v226
    v_dot2_f32_bf16 v227, v139, v45, v227
    v_dot2_f32_bf16 v228, v168, v44, v228
    v_dot2_f32_bf16 v229, v168, v45, v229
    s_barrier
    s_bfe_u32 s91, s69, 0x4001c
    s_lshl_b32 s92, s91, 7
    s_mul_i32 s93, s91, 393216
    s_add_u32 m0, s94, 0
    s_nop 0
    buffer_load_dwordx4 v20, s[24:27], s92 offen offset:0 lds
    buffer_load_dwordx4 v21, s[24:27], s92 offen offset:1024 lds
    buffer_load_dwordx4 v22, s[24:27], s92 offen offset:2048 lds
    buffer_load_dwordx4 v23, s[24:27], s92 offen offset:3072 lds
    s_add_u32 m0, s95, 0
    s_nop 0
    buffer_load_dwordx4 v24, s[28:31], s93 offen offset:0 lds
    v_dot2_f32_bf16 v230, v169, v44, v230
    v_dot2_f32_bf16 v231, v169, v45, v231
    v_dot2_f32_bf16 v232, v170, v44, v232
    v_dot2_f32_bf16 v233, v170, v45, v233
    v_dot2_f32_bf16 v234, v171, v44, v234
    v_dot2_f32_bf16 v235, v171, v45, v235
    v_dot2_f32_bf16 v220, v140, v46, v220
    v_dot2_f32_bf16 v221, v140, v47, v221
    v_dot2_f32_bf16 v222, v141, v46, v222
    v_dot2_f32_bf16 v223, v141, v47, v223
    v_dot2_f32_bf16 v224, v142, v46, v224
    v_dot2_f32_bf16 v225, v142, v47, v225
    v_dot2_f32_bf16 v226, v143, v46, v226
    v_dot2_f32_bf16 v227, v143, v47, v227
    v_dot2_f32_bf16 v228, v172, v46, v228
    v_dot2_f32_bf16 v229, v172, v47, v229
    v_dot2_f32_bf16 v230, v173, v46, v230
    v_dot2_f32_bf16 v231, v173, v47, v231
    v_dot2_f32_bf16 v232, v174, v46, v232
    v_dot2_f32_bf16 v233, v174, v47, v233
    v_dot2_f32_bf16 v234, v175, v46, v234
    v_dot2_f32_bf16 v235, v175, v47, v235
    v_dot2_f32_bf16 v220, v144, v48, v220
    v_dot2_f32_bf16 v221, v144, v49, v221
    v_dot2_f32_bf16 v222, v145, v48, v222
    v_dot2_f32_bf16 v223, v145, v49, v223
    v_dot2_f32_bf16 v224, v146, v48, v224
    v_dot2_f32_bf16 v225, v146, v49, v225
    v_dot2_f32_bf16 v226, v147, v48, v226
    v_dot2_f32_bf16 v227, v147, v49, v227
    v_dot2_f32_bf16 v228, v176, v48, v228
    v_dot2_f32_bf16 v229, v176, v49, v229
    v_dot2_f32_bf16 v230, v177, v48, v230
    v_dot2_f32_bf16 v231, v177, v49, v231
    v_dot2_f32_bf16 v232, v178, v48, v232
    v_dot2_f32_bf16 v233, v178, v49, v233
    v_dot2_f32_bf16 v234, v179, v48, v234
    v_dot2_f32_bf16 v235, v179, v49, v235
    v_dot2_f32_bf16 v220, v148, v50, v220
    v_dot2_f32_bf16 v221, v148, v51, v221
    v_dot2_f32_bf16 v222, v149, v50, v222
    v_dot2_f32_bf16 v223, v149, v51, v223
    v_dot2_f32_bf16 v224, v150, v50, v224
    v_dot2_f32_bf16 v225, v150, v51, v225
    v_dot2_f32_bf16 v226, v151, v50, v226
    v_dot2_f32_bf16 v227, v151, v51, v227
    v_dot2_f32_bf16 v228, v180, v50, v228
    v_dot2_f32_bf16 v229, v180, v51, v229
    v_dot2_f32_bf16 v230, v181, v50, v230
    v_dot2_f32_bf16 v231, v181, v51, v231
    v_dot2_f32_bf16 v232, v182, v50, v232
    v_dot2_f32_bf16 v233, v182, v51, v233
    v_dot2_f32_bf16 v234, v183, v50, v234
    v_dot2_f32_bf16 v235, v183, v51, v235
    v_dot2_f32_bf16 v220, v152, v52, v220
    v_dot2_f32_bf16 v221, v152, v53, v221
    v_dot2_f32_bf16 v222, v153, v52, v222
    v_dot2_f32_bf16 v223, v153, v53, v223
    s_waitcnt vmcnt(12)
    s_barrier
    s_add_u32 m0, s95, 0
    s_nop 0
    buffer_load_dwordx4 v25, s[28:31], s93 offen offset:1024 lds
    buffer_load_dwordx4 v26, s[28:31], s93 offen offset:2048 lds
    s_add_u32 m0, s95, 3072
    s_nop 0
    buffer_load_dwordx4 v27, s[28:31], s93 offen offset:0 lds
    buffer_load_dwordx4 v28, s[28:31], s93 offen offset:1024 lds
    buffer_load_dwordx4 v29, s[28:31], s93 offen offset:2048 lds
    s_mul_i32 s12, s21, 8
    s_add_u32 s12, s12, 96
    s_lshl_b32 s13, s12, 10
    s_lshl_b32 s12, s12, 14
    s_add_u32 m0, s13, 24576
    s_add_u32 s90, s12, 0
    buffer_load_dwordx4 v33, s[36:39], s90 offen lds
    s_add_u32 m0, s13, 25600
    s_add_u32 s90, s12, 16384
    buffer_load_dwordx4 v33, s[36:39], s90 offen lds
    s_add_u32 m0, s13, 26624
    s_add_u32 s90, s12, 32768
    buffer_load_dwordx4 v33, s[36:39], s90 offen lds
    s_add_u32 m0, s13, 27648
    s_add_u32 s90, s12, 49152
    buffer_load_dwordx4 v33, s[36:39], s90 offen lds
    s_add_u32 m0, s13, 28672
    s_add_u32 s90, s12, 65536
    buffer_load_dwordx4 v33, s[36:39], s90 offen lds
    s_add_u32 m0, s13, 29696
    s_add_u32 s90, s12, 81920
    buffer_load_dwordx4 v33, s[36:39], s90 offen lds
    s_add_u32 m0, s13, 30720
    s_add_u32 s90, s12, 98304
    buffer_load_dwordx4 v33, s[36:39], s90 offen lds
    s_add_u32 m0, s13, 31744
    s_add_u32 s90, s12, 114688
    buffer_load_dwordx4 v33, s[36:39], s90 offen lds
    v_dot2_f32_bf16 v224, v154, v52, v224
    v_dot2_f32_bf16 v225, v154, v53, v225
    v_dot2_f32_bf16 v226, v155, v52, v226
    v_dot2_f32_bf16 v227, v155, v53, v227
    v_dot2_f32_bf16 v228, v184, v52, v228
    v_dot2_f32_bf16 v229, v184, v53, v229
    v_dot2_f32_bf16 v230, v185, v52, v230
    v_dot2_f32_bf16 v231, v185, v53, v231
    v_dot2_f32_bf16 v232, v186, v52, v232
    v_dot2_f32_bf16 v233, v186, v53, v233
    v_dot2_f32_bf16 v234, v187, v52, v234
    v_dot2_f32_bf16 v235, v187, v53, v235
    v_dot2_f32_bf16 v220, v156, v54, v220
    v_dot2_f32_bf16 v221, v156, v55, v221
    v_dot2_f32_bf16 v222, v157, v54, v222
    v_dot2_f32_bf16 v223, v157, v55, v223
    v_dot2_f32_bf16 v224, v158, v54, v224
    v_dot2_f32_bf16 v225, v158, v55, v225
    v_dot2_f32_bf16 v226, v159, v54, v226
    v_dot2_f32_bf16 v227, v159, v55, v227
    v_dot2_f32_bf16 v228, v188, v54, v228
    v_dot2_f32_bf16 v229, v188, v55, v229
    v_dot2_f32_bf16 v230, v189, v54, v230
    v_dot2_f32_bf16 v231, v189, v55, v231
    v_dot2_f32_bf16 v232, v190, v54, v232
    v_dot2_f32_bf16 v233, v190, v55, v233
    v_dot2_f32_bf16 v234, v191, v54, v234
    v_dot2_f32_bf16 v235, v191, v55, v235
    v_permlane32_swap_b32 v220, v228
    v_permlane32_swap_b32 v221, v229
    v_permlane32_swap_b32 v222, v230
    v_permlane32_swap_b32 v223, v231
    v_permlane32_swap_b32 v224, v232
    v_permlane32_swap_b32 v225, v233
    v_permlane32_swap_b32 v226, v234
    v_permlane32_swap_b32 v227, v235
    v_add_f32 v220, v220, v228
    v_add_f32 v221, v221, v229
    v_add_f32 v222, v222, v230
    v_add_f32 v223, v223, v231
    v_add_f32 v224, v224, v232
    v_add_f32 v225, v225, v233
    v_add_f32 v226, v226, v234
    v_add_f32 v227, v227, v235
    v_permlane16_swap_b32 v220, v224
    v_permlane16_swap_b32 v221, v225
    v_permlane16_swap_b32 v222, v226
    v_permlane16_swap_b32 v223, v227
    v_add_f32 v220, v220, v224
    v_add_f32 v221, v221, v225
    v_add_f32 v222, v222, v226
    v_add_f32 v223, v223, v227
    v_add_f32_dpp v220, v220, v220 row_ror:8 row_mask:0xf bank_mask:0xf
    v_add_f32_dpp v221, v221, v221 row_ror:8 row_mask:0xf bank_mask:0xf
    v_add_f32_dpp v222, v222, v222 row_ror:8 row_mask:0xf bank_mask:0xf
    v_add_f32_dpp v223, v223, v223 row_ror:8 row_mask:0xf bank_mask:0xf
    s_waitcnt vmcnt(8)
    s_barrier
    s_branch L_varend
L_var3:
    s_nop 0
    s_add_u32 m0, s95, 40960
    s_nop 0
    buffer_load_dwordx4 v26, s[28:31], s93 offen offset:2048 lds
    s_add_u32 m0, s95, 44032
    s_nop 0
    buffer_load_dwordx4 v27, s[28:31], s93 offen offset:0 lds
    buffer_load_dwordx4 v28, s[28:31], s93 offen offset:1024 lds
    buffer_load_dwordx4 v29, s[28:31], s93 offen offset:2048 lds
    s_bfe_u32 s91, s68, 0x40008
    s_lshl_b32 s92, s91, 7
    s_mul_i32 s93, s91, 393216
    s_add_u32 m0, s94, 81920
    s_nop 0
    buffer_load_dwordx4 v20, s[24:27], s92 offen offset:0 lds
    buffer_load_dwordx4 v21, s[24:27], s92 offen offset:1024 lds
    buffer_load_dwordx4 v22, s[24:27], s92 offen offset:2048 lds
    buffer_load_dwordx4 v23, s[24:27], s92 offen offset:3072 lds
    s_add_u32 m0, s95, 81920
    s_nop 0
    buffer_load_dwordx4 v24, s[28:31], s93 offen offset:0 lds
    buffer_load_dwordx4 v25, s[28:31], s93 offen offset:1024 lds
    buffer_load_dwordx4 v26, s[28:31], s93 offen offset:2048 lds
    s_add_u32 m0, s95, 84992
    s_nop 0
    buffer_load_dwordx4 v27, s[28:31], s93 offen offset:0 lds
    buffer_load_dwordx4 v28, s[28:31], s93 offen offset:1024 lds
    buffer_load_dwordx4 v29, s[28:31], s93 offen offset:2048 lds
    s_lshl_b32 s12, s19, 2
    s_add_u32 s12, s12, s21
    s_lshl_b32 s12, s12, 10
    s_lshl_b32 s13, s21, 10
    s_add_u32 m0, s13, 155648
    s_nop 0
    buffer_load_dwordx4 v5, s[76:79], s12 offen lds
    s_lshl_b32 s12, s22, 11
    buffer_load_dwordx4 v[40:43], v5, s[24:27], s12 offen offset:0
    buffer_load_dwordx4 v[44:47], v5, s[24:27], s12 offen offset:1024
    buffer_load_dwordx4 v[48:51], v5, s[24:27], s12 offen offset:2048
    buffer_load_dwordx4 v[52:55], v5, s[24:27], s12 offen offset:3072
    buffer_load_dwordx4 v[56:59], v5, s[80:83], 0 offen offset:0
    buffer_load_dwordx4 v[60:63], v5, s[80:83], 0 offen offset:1024
    buffer_load_dwordx4 v[64:67], v5, s[84:87], 0 offen offset:0
    buffer_load_dwordx4 v[68:71], v5, s[84:87], 0 offen offset:1024
    s_waitcnt vmcnt(19)
    s_barrier
    s_bfe_u32 s91, s68, 0x4000c
    s_lshl_b32 s92, s91, 7
    s_mul_i32 s93, s91, 393216
    s_add_u32 m0, s94, 0
    s_nop 0
    buffer_load_dwordx4 v20, s[24:27], s92 offen offset:0 lds
    buffer_load_dwordx4 v21, s[24:27], s92 offen offset:1024 lds
    buffer_load_dwordx4 v22, s[24:27], s92 offen offset:2048 lds
    buffer_load_dwordx4 v23, s[24:27], s92 offen offset:3072 lds
    s_add_u32 m0, s95, 0
    s_nop 0
    buffer_load_dwordx4 v24, s[28:31], s93 offen offset:0 lds
    buffer_load_dwordx4 v25, s[28:31], s93 offen offset:1024 lds
    buffer_load_dwordx4 v26, s[28:31], s93 offen offset:2048 lds
    s_add_u32 m0, s95, 3072
    s_nop 0
    buffer_load_dwordx4 v27, s[28:31], s93 offen offset:0 lds
    buffer_load_dwordx4 v28, s[28:31], s93 offen offset:1024 lds
    buffer_load_dwordx4 v29, s[28:31], s93 offen offset:2048 lds
    s_cmp_lg_u32 s21, 0
    s_cbranch_scc1 L_noclr_3
    v_mov_b32 v104, -1
    v_mov_b32 v105, -1
    v_mov_b32 v106, -1
    v_mov_b32 v107, -1
    s_lshl_b32 s12, s19, 13
    s_lshl_b32 s13, s18, 9
    s_add_u32 s12, s12, s13
    s_add_u32 s12, s12, 32768
    s_lshl_b32 s13, s19, 11
    s_lshl_b32 s90, s18, 7
    s_add_u32 s13, s13, s90
    s_add_u32 s13, s13, 163840
    s_mov_b32 exec_hi, 0
    buffer_store_dwordx4 v[104:107], v5, s[32:35], s12 offen sc1
    s_mov_b32 exec_lo, 255
    buffer_store_dwordx4 v[104:107], v5, s[32:35], s13 offen sc1
    s_mov_b64 exec, -1
L_noclr_3:
    s_waitcnt vmcnt(10)
    v_lshlrev_b32 v72, 16, v64
    v_and_b32 v73, 0xffff0000, v64
    v_lshlrev_b32 v74, 16, v65
    v_and_b32 v75, 0xffff0000, v65
    v_lshlrev_b32 v76, 16, v66
    v_and_b32 v77, 0xffff0000, v66
    v_lshlrev_b32 v78, 16, v67
    v_and_b32 v79, 0xffff0000, v67
    v_lshlrev_b32 v80, 16, v68
    v_and_b32 v81, 0xffff0000, v68
    v_lshlrev_b32 v82, 16, v69
    v_and_b32 v83, 0xffff0000, v69
    v_lshlrev_b32 v84, 16, v70
    v_and_b32 v85, 0xffff0000, v70
    v_lshlrev_b32 v86, 16, v71
    v_and_b32 v87, 0xffff0000, v71
    v_mov_b32 v90, 0
    v_mov_b32 v91, 0
    v_dot2_f32_bf16 v90, v40, v56, v90
    v_lshlrev_b32 v94, 16, v40
    v_and_b32 v95, 0xffff0000, v40
    v_mul_f32 v94, v94, v72
    v_mul_f32 v95, v95, v73
    v_cvt_pk_bf16_f32 v94, v94, v95
    v_lshlrev_b32 v95, 16, v94
    v_and_b32 v94, 0xffff0000, v94
    v_add_f32 v91, v91, v95
    v_add_f32 v91, v91, v94
    v_dot2_f32_bf16 v90, v41, v57, v90
    v_lshlrev_b32 v94, 16, v41
    v_and_b32 v95, 0xffff0000, v41
    v_mul_f32 v94, v94, v74
    v_mul_f32 v95, v95, v75
    v_cvt_pk_bf16_f32 v94, v94, v95
    v_lshlrev_b32 v95, 16, v94
    v_and_b32 v94, 0xffff0000, v94
    v_add_f32 v91, v91, v95
    v_add_f32 v91, v91, v94
    v_dot2_f32_bf16 v90, v42, v58, v90
    v_lshlrev_b32 v94, 16, v42
    v_and_b32 v95, 0xffff0000, v42
    v_mul_f32 v94, v94, v76
    v_mul_f32 v95, v95, v77
    v_cvt_pk_bf16_f32 v94, v94, v95
    v_lshlrev_b32 v95, 16, v94
    v_and_b32 v94, 0xffff0000, v94
    v_add_f32 v91, v91, v95
    v_add_f32 v91, v91, v94
    v_dot2_f32_bf16 v90, v43, v59, v90
    v_lshlrev_b32 v94, 16, v43
    v_and_b32 v95, 0xffff0000, v43
    v_mul_f32 v94, v94, v78
    v_mul_f32 v95, v95, v79
    v_cvt_pk_bf16_f32 v94, v94, v95
    v_lshlrev_b32 v95, 16, v94
    v_and_b32 v94, 0xffff0000, v94
    v_add_f32 v91, v91, v95
    v_add_f32 v91, v91, v94
    v_dot2_f32_bf16 v90, v44, v60, v90
    v_lshlrev_b32 v94, 16, v44
    v_and_b32 v95, 0xffff0000, v44
    v_mul_f32 v94, v94, v80
    v_mul_f32 v95, v95, v81
    v_cvt_pk_bf16_f32 v94, v94, v95
    v_lshlrev_b32 v95, 16, v94
    v_and_b32 v94, 0xffff0000, v94
    v_add_f32 v91, v91, v95
    v_add_f32 v91, v91, v94
    v_dot2_f32_bf16 v90, v45, v61, v90
    v_lshlrev_b32 v94, 16, v45
    v_and_b32 v95, 0xffff0000, v45
    v_mul_f32 v94, v94, v82
    v_mul_f32 v95, v95, v83
    v_cvt_pk_bf16_f32 v94, v94, v95
    v_lshlrev_b32 v95, 16, v94
    v_and_b32 v94, 0xffff0000, v94
    v_add_f32 v91, v91, v95
    v_add_f32 v91, v91, v94
    v_dot2_f32_bf16 v90, v46, v62, v90
    v_lshlrev_b32 v94, 16, v46
    v_and_b32 v95, 0xffff0000, v46
    v_mul_f32 v94, v94, v84
    v_mul_f32 v95, v95, v85
    v_cvt_pk_bf16_f32 v94, v94, v95
    v_lshlrev_b32 v95, 16, v94
    v_and_b32 v94, 0xffff0000, v94
    v_add_f32 v91, v91, v95
    v_add_f32 v91, v91, v94
    v_dot2_f32_bf16 v90, v47, v63, v90
    v_lshlrev_b32 v94, 16, v47
    v_and_b32 v95, 0xffff0000, v47
    v_mul_f32 v94, v94, v86
    v_mul_f32 v95, v95, v87
    v_cvt_pk_bf16_f32 v94, v94, v95
    v_lshlrev_b32 v95, 16, v94
    v_and_b32 v94, 0xffff0000, v94
    v_add_f32 v91, v91, v95
    v_add_f32 v91, v91, v94
    v_mov_b32 v92, 0
    v_mov_b32 v93, 0
    v_dot2_f32_bf16 v92, v48, v56, v92
    v_lshlrev_b32 v94, 16, v48
    v_and_b32 v95, 0xffff0000, v48
    v_mul_f32 v94, v94, v72
    v_mul_f32 v95, v95, v73
    v_cvt_pk_bf16_f32 v94, v94, v95
    v_lshlrev_b32 v95, 16, v94
    v_and_b32 v94, 0xffff0000, v94
    v_add_f32 v93, v93, v95
    v_add_f32 v93, v93, v94
    v_dot2_f32_bf16 v92, v49, v57, v92
    v_lshlrev_b32 v94, 16, v49
    v_and_b32 v95, 0xffff0000, v49
    v_mul_f32 v94, v94, v74
    v_mul_f32 v95, v95, v75
    v_cvt_pk_bf16_f32 v94, v94, v95
    v_lshlrev_b32 v95, 16, v94
    v_and_b32 v94, 0xffff0000, v94
    v_add_f32 v93, v93, v95
    v_add_f32 v93, v93, v94
    v_dot2_f32_bf16 v92, v50, v58, v92
    s_barrier
    s_bfe_u32 s91, s68, 0x40010
    s_lshl_b32 s92, s91, 7
    s_mul_i32 s93, s91, 393216
    s_add_u32 m0, s94, 40960
    s_nop 0
    buffer_load_dwordx4 v20, s[24:27], s92 offen offset:0 lds
    buffer_load_dwordx4 v21, s[24:27], s92 offen offset:1024 lds
    buffer_load_dwordx4 v22, s[24:27], s92 offen offset:2048 lds
    buffer_load_dwordx4 v23, s[24:27], s92 offen offset:3072 lds
    s_add_u32 m0, s95, 40960
    s_nop 0
    buffer_load_dwordx4 v24, s[28:31], s93 offen offset:0 lds
    buffer_load_dwordx4 v25, s[28:31], s93 offen offset:1024 lds
    buffer_load_dwordx4 v26, s[28:31], s93 offen offset:2048 lds
    s_add_u32 m0, s95, 44032
    s_nop 0
    buffer_load_dwordx4 v27, s[28:31], s93 offen offset:0 lds
    buffer_load_dwordx4 v28, s[28:31], s93 offen offset:1024 lds
    buffer_load_dwordx4 v29, s[28:31], s93 offen offset:2048 lds
    v_lshlrev_b32 v94, 16, v50
    v_and_b32 v95, 0xffff0000, v50
    v_mul_f32 v94, v94, v76
    v_mul_f32 v95, v95, v77
    v_cvt_pk_bf16_f32 v94, v94, v95
    v_lshlrev_b32 v95, 16, v94
    v_and_b32 v94, 0xffff0000, v94
    v_add_f32 v93, v93, v95
    v_add_f32 v93, v93, v94
    v_dot2_f32_bf16 v92, v51, v59, v92
    v_lshlrev_b32 v94, 16, v51
    v_and_b32 v95, 0xffff0000, v51
    v_mul_f32 v94, v94, v78
    v_mul_f32 v95, v95, v79
    v_cvt_pk_bf16_f32 v94, v94, v95
    v_lshlrev_b32 v95, 16, v94
    v_and_b32 v94, 0xffff0000, v94
    v_add_f32 v93, v93, v95
    v_add_f32 v93, v93, v94
    v_dot2_f32_bf16 v92, v52, v60, v92
    v_lshlrev_b32 v94, 16, v52
    v_and_b32 v95, 0xffff0000, v52
    v_mul_f32 v94, v94, v80
    v_mul_f32 v95, v95, v81
    v_cvt_pk_bf16_f32 v94, v94, v95
    v_lshlrev_b32 v95, 16, v94
    v_and_b32 v94, 0xffff0000, v94
    v_add_f32 v93, v93, v95
    v_add_f32 v93, v93, v94
    v_dot2_f32_bf16 v92, v53, v61, v92
    v_lshlrev_b32 v94, 16, v53
    v_and_b32 v95, 0xffff0000, v53
    v_mul_f32 v94, v94, v82
    v_mul_f32 v95, v95, v83
    v_cvt_pk_bf16_f32 v94, v94, v95
    v_lshlrev_b32 v95, 16, v94
    v_and_b32 v94, 0xffff0000, v94
    v_add_f32 v93, v93, v95
    v_add_f32 v93, v93, v94
    v_dot2_f32_bf16 v92, v54, v62, v92
    v_lshlrev_b32 v94, 16, v54
    v_and_b32 v95, 0xffff0000, v54
    v_mul_f32 v94, v94, v84
    v_mul_f32 v95, v95, v85
    v_cvt_pk_bf16_f32 v94, v94, v95
    v_lshlrev_b32 v95, 16, v94
    v_and_b32 v94, 0xffff0000, v94
    v_add_f32 v93, v93, v95
    v_add_f32 v93, v93, v94
    v_dot2_f32_bf16 v92, v55, v63, v92
    v_lshlrev_b32 v94, 16, v55
    v_and_b32 v95, 0xffff0000, v55
    v_mul_f32 v94, v94, v86
    v_mul_f32 v95, v95, v87
    v_cvt_pk_bf16_f32 v94, v94, v95
    v_lshlrev_b32 v95, 16, v94
    v_and_b32 v94, 0xffff0000, v94
    v_add_f32 v93, v93, v95
    v_add_f32 v93, v93, v94
    v_add_f32_dpp v90, v90, v90 row_shr:1 row_mask:0xf bank_mask:0xf
    v_add_f32_dpp v91, v91, v91 row_shr:1 row_mask:0xf bank_mask:0xf
    v_add_f32_dpp v92, v92, v92 row_shr:1 row_mask:0xf bank_mask:0xf
    v_add_f32_dpp v93, v93, v93 row_shr:1 row_mask:0xf bank_mask:0xf
    v_add_f32_dpp v90, v90, v90 row_shr:2 row_mask:0xf bank_mask:0xf
    v_add_f32_dpp v91, v91, v91 row_shr:2 row_mask:0xf bank_mask:0xf
    v_add_f32_dpp v92, v92, v92 row_shr:2 row_mask:0xf bank_mask:0xf
    v_add_f32_dpp v93, v93, v93 row_shr:2 row_mask:0xf bank_mask:0xf
    v_add_f32_dpp v90, v90, v90 row_shr:4 row_mask:0xf bank_mask:0xf
    v_add_f32_dpp v91, v91, v91 row_shr:4 row_mask:0xf bank_mask:0xf
    v_add_f32_dpp v92, v92, v92 row_shr:4 row_mask:0xf bank_mask:0xf
    v_add_f32_dpp v93, v93, v93 row_shr:4 row_mask:0xf bank_mask:0xf
    v_add_f32_dpp v90, v90, v90 row_shr:8 row_mask:0xf bank_mask:0xf
    v_add_f32_dpp v91, v91, v91 row_shr:8 row_mask:0xf bank_mask:0xf
    v_add_f32_dpp v92, v92, v92 row_shr:8 row_mask:0xf bank_mask:0xf
    v_add_f32_dpp v93, v93, v93 row_shr:8 row_mask:0xf bank_mask:0xf
    v_add_f32_dpp v90, v90, v90 row_bcast:15 row_mask:0xa bank_mask:0xf
    v_add_f32_dpp v91, v91, v91 row_bcast:15 row_mask:0xa bank_mask:0xf
    v_add_f32_dpp v92, v92, v92 row_bcast:15 row_mask:0xa bank_mask:0xf
    v_add_f32_dpp v93, v93, v93 row_bcast:15 row_mask:0xa bank_mask:0xf
    v_add_f32_dpp v90, v90, v90 row_bcast:31 row_mask:0xc bank_mask:0xf
    v_add_f32_dpp v91, v91, v91 row_bcast:31 row_mask:0xc bank_mask:0xf
    v_add_f32_dpp v92, v92, v92 row_bcast:31 row_mask:0xc bank_mask:0xf
    v_add_f32_dpp v93, v93, v93 row_bcast:31 row_mask:0xc bank_mask:0xf
    v_cvt_pk_bf16_f32 v94, v90, v91
    v_and_b32 v95, 0xffff, v94
    v_and_b32 v96, 0x8000, v94
    v_cmp_ne_u32 vcc, 0, v96
    v_mov_b32 v97, 0x8000
    v_mov_b32 v98, 0xffff
    v_cndmask_b32 v96, v97, v98, vcc
    v_xor_b32 v95, v95, v96
    s_sub_u32 s12, 2047, s22
    v_lshlrev_b32 v95, 11, v95
    v_or_b32 v100, s12, v95
    v_and_b32 v94, 0xffff0000, v94
    v_mul_f32 v94, 0xbfb8aa3b, v94
    v_exp_f32 v94, v94
    s_nop 0
    v_add_f32 v94, 1.0, v94
    v_rcp_f32 v94, v94
    s_nop 0
    v_cvt_pk_bf16_f32 v94, v94, v94
    v_lshlrev_b32 v102, 16, v94
    v_cvt_pk_bf16_f32 v94, v92, v93
    v_and_b32 v95, 0xffff, v94
    v_and_b32 v96, 0x8000, v94
    v_cmp_ne_u32 vcc, 0, v96
    v_mov_b32 v97, 0x8000
    v_mov_b32 v98, 0xffff
    v_cndmask_b32 v96, v97, v98, vcc
    v_xor_b32 v95, v95, v96
    s_sub_u32 s12, 2046, s22
    v_lshlrev_b32 v95, 11, v95
    v_or_b32 v101, s12, v95
    v_and_b32 v94, 0xffff0000, v94
    v_mul_f32 v94, 0xbfb8aa3b, v94
    v_exp_f32 v94, v94
    s_nop 0
    v_add_f32 v94, 1.0, v94
    v_rcp_f32 v94, v94
    s_nop 0
    v_cvt_pk_bf16_f32 v94, v94, v94
    v_lshlrev_b32 v103, 16, v94
    v_max_u32 v100, v100, v101
    s_lshl_b32 s12, s22, 2
    s_add_u32 s12, s12, 4096
    s_lshl_b32 s13, s21, 2
    s_add_u32 s13, s13, 162880
    v_mov_b32 v14, s13
    s_mov_b32 exec_lo, 0
    s_mov_b32 exec_hi, 0x80000000
    buffer_store_dwordx2 v[102:103], v13, s[32:35], s12 offen sc1
    ds_write_b32 v14, v100
    s_mov_b64 exec, -1
    s_waitcnt lgkmcnt(0)
    buffer_load_dword v15, v13, s[72:75], 0 offen offset:4 sc1
    s_waitcnt vmcnt(12)
    s_barrier
    s_bfe_u32 s91, s68, 0x40014
    s_lshl_b32 s92, s91, 7
    s_mul_i32 s93, s91, 393216
    s_add_u32 m0, s94, 81920
    s_nop 0
    buffer_load_dwordx4 v20, s[24:27], s92 offen offset:0 lds
    buffer_load_dwordx4 v21, s[24:27], s92 offen offset:1024 lds
    buffer_load_dwordx4 v22, s[24:27], s92 offen offset:2048 lds
    buffer_load_dwordx4 v23, s[24:27], s92 offen offset:3072 lds
    s_add_u32 m0, s95, 81920
    s_nop 0
    buffer_load_dwordx4 v24, s[28:31], s93 offen offset:0 lds
    buffer_load_dwordx4 v25, s[28:31], s93 offen offset:1024 lds
    buffer_load_dwordx4 v26, s[28:31], s93 offen offset:2048 lds
    s_add_u32 m0, s95, 84992
    s_nop 0
    buffer_load_dwordx4 v27, s[28:31], s93 offen offset:0 lds
    buffer_load_dwordx4 v28, s[28:31], s93 offen offset:1024 lds
    buffer_load_dwordx4 v29, s[28:31], s93 offen offset:2048 lds
    s_cmp_ge_u32 s10, 224
    s_cbranch_scc1 L_p30_3
    s_add_u32 s12, s71, 0
    buffer_load_dwordx4 v[128:131], v30, s[40:43], s12 offen nt
    s_add_u32 s12, s71, 7168
    buffer_load_dwordx4 v[132:135], v30, s[40:43], s12 offen nt
    s_add_u32 s12, s71, 14336
    buffer_load_dwordx4 v[136:139], v30, s[40:43], s12 offen nt
    s_add_u32 s12, s71, 21504
    buffer_load_dwordx4 v[140:143], v30, s[40:43], s12 offen nt
    s_add_u32 s12, s71, 28672
    buffer_load_dwordx4 v[144:147], v30, s[40:43], s12 offen nt
    s_add_u32 s12, s71, 35840
    buffer_load_dwordx4 v[148:151], v30, s[40:43], s12 offen nt
    s_add_u32 s12, s71, 43008
    buffer_load_dwordx4 v[152:155], v30, s[40:43], s12 offen nt
    s_add_u32 s12, s71, 50176
    buffer_load_dwordx4 v[156:159], v30, s[40:43], s12 offen nt
    s_branch L_p3e0_3
L_p30_3:
    s_mov_b64 exec, 63
    s_bfe_u32 s12, s68, 0x4000c
    s_mul_i32 s12, s12, 393216
    buffer_load_dword v128, v32, s[28:31], s12 offen
    s_bfe_u32 s12, s68, 0x40010
    s_mul_i32 s12, s12, 393216
    buffer_load_dword v132, v32, s[28:31], s12 offen
    s_bfe_u32 s12, s68, 0x40014
    s_mul_i32 s12, s12, 393216
    buffer_load_dword v136, v32, s[28:31], s12 offen
    s_bfe_u32 s12, s68, 0x40018
    s_mul_i32 s12, s12, 393216
    buffer_load_dword v140, v32, s[28:31], s12 offen
    s_bfe_u32 s12, s68, 0x4001c
    s_mul_i32 s12, s12, 393216
    buffer_load_dword v144, v32, s[28:31], s12 offen
    s_bfe_u32 s12, s69, 0x40000
    s_mul_i32 s12, s12, 393216
    buffer_load_dword v148, v32, s[28:31], s12 offen
    s_bfe_u32 s12, s69, 0x40004
    s_mul_i32 s12, s12, 393216
    buffer_load_dword v152, v32, s[28:31], s12 offen
    s_bfe_u32 s12, s69, 0x40008
    s_mul_i32 s12, s12, 393216
    buffer_load_dword v156, v32, s[28:31], s12 offen
    s_mov_b64 exec, -1
L_p3e0_3:
    s_waitcnt vmcnt(20)
    s_barrier
    s_bfe_u32 s91, s68, 0x40018
    s_lshl_b32 s92, s91, 7
    s_mul_i32 s93, s91, 393216
    s_add_u32 m0, s94, 0
    s_nop 0
    buffer_load_dwordx4 v20, s[24:27], s92 offen offset:0 lds
    buffer_load_dwordx4 v21, s[24:27], s92 offen offset:1024 lds
    buffer_load_dwordx4 v22, s[24:27], s92 offen offset:2048 lds
    buffer_load_dwordx4 v23, s[24:27], s92 offen offset:3072 lds
    s_add_u32 m0, s95, 0
    s_nop 0
    buffer_load_dwordx4 v24, s[28:31], s93 offen offset:0 lds
    s_waitcnt vmcnt(23)
    s_mov_b32 s13, 0
L_tagchk_3:
    v_readfirstlane_b32 s23, v15
    s_nop 1
    s_cmp_lg_u32 s23, 0
    s_cbranch_scc1 L_tagok_3
    s_add_u32 s13, s13, 1
    s_cmp_ge_u32 s13, 16384
    s_cbranch_scc1 L_tagok_3
    buffer_load_dword v15, v13, s[72:75], 0 offen offset:4 sc1
    s_waitcnt vmcnt(0)
    s_branch L_tagchk_3
L_tagok_3:
    s_and_b32 s76, s23, 0xff
    s_bfe_u32 s77, s23, 0x80008
    s_bfe_u32 s78, s23, 0x80010
    s_lshr_b32 s79, s23, 24
    v_and_b32 v35, 3, v2
    v_lshlrev_b32 v35, 3, v35
    v_bfe_u32 v35, s23, v35, 8
    s_cmp_lg_u32 s21, 0
    s_cbranch_scc1 L_nopub_3
    v_mov_b32 v14, 162880
    ds_read_b128 v[104:107], v14
    s_lshl_b32 s12, s2, 3
    s_add_u32 s12, s12, 0
    s_waitcnt lgkmcnt(0)
    v_max3_u32 v104, v104, v105, v106
    v_max_u32 v104, v104, v107
    v_mov_b32 v105, s23
    s_mov_b64 exec, 1
    buffer_store_dwordx2 v[104:105], v13, s[32:35], s12 offen sc1
    s_mov_b64 exec, -1
L_nopub_3:
    s_waitcnt vmcnt(13)
    s_barrier
    s_add_u32 m0, s95, 0
    s_nop 0
    buffer_load_dwordx4 v25, s[28:31], s93 offen offset:1024 lds
    buffer_load_dwordx4 v26, s[28:31], s93 offen offset:2048 lds
    s_add_u32 m0, s95, 3072
    s_nop 0
    buffer_load_dwordx4 v27, s[28:31], s93 offen offset:0 lds
    buffer_load_dwordx4 v28, s[28:31], s93 offen offset:1024 lds
    buffer_load_dwordx4 v29, s[28:31], s93 offen offset:2048 lds
    s_bfe_u32 s91, s68, 0x4001c
    s_lshl_b32 s92, s91, 7
    s_mul_i32 s93, s91, 393216
    s_add_u32 m0, s94, 40960
    s_nop 0
    buffer_load_dwordx4 v20, s[24:27], s92 offen offset:0 lds
    buffer_load_dwordx4 v21, s[24:27], s92 offen offset:1024 lds
    buffer_load_dwordx4 v22, s[24:27], s92 offen offset:2048 lds
    buffer_load_dwordx4 v23, s[24:27], s92 offen offset:3072 lds
    s_add_u32 m0, s95, 40960
    s_nop 0
    buffer_load_dwordx4 v24, s[28:31], s93 offen offset:0 lds
    buffer_load_dwordx4 v25, s[28:31], s93 offen offset:1024 lds
    buffer_load_dwordx4 v26, s[28:31], s93 offen offset:2048 lds
    s_waitcnt vmcnt(7)
    s_barrier
    s_add_u32 m0, s95, 44032
    s_nop 0
    buffer_load_dwordx4 v27, s[28:31], s93 offen offset:0 lds
    buffer_load_dwordx4 v28, s[28:31], s93 offen offset:1024 lds
    buffer_load_dwordx4 v29, s[28:31], s93 offen offset:2048 lds
    s_bfe_u32 s91, s69, 0x40000
    s_lshl_b32 s92, s91, 7
    s_mul_i32 s93, s91, 393216
    s_add_u32 m0, s94, 81920
    s_nop 0
    buffer_load_dwordx4 v20, s[24:27], s92 offen offset:0 lds
    buffer_load_dwordx4 v21, s[24:27], s92 offen offset:1024 lds
    buffer_load_dwordx4 v22, s[24:27], s92 offen offset:2048 lds
    buffer_load_dwordx4 v23, s[24:27], s92 offen offset:3072 lds
    s_add_u32 m0, s95, 81920
    s_nop 0
    buffer_load_dwordx4 v24, s[28:31], s93 offen offset:0 lds
    buffer_load_dwordx4 v25, s[28:31], s93 offen offset:1024 lds
    buffer_load_dwordx4 v26, s[28:31], s93 offen offset:2048 lds
    s_add_u32 m0, s95, 84992
    s_nop 0
    buffer_load_dwordx4 v27, s[28:31], s93 offen offset:0 lds
    buffer_load_dwordx4 v28, s[28:31], s93 offen offset:1024 lds
    s_waitcnt vmcnt(9)
    s_barrier
    s_add_u32 m0, s95, 84992
    s_nop 0
    buffer_load_dwordx4 v29, s[28:31], s93 offen offset:2048 lds
    s_bfe_u32 s91, s69, 0x40004
    s_lshl_b32 s92, s91, 7
    s_mul_i32 s93, s91, 393216
    s_add_u32 m0, s94, 0
    s_nop 0
    buffer_load_dwordx4 v20, s[24:27], s92 offen offset:0 lds
    buffer_load_dwordx4 v21, s[24:27], s92 offen offset:1024 lds
    buffer_load_dwordx4 v22, s[24:27], s92 offen offset:2048 lds
    buffer_load_dwordx4 v23, s[24:27], s92 offen offset:3072 lds
    s_add_u32 m0, s95, 0
    s_nop 0
    buffer_load_dwordx4 v24, s[28:31], s93 offen offset:0 lds
    buffer_load_dwordx4 v25, s[28:31], s93 offen offset:1024 lds
    buffer_load_dwordx4 v26, s[28:31], s93 offen offset:2048 lds
    s_add_u32 m0, s95, 3072
    s_nop 0
    buffer_load_dwordx4 v27, s[28:31], s93 offen offset:0 lds
    buffer_load_dwordx4 v28, s[28:31], s93 offen offset:1024 lds
    buffer_load_dwordx4 v29, s[28:31], s93 offen offset:2048 lds
    s_waitcnt vmcnt(10)
    s_barrier
    s_bfe_u32 s91, s69, 0x40008
    s_lshl_b32 s92, s91, 7
    s_mul_i32 s93, s91, 393216
    s_add_u32 m0, s94, 40960
    s_nop 0
    buffer_load_dwordx4 v20, s[24:27], s92 offen offset:0 lds
    buffer_load_dwordx4 v21, s[24:27], s92 offen offset:1024 lds
    buffer_load_dwordx4 v22, s[24:27], s92 offen offset:2048 lds
    buffer_load_dwordx4 v23, s[24:27], s92 offen offset:3072 lds
    s_add_u32 m0, s95, 40960
    s_nop 0
    buffer_load_dwordx4 v24, s[28:31], s93 offen offset:0 lds
    buffer_load_dwordx4 v25, s[28:31], s93 offen offset:1024 lds
    buffer_load_dwordx4 v26, s[28:31], s93 offen offset:2048 lds
    s_add_u32 m0, s95, 44032
    s_nop 0
    buffer_load_dwordx4 v27, s[28:31], s93 offen offset:0 lds
    buffer_load_dwordx4 v28, s[28:31], s93 offen offset:1024 lds
    buffer_load_dwordx4 v29, s[28:31], s93 offen offset:2048 lds
    s_cmp_ge_u32 s10, 224
    s_cbranch_scc1 L_p31_3
    s_add_u32 s12, s9, 0
    buffer_load_dwordx4 v[160:163], v30, s[44:47], s12 offen nt
    s_add_u32 s12, s9, 7168
    buffer_load_dwordx4 v[164:167], v30, s[44:47], s12 offen nt
    s_add_u32 s12, s9, 14336
    buffer_load_dwordx4 v[168:171], v30, s[44:47], s12 offen nt
    s_add_u32 s12, s9, 21504
    buffer_load_dwordx4 v[172:175], v30, s[44:47], s12 offen nt
    s_add_u32 s12, s9, 28672
    buffer_load_dwordx4 v[176:179], v30, s[44:47], s12 offen nt
    s_add_u32 s12, s9, 35840
    buffer_load_dwordx4 v[180:183], v30, s[44:47], s12 offen nt
    s_add_u32 s12, s9, 43008
    buffer_load_dwordx4 v[184:187], v30, s[44:47], s12 offen nt
    s_add_u32 s12, s9, 50176
    buffer_load_dwordx4 v[188:191], v30, s[44:47], s12 offen nt
    s_branch L_p3e1_3
L_p31_3:
    s_mov_b64 exec, 63
    s_bfe_u32 s12, s69, 0x4000c
    s_mul_i32 s12, s12, 393216
    buffer_load_dword v160, v32, s[28:31], s12 offen
    s_bfe_u32 s12, s69, 0x40010
    s_mul_i32 s12, s12, 393216
    buffer_load_dword v164, v32, s[28:31], s12 offen
    s_bfe_u32 s12, s69, 0x40014
    s_mul_i32 s12, s12, 393216
    buffer_load_dword v168, v32, s[28:31], s12 offen
    s_bfe_u32 s12, s69, 0x40018
    s_mul_i32 s12, s12, 393216
    buffer_load_dword v172, v32, s[28:31], s12 offen
    s_bfe_u32 s12, s69, 0x4001c
    s_mul_i32 s12, s12, 393216
    buffer_load_dword v176, v32, s[28:31], s12 offen
    s_mov_b64 exec, 1
    s_bfe_u32 s12, s69, 0x4001c
    s_mul_i32 s12, s12, 393216
    buffer_load_dword v180, v32, s[28:31], s12 offen
    s_bfe_u32 s12, s69, 0x4001c
    s_mul_i32 s12, s12, 393216
    buffer_load_dword v184, v32, s[28:31], s12 offen
    s_bfe_u32 s12, s69, 0x4001c
    s_mul_i32 s12, s12, 393216
    buffer_load_dword v188, v32, s[28:31], s12 offen
    s_mov_b64 exec, -1
L_p3e1_3:
    s_mov_b32 exec_lo, 0xffff0000
    s_mov_b32 exec_hi, 0
    buffer_load_dword v19, v10, s[36:39], 0 offen
    s_mov_b64 exec, -1
    s_waitcnt vmcnt(19)
    s_barrier
    s_bfe_u32 s91, s69, 0x4000c
    s_lshl_b32 s92, s91, 7
    s_mul_i32 s93, s91, 393216
    s_add_u32 m0, s94, 81920
    s_nop 0
    buffer_load_dwordx4 v20, s[24:27], s92 offen offset:0 lds
    buffer_load_dwordx4 v21, s[24:27], s92 offen offset:1024 lds
    buffer_load_dwordx4 v22, s[24:27], s92 offen offset:2048 lds
    buffer_load_dwordx4 v23, s[24:27], s92 offen offset:3072 lds
    s_add_u32 m0, s95, 81920
    s_nop 0
    buffer_load_dwordx4 v24, s[28:31], s93 offen offset:0 lds
    s_mov_b32 s12, 0
    buffer_load_dwordx4 v[104:107], v5, s[32:35], s12 offen offset:0 sc1
    buffer_load_dwordx4 v[108:111], v5, s[32:35], s12 offen offset:1024 sc1
    s_waitcnt vmcnt(16)
    s_barrier
    s_add_u32 m0, s95, 81920
    s_nop 0
    buffer_load_dwordx4 v25, s[28:31], s93 offen offset:1024 lds
    buffer_load_dwordx4 v26, s[28:31], s93 offen offset:2048 lds
    s_add_u32 m0, s95, 84992
    s_nop 0
    buffer_load_dwordx4 v27, s[28:31], s93 offen offset:0 lds
    buffer_load_dwordx4 v28, s[28:31], s93 offen offset:1024 lds
    buffer_load_dwordx4 v29, s[28:31], s93 offen offset:2048 lds
    s_bfe_u32 s91, s69, 0x40010
    s_lshl_b32 s92, s91, 7
    s_mul_i32 s93, s91, 393216
    s_add_u32 m0, s94, 0
    s_nop 0
    buffer_load_dwordx4 v20, s[24:27], s92 offen offset:0 lds
    buffer_load_dwordx4 v21, s[24:27], s92 offen offset:1024 lds
    buffer_load_dwordx4 v22, s[24:27], s92 offen offset:2048 lds
    buffer_load_dwordx4 v23, s[24:27], s92 offen offset:3072 lds
    s_add_u32 m0, s95, 0
    s_nop 0
    buffer_load_dwordx4 v24, s[28:31], s93 offen offset:0 lds
    buffer_load_dwordx4 v25, s[28:31], s93 offen offset:1024 lds
    buffer_load_dwordx4 v26, s[28:31], s93 offen offset:2048 lds
    s_waitcnt vmcnt(7)
    s_barrier
    s_add_u32 m0, s95, 3072
    s_nop 0
    buffer_load_dwordx4 v27, s[28:31], s93 offen offset:0 lds
    buffer_load_dwordx4 v28, s[28:31], s93 offen offset:1024 lds
    buffer_load_dwordx4 v29, s[28:31], s93 offen offset:2048 lds
    s_bfe_u32 s91, s69, 0x40014
    s_lshl_b32 s92, s91, 7
    s_mul_i32 s93, s91, 393216
    s_add_u32 m0, s94, 40960
    s_nop 0
    buffer_load_dwordx4 v20, s[24:27], s92 offen offset:0 lds
    buffer_load_dwordx4 v21, s[24:27], s92 offen offset:1024 lds
    buffer_load_dwordx4 v22, s[24:27], s92 offen offset:2048 lds
    buffer_load_dwordx4 v23, s[24:27], s92 offen offset:3072 lds
    s_add_u32 m0, s95, 40960
    s_nop 0
    buffer_load_dwordx4 v24, s[28:31], s93 offen offset:0 lds
    buffer_load_dwordx4 v25, s[28:31], s93 offen offset:1024 lds
    buffer_load_dwordx4 v26, s[28:31], s93 offen offset:2048 lds
    s_add_u32 m0, s95, 44032
    s_nop 0
    buffer_load_dwordx4 v27, s[28:31], s93 offen offset:0 lds
    buffer_load_dwordx4 v28, s[28:31], s93 offen offset:1024 lds
    s_mov_b32 s13, 0
L_keychk_3:
    v_xor_b32 v105, s23, v105
    v_xor_b32 v107, s23, v107
    v_xor_b32 v109, s23, v109
    v_xor_b32 v111, s23, v111
    v_or3_b32 v105, v105, v107, v109
    v_or_b32 v105, v105, v111
    v_cmp_ne_u32 vcc, 0, v105
    s_cbranch_vccz L_keyok_3
    s_add_u32 s13, s13, 1
    s_cmp_ge_u32 s13, 16384
    s_cbranch_scc1 L_keyok_3
    s_mov_b32 s12, 0
    buffer_load_dwordx4 v[104:107], v5, s[32:35], s12 offen offset:0 sc1
    buffer_load_dwordx4 v[108:111], v5, s[32:35], s12 offen offset:1024 sc1
    s_waitcnt vmcnt(0)
    s_branch L_keychk_3
L_keyok_3:
    v_max3_u32 v104, v104, v106, v108
    v_max_u32 v104, v104, v110
    s_nop 1
    v_max_u32_dpp v104, v104, v104 row_shr:1 row_mask:0xf bank_mask:0xf
    s_nop 1
    v_max_u32_dpp v104, v104, v104 row_shr:2 row_mask:0xf bank_mask:0xf
    s_nop 1
    v_max_u32_dpp v104, v104, v104 row_shr:4 row_mask:0xf bank_mask:0xf
    s_nop 1
    v_max_u32_dpp v104, v104, v104 row_shr:8 row_mask:0xf bank_mask:0xf
    s_nop 1
    v_max_u32_dpp v104, v104, v104 row_bcast:15 row_mask:0xa bank_mask:0xf
    s_nop 1
    v_max_u32_dpp v104, v104, v104 row_bcast:31 row_mask:0xc bank_mask:0xf
    s_nop 0
    v_readlane_b32 s14, v104, 63
    s_nop 1
    s_and_b32 s15, s14, 2047
    s_sub_u32 s15, 2047, s15
    s_lshl_b32 s12, s15, 11
    s_lshl_b32 s13, s70, 1
    s_add_u32 s12, s12, s13
    buffer_load_dwordx4 v[36:39], v34, s[24:27], s12 offen
    s_lshr_b32 s12, s14, 11
    s_and_b32 s13, s12, 0x8000
    s_cmp_lg_u32 s13, 0
    s_mov_b32 s13, 0xffff
    s_cselect_b32 s13, 0x8000, s13
    s_xor_b32 s12, s12, s13
    s_lshl_b32 s12, s12, 16
    v_mov_b32 v105, s12
    v_mul_f32 v105, 0xbfb8aa3b, v105
    v_exp_f32 v105, v105
    s_nop 0
    v_add_f32 v105, 1.0, v105
    v_rcp_f32 v105, v105
    s_nop 0
    v_cvt_pk_bf16_f32 v105, v105, v105
    v_lshlrev_b32 v105, 16, v105
    s_nop 0
    v_readfirstlane_b32 s14, v105
    s_add_u32 s12, s15, 1
    v_mov_b32 v104, s12
    v_mov_b32 v106, s23
    v_mov_b32 v14, 162864
    s_mov_b64 exec, 1
    ds_write_b96 v14, v[104:106]
    s_mov_b64 exec, -1
    s_waitcnt lgkmcnt(0)
    s_waitcnt vmcnt(10)
    s_barrier
    s_add_u32 m0, s95, 44032
    s_nop 0
    buffer_load_dwordx4 v29, s[28:31], s93 offen offset:2048 lds
    s_bfe_u32 s91, s69, 0x40018
    s_lshl_b32 s92, s91, 7
    s_mul_i32 s93, s91, 393216
    s_add_u32 m0, s94, 81920
    s_nop 0
    buffer_load_dwordx4 v20, s[24:27], s92 offen offset:0 lds
    buffer_load_dwordx4 v21, s[24:27], s92 offen offset:1024 lds
    buffer_load_dwordx4 v22, s[24:27], s92 offen offset:2048 lds
    buffer_load_dwordx4 v23, s[24:27], s92 offen offset:3072 lds
    s_add_u32 m0, s95, 81920
    s_nop 0
    buffer_load_dwordx4 v24, s[28:31], s93 offen offset:0 lds
    buffer_load_dwordx4 v25, s[28:31], s93 offen offset:1024 lds
    buffer_load_dwordx4 v26, s[28:31], s93 offen offset:2048 lds
    s_add_u32 m0, s95, 84992
    s_nop 0
    buffer_load_dwordx4 v27, s[28:31], s93 offen offset:0 lds
    buffer_load_dwordx4 v28, s[28:31], s93 offen offset:1024 lds
    buffer_load_dwordx4 v29, s[28:31], s93 offen offset:2048 lds
    s_waitcnt vmcnt(11)
    v_and_b32 v40, 0xffff, v36
    v_lshlrev_b32 v41, 16, v36
    v_lshrrev_b32 v42, 16, v36
    v_and_b32 v43, 0xffff0000, v36
    v_and_b32 v44, 0xffff, v37
    v_lshlrev_b32 v45, 16, v37
    v_lshrrev_b32 v46, 16, v37
    v_and_b32 v47, 0xffff0000, v37
    v_and_b32 v48, 0xffff, v38
    v_lshlrev_b32 v49, 16, v38
    v_lshrrev_b32 v50, 16, v38
    v_and_b32 v51, 0xffff0000, v38
    v_and_b32 v52, 0xffff, v39
    v_lshlrev_b32 v53, 16, v39
    v_lshrrev_b32 v54, 16, v39
    v_and_b32 v55, 0xffff0000, v39
    v_dot2_f32_bf16 v220, v128, v40, 0
    v_dot2_f32_bf16 v221, v128, v41, 0
    v_dot2_f32_bf16 v222, v129, v40, 0
    v_dot2_f32_bf16 v223, v129, v41, 0
    v_dot2_f32_bf16 v224, v130, v40, 0
    v_dot2_f32_bf16 v225, v130, v41, 0
    v_dot2_f32_bf16 v226, v131, v40, 0
    v_dot2_f32_bf16 v227, v131, v41, 0
    v_dot2_f32_bf16 v228, v160, v40, 0
    v_dot2_f32_bf16 v229, v160, v41, 0
    v_dot2_f32_bf16 v230, v161, v40, 0
    v_dot2_f32_bf16 v231, v161, v41, 0
    v_dot2_f32_bf16 v232, v162, v40, 0
    v_dot2_f32_bf16 v233, v162, v41, 0
    v_dot2_f32_bf16 v234, v163, v40, 0
    v_dot2_f32_bf16 v235, v163, v41, 0
    v_dot2_f32_bf16 v220, v132, v42, v220
    v_dot2_f32_bf16 v221, v132, v43, v221
    v_dot2_f32_bf16 v222, v133, v42, v222
    v_dot2_f32_bf16 v223, v133, v43, v223
    v_dot2_f32_bf16 v224, v134, v42, v224
    v_dot2_f32_bf16 v225, v134, v43, v225
    v_dot2_f32_bf16 v226, v135, v42, v226
    v_dot2_f32_bf16 v227, v135, v43, v227
    v_dot2_f32_bf16 v228, v164, v42, v228
    v_dot2_f32_bf16 v229, v164, v43, v229
    v_dot2_f32_bf16 v230, v165, v42, v230
    v_dot2_f32_bf16 v231, v165, v43, v231
    v_dot2_f32_bf16 v232, v166, v42, v232
    v_dot2_f32_bf16 v233, v166, v43, v233
    v_dot2_f32_bf16 v234, v167, v42, v234
    v_dot2_f32_bf16 v235, v167, v43, v235
    v_dot2_f32_bf16 v220, v136, v44, v220
    v_dot2_f32_bf16 v221, v136, v45, v221
    v_dot2_f32_bf16 v222, v137, v44, v222
    v_dot2_f32_bf16 v223, v137, v45, v223
    v_dot2_f32_bf16 v224, v138, v44, v224
    v_dot2_f32_bf16 v225, v138, v45, v225
    v_dot2_f32_bf16 v226, v139, v44, v226
    v_dot2_f32_bf16 v227, v139, v45, v227
    v_dot2_f32_bf16 v228, v168, v44, v228
    v_dot2_f32_bf16 v229, v168, v45, v229
    s_waitcnt vmcnt(10)
    s_barrier
    s_bfe_u32 s91, s69, 0x4001c
    s_lshl_b32 s92, s91, 7
    s_mul_i32 s93, s91, 393216
    s_add_u32 m0, s94, 0
    s_nop 0
    buffer_load_dwordx4 v20, s[24:27], s92 offen offset:0 lds
    buffer_load_dwordx4 v21, s[24:27], s92 offen offset:1024 lds
    buffer_load_dwordx4 v22, s[24:27], s92 offen offset:2048 lds
    buffer_load_dwordx4 v23, s[24:27], s92 offen offset:3072 lds
    s_add_u32 m0, s95, 0
    s_nop 0
    buffer_load_dwordx4 v24, s[28:31], s93 offen offset:0 lds
    buffer_load_dwordx4 v25, s[28:31], s93 offen offset:1024 lds
    buffer_load_dwordx4 v26, s[28:31], s93 offen offset:2048 lds
    s_add_u32 m0, s95, 3072
    s_nop 0
    buffer_load_dwordx4 v27, s[28:31], s93 offen offset:0 lds
    buffer_load_dwordx4 v28, s[28:31], s93 offen offset:1024 lds
    buffer_load_dwordx4 v29, s[28:31], s93 offen offset:2048 lds
    s_add_u32 s12, s97, 0
    buffer_load_dwordx4 v[192:195], v31, s[64:67], s12 offen nt
    s_add_u32 s12, s97, 16384
    buffer_load_dwordx4 v[196:199], v31, s[64:67], s12 offen nt
    s_add_u32 s12, s97, 32768
    buffer_load_dwordx4 v[200:203], v31, s[64:67], s12 offen nt
    s_add_u32 s12, s97, 49152
    buffer_load_dwordx4 v[204:207], v31, s[64:67], s12 offen nt
    s_add_u32 s12, s97, 65536
    buffer_load_dwordx4 v[208:211], v31, s[64:67], s12 offen nt
    s_add_u32 s12, s97, 81920
    buffer_load_dwordx4 v[212:215], v31, s[64:67], s12 offen nt
    s_add_u32 s12, s97, 98304
    buffer_load_dwordx4 v[216:219], v31, s[64:67], s12 offen nt
    v_dot2_f32_bf16 v230, v169, v44, v230
    v_dot2_f32_bf16 v231, v169, v45, v231
    v_dot2_f32_bf16 v232, v170, v44, v232
    v_dot2_f32_bf16 v233, v170, v45, v233
    v_dot2_f32_bf16 v234, v171, v44, v234
    v_dot2_f32_bf16 v235, v171, v45, v235
    v_dot2_f32_bf16 v220, v140, v46, v220
    v_dot2_f32_bf16 v221, v140, v47, v221
    v_dot2_f32_bf16 v222, v141, v46, v222
    v_dot2_f32_bf16 v223, v141, v47, v223
    v_dot2_f32_bf16 v224, v142, v46, v224
    v_dot2_f32_bf16 v225, v142, v47, v225
    v_dot2_f32_bf16 v226, v143, v46, v226
    v_dot2_f32_bf16 v227, v143, v47, v227
    v_dot2_f32_bf16 v228, v172, v46, v228
    v_dot2_f32_bf16 v229, v172, v47, v229
    v_dot2_f32_bf16 v230, v173, v46, v230
    v_dot2_f32_bf16 v231, v173, v47, v231
    v_dot2_f32_bf16 v232, v174, v46, v232
    v_dot2_f32_bf16 v233, v174, v47, v233
    v_dot2_f32_bf16 v234, v175, v46, v234
    v_dot2_f32_bf16 v235, v175, v47, v235
    v_dot2_f32_bf16 v220, v144, v48, v220
    v_dot2_f32_bf16 v221, v144, v49, v221
    v_dot2_f32_bf16 v222, v145, v48, v222
    v_dot2_f32_bf16 v223, v145, v49, v223
    v_dot2_f32_bf16 v224, v146, v48, v224
    v_dot2_f32_bf16 v225, v146, v49, v225
    v_dot2_f32_bf16 v226, v147, v48, v226
    v_dot2_f32_bf16 v227, v147, v49, v227
    v_dot2_f32_bf16 v228, v176, v48, v228
    v_dot2_f32_bf16 v229, v176, v49, v229
    v_dot2_f32_bf16 v230, v177, v48, v230
    v_dot2_f32_bf16 v231, v177, v49, v231
    v_dot2_f32_bf16 v232, v178, v48, v232
    v_dot2_f32_bf16 v233, v178, v49, v233
    v_dot2_f32_bf16 v234, v179, v48, v234
    v_dot2_f32_bf16 v235, v179, v49, v235
    v_dot2_f32_bf16 v220, v148, v50, v220
    v_dot2_f32_bf16 v221, v148, v51, v221
    v_dot2_f32_bf16 v222, v149, v50, v222
    v_dot2_f32_bf16 v223, v149, v51, v223
    v_dot2_f32_bf16 v224, v150, v50, v224
    v_dot2_f32_bf16 v225, v150, v51, v225
    v_dot2_f32_bf16 v226, v151, v50, v226
    v_dot2_f32_bf16 v227, v151, v51, v227
    v_dot2_f32_bf16 v228, v180, v50, v228
    v_dot2_f32_bf16 v229, v180, v51, v229
    v_dot2_f32_bf16 v230, v181, v50, v230
    v_dot2_f32_bf16 v231, v181, v51, v231
    v_dot2_f32_bf16 v232, v182, v50, v232
    v_dot2_f32_bf16 v233, v182, v51, v233
    v_dot2_f32_bf16 v234, v183, v50, v234
    v_dot2_f32_bf16 v235, v183, v51, v235
    v_dot2_f32_bf16 v220, v152, v52, v220
    v_dot2_f32_bf16 v221, v152, v53, v221
    v_dot2_f32_bf16 v222, v153, v52, v222
    v_dot2_f32_bf16 v223, v153, v53, v223
    s_waitcnt vmcnt(17)
    s_barrier
    s_mul_i32 s12, s21, 8
    s_add_u32 s12, s12, 96
    s_lshl_b32 s13, s12, 10
    s_lshl_b32 s12, s12, 14
    s_add_u32 m0, s13, 24576
    s_add_u32 s90, s12, 0
    buffer_load_dwordx4 v33, s[36:39], s90 offen lds
    s_add_u32 m0, s13, 25600
    s_add_u32 s90, s12, 16384
    buffer_load_dwordx4 v33, s[36:39], s90 offen lds
    s_add_u32 m0, s13, 26624
    s_add_u32 s90, s12, 32768
    buffer_load_dwordx4 v33, s[36:39], s90 offen lds
    s_add_u32 m0, s13, 27648
    s_add_u32 s90, s12, 49152
    buffer_load_dwordx4 v33, s[36:39], s90 offen lds
    s_add_u32 m0, s13, 28672
    s_add_u32 s90, s12, 65536
    buffer_load_dwordx4 v33, s[36:39], s90 offen lds
    s_add_u32 m0, s13, 29696
    s_add_u32 s90, s12, 81920
    buffer_load_dwordx4 v33, s[36:39], s90 offen lds
    s_add_u32 m0, s13, 30720
    s_add_u32 s90, s12, 98304
    buffer_load_dwordx4 v33, s[36:39], s90 offen lds
    s_add_u32 m0, s13, 31744
    s_add_u32 s90, s12, 114688
    buffer_load_dwordx4 v33, s[36:39], s90 offen lds
    v_dot2_f32_bf16 v224, v154, v52, v224
    v_dot2_f32_bf16 v225, v154, v53, v225
    v_dot2_f32_bf16 v226, v155, v52, v226
    v_dot2_f32_bf16 v227, v155, v53, v227
    v_dot2_f32_bf16 v228, v184, v52, v228
    v_dot2_f32_bf16 v229, v184, v53, v229
    v_dot2_f32_bf16 v230, v185, v52, v230
    v_dot2_f32_bf16 v231, v185, v53, v231
    v_dot2_f32_bf16 v232, v186, v52, v232
    v_dot2_f32_bf16 v233, v186, v53, v233
    v_dot2_f32_bf16 v234, v187, v52, v234
    v_dot2_f32_bf16 v235, v187, v53, v235
    v_dot2_f32_bf16 v220, v156, v54, v220
    v_dot2_f32_bf16 v221, v156, v55, v221
    v_dot2_f32_bf16 v222, v157, v54, v222
    v_dot2_f32_bf16 v223, v157, v55, v223
    v_dot2_f32_bf16 v224, v158, v54, v224
    v_dot2_f32_bf16 v225, v158, v55, v225
    v_dot2_f32_bf16 v226, v159, v54, v226
    v_dot2_f32_bf16 v227, v159, v55, v227
    v_dot2_f32_bf16 v228, v188, v54, v228
    v_dot2_f32_bf16 v229, v188, v55, v229
    v_dot2_f32_bf16 v230, v189, v54, v230
    v_dot2_f32_bf16 v231, v189, v55, v231
    v_dot2_f32_bf16 v232, v190, v54, v232
    v_dot2_f32_bf16 v233, v190, v55, v233
    v_dot2_f32_bf16 v234, v191, v54, v234
    v_dot2_f32_bf16 v235, v191, v55, v235
    v_permlane32_swap_b32 v220, v228
    v_permlane32_swap_b32 v221, v229
    v_permlane32_swap_b32 v222, v230
    v_permlane32_swap_b32 v223, v231
    v_permlane32_swap_b32 v224, v232
    v_permlane32_swap_b32 v225, v233
    v_permlane32_swap_b32 v226, v234
    v_permlane32_swap_b32 v227, v235
    v_add_f32 v220, v220, v228
    v_add_f32 v221, v221, v229
    v_add_f32 v222, v222, v230
    v_add_f32 v223, v223, v231
    v_add_f32 v224, v224, v232
    v_add_f32 v225, v225, v233
    v_add_f32 v226, v226, v234
    v_add_f32 v227, v227, v235
    v_permlane16_swap_b32 v220, v224
    v_permlane16_swap_b32 v221, v225
    v_permlane16_swap_b32 v222, v226
    v_permlane16_swap_b32 v223, v227
    v_add_f32 v220, v220, v224
    v_add_f32 v221, v221, v225
    v_add_f32 v222, v222, v226
    v_add_f32 v223, v223, v227
    v_add_f32_dpp v220, v220, v220 row_ror:8 row_mask:0xf bank_mask:0xf
    v_add_f32_dpp v221, v221, v221 row_ror:8 row_mask:0xf bank_mask:0xf
    v_add_f32_dpp v222, v222, v222 row_ror:8 row_mask:0xf bank_mask:0xf
    v_add_f32_dpp v223, v223, v223 row_ror:8 row_mask:0xf bank_mask:0xf
    s_waitcnt vmcnt(15)
    s_barrier
    s_branch L_varend
L_var4:
    s_nop 0
    s_add_u32 m0, s95, 40960
    s_nop 0
    buffer_load_dwordx4 v26, s[28:31], s93 offen offset:2048 lds
    s_add_u32 m0, s95, 44032
    s_nop 0
    buffer_load_dwordx4 v27, s[28:31], s93 offen offset:0 lds
    buffer_load_dwordx4 v28, s[28:31], s93 offen offset:1024 lds
    buffer_load_dwordx4 v29, s[28:31], s93 offen offset:2048 lds
    s_bfe_u32 s91, s68, 0x40008
    s_lshl_b32 s92, s91, 7
    s_mul_i32 s93, s91, 393216
    s_add_u32 m0, s94, 81920
    s_nop 0
    buffer_load_dwordx4 v20, s[24:27], s92 offen offset:0 lds
    buffer_load_dwordx4 v21, s[24:27], s92 offen offset:1024 lds
    buffer_load_dwordx4 v22, s[24:27], s92 offen offset:2048 lds
    buffer_load_dwordx4 v23, s[24:27], s92 offen offset:3072 lds
    s_add_u32 m0, s95, 81920
    s_nop 0
    buffer_load_dwordx4 v24, s[28:31], s93 offen offset:0 lds
    buffer_load_dwordx4 v25, s[28:31], s93 offen offset:1024 lds
    buffer_load_dwordx4 v26, s[28:31], s93 offen offset:2048 lds
    s_add_u32 m0, s95, 84992
    s_nop 0
    buffer_load_dwordx4 v27, s[28:31], s93 offen offset:0 lds
    buffer_load_dwordx4 v28, s[28:31], s93 offen offset:1024 lds
    buffer_load_dwordx4 v29, s[28:31], s93 offen offset:2048 lds
    s_lshl_b32 s12, s19, 2
    s_add_u32 s12, s12, s21
    s_lshl_b32 s12, s12, 10
    s_lshl_b32 s13, s21, 10
    s_add_u32 m0, s13, 155648
    s_nop 0
    buffer_load_dwordx4 v5, s[76:79], s12 offen lds
    s_lshl_b32 s12, s22, 11
    buffer_load_dwordx4 v[40:43], v5, s[24:27], s12 offen offset:0
    buffer_load_dwordx4 v[44:47], v5, s[24:27], s12 offen offset:1024
    buffer_load_dwordx4 v[48:51], v5, s[24:27], s12 offen offset:2048
    buffer_load_dwordx4 v[52:55], v5, s[24:27], s12 offen offset:3072
    buffer_load_dwordx4 v[56:59], v5, s[80:83], 0 offen offset:0
    buffer_load_dwordx4 v[60:63], v5, s[80:83], 0 offen offset:1024
    buffer_load_dwordx4 v[64:67], v5, s[84:87], 0 offen offset:0
    buffer_load_dwordx4 v[68:71], v5, s[84:87], 0 offen offset:1024
    s_waitcnt vmcnt(19)
    s_barrier
    s_bfe_u32 s91, s68, 0x4000c
    s_lshl_b32 s92, s91, 7
    s_mul_i32 s93, s91, 393216
    s_add_u32 m0, s94, 0
    s_nop 0
    buffer_load_dwordx4 v20, s[24:27], s92 offen offset:0 lds
    buffer_load_dwordx4 v21, s[24:27], s92 offen offset:1024 lds
    buffer_load_dwordx4 v22, s[24:27], s92 offen offset:2048 lds
    buffer_load_dwordx4 v23, s[24:27], s92 offen offset:3072 lds
    s_add_u32 m0, s95, 0
    s_nop 0
    buffer_load_dwordx4 v24, s[28:31], s93 offen offset:0 lds
    buffer_load_dwordx4 v25, s[28:31], s93 offen offset:1024 lds
    buffer_load_dwordx4 v26, s[28:31], s93 offen offset:2048 lds
    s_add_u32 m0, s95, 3072
    s_nop 0
    buffer_load_dwordx4 v27, s[28:31], s93 offen offset:0 lds
    buffer_load_dwordx4 v28, s[28:31], s93 offen offset:1024 lds
    buffer_load_dwordx4 v29, s[28:31], s93 offen offset:2048 lds
    s_cmp_lg_u32 s21, 0
    s_cbranch_scc1 L_noclr_4
    v_mov_b32 v104, -1
    v_mov_b32 v105, -1
    v_mov_b32 v106, -1
    v_mov_b32 v107, -1
    s_lshl_b32 s12, s19, 13
    s_lshl_b32 s13, s18, 9
    s_add_u32 s12, s12, s13
    s_add_u32 s12, s12, 32768
    s_lshl_b32 s13, s19, 11
    s_lshl_b32 s90, s18, 7
    s_add_u32 s13, s13, s90
    s_add_u32 s13, s13, 163840
    s_mov_b32 exec_hi, 0
    buffer_store_dwordx4 v[104:107], v5, s[32:35], s12 offen sc1
    s_mov_b32 exec_lo, 255
    buffer_store_dwordx4 v[104:107], v5, s[32:35], s13 offen sc1
    s_mov_b64 exec, -1
L_noclr_4:
    s_waitcnt vmcnt(10)
    v_lshlrev_b32 v72, 16, v64
    v_and_b32 v73, 0xffff0000, v64
    v_lshlrev_b32 v74, 16, v65
    v_and_b32 v75, 0xffff0000, v65
    v_lshlrev_b32 v76, 16, v66
    v_and_b32 v77, 0xffff0000, v66
    v_lshlrev_b32 v78, 16, v67
    v_and_b32 v79, 0xffff0000, v67
    v_lshlrev_b32 v80, 16, v68
    v_and_b32 v81, 0xffff0000, v68
    v_lshlrev_b32 v82, 16, v69
    v_and_b32 v83, 0xffff0000, v69
    v_lshlrev_b32 v84, 16, v70
    v_and_b32 v85, 0xffff0000, v70
    v_lshlrev_b32 v86, 16, v71
    v_and_b32 v87, 0xffff0000, v71
    v_mov_b32 v90, 0
    v_mov_b32 v91, 0
    v_dot2_f32_bf16 v90, v40, v56, v90
    v_lshlrev_b32 v94, 16, v40
    v_and_b32 v95, 0xffff0000, v40
    v_mul_f32 v94, v94, v72
    v_mul_f32 v95, v95, v73
    v_cvt_pk_bf16_f32 v94, v94, v95
    v_lshlrev_b32 v95, 16, v94
    v_and_b32 v94, 0xffff0000, v94
    v_add_f32 v91, v91, v95
    v_add_f32 v91, v91, v94
    v_dot2_f32_bf16 v90, v41, v57, v90
    v_lshlrev_b32 v94, 16, v41
    v_and_b32 v95, 0xffff0000, v41
    v_mul_f32 v94, v94, v74
    v_mul_f32 v95, v95, v75
    v_cvt_pk_bf16_f32 v94, v94, v95
    v_lshlrev_b32 v95, 16, v94
    v_and_b32 v94, 0xffff0000, v94
    v_add_f32 v91, v91, v95
    v_add_f32 v91, v91, v94
    v_dot2_f32_bf16 v90, v42, v58, v90
    v_lshlrev_b32 v94, 16, v42
    v_and_b32 v95, 0xffff0000, v42
    v_mul_f32 v94, v94, v76
    v_mul_f32 v95, v95, v77
    v_cvt_pk_bf16_f32 v94, v94, v95
    v_lshlrev_b32 v95, 16, v94
    v_and_b32 v94, 0xffff0000, v94
    v_add_f32 v91, v91, v95
    v_add_f32 v91, v91, v94
    v_dot2_f32_bf16 v90, v43, v59, v90
    v_lshlrev_b32 v94, 16, v43
    v_and_b32 v95, 0xffff0000, v43
    v_mul_f32 v94, v94, v78
    v_mul_f32 v95, v95, v79
    v_cvt_pk_bf16_f32 v94, v94, v95
    v_lshlrev_b32 v95, 16, v94
    v_and_b32 v94, 0xffff0000, v94
    v_add_f32 v91, v91, v95
    v_add_f32 v91, v91, v94
    v_dot2_f32_bf16 v90, v44, v60, v90
    v_lshlrev_b32 v94, 16, v44
    v_and_b32 v95, 0xffff0000, v44
    v_mul_f32 v94, v94, v80
    v_mul_f32 v95, v95, v81
    v_cvt_pk_bf16_f32 v94, v94, v95
    v_lshlrev_b32 v95, 16, v94
    v_and_b32 v94, 0xffff0000, v94
    v_add_f32 v91, v91, v95
    v_add_f32 v91, v91, v94
    v_dot2_f32_bf16 v90, v45, v61, v90
    v_lshlrev_b32 v94, 16, v45
    v_and_b32 v95, 0xffff0000, v45
    v_mul_f32 v94, v94, v82
    v_mul_f32 v95, v95, v83
    v_cvt_pk_bf16_f32 v94, v94, v95
    v_lshlrev_b32 v95, 16, v94
    v_and_b32 v94, 0xffff0000, v94
    v_add_f32 v91, v91, v95
    v_add_f32 v91, v91, v94
    v_dot2_f32_bf16 v90, v46, v62, v90
    v_lshlrev_b32 v94, 16, v46
    v_and_b32 v95, 0xffff0000, v46
    v_mul_f32 v94, v94, v84
    v_mul_f32 v95, v95, v85
    v_cvt_pk_bf16_f32 v94, v94, v95
    v_lshlrev_b32 v95, 16, v94
    v_and_b32 v94, 0xffff0000, v94
    v_add_f32 v91, v91, v95
    v_add_f32 v91, v91, v94
    v_dot2_f32_bf16 v90, v47, v63, v90
    v_lshlrev_b32 v94, 16, v47
    v_and_b32 v95, 0xffff0000, v47
    v_mul_f32 v94, v94, v86
    v_mul_f32 v95, v95, v87
    v_cvt_pk_bf16_f32 v94, v94, v95
    v_lshlrev_b32 v95, 16, v94
    v_and_b32 v94, 0xffff0000, v94
    v_add_f32 v91, v91, v95
    v_add_f32 v91, v91, v94
    v_mov_b32 v92, 0
    v_mov_b32 v93, 0
    v_dot2_f32_bf16 v92, v48, v56, v92
    v_lshlrev_b32 v94, 16, v48
    v_and_b32 v95, 0xffff0000, v48
    v_mul_f32 v94, v94, v72
    v_mul_f32 v95, v95, v73
    v_cvt_pk_bf16_f32 v94, v94, v95
    v_lshlrev_b32 v95, 16, v94
    v_and_b32 v94, 0xffff0000, v94
    v_add_f32 v93, v93, v95
    v_add_f32 v93, v93, v94
    v_dot2_f32_bf16 v92, v49, v57, v92
    v_lshlrev_b32 v94, 16, v49
    v_and_b32 v95, 0xffff0000, v49
    v_mul_f32 v94, v94, v74
    v_mul_f32 v95, v95, v75
    v_cvt_pk_bf16_f32 v94, v94, v95
    v_lshlrev_b32 v95, 16, v94
    v_and_b32 v94, 0xffff0000, v94
    v_add_f32 v93, v93, v95
    v_add_f32 v93, v93, v94
    v_dot2_f32_bf16 v92, v50, v58, v92
    s_barrier
    s_bfe_u32 s91, s68, 0x40010
    s_lshl_b32 s92, s91, 7
    s_mul_i32 s93, s91, 393216
    s_add_u32 m0, s94, 40960
    s_nop 0
    buffer_load_dwordx4 v20, s[24:27], s92 offen offset:0 lds
    buffer_load_dwordx4 v21, s[24:27], s92 offen offset:1024 lds
    buffer_load_dwordx4 v22, s[24:27], s92 offen offset:2048 lds
    buffer_load_dwordx4 v23, s[24:27], s92 offen offset:3072 lds
    s_add_u32 m0, s95, 40960
    s_nop 0
    buffer_load_dwordx4 v24, s[28:31], s93 offen offset:0 lds
    buffer_load_dwordx4 v25, s[28:31], s93 offen offset:1024 lds
    buffer_load_dwordx4 v26, s[28:31], s93 offen offset:2048 lds
    s_add_u32 m0, s95, 44032
    s_nop 0
    buffer_load_dwordx4 v27, s[28:31], s93 offen offset:0 lds
    buffer_load_dwordx4 v28, s[28:31], s93 offen offset:1024 lds
    buffer_load_dwordx4 v29, s[28:31], s93 offen offset:2048 lds
    v_lshlrev_b32 v94, 16, v50
    v_and_b32 v95, 0xffff0000, v50
    v_mul_f32 v94, v94, v76
    v_mul_f32 v95, v95, v77
    v_cvt_pk_bf16_f32 v94, v94, v95
    v_lshlrev_b32 v95, 16, v94
    v_and_b32 v94, 0xffff0000, v94
    v_add_f32 v93, v93, v95
    v_add_f32 v93, v93, v94
    v_dot2_f32_bf16 v92, v51, v59, v92
    v_lshlrev_b32 v94, 16, v51
    v_and_b32 v95, 0xffff0000, v51
    v_mul_f32 v94, v94, v78
    v_mul_f32 v95, v95, v79
    v_cvt_pk_bf16_f32 v94, v94, v95
    v_lshlrev_b32 v95, 16, v94
    v_and_b32 v94, 0xffff0000, v94
    v_add_f32 v93, v93, v95
    v_add_f32 v93, v93, v94
    v_dot2_f32_bf16 v92, v52, v60, v92
    v_lshlrev_b32 v94, 16, v52
    v_and_b32 v95, 0xffff0000, v52
    v_mul_f32 v94, v94, v80
    v_mul_f32 v95, v95, v81
    v_cvt_pk_bf16_f32 v94, v94, v95
    v_lshlrev_b32 v95, 16, v94
    v_and_b32 v94, 0xffff0000, v94
    v_add_f32 v93, v93, v95
    v_add_f32 v93, v93, v94
    v_dot2_f32_bf16 v92, v53, v61, v92
    v_lshlrev_b32 v94, 16, v53
    v_and_b32 v95, 0xffff0000, v53
    v_mul_f32 v94, v94, v82
    v_mul_f32 v95, v95, v83
    v_cvt_pk_bf16_f32 v94, v94, v95
    v_lshlrev_b32 v95, 16, v94
    v_and_b32 v94, 0xffff0000, v94
    v_add_f32 v93, v93, v95
    v_add_f32 v93, v93, v94
    v_dot2_f32_bf16 v92, v54, v62, v92
    v_lshlrev_b32 v94, 16, v54
    v_and_b32 v95, 0xffff0000, v54
    v_mul_f32 v94, v94, v84
    v_mul_f32 v95, v95, v85
    v_cvt_pk_bf16_f32 v94, v94, v95
    v_lshlrev_b32 v95, 16, v94
    v_and_b32 v94, 0xffff0000, v94
    v_add_f32 v93, v93, v95
    v_add_f32 v93, v93, v94
    v_dot2_f32_bf16 v92, v55, v63, v92
    v_lshlrev_b32 v94, 16, v55
    v_and_b32 v95, 0xffff0000, v55
    v_mul_f32 v94, v94, v86
    v_mul_f32 v95, v95, v87
    v_cvt_pk_bf16_f32 v94, v94, v95
    v_lshlrev_b32 v95, 16, v94
    v_and_b32 v94, 0xffff0000, v94
    v_add_f32 v93, v93, v95
    v_add_f32 v93, v93, v94
    v_add_f32_dpp v90, v90, v90 row_shr:1 row_mask:0xf bank_mask:0xf
    v_add_f32_dpp v91, v91, v91 row_shr:1 row_mask:0xf bank_mask:0xf
    v_add_f32_dpp v92, v92, v92 row_shr:1 row_mask:0xf bank_mask:0xf
    v_add_f32_dpp v93, v93, v93 row_shr:1 row_mask:0xf bank_mask:0xf
    v_add_f32_dpp v90, v90, v90 row_shr:2 row_mask:0xf bank_mask:0xf
    v_add_f32_dpp v91, v91, v91 row_shr:2 row_mask:0xf bank_mask:0xf
    v_add_f32_dpp v92, v92, v92 row_shr:2 row_mask:0xf bank_mask:0xf
    v_add_f32_dpp v93, v93, v93 row_shr:2 row_mask:0xf bank_mask:0xf
    v_add_f32_dpp v90, v90, v90 row_shr:4 row_mask:0xf bank_mask:0xf
    v_add_f32_dpp v91, v91, v91 row_shr:4 row_mask:0xf bank_mask:0xf
    v_add_f32_dpp v92, v92, v92 row_shr:4 row_mask:0xf bank_mask:0xf
    v_add_f32_dpp v93, v93, v93 row_shr:4 row_mask:0xf bank_mask:0xf
    v_add_f32_dpp v90, v90, v90 row_shr:8 row_mask:0xf bank_mask:0xf
    v_add_f32_dpp v91, v91, v91 row_shr:8 row_mask:0xf bank_mask:0xf
    v_add_f32_dpp v92, v92, v92 row_shr:8 row_mask:0xf bank_mask:0xf
    v_add_f32_dpp v93, v93, v93 row_shr:8 row_mask:0xf bank_mask:0xf
    v_add_f32_dpp v90, v90, v90 row_bcast:15 row_mask:0xa bank_mask:0xf
    v_add_f32_dpp v91, v91, v91 row_bcast:15 row_mask:0xa bank_mask:0xf
    v_add_f32_dpp v92, v92, v92 row_bcast:15 row_mask:0xa bank_mask:0xf
    v_add_f32_dpp v93, v93, v93 row_bcast:15 row_mask:0xa bank_mask:0xf
    v_add_f32_dpp v90, v90, v90 row_bcast:31 row_mask:0xc bank_mask:0xf
    v_add_f32_dpp v91, v91, v91 row_bcast:31 row_mask:0xc bank_mask:0xf
    v_add_f32_dpp v92, v92, v92 row_bcast:31 row_mask:0xc bank_mask:0xf
    v_add_f32_dpp v93, v93, v93 row_bcast:31 row_mask:0xc bank_mask:0xf
    v_cvt_pk_bf16_f32 v94, v90, v91
    v_and_b32 v95, 0xffff, v94
    v_and_b32 v96, 0x8000, v94
    v_cmp_ne_u32 vcc, 0, v96
    v_mov_b32 v97, 0x8000
    v_mov_b32 v98, 0xffff
    v_cndmask_b32 v96, v97, v98, vcc
    v_xor_b32 v95, v95, v96
    s_sub_u32 s12, 2047, s22
    v_lshlrev_b32 v95, 11, v95
    v_or_b32 v100, s12, v95
    v_and_b32 v94, 0xffff0000, v94
    v_mul_f32 v94, 0xbfb8aa3b, v94
    v_exp_f32 v94, v94
    s_nop 0
    v_add_f32 v94, 1.0, v94
    v_rcp_f32 v94, v94
    s_nop 0
    v_cvt_pk_bf16_f32 v94, v94, v94
    v_lshlrev_b32 v102, 16, v94
    v_cvt_pk_bf16_f32 v94, v92, v93
    v_and_b32 v95, 0xffff, v94
    v_and_b32 v96, 0x8000, v94
    v_cmp_ne_u32 vcc, 0, v96
    v_mov_b32 v97, 0x8000
    v_mov_b32 v98, 0xffff
    v_cndmask_b32 v96, v97, v98, vcc
    v_xor_b32 v95, v95, v96
    s_sub_u32 s12, 2046, s22
    v_lshlrev_b32 v95, 11, v95
    v_or_b32 v101, s12, v95
    v_and_b32 v94, 0xffff0000, v94
    v_mul_f32 v94, 0xbfb8aa3b, v94
    v_exp_f32 v94, v94
    s_nop 0
    v_add_f32 v94, 1.0, v94
    v_rcp_f32 v94, v94
    s_nop 0
    v_cvt_pk_bf16_f32 v94, v94, v94
    v_lshlrev_b32 v103, 16, v94
    v_max_u32 v100, v100, v101
    s_lshl_b32 s12, s22, 2
    s_add_u32 s12, s12, 4096
    s_lshl_b32 s13, s21, 2
    s_add_u32 s13, s13, 162880
    v_mov_b32 v14, s13
    s_mov_b32 exec_lo, 0
    s_mov_b32 exec_hi, 0x80000000
    buffer_store_dwordx2 v[102:103], v13, s[32:35], s12 offen sc1
    ds_write_b32 v14, v100
    s_mov_b64 exec, -1
    s_waitcnt lgkmcnt(0)
    buffer_load_dword v15, v13, s[72:75], 0 offen offset:4 sc1
    s_waitcnt vmcnt(12)
    s_barrier
    s_bfe_u32 s91, s68, 0x40014
    s_lshl_b32 s92, s91, 7
    s_mul_i32 s93, s91, 393216
    s_add_u32 m0, s94, 81920
    s_nop 0
    buffer_load_dwordx4 v20, s[24:27], s92 offen offset:0 lds
    buffer_load_dwordx4 v21, s[24:27], s92 offen offset:1024 lds
    buffer_load_dwordx4 v22, s[24:27], s92 offen offset:2048 lds
    buffer_load_dwordx4 v23, s[24:27], s92 offen offset:3072 lds
    s_add_u32 m0, s95, 81920
    s_nop 0
    buffer_load_dwordx4 v24, s[28:31], s93 offen offset:0 lds
    buffer_load_dwordx4 v25, s[28:31], s93 offen offset:1024 lds
    buffer_load_dwordx4 v26, s[28:31], s93 offen offset:2048 lds
    s_add_u32 m0, s95, 84992
    s_nop 0
    buffer_load_dwordx4 v27, s[28:31], s93 offen offset:0 lds
    buffer_load_dwordx4 v28, s[28:31], s93 offen offset:1024 lds
    buffer_load_dwordx4 v29, s[28:31], s93 offen offset:2048 lds
    s_waitcnt vmcnt(12)
    s_barrier
    s_bfe_u32 s91, s68, 0x40018
    s_lshl_b32 s92, s91, 7
    s_mul_i32 s93, s91, 393216
    s_add_u32 m0, s94, 0
    s_nop 0
    buffer_load_dwordx4 v20, s[24:27], s92 offen offset:0 lds
    buffer_load_dwordx4 v21, s[24:27], s92 offen offset:1024 lds
    buffer_load_dwordx4 v22, s[24:27], s92 offen offset:2048 lds
    buffer_load_dwordx4 v23, s[24:27], s92 offen offset:3072 lds
    s_add_u32 m0, s95, 0
    s_nop 0
    buffer_load_dwordx4 v24, s[28:31], s93 offen offset:0 lds
    buffer_load_dwordx4 v25, s[28:31], s93 offen offset:1024 lds
    buffer_load_dwordx4 v26, s[28:31], s93 offen offset:2048 lds
    s_add_u32 m0, s95, 3072
    s_nop 0
    buffer_load_dwordx4 v27, s[28:31], s93 offen offset:0 lds
    buffer_load_dwordx4 v28, s[28:31], s93 offen offset:1024 lds
    buffer_load_dwordx4 v29, s[28:31], s93 offen offset:2048 lds
    s_cmp_ge_u32 s10, 224
    s_cbranch_scc1 L_p30_4
    s_add_u32 s12, s71, 0
    buffer_load_dwordx4 v[128:131], v30, s[40:43], s12 offen nt
    s_add_u32 s12, s71, 7168
    buffer_load_dwordx4 v[132:135], v30, s[40:43], s12 offen nt
    s_add_u32 s12, s71, 14336
    buffer_load_dwordx4 v[136:139], v30, s[40:43], s12 offen nt
    s_add_u32 s12, s71, 21504
    buffer_load_dwordx4 v[140:143], v30, s[40:43], s12 offen nt
    s_add_u32 s12, s71, 28672
    buffer_load_dwordx4 v[144:147], v30, s[40:43], s12 offen nt
    s_add_u32 s12, s71, 35840
    buffer_load_dwordx4 v[148:151], v30, s[40:43], s12 offen nt
    s_add_u32 s12, s71, 43008
    buffer_load_dwordx4 v[152:155], v30, s[40:43], s12 offen nt
    s_add_u32 s12, s71, 50176
    buffer_load_dwordx4 v[156:159], v30, s[40:43], s12 offen nt
    s_branch L_p3e0_4
L_p30_4:
    s_mov_b64 exec, 63
    s_bfe_u32 s12, s68, 0x4000c
    s_mul_i32 s12, s12, 393216
    buffer_load_dword v128, v32, s[28:31], s12 offen
    s_bfe_u32 s12, s68, 0x40010
    s_mul_i32 s12, s12, 393216
    buffer_load_dword v132, v32, s[28:31], s12 offen
    s_bfe_u32 s12, s68, 0x40014
    s_mul_i32 s12, s12, 393216
    buffer_load_dword v136, v32, s[28:31], s12 offen
    s_bfe_u32 s12, s68, 0x40018
    s_mul_i32 s12, s12, 393216
    buffer_load_dword v140, v32, s[28:31], s12 offen
    s_bfe_u32 s12, s68, 0x4001c
    s_mul_i32 s12, s12, 393216
    buffer_load_dword v144, v32, s[28:31], s12 offen
    s_bfe_u32 s12, s69, 0x40000
    s_mul_i32 s12, s12, 393216
    buffer_load_dword v148, v32, s[28:31], s12 offen
    s_bfe_u32 s12, s69, 0x40004
    s_mul_i32 s12, s12, 393216
    buffer_load_dword v152, v32, s[28:31], s12 offen
    s_bfe_u32 s12, s69, 0x40008
    s_mul_i32 s12, s12, 393216
    buffer_load_dword v156, v32, s[28:31], s12 offen
    s_mov_b64 exec, -1
L_p3e0_4:
    s_waitcnt vmcnt(28)
    s_mov_b32 s13, 0
L_tagchk_4:
    v_readfirstlane_b32 s23, v15
    s_nop 1
    s_cmp_lg_u32 s23, 0
    s_cbranch_scc1 L_tagok_4
    s_add_u32 s13, s13, 1
    s_cmp_ge_u32 s13, 16384
    s_cbranch_scc1 L_tagok_4
    buffer_load_dword v15, v13, s[72:75], 0 offen offset:4 sc1
    s_waitcnt vmcnt(0)
    s_branch L_tagchk_4
L_tagok_4:
    s_and_b32 s76, s23, 0xff
    s_bfe_u32 s77, s23, 0x80008
    s_bfe_u32 s78, s23, 0x80010
    s_lshr_b32 s79, s23, 24
    v_and_b32 v35, 3, v2
    v_lshlrev_b32 v35, 3, v35
    v_bfe_u32 v35, s23, v35, 8
    s_cmp_lg_u32 s21, 0
    s_cbranch_scc1 L_nopub_4
    v_mov_b32 v14, 162880
    ds_read_b128 v[104:107], v14
    s_lshl_b32 s12, s2, 3
    s_add_u32 s12, s12, 0
    s_waitcnt lgkmcnt(0)
    v_max3_u32 v104, v104, v105, v106
    v_max_u32 v104, v104, v107
    v_mov_b32 v105, s23
    s_mov_b64 exec, 1
    buffer_store_dwordx2 v[104:105], v13, s[32:35], s12 offen sc1
    s_mov_b64 exec, -1
L_nopub_4:
    s_waitcnt vmcnt(18)
    s_barrier
    s_bfe_u32 s91, s68, 0x4001c
    s_lshl_b32 s92, s91, 7
    s_mul_i32 s93, s91, 393216
    s_add_u32 m0, s94, 40960
    s_nop 0
    buffer_load_dwordx4 v20, s[24:27], s92 offen offset:0 lds
    buffer_load_dwordx4 v21, s[24:27], s92 offen offset:1024 lds
    buffer_load_dwordx4 v22, s[24:27], s92 offen offset:2048 lds
    buffer_load_dwordx4 v23, s[24:27], s92 offen offset:3072 lds
    s_add_u32 m0, s95, 40960
    s_nop 0
    buffer_load_dwordx4 v24, s[28:31], s93 offen offset:0 lds
    s_waitcnt vmcnt(13)
    s_barrier
    s_add_u32 m0, s95, 40960
    s_nop 0
    buffer_load_dwordx4 v25, s[28:31], s93 offen offset:1024 lds
    buffer_load_dwordx4 v26, s[28:31], s93 offen offset:2048 lds
    s_add_u32 m0, s95, 44032
    s_nop 0
    buffer_load_dwordx4 v27, s[28:31], s93 offen offset:0 lds
    buffer_load_dwordx4 v28, s[28:31], s93 offen offset:1024 lds
    buffer_load_dwordx4 v29, s[28:31], s93 offen offset:2048 lds
    s_bfe_u32 s91, s69, 0x40000
    s_lshl_b32 s92, s91, 7
    s_mul_i32 s93, s91, 393216
    s_add_u32 m0, s94, 81920
    s_nop 0
    buffer_load_dwordx4 v20, s[24:27], s92 offen offset:0 lds
    buffer_load_dwordx4 v21, s[24:27], s92 offen offset:1024 lds
    buffer_load_dwordx4 v22, s[24:27], s92 offen offset:2048 lds
    buffer_load_dwordx4 v23, s[24:27], s92 offen offset:3072 lds
    s_add_u32 m0, s95, 81920
    s_nop 0
    buffer_load_dwordx4 v24, s[28:31], s93 offen offset:0 lds
    buffer_load_dwordx4 v25, s[28:31], s93 offen offset:1024 lds
    buffer_load_dwordx4 v26, s[28:31], s93 offen offset:2048 lds
    s_waitcnt vmcnt(7)
    s_barrier
    s_add_u32 m0, s95, 84992
    s_nop 0
    buffer_load_dwordx4 v27, s[28:31], s93 offen offset:0 lds
    buffer_load_dwordx4 v28, s[28:31], s93 offen offset:1024 lds
    buffer_load_dwordx4 v29, s[28:31], s93 offen offset:2048 lds
    s_bfe_u32 s91, s69, 0x40004
    s_lshl_b32 s92, s91, 7
    s_mul_i32 s93, s91, 393216
    s_add_u32 m0, s94, 0
    s_nop 0
    buffer_load_dwordx4 v20, s[24:27], s92 offen offset:0 lds
    buffer_load_dwordx4 v21, s[24:27], s92 offen offset:1024 lds
    buffer_load_dwordx4 v22, s[24:27], s92 offen offset:2048 lds
    buffer_load_dwordx4 v23, s[24:27], s92 offen offset:3072 lds
    s_add_u32 m0, s95, 0
    s_nop 0
    buffer_load_dwordx4 v24, s[28:31], s93 offen offset:0 lds
    buffer_load_dwordx4 v25, s[28:31], s93 offen offset:1024 lds
    buffer_load_dwordx4 v26, s[28:31], s93 offen offset:2048 lds
    s_add_u32 m0, s95, 3072
    s_nop 0
    buffer_load_dwordx4 v27, s[28:31], s93 offen offset:0 lds
    buffer_load_dwordx4 v28, s[28:31], s93 offen offset:1024 lds
    s_waitcnt vmcnt(9)
    s_barrier
    s_add_u32 m0, s95, 3072
    s_nop 0
    buffer_load_dwordx4 v29, s[28:31], s93 offen offset:2048 lds
    s_bfe_u32 s91, s69, 0x40008
    s_lshl_b32 s92, s91, 7
    s_mul_i32 s93, s91, 393216
    s_add_u32 m0, s94, 40960
    s_nop 0
    buffer_load_dwordx4 v20, s[24:27], s92 offen offset:0 lds
    buffer_load_dwordx4 v21, s[24:27], s92 offen offset:1024 lds
    buffer_load_dwordx4 v22, s[24:27], s92 offen offset:2048 lds
    buffer_load_dwordx4 v23, s[24:27], s92 offen offset:3072 lds
    s_add_u32 m0, s95, 40960
    s_nop 0
    buffer_load_dwordx4 v24, s[28:31], s93 offen offset:0 lds
    buffer_load_dwordx4 v25, s[28:31], s93 offen offset:1024 lds
    buffer_load_dwordx4 v26, s[28:31], s93 offen offset:2048 lds
    s_add_u32 m0, s95, 44032
    s_nop 0
    buffer_load_dwordx4 v27, s[28:31], s93 offen offset:0 lds
    buffer_load_dwordx4 v28, s[28:31], s93 offen offset:1024 lds
    buffer_load_dwordx4 v29, s[28:31], s93 offen offset:2048 lds
    s_waitcnt vmcnt(10)
    s_barrier
    s_bfe_u32 s91, s69, 0x4000c
    s_lshl_b32 s92, s91, 7
    s_mul_i32 s93, s91, 393216
    s_add_u32 m0, s94, 81920
    s_nop 0
    buffer_load_dwordx4 v20, s[24:27], s92 offen offset:0 lds
    buffer_load_dwordx4 v21, s[24:27], s92 offen offset:1024 lds
    buffer_load_dwordx4 v22, s[24:27], s92 offen offset:2048 lds
    buffer_load_dwordx4 v23, s[24:27], s92 offen offset:3072 lds
    s_add_u32 m0, s95, 81920
    s_nop 0
    buffer_load_dwordx4 v24, s[28:31], s93 offen offset:0 lds
    buffer_load_dwordx4 v25, s[28:31], s93 offen offset:1024 lds
    buffer_load_dwordx4 v26, s[28:31], s93 offen offset:2048 lds
    s_add_u32 m0, s95, 84992
    s_nop 0
    buffer_load_dwordx4 v27, s[28:31], s93 offen offset:0 lds
    buffer_load_dwordx4 v28, s[28:31], s93 offen offset:1024 lds
    buffer_load_dwordx4 v29, s[28:31], s93 offen offset:2048 lds
    s_cmp_ge_u32 s10, 224
    s_cbranch_scc1 L_p31_4
    s_add_u32 s12, s9, 0
    buffer_load_dwordx4 v[160:163], v30, s[44:47], s12 offen nt
    s_add_u32 s12, s9, 7168
    buffer_load_dwordx4 v[164:167], v30, s[44:47], s12 offen nt
    s_add_u32 s12, s9, 14336
    buffer_load_dwordx4 v[168:171], v30, s[44:47], s12 offen nt
    s_add_u32 s12, s9, 21504
    buffer_load_dwordx4 v[172:175], v30, s[44:47], s12 offen nt
    s_add_u32 s12, s9, 28672
    buffer_load_dwordx4 v[176:179], v30, s[44:47], s12 offen nt
    s_add_u32 s12, s9, 35840
    buffer_load_dwordx4 v[180:183], v30, s[44:47], s12 offen nt
    s_add_u32 s12, s9, 43008
    buffer_load_dwordx4 v[184:187], v30, s[44:47], s12 offen nt
    s_add_u32 s12, s9, 50176
    buffer_load_dwordx4 v[188:191], v30, s[44:47], s12 offen nt
    s_branch L_p3e1_4
L_p31_4:
    s_mov_b64 exec, 63
    s_bfe_u32 s12, s69, 0x4000c
    s_mul_i32 s12, s12, 393216
    buffer_load_dword v160, v32, s[28:31], s12 offen
    s_bfe_u32 s12, s69, 0x40010
    s_mul_i32 s12, s12, 393216
    buffer_load_dword v164, v32, s[28:31], s12 offen
    s_bfe_u32 s12, s69, 0x40014
    s_mul_i32 s12, s12, 393216
    buffer_load_dword v168, v32, s[28:31], s12 offen
    s_bfe_u32 s12, s69, 0x40018
    s_mul_i32 s12, s12, 393216
    buffer_load_dword v172, v32, s[28:31], s12 offen
    s_bfe_u32 s12, s69, 0x4001c
    s_mul_i32 s12, s12, 393216
    buffer_load_dword v176, v32, s[28:31], s12 offen
    s_mov_b64 exec, 1
    s_bfe_u32 s12, s69, 0x4001c
    s_mul_i32 s12, s12, 393216
    buffer_load_dword v180, v32, s[28:31], s12 offen
    s_bfe_u32 s12, s69, 0x4001c
    s_mul_i32 s12, s12, 393216
    buffer_load_dword v184, v32, s[28:31], s12 offen
    s_bfe_u32 s12, s69, 0x4001c
    s_mul_i32 s12, s12, 393216
    buffer_load_dword v188, v32, s[28:31], s12 offen
    s_mov_b64 exec, -1
L_p3e1_4:
    s_mov_b32 exec_lo, 0xffff0000
    s_mov_b32 exec_hi, 0
    buffer_load_dword v19, v10, s[36:39], 0 offen
    s_mov_b64 exec, -1
    s_mov_b32 s12, 0
    buffer_load_dwordx4 v[104:107], v5, s[32:35], s12 offen offset:0 sc1
    buffer_load_dwordx4 v[108:111], v5, s[32:35], s12 offen offset:1024 sc1
    s_waitcnt vmcnt(21)
    s_barrier
    s_bfe_u32 s91, s69, 0x40010
    s_lshl_b32 s92, s91, 7
    s_mul_i32 s93, s91, 393216
    s_add_u32 m0, s94, 0
    s_nop 0
    buffer_load_dwordx4 v20, s[24:27], s92 offen offset:0 lds
    buffer_load_dwordx4 v21, s[24:27], s92 offen offset:1024 lds
    buffer_load_dwordx4 v22, s[24:27], s92 offen offset:2048 lds
    buffer_load_dwordx4 v23, s[24:27], s92 offen offset:3072 lds
    s_add_u32 m0, s95, 0
    s_nop 0
    buffer_load_dwordx4 v24, s[28:31], s93 offen offset:0 lds
    s_waitcnt vmcnt(16)
    s_barrier
    s_add_u32 m0, s95, 0
    s_nop 0
    buffer_load_dwordx4 v25, s[28:31], s93 offen offset:1024 lds
    buffer_load_dwordx4 v26, s[28:31], s93 offen offset:2048 lds
    s_add_u32 m0, s95, 3072
    s_nop 0
    buffer_load_dwordx4 v27, s[28:31], s93 offen offset:0 lds
    buffer_load_dwordx4 v28, s[28:31], s93 offen offset:1024 lds
    buffer_load_dwordx4 v29, s[28:31], s93 offen offset:2048 lds
    s_bfe_u32 s91, s69, 0x40014
    s_lshl_b32 s92, s91, 7
    s_mul_i32 s93, s91, 393216
    s_add_u32 m0, s94, 40960
    s_nop 0
    buffer_load_dwordx4 v20, s[24:27], s92 offen offset:0 lds
    buffer_load_dwordx4 v21, s[24:27], s92 offen offset:1024 lds
    buffer_load_dwordx4 v22, s[24:27], s92 offen offset:2048 lds
    buffer_load_dwordx4 v23, s[24:27], s92 offen offset:3072 lds
    s_add_u32 m0, s95, 40960
    s_nop 0
    buffer_load_dwordx4 v24, s[28:31], s93 offen offset:0 lds
    buffer_load_dwordx4 v25, s[28:31], s93 offen offset:1024 lds
    buffer_load_dwordx4 v26, s[28:31], s93 offen offset:2048 lds
    s_waitcnt vmcnt(17)
    s_mov_b32 s13, 0
L_keychk_4:
    v_xor_b32 v105, s23, v105
    v_xor_b32 v107, s23, v107
    v_xor_b32 v109, s23, v109
    v_xor_b32 v111, s23, v111
    v_or3_b32 v105, v105, v107, v109
    v_or_b32 v105, v105, v111
    v_cmp_ne_u32 vcc, 0, v105
    s_cbranch_vccz L_keyok_4
    s_add_u32 s13, s13, 1
    s_cmp_ge_u32 s13, 16384
    s_cbranch_scc1 L_keyok_4
    s_mov_b32 s12, 0
    buffer_load_dwordx4 v[104:107], v5, s[32:35], s12 offen offset:0 sc1
    buffer_load_dwordx4 v[108:111], v5, s[32:35], s12 offen offset:1024 sc1
    s_waitcnt vmcnt(0)
    s_branch L_keychk_4
L_keyok_4:
    v_max3_u32 v104, v104, v106, v108
    v_max_u32 v104, v104, v110
    s_nop 1
    v_max_u32_dpp v104, v104, v104 row_shr:1 row_mask:0xf bank_mask:0xf
    s_nop 1
    v_max_u32_dpp v104, v104, v104 row_shr:2 row_mask:0xf bank_mask:0xf
    s_nop 1
    v_max_u32_dpp v104, v104, v104 row_shr:4 row_mask:0xf bank_mask:0xf
    s_nop 1
    v_max_u32_dpp v104, v104, v104 row_shr:8 row_mask:0xf bank_mask:0xf
    s_nop 1
    v_max_u32_dpp v104, v104, v104 row_bcast:15 row_mask:0xa bank_mask:0xf
    s_nop 1
    v_max_u32_dpp v104, v104, v104 row_bcast:31 row_mask:0xc bank_mask:0xf
    s_nop 0
    v_readlane_b32 s14, v104, 63
    s_nop 1
    s_and_b32 s15, s14, 2047
    s_sub_u32 s15, 2047, s15
    s_lshl_b32 s12, s15, 11
    s_lshl_b32 s13, s70, 1
    s_add_u32 s12, s12, s13
    buffer_load_dwordx4 v[36:39], v34, s[24:27], s12 offen
    s_lshr_b32 s12, s14, 11
    s_and_b32 s13, s12, 0x8000
    s_cmp_lg_u32 s13, 0
    s_mov_b32 s13, 0xffff
    s_cselect_b32 s13, 0x8000, s13
    s_xor_b32 s12, s12, s13
    s_lshl_b32 s12, s12, 16
    v_mov_b32 v105, s12
    v_mul_f32 v105, 0xbfb8aa3b, v105
    v_exp_f32 v105, v105
    s_nop 0
    v_add_f32 v105, 1.0, v105
    v_rcp_f32 v105, v105
    s_nop 0
    v_cvt_pk_bf16_f32 v105, v105, v105
    v_lshlrev_b32 v105, 16, v105
    s_nop 0
    v_readfirstlane_b32 s14, v105
    s_add_u32 s12, s15, 1
    v_mov_b32 v104, s12
    v_mov_b32 v106, s23
    v_mov_b32 v14, 162864
    s_mov_b64 exec, 1
    ds_write_b96 v14, v[104:106]
    s_mov_b64 exec, -1
    s_waitcnt lgkmcnt(0)
    s_waitcnt vmcnt(8)
    s_barrier
    s_add_u32 m0, s95, 44032
    s_nop 0
    buffer_load_dwordx4 v27, s[28:31], s93 offen offset:0 lds
    buffer_load_dwordx4 v28, s[28:31], s93 offen offset:1024 lds
    buffer_load_dwordx4 v29, s[28:31], s93 offen offset:2048 lds
    s_bfe_u32 s91, s69, 0x40018
    s_lshl_b32 s92, s91, 7
    s_mul_i32 s93, s91, 393216
    s_add_u32 m0, s94, 81920
    s_nop 0
    buffer_load_dwordx4 v20, s[24:27], s92 offen offset:0 lds
    buffer_load_dwordx4 v21, s[24:27], s92 offen offset:1024 lds
    buffer_load_dwordx4 v22, s[24:27], s92 offen offset:2048 lds
    buffer_load_dwordx4 v23, s[24:27], s92 offen offset:3072 lds
    s_add_u32 m0, s95, 81920
    s_nop 0
    buffer_load_dwordx4 v24, s[28:31], s93 offen offset:0 lds
    buffer_load_dwordx4 v25, s[28:31], s93 offen offset:1024 lds
    buffer_load_dwordx4 v26, s[28:31], s93 offen offset:2048 lds
    s_add_u32 m0, s95, 84992
    s_nop 0
    buffer_load_dwordx4 v27, s[28:31], s93 offen offset:0 lds
    buffer_load_dwordx4 v28, s[28:31], s93 offen offset:1024 lds
    s_waitcnt vmcnt(12)
    v_and_b32 v40, 0xffff, v36
    v_lshlrev_b32 v41, 16, v36
    v_lshrrev_b32 v42, 16, v36
    v_and_b32 v43, 0xffff0000, v36
    v_and_b32 v44, 0xffff, v37
    v_lshlrev_b32 v45, 16, v37
    v_lshrrev_b32 v46, 16, v37
    v_and_b32 v47, 0xffff0000, v37
    v_and_b32 v48, 0xffff, v38
    v_lshlrev_b32 v49, 16, v38
    v_lshrrev_b32 v50, 16, v38
    v_and_b32 v51, 0xffff0000, v38
    v_and_b32 v52, 0xffff, v39
    v_lshlrev_b32 v53, 16, v39
    v_lshrrev_b32 v54, 16, v39
    v_and_b32 v55, 0xffff0000, v39
    v_dot2_f32_bf16 v220, v128, v40, 0
    v_dot2_f32_bf16 v221, v128, v41, 0
    v_dot2_f32_bf16 v222, v129, v40, 0
    v_dot2_f32_bf16 v223, v129, v41, 0
    v_dot2_f32_bf16 v224, v130, v40, 0
    v_dot2_f32_bf16 v225, v130, v41, 0
    v_dot2_f32_bf16 v226, v131, v40, 0
    v_dot2_f32_bf16 v227, v131, v41, 0
    v_dot2_f32_bf16 v228, v160, v40, 0
    v_dot2_f32_bf16 v229, v160, v41, 0
    v_dot2_f32_bf16 v230, v161, v40, 0
    v_dot2_f32_bf16 v231, v161, v41, 0
    v_dot2_f32_bf16 v232, v162, v40, 0
    v_dot2_f32_bf16 v233, v162, v41, 0
    v_dot2_f32_bf16 v234, v163, v40, 0
    v_dot2_f32_bf16 v235, v163, v41, 0
    v_dot2_f32_bf16 v220, v132, v42, v220
    v_dot2_f32_bf16 v221, v132, v43, v221
    v_dot2_f32_bf16 v222, v133, v42, v222
    v_dot2_f32_bf16 v223, v133, v43, v223
    v_dot2_f32_bf16 v224, v134, v42, v224
    v_dot2_f32_bf16 v225, v134, v43, v225
    v_dot2_f32_bf16 v226, v135, v42, v226
    v_dot2_f32_bf16 v227, v135, v43, v227
    v_dot2_f32_bf16 v228, v164, v42, v228
    v_dot2_f32_bf16 v229, v164, v43, v229
    v_dot2_f32_bf16 v230, v165, v42, v230
    v_dot2_f32_bf16 v231, v165, v43, v231
    v_dot2_f32_bf16 v232, v166, v42, v232
    v_dot2_f32_bf16 v233, v166, v43, v233
    v_dot2_f32_bf16 v234, v167, v42, v234
    v_dot2_f32_bf16 v235, v167, v43, v235
    v_dot2_f32_bf16 v220, v136, v44, v220
    v_dot2_f32_bf16 v221, v136, v45, v221
    v_dot2_f32_bf16 v222, v137, v44, v222
    v_dot2_f32_bf16 v223, v137, v45, v223
    v_dot2_f32_bf16 v224, v138, v44, v224
    v_dot2_f32_bf16 v225, v138, v45, v225
    v_dot2_f32_bf16 v226, v139, v44, v226
    v_dot2_f32_bf16 v227, v139, v45, v227
    v_dot2_f32_bf16 v228, v168, v44, v228
    v_dot2_f32_bf16 v229, v168, v45, v229
    s_waitcnt vmcnt(9)
    s_barrier
    s_add_u32 m0, s95, 84992
    s_nop 0
    buffer_load_dwordx4 v29, s[28:31], s93 offen offset:2048 lds
    s_bfe_u32 s91, s69, 0x4001c
    s_lshl_b32 s92, s91, 7
    s_mul_i32 s93, s91, 393216
    s_add_u32 m0, s94, 0
    s_nop 0
    buffer_load_dwordx4 v20, s[24:27], s92 offen offset:0 lds
    buffer_load_dwordx4 v21, s[24:27], s92 offen offset:1024 lds
    buffer_load_dwordx4 v22, s[24:27], s92 offen offset:2048 lds
    buffer_load_dwordx4 v23, s[24:27], s92 offen offset:3072 lds
    s_add_u32 m0, s95, 0
    s_nop 0
    buffer_load_dwordx4 v24, s[28:31], s93 offen offset:0 lds
    buffer_load_dwordx4 v25, s[28:31], s93 offen offset:1024 lds
    buffer_load_dwordx4 v26, s[28:31], s93 offen offset:2048 lds
    s_add_u32 m0, s95, 3072
    s_nop 0
    buffer_load_dwordx4 v27, s[28:31], s93 offen offset:0 lds
    buffer_load_dwordx4 v28, s[28:31], s93 offen offset:1024 lds
    buffer_load_dwordx4 v29, s[28:31], s93 offen offset:2048 lds
    v_dot2_f32_bf16 v230, v169, v44, v230
    v_dot2_f32_bf16 v231, v169, v45, v231
    v_dot2_f32_bf16 v232, v170, v44, v232
    v_dot2_f32_bf16 v233, v170, v45, v233
    v_dot2_f32_bf16 v234, v171, v44, v234
    v_dot2_f32_bf16 v235, v171, v45, v235
    v_dot2_f32_bf16 v220, v140, v46, v220
    v_dot2_f32_bf16 v221, v140, v47, v221
    v_dot2_f32_bf16 v222, v141, v46, v222
    v_dot2_f32_bf16 v223, v141, v47, v223
    v_dot2_f32_bf16 v224, v142, v46, v224
    v_dot2_f32_bf16 v225, v142, v47, v225
    v_dot2_f32_bf16 v226, v143, v46, v226
    v_dot2_f32_bf16 v227, v143, v47, v227
    v_dot2_f32_bf16 v228, v172, v46, v228
    v_dot2_f32_bf16 v229, v172, v47, v229
    v_dot2_f32_bf16 v230, v173, v46, v230
    v_dot2_f32_bf16 v231, v173, v47, v231
    v_dot2_f32_bf16 v232, v174, v46, v232
    v_dot2_f32_bf16 v233, v174, v47, v233
    v_dot2_f32_bf16 v234, v175, v46, v234
    v_dot2_f32_bf16 v235, v175, v47, v235
    v_dot2_f32_bf16 v220, v144, v48, v220
    v_dot2_f32_bf16 v221, v144, v49, v221
    v_dot2_f32_bf16 v222, v145, v48, v222
    v_dot2_f32_bf16 v223, v145, v49, v223
    v_dot2_f32_bf16 v224, v146, v48, v224
    v_dot2_f32_bf16 v225, v146, v49, v225
    v_dot2_f32_bf16 v226, v147, v48, v226
    v_dot2_f32_bf16 v227, v147, v49, v227
    v_dot2_f32_bf16 v228, v176, v48, v228
    v_dot2_f32_bf16 v229, v176, v49, v229
    v_dot2_f32_bf16 v230, v177, v48, v230
    v_dot2_f32_bf16 v231, v177, v49, v231
    v_dot2_f32_bf16 v232, v178, v48, v232
    v_dot2_f32_bf16 v233, v178, v49, v233
    v_dot2_f32_bf16 v234, v179, v48, v234
    v_dot2_f32_bf16 v235, v179, v49, v235
    v_dot2_f32_bf16 v220, v148, v50, v220
    v_dot2_f32_bf16 v221, v148, v51, v221
    v_dot2_f32_bf16 v222, v149, v50, v222
    v_dot2_f32_bf16 v223, v149, v51, v223
    v_dot2_f32_bf16 v224, v150, v50, v224
    v_dot2_f32_bf16 v225, v150, v51, v225
    v_dot2_f32_bf16 v226, v151, v50, v226
    v_dot2_f32_bf16 v227, v151, v51, v227
    v_dot2_f32_bf16 v228, v180, v50, v228
    v_dot2_f32_bf16 v229, v180, v51, v229
    v_dot2_f32_bf16 v230, v181, v50, v230
    v_dot2_f32_bf16 v231, v181, v51, v231
    v_dot2_f32_bf16 v232, v182, v50, v232
    v_dot2_f32_bf16 v233, v182, v51, v233
    v_dot2_f32_bf16 v234, v183, v50, v234
    v_dot2_f32_bf16 v235, v183, v51, v235
    v_dot2_f32_bf16 v220, v152, v52, v220
    v_dot2_f32_bf16 v221, v152, v53, v221
    v_dot2_f32_bf16 v222, v153, v52, v222
    v_dot2_f32_bf16 v223, v153, v53, v223
    s_waitcnt vmcnt(10)
    s_barrier
    s_add_u32 s12, s97, 0
    buffer_load_dwordx4 v[192:195], v31, s[64:67], s12 offen nt
    s_add_u32 s12, s97, 16384
    buffer_load_dwordx4 v[196:199], v31, s[64:67], s12 offen nt
    s_add_u32 s12, s97, 32768
    buffer_load_dwordx4 v[200:203], v31, s[64:67], s12 offen nt
    s_add_u32 s12, s97, 49152
    buffer_load_dwordx4 v[204:207], v31, s[64:67], s12 offen nt
    s_add_u32 s12, s97, 65536
    buffer_load_dwordx4 v[208:211], v31, s[64:67], s12 offen nt
    s_add_u32 s12, s97, 81920
    buffer_load_dwordx4 v[212:215], v31, s[64:67], s12 offen nt
    s_add_u32 s12, s97, 98304
    buffer_load_dwordx4 v[216:219], v31, s[64:67], s12 offen nt
    s_mul_i32 s12, s21, 8
    s_add_u32 s12, s12, 96
    s_lshl_b32 s13, s12, 10
    s_lshl_b32 s12, s12, 14
    s_add_u32 m0, s13, 24576
    s_add_u32 s90, s12, 0
    buffer_load_dwordx4 v33, s[36:39], s90 offen lds
    s_add_u32 m0, s13, 25600
    s_add_u32 s90, s12, 16384
    buffer_load_dwordx4 v33, s[36:39], s90 offen lds
    s_add_u32 m0, s13, 26624
    s_add_u32 s90, s12, 32768
    buffer_load_dwordx4 v33, s[36:39], s90 offen lds
    s_add_u32 m0, s13, 27648
    s_add_u32 s90, s12, 49152
    buffer_load_dwordx4 v33, s[36:39], s90 offen lds
    s_add_u32 m0, s13, 28672
    s_add_u32 s90, s12, 65536
    buffer_load_dwordx4 v33, s[36:39], s90 offen lds
    s_add_u32 m0, s13, 29696
    s_add_u32 s90, s12, 81920
    buffer_load_dwordx4 v33, s[36:39], s90 offen lds
    s_add_u32 m0, s13, 30720
    s_add_u32 s90, s12, 98304
    buffer_load_dwordx4 v33, s[36:39], s90 offen lds
    s_add_u32 m0, s13, 31744
    s_add_u32 s90, s12, 114688
    buffer_load_dwordx4 v33, s[36:39], s90 offen lds
    v_dot2_f32_bf16 v224, v154, v52, v224
    v_dot2_f32_bf16 v225, v154, v53, v225
    v_dot2_f32_bf16 v226, v155, v52, v226
    v_dot2_f32_bf16 v227, v155, v53, v227
    v_dot2_f32_bf16 v228, v184, v52, v228
    v_dot2_f32_bf16 v229, v184, v53, v229
    v_dot2_f32_bf16 v230, v185, v52, v230
    v_dot2_f32_bf16 v231, v185, v53, v231
    v_dot2_f32_bf16 v232, v186, v52, v232
    v_dot2_f32_bf16 v233, v186, v53, v233
    v_dot2_f32_bf16 v234, v187, v52, v234
    v_dot2_f32_bf16 v235, v187, v53, v235
    v_dot2_f32_bf16 v220, v156, v54, v220
    v_dot2_f32_bf16 v221, v156, v55, v221
    v_dot2_f32_bf16 v222, v157, v54, v222
    v_dot2_f32_bf16 v223, v157, v55, v223
    v_dot2_f32_bf16 v224, v158, v54, v224
    v_dot2_f32_bf16 v225, v158, v55, v225
    v_dot2_f32_bf16 v226, v159, v54, v226
    v_dot2_f32_bf16 v227, v159, v55, v227
    v_dot2_f32_bf16 v228, v188, v54, v228
    v_dot2_f32_bf16 v229, v188, v55, v229
    v_dot2_f32_bf16 v230, v189, v54, v230
    v_dot2_f32_bf16 v231, v189, v55, v231
    v_dot2_f32_bf16 v232, v190, v54, v232
    v_dot2_f32_bf16 v233, v190, v55, v233
    v_dot2_f32_bf16 v234, v191, v54, v234
    v_dot2_f32_bf16 v235, v191, v55, v235
    v_permlane32_swap_b32 v220, v228
    v_permlane32_swap_b32 v221, v229
    v_permlane32_swap_b32 v222, v230
    v_permlane32_swap_b32 v223, v231
    v_permlane32_swap_b32 v224, v232
    v_permlane32_swap_b32 v225, v233
    v_permlane32_swap_b32 v226, v234
    v_permlane32_swap_b32 v227, v235
    v_add_f32 v220, v220, v228
    v_add_f32 v221, v221, v229
    v_add_f32 v222, v222, v230
    v_add_f32 v223, v223, v231
    v_add_f32 v224, v224, v232
    v_add_f32 v225, v225, v233
    v_add_f32 v226, v226, v234
    v_add_f32 v227, v227, v235
    v_permlane16_swap_b32 v220, v224
    v_permlane16_swap_b32 v221, v225
    v_permlane16_swap_b32 v222, v226
    v_permlane16_swap_b32 v223, v227
    v_add_f32 v220, v220, v224
    v_add_f32 v221, v221, v225
    v_add_f32 v222, v222, v226
    v_add_f32 v223, v223, v227
    v_add_f32_dpp v220, v220, v220 row_ror:8 row_mask:0xf bank_mask:0xf
    v_add_f32_dpp v221, v221, v221 row_ror:8 row_mask:0xf bank_mask:0xf
    v_add_f32_dpp v222, v222, v222 row_ror:8 row_mask:0xf bank_mask:0xf
    v_add_f32_dpp v223, v223, v223 row_ror:8 row_mask:0xf bank_mask:0xf
    s_waitcnt vmcnt(15)
    s_barrier
L_varend:
    s_nop 0
    v_lshrrev_b32 v14, 5, v2
    v_lshlrev_b32 v14, 8, v14
    v_lshl_add_u32 v14, v6, 5, v14
    v_and_b32 v16, 16, v2
    v_add_u32 v14, v14, v16
    s_lshl_b32 s12, s21, 9
    s_add_u32 s12, s12, 159744
    v_add_u32 v14, s12, v14
    ds_write_b128 v14, v[220:223]
    v_mov_b32 v14, 162848
    v_mov_b32 v16, 1
    s_mov_b64 exec, 1
    ds_add_rtn_u32 v17, v14, v16
    s_mov_b64 exec, -1
    s_waitcnt lgkmcnt(0)
    v_readfirstlane_b32 s12, v17
    s_nop 1
    s_cmp_lg_u32 s12, 3
    s_cbranch_scc1 L_nogu
    s_cmp_ge_u32 s10, 224
    s_cbranch_scc1 L_nogu
    v_lshlrev_b32 v14, 2, v2
    v_add_u32 v14, 159744, v14
    ds_read2st64_b32 v[220:221], v14 offset0:0 offset1:1
    ds_read2st64_b32 v[222:223], v14 offset0:2 offset1:3
    ds_read2st64_b32 v[224:225], v14 offset0:4 offset1:5
    ds_read2st64_b32 v[226:227], v14 offset0:6 offset1:7
    s_and_b32 s12, s10, 3
    s_mul_i32 s12, s12, 28672
    s_lshr_b32 s13, s10, 2
    s_lshl_b32 s13, s13, 8
    s_add_u32 s12, s12, 327680
    s_xor_b32 s90, s13, 1024
    s_add_u32 s90, s90, s12
    s_add_u32 s90, s90, 14336
    s_add_u32 s12, s12, s13
    v_lshlrev_b32 v14, 2, v2
    v_and_b32 v16, 1, v2
    v_lshlrev_b32 v16, 4, v16
    v_lshrrev_b32 v16, v16, s23
    v_bfe_u32 v17, v16, 8, 8
    v_and_b32 v16, 0xff, v16
    s_mov_b32 s13, 0xffffff00
    s_waitcnt lgkmcnt(0)
    v_pk_add_f32 v[220:221], v[220:221], v[222:223]
    v_pk_add_f32 v[224:225], v[224:225], v[226:227]
    v_pk_add_f32 v[220:221], v[220:221], v[224:225]
    v_and_or_b32 v220, v220, s13, v16
    v_and_or_b32 v221, v221, s13, v17
    buffer_store_dword v220, v14, s[32:35], s12 offen sc1
    buffer_store_dword v221, v14, s[32:35], s90 offen sc1
L_nogu:
    s_mul_i32 s12, s21, 4
    s_add_u32 s12, s12, 40
    s_lshl_b32 s13, s12, 10
    s_lshl_b32 s12, s12, 14
    s_add_u32 m0, s13, 24576
    s_add_u32 s90, s12, 0
    buffer_load_dwordx4 v33, s[36:39], s90 offen lds
    s_add_u32 m0, s13, 25600
    s_add_u32 s90, s12, 16384
    buffer_load_dwordx4 v33, s[36:39], s90 offen lds
    s_add_u32 m0, s13, 26624
    s_add_u32 s90, s12, 32768
    buffer_load_dwordx4 v33, s[36:39], s90 offen lds
    s_add_u32 m0, s13, 27648
    s_add_u32 s90, s12, 49152
    buffer_load_dwordx4 v33, s[36:39], s90 offen lds
    s_mul_i32 s12, s21, 10
    s_add_u32 s12, s12, 56
    s_lshl_b32 s13, s12, 10
    s_lshl_b32 s12, s12, 14
    s_add_u32 m0, s13, 24576
    s_add_u32 s90, s12, 0
    buffer_load_dwordx4 v33, s[36:39], s90 offen lds
    s_add_u32 m0, s13, 25600
    s_add_u32 s90, s12, 16384
    buffer_load_dwordx4 v33, s[36:39], s90 offen lds
    s_add_u32 m0, s13, 26624
    s_add_u32 s90, s12, 32768
    buffer_load_dwordx4 v33, s[36:39], s90 offen lds
    s_add_u32 m0, s13, 27648
    s_add_u32 s90, s12, 49152
    buffer_load_dwordx4 v33, s[36:39], s90 offen lds
    s_add_u32 m0, s13, 28672
    s_add_u32 s90, s12, 65536
    buffer_load_dwordx4 v33, s[36:39], s90 offen lds
    s_add_u32 m0, s13, 29696
    s_add_u32 s90, s12, 81920
    buffer_load_dwordx4 v33, s[36:39], s90 offen lds
    s_add_u32 m0, s13, 30720
    s_add_u32 s90, s12, 98304
    buffer_load_dwordx4 v33, s[36:39], s90 offen lds
    s_add_u32 m0, s13, 31744
    s_add_u32 s90, s12, 114688
    buffer_load_dwordx4 v33, s[36:39], s90 offen lds
    s_add_u32 m0, s13, 32768
    s_add_u32 s90, s12, 131072
    buffer_load_dwordx4 v33, s[36:39], s90 offen lds
    s_add_u32 m0, s13, 33792
    s_add_u32 s90, s12, 147456
    buffer_load_dwordx4 v33, s[36:39], s90 offen lds
    v_mov_b32 v14, 162816
    s_mov_b32 s13, 0
L_dspin_g:
    ds_read_b128 v[104:107], v14
    s_add_u32 s13, s13, 1
    s_cmp_ge_u32 s13, 262144
    s_cbranch_scc1 L_dok_g
    s_waitcnt lgkmcnt(0)
    v_and_b32 v104, v104, v105
    v_and_b32 v106, v106, v107
    v_and_b32 v104, v104, v106
    v_cmp_eq_u32 vcc, 1, v104
    s_cbranch_vccz L_dspin_g
L_dok_g:
    s_waitcnt lgkmcnt(0)
    s_mul_i32 s12, s21, 10
    s_add_u32 s12, s12, 0
    s_lshl_b32 s13, s12, 10
    s_lshl_b32 s12, s12, 14
    s_add_u32 m0, s13, 0
    s_add_u32 s90, s12, 0
    buffer_load_dwordx4 v33, s[36:39], s90 offen lds
    s_add_u32 m0, s13, 1024
    s_add_u32 s90, s12, 16384
    buffer_load_dwordx4 v33, s[36:39], s90 offen lds
    s_add_u32 m0, s13, 2048
    s_add_u32 s90, s12, 32768
    buffer_load_dwordx4 v33, s[36:39], s90 offen lds
    s_add_u32 m0, s13, 3072
    s_add_u32 s90, s12, 49152
    buffer_load_dwordx4 v33, s[36:39], s90 offen lds
    s_add_u32 m0, s13, 4096
    s_add_u32 s90, s12, 65536
    buffer_load_dwordx4 v33, s[36:39], s90 offen lds
    s_add_u32 m0, s13, 5120
    s_add_u32 s90, s12, 81920
    buffer_load_dwordx4 v33, s[36:39], s90 offen lds
    s_add_u32 m0, s13, 6144
    s_add_u32 s90, s12, 98304
    buffer_load_dwordx4 v33, s[36:39], s90 offen lds
    s_add_u32 m0, s13, 7168
    s_add_u32 s90, s12, 114688
    buffer_load_dwordx4 v33, s[36:39], s90 offen lds
    s_add_u32 m0, s13, 8192
    s_add_u32 s90, s12, 131072
    buffer_load_dwordx4 v33, s[36:39], s90 offen lds
    s_add_u32 m0, s13, 9216
    s_add_u32 s90, s12, 147456
    buffer_load_dwordx4 v33, s[36:39], s90 offen lds
    v_mov_b32 v62, v6
    v_mov_b32 v63, v35
    s_mov_b32 s86, s96
    s_mov_b32 s4, s15
    s_mov_b32 s5, s14
    v_mov_b32 v61, v33
    s_mov_b32 s68, s58
    s_and_b32 s69, s59, 0xffff
    s_mov_b32 s70, 4194304
    s_mov_b32 s71, 0x00020000
    s_and_b32 s90, s20, 3
    s_lshr_b32 s91, s20, 2
    s_lshl_b32 s12, s88, 3
    s_lshl_b32 s13, s90, 1
    s_add_u32 s12, s12, s13
    s_add_u32 s92, s12, s91
    s_lshl_b32 s12, s92, 4
    v_and_b32 v3, 15, v2
    v_add_u32 v6, s12, v3
    v_lshlrev_b32 v8, 2, v6
    v_bfe_u32 v9, v2, 4, 1
    v_lshrrev_b32 v10, 5, v2
    v_lshlrev_b32 v7, 11, v6
    v_lshl_add_u32 v7, v9, 6, v7
    v_lshl_add_u32 v7, v10, 4, v7
    s_lshl_b32 s12, s89, 7
    v_add_u32 v7, s12, v7
    s_mov_b32 s12, 4096
    buffer_load_dwordx4 v[24:27], v7, s[24:27], 0 offen
    buffer_load_dwordx4 v[28:31], v7, s[24:27], 0 offen offset:32
    buffer_load_dword v48, v8, s[32:35], s12 offen sc1
    v_lshlrev_b32 v22, 8, v3
    v_lshl_add_u32 v22, v9, 7, v22
    v_lshl_add_u32 v22, v10, 5, v22
    v_lshlrev_b32 v10, 9, v10
    v_bfe_u32 v11, v2, 2, 2
    v_lshl_add_u32 v10, v11, 7, v10
    v_bfe_u32 v11, v2, 3, 1
    v_lshl_add_u32 v10, v11, 6, v10
    v_lshl_add_u32 v10, v9, 5, v10
    v_and_b32 v11, 3, v2
    v_lshl_add_u32 v10, v11, 3, v10
    v_xor_b32 v11, 64, v10
    s_lshl_b32 s12, s91, 8
    v_xor_b32 v17, s12, v5
    v_lshlrev_b32 v8, 2, v3
    s_lshl_b32 s12, s20, 12
    s_mov_b32 s15, 40960
    s_cmp_lt_u32 s20, 6
    s_cselect_b32 s13, s15, 131072
    s_add_u32 s12, s12, s13
    v_add_u32 v20, s12, v5
    s_xor_b32 s14, s20, 4
    s_lshl_b32 s12, s14, 12
    s_cmp_lt_u32 s14, 6
    s_cselect_b32 s13, s15, 131072
    s_add_u32 s12, s12, s13
    v_add_u32 v21, s12, v5
    s_lshl_b32 s12, s88, 2
    s_add_u32 s12, s12, s90
    s_lshl_b32 s13, s12, 16
    s_lshl_b32 s14, s91, 15
    s_add_u32 s13, s13, s14
    s_add_u32 s95, s13, 8388608
    s_lshl_b32 s12, s88, 12
    s_lshl_b32 s13, s89, 8
    s_mul_i32 s13, s13, 1
    s_add_u32 s12, s12, s13
    s_lshr_b32 s13, s90, 1
    s_lshl_b32 s13, s13, 7
    s_add_u32 s12, s12, s13
    s_lshl_b32 s13, s91, 6
    s_add_u32 s12, s12, s13
    s_add_u32 s15, s12, 524288
    s_lshl_b32 s97, s91, 4
    v_lshlrev_b32 v8, 7, v3
    s_lshl_b32 s12, s88, 1
    s_lshr_b32 s13, s90, 1
    s_add_u32 s12, s12, s13
    s_lshl_b32 s12, s12, 12
    s_lshl_b32 s13, s91, 11
    s_add_u32 s12, s12, s13
    s_and_b32 s13, s89, 0
    s_lshl_b32 s13, s13, 17
    s_add_u32 s12, s12, s13
    s_add_u32 s15, s12, 6291456
    s_mov_b32 s93, s89
    s_cmp_lg_u32 s21, 0
    s_cbranch_scc0 L_hop
    s_waitcnt vmcnt(0)
    v_sub_f32 v50, 1.0, v48
    v_cvt_pk_bf16_f32 v50, v50, v50
    v_lshlrev_b32 v50, 16, v50
    v_lshlrev_b32 v32, 16, v24
    v_and_b32 v33, 0xffff0000, v24
    v_lshlrev_b32 v34, 16, v25
    v_and_b32 v35, 0xffff0000, v25
    v_lshlrev_b32 v36, 16, v26
    v_and_b32 v37, 0xffff0000, v26
    v_lshlrev_b32 v38, 16, v27
    v_and_b32 v39, 0xffff0000, v27
    v_lshlrev_b32 v40, 16, v28
    v_and_b32 v41, 0xffff0000, v28
    v_lshlrev_b32 v42, 16, v29
    v_and_b32 v43, 0xffff0000, v29
    v_lshlrev_b32 v44, 16, v30
    v_and_b32 v45, 0xffff0000, v30
    v_lshlrev_b32 v46, 16, v31
    v_and_b32 v47, 0xffff0000, v31
    v_pk_mul_f32 v[32:33], v[32:33], v[50:51] op_sel_hi:[1,0]
    v_pk_mul_f32 v[34:35], v[34:35], v[50:51] op_sel_hi:[1,0]
    v_pk_mul_f32 v[36:37], v[36:37], v[50:51] op_sel_hi:[1,0]
    v_pk_mul_f32 v[38:39], v[38:39], v[50:51] op_sel_hi:[1,0]
    v_pk_mul_f32 v[40:41], v[40:41], v[50:51] op_sel_hi:[1,0]
    v_pk_mul_f32 v[42:43], v[42:43], v[50:51] op_sel_hi:[1,0]
    v_pk_mul_f32 v[44:45], v[44:45], v[50:51] op_sel_hi:[1,0]
    v_pk_mul_f32 v[46:47], v[46:47], v[50:51] op_sel_hi:[1,0]
    v_cvt_pk_bf16_f32 v33, v32, v33
    v_cvt_pk_bf16_f32 v35, v34, v35
    v_cvt_pk_bf16_f32 v37, v36, v37
    v_cvt_pk_bf16_f32 v39, v38, v39
    v_cvt_pk_bf16_f32 v41, v40, v41
    v_cvt_pk_bf16_f32 v43, v42, v43
    v_cvt_pk_bf16_f32 v45, v44, v45
    v_cvt_pk_bf16_f32 v47, v46, v47
    v_lshlrev_b32 v32, 16, v33
    v_and_b32 v33, 0xffff0000, v33
    v_lshlrev_b32 v34, 16, v35
    v_and_b32 v35, 0xffff0000, v35
    v_lshlrev_b32 v36, 16, v37
    v_and_b32 v37, 0xffff0000, v37
    v_lshlrev_b32 v38, 16, v39
    v_and_b32 v39, 0xffff0000, v39
    v_lshlrev_b32 v40, 16, v41
    v_and_b32 v41, 0xffff0000, v41
    v_lshlrev_b32 v42, 16, v43
    v_and_b32 v43, 0xffff0000, v43
    v_lshlrev_b32 v44, 16, v45
    v_and_b32 v45, 0xffff0000, v45
    v_lshlrev_b32 v46, 16, v47
    v_and_b32 v47, 0xffff0000, v47
    v_mov_b32 v78, 162928
    s_mov_b32 s13, 0
L_gtu:
    ds_read_b128 v[104:107], v78
    s_add_u32 s13, s13, 1
    s_cmp_ge_u32 s13, 262144
    s_cbranch_scc1 L_gxu
    s_waitcnt lgkmcnt(0)
    v_and_b32 v104, v104, v105
    v_and_b32 v106, v106, v107
    v_and_b32 v104, v104, v106
    v_cmp_eq_u32 vcc, 1, v104
    s_cbranch_vccz L_gtu
L_gxu:
    s_waitcnt lgkmcnt(0)
    s_branch L_nohop
L_hop:
    v_mov_b32 v78, 162928
    s_mov_b32 s13, 0
L_gth:
    ds_read_b128 v[104:107], v78
    s_add_u32 s13, s13, 1
    s_cmp_ge_u32 s13, 262144
    s_cbranch_scc1 L_gxh
    s_waitcnt lgkmcnt(0)
    v_and_b32 v104, v104, v105
    v_and_b32 v106, v106, v107
    v_and_b32 v104, v104, v106
    v_cmp_eq_u32 vcc, 1, v104
    s_cbranch_vccz L_gth
L_gxh:
    s_waitcnt lgkmcnt(0)
    s_lshl_b32 s12, s19, 18
    s_lshl_b32 s13, s18, 14
    s_add_u32 s12, s12, s13
    s_add_u32 s80, s12, 1048576
    s_add_u32 s81, s80, 4096
    s_add_u32 s82, s80, 8192
    s_add_u32 s83, s80, 12288
    s_mov_b32 s13, 0
    s_lshl_b32 s12, s19, 13
    s_lshr_b32 s84, s18, 2
    s_lshl_b32 s84, s84, 11
    s_add_u32 s12, s12, s84
    s_bfe_u32 s84, s18, 0x10001
    s_lshl_b32 s84, s84, 6
    s_add_u32 s12, s12, s84
    s_and_b32 s84, s18, 1
    s_lshl_b32 s84, s84, 4
    s_add_u32 s12, s12, s84
    s_add_u32 s84, s12, 5242880
    v_and_b32 v80, 15, v2
    v_lshlrev_b32 v80, 7, v80
    v_lshrrev_b32 v78, 5, v2
    v_lshl_add_u32 v80, v78, 5, v80
    s_mov_b32 s87, 0
    s_mov_b32 s85, 0xffff
L_h1:
    buffer_load_dwordx4 v[104:107], v80, s[32:35], s84 offen sc1
    s_add_u32 s13, s13, 1
    s_cmp_ge_u32 s13, 16384
    s_cbranch_scc1 L_h1ok
    s_cmp_lg_u32 s87, 0
    s_cbranch_scc1 L_h1d
    s_waitcnt vmcnt(0)
    v_msad_u8 v108, v104, s76, 0
    v_msad_u8 v108, v105, s77, v108
    v_msad_u8 v108, v106, s78, v108
    v_msad_u8 v108, v107, s79, v108
    v_cmp_ne_u32 vcc, 0, v108
    s_nop 1
    s_or_b32 s12, vcc_lo, vcc_hi
    s_and_b32 s12, s12, 0xffff
    s_bcnt1_i32_b32 s12, s12
    s_cmp_le_u32 s12, 6
    s_cselect_b32 s87, 1, 0
    s_branch L_h1
L_h1d:
    s_bitcmp1_b32 s85, 0
    s_cselect_b64 exec, -1, 0
    buffer_load_dwordx4 v[128:131], v5, s[32:35], s80 offen offset:0 sc1
    s_bitcmp1_b32 s85, 1
    s_cselect_b64 exec, -1, 0
    buffer_load_dwordx4 v[132:135], v5, s[32:35], s80 offen offset:1024 sc1
    s_bitcmp1_b32 s85, 2
    s_cselect_b64 exec, -1, 0
    buffer_load_dwordx4 v[136:139], v5, s[32:35], s80 offen offset:2048 sc1
    s_bitcmp1_b32 s85, 3
    s_cselect_b64 exec, -1, 0
    buffer_load_dwordx4 v[140:143], v5, s[32:35], s80 offen offset:3072 sc1
    s_bitcmp1_b32 s85, 4
    s_cselect_b64 exec, -1, 0
    buffer_load_dwordx4 v[144:147], v5, s[32:35], s81 offen offset:0 sc1
    s_bitcmp1_b32 s85, 5
    s_cselect_b64 exec, -1, 0
    buffer_load_dwordx4 v[148:151], v5, s[32:35], s81 offen offset:1024 sc1
    s_bitcmp1_b32 s85, 6
    s_cselect_b64 exec, -1, 0
    buffer_load_dwordx4 v[152:155], v5, s[32:35], s81 offen offset:2048 sc1
    s_bitcmp1_b32 s85, 7
    s_cselect_b64 exec, -1, 0
    buffer_load_dwordx4 v[156:159], v5, s[32:35], s81 offen offset:3072 sc1
    s_bitcmp1_b32 s85, 8
    s_cselect_b64 exec, -1, 0
    buffer_load_dwordx4 v[160:163], v5, s[32:35], s82 offen offset:0 sc1
    s_bitcmp1_b32 s85, 9
    s_cselect_b64 exec, -1, 0
    buffer_load_dwordx4 v[164:167], v5, s[32:35], s82 offen offset:1024 sc1
    s_bitcmp1_b32 s85, 10
    s_cselect_b64 exec, -1, 0
    buffer_load_dwordx4 v[168:171], v5, s[32:35], s82 offen offset:2048 sc1
    s_bitcmp1_b32 s85, 11
    s_cselect_b64 exec, -1, 0
    buffer_load_dwordx4 v[172:175], v5, s[32:35], s82 offen offset:3072 sc1
    s_bitcmp1_b32 s85, 12
    s_cselect_b64 exec, -1, 0
    buffer_load_dwordx4 v[176:179], v5, s[32:35], s83 offen offset:0 sc1
    s_bitcmp1_b32 s85, 13
    s_cselect_b64 exec, -1, 0
    buffer_load_dwordx4 v[180:183], v5, s[32:35], s83 offen offset:1024 sc1
    s_bitcmp1_b32 s85, 14
    s_cselect_b64 exec, -1, 0
    buffer_load_dwordx4 v[184:187], v5, s[32:35], s83 offen offset:2048 sc1
    s_bitcmp1_b32 s85, 15
    s_cselect_b64 exec, -1, 0
    buffer_load_dwordx4 v[188:191], v5, s[32:35], s83 offen offset:3072 sc1
    s_mov_b64 exec, -1
    s_waitcnt vmcnt(16)
    v_msad_u8 v108, v104, s76, 0
    v_msad_u8 v108, v105, s77, v108
    v_msad_u8 v108, v106, s78, v108
    v_msad_u8 v108, v107, s79, v108
    v_cmp_ne_u32 vcc, 0, v108
    s_nop 1
    s_or_b32 s85, vcc_lo, vcc_hi
    s_and_b32 s85, s85, 0xffff
    s_bcnt1_i32_b32 s12, s85
    s_cmp_le_u32 s12, 6
    s_cselect_b32 s87, 1, 0
    s_cmp_lg_u32 s85, 0
    s_waitcnt vmcnt(0)
    s_cbranch_scc1 L_h1
    v_msad_u8 v108, v128, v63, 0
    v_msad_u8 v109, v132, v63, 0
    v_msad_u8 v108, v136, v63, v108
    v_msad_u8 v109, v140, v63, v109
    v_msad_u8 v108, v144, v63, v108
    v_msad_u8 v109, v148, v63, v109
    v_msad_u8 v108, v152, v63, v108
    v_msad_u8 v109, v156, v63, v109
    v_msad_u8 v108, v160, v63, v108
    v_msad_u8 v109, v164, v63, v109
    v_msad_u8 v108, v168, v63, v108
    v_msad_u8 v109, v172, v63, v109
    v_msad_u8 v108, v176, v63, v108
    v_msad_u8 v109, v180, v63, v109
    v_msad_u8 v108, v184, v63, v108
    v_msad_u8 v109, v188, v63, v109
    v_or_b32 v108, v108, v109
    v_cmp_ne_u32 vcc, 0, v108
    s_mov_b32 s85, 0xffff
    s_cbranch_vccnz L_h1
L_h1ok:
    s_waitcnt vmcnt(0)
    v_pk_add_f32 v[128:129], v[128:129], v[160:161]
    v_pk_add_f32 v[130:131], v[130:131], v[162:163]
    v_pk_add_f32 v[132:133], v[132:133], v[164:165]
    v_pk_add_f32 v[134:135], v[134:135], v[166:167]
    v_pk_add_f32 v[136:137], v[136:137], v[168:169]
    v_pk_add_f32 v[138:139], v[138:139], v[170:171]
    v_pk_add_f32 v[140:141], v[140:141], v[172:173]
    v_pk_add_f32 v[142:143], v[142:143], v[174:175]
    v_pk_add_f32 v[144:145], v[144:145], v[176:177]
    v_pk_add_f32 v[146:147], v[146:147], v[178:179]
    v_pk_add_f32 v[148:149], v[148:149], v[180:181]
    v_pk_add_f32 v[150:151], v[150:151], v[182:183]
    v_pk_add_f32 v[152:153], v[152:153], v[184:185]
    v_pk_add_f32 v[154:155], v[154:155], v[186:187]
    v_pk_add_f32 v[156:157], v[156:157], v[188:189]
    v_pk_add_f32 v[158:159], v[158:159], v[190:191]
    v_pk_add_f32 v[128:129], v[128:129], v[144:145]
    v_pk_add_f32 v[130:131], v[130:131], v[146:147]
    v_pk_add_f32 v[132:133], v[132:133], v[148:149]
    v_pk_add_f32 v[134:135], v[134:135], v[150:151]
    v_pk_add_f32 v[136:137], v[136:137], v[152:153]
    v_pk_add_f32 v[138:139], v[138:139], v[154:155]
    v_pk_add_f32 v[140:141], v[140:141], v[156:157]
    v_pk_add_f32 v[142:143], v[142:143], v[158:159]
    v_pk_add_f32 v[128:129], v[128:129], v[136:137]
    v_pk_add_f32 v[130:131], v[130:131], v[138:139]
    v_pk_add_f32 v[132:133], v[132:133], v[140:141]
    v_pk_add_f32 v[134:135], v[134:135], v[142:143]
    v_pk_add_f32 v[128:129], v[128:129], v[132:133]
    v_pk_add_f32 v[130:131], v[130:131], v[134:135]
    v_add_f32_dpp v104, v104, v104 row_ror:1 row_mask:0xf bank_mask:0xf
    v_add_f32_dpp v105, v105, v105 row_ror:1 row_mask:0xf bank_mask:0xf
    v_add_f32_dpp v106, v106, v106 row_ror:1 row_mask:0xf bank_mask:0xf
    v_add_f32_dpp v107, v107, v107 row_ror:1 row_mask:0xf bank_mask:0xf
    v_add_f32_dpp v104, v104, v104 row_ror:2 row_mask:0xf bank_mask:0xf
    v_add_f32_dpp v105, v105, v105 row_ror:2 row_mask:0xf bank_mask:0xf
    v_add_f32_dpp v106, v106, v106 row_ror:2 row_mask:0xf bank_mask:0xf
    v_add_f32_dpp v107, v107, v107 row_ror:2 row_mask:0xf bank_mask:0xf
    v_add_f32_dpp v104, v104, v104 row_ror:4 row_mask:0xf bank_mask:0xf
    v_add_f32_dpp v105, v105, v105 row_ror:4 row_mask:0xf bank_mask:0xf
    v_add_f32_dpp v106, v106, v106 row_ror:4 row_mask:0xf bank_mask:0xf
    v_add_f32_dpp v107, v107, v107 row_ror:4 row_mask:0xf bank_mask:0xf
    v_add_f32_dpp v104, v104, v104 row_ror:8 row_mask:0xf bank_mask:0xf
    v_add_f32_dpp v105, v105, v105 row_ror:8 row_mask:0xf bank_mask:0xf
    v_add_f32_dpp v106, v106, v106 row_ror:8 row_mask:0xf bank_mask:0xf
    v_add_f32_dpp v107, v107, v107 row_ror:8 row_mask:0xf bank_mask:0xf
    v_cvt_pk_bf16_f32 v108, v128, v129
    v_cvt_pk_bf16_f32 v109, v130, v131
    v_cvt_pk_bf16_f32 v112, v104, v105
    v_cvt_pk_bf16_f32 v113, v106, v107
    v_mov_b32 v110, v108
    v_mov_b32 v111, v109
    v_mov_b32 v114, v112
    v_mov_b32 v115, v113
    s_lshl_b32 s12, s19, 13
    s_lshl_b32 s13, s18, 9
    s_add_u32 s12, s12, s13
    s_add_u32 s12, s12, 32768
    s_lshl_b32 s13, s19, 11
    s_lshl_b32 s80, s18, 7
    s_add_u32 s13, s13, s80
    s_add_u32 s13, s13, 163840
    v_permlane32_swap_b32 v108, v110
    v_permlane32_swap_b32 v109, v111
    v_permlane32_swap_b32 v112, v114
    v_permlane32_swap_b32 v113, v115
    s_mov_b32 exec_hi, 0
    buffer_store_dwordx4 v[108:111], v5, s[32:35], s12 offen sc1
    s_mov_b32 exec_lo, 255
    buffer_store_dwordx4 v[112:115], v5, s[32:35], s13 offen sc1
    s_mov_b64 exec, -1
L_nohop:
    v_min_u32 v80, 6, v62
    v_lshl_add_u32 v80, v80, 3, v4
    v_lshlrev_b32 v80, 2, v80
    s_lshl_b32 s12, s86, 2
    s_add_u32 s80, s12, 327680
    s_add_u32 s81, s80, 28672
    s_add_u32 s82, s80, 57344
    s_add_u32 s83, s80, 86016
    v_and_b32 v78, 1, v4
    v_lshlrev_b32 v78, 4, v78
    v_lshrrev_b32 v78, v78, s23
    v_bfe_u32 v79, v78, 8, 8
    v_and_b32 v78, 0xff, v78
    s_mov_b32 s13, 0
    v_add_u32 v81, 14336, v80
L_gu:
    buffer_load_dword v104, v80, s[32:35], s80 offen sc1
    buffer_load_dword v105, v81, s[32:35], s80 offen sc1
    buffer_load_dword v106, v80, s[32:35], s81 offen sc1
    buffer_load_dword v107, v81, s[32:35], s81 offen sc1
    buffer_load_dword v108, v80, s[32:35], s82 offen sc1
    buffer_load_dword v109, v81, s[32:35], s82 offen sc1
    buffer_load_dword v110, v80, s[32:35], s83 offen sc1
    buffer_load_dword v111, v81, s[32:35], s83 offen sc1
    s_add_u32 s13, s13, 1
    s_cmp_lg_u32 s21, 0
    s_cbranch_scc1 L_nofl
    s_waitcnt vmcnt(8)
    v_mov_b32 v112, 162896
    v_mov_b32 v113, 1
    s_mov_b64 exec, 1
    ds_write_b32 v112, v113
    s_mov_b64 exec, -1
L_nofl:
    s_waitcnt vmcnt(0)
    v_msad_u8 v112, v104, v78, 0
    v_msad_u8 v112, v105, v79, v112
    v_msad_u8 v112, v106, v78, v112
    v_msad_u8 v112, v107, v79, v112
    v_msad_u8 v112, v108, v78, v112
    v_msad_u8 v112, v109, v79, v112
    v_msad_u8 v112, v110, v78, v112
    v_msad_u8 v112, v111, v79, v112
    v_cmp_ne_u32 vcc, 0, v112
    s_cbranch_vccz L_guok
    s_cmp_lt_u32 s13, 16384
    s_cbranch_scc1 L_gu
L_guok:
    v_pk_add_f32 v[104:105], v[104:105], v[106:107]
    v_pk_add_f32 v[108:109], v[108:109], v[110:111]
    v_pk_add_f32 v[104:105], v[104:105], v[108:109]
    v_cvt_pk_bf16_f32 v104, v104, v105
    v_and_b32 v105, 0xffff0000, v104
    v_lshlrev_b32 v104, 16, v104
    v_mul_f32 v106, 0xbfb8aa3b, v104
    v_exp_f32 v106, v106
    s_nop 0
    v_add_f32 v106, 1.0, v106
    v_rcp_f32 v106, v106
    s_nop 0
    v_mul_f32 v106, v106, v104
    v_cvt_pk_bf16_f32 v106, v106, v106
    v_lshlrev_b32 v106, 16, v106
    v_mul_f32 v106, v106, v105
    v_cvt_pk_bf16_f32 v106, v106, v106
    ds_swizzle_b32 v64, v106 offset:0x18
    ds_swizzle_b32 v66, v106 offset:0x38
    ds_swizzle_b32 v68, v106 offset:0x58
    ds_swizzle_b32 v70, v106 offset:0x78
    ds_swizzle_b32 v72, v106 offset:0x98
    ds_swizzle_b32 v74, v106 offset:0xb8
    ds_swizzle_b32 v76, v106 offset:0xd8
    s_waitcnt lgkmcnt(0)
    v_and_b32 v65, 0xffff0000, v64
    v_and_b32 v64, 0xffff, v64
    v_and_b32 v67, 0xffff0000, v66
    v_and_b32 v66, 0xffff, v66
    v_and_b32 v69, 0xffff0000, v68
    v_and_b32 v68, 0xffff, v68
    v_and_b32 v71, 0xffff0000, v70
    v_and_b32 v70, 0xffff, v70
    v_and_b32 v73, 0xffff0000, v72
    v_and_b32 v72, 0xffff, v72
    v_and_b32 v75, 0xffff0000, v74
    v_and_b32 v74, 0xffff, v74
    v_and_b32 v77, 0xffff0000, v76
    v_and_b32 v76, 0xffff, v76
    v_dot2_f32_bf16 v220, v192, v64, 0
    v_dot2_f32_bf16 v221, v192, v65, 0
    v_dot2_f32_bf16 v222, v193, v64, 0
    v_dot2_f32_bf16 v223, v193, v65, 0
    v_dot2_f32_bf16 v224, v194, v64, 0
    v_dot2_f32_bf16 v225, v194, v65, 0
    v_dot2_f32_bf16 v226, v195, v64, 0
    v_dot2_f32_bf16 v227, v195, v65, 0
    v_dot2_f32_bf16 v220, v196, v66, v220
    v_dot2_f32_bf16 v221, v196, v67, v221
    v_dot2_f32_bf16 v222, v197, v66, v222
    v_dot2_f32_bf16 v223, v197, v67, v223
    v_dot2_f32_bf16 v224, v198, v66, v224
    v_dot2_f32_bf16 v225, v198, v67, v225
    v_dot2_f32_bf16 v226, v199, v66, v226
    v_dot2_f32_bf16 v227, v199, v67, v227
    v_dot2_f32_bf16 v220, v200, v68, v220
    v_dot2_f32_bf16 v221, v200, v69, v221
    v_dot2_f32_bf16 v222, v201, v68, v222
    v_dot2_f32_bf16 v223, v201, v69, v223
    v_dot2_f32_bf16 v224, v202, v68, v224
    v_dot2_f32_bf16 v225, v202, v69, v225
    v_dot2_f32_bf16 v226, v203, v68, v226
    v_dot2_f32_bf16 v227, v203, v69, v227
    v_dot2_f32_bf16 v220, v204, v70, v220
    v_dot2_f32_bf16 v221, v204, v71, v221
    v_dot2_f32_bf16 v222, v205, v70, v222
    v_dot2_f32_bf16 v223, v205, v71, v223
    v_dot2_f32_bf16 v224, v206, v70, v224
    v_dot2_f32_bf16 v225, v206, v71, v225
    v_dot2_f32_bf16 v226, v207, v70, v226
    v_dot2_f32_bf16 v227, v207, v71, v227
    v_dot2_f32_bf16 v220, v208, v72, v220
    v_dot2_f32_bf16 v221, v208, v73, v221
    v_dot2_f32_bf16 v222, v209, v72, v222
    v_dot2_f32_bf16 v223, v209, v73, v223
    v_dot2_f32_bf16 v224, v210, v72, v224
    v_dot2_f32_bf16 v225, v210, v73, v225
    v_dot2_f32_bf16 v226, v211, v72, v226
    v_dot2_f32_bf16 v227, v211, v73, v227
    v_dot2_f32_bf16 v220, v212, v74, v220
    v_dot2_f32_bf16 v221, v212, v75, v221
    v_dot2_f32_bf16 v222, v213, v74, v222
    v_dot2_f32_bf16 v223, v213, v75, v223
    v_dot2_f32_bf16 v224, v214, v74, v224
    v_dot2_f32_bf16 v225, v214, v75, v225
    v_dot2_f32_bf16 v226, v215, v74, v226
    v_dot2_f32_bf16 v227, v215, v75, v227
    v_dot2_f32_bf16 v220, v216, v76, v220
    v_dot2_f32_bf16 v221, v216, v77, v221
    v_dot2_f32_bf16 v222, v217, v76, v222
    v_dot2_f32_bf16 v223, v217, v77, v223
    v_dot2_f32_bf16 v224, v218, v76, v224
    v_dot2_f32_bf16 v225, v218, v77, v225
    v_dot2_f32_bf16 v226, v219, v76, v226
    v_dot2_f32_bf16 v227, v219, v77, v227
    v_permlane32_swap_b32 v220, v224
    v_permlane32_swap_b32 v221, v225
    v_permlane32_swap_b32 v222, v226
    v_permlane32_swap_b32 v223, v227
    v_add_f32 v220, v220, v224
    v_add_f32 v221, v221, v225
    v_add_f32 v222, v222, v226
    v_add_f32 v223, v223, v227
    s_nop 0
    v_permlane16_swap_b32 v220, v222
    v_permlane16_swap_b32 v221, v223
    v_add_f32 v220, v220, v222
    v_add_f32 v221, v221, v223
    s_nop 0
    v_add_f32_dpp v220, v220, v220 row_ror:8 row_mask:0xf bank_mask:0xf
    v_add_f32_dpp v221, v221, v221 row_ror:8 row_mask:0xf bank_mask:0xf
    v_lshrrev_b32 v80, 4, v2
    v_lshlrev_b32 v80, 3, v80
    v_lshl_add_u32 v80, v62, 5, v80
    s_lshl_b32 s12, s21, 8
    s_add_u32 s12, s12, 161792
    v_add_u32 v80, s12, v80
    ds_write_b64 v80, v[220:221]
    v_mov_b32 v80, 162848
    v_mov_b32 v78, 1
    s_mov_b64 exec, 1
    ds_add_rtn_u32 v79, v80, v78 offset:4
    s_mov_b64 exec, -1
    s_waitcnt lgkmcnt(0)
    v_readfirstlane_b32 s12, v79
    s_nop 1
    s_cmp_lg_u32 s12, 3
    s_cbranch_scc1 L_noy
    v_lshlrev_b32 v78, 2, v2
    v_add_u32 v80, 161792, v78
    ds_read2st64_b32 v[220:221], v80 offset0:0 offset1:1
    ds_read2st64_b32 v[222:223], v80 offset0:2 offset1:3
    s_lshl_b32 s12, s11, 8
    s_add_u32 s12, s12, 458752
    s_mov_b32 s13, 0xffffff00
    s_waitcnt lgkmcnt(0)
    v_pk_add_f32 v[220:221], v[220:221], v[222:223]
    v_add_f32 v220, v220, v221
    v_and_or_b32 v220, v220, s13, v63
    buffer_store_dword v220, v78, s[32:35], s12 offen sc1
L_noy:
    s_cmp_lg_u32 s21, 0
    s_cbranch_scc1 L_prepd
    s_waitcnt vmcnt(0)
    v_sub_f32 v50, 1.0, v48
    v_cvt_pk_bf16_f32 v50, v50, v50
    v_lshlrev_b32 v50, 16, v50
    v_lshlrev_b32 v32, 16, v24
    v_and_b32 v33, 0xffff0000, v24
    v_lshlrev_b32 v34, 16, v25
    v_and_b32 v35, 0xffff0000, v25
    v_lshlrev_b32 v36, 16, v26
    v_and_b32 v37, 0xffff0000, v26
    v_lshlrev_b32 v38, 16, v27
    v_and_b32 v39, 0xffff0000, v27
    v_lshlrev_b32 v40, 16, v28
    v_and_b32 v41, 0xffff0000, v28
    v_lshlrev_b32 v42, 16, v29
    v_and_b32 v43, 0xffff0000, v29
    v_lshlrev_b32 v44, 16, v30
    v_and_b32 v45, 0xffff0000, v30
    v_lshlrev_b32 v46, 16, v31
    v_and_b32 v47, 0xffff0000, v31
    v_pk_mul_f32 v[32:33], v[32:33], v[50:51] op_sel_hi:[1,0]
    v_pk_mul_f32 v[34:35], v[34:35], v[50:51] op_sel_hi:[1,0]
    v_pk_mul_f32 v[36:37], v[36:37], v[50:51] op_sel_hi:[1,0]
    v_pk_mul_f32 v[38:39], v[38:39], v[50:51] op_sel_hi:[1,0]
    v_pk_mul_f32 v[40:41], v[40:41], v[50:51] op_sel_hi:[1,0]
    v_pk_mul_f32 v[42:43], v[42:43], v[50:51] op_sel_hi:[1,0]
    v_pk_mul_f32 v[44:45], v[44:45], v[50:51] op_sel_hi:[1,0]
    v_pk_mul_f32 v[46:47], v[46:47], v[50:51] op_sel_hi:[1,0]
    v_cvt_pk_bf16_f32 v33, v32, v33
    v_cvt_pk_bf16_f32 v35, v34, v35
    v_cvt_pk_bf16_f32 v37, v36, v37
    v_cvt_pk_bf16_f32 v39, v38, v39
    v_cvt_pk_bf16_f32 v41, v40, v41
    v_cvt_pk_bf16_f32 v43, v42, v43
    v_cvt_pk_bf16_f32 v45, v44, v45
    v_cvt_pk_bf16_f32 v47, v46, v47
    v_lshlrev_b32 v32, 16, v33
    v_and_b32 v33, 0xffff0000, v33
    v_lshlrev_b32 v34, 16, v35
    v_and_b32 v35, 0xffff0000, v35
    v_lshlrev_b32 v36, 16, v37
    v_and_b32 v37, 0xffff0000, v37
    v_lshlrev_b32 v38, 16, v39
    v_and_b32 v39, 0xffff0000, v39
    v_lshlrev_b32 v40, 16, v41
    v_and_b32 v41, 0xffff0000, v41
    v_lshlrev_b32 v42, 16, v43
    v_and_b32 v43, 0xffff0000, v43
    v_lshlrev_b32 v44, 16, v45
    v_and_b32 v45, 0xffff0000, v45
    v_lshlrev_b32 v46, 16, v47
    v_and_b32 v47, 0xffff0000, v47
L_prepd:
    s_mov_b32 s21, s4
    s_mov_b32 s22, s5
    s_mov_b32 s45, 0
    s_lshr_b32 s12, s21, 4
    s_cmp_eq_u32 s12, s92
    s_cselect_b32 s46, 1, 0
    s_cbranch_scc0 L_b_noownl
    s_lshl_b32 s12, s89, 12
    s_add_u32 s12, s12, 458752
    buffer_load_dwordx4 v[224:227], v22, s[32:35], s12 offen offset:0 sc1
    buffer_load_dwordx4 v[228:231], v22, s[32:35], s12 offen offset:16 sc1
    buffer_load_dwordx4 v[232:235], v22, s[32:35], s12 offen offset:64 sc1
    buffer_load_dwordx4 v[236:239], v22, s[32:35], s12 offen offset:80 sc1
L_b_noownl:
    s_branch L_phaseb
L_compute:
    s_setprio 1
    s_lshr_b32 s21, s20, 1
    s_and_b32 s22, s20, 1
    v_lshrrev_b32 v3, 5, v2
    v_and_b32 v4, 31, v2
    s_lshl_b32 s12, s21, 13
    v_lshlrev_b32 v6, 7, v4
    v_add_u32 v6, s12, v6
    v_bfe_u32 v7, v2, 1, 3
    v_add_u32 v8, 0, v3
    v_xor_b32 v8, v8, v7
    v_lshl_add_u32 v20, v8, 4, v6
    v_add_u32 v8, 2, v3
    v_xor_b32 v8, v8, v7
    v_lshl_add_u32 v21, v8, 4, v6
    v_add_u32 v8, 4, v3
    v_xor_b32 v8, v8, v7
    v_lshl_add_u32 v22, v8, 4, v6
    v_add_u32 v8, 6, v3
    v_xor_b32 v8, v8, v7
    v_lshl_add_u32 v23, v8, 4, v6
    v_lshlrev_b32 v6, 10, v3
    v_bfe_u32 v7, v2, 2, 2
    v_lshl_add_u32 v6, v7, 7, v6
    v_bfe_u32 v8, v2, 3, 1
    v_xor_b32 v8, s22, v8
    v_lshl_add_u32 v6, v8, 6, v6
    v_bfe_u32 v8, v2, 4, 1
    v_lshlrev_b32 v8, 5, v8
    v_and_b32 v9, 3, v2
    v_lshl_add_u32 v8, v9, 3, v8
    v_add_u32 v6, v6, v8
    v_add_u32 v36, 16384, v6
    v_lshl_add_u32 v7, v3, 2, v7
    v_lshl_add_u32 v12, v7, 6, v8
    s_lshl_b32 s12, s22, 11
    s_add_u32 s12, s12, 155648
    v_add_u32 v12, s12, v12
    v_lshlrev_b32 v6, 14, v3
    v_lshl_add_u32 v6, v4, 4, v6
    v_lshlrev_b32 v7, 9, v3
    s_lshl_b32 s12, s22, 3
    s_lshl_b32 s13, s21, 2
    s_add_u32 s12, s12, s13
    s_lshl_b32 s13, s12, 14
    s_lshl_b32 s14, s19, 18
    s_add_u32 s13, s13, s14
    s_lshl_b32 s14, s18, 10
    s_add_u32 s13, s13, s14
    s_add_u32 s40, s13, 1048576
    s_add_u32 s41, s40, 32768
    s_lshl_b32 s13, s12, 9
    s_lshl_b32 s14, s19, 13
    s_add_u32 s13, s13, s14
    s_lshl_b32 s14, s18, 5
    s_add_u32 s13, s13, s14
    s_add_u32 s42, s13, 5242880
    s_add_u32 s43, s42, 1024
    s_lshl_b32 s13, s21, 4
    s_lshl_b32 s44, 1, s13
    s_xor_b32 s13, s13, 16
    s_lshl_b32 s45, 1, s13
    s_lshl_b32 s13, s22, 1
    s_add_u32 s13, s13, s21
    s_lshl_b32 s13, s13, 11
    s_lshl_b32 s14, s19, 13
    s_add_u32 s13, s13, s14
    s_lshl_b32 s14, s18, 7
    s_add_u32 s13, s13, s14
    s_add_u32 s42, s13, 5242880
    s_mov_b32 s45, 0x10001
    v_lshlrev_b32 v7, 2, v2
    v_mov_b32 v68, 0
    v_mov_b32 v69, 0
    v_mov_b32 v70, 0
    v_mov_b32 v71, 0
    v_mov_b32 v160, 0
    v_mov_b32 v161, 0
    v_mov_b32 v162, 0
    v_mov_b32 v163, 0
    v_mov_b32 v164, 0
    v_mov_b32 v165, 0
    v_mov_b32 v166, 0
    v_mov_b32 v167, 0
    v_mov_b32 v168, 0
    v_mov_b32 v169, 0
    v_mov_b32 v170, 0
    v_mov_b32 v171, 0
    v_mov_b32 v172, 0
    v_mov_b32 v173, 0
    v_mov_b32 v174, 0
    v_mov_b32 v175, 0
    v_mov_b32 v176, 0
    v_mov_b32 v177, 0
    v_mov_b32 v178, 0
    v_mov_b32 v179, 0
    v_mov_b32 v180, 0
    v_mov_b32 v181, 0
    v_mov_b32 v182, 0
    v_mov_b32 v183, 0
    v_mov_b32 v184, 0
    v_mov_b32 v185, 0
    v_mov_b32 v186, 0
    v_mov_b32 v187, 0
    v_mov_b32 v188, 0
    v_mov_b32 v189, 0
    v_mov_b32 v190, 0
    v_mov_b32 v191, 0
    v_mov_b32 v192, 0
    v_mov_b32 v193, 0
    v_mov_b32 v194, 0
    v_mov_b32 v195, 0
    v_mov_b32 v196, 0
    v_mov_b32 v197, 0
    v_mov_b32 v198, 0
    v_mov_b32 v199, 0
    v_mov_b32 v200, 0
    v_mov_b32 v201, 0
    v_mov_b32 v202, 0
    v_mov_b32 v203, 0
    v_mov_b32 v204, 0
    v_mov_b32 v205, 0
    v_mov_b32 v206, 0
    v_mov_b32 v207, 0
    v_mov_b32 v208, 0
    v_mov_b32 v209, 0
    v_mov_b32 v210, 0
    v_mov_b32 v211, 0
    v_mov_b32 v212, 0
    v_mov_b32 v213, 0
    v_mov_b32 v214, 0
    v_mov_b32 v215, 0
    v_mov_b32 v216, 0
    v_mov_b32 v217, 0
    v_mov_b32 v218, 0
    v_mov_b32 v219, 0
    v_mov_b32 v220, 0
    v_mov_b32 v221, 0
    v_mov_b32 v222, 0
    v_mov_b32 v223, 0
    v_mov_b32 v224, 0
    v_mov_b32 v225, 0
    v_mov_b32 v226, 0
    v_mov_b32 v227, 0
    v_mov_b32 v228, 0
    v_mov_b32 v229, 0
    v_mov_b32 v230, 0
    v_mov_b32 v231, 0
    v_mov_b32 v232, 0
    v_mov_b32 v233, 0
    v_mov_b32 v234, 0
    v_mov_b32 v235, 0
    v_mov_b32 v236, 0
    v_mov_b32 v237, 0
    v_mov_b32 v238, 0
    v_mov_b32 v239, 0
    v_mov_b32 v240, 0
    v_mov_b32 v241, 0
    v_mov_b32 v242, 0
    v_mov_b32 v243, 0
    v_mov_b32 v244, 0
    v_mov_b32 v245, 0
    v_mov_b32 v246, 0
    v_mov_b32 v247, 0
    v_mov_b32 v248, 0
    v_mov_b32 v249, 0
    v_mov_b32 v250, 0
    v_mov_b32 v251, 0
    v_mov_b32 v252, 0
    v_mov_b32 v253, 0
    v_mov_b32 v254, 0
    v_mov_b32 v255, 0
    v_lshlrev_b32 v8, 2, v3
    v_sub_u32 v8, v4, v8
    v_mov_b32 v9, 0x3f80
    v_mov_b32 v10, 0x3f800000
    v_cmp_eq_u32 vcc, 0, v8
    s_nop 1
    v_cndmask_b32 v11, 0, v9, vcc
    v_cmp_eq_u32 vcc, 1, v8
    s_nop 1
    v_cndmask_b32 v48, v11, v10, vcc
    v_cmp_eq_u32 vcc, 2, v8
    s_nop 1
    v_cndmask_b32 v11, 0, v9, vcc
    v_cmp_eq_u32 vcc, 3, v8
    s_nop 1
    v_cndmask_b32 v49, v11, v10, vcc
    v_cmp_eq_u32 vcc, 8, v8
    s_nop 1
    v_cndmask_b32 v11, 0, v9, vcc
    v_cmp_eq_u32 vcc, 9, v8
    s_nop 1
    v_cndmask_b32 v50, v11, v10, vcc
    v_cmp_eq_u32 vcc, 10, v8
    s_nop 1
    v_cndmask_b32 v11, 0, v9, vcc
    v_cmp_eq_u32 vcc, 11, v8
    s_nop 1
    v_cndmask_b32 v51, v11, v10, vcc
    v_cmp_eq_u32 vcc, 16, v8
    s_nop 1
    v_cndmask_b32 v11, 0, v9, vcc
    v_cmp_eq_u32 vcc, 17, v8
    s_nop 1
    v_cndmask_b32 v52, v11, v10, vcc
    v_cmp_eq_u32 vcc, 18, v8
    s_nop 1
    v_cndmask_b32 v11, 0, v9, vcc
    v_cmp_eq_u32 vcc, 19, v8
    s_nop 1
    v_cndmask_b32 v53, v11, v10, vcc
    v_cmp_eq_u32 vcc, 24, v8
    s_nop 1
    v_cndmask_b32 v11, 0, v9, vcc
    v_cmp_eq_u32 vcc, 25, v8
    s_nop 1
    v_cndmask_b32 v54, v11, v10, vcc
    v_cmp_eq_u32 vcc, 26, v8
    s_nop 1
    v_cndmask_b32 v11, 0, v9, vcc
    v_cmp_eq_u32 vcc, 27, v8
    s_nop 1
    v_cndmask_b32 v55, v11, v10, vcc
    v_mov_b32 v9, 0x3f803f80
    v_cmp_gt_u32 vcc, 16, v4
    s_nop 1
    v_cndmask_b32 v56, 0, v9, vcc
    v_cndmask_b32 v60, v9, 0, vcc
    v_cndmask_b32 v57, 0, v9, vcc
    v_cndmask_b32 v61, v9, 0, vcc
    v_cndmask_b32 v58, 0, v9, vcc
    v_cndmask_b32 v62, v9, 0, vcc
    v_cndmask_b32 v59, 0, v9, vcc
    v_cndmask_b32 v63, v9, 0, vcc
    s_waitcnt lgkmcnt(0)
    s_mov_b32 s32, s62
    s_and_b32 s33, s63, 0xffff
    s_mov_b32 s34, 33554432
    s_mov_b32 s35, 0x00020000
    s_mov_b32 s24, s4
    s_and_b32 s25, s5, 0xffff
    s_mov_b32 s26, 4194304
    s_mov_b32 s27, 0x00020000
    s_cmp_lg_u32 s20, 0
    s_cbranch_scc1 L_c_noinit
    v_add_u32 v8, 162816, v5
    s_mov_b64 exec, 0xff
    ds_write_b128 v8, v[68:71]
    s_mov_b64 exec, -1
    s_cmp_lg_u32 s2, 0
    s_cbranch_scc1 L_c_noinit
    s_mov_b32 s72, s60
    s_and_b32 s73, s61, 0xffff
    s_mov_b32 s74, 256
    s_mov_b32 s75, 0x00020000
    s_memrealtime s[14:15]
    s_waitcnt lgkmcnt(0)
    s_mul_i32 s14, s14, 0x9e3779b1
    s_or_b32 s14, s14, 0x01010101
    v_mov_b32 v8, s14
    s_mov_b64 exec, 1
    buffer_store_dword v8, v68, s[72:75], 0 offen offset:4 sc1
    s_mov_b64 exec, -1
L_c_noinit:
    s_lshl_b32 s14, s22, 1
    s_add_u32 s15, s14, s21
    s_xor_b32 s14, s15, 1
    s_mul_i32 s14, s14, 4352
    s_mul_i32 s15, s15, 4352
    s_add_u32 s14, s14, 40960
    s_add_u32 s15, s15, 40960
    v_add_u32 v8, s14, v5
    v_add_u32 v9, s15, v5
    v_lshlrev_b32 v11, 4, v3
    v_add_u32 v10, s14, v11
    v_add_u32 v11, s15, v11
    s_lshl_b32 s14, s20, 2
    s_add_u32 s15, s14, 162832
    v_mov_b32 v13, s15
    v_xor_b32 v14, 8, v13
    v_subrev_u32 v17, 16, v13
    v_mov_b32 v15, 1
    v_bfe_u32 v16, v2, 4, 1
    v_cmp_eq_u32 vcc, s21, v16
    s_nop 1
    v_cndmask_b32 v10, v10, v11, vcc
    s_lshl_b32 s14, s21, 7
    v_add_u32 v10, s14, v10
    v_lshrrev_b32 v11, 2, v5
    v_sub_u32 v16, v9, v5
    v_add_u32 v11, v16, v11
    s_waitcnt lgkmcnt(0)
    s_barrier
    ds_read_b128 v[100:103], v20
    ds_read_b64_tr_b16 v[108:109], v36 offset:0
    ds_read_b64_tr_b16 v[110:111], v36 offset:512
    ds_read_b128 v[104:107], v20 offset:4096
    ds_read_b64_tr_b16 v[112:113], v36 offset:8192
    ds_read_b64_tr_b16 v[114:115], v36 offset:8704
    ds_read_b64_tr_b16 v[116:117], v36 offset:16384
    ds_read_b64_tr_b16 v[118:119], v36 offset:16896
    s_mov_b32 s48, 0
    s_mov_b32 s49, 0
.p2align 3
L_c_loop:
    s_add_u32 s49, s49, 1
    s_cmp_eq_u32 s49, 3
    s_mov_b32 s50, 40960
    s_cselect_b32 s50, 4294885376, s50
    s_cselect_b32 s49, 0, s49
    s_waitcnt lgkmcnt(5)
    v_mfma_f32_32x32x16_bf16 v[160:175], v[108:111], v[100:103], v[160:175]
    ds_read_b128 v[120:123], v21
    ds_read_b64_tr_b16 v[128:129], v36 offset:2048
    s_waitcnt lgkmcnt(6)
    v_mfma_f32_32x32x16_bf16 v[176:191], v[108:111], v[104:107], v[176:191]
    ds_read_b64_tr_b16 v[130:131], v36 offset:2560
    s_waitcnt lgkmcnt(5)
    v_mfma_f32_32x32x16_bf16 v[192:207], v[112:115], v[100:103], v[192:207]
    ds_read_b128 v[124:127], v21 offset:4096
    v_mfma_f32_32x32x16_bf16 v[208:223], v[112:115], v[104:107], v[208:223]
    ds_read_b64_tr_b16 v[132:133], v36 offset:10240
    ds_read_b64_tr_b16 v[134:135], v36 offset:10752
    s_waitcnt lgkmcnt(6)
    v_mfma_f32_32x32x16_bf16 v[224:239], v[100:103], v[116:119], v[224:239]
    ds_read_b64_tr_b16 v[136:137], v36 offset:18432
    v_add_u32 v21, s50, v21
    v_mfma_f32_32x32x16_bf16 v[240:255], v[104:107], v[116:119], v[240:255]
    ds_read_b64_tr_b16 v[138:139], v36 offset:18944
    v_add_u32 v20, s50, v20
    s_waitcnt lgkmcnt(5)
    v_mfma_f32_32x32x16_bf16 v[160:175], v[128:131], v[120:123], v[160:175]
    ds_read_b128 v[100:103], v22
    ds_read_b64_tr_b16 v[108:109], v36 offset:4096
    s_waitcnt lgkmcnt(6)
    v_mfma_f32_32x32x16_bf16 v[176:191], v[128:131], v[124:127], v[176:191]
    ds_read_b64_tr_b16 v[110:111], v36 offset:4608
    s_waitcnt lgkmcnt(5)
    v_mfma_f32_32x32x16_bf16 v[192:207], v[132:135], v[120:123], v[192:207]
    ds_read_b128 v[104:107], v22 offset:4096
    v_mfma_f32_32x32x16_bf16 v[208:223], v[132:135], v[124:127], v[208:223]
    ds_read_b64_tr_b16 v[112:113], v36 offset:12288
    ds_read_b64_tr_b16 v[114:115], v36 offset:12800
    s_waitcnt lgkmcnt(6)
    v_mfma_f32_32x32x16_bf16 v[224:239], v[120:123], v[136:139], v[224:239]
    ds_read_b64_tr_b16 v[116:117], v36 offset:20480
    v_add_u32 v22, s50, v22
    v_mfma_f32_32x32x16_bf16 v[240:255], v[124:127], v[136:139], v[240:255]
    ds_read_b64_tr_b16 v[118:119], v36 offset:20992
    s_waitcnt lgkmcnt(5)
    v_mfma_f32_32x32x16_bf16 v[160:175], v[108:111], v[100:103], v[160:175]
    ds_read_b128 v[120:123], v23
    ds_read_b64_tr_b16 v[128:129], v36 offset:6144
    ds_read_b64_tr_b16 v[130:131], v36 offset:6656
    s_waitcnt lgkmcnt(7)
    v_mfma_f32_32x32x16_bf16 v[176:191], v[108:111], v[104:107], v[176:191]
    ds_read_b128 v[124:127], v23 offset:4096
    ds_read_b64_tr_b16 v[132:133], v36 offset:14336
    ds_read_b64_tr_b16 v[134:135], v36 offset:14848
    s_waitcnt lgkmcnt(8)
    v_mfma_f32_32x32x16_bf16 v[192:207], v[112:115], v[100:103], v[192:207]
    ds_read_b64_tr_b16 v[136:137], v36 offset:22528
    ds_read_b64_tr_b16 v[138:139], v36 offset:23040
    v_mfma_f32_32x32x16_bf16 v[208:223], v[112:115], v[104:107], v[208:223]
    s_waitcnt lgkmcnt(8)
    v_mfma_f32_32x32x16_bf16 v[224:239], v[100:103], v[116:119], v[224:239]
    v_add_u32 v23, s50, v23
    v_mfma_f32_32x32x16_bf16 v[240:255], v[104:107], v[116:119], v[240:255]
    v_add_u32 v36, s50, v36
    s_waitcnt lgkmcnt(0)
    v_mfma_f32_32x32x16_bf16 v[160:175], v[128:131], v[120:123], v[160:175]
    s_barrier
    ds_read_b128 v[100:103], v20
    ds_read_b64_tr_b16 v[108:109], v36 offset:0
    ds_read_b64_tr_b16 v[110:111], v36 offset:512
    v_mfma_f32_32x32x16_bf16 v[176:191], v[128:131], v[124:127], v[176:191]
    ds_read_b128 v[104:107], v20 offset:4096
    ds_read_b64_tr_b16 v[112:113], v36 offset:8192
    ds_read_b64_tr_b16 v[114:115], v36 offset:8704
    v_mfma_f32_32x32x16_bf16 v[192:207], v[132:135], v[120:123], v[192:207]
    ds_read_b64_tr_b16 v[116:117], v36 offset:16384
    ds_read_b64_tr_b16 v[118:119], v36 offset:16896
    v_mfma_f32_32x32x16_bf16 v[208:223], v[132:135], v[124:127], v[208:223]
    v_mfma_f32_32x32x16_bf16 v[224:239], v[120:123], v[136:139], v[224:239]
    s_add_u32 s48, s48, 1
    s_cmp_lt_u32 s48, 15
    v_mfma_f32_32x32x16_bf16 v[240:255], v[124:127], v[136:139], v[240:255]
    s_cbranch_scc1 L_c_loop
    s_waitcnt lgkmcnt(5)
    v_mfma_f32_32x32x16_bf16 v[160:175], v[108:111], v[100:103], v[160:175]
    ds_read_b128 v[120:123], v21
    ds_read_b64_tr_b16 v[128:129], v36 offset:2048
    s_waitcnt lgkmcnt(6)
    v_mfma_f32_32x32x16_bf16 v[176:191], v[108:111], v[104:107], v[176:191]
    ds_read_b64_tr_b16 v[130:131], v36 offset:2560
    s_waitcnt lgkmcnt(5)
    v_mfma_f32_32x32x16_bf16 v[192:207], v[112:115], v[100:103], v[192:207]
    ds_read_b128 v[124:127], v21 offset:4096
    v_mfma_f32_32x32x16_bf16 v[208:223], v[112:115], v[104:107], v[208:223]
    ds_read_b64_tr_b16 v[132:133], v36 offset:10240
    ds_read_b64_tr_b16 v[134:135], v36 offset:10752
    s_waitcnt lgkmcnt(6)
    v_mfma_f32_32x32x16_bf16 v[224:239], v[100:103], v[116:119], v[224:239]
    ds_read_b64_tr_b16 v[136:137], v36 offset:18432
    v_mfma_f32_32x32x16_bf16 v[240:255], v[104:107], v[116:119], v[240:255]
    ds_read_b64_tr_b16 v[138:139], v36 offset:18944
    s_waitcnt lgkmcnt(5)
    v_mfma_f32_32x32x16_bf16 v[160:175], v[128:131], v[120:123], v[160:175]
    ds_read_b128 v[100:103], v22
    ds_read_b64_tr_b16 v[108:109], v36 offset:4096
    s_waitcnt lgkmcnt(6)
    v_mfma_f32_32x32x16_bf16 v[176:191], v[128:131], v[124:127], v[176:191]
    ds_read_b64_tr_b16 v[110:111], v36 offset:4608
    s_waitcnt lgkmcnt(5)
    v_mfma_f32_32x32x16_bf16 v[192:207], v[132:135], v[120:123], v[192:207]
    ds_read_b128 v[104:107], v22 offset:4096
    v_mfma_f32_32x32x16_bf16 v[208:223], v[132:135], v[124:127], v[208:223]
    ds_read_b64_tr_b16 v[112:113], v36 offset:12288
    ds_read_b64_tr_b16 v[114:115], v36 offset:12800
    s_waitcnt lgkmcnt(6)
    v_mfma_f32_32x32x16_bf16 v[224:239], v[120:123], v[136:139], v[224:239]
    ds_read_b64_tr_b16 v[116:117], v36 offset:20480
    v_mfma_f32_32x32x16_bf16 v[240:255], v[124:127], v[136:139], v[240:255]
    ds_read_b64_tr_b16 v[118:119], v36 offset:20992
    s_waitcnt lgkmcnt(5)
    v_mfma_f32_32x32x16_bf16 v[160:175], v[108:111], v[100:103], v[160:175]
    ds_read_b128 v[120:123], v23
    ds_read_b64_tr_b16 v[128:129], v36 offset:6144
    ds_read_b64_tr_b16 v[130:131], v36 offset:6656
    s_waitcnt lgkmcnt(7)
    v_mfma_f32_32x32x16_bf16 v[176:191], v[108:111], v[104:107], v[176:191]
    ds_read_b128 v[124:127], v23 offset:4096
    ds_read_b64_tr_b16 v[132:133], v36 offset:14336
    ds_read_b64_tr_b16 v[134:135], v36 offset:14848
    s_waitcnt lgkmcnt(8)
    v_mfma_f32_32x32x16_bf16 v[192:207], v[112:115], v[100:103], v[192:207]
    ds_read_b64_tr_b16 v[136:137], v36 offset:22528
    ds_read_b64_tr_b16 v[138:139], v36 offset:23040
    v_mfma_f32_32x32x16_bf16 v[208:223], v[112:115], v[104:107], v[208:223]
    s_waitcnt lgkmcnt(8)
    v_mfma_f32_32x32x16_bf16 v[224:239], v[100:103], v[116:119], v[224:239]
    v_mfma_f32_32x32x16_bf16 v[240:255], v[104:107], v[116:119], v[240:255]
    s_waitcnt lgkmcnt(0)
    v_mfma_f32_32x32x16_bf16 v[160:175], v[128:131], v[120:123], v[160:175]
    s_mov_b64 exec, 1
    ds_write_b32 v17, v15
    s_mov_b64 exec, -1
    ds_read_b64_tr_b16 v[40:41], v12 offset:0
    ds_read_b64_tr_b16 v[42:43], v12 offset:512
    ds_read_b64_tr_b16 v[44:45], v12 offset:1024
    ds_read_b64_tr_b16 v[46:47], v12 offset:1536
    v_mov_b32 v16, 162864
    ds_read_b96 v[24:26], v16
    v_mfma_f32_32x32x16_bf16 v[176:191], v[128:131], v[124:127], v[176:191]
    v_mfma_f32_32x32x16_bf16 v[192:207], v[132:135], v[120:123], v[192:207]
    v_mfma_f32_32x32x16_bf16 v[208:223], v[132:135], v[124:127], v[208:223]
    v_mfma_f32_32x32x16_bf16 v[224:239], v[120:123], v[136:139], v[224:239]
    v_mfma_f32_32x32x16_bf16 v[240:255], v[124:127], v[136:139], v[240:255]
    s_mov_b32 s48, 0x3fb8aa3b
    s_mov_b32 s52, 0xbfb8aa3b
    s_nop 6
    v_cvt_pk_bf16_f32 v64, v192, v193
    v_cvt_pk_bf16_f32 v65, v194, v195
    v_cvt_pk_bf16_f32 v66, v196, v197
    v_cvt_pk_bf16_f32 v67, v198, v199
    v_cvt_pk_bf16_f32 v68, v200, v201
    v_cvt_pk_bf16_f32 v69, v202, v203
    v_cvt_pk_bf16_f32 v70, v204, v205
    v_cvt_pk_bf16_f32 v71, v206, v207
    s_waitcnt lgkmcnt(0)
    v_mfma_f32_32x32x16_bf16 v[192:207], v[40:43], v[64:67], 0
    v_mfma_f32_32x32x16_bf16 v[192:207], v[44:47], v[68:71], v[192:207]
    v_cvt_pk_bf16_f32 v72, v208, v209
    v_cvt_pk_bf16_f32 v73, v210, v211
    v_cvt_pk_bf16_f32 v74, v212, v213
    v_cvt_pk_bf16_f32 v75, v214, v215
    v_cvt_pk_bf16_f32 v76, v216, v217
    v_cvt_pk_bf16_f32 v77, v218, v219
    v_cvt_pk_bf16_f32 v78, v220, v221
    v_cvt_pk_bf16_f32 v79, v222, v223
    v_mfma_f32_32x32x16_bf16 v[208:223], v[40:43], v[72:75], 0
    s_nop 0
    v_mfma_f32_32x32x16_bf16 v[208:223], v[44:47], v[76:79], v[208:223]
    v_readfirstlane_b32 s72, v24
    v_readfirstlane_b32 s73, v25
    v_readfirstlane_b32 s74, v26
    v_and_b32 v27, 3, v2
    v_lshlrev_b32 v27, 3, v27
    v_bfe_u32 v27, v26, v27, 8
    v_mov_b32 v28, 0xffffff00
    s_and_b32 s76, s74, 0xff
    s_bfe_u32 s77, s74, 0x80008
    s_bfe_u32 s78, s74, 0x80010
    s_lshr_b32 s79, s74, 24
    v_cvt_pk_bf16_f32 v80, v224, v225
    v_cvt_pk_bf16_f32 v81, v226, v227
    v_cvt_pk_bf16_f32 v82, v228, v229
    v_cvt_pk_bf16_f32 v83, v230, v231
    v_cvt_pk_bf16_f32 v84, v232, v233
    v_cvt_pk_bf16_f32 v85, v234, v235
    v_cvt_pk_bf16_f32 v86, v236, v237
    v_cvt_pk_bf16_f32 v87, v238, v239
    v_cvt_pk_bf16_f32 v88, v240, v241
    v_cvt_pk_bf16_f32 v89, v242, v243
    v_cvt_pk_bf16_f32 v90, v244, v245
    v_cvt_pk_bf16_f32 v91, v246, v247
    v_cvt_pk_bf16_f32 v92, v248, v249
    v_cvt_pk_bf16_f32 v93, v250, v251
    v_cvt_pk_bf16_f32 v94, v252, v253
    v_cvt_pk_bf16_f32 v95, v254, v255
    v_cvt_pk_bf16_f32 v64, v192, v193
    v_cvt_pk_bf16_f32 v65, v194, v195
    v_cvt_pk_bf16_f32 v66, v196, v197
    v_cvt_pk_bf16_f32 v67, v198, v199
    v_cvt_pk_bf16_f32 v68, v200, v201
    v_cvt_pk_bf16_f32 v69, v202, v203
    v_cvt_pk_bf16_f32 v70, v204, v205
    v_cvt_pk_bf16_f32 v71, v206, v207
    v_lshlrev_b32 v192, 16, v64
    v_and_b32 v193, 0xffff0000, v64
    v_lshlrev_b32 v194, 16, v65
    v_and_b32 v195, 0xffff0000, v65
    v_lshlrev_b32 v196, 16, v66
    v_and_b32 v197, 0xffff0000, v66
    v_lshlrev_b32 v198, 16, v67
    v_and_b32 v199, 0xffff0000, v67
    v_lshlrev_b32 v200, 16, v68
    v_and_b32 v201, 0xffff0000, v68
    v_lshlrev_b32 v202, 16, v69
    v_and_b32 v203, 0xffff0000, v69
    v_lshlrev_b32 v204, 16, v70
    v_and_b32 v205, 0xffff0000, v70
    v_lshlrev_b32 v206, 16, v71
    v_and_b32 v207, 0xffff0000, v71
    v_cvt_pk_bf16_f32 v72, v208, v209
    v_cvt_pk_bf16_f32 v73, v210, v211
    v_cvt_pk_bf16_f32 v74, v212, v213
    v_cvt_pk_bf16_f32 v75, v214, v215
    v_cvt_pk_bf16_f32 v76, v216, v217
    v_cvt_pk_bf16_f32 v77, v218, v219
    v_cvt_pk_bf16_f32 v78, v220, v221
    v_cvt_pk_bf16_f32 v79, v222, v223
    v_lshlrev_b32 v208, 16, v72
    v_and_b32 v209, 0xffff0000, v72
    v_lshlrev_b32 v210, 16, v73
    v_and_b32 v211, 0xffff0000, v73
    v_lshlrev_b32 v212, 16, v74
    v_and_b32 v213, 0xffff0000, v74
    v_lshlrev_b32 v214, 16, v75
    v_and_b32 v215, 0xffff0000, v75
    v_lshlrev_b32 v216, 16, v76
    v_and_b32 v217, 0xffff0000, v76
    v_lshlrev_b32 v218, 16, v77
    v_and_b32 v219, 0xffff0000, v77
    v_lshlrev_b32 v220, 16, v78
    v_and_b32 v221, 0xffff0000, v78
    v_lshlrev_b32 v222, 16, v79
    v_and_b32 v223, 0xffff0000, v79
    v_max3_f32 v144, v192, v193, v194
    v_max3_f32 v145, v195, v196, v197
    v_max3_f32 v146, v198, v199, v200
    v_max3_f32 v147, v201, v202, v203
    v_max3_f32 v148, v204, v205, v206
    v_max3_f32 v144, v144, v145, v207
    v_max3_f32 v146, v146, v147, v148
    v_max_f32 v144, v144, v146
    v_min3_f32 v150, v192, v193, v194
    v_min3_f32 v151, v195, v196, v197
    v_min3_f32 v152, v198, v199, v200
    v_min3_f32 v153, v201, v202, v203
    v_min3_f32 v154, v204, v205, v206
    v_min3_f32 v150, v150, v151, v207
    v_min3_f32 v152, v152, v153, v154
    v_min_f32 v150, v150, v152
    v_mov_b32 v145, v144
    v_mov_b32 v151, v150
    s_nop 0
    v_permlane32_swap_b32 v144, v145
    v_permlane32_swap_b32 v150, v151
    v_max_f32 v144, v144, v145
    v_min_f32 v150, v150, v151
    v_mul_f32 v144, s52, v144
    v_mul_f32 v150, s48, v150
    v_pk_fma_f32 v[224:225], v[192:193], s[48:49], v[144:145] op_sel_hi:[1,0,0]
    v_pk_fma_f32 v[112:113], v[192:193], s[52:53], v[150:151] op_sel_hi:[1,0,0]
    v_pk_fma_f32 v[226:227], v[194:195], s[48:49], v[144:145] op_sel_hi:[1,0,0]
    v_pk_fma_f32 v[114:115], v[194:195], s[52:53], v[150:151] op_sel_hi:[1,0,0]
    v_pk_fma_f32 v[228:229], v[196:197], s[48:49], v[144:145] op_sel_hi:[1,0,0]
    v_pk_fma_f32 v[116:117], v[196:197], s[52:53], v[150:151] op_sel_hi:[1,0,0]
    v_pk_fma_f32 v[230:231], v[198:199], s[48:49], v[144:145] op_sel_hi:[1,0,0]
    v_pk_fma_f32 v[118:119], v[198:199], s[52:53], v[150:151] op_sel_hi:[1,0,0]
    v_pk_fma_f32 v[232:233], v[200:201], s[48:49], v[144:145] op_sel_hi:[1,0,0]
    v_pk_fma_f32 v[120:121], v[200:201], s[52:53], v[150:151] op_sel_hi:[1,0,0]
    v_pk_fma_f32 v[234:235], v[202:203], s[48:49], v[144:145] op_sel_hi:[1,0,0]
    v_pk_fma_f32 v[122:123], v[202:203], s[52:53], v[150:151] op_sel_hi:[1,0,0]
    v_pk_fma_f32 v[236:237], v[204:205], s[48:49], v[144:145] op_sel_hi:[1,0,0]
    v_pk_fma_f32 v[124:125], v[204:205], s[52:53], v[150:151] op_sel_hi:[1,0,0]
    v_pk_fma_f32 v[238:239], v[206:207], s[48:49], v[144:145] op_sel_hi:[1,0,0]
    v_pk_fma_f32 v[126:127], v[206:207], s[52:53], v[150:151] op_sel_hi:[1,0,0]
    v_exp_f32 v224, v224
    v_exp_f32 v112, v112
    v_exp_f32 v225, v225
    v_exp_f32 v113, v113
    v_exp_f32 v226, v226
    v_exp_f32 v114, v114
    v_exp_f32 v227, v227
    v_exp_f32 v115, v115
    v_exp_f32 v228, v228
    v_exp_f32 v116, v116
    v_exp_f32 v229, v229
    v_exp_f32 v117, v117
    v_exp_f32 v230, v230
    v_exp_f32 v118, v118
    v_exp_f32 v231, v231
    v_exp_f32 v119, v119
    v_exp_f32 v232, v232
    v_exp_f32 v120, v120
    v_exp_f32 v233, v233
    v_exp_f32 v121, v121
    v_exp_f32 v234, v234
    v_exp_f32 v122, v122
    v_exp_f32 v235, v235
    v_exp_f32 v123, v123
    v_exp_f32 v236, v236
    v_exp_f32 v124, v124
    v_exp_f32 v237, v237
    v_exp_f32 v125, v125
    v_exp_f32 v238, v238
    v_exp_f32 v126, v126
    v_exp_f32 v239, v239
    v_exp_f32 v127, v127
    v_pk_add_f32 v[144:145], v[224:225], v[226:227]
    v_pk_add_f32 v[146:147], v[228:229], v[230:231]
    v_pk_add_f32 v[148:149], v[232:233], v[234:235]
    v_pk_add_f32 v[150:151], v[112:113], v[114:115]
    v_pk_add_f32 v[152:153], v[116:117], v[118:119]
    v_pk_add_f32 v[154:155], v[120:121], v[122:123]
    v_pk_add_f32 v[144:145], v[144:145], v[236:237]
    v_pk_add_f32 v[146:147], v[146:147], v[238:239]
    v_pk_add_f32 v[150:151], v[150:151], v[124:125]
    v_pk_add_f32 v[152:153], v[152:153], v[126:127]
    v_pk_add_f32 v[144:145], v[144:145], v[148:149]
    v_pk_add_f32 v[150:151], v[150:151], v[154:155]
    v_pk_add_f32 v[144:145], v[144:145], v[146:147]
    v_pk_add_f32 v[150:151], v[150:151], v[152:153]
    v_add_f32 v144, v144, v145
    v_add_f32 v150, v150, v151
    v_mov_b32 v145, v144
    v_mov_b32 v151, v150
    s_nop 0
    v_permlane32_swap_b32 v144, v145
    v_permlane32_swap_b32 v150, v151
    v_add_f32 v144, v144, v145
    v_add_f32 v150, v150, v151
    v_rcp_f32 v144, v144
    v_rcp_f32 v150, v150
    v_pk_mul_f32 v[224:225], v[224:225], v[144:145] op_sel_hi:[1,0]
    v_pk_mul_f32 v[112:113], v[112:113], v[150:151] op_sel_hi:[1,0]
    v_pk_mul_f32 v[226:227], v[226:227], v[144:145] op_sel_hi:[1,0]
    v_pk_mul_f32 v[114:115], v[114:115], v[150:151] op_sel_hi:[1,0]
    v_pk_mul_f32 v[228:229], v[228:229], v[144:145] op_sel_hi:[1,0]
    v_pk_mul_f32 v[116:117], v[116:117], v[150:151] op_sel_hi:[1,0]
    v_pk_mul_f32 v[230:231], v[230:231], v[144:145] op_sel_hi:[1,0]
    v_pk_mul_f32 v[118:119], v[118:119], v[150:151] op_sel_hi:[1,0]
    v_pk_mul_f32 v[232:233], v[232:233], v[144:145] op_sel_hi:[1,0]
    v_pk_mul_f32 v[120:121], v[120:121], v[150:151] op_sel_hi:[1,0]
    v_pk_mul_f32 v[234:235], v[234:235], v[144:145] op_sel_hi:[1,0]
    v_pk_mul_f32 v[122:123], v[122:123], v[150:151] op_sel_hi:[1,0]
    v_pk_mul_f32 v[236:237], v[236:237], v[144:145] op_sel_hi:[1,0]
    v_pk_mul_f32 v[124:125], v[124:125], v[150:151] op_sel_hi:[1,0]
    v_pk_mul_f32 v[238:239], v[238:239], v[144:145] op_sel_hi:[1,0]
    v_pk_mul_f32 v[126:127], v[126:127], v[150:151] op_sel_hi:[1,0]
    v_cvt_pk_bf16_f32 v64, v224, v225
    v_cvt_pk_bf16_f32 v96, v112, v113
    v_cvt_pk_bf16_f32 v65, v226, v227
    v_cvt_pk_bf16_f32 v97, v114, v115
    v_cvt_pk_bf16_f32 v66, v228, v229
    v_cvt_pk_bf16_f32 v98, v116, v117
    v_cvt_pk_bf16_f32 v67, v230, v231
    v_cvt_pk_bf16_f32 v99, v118, v119
    v_cvt_pk_bf16_f32 v68, v232, v233
    v_cvt_pk_bf16_f32 v100, v120, v121
    v_cvt_pk_bf16_f32 v69, v234, v235
    v_cvt_pk_bf16_f32 v101, v122, v123
    v_cvt_pk_bf16_f32 v70, v236, v237
    v_cvt_pk_bf16_f32 v102, v124, v125
    v_cvt_pk_bf16_f32 v71, v238, v239
    v_cvt_pk_bf16_f32 v103, v126, v127
    v_mfma_f32_32x32x16_bf16 v[192:207], v[64:67], v[48:51], 0
    v_mfma_f32_32x32x16_bf16 v[192:207], v[68:71], v[52:55], v[192:207]
    v_mfma_f32_32x32x16_bf16 v[224:239], v[96:99], v[48:51], 0
    v_mfma_f32_32x32x16_bf16 v[224:239], v[100:103], v[52:55], v[224:239]
    v_max3_f32 v144, v208, v209, v210
    v_max3_f32 v145, v211, v212, v213
    v_max3_f32 v146, v214, v215, v216
    v_max3_f32 v147, v217, v218, v219
    v_max3_f32 v148, v220, v221, v222
    v_max3_f32 v144, v144, v145, v223
    v_max3_f32 v146, v146, v147, v148
    v_max_f32 v144, v144, v146
    v_min3_f32 v150, v208, v209, v210
    v_min3_f32 v151, v211, v212, v213
    v_min3_f32 v152, v214, v215, v216
    v_min3_f32 v153, v217, v218, v219
    v_min3_f32 v154, v220, v221, v222
    v_min3_f32 v150, v150, v151, v223
    v_min3_f32 v152, v152, v153, v154
    v_min_f32 v150, v150, v152
    v_mov_b32 v145, v144
    v_mov_b32 v151, v150
    s_nop 0
    v_permlane32_swap_b32 v144, v145
    v_permlane32_swap_b32 v150, v151
    v_max_f32 v144, v144, v145
    v_min_f32 v150, v150, v151
    v_mul_f32 v144, s52, v144
    v_mul_f32 v150, s48, v150
    v_pk_fma_f32 v[240:241], v[208:209], s[48:49], v[144:145] op_sel_hi:[1,0,0]
    v_pk_fma_f32 v[128:129], v[208:209], s[52:53], v[150:151] op_sel_hi:[1,0,0]
    v_pk_fma_f32 v[242:243], v[210:211], s[48:49], v[144:145] op_sel_hi:[1,0,0]
    v_pk_fma_f32 v[130:131], v[210:211], s[52:53], v[150:151] op_sel_hi:[1,0,0]
    v_pk_fma_f32 v[244:245], v[212:213], s[48:49], v[144:145] op_sel_hi:[1,0,0]
    v_pk_fma_f32 v[132:133], v[212:213], s[52:53], v[150:151] op_sel_hi:[1,0,0]
    v_pk_fma_f32 v[246:247], v[214:215], s[48:49], v[144:145] op_sel_hi:[1,0,0]
    v_pk_fma_f32 v[134:135], v[214:215], s[52:53], v[150:151] op_sel_hi:[1,0,0]
    v_pk_fma_f32 v[248:249], v[216:217], s[48:49], v[144:145] op_sel_hi:[1,0,0]
    v_pk_fma_f32 v[136:137], v[216:217], s[52:53], v[150:151] op_sel_hi:[1,0,0]
    v_pk_fma_f32 v[250:251], v[218:219], s[48:49], v[144:145] op_sel_hi:[1,0,0]
    v_pk_fma_f32 v[138:139], v[218:219], s[52:53], v[150:151] op_sel_hi:[1,0,0]
    v_pk_fma_f32 v[252:253], v[220:221], s[48:49], v[144:145] op_sel_hi:[1,0,0]
    v_pk_fma_f32 v[140:141], v[220:221], s[52:53], v[150:151] op_sel_hi:[1,0,0]
    v_pk_fma_f32 v[254:255], v[222:223], s[48:49], v[144:145] op_sel_hi:[1,0,0]
    v_pk_fma_f32 v[142:143], v[222:223], s[52:53], v[150:151] op_sel_hi:[1,0,0]
    v_exp_f32 v240, v240
    v_exp_f32 v128, v128
    v_exp_f32 v241, v241
    v_exp_f32 v129, v129
    v_exp_f32 v242, v242
    v_exp_f32 v130, v130
    v_exp_f32 v243, v243
    v_exp_f32 v131, v131
    v_exp_f32 v244, v244
    v_exp_f32 v132, v132
    v_exp_f32 v245, v245
    v_exp_f32 v133, v133
    v_exp_f32 v246, v246
    v_exp_f32 v134, v134
    v_exp_f32 v247, v247
    v_exp_f32 v135, v135
    v_exp_f32 v248, v248
    v_exp_f32 v136, v136
    v_exp_f32 v249, v249
    v_exp_f32 v137, v137
    v_exp_f32 v250, v250
    v_exp_f32 v138, v138
    v_exp_f32 v251, v251
    v_exp_f32 v139, v139
    v_exp_f32 v252, v252
    v_exp_f32 v140, v140
    v_exp_f32 v253, v253
    v_exp_f32 v141, v141
    v_exp_f32 v254, v254
    v_exp_f32 v142, v142
    v_exp_f32 v255, v255
    v_exp_f32 v143, v143
    v_pk_add_f32 v[144:145], v[240:241], v[242:243]
    v_pk_add_f32 v[146:147], v[244:245], v[246:247]
    v_pk_add_f32 v[148:149], v[248:249], v[250:251]
    v_pk_add_f32 v[150:151], v[128:129], v[130:131]
    v_pk_add_f32 v[152:153], v[132:133], v[134:135]
    v_pk_add_f32 v[154:155], v[136:137], v[138:139]
    v_pk_add_f32 v[144:145], v[144:145], v[252:253]
    v_pk_add_f32 v[146:147], v[146:147], v[254:255]
    v_pk_add_f32 v[150:151], v[150:151], v[140:141]
    v_pk_add_f32 v[152:153], v[152:153], v[142:143]
    v_pk_add_f32 v[144:145], v[144:145], v[148:149]
    v_pk_add_f32 v[150:151], v[150:151], v[154:155]
    v_pk_add_f32 v[144:145], v[144:145], v[146:147]
    v_pk_add_f32 v[150:151], v[150:151], v[152:153]
    v_add_f32 v144, v144, v145
    v_add_f32 v150, v150, v151
    v_mov_b32 v145, v144
    v_mov_b32 v151, v150
    s_nop 0
    v_permlane32_swap_b32 v144, v145
    v_permlane32_swap_b32 v150, v151
    v_add_f32 v144, v144, v145
    v_add_f32 v150, v150, v151
    v_rcp_f32 v144, v144
    v_rcp_f32 v150, v150
    v_pk_mul_f32 v[240:241], v[240:241], v[144:145] op_sel_hi:[1,0]
    v_pk_mul_f32 v[128:129], v[128:129], v[150:151] op_sel_hi:[1,0]
    v_pk_mul_f32 v[242:243], v[242:243], v[144:145] op_sel_hi:[1,0]
    v_pk_mul_f32 v[130:131], v[130:131], v[150:151] op_sel_hi:[1,0]
    v_pk_mul_f32 v[244:245], v[244:245], v[144:145] op_sel_hi:[1,0]
    v_pk_mul_f32 v[132:133], v[132:133], v[150:151] op_sel_hi:[1,0]
    v_pk_mul_f32 v[246:247], v[246:247], v[144:145] op_sel_hi:[1,0]
    v_pk_mul_f32 v[134:135], v[134:135], v[150:151] op_sel_hi:[1,0]
    v_pk_mul_f32 v[248:249], v[248:249], v[144:145] op_sel_hi:[1,0]
    v_pk_mul_f32 v[136:137], v[136:137], v[150:151] op_sel_hi:[1,0]
    v_pk_mul_f32 v[250:251], v[250:251], v[144:145] op_sel_hi:[1,0]
    v_pk_mul_f32 v[138:139], v[138:139], v[150:151] op_sel_hi:[1,0]
    v_pk_mul_f32 v[252:253], v[252:253], v[144:145] op_sel_hi:[1,0]
    v_pk_mul_f32 v[140:141], v[140:141], v[150:151] op_sel_hi:[1,0]
    v_pk_mul_f32 v[254:255], v[254:255], v[144:145] op_sel_hi:[1,0]
    v_pk_mul_f32 v[142:143], v[142:143], v[150:151] op_sel_hi:[1,0]
    v_cvt_pk_bf16_f32 v72, v240, v241
    v_cvt_pk_bf16_f32 v104, v128, v129
    v_cvt_pk_bf16_f32 v73, v242, v243
    v_cvt_pk_bf16_f32 v105, v130, v131
    v_cvt_pk_bf16_f32 v74, v244, v245
    v_cvt_pk_bf16_f32 v106, v132, v133
    v_cvt_pk_bf16_f32 v75, v246, v247
    v_cvt_pk_bf16_f32 v107, v134, v135
    v_cvt_pk_bf16_f32 v76, v248, v249
    v_cvt_pk_bf16_f32 v108, v136, v137
    v_cvt_pk_bf16_f32 v77, v250, v251
    v_cvt_pk_bf16_f32 v109, v138, v139
    v_cvt_pk_bf16_f32 v78, v252, v253
    v_cvt_pk_bf16_f32 v110, v140, v141
    v_cvt_pk_bf16_f32 v79, v254, v255
    v_cvt_pk_bf16_f32 v111, v142, v143
    v_mfma_f32_32x32x16_bf16 v[208:223], v[72:75], v[48:51], 0
    v_mfma_f32_32x32x16_bf16 v[208:223], v[76:79], v[52:55], v[208:223]
    v_mfma_f32_32x32x16_bf16 v[240:255], v[104:107], v[48:51], 0
    v_mfma_f32_32x32x16_bf16 v[240:255], v[108:111], v[52:55], v[240:255]
    v_cvt_pk_bf16_f32 v64, v192, v193
    v_cvt_pk_bf16_f32 v65, v194, v195
    v_cvt_pk_bf16_f32 v66, v196, v197
    v_cvt_pk_bf16_f32 v67, v198, v199
    v_cvt_pk_bf16_f32 v68, v200, v201
    v_cvt_pk_bf16_f32 v69, v202, v203
    v_cvt_pk_bf16_f32 v70, v204, v205
    v_cvt_pk_bf16_f32 v71, v206, v207
    v_cvt_pk_bf16_f32 v96, v224, v225
    v_cvt_pk_bf16_f32 v97, v226, v227
    v_cvt_pk_bf16_f32 v98, v228, v229
    v_cvt_pk_bf16_f32 v99, v230, v231
    v_cvt_pk_bf16_f32 v100, v232, v233
    v_cvt_pk_bf16_f32 v101, v234, v235
    v_cvt_pk_bf16_f32 v102, v236, v237
    v_cvt_pk_bf16_f32 v103, v238, v239
    v_mfma_f32_32x32x16_bf16 v[112:127], v[64:67], v[80:83], 0
    v_mfma_f32_32x32x16_bf16 v[112:127], v[68:71], v[84:87], v[112:127]
    v_mfma_f32_32x32x16_bf16 v[128:143], v[96:99], v[80:83], 0
    v_mfma_f32_32x32x16_bf16 v[128:143], v[100:103], v[84:87], v[128:143]
    v_mfma_f32_32x32x16_bf16 v[144:159], v[64:67], v[56:59], 0
    v_mfma_f32_32x32x16_bf16 v[144:159], v[68:71], v[56:59], v[144:159]
    v_mfma_f32_32x32x16_bf16 v[144:159], v[96:99], v[60:63], v[144:159]
    v_mfma_f32_32x32x16_bf16 v[144:159], v[100:103], v[60:63], v[144:159]
    v_cvt_pk_bf16_f32 v72, v208, v209
    v_cvt_pk_bf16_f32 v73, v210, v211
    v_cvt_pk_bf16_f32 v74, v212, v213
    v_cvt_pk_bf16_f32 v75, v214, v215
    v_cvt_pk_bf16_f32 v76, v216, v217
    v_cvt_pk_bf16_f32 v77, v218, v219
    v_cvt_pk_bf16_f32 v78, v220, v221
    v_cvt_pk_bf16_f32 v79, v222, v223
    v_cvt_pk_bf16_f32 v104, v240, v241
    v_cvt_pk_bf16_f32 v105, v242, v243
    v_cvt_pk_bf16_f32 v106, v244, v245
    v_cvt_pk_bf16_f32 v107, v246, v247
    v_cvt_pk_bf16_f32 v108, v248, v249
    v_cvt_pk_bf16_f32 v109, v250, v251
    v_cvt_pk_bf16_f32 v110, v252, v253
    v_cvt_pk_bf16_f32 v111, v254, v255
    v_mfma_f32_32x32x16_bf16 v[112:127], v[72:75], v[88:91], v[112:127]
    v_mfma_f32_32x32x16_bf16 v[112:127], v[76:79], v[92:95], v[112:127]
    v_mfma_f32_32x32x16_bf16 v[128:143], v[104:107], v[88:91], v[128:143]
    v_mfma_f32_32x32x16_bf16 v[128:143], v[108:111], v[92:95], v[128:143]
    v_mfma_f32_32x32x16_bf16 v[144:159], v[72:75], v[56:59], v[144:159]
    v_mfma_f32_32x32x16_bf16 v[144:159], v[76:79], v[56:59], v[144:159]
    v_mfma_f32_32x32x16_bf16 v[144:159], v[104:107], v[60:63], v[144:159]
    v_mfma_f32_32x32x16_bf16 v[144:159], v[108:111], v[60:63], v[144:159]
    s_cmp_eq_u32 s21, 0
    s_cbranch_scc0 L_c_rw1
    s_nop 5
    ds_write_b128 v8, v[128:131] offset:0
    ds_write_b128 v8, v[132:135] offset:1024
    ds_write_b128 v8, v[136:139] offset:2048
    ds_write_b128 v8, v[140:143] offset:3072
    s_mov_b32 exec_lo, s45
    s_mov_b32 exec_hi, s45
    ds_write_b128 v10, v[144:147] offset:4096
    ds_write_b128 v10, v[148:151] offset:4128
    ds_write_b128 v10, v[152:155] offset:4160
    ds_write_b128 v10, v[156:159] offset:4192
    ds_write_b32 v13, v15
    s_mov_b64 exec, -1
    s_mov_b32 s13, 0
L_c_x0:
    ds_read_b32 v16, v14
    ds_read_b128 v[192:195], v9 offset:0
    ds_read_b128 v[196:199], v9 offset:1024
    ds_read_b128 v[200:203], v9 offset:2048
    ds_read_b128 v[204:207], v9 offset:3072
    ds_read_b32 v208, v11 offset:4096
    ds_read_b32 v209, v11 offset:4224
    s_add_u32 s13, s13, 1
    s_cmp_ge_u32 s13, 262144
    s_cbranch_scc1 L_c_y0
    s_waitcnt lgkmcnt(6)
    v_cmp_eq_u32 vcc, 1, v16
    s_cbranch_vccz L_c_x0
L_c_y0:
    s_waitcnt lgkmcnt(2)
    v_pk_add_f32 v[112:113], v[112:113], v[192:193]
    v_pk_add_f32 v[114:115], v[114:115], v[194:195]
    v_pk_add_f32 v[116:117], v[116:117], v[196:197]
    v_pk_add_f32 v[118:119], v[118:119], v[198:199]
    v_pk_add_f32 v[120:121], v[120:121], v[200:201]
    v_pk_add_f32 v[122:123], v[122:123], v[202:203]
    v_pk_add_f32 v[124:125], v[124:125], v[204:205]
    v_pk_add_f32 v[126:127], v[126:127], v[206:207]
    v_and_or_b32 v112, v112, v28, v27
    buffer_store_dwordx4 v[112:115], v6, s[32:35], s40 offen offset:0 sc1
    v_and_or_b32 v116, v116, v28, v27
    buffer_store_dwordx4 v[116:119], v6, s[32:35], s40 offen offset:512 sc1
    v_and_or_b32 v120, v120, v28, v27
    buffer_store_dwordx4 v[120:123], v6, s[32:35], s41 offen offset:0 sc1
    v_and_or_b32 v124, v124, v28, v27
    buffer_store_dwordx4 v[124:127], v6, s[32:35], s41 offen offset:512 sc1
    s_branch L_c_zs
L_c_rw1:
    s_nop 7
    ds_write_b128 v8, v[112:115] offset:0
    ds_write_b128 v8, v[116:119] offset:1024
    ds_write_b128 v8, v[120:123] offset:2048
    ds_write_b128 v8, v[124:127] offset:3072
    s_mov_b32 exec_lo, s45
    s_mov_b32 exec_hi, s45
    ds_write_b128 v10, v[144:147] offset:4096
    ds_write_b128 v10, v[148:151] offset:4128
    ds_write_b128 v10, v[152:155] offset:4160
    ds_write_b128 v10, v[156:159] offset:4192
    ds_write_b32 v13, v15
    s_mov_b64 exec, -1
    s_mov_b32 s13, 0
L_c_x1:
    ds_read_b32 v16, v14
    ds_read_b128 v[192:195], v9 offset:0
    ds_read_b128 v[196:199], v9 offset:1024
    ds_read_b128 v[200:203], v9 offset:2048
    ds_read_b128 v[204:207], v9 offset:3072
    ds_read_b32 v208, v11 offset:4096
    ds_read_b32 v209, v11 offset:4224
    s_add_u32 s13, s13, 1
    s_cmp_ge_u32 s13, 262144
    s_cbranch_scc1 L_c_y1
    s_waitcnt lgkmcnt(6)
    v_cmp_eq_u32 vcc, 1, v16
    s_cbranch_vccz L_c_x1
L_c_y1:
    s_waitcnt lgkmcnt(2)
    v_pk_add_f32 v[128:129], v[128:129], v[192:193]
    v_pk_add_f32 v[130:131], v[130:131], v[194:195]
    v_pk_add_f32 v[132:133], v[132:133], v[196:197]
    v_pk_add_f32 v[134:135], v[134:135], v[198:199]
    v_pk_add_f32 v[136:137], v[136:137], v[200:201]
    v_pk_add_f32 v[138:139], v[138:139], v[202:203]
    v_pk_add_f32 v[140:141], v[140:141], v[204:205]
    v_pk_add_f32 v[142:143], v[142:143], v[206:207]
    v_and_or_b32 v128, v128, v28, v27
    buffer_store_dwordx4 v[128:131], v6, s[32:35], s40 offen offset:0 sc1
    v_and_or_b32 v132, v132, v28, v27
    buffer_store_dwordx4 v[132:135], v6, s[32:35], s40 offen offset:512 sc1
    v_and_or_b32 v136, v136, v28, v27
    buffer_store_dwordx4 v[136:139], v6, s[32:35], s41 offen offset:0 sc1
    v_and_or_b32 v140, v140, v28, v27
    buffer_store_dwordx4 v[140:143], v6, s[32:35], s41 offen offset:512 sc1
L_c_zs:
    s_waitcnt lgkmcnt(0)
    v_add_f32 v208, v208, v209
    v_and_or_b32 v208, v208, v28, v27
    s_mov_b32 exec_hi, 0
    buffer_store_dword v208, v7, s[32:35], s42 offen sc1
    s_mov_b32 exec_lo, 1
    ds_write_b32 v13, v15 offset:96
    s_mov_b64 exec, -1
    v_cvt_pk_bf16_f32 v64, v160, v161
    v_cvt_pk_bf16_f32 v65, v162, v163
    v_cvt_pk_bf16_f32 v66, v164, v165
    v_cvt_pk_bf16_f32 v67, v166, v167
    v_cvt_pk_bf16_f32 v68, v168, v169
    v_cvt_pk_bf16_f32 v69, v170, v171
    v_cvt_pk_bf16_f32 v70, v172, v173
    v_cvt_pk_bf16_f32 v71, v174, v175
    v_mfma_f32_32x32x16_bf16 v[160:175], v[40:43], v[64:67], 0
    s_nop 0
    v_mfma_f32_32x32x16_bf16 v[160:175], v[44:47], v[68:71], v[160:175]
    v_cvt_pk_bf16_f32 v72, v176, v177
    v_cvt_pk_bf16_f32 v73, v178, v179
    v_cvt_pk_bf16_f32 v74, v180, v181
    v_cvt_pk_bf16_f32 v75, v182, v183
    v_cvt_pk_bf16_f32 v76, v184, v185
    v_cvt_pk_bf16_f32 v77, v186, v187
    v_cvt_pk_bf16_f32 v78, v188, v189
    v_cvt_pk_bf16_f32 v79, v190, v191
    v_mfma_f32_32x32x16_bf16 v[176:191], v[40:43], v[72:75], 0
    s_nop 0
    v_mfma_f32_32x32x16_bf16 v[176:191], v[44:47], v[76:79], v[176:191]
    s_nop 0
    v_cvt_pk_bf16_f32 v64, v160, v161
    v_cvt_pk_bf16_f32 v65, v162, v163
    v_cvt_pk_bf16_f32 v66, v164, v165
    v_cvt_pk_bf16_f32 v67, v166, v167
    v_cvt_pk_bf16_f32 v68, v168, v169
    v_cvt_pk_bf16_f32 v69, v170, v171
    v_cvt_pk_bf16_f32 v70, v172, v173
    v_cvt_pk_bf16_f32 v71, v174, v175
    v_lshlrev_b32 v160, 16, v64
    v_and_b32 v161, 0xffff0000, v64
    v_lshlrev_b32 v162, 16, v65
    v_and_b32 v163, 0xffff0000, v65
    v_lshlrev_b32 v164, 16, v66
    v_and_b32 v165, 0xffff0000, v66
    v_lshlrev_b32 v166, 16, v67
    v_and_b32 v167, 0xffff0000, v67
    v_lshlrev_b32 v168, 16, v68
    v_and_b32 v169, 0xffff0000, v68
    v_lshlrev_b32 v170, 16, v69
    v_and_b32 v171, 0xffff0000, v69
    v_lshlrev_b32 v172, 16, v70
    v_and_b32 v173, 0xffff0000, v70
    v_lshlrev_b32 v174, 16, v71
    v_and_b32 v175, 0xffff0000, v71
    v_cvt_pk_bf16_f32 v72, v176, v177
    v_cvt_pk_bf16_f32 v73, v178, v179
    v_cvt_pk_bf16_f32 v74, v180, v181
    v_cvt_pk_bf16_f32 v75, v182, v183
    v_cvt_pk_bf16_f32 v76, v184, v185
    v_cvt_pk_bf16_f32 v77, v186, v187
    v_cvt_pk_bf16_f32 v78, v188, v189
    v_cvt_pk_bf16_f32 v79, v190, v191
    v_lshlrev_b32 v176, 16, v72
    v_and_b32 v177, 0xffff0000, v72
    v_lshlrev_b32 v178, 16, v73
    v_and_b32 v179, 0xffff0000, v73
    v_lshlrev_b32 v180, 16, v74
    v_and_b32 v181, 0xffff0000, v74
    v_lshlrev_b32 v182, 16, v75
    v_and_b32 v183, 0xffff0000, v75
    v_lshlrev_b32 v184, 16, v76
    v_and_b32 v185, 0xffff0000, v76
    v_lshlrev_b32 v186, 16, v77
    v_and_b32 v187, 0xffff0000, v77
    v_lshlrev_b32 v188, 16, v78
    v_and_b32 v189, 0xffff0000, v78
    v_lshlrev_b32 v190, 16, v79
    v_and_b32 v191, 0xffff0000, v79
    v_max3_f32 v24, v160, v161, v162
    v_max3_f32 v25, v163, v164, v165
    v_max3_f32 v26, v166, v167, v168
    v_max3_f32 v27, v169, v170, v171
    v_max3_f32 v28, v172, v173, v174
    v_max3_f32 v24, v24, v25, v175
    v_max3_f32 v26, v26, v27, v28
    v_max_f32 v24, v24, v26
    v_min3_f32 v30, v160, v161, v162
    v_min3_f32 v31, v163, v164, v165
    v_min3_f32 v32, v166, v167, v168
    v_min3_f32 v33, v169, v170, v171
    v_min3_f32 v34, v172, v173, v174
    v_min3_f32 v30, v30, v31, v175
    v_min3_f32 v32, v32, v33, v34
    v_min_f32 v30, v30, v32
    v_mov_b32 v25, v24
    v_mov_b32 v31, v30
    s_nop 0
    v_permlane32_swap_b32 v24, v25
    v_permlane32_swap_b32 v30, v31
    v_max_f32 v24, v24, v25
    v_min_f32 v30, v30, v31
    v_mul_f32 v24, s52, v24
    v_mul_f32 v30, s48, v30
    v_pk_fma_f32 v[192:193], v[160:161], s[48:49], v[24:25] op_sel_hi:[1,0,0]
    v_pk_fma_f32 v[224:225], v[160:161], s[52:53], v[30:31] op_sel_hi:[1,0,0]
    v_pk_fma_f32 v[194:195], v[162:163], s[48:49], v[24:25] op_sel_hi:[1,0,0]
    v_pk_fma_f32 v[226:227], v[162:163], s[52:53], v[30:31] op_sel_hi:[1,0,0]
    v_pk_fma_f32 v[196:197], v[164:165], s[48:49], v[24:25] op_sel_hi:[1,0,0]
    v_pk_fma_f32 v[228:229], v[164:165], s[52:53], v[30:31] op_sel_hi:[1,0,0]
    v_pk_fma_f32 v[198:199], v[166:167], s[48:49], v[24:25] op_sel_hi:[1,0,0]
    v_pk_fma_f32 v[230:231], v[166:167], s[52:53], v[30:31] op_sel_hi:[1,0,0]
    v_pk_fma_f32 v[200:201], v[168:169], s[48:49], v[24:25] op_sel_hi:[1,0,0]
    v_pk_fma_f32 v[232:233], v[168:169], s[52:53], v[30:31] op_sel_hi:[1,0,0]
    v_pk_fma_f32 v[202:203], v[170:171], s[48:49], v[24:25] op_sel_hi:[1,0,0]
    v_pk_fma_f32 v[234:235], v[170:171], s[52:53], v[30:31] op_sel_hi:[1,0,0]
    v_pk_fma_f32 v[204:205], v[172:173], s[48:49], v[24:25] op_sel_hi:[1,0,0]
    v_pk_fma_f32 v[236:237], v[172:173], s[52:53], v[30:31] op_sel_hi:[1,0,0]
    v_pk_fma_f32 v[206:207], v[174:175], s[48:49], v[24:25] op_sel_hi:[1,0,0]
    v_pk_fma_f32 v[238:239], v[174:175], s[52:53], v[30:31] op_sel_hi:[1,0,0]
    v_exp_f32 v192, v192
    v_exp_f32 v224, v224
    v_exp_f32 v193, v193
    v_exp_f32 v225, v225
    v_exp_f32 v194, v194
    v_exp_f32 v226, v226
    v_exp_f32 v195, v195
    v_exp_f32 v227, v227
    v_exp_f32 v196, v196
    v_exp_f32 v228, v228
    v_exp_f32 v197, v197
    v_exp_f32 v229, v229
    v_exp_f32 v198, v198
    v_exp_f32 v230, v230
    v_exp_f32 v199, v199
    v_exp_f32 v231, v231
    v_exp_f32 v200, v200
    v_exp_f32 v232, v232
    v_exp_f32 v201, v201
    v_exp_f32 v233, v233
    v_exp_f32 v202, v202
    v_exp_f32 v234, v234
    v_exp_f32 v203, v203
    v_exp_f32 v235, v235
    v_exp_f32 v204, v204
    v_exp_f32 v236, v236
    v_exp_f32 v205, v205
    v_exp_f32 v237, v237
    v_exp_f32 v206, v206
    v_exp_f32 v238, v238
    v_exp_f32 v207, v207
    v_exp_f32 v239, v239
    v_pk_add_f32 v[24:25], v[192:193], v[194:195]
    v_pk_add_f32 v[26:27], v[196:197], v[198:199]
    v_pk_add_f32 v[28:29], v[200:201], v[202:203]
    v_pk_add_f32 v[30:31], v[224:225], v[226:227]
    v_pk_add_f32 v[32:33], v[228:229], v[230:231]
    v_pk_add_f32 v[34:35], v[232:233], v[234:235]
    v_pk_add_f32 v[24:25], v[24:25], v[204:205]
    v_pk_add_f32 v[26:27], v[26:27], v[206:207]
    v_pk_add_f32 v[30:31], v[30:31], v[236:237]
    v_pk_add_f32 v[32:33], v[32:33], v[238:239]
    v_pk_add_f32 v[24:25], v[24:25], v[28:29]
    v_pk_add_f32 v[30:31], v[30:31], v[34:35]
    v_pk_add_f32 v[24:25], v[24:25], v[26:27]
    v_pk_add_f32 v[30:31], v[30:31], v[32:33]
    v_add_f32 v24, v24, v25
    v_add_f32 v30, v30, v31
    v_mov_b32 v25, v24
    v_mov_b32 v31, v30
    s_nop 0
    v_permlane32_swap_b32 v24, v25
    v_permlane32_swap_b32 v30, v31
    v_add_f32 v24, v24, v25
    v_add_f32 v30, v30, v31
    v_rcp_f32 v24, v24
    v_rcp_f32 v30, v30
    v_pk_mul_f32 v[192:193], v[192:193], v[24:25] op_sel_hi:[1,0]
    v_pk_mul_f32 v[224:225], v[224:225], v[30:31] op_sel_hi:[1,0]
    v_pk_mul_f32 v[194:195], v[194:195], v[24:25] op_sel_hi:[1,0]
    v_pk_mul_f32 v[226:227], v[226:227], v[30:31] op_sel_hi:[1,0]
    v_pk_mul_f32 v[196:197], v[196:197], v[24:25] op_sel_hi:[1,0]
    v_pk_mul_f32 v[228:229], v[228:229], v[30:31] op_sel_hi:[1,0]
    v_pk_mul_f32 v[198:199], v[198:199], v[24:25] op_sel_hi:[1,0]
    v_pk_mul_f32 v[230:231], v[230:231], v[30:31] op_sel_hi:[1,0]
    v_pk_mul_f32 v[200:201], v[200:201], v[24:25] op_sel_hi:[1,0]
    v_pk_mul_f32 v[232:233], v[232:233], v[30:31] op_sel_hi:[1,0]
    v_pk_mul_f32 v[202:203], v[202:203], v[24:25] op_sel_hi:[1,0]
    v_pk_mul_f32 v[234:235], v[234:235], v[30:31] op_sel_hi:[1,0]
    v_pk_mul_f32 v[204:205], v[204:205], v[24:25] op_sel_hi:[1,0]
    v_pk_mul_f32 v[236:237], v[236:237], v[30:31] op_sel_hi:[1,0]
    v_pk_mul_f32 v[206:207], v[206:207], v[24:25] op_sel_hi:[1,0]
    v_pk_mul_f32 v[238:239], v[238:239], v[30:31] op_sel_hi:[1,0]
    v_cvt_pk_bf16_f32 v80, v192, v193
    v_cvt_pk_bf16_f32 v88, v224, v225
    v_cvt_pk_bf16_f32 v81, v194, v195
    v_cvt_pk_bf16_f32 v89, v226, v227
    v_cvt_pk_bf16_f32 v82, v196, v197
    v_cvt_pk_bf16_f32 v90, v228, v229
    v_cvt_pk_bf16_f32 v83, v198, v199
    v_cvt_pk_bf16_f32 v91, v230, v231
    v_cvt_pk_bf16_f32 v84, v200, v201
    v_cvt_pk_bf16_f32 v92, v232, v233
    v_cvt_pk_bf16_f32 v85, v202, v203
    v_cvt_pk_bf16_f32 v93, v234, v235
    v_cvt_pk_bf16_f32 v86, v204, v205
    v_cvt_pk_bf16_f32 v94, v236, v237
    v_cvt_pk_bf16_f32 v87, v206, v207
    v_cvt_pk_bf16_f32 v95, v238, v239
    v_max3_f32 v24, v176, v177, v178
    v_max3_f32 v25, v179, v180, v181
    v_max3_f32 v26, v182, v183, v184
    v_max3_f32 v27, v185, v186, v187
    v_max3_f32 v28, v188, v189, v190
    v_max3_f32 v24, v24, v25, v191
    v_max3_f32 v26, v26, v27, v28
    v_max_f32 v24, v24, v26
    v_min3_f32 v30, v176, v177, v178
    v_min3_f32 v31, v179, v180, v181
    v_min3_f32 v32, v182, v183, v184
    v_min3_f32 v33, v185, v186, v187
    v_min3_f32 v34, v188, v189, v190
    v_min3_f32 v30, v30, v31, v191
    v_min3_f32 v32, v32, v33, v34
    v_min_f32 v30, v30, v32
    v_mov_b32 v25, v24
    v_mov_b32 v31, v30
    s_nop 0
    v_permlane32_swap_b32 v24, v25
    v_permlane32_swap_b32 v30, v31
    v_max_f32 v24, v24, v25
    v_min_f32 v30, v30, v31
    v_mul_f32 v24, s52, v24
    v_mul_f32 v30, s48, v30
    v_pk_fma_f32 v[208:209], v[176:177], s[48:49], v[24:25] op_sel_hi:[1,0,0]
    v_pk_fma_f32 v[240:241], v[176:177], s[52:53], v[30:31] op_sel_hi:[1,0,0]
    v_pk_fma_f32 v[210:211], v[178:179], s[48:49], v[24:25] op_sel_hi:[1,0,0]
    v_pk_fma_f32 v[242:243], v[178:179], s[52:53], v[30:31] op_sel_hi:[1,0,0]
    v_pk_fma_f32 v[212:213], v[180:181], s[48:49], v[24:25] op_sel_hi:[1,0,0]
    v_pk_fma_f32 v[244:245], v[180:181], s[52:53], v[30:31] op_sel_hi:[1,0,0]
    v_pk_fma_f32 v[214:215], v[182:183], s[48:49], v[24:25] op_sel_hi:[1,0,0]
    v_pk_fma_f32 v[246:247], v[182:183], s[52:53], v[30:31] op_sel_hi:[1,0,0]
    v_pk_fma_f32 v[216:217], v[184:185], s[48:49], v[24:25] op_sel_hi:[1,0,0]
    v_pk_fma_f32 v[248:249], v[184:185], s[52:53], v[30:31] op_sel_hi:[1,0,0]
    v_pk_fma_f32 v[218:219], v[186:187], s[48:49], v[24:25] op_sel_hi:[1,0,0]
    v_pk_fma_f32 v[250:251], v[186:187], s[52:53], v[30:31] op_sel_hi:[1,0,0]
    v_pk_fma_f32 v[220:221], v[188:189], s[48:49], v[24:25] op_sel_hi:[1,0,0]
    v_pk_fma_f32 v[252:253], v[188:189], s[52:53], v[30:31] op_sel_hi:[1,0,0]
    v_pk_fma_f32 v[222:223], v[190:191], s[48:49], v[24:25] op_sel_hi:[1,0,0]
    v_pk_fma_f32 v[254:255], v[190:191], s[52:53], v[30:31] op_sel_hi:[1,0,0]
    v_exp_f32 v208, v208
    v_exp_f32 v240, v240
    v_exp_f32 v209, v209
    v_exp_f32 v241, v241
    v_exp_f32 v210, v210
    v_exp_f32 v242, v242
    v_exp_f32 v211, v211
    v_exp_f32 v243, v243
    v_exp_f32 v212, v212
    v_exp_f32 v244, v244
    v_exp_f32 v213, v213
    v_exp_f32 v245, v245
    v_exp_f32 v214, v214
    v_exp_f32 v246, v246
    v_exp_f32 v215, v215
    v_exp_f32 v247, v247
    v_exp_f32 v216, v216
    v_exp_f32 v248, v248
    v_exp_f32 v217, v217
    v_exp_f32 v249, v249
    v_exp_f32 v218, v218
    v_exp_f32 v250, v250
    v_exp_f32 v219, v219
    v_exp_f32 v251, v251
    v_exp_f32 v220, v220
    v_exp_f32 v252, v252
    v_exp_f32 v221, v221
    v_exp_f32 v253, v253
    v_exp_f32 v222, v222
    v_exp_f32 v254, v254
    v_exp_f32 v223, v223
    v_exp_f32 v255, v255
    v_pk_add_f32 v[24:25], v[208:209], v[210:211]
    v_pk_add_f32 v[26:27], v[212:213], v[214:215]
    v_pk_add_f32 v[28:29], v[216:217], v[218:219]
    v_pk_add_f32 v[30:31], v[240:241], v[242:243]
    v_pk_add_f32 v[32:33], v[244:245], v[246:247]
    v_pk_add_f32 v[34:35], v[248:249], v[250:251]
    v_pk_add_f32 v[24:25], v[24:25], v[220:221]
    v_pk_add_f32 v[26:27], v[26:27], v[222:223]
    v_pk_add_f32 v[30:31], v[30:31], v[252:253]
    v_pk_add_f32 v[32:33], v[32:33], v[254:255]
    v_pk_add_f32 v[24:25], v[24:25], v[28:29]
    v_pk_add_f32 v[30:31], v[30:31], v[34:35]
    v_pk_add_f32 v[24:25], v[24:25], v[26:27]
    v_pk_add_f32 v[30:31], v[30:31], v[32:33]
    v_add_f32 v24, v24, v25
    v_add_f32 v30, v30, v31
    v_mov_b32 v25, v24
    v_mov_b32 v31, v30
    s_nop 0
    v_permlane32_swap_b32 v24, v25
    v_permlane32_swap_b32 v30, v31
    v_add_f32 v24, v24, v25
    v_add_f32 v30, v30, v31
    v_rcp_f32 v24, v24
    v_rcp_f32 v30, v30
    v_pk_mul_f32 v[208:209], v[208:209], v[24:25] op_sel_hi:[1,0]
    v_pk_mul_f32 v[240:241], v[240:241], v[30:31] op_sel_hi:[1,0]
    v_pk_mul_f32 v[210:211], v[210:211], v[24:25] op_sel_hi:[1,0]
    v_pk_mul_f32 v[242:243], v[242:243], v[30:31] op_sel_hi:[1,0]
    v_pk_mul_f32 v[212:213], v[212:213], v[24:25] op_sel_hi:[1,0]
    v_pk_mul_f32 v[244:245], v[244:245], v[30:31] op_sel_hi:[1,0]
    v_pk_mul_f32 v[214:215], v[214:215], v[24:25] op_sel_hi:[1,0]
    v_pk_mul_f32 v[246:247], v[246:247], v[30:31] op_sel_hi:[1,0]
    v_pk_mul_f32 v[216:217], v[216:217], v[24:25] op_sel_hi:[1,0]
    v_pk_mul_f32 v[248:249], v[248:249], v[30:31] op_sel_hi:[1,0]
    v_pk_mul_f32 v[218:219], v[218:219], v[24:25] op_sel_hi:[1,0]
    v_pk_mul_f32 v[250:251], v[250:251], v[30:31] op_sel_hi:[1,0]
    v_pk_mul_f32 v[220:221], v[220:221], v[24:25] op_sel_hi:[1,0]
    v_pk_mul_f32 v[252:253], v[252:253], v[30:31] op_sel_hi:[1,0]
    v_pk_mul_f32 v[222:223], v[222:223], v[24:25] op_sel_hi:[1,0]
    v_pk_mul_f32 v[254:255], v[254:255], v[30:31] op_sel_hi:[1,0]
    v_cvt_pk_bf16_f32 v96, v208, v209
    v_cvt_pk_bf16_f32 v104, v240, v241
    v_cvt_pk_bf16_f32 v97, v210, v211
    v_cvt_pk_bf16_f32 v105, v242, v243
    v_cvt_pk_bf16_f32 v98, v212, v213
    v_cvt_pk_bf16_f32 v106, v244, v245
    v_cvt_pk_bf16_f32 v99, v214, v215
    v_cvt_pk_bf16_f32 v107, v246, v247
    v_cvt_pk_bf16_f32 v100, v216, v217
    v_cvt_pk_bf16_f32 v108, v248, v249
    v_cvt_pk_bf16_f32 v101, v218, v219
    v_cvt_pk_bf16_f32 v109, v250, v251
    v_cvt_pk_bf16_f32 v102, v220, v221
    v_cvt_pk_bf16_f32 v110, v252, v253
    v_cvt_pk_bf16_f32 v103, v222, v223
    v_cvt_pk_bf16_f32 v111, v254, v255
    s_lshl_b32 s12, s19, 1
    s_add_u32 s23, s12, s22
    s_lshl_b32 s12, s23, 12
    s_add_u32 s43, s12, 32768
    s_lshl_b32 s14, s23, 10
    s_add_u32 s46, s14, 163840
    v_lshlrev_b32 v52, 7, v3
    v_lshrrev_b32 v53, 2, v4
    v_lshlrev_b32 v53, 7, v53
    s_lshl_b32 s40, s18, 1
    s_add_u32 s40, s40, s21
    s_lshl_b32 s41, s40, 6
    s_add_u32 s41, s41, s23
    s_lshl_b32 s41, s41, 11
    s_add_u32 s41, s41, 8388608
    s_add_u32 s42, s41, 65536
    s_lshl_b32 s12, s18, 10
    s_lshl_b32 s40, s21, 5
    s_add_u32 s40, s40, s12
    s_add_u32 s40, s40, s23
    s_lshl_b32 s40, s40, 2
    s_add_u32 s40, s40, 524288
    s_sub_u32 s21, s72, 1
    s_mov_b32 s22, s73
    s_mov_b32 s23, s74
    s_lshl_b32 s40, s18, 1
    s_lshr_b32 s12, s20, 1
    s_add_u32 s40, s40, s12
    s_lshl_b32 s40, s40, 5
    s_lshl_b32 s12, s19, 1
    s_add_u32 s40, s40, s12
    s_and_b32 s12, s20, 1
    s_add_u32 s40, s40, s12
    s_lshl_b32 s40, s40, 7
    s_add_u32 s40, s40, 6291456
    s_and_b32 s88, s16, 1
    s_lshl_b32 s88, s88, 3
    s_lshr_b32 s89, s16, 1
    s_lshl_b32 s89, s89, 1
    s_add_u32 s88, s88, s89
    s_lshr_b32 s89, s17, 4
    s_add_u32 s88, s88, s89
    s_and_b32 s89, s17, 15
    s_mov_b32 s68, s58
    s_and_b32 s69, s59, 0xffff
    s_mov_b32 s70, 4194304
    s_mov_b32 s71, 0x00020000
    s_and_b32 s90, s20, 3
    s_lshr_b32 s91, s20, 2
    s_lshl_b32 s12, s88, 3
    s_lshl_b32 s13, s90, 1
    s_add_u32 s12, s12, s13
    s_add_u32 s92, s12, s91
    s_lshl_b32 s12, s92, 4
    v_and_b32 v3, 15, v2
    v_add_u32 v6, s12, v3
    v_lshlrev_b32 v8, 2, v6
    v_bfe_u32 v9, v2, 4, 1
    v_lshrrev_b32 v10, 5, v2
    v_lshlrev_b32 v7, 11, v6
    v_lshl_add_u32 v7, v9, 6, v7
    v_lshl_add_u32 v7, v10, 4, v7
    s_lshl_b32 s12, s89, 7
    v_add_u32 v7, s12, v7
    s_mov_b32 s12, 4096
    buffer_load_dwordx4 v[24:27], v7, s[24:27], 0 offen
    buffer_load_dwordx4 v[28:31], v7, s[24:27], 0 offen offset:32
    buffer_load_dword v48, v8, s[32:35], s12 offen sc1
    v_lshlrev_b32 v22, 8, v3
    v_lshl_add_u32 v22, v9, 7, v22
    v_lshl_add_u32 v22, v10, 5, v22
    v_lshlrev_b32 v10, 9, v10
    v_bfe_u32 v11, v2, 2, 2
    v_lshl_add_u32 v10, v11, 7, v10
    v_bfe_u32 v11, v2, 3, 1
    v_lshl_add_u32 v10, v11, 6, v10
    v_lshl_add_u32 v10, v9, 5, v10
    v_and_b32 v11, 3, v2
    v_lshl_add_u32 v10, v11, 3, v10
    v_xor_b32 v11, 64, v10
    s_lshl_b32 s12, s91, 8
    v_xor_b32 v17, s12, v5
    v_lshlrev_b32 v8, 2, v3
    s_lshl_b32 s12, s20, 12
    s_mov_b32 s15, 40960
    s_cmp_lt_u32 s20, 6
    s_cselect_b32 s13, s15, 131072
    s_add_u32 s12, s12, s13
    v_add_u32 v20, s12, v5
    s_xor_b32 s14, s20, 4
    s_lshl_b32 s12, s14, 12
    s_cmp_lt_u32 s14, 6
    s_cselect_b32 s13, s15, 131072
    s_add_u32 s12, s12, s13
    v_add_u32 v21, s12, v5
    s_lshl_b32 s12, s88, 2
    s_add_u32 s12, s12, s90
    s_lshl_b32 s13, s12, 16
    s_lshl_b32 s14, s91, 15
    s_add_u32 s13, s13, s14
    s_add_u32 s95, s13, 8388608
    s_lshl_b32 s12, s88, 12
    s_lshl_b32 s13, s89, 8
    s_mul_i32 s13, s13, 1
    s_add_u32 s12, s12, s13
    s_lshr_b32 s13, s90, 1
    s_lshl_b32 s13, s13, 7
    s_add_u32 s12, s12, s13
    s_lshl_b32 s13, s91, 6
    s_add_u32 s12, s12, s13
    s_add_u32 s15, s12, 524288
    s_lshl_b32 s97, s91, 4
    v_lshlrev_b32 v8, 7, v3
    s_lshl_b32 s12, s88, 1
    s_lshr_b32 s13, s90, 1
    s_add_u32 s12, s12, s13
    s_lshl_b32 s12, s12, 12
    s_lshl_b32 s13, s91, 11
    s_add_u32 s12, s12, s13
    s_and_b32 s13, s89, 0
    s_lshl_b32 s13, s13, 17
    s_add_u32 s12, s12, s13
    s_add_u32 s15, s12, 6291456
    s_mov_b32 s93, s89
    s_waitcnt vmcnt(0)
    v_sub_f32 v50, 1.0, v48
    v_cvt_pk_bf16_f32 v50, v50, v50
    v_lshlrev_b32 v50, 16, v50
    v_lshlrev_b32 v32, 16, v24
    v_and_b32 v33, 0xffff0000, v24
    v_lshlrev_b32 v34, 16, v25
    v_and_b32 v35, 0xffff0000, v25
    v_lshlrev_b32 v36, 16, v26
    v_and_b32 v37, 0xffff0000, v26
    v_lshlrev_b32 v38, 16, v27
    v_and_b32 v39, 0xffff0000, v27
    v_lshlrev_b32 v40, 16, v28
    v_and_b32 v41, 0xffff0000, v28
    v_lshlrev_b32 v42, 16, v29
    v_and_b32 v43, 0xffff0000, v29
    v_lshlrev_b32 v44, 16, v30
    v_and_b32 v45, 0xffff0000, v30
    v_lshlrev_b32 v46, 16, v31
    v_and_b32 v47, 0xffff0000, v31
    v_pk_mul_f32 v[32:33], v[32:33], v[50:51] op_sel_hi:[1,0]
    v_pk_mul_f32 v[34:35], v[34:35], v[50:51] op_sel_hi:[1,0]
    v_pk_mul_f32 v[36:37], v[36:37], v[50:51] op_sel_hi:[1,0]
    v_pk_mul_f32 v[38:39], v[38:39], v[50:51] op_sel_hi:[1,0]
    v_pk_mul_f32 v[40:41], v[40:41], v[50:51] op_sel_hi:[1,0]
    v_pk_mul_f32 v[42:43], v[42:43], v[50:51] op_sel_hi:[1,0]
    v_pk_mul_f32 v[44:45], v[44:45], v[50:51] op_sel_hi:[1,0]
    v_pk_mul_f32 v[46:47], v[46:47], v[50:51] op_sel_hi:[1,0]
    v_cvt_pk_bf16_f32 v33, v32, v33
    v_cvt_pk_bf16_f32 v35, v34, v35
    v_cvt_pk_bf16_f32 v37, v36, v37
    v_cvt_pk_bf16_f32 v39, v38, v39
    v_cvt_pk_bf16_f32 v41, v40, v41
    v_cvt_pk_bf16_f32 v43, v42, v43
    v_cvt_pk_bf16_f32 v45, v44, v45
    v_cvt_pk_bf16_f32 v47, v46, v47
    v_lshlrev_b32 v32, 16, v33
    v_and_b32 v33, 0xffff0000, v33
    v_lshlrev_b32 v34, 16, v35
    v_and_b32 v35, 0xffff0000, v35
    v_lshlrev_b32 v36, 16, v37
    v_and_b32 v37, 0xffff0000, v37
    v_lshlrev_b32 v38, 16, v39
    v_and_b32 v39, 0xffff0000, v39
    v_lshlrev_b32 v40, 16, v41
    v_and_b32 v41, 0xffff0000, v41
    v_lshlrev_b32 v42, 16, v43
    v_and_b32 v43, 0xffff0000, v43
    v_lshlrev_b32 v44, 16, v45
    v_and_b32 v45, 0xffff0000, v45
    v_lshlrev_b32 v46, 16, v47
    v_and_b32 v47, 0xffff0000, v47
    s_mov_b32 s13, 0
    v_mov_b32 v54, 162896
L_c_kz:
    ds_read_b32 v55, v54
    s_add_u32 s13, s13, 1
    s_cmp_ge_u32 s13, 262144
    s_cbranch_scc1 L_c_kzok
    s_waitcnt lgkmcnt(0)
    v_cmp_eq_u32 vcc, 1, v55
    s_cbranch_vccz L_c_kz
L_c_kzok:
    s_mov_b32 s13, 0
L_c_kv:
    buffer_load_dwordx4 v[112:115], v5, s[32:35], s43 offen offset:0 sc1
    buffer_load_dwordx4 v[116:119], v5, s[32:35], s43 offen offset:1024 sc1
    buffer_load_dwordx4 v[120:123], v5, s[32:35], s43 offen offset:2048 sc1
    buffer_load_dwordx4 v[124:127], v5, s[32:35], s43 offen offset:3072 sc1
    buffer_load_dwordx4 v[128:131], v52, s[32:35], s46 offen offset:0 sc1
    buffer_load_dwordx4 v[132:135], v52, s[32:35], s46 offen offset:256 sc1
    buffer_load_dwordx4 v[136:139], v52, s[32:35], s46 offen offset:512 sc1
    buffer_load_dwordx4 v[140:143], v52, s[32:35], s46 offen offset:768 sc1
    s_add_u32 s13, s13, 1
    s_waitcnt vmcnt(0)
    v_max3_u32 v55, v112, v113, v114
    v_max3_u32 v55, v55, v115, v116
    v_max3_u32 v55, v55, v117, v118
    v_max3_u32 v55, v55, v119, v120
    v_max3_u32 v55, v55, v121, v122
    v_max3_u32 v55, v55, v123, v124
    v_max3_u32 v55, v55, v125, v126
    v_max3_u32 v55, v55, v127, v128
    v_max3_u32 v55, v55, v129, v130
    v_max3_u32 v55, v55, v131, v132
    v_max3_u32 v55, v55, v133, v134
    v_max3_u32 v55, v55, v135, v136
    v_max3_u32 v55, v55, v137, v138
    v_max3_u32 v55, v55, v139, v140
    v_max3_u32 v55, v55, v141, v142
    v_max_u32 v55, v55, v143
    v_cmp_eq_u32 vcc, -1, v55
    s_cbranch_vccz L_c_kvok
    s_cmp_lt_u32 s13, 16384
    s_cbranch_scc1 L_c_kv
L_c_kvok:
    v_mfma_f32_32x32x16_bf16 v[192:207], v[128:131], v[80:83], 0
    v_mfma_f32_32x32x16_bf16 v[160:175], v[112:115], v[80:83], 0
    v_mfma_f32_32x32x16_bf16 v[192:207], v[132:135], v[84:87], v[192:207]
    v_mfma_f32_32x32x16_bf16 v[160:175], v[116:119], v[84:87], v[160:175]
    v_mfma_f32_32x32x16_bf16 v[192:207], v[136:139], v[88:91], v[192:207]
    v_mfma_f32_32x32x16_bf16 v[160:175], v[120:123], v[88:91], v[160:175]
    v_mfma_f32_32x32x16_bf16 v[192:207], v[140:143], v[92:95], v[192:207]
    v_mfma_f32_32x32x16_bf16 v[160:175], v[124:127], v[92:95], v[160:175]
    v_mfma_f32_32x32x16_bf16 v[208:223], v[128:131], v[96:99], 0
    v_mfma_f32_32x32x16_bf16 v[176:191], v[112:115], v[96:99], 0
    v_mfma_f32_32x32x16_bf16 v[208:223], v[132:135], v[100:103], v[208:223]
    v_mfma_f32_32x32x16_bf16 v[176:191], v[116:119], v[100:103], v[176:191]
    v_mfma_f32_32x32x16_bf16 v[208:223], v[136:139], v[104:107], v[208:223]
    v_mfma_f32_32x32x16_bf16 v[176:191], v[120:123], v[104:107], v[176:191]
    v_mfma_f32_32x32x16_bf16 v[208:223], v[140:143], v[108:111], v[208:223]
    v_mfma_f32_32x32x16_bf16 v[176:191], v[124:127], v[108:111], v[176:191]
    s_nop 2
    v_cvt_pk_bf16_f32 v56, v192, v192
    v_lshlrev_b32 v56, 16, v56
    v_add_f32 v56, 0x358637bd, v56
    v_cvt_pk_bf16_f32 v56, v56, v56
    v_lshlrev_b32 v56, 16, v56
    v_rcp_f32 v56, v56
    v_cvt_pk_bf16_f32 v64, v160, v161
    v_cvt_pk_bf16_f32 v65, v162, v163
    v_cvt_pk_bf16_f32 v66, v164, v165
    v_cvt_pk_bf16_f32 v67, v166, v167
    v_cvt_pk_bf16_f32 v68, v168, v169
    v_cvt_pk_bf16_f32 v69, v170, v171
    v_cvt_pk_bf16_f32 v70, v172, v173
    v_cvt_pk_bf16_f32 v71, v174, v175
    v_lshlrev_b32 v160, 16, v64
    v_and_b32 v161, 0xffff0000, v64
    v_lshlrev_b32 v162, 16, v65
    v_and_b32 v163, 0xffff0000, v65
    v_lshlrev_b32 v164, 16, v66
    v_and_b32 v165, 0xffff0000, v66
    v_lshlrev_b32 v166, 16, v67
    v_and_b32 v167, 0xffff0000, v67
    v_lshlrev_b32 v168, 16, v68
    v_and_b32 v169, 0xffff0000, v68
    v_lshlrev_b32 v170, 16, v69
    v_and_b32 v171, 0xffff0000, v69
    v_lshlrev_b32 v172, 16, v70
    v_and_b32 v173, 0xffff0000, v70
    v_lshlrev_b32 v174, 16, v71
    v_and_b32 v175, 0xffff0000, v71
    v_pk_mul_f32 v[160:161], v[160:161], v[56:57] op_sel_hi:[1,0]
    v_pk_mul_f32 v[162:163], v[162:163], v[56:57] op_sel_hi:[1,0]
    v_pk_mul_f32 v[164:165], v[164:165], v[56:57] op_sel_hi:[1,0]
    v_pk_mul_f32 v[166:167], v[166:167], v[56:57] op_sel_hi:[1,0]
    v_pk_mul_f32 v[168:169], v[168:169], v[56:57] op_sel_hi:[1,0]
    v_pk_mul_f32 v[170:171], v[170:171], v[56:57] op_sel_hi:[1,0]
    v_pk_mul_f32 v[172:173], v[172:173], v[56:57] op_sel_hi:[1,0]
    v_pk_mul_f32 v[174:175], v[174:175], v[56:57] op_sel_hi:[1,0]
    v_cvt_pk_bf16_f32 v64, v160, v161
    v_cvt_pk_bf16_f32 v65, v162, v163
    v_cvt_pk_bf16_f32 v66, v164, v165
    v_cvt_pk_bf16_f32 v67, v166, v167
    v_cvt_pk_bf16_f32 v68, v168, v169
    v_cvt_pk_bf16_f32 v69, v170, v171
    v_cvt_pk_bf16_f32 v70, v172, v173
    v_cvt_pk_bf16_f32 v71, v174, v175
    buffer_store_dwordx4 v[64:67], v5, s[32:35], s41 offen sc1
    buffer_store_dwordx4 v[68:71], v5, s[32:35], s41 offen offset:1024 sc1
    v_cvt_pk_bf16_f32 v58, v208, v208
    v_lshlrev_b32 v58, 16, v58
    v_add_f32 v58, 0x358637bd, v58
    v_cvt_pk_bf16_f32 v58, v58, v58
    v_lshlrev_b32 v58, 16, v58
    v_rcp_f32 v58, v58
    v_cvt_pk_bf16_f32 v72, v176, v177
    v_cvt_pk_bf16_f32 v73, v178, v179
    v_cvt_pk_bf16_f32 v74, v180, v181
    v_cvt_pk_bf16_f32 v75, v182, v183
    v_cvt_pk_bf16_f32 v76, v184, v185
    v_cvt_pk_bf16_f32 v77, v186, v187
    v_cvt_pk_bf16_f32 v78, v188, v189
    v_cvt_pk_bf16_f32 v79, v190, v191
    v_lshlrev_b32 v176, 16, v72
    v_and_b32 v177, 0xffff0000, v72
    v_lshlrev_b32 v178, 16, v73
    v_and_b32 v179, 0xffff0000, v73
    v_lshlrev_b32 v180, 16, v74
    v_and_b32 v181, 0xffff0000, v74
    v_lshlrev_b32 v182, 16, v75
    v_and_b32 v183, 0xffff0000, v75
    v_lshlrev_b32 v184, 16, v76
    v_and_b32 v185, 0xffff0000, v76
    v_lshlrev_b32 v186, 16, v77
    v_and_b32 v187, 0xffff0000, v77
    v_lshlrev_b32 v188, 16, v78
    v_and_b32 v189, 0xffff0000, v78
    v_lshlrev_b32 v190, 16, v79
    v_and_b32 v191, 0xffff0000, v79
    v_pk_mul_f32 v[176:177], v[176:177], v[58:59] op_sel_hi:[1,0]
    v_pk_mul_f32 v[178:179], v[178:179], v[58:59] op_sel_hi:[1,0]
    v_pk_mul_f32 v[180:181], v[180:181], v[58:59] op_sel_hi:[1,0]
    v_pk_mul_f32 v[182:183], v[182:183], v[58:59] op_sel_hi:[1,0]
    v_pk_mul_f32 v[184:185], v[184:185], v[58:59] op_sel_hi:[1,0]
    v_pk_mul_f32 v[186:187], v[186:187], v[58:59] op_sel_hi:[1,0]
    v_pk_mul_f32 v[188:189], v[188:189], v[58:59] op_sel_hi:[1,0]
    v_pk_mul_f32 v[190:191], v[190:191], v[58:59] op_sel_hi:[1,0]
    v_cvt_pk_bf16_f32 v72, v176, v177
    v_cvt_pk_bf16_f32 v73, v178, v179
    v_cvt_pk_bf16_f32 v74, v180, v181
    v_cvt_pk_bf16_f32 v75, v182, v183
    v_cvt_pk_bf16_f32 v76, v184, v185
    v_cvt_pk_bf16_f32 v77, v186, v187
    v_cvt_pk_bf16_f32 v78, v188, v189
    v_cvt_pk_bf16_f32 v79, v190, v191
    buffer_store_dwordx4 v[72:75], v5, s[32:35], s42 offen sc1
    buffer_store_dwordx4 v[76:79], v5, s[32:35], s42 offen offset:1024 sc1
    v_mov_b32 v56, s23
    v_mov_b32 v57, s23
    v_mov_b32 v58, s23
    v_mov_b32 v59, s23
    v_lshrrev_b32 v60, 3, v2
    v_lshlrev_b32 v60, 17, v60
    v_and_b32 v61, 0x70, v5
    v_add_u32 v60, v60, v61
    s_mov_b32 s45, 0
    s_lshr_b32 s12, s21, 4
    s_cmp_eq_u32 s12, s92
    s_cselect_b32 s46, 1, 0
    s_cbranch_scc0 L_b_noownc
    s_lshl_b32 s12, s89, 12
    s_add_u32 s12, s12, 458752
    buffer_load_dwordx4 v[224:227], v22, s[32:35], s12 offen offset:0 sc1
    buffer_load_dwordx4 v[228:231], v22, s[32:35], s12 offen offset:16 sc1
    buffer_load_dwordx4 v[232:235], v22, s[32:35], s12 offen offset:64 sc1
    buffer_load_dwordx4 v[236:239], v22, s[32:35], s12 offen offset:80 sc1
L_b_noownc:
    s_waitcnt vmcnt(0)
    s_mov_b32 exec_lo, 0xff
    s_mov_b32 exec_hi, 0
    buffer_store_dwordx4 v[56:59], v60, s[32:35], s40 offen sc1
    s_mov_b64 exec, -1
L_phaseb:
    s_setprio 0
    s_nop 4
    s_cmp_lg_u32 s46, 0
    s_cbranch_scc1 L_own
L_own_r0:
    s_nop 0
    s_barrier
    s_mov_b32 s14, 0xffff0000
    s_mov_b32 s47, 0
    s_mov_b32 s96, 0
    s_waitcnt vmcnt(0)
    s_cmp_lg_u32 s96, 0
    s_cbranch_scc1 L_pk0
L_pl0:
    buffer_load_dword v52, v8, s[32:35], s15 offen sc1
    s_add_u32 s47, s47, 1
    s_cmp_ge_u32 s47, 16384
    s_cselect_b32 s12, -1, 0
    s_waitcnt vmcnt(0)
    v_cmp_eq_u32 vcc, s23, v52
    s_nop 1
    s_or_b32 s12, s12, vcc_lo
    s_lshr_b32 s12, s12, s93
    s_or_b32 s96, s96, s12
    s_andn2_b32 s96, s96, s14
    s_cbranch_scc0 L_pl0
L_pk0:
    s_ff1_i32_b32 s12, s96
    s_bitset0_b32 s96, s12
    s_bitset1_b32 s14, s12
    s_add_u32 s12, s12, s93
    s_and_b32 s80, s12, 15
    s_lshl_b32 s94, s80, 11
    s_add_u32 s94, s94, s95
    buffer_load_dwordx4 v[96:99], v17, s[32:35], s94 offen
    buffer_load_dwordx4 v[100:103], v17, s[32:35], s94 offen offset:1024
    s_add_u32 s12, s80, s97
    s_lshl_b32 s13, s12, 12
    s_cmp_ge_u32 s12, 10
    s_cselect_b32 s12, 24576, 0
    s_add_u32 s13, s13, s12
    v_add_u32 v12, s13, v10
    v_add_u32 v13, s13, v11
    ds_read_b64_tr_b16 v[120:121], v12 offset:0
    ds_read_b64_tr_b16 v[122:123], v12 offset:1024
    ds_read_b64_tr_b16 v[124:125], v13 offset:0
    ds_read_b64_tr_b16 v[126:127], v13 offset:1024
    ds_read_b64_tr_b16 v[128:129], v12 offset:2048
    ds_read_b64_tr_b16 v[130:131], v12 offset:3072
    ds_read_b64_tr_b16 v[132:133], v13 offset:2048
    ds_read_b64_tr_b16 v[134:135], v13 offset:3072
    s_cmp_lg_u32 s96, 0
    s_cbranch_scc1 L_pk1
L_pl1:
    buffer_load_dword v53, v8, s[32:35], s15 offen sc1
    s_add_u32 s47, s47, 1
    s_cmp_ge_u32 s47, 16384
    s_cselect_b32 s12, -1, 0
    s_waitcnt vmcnt(0)
    v_cmp_eq_u32 vcc, s23, v53
    s_nop 1
    s_or_b32 s12, s12, vcc_lo
    s_lshr_b32 s12, s12, s93
    s_or_b32 s96, s96, s12
    s_andn2_b32 s96, s96, s14
    s_cbranch_scc0 L_pl1
L_pk1:
    s_ff1_i32_b32 s12, s96
    s_bitset0_b32 s96, s12
    s_bitset1_b32 s14, s12
    s_add_u32 s12, s12, s93
    s_and_b32 s81, s12, 15
    s_lshl_b32 s94, s81, 11
    s_add_u32 s94, s94, s95
    buffer_load_dwordx4 v[104:107], v17, s[32:35], s94 offen
    buffer_load_dwordx4 v[108:111], v17, s[32:35], s94 offen offset:1024
    s_cmp_lg_u32 s96, 0
    s_cbranch_scc1 L_pk2
L_pl2:
    buffer_load_dword v54, v8, s[32:35], s15 offen sc1
    s_add_u32 s47, s47, 1
    s_cmp_ge_u32 s47, 16384
    s_cselect_b32 s12, -1, 0
    s_waitcnt vmcnt(0)
    v_cmp_eq_u32 vcc, s23, v54
    s_nop 1
    s_or_b32 s12, s12, vcc_lo
    s_lshr_b32 s12, s12, s93
    s_or_b32 s96, s96, s12
    s_andn2_b32 s96, s96, s14
    s_cbranch_scc0 L_pl2
L_pk2:
    s_ff1_i32_b32 s12, s96
    s_bitset0_b32 s96, s12
    s_bitset1_b32 s14, s12
    s_add_u32 s12, s12, s93
    s_and_b32 s82, s12, 15
    s_lshl_b32 s94, s82, 11
    s_add_u32 s94, s94, s95
    buffer_load_dwordx4 v[112:115], v17, s[32:35], s94 offen
    buffer_load_dwordx4 v[116:119], v17, s[32:35], s94 offen offset:1024
    s_add_u32 s12, s81, s97
    s_lshl_b32 s13, s12, 12
    s_cmp_ge_u32 s12, 10
    s_cselect_b32 s12, 24576, 0
    s_add_u32 s13, s13, s12
    v_add_u32 v14, s13, v10
    v_add_u32 v15, s13, v11
    s_waitcnt vmcnt(4)
    s_waitcnt lgkmcnt(6)
    v_mfma_f32_32x32x16_bf16 v[64:79], v[120:123], v[96:99], 0
    ds_read_b64_tr_b16 v[136:137], v14 offset:0
    ds_read_b64_tr_b16 v[138:139], v14 offset:1024
    s_waitcnt lgkmcnt(6)
    v_mfma_f32_32x32x16_bf16 v[80:95], v[124:127], v[96:99], 0
    ds_read_b64_tr_b16 v[140:141], v15 offset:0
    ds_read_b64_tr_b16 v[142:143], v15 offset:1024
    s_waitcnt lgkmcnt(6)
    v_mfma_f32_32x32x16_bf16 v[64:79], v[128:131], v[100:103], v[64:79]
    ds_read_b64_tr_b16 v[144:145], v14 offset:2048
    ds_read_b64_tr_b16 v[146:147], v14 offset:3072
    s_waitcnt lgkmcnt(6)
    v_mfma_f32_32x32x16_bf16 v[80:95], v[132:135], v[100:103], v[80:95]
    ds_read_b64_tr_b16 v[148:149], v15 offset:2048
    ds_read_b64_tr_b16 v[150:151], v15 offset:3072
    s_cmp_lg_u32 s96, 0
    s_cbranch_scc1 L_pk3
L_pl3:
    buffer_load_dword v55, v8, s[32:35], s15 offen sc1
    s_add_u32 s47, s47, 1
    s_cmp_ge_u32 s47, 16384
    s_cselect_b32 s12, -1, 0
    s_waitcnt vmcnt(0)
    v_cmp_eq_u32 vcc, s23, v55
    s_nop 1
    s_or_b32 s12, s12, vcc_lo
    s_lshr_b32 s12, s12, s93
    s_or_b32 s96, s96, s12
    s_andn2_b32 s96, s96, s14
    s_cbranch_scc0 L_pl3
L_pk3:
    s_ff1_i32_b32 s12, s96
    s_bitset0_b32 s96, s12
    s_bitset1_b32 s14, s12
    s_add_u32 s12, s12, s93
    s_and_b32 s83, s12, 15
    s_lshl_b32 s94, s83, 11
    s_add_u32 s94, s94, s95
    buffer_load_dwordx4 v[96:99], v17, s[32:35], s94 offen
    buffer_load_dwordx4 v[100:103], v17, s[32:35], s94 offen offset:1024
    s_add_u32 s12, s82, s97
    s_lshl_b32 s13, s12, 12
    s_cmp_ge_u32 s12, 10
    s_cselect_b32 s12, 24576, 0
    s_add_u32 s13, s13, s12
    v_add_u32 v12, s13, v10
    v_add_u32 v13, s13, v11
    s_waitcnt vmcnt(4)
    s_waitcnt lgkmcnt(6)
    v_mfma_f32_32x32x16_bf16 v[64:79], v[136:139], v[104:107], v[64:79]
    ds_read_b64_tr_b16 v[120:121], v12 offset:0
    ds_read_b64_tr_b16 v[122:123], v12 offset:1024
    s_waitcnt lgkmcnt(6)
    v_mfma_f32_32x32x16_bf16 v[80:95], v[140:143], v[104:107], v[80:95]
    ds_read_b64_tr_b16 v[124:125], v13 offset:0
    ds_read_b64_tr_b16 v[126:127], v13 offset:1024
    s_waitcnt lgkmcnt(6)
    v_mfma_f32_32x32x16_bf16 v[64:79], v[144:147], v[108:111], v[64:79]
    ds_read_b64_tr_b16 v[128:129], v12 offset:2048
    ds_read_b64_tr_b16 v[130:131], v12 offset:3072
    s_waitcnt lgkmcnt(6)
    v_mfma_f32_32x32x16_bf16 v[80:95], v[148:151], v[108:111], v[80:95]
    ds_read_b64_tr_b16 v[132:133], v13 offset:2048
    ds_read_b64_tr_b16 v[134:135], v13 offset:3072
    s_cmp_lg_u32 s96, 0
    s_cbranch_scc1 L_pk4
L_pl4:
    buffer_load_dword v56, v8, s[32:35], s15 offen sc1
    s_add_u32 s47, s47, 1
    s_cmp_ge_u32 s47, 16384
    s_cselect_b32 s12, -1, 0
    s_waitcnt vmcnt(0)
    v_cmp_eq_u32 vcc, s23, v56
    s_nop 1
    s_or_b32 s12, s12, vcc_lo
    s_lshr_b32 s12, s12, s93
    s_or_b32 s96, s96, s12
    s_andn2_b32 s96, s96, s14
    s_cbranch_scc0 L_pl4
L_pk4:
    s_ff1_i32_b32 s12, s96
    s_bitset0_b32 s96, s12
    s_bitset1_b32 s14, s12
    s_add_u32 s12, s12, s93
    s_and_b32 s84, s12, 15
    s_lshl_b32 s94, s84, 11
    s_add_u32 s94, s94, s95
    buffer_load_dwordx4 v[104:107], v17, s[32:35], s94 offen
    buffer_load_dwordx4 v[108:111], v17, s[32:35], s94 offen offset:1024
    s_add_u32 s12, s83, s97
    s_lshl_b32 s13, s12, 12
    s_cmp_ge_u32 s12, 10
    s_cselect_b32 s12, 24576, 0
    s_add_u32 s13, s13, s12
    v_add_u32 v14, s13, v10
    v_add_u32 v15, s13, v11
    s_waitcnt vmcnt(4)
    s_waitcnt lgkmcnt(6)
    v_mfma_f32_32x32x16_bf16 v[64:79], v[120:123], v[112:115], v[64:79]
    ds_read_b64_tr_b16 v[136:137], v14 offset:0
    ds_read_b64_tr_b16 v[138:139], v14 offset:1024
    s_waitcnt lgkmcnt(6)
    v_mfma_f32_32x32x16_bf16 v[80:95], v[124:127], v[112:115], v[80:95]
    ds_read_b64_tr_b16 v[140:141], v15 offset:0
    ds_read_b64_tr_b16 v[142:143], v15 offset:1024
    s_waitcnt lgkmcnt(6)
    v_mfma_f32_32x32x16_bf16 v[64:79], v[128:131], v[116:119], v[64:79]
    ds_read_b64_tr_b16 v[144:145], v14 offset:2048
    ds_read_b64_tr_b16 v[146:147], v14 offset:3072
    s_waitcnt lgkmcnt(6)
    v_mfma_f32_32x32x16_bf16 v[80:95], v[132:135], v[116:119], v[80:95]
    ds_read_b64_tr_b16 v[148:149], v15 offset:2048
    ds_read_b64_tr_b16 v[150:151], v15 offset:3072
    s_cmp_lg_u32 s96, 0
    s_cbranch_scc1 L_pk5
L_pl5:
    buffer_load_dword v57, v8, s[32:35], s15 offen sc1
    s_add_u32 s47, s47, 1
    s_cmp_ge_u32 s47, 16384
    s_cselect_b32 s12, -1, 0
    s_waitcnt vmcnt(0)
    v_cmp_eq_u32 vcc, s23, v57
    s_nop 1
    s_or_b32 s12, s12, vcc_lo
    s_lshr_b32 s12, s12, s93
    s_or_b32 s96, s96, s12
    s_andn2_b32 s96, s96, s14
    s_cbranch_scc0 L_pl5
L_pk5:
    s_ff1_i32_b32 s12, s96
    s_bitset0_b32 s96, s12
    s_bitset1_b32 s14, s12
    s_add_u32 s12, s12, s93
    s_and_b32 s85, s12, 15
    s_lshl_b32 s94, s85, 11
    s_add_u32 s94, s94, s95
    buffer_load_dwordx4 v[112:115], v17, s[32:35], s94 offen
    buffer_load_dwordx4 v[116:119], v17, s[32:35], s94 offen offset:1024
    s_add_u32 s12, s84, s97
    s_lshl_b32 s13, s12, 12
    s_cmp_ge_u32 s12, 10
    s_cselect_b32 s12, 24576, 0
    s_add_u32 s13, s13, s12
    v_add_u32 v12, s13, v10
    v_add_u32 v13, s13, v11
    s_waitcnt vmcnt(4)
    s_waitcnt lgkmcnt(6)
    v_mfma_f32_32x32x16_bf16 v[64:79], v[136:139], v[96:99], v[64:79]
    ds_read_b64_tr_b16 v[120:121], v12 offset:0
    ds_read_b64_tr_b16 v[122:123], v12 offset:1024
    s_waitcnt lgkmcnt(6)
    v_mfma_f32_32x32x16_bf16 v[80:95], v[140:143], v[96:99], v[80:95]
    ds_read_b64_tr_b16 v[124:125], v13 offset:0
    ds_read_b64_tr_b16 v[126:127], v13 offset:1024
    s_waitcnt lgkmcnt(6)
    v_mfma_f32_32x32x16_bf16 v[64:79], v[144:147], v[100:103], v[64:79]
    ds_read_b64_tr_b16 v[128:129], v12 offset:2048
    ds_read_b64_tr_b16 v[130:131], v12 offset:3072
    s_waitcnt lgkmcnt(6)
    v_mfma_f32_32x32x16_bf16 v[80:95], v[148:151], v[100:103], v[80:95]
    ds_read_b64_tr_b16 v[132:133], v13 offset:2048
    ds_read_b64_tr_b16 v[134:135], v13 offset:3072
    s_cmp_lg_u32 s96, 0
    s_cbranch_scc1 L_pk6
L_pl6:
    buffer_load_dword v58, v8, s[32:35], s15 offen sc1
    s_add_u32 s47, s47, 1
    s_cmp_ge_u32 s47, 16384
    s_cselect_b32 s12, -1, 0
    s_waitcnt vmcnt(0)
    v_cmp_eq_u32 vcc, s23, v58
    s_nop 1
    s_or_b32 s12, s12, vcc_lo
    s_lshr_b32 s12, s12, s93
    s_or_b32 s96, s96, s12
    s_andn2_b32 s96, s96, s14
    s_cbranch_scc0 L_pl6
L_pk6:
    s_ff1_i32_b32 s12, s96
    s_bitset0_b32 s96, s12
    s_bitset1_b32 s14, s12
    s_add_u32 s12, s12, s93
    s_and_b32 s86, s12, 15
    s_lshl_b32 s94, s86, 11
    s_add_u32 s94, s94, s95
    buffer_load_dwordx4 v[96:99], v17, s[32:35], s94 offen
    buffer_load_dwordx4 v[100:103], v17, s[32:35], s94 offen offset:1024
    s_add_u32 s12, s85, s97
    s_lshl_b32 s13, s12, 12
    s_cmp_ge_u32 s12, 10
    s_cselect_b32 s12, 24576, 0
    s_add_u32 s13, s13, s12
    v_add_u32 v14, s13, v10
    v_add_u32 v15, s13, v11
    s_waitcnt vmcnt(4)
    s_waitcnt lgkmcnt(6)
    v_mfma_f32_32x32x16_bf16 v[64:79], v[120:123], v[104:107], v[64:79]
    ds_read_b64_tr_b16 v[136:137], v14 offset:0
    ds_read_b64_tr_b16 v[138:139], v14 offset:1024
    s_waitcnt lgkmcnt(6)
    v_mfma_f32_32x32x16_bf16 v[80:95], v[124:127], v[104:107], v[80:95]
    ds_read_b64_tr_b16 v[140:141], v15 offset:0
    ds_read_b64_tr_b16 v[142:143], v15 offset:1024
    s_waitcnt lgkmcnt(6)
    v_mfma_f32_32x32x16_bf16 v[64:79], v[128:131], v[108:111], v[64:79]
    ds_read_b64_tr_b16 v[144:145], v14 offset:2048
    ds_read_b64_tr_b16 v[146:147], v14 offset:3072
    s_waitcnt lgkmcnt(6)
    v_mfma_f32_32x32x16_bf16 v[80:95], v[132:135], v[108:111], v[80:95]
    ds_read_b64_tr_b16 v[148:149], v15 offset:2048
    ds_read_b64_tr_b16 v[150:151], v15 offset:3072
    s_cmp_lg_u32 s96, 0
    s_cbranch_scc1 L_pk7
L_pl7:
    buffer_load_dword v59, v8, s[32:35], s15 offen sc1
    s_add_u32 s47, s47, 1
    s_cmp_ge_u32 s47, 16384
    s_cselect_b32 s12, -1, 0
    s_waitcnt vmcnt(0)
    v_cmp_eq_u32 vcc, s23, v59
    s_nop 1
    s_or_b32 s12, s12, vcc_lo
    s_lshr_b32 s12, s12, s93
    s_or_b32 s96, s96, s12
    s_andn2_b32 s96, s96, s14
    s_cbranch_scc0 L_pl7
L_pk7:
    s_ff1_i32_b32 s12, s96
    s_bitset0_b32 s96, s12
    s_bitset1_b32 s14, s12
    s_add_u32 s12, s12, s93
    s_and_b32 s87, s12, 15
    s_lshl_b32 s94, s87, 11
    s_add_u32 s94, s94, s95
    buffer_load_dwordx4 v[104:107], v17, s[32:35], s94 offen
    buffer_load_dwordx4 v[108:111], v17, s[32:35], s94 offen offset:1024
    s_add_u32 s12, s86, s97
    s_lshl_b32 s13, s12, 12
    s_cmp_ge_u32 s12, 10
    s_cselect_b32 s12, 24576, 0
    s_add_u32 s13, s13, s12
    v_add_u32 v12, s13, v10
    v_add_u32 v13, s13, v11
    s_waitcnt vmcnt(4)
    s_waitcnt lgkmcnt(6)
    v_mfma_f32_32x32x16_bf16 v[64:79], v[136:139], v[112:115], v[64:79]
    ds_read_b64_tr_b16 v[120:121], v12 offset:0
    ds_read_b64_tr_b16 v[122:123], v12 offset:1024
    s_waitcnt lgkmcnt(6)
    v_mfma_f32_32x32x16_bf16 v[80:95], v[140:143], v[112:115], v[80:95]
    ds_read_b64_tr_b16 v[124:125], v13 offset:0
    ds_read_b64_tr_b16 v[126:127], v13 offset:1024
    s_waitcnt lgkmcnt(6)
    v_mfma_f32_32x32x16_bf16 v[64:79], v[144:147], v[116:119], v[64:79]
    ds_read_b64_tr_b16 v[128:129], v12 offset:2048
    ds_read_b64_tr_b16 v[130:131], v12 offset:3072
    s_waitcnt lgkmcnt(6)
    v_mfma_f32_32x32x16_bf16 v[80:95], v[148:151], v[116:119], v[80:95]
    ds_read_b64_tr_b16 v[132:133], v13 offset:2048
    ds_read_b64_tr_b16 v[134:135], v13 offset:3072
    s_cmp_lg_u32 s96, 0
    s_cbranch_scc1 L_pk8
L_pl8:
    buffer_load_dword v52, v8, s[32:35], s15 offen sc1
    s_add_u32 s47, s47, 1
    s_cmp_ge_u32 s47, 16384
    s_cselect_b32 s12, -1, 0
    s_waitcnt vmcnt(0)
    v_cmp_eq_u32 vcc, s23, v52
    s_nop 1
    s_or_b32 s12, s12, vcc_lo
    s_lshr_b32 s12, s12, s93
    s_or_b32 s96, s96, s12
    s_andn2_b32 s96, s96, s14
    s_cbranch_scc0 L_pl8
L_pk8:
    s_ff1_i32_b32 s12, s96
    s_bitset0_b32 s96, s12
    s_bitset1_b32 s14, s12
    s_add_u32 s12, s12, s93
    s_and_b32 s80, s12, 15
    s_lshl_b32 s94, s80, 11
    s_add_u32 s94, s94, s95
    buffer_load_dwordx4 v[112:115], v17, s[32:35], s94 offen
    buffer_load_dwordx4 v[116:119], v17, s[32:35], s94 offen offset:1024
    s_add_u32 s12, s87, s97
    s_lshl_b32 s13, s12, 12
    s_cmp_ge_u32 s12, 10
    s_cselect_b32 s12, 24576, 0
    s_add_u32 s13, s13, s12
    v_add_u32 v14, s13, v10
    v_add_u32 v15, s13, v11
    s_waitcnt vmcnt(4)
    s_waitcnt lgkmcnt(6)
    v_mfma_f32_32x32x16_bf16 v[64:79], v[120:123], v[96:99], v[64:79]
    ds_read_b64_tr_b16 v[136:137], v14 offset:0
    ds_read_b64_tr_b16 v[138:139], v14 offset:1024
    s_waitcnt lgkmcnt(6)
    v_mfma_f32_32x32x16_bf16 v[80:95], v[124:127], v[96:99], v[80:95]
    ds_read_b64_tr_b16 v[140:141], v15 offset:0
    ds_read_b64_tr_b16 v[142:143], v15 offset:1024
    s_waitcnt lgkmcnt(6)
    v_mfma_f32_32x32x16_bf16 v[64:79], v[128:131], v[100:103], v[64:79]
    ds_read_b64_tr_b16 v[144:145], v14 offset:2048
    ds_read_b64_tr_b16 v[146:147], v14 offset:3072
    s_waitcnt lgkmcnt(6)
    v_mfma_f32_32x32x16_bf16 v[80:95], v[132:135], v[100:103], v[80:95]
    ds_read_b64_tr_b16 v[148:149], v15 offset:2048
    ds_read_b64_tr_b16 v[150:151], v15 offset:3072
    s_cmp_lg_u32 s96, 0
    s_cbranch_scc1 L_pk9
L_pl9:
    buffer_load_dword v53, v8, s[32:35], s15 offen sc1
    s_add_u32 s47, s47, 1
    s_cmp_ge_u32 s47, 16384
    s_cselect_b32 s12, -1, 0
    s_waitcnt vmcnt(0)
    v_cmp_eq_u32 vcc, s23, v53
    s_nop 1
    s_or_b32 s12, s12, vcc_lo
    s_lshr_b32 s12, s12, s93
    s_or_b32 s96, s96, s12
    s_andn2_b32 s96, s96, s14
    s_cbranch_scc0 L_pl9
L_pk9:
    s_ff1_i32_b32 s12, s96
    s_bitset0_b32 s96, s12
    s_bitset1_b32 s14, s12
    s_add_u32 s12, s12, s93
    s_and_b32 s81, s12, 15
    s_lshl_b32 s94, s81, 11
    s_add_u32 s94, s94, s95
    buffer_load_dwordx4 v[96:99], v17, s[32:35], s94 offen
    buffer_load_dwordx4 v[100:103], v17, s[32:35], s94 offen offset:1024
    s_add_u32 s12, s80, s97
    s_lshl_b32 s13, s12, 12
    s_cmp_ge_u32 s12, 10
    s_cselect_b32 s12, 24576, 0
    s_add_u32 s13, s13, s12
    v_add_u32 v12, s13, v10
    v_add_u32 v13, s13, v11
    s_waitcnt vmcnt(4)
    s_waitcnt lgkmcnt(6)
    v_mfma_f32_32x32x16_bf16 v[64:79], v[136:139], v[104:107], v[64:79]
    ds_read_b64_tr_b16 v[120:121], v12 offset:0
    ds_read_b64_tr_b16 v[122:123], v12 offset:1024
    s_waitcnt lgkmcnt(6)
    v_mfma_f32_32x32x16_bf16 v[80:95], v[140:143], v[104:107], v[80:95]
    ds_read_b64_tr_b16 v[124:125], v13 offset:0
    ds_read_b64_tr_b16 v[126:127], v13 offset:1024
    s_waitcnt lgkmcnt(6)
    v_mfma_f32_32x32x16_bf16 v[64:79], v[144:147], v[108:111], v[64:79]
    ds_read_b64_tr_b16 v[128:129], v12 offset:2048
    ds_read_b64_tr_b16 v[130:131], v12 offset:3072
    s_waitcnt lgkmcnt(6)
    v_mfma_f32_32x32x16_bf16 v[80:95], v[148:151], v[108:111], v[80:95]
    ds_read_b64_tr_b16 v[132:133], v13 offset:2048
    ds_read_b64_tr_b16 v[134:135], v13 offset:3072
    s_cmp_lg_u32 s96, 0
    s_cbranch_scc1 L_pk10
L_pl10:
    buffer_load_dword v54, v8, s[32:35], s15 offen sc1
    s_add_u32 s47, s47, 1
    s_cmp_ge_u32 s47, 16384
    s_cselect_b32 s12, -1, 0
    s_waitcnt vmcnt(0)
    v_cmp_eq_u32 vcc, s23, v54
    s_nop 1
    s_or_b32 s12, s12, vcc_lo
    s_lshr_b32 s12, s12, s93
    s_or_b32 s96, s96, s12
    s_andn2_b32 s96, s96, s14
    s_cbranch_scc0 L_pl10
L_pk10:
    s_ff1_i32_b32 s12, s96
    s_bitset0_b32 s96, s12
    s_bitset1_b32 s14, s12
    s_add_u32 s12, s12, s93
    s_and_b32 s82, s12, 15
    s_lshl_b32 s94, s82, 11
    s_add_u32 s94, s94, s95
    buffer_load_dwordx4 v[104:107], v17, s[32:35], s94 offen
    buffer_load_dwordx4 v[108:111], v17, s[32:35], s94 offen offset:1024
    s_add_u32 s12, s81, s97
    s_lshl_b32 s13, s12, 12
    s_cmp_ge_u32 s12, 10
    s_cselect_b32 s12, 24576, 0
    s_add_u32 s13, s13, s12
    v_add_u32 v14, s13, v10
    v_add_u32 v15, s13, v11
    s_waitcnt vmcnt(4)
    s_waitcnt lgkmcnt(6)
    v_mfma_f32_32x32x16_bf16 v[64:79], v[120:123], v[112:115], v[64:79]
    ds_read_b64_tr_b16 v[136:137], v14 offset:0
    ds_read_b64_tr_b16 v[138:139], v14 offset:1024
    s_waitcnt lgkmcnt(6)
    v_mfma_f32_32x32x16_bf16 v[80:95], v[124:127], v[112:115], v[80:95]
    ds_read_b64_tr_b16 v[140:141], v15 offset:0
    ds_read_b64_tr_b16 v[142:143], v15 offset:1024
    s_waitcnt lgkmcnt(6)
    v_mfma_f32_32x32x16_bf16 v[64:79], v[128:131], v[116:119], v[64:79]
    ds_read_b64_tr_b16 v[144:145], v14 offset:2048
    ds_read_b64_tr_b16 v[146:147], v14 offset:3072
    s_waitcnt lgkmcnt(6)
    v_mfma_f32_32x32x16_bf16 v[80:95], v[132:135], v[116:119], v[80:95]
    ds_read_b64_tr_b16 v[148:149], v15 offset:2048
    ds_read_b64_tr_b16 v[150:151], v15 offset:3072
    s_cmp_lg_u32 s96, 0
    s_cbranch_scc1 L_pk11
L_pl11:
    buffer_load_dword v55, v8, s[32:35], s15 offen sc1
    s_add_u32 s47, s47, 1
    s_cmp_ge_u32 s47, 16384
    s_cselect_b32 s12, -1, 0
    s_waitcnt vmcnt(0)
    v_cmp_eq_u32 vcc, s23, v55
    s_nop 1
    s_or_b32 s12, s12, vcc_lo
    s_lshr_b32 s12, s12, s93
    s_or_b32 s96, s96, s12
    s_andn2_b32 s96, s96, s14
    s_cbranch_scc0 L_pl11
L_pk11:
    s_ff1_i32_b32 s12, s96
    s_bitset0_b32 s96, s12
    s_bitset1_b32 s14, s12
    s_add_u32 s12, s12, s93
    s_and_b32 s83, s12, 15
    s_lshl_b32 s94, s83, 11
    s_add_u32 s94, s94, s95
    buffer_load_dwordx4 v[112:115], v17, s[32:35], s94 offen
    buffer_load_dwordx4 v[116:119], v17, s[32:35], s94 offen offset:1024
    s_add_u32 s12, s82, s97
    s_lshl_b32 s13, s12, 12
    s_cmp_ge_u32 s12, 10
    s_cselect_b32 s12, 24576, 0
    s_add_u32 s13, s13, s12
    v_add_u32 v12, s13, v10
    v_add_u32 v13, s13, v11
    s_waitcnt vmcnt(4)
    s_waitcnt lgkmcnt(6)
    v_mfma_f32_32x32x16_bf16 v[64:79], v[136:139], v[96:99], v[64:79]
    ds_read_b64_tr_b16 v[120:121], v12 offset:0
    ds_read_b64_tr_b16 v[122:123], v12 offset:1024
    s_waitcnt lgkmcnt(6)
    v_mfma_f32_32x32x16_bf16 v[80:95], v[140:143], v[96:99], v[80:95]
    ds_read_b64_tr_b16 v[124:125], v13 offset:0
    ds_read_b64_tr_b16 v[126:127], v13 offset:1024
    s_waitcnt lgkmcnt(6)
    v_mfma_f32_32x32x16_bf16 v[64:79], v[144:147], v[100:103], v[64:79]
    ds_read_b64_tr_b16 v[128:129], v12 offset:2048
    ds_read_b64_tr_b16 v[130:131], v12 offset:3072
    s_waitcnt lgkmcnt(6)
    v_mfma_f32_32x32x16_bf16 v[80:95], v[148:151], v[100:103], v[80:95]
    ds_read_b64_tr_b16 v[132:133], v13 offset:2048
    ds_read_b64_tr_b16 v[134:135], v13 offset:3072
    s_cmp_lg_u32 s96, 0
    s_cbranch_scc1 L_pk12
L_pl12:
    buffer_load_dword v56, v8, s[32:35], s15 offen sc1
    s_add_u32 s47, s47, 1
    s_cmp_ge_u32 s47, 16384
    s_cselect_b32 s12, -1, 0
    s_waitcnt vmcnt(0)
    v_cmp_eq_u32 vcc, s23, v56
    s_nop 1
    s_or_b32 s12, s12, vcc_lo
    s_lshr_b32 s12, s12, s93
    s_or_b32 s96, s96, s12
    s_andn2_b32 s96, s96, s14
    s_cbranch_scc0 L_pl12
L_pk12:
    s_ff1_i32_b32 s12, s96
    s_bitset0_b32 s96, s12
    s_bitset1_b32 s14, s12
    s_add_u32 s12, s12, s93
    s_and_b32 s84, s12, 15
    s_lshl_b32 s94, s84, 11
    s_add_u32 s94, s94, s95
    buffer_load_dwordx4 v[96:99], v17, s[32:35], s94 offen
    buffer_load_dwordx4 v[100:103], v17, s[32:35], s94 offen offset:1024
    s_add_u32 s12, s83, s97
    s_lshl_b32 s13, s12, 12
    s_cmp_ge_u32 s12, 10
    s_cselect_b32 s12, 24576, 0
    s_add_u32 s13, s13, s12
    v_add_u32 v14, s13, v10
    v_add_u32 v15, s13, v11
    s_waitcnt vmcnt(4)
    s_waitcnt lgkmcnt(6)
    v_mfma_f32_32x32x16_bf16 v[64:79], v[120:123], v[104:107], v[64:79]
    ds_read_b64_tr_b16 v[136:137], v14 offset:0
    ds_read_b64_tr_b16 v[138:139], v14 offset:1024
    s_waitcnt lgkmcnt(6)
    v_mfma_f32_32x32x16_bf16 v[80:95], v[124:127], v[104:107], v[80:95]
    ds_read_b64_tr_b16 v[140:141], v15 offset:0
    ds_read_b64_tr_b16 v[142:143], v15 offset:1024
    s_waitcnt lgkmcnt(6)
    v_mfma_f32_32x32x16_bf16 v[64:79], v[128:131], v[108:111], v[64:79]
    ds_read_b64_tr_b16 v[144:145], v14 offset:2048
    ds_read_b64_tr_b16 v[146:147], v14 offset:3072
    s_waitcnt lgkmcnt(6)
    v_mfma_f32_32x32x16_bf16 v[80:95], v[132:135], v[108:111], v[80:95]
    ds_read_b64_tr_b16 v[148:149], v15 offset:2048
    ds_read_b64_tr_b16 v[150:151], v15 offset:3072
    s_cmp_lg_u32 s96, 0
    s_cbranch_scc1 L_pk13
L_pl13:
    buffer_load_dword v57, v8, s[32:35], s15 offen sc1
    s_add_u32 s47, s47, 1
    s_cmp_ge_u32 s47, 16384
    s_cselect_b32 s12, -1, 0
    s_waitcnt vmcnt(0)
    v_cmp_eq_u32 vcc, s23, v57
    s_nop 1
    s_or_b32 s12, s12, vcc_lo
    s_lshr_b32 s12, s12, s93
    s_or_b32 s96, s96, s12
    s_andn2_b32 s96, s96, s14
    s_cbranch_scc0 L_pl13
L_pk13:
    s_ff1_i32_b32 s12, s96
    s_bitset0_b32 s96, s12
    s_bitset1_b32 s14, s12
    s_add_u32 s12, s12, s93
    s_and_b32 s85, s12, 15
    s_lshl_b32 s94, s85, 11
    s_add_u32 s94, s94, s95
    buffer_load_dwordx4 v[104:107], v17, s[32:35], s94 offen
    buffer_load_dwordx4 v[108:111], v17, s[32:35], s94 offen offset:1024
    s_add_u32 s12, s84, s97
    s_lshl_b32 s13, s12, 12
    s_cmp_ge_u32 s12, 10
    s_cselect_b32 s12, 24576, 0
    s_add_u32 s13, s13, s12
    v_add_u32 v12, s13, v10
    v_add_u32 v13, s13, v11
    s_waitcnt vmcnt(4)
    s_waitcnt lgkmcnt(6)
    v_mfma_f32_32x32x16_bf16 v[64:79], v[136:139], v[112:115], v[64:79]
    ds_read_b64_tr_b16 v[120:121], v12 offset:0
    ds_read_b64_tr_b16 v[122:123], v12 offset:1024
    s_waitcnt lgkmcnt(6)
    v_mfma_f32_32x32x16_bf16 v[80:95], v[140:143], v[112:115], v[80:95]
    ds_read_b64_tr_b16 v[124:125], v13 offset:0
    ds_read_b64_tr_b16 v[126:127], v13 offset:1024
    s_waitcnt lgkmcnt(6)
    v_mfma_f32_32x32x16_bf16 v[64:79], v[144:147], v[116:119], v[64:79]
    ds_read_b64_tr_b16 v[128:129], v12 offset:2048
    ds_read_b64_tr_b16 v[130:131], v12 offset:3072
    s_waitcnt lgkmcnt(6)
    v_mfma_f32_32x32x16_bf16 v[80:95], v[148:151], v[116:119], v[80:95]
    ds_read_b64_tr_b16 v[132:133], v13 offset:2048
    ds_read_b64_tr_b16 v[134:135], v13 offset:3072
    s_cmp_lg_u32 s96, 0
    s_cbranch_scc1 L_pk14
L_pl14:
    buffer_load_dword v58, v8, s[32:35], s15 offen sc1
    s_add_u32 s47, s47, 1
    s_cmp_ge_u32 s47, 16384
    s_cselect_b32 s12, -1, 0
    s_waitcnt vmcnt(0)
    v_cmp_eq_u32 vcc, s23, v58
    s_nop 1
    s_or_b32 s12, s12, vcc_lo
    s_lshr_b32 s12, s12, s93
    s_or_b32 s96, s96, s12
    s_andn2_b32 s96, s96, s14
    s_cbranch_scc0 L_pl14
L_pk14:
    s_ff1_i32_b32 s12, s96
    s_bitset0_b32 s96, s12
    s_bitset1_b32 s14, s12
    s_add_u32 s12, s12, s93
    s_and_b32 s86, s12, 15
    s_lshl_b32 s94, s86, 11
    s_add_u32 s94, s94, s95
    buffer_load_dwordx4 v[112:115], v17, s[32:35], s94 offen
    buffer_load_dwordx4 v[116:119], v17, s[32:35], s94 offen offset:1024
    s_add_u32 s12, s85, s97
    s_lshl_b32 s13, s12, 12
    s_cmp_ge_u32 s12, 10
    s_cselect_b32 s12, 24576, 0
    s_add_u32 s13, s13, s12
    v_add_u32 v14, s13, v10
    v_add_u32 v15, s13, v11
    s_waitcnt vmcnt(4)
    s_waitcnt lgkmcnt(6)
    v_mfma_f32_32x32x16_bf16 v[64:79], v[120:123], v[96:99], v[64:79]
    ds_read_b64_tr_b16 v[136:137], v14 offset:0
    ds_read_b64_tr_b16 v[138:139], v14 offset:1024
    s_waitcnt lgkmcnt(6)
    v_mfma_f32_32x32x16_bf16 v[80:95], v[124:127], v[96:99], v[80:95]
    ds_read_b64_tr_b16 v[140:141], v15 offset:0
    ds_read_b64_tr_b16 v[142:143], v15 offset:1024
    s_waitcnt lgkmcnt(6)
    v_mfma_f32_32x32x16_bf16 v[64:79], v[128:131], v[100:103], v[64:79]
    ds_read_b64_tr_b16 v[144:145], v14 offset:2048
    ds_read_b64_tr_b16 v[146:147], v14 offset:3072
    s_waitcnt lgkmcnt(6)
    v_mfma_f32_32x32x16_bf16 v[80:95], v[132:135], v[100:103], v[80:95]
    ds_read_b64_tr_b16 v[148:149], v15 offset:2048
    ds_read_b64_tr_b16 v[150:151], v15 offset:3072
    s_cmp_lg_u32 s96, 0
    s_cbranch_scc1 L_pk15
L_pl15:
    buffer_load_dword v59, v8, s[32:35], s15 offen sc1
    s_add_u32 s47, s47, 1
    s_cmp_ge_u32 s47, 16384
    s_cselect_b32 s12, -1, 0
    s_waitcnt vmcnt(0)
    v_cmp_eq_u32 vcc, s23, v59
    s_nop 1
    s_or_b32 s12, s12, vcc_lo
    s_lshr_b32 s12, s12, s93
    s_or_b32 s96, s96, s12
    s_andn2_b32 s96, s96, s14
    s_cbranch_scc0 L_pl15
L_pk15:
    s_ff1_i32_b32 s12, s96
    s_bitset0_b32 s96, s12
    s_bitset1_b32 s14, s12
    s_add_u32 s12, s12, s93
    s_and_b32 s87, s12, 15
    s_lshl_b32 s94, s87, 11
    s_add_u32 s94, s94, s95
    buffer_load_dwordx4 v[96:99], v17, s[32:35], s94 offen
    buffer_load_dwordx4 v[100:103], v17, s[32:35], s94 offen offset:1024
    s_mov_b32 s45, 1
    s_cmp_eq_u32 s46, 0
    s_cbranch_scc1 L_b_nold
    s_lshl_b32 s12, s89, 12
    s_add_u32 s12, s12, 458752
    buffer_load_dwordx4 v[224:227], v22, s[32:35], s12 offen offset:0 sc1
    buffer_load_dwordx4 v[228:231], v22, s[32:35], s12 offen offset:16 sc1
    buffer_load_dwordx4 v[232:235], v22, s[32:35], s12 offen offset:64 sc1
    buffer_load_dwordx4 v[236:239], v22, s[32:35], s12 offen offset:80 sc1
L_b_nold:
    s_add_u32 s12, s86, s97
    s_lshl_b32 s13, s12, 12
    s_cmp_ge_u32 s12, 10
    s_cselect_b32 s12, 24576, 0
    s_add_u32 s13, s13, s12
    v_add_u32 v12, s13, v10
    v_add_u32 v13, s13, v11
    s_waitcnt vmcnt(4)
    s_waitcnt lgkmcnt(6)
    v_mfma_f32_32x32x16_bf16 v[64:79], v[136:139], v[104:107], v[64:79]
    ds_read_b64_tr_b16 v[120:121], v12 offset:0
    ds_read_b64_tr_b16 v[122:123], v12 offset:1024
    s_waitcnt lgkmcnt(6)
    v_mfma_f32_32x32x16_bf16 v[80:95], v[140:143], v[104:107], v[80:95]
    ds_read_b64_tr_b16 v[124:125], v13 offset:0
    ds_read_b64_tr_b16 v[126:127], v13 offset:1024
    s_waitcnt lgkmcnt(6)
    v_mfma_f32_32x32x16_bf16 v[64:79], v[144:147], v[108:111], v[64:79]
    ds_read_b64_tr_b16 v[128:129], v12 offset:2048
    ds_read_b64_tr_b16 v[130:131], v12 offset:3072
    s_waitcnt lgkmcnt(6)
    v_mfma_f32_32x32x16_bf16 v[80:95], v[148:151], v[108:111], v[80:95]
    ds_read_b64_tr_b16 v[132:133], v13 offset:2048
    ds_read_b64_tr_b16 v[134:135], v13 offset:3072
    s_add_u32 s12, s87, s97
    s_lshl_b32 s13, s12, 12
    s_cmp_ge_u32 s12, 10
    s_cselect_b32 s12, 24576, 0
    s_add_u32 s13, s13, s12
    v_add_u32 v14, s13, v10
    v_add_u32 v15, s13, v11
    s_waitcnt vmcnt(2)
    s_waitcnt lgkmcnt(6)
    v_mfma_f32_32x32x16_bf16 v[64:79], v[120:123], v[112:115], v[64:79]
    ds_read_b64_tr_b16 v[136:137], v14 offset:0
    ds_read_b64_tr_b16 v[138:139], v14 offset:1024
    s_waitcnt lgkmcnt(6)
    v_mfma_f32_32x32x16_bf16 v[80:95], v[124:127], v[112:115], v[80:95]
    ds_read_b64_tr_b16 v[140:141], v15 offset:0
    ds_read_b64_tr_b16 v[142:143], v15 offset:1024
    s_waitcnt lgkmcnt(6)
    v_mfma_f32_32x32x16_bf16 v[64:79], v[128:131], v[116:119], v[64:79]
    ds_read_b64_tr_b16 v[144:145], v14 offset:2048
    ds_read_b64_tr_b16 v[146:147], v14 offset:3072
    s_waitcnt lgkmcnt(6)
    v_mfma_f32_32x32x16_bf16 v[80:95], v[132:135], v[116:119], v[80:95]
    ds_read_b64_tr_b16 v[148:149], v15 offset:2048
    ds_read_b64_tr_b16 v[150:151], v15 offset:3072
    s_waitcnt vmcnt(0)
    s_waitcnt lgkmcnt(6)
    v_mfma_f32_32x32x16_bf16 v[64:79], v[136:139], v[96:99], v[64:79]
    s_waitcnt lgkmcnt(4)
    v_mfma_f32_32x32x16_bf16 v[80:95], v[140:143], v[96:99], v[80:95]
    s_waitcnt lgkmcnt(2)
    v_mfma_f32_32x32x16_bf16 v[64:79], v[144:147], v[100:103], v[64:79]
    s_waitcnt lgkmcnt(0)
    v_mfma_f32_32x32x16_bf16 v[80:95], v[148:151], v[100:103], v[80:95]
    s_cmp_lg_u32 s46, 0
    s_cbranch_scc1 L_own
L_own_r1:
    s_nop 0
    s_nop 8
    v_permlane16_swap_b32 v64, v80
    v_permlane16_swap_b32 v65, v81
    v_permlane16_swap_b32 v66, v82
    v_permlane16_swap_b32 v67, v83
    v_permlane16_swap_b32 v68, v84
    v_permlane16_swap_b32 v69, v85
    v_permlane16_swap_b32 v70, v86
    v_permlane16_swap_b32 v71, v87
    v_permlane16_swap_b32 v72, v88
    v_permlane16_swap_b32 v73, v89
    v_permlane16_swap_b32 v74, v90
    v_permlane16_swap_b32 v75, v91
    v_permlane16_swap_b32 v76, v92
    v_permlane16_swap_b32 v77, v93
    v_permlane16_swap_b32 v78, v94
    v_permlane16_swap_b32 v79, v95
    ds_write_b128 v20, v[80:83] offset:0
    ds_write_b128 v20, v[84:87] offset:1024
    ds_write_b128 v20, v[88:91] offset:2048
    ds_write_b128 v20, v[92:95] offset:3072
    s_waitcnt lgkmcnt(0)
    v_bfe_u32 v9, v2, 3, 1
    v_mul_u32_u24 v9, 16352, v9
    v_sub_u32 v7, v7, v9
    s_mov_b32 s12, 16384
    s_barrier
    ds_read_b128 v[80:83], v21 offset:0
    ds_read_b128 v[84:87], v21 offset:1024
    ds_read_b128 v[88:91], v21 offset:2048
    ds_read_b128 v[92:95], v21 offset:3072
    s_waitcnt lgkmcnt(3)
    v_pk_add_f32 v[64:65], v[64:65], v[80:81]
    v_pk_add_f32 v[66:67], v[66:67], v[82:83]
    v_cvt_pk_bf16_f32 v96, v64, v65
    v_cvt_pk_bf16_f32 v97, v66, v67
    s_waitcnt lgkmcnt(2)
    v_pk_add_f32 v[68:69], v[68:69], v[84:85]
    v_pk_add_f32 v[70:71], v[70:71], v[86:87]
    v_cvt_pk_bf16_f32 v98, v68, v69
    v_cvt_pk_bf16_f32 v99, v70, v71
    s_waitcnt lgkmcnt(1)
    v_pk_add_f32 v[72:73], v[72:73], v[88:89]
    v_pk_add_f32 v[74:75], v[74:75], v[90:91]
    v_cvt_pk_bf16_f32 v100, v72, v73
    v_cvt_pk_bf16_f32 v101, v74, v75
    s_waitcnt lgkmcnt(0)
    v_pk_add_f32 v[76:77], v[76:77], v[92:93]
    v_pk_add_f32 v[78:79], v[78:79], v[94:95]
    v_cvt_pk_bf16_f32 v102, v76, v77
    v_cvt_pk_bf16_f32 v103, v78, v79
    v_permlane32_swap_b32 v96, v98
    v_permlane32_swap_b32 v97, v99
    v_permlane32_swap_b32 v100, v102
    v_permlane32_swap_b32 v101, v103
    v_lshlrev_b32 v104, 16, v96
    v_and_b32 v105, 0xffff0000, v96
    v_lshlrev_b32 v106, 16, v97
    v_and_b32 v107, 0xffff0000, v97
    v_lshlrev_b32 v108, 16, v98
    v_and_b32 v109, 0xffff0000, v98
    v_lshlrev_b32 v110, 16, v99
    v_and_b32 v111, 0xffff0000, v99
    v_pk_mul_f32 v[104:105], v[104:105], v[48:49] op_sel_hi:[1,0]
    v_pk_mul_f32 v[106:107], v[106:107], v[48:49] op_sel_hi:[1,0]
    v_pk_mul_f32 v[108:109], v[108:109], v[48:49] op_sel_hi:[1,0]
    v_pk_mul_f32 v[110:111], v[110:111], v[48:49] op_sel_hi:[1,0]
    v_cvt_pk_bf16_f32 v96, v104, v105
    v_cvt_pk_bf16_f32 v97, v106, v107
    v_cvt_pk_bf16_f32 v98, v108, v109
    v_cvt_pk_bf16_f32 v99, v110, v111
    v_lshlrev_b32 v104, 16, v96
    v_and_b32 v105, 0xffff0000, v96
    v_lshlrev_b32 v106, 16, v97
    v_and_b32 v107, 0xffff0000, v97
    v_lshlrev_b32 v108, 16, v98
    v_and_b32 v109, 0xffff0000, v98
    v_lshlrev_b32 v110, 16, v99
    v_and_b32 v111, 0xffff0000, v99
    v_pk_add_f32 v[104:105], v[104:105], v[32:33]
    v_pk_add_f32 v[106:107], v[106:107], v[34:35]
    v_pk_add_f32 v[108:109], v[108:109], v[36:37]
    v_pk_add_f32 v[110:111], v[110:111], v[38:39]
    v_cvt_pk_bf16_f32 v96, v104, v105
    v_cvt_pk_bf16_f32 v97, v106, v107
    v_cvt_pk_bf16_f32 v98, v108, v109
    v_cvt_pk_bf16_f32 v99, v110, v111
    v_lshlrev_b32 v112, 16, v100
    v_and_b32 v113, 0xffff0000, v100
    v_lshlrev_b32 v114, 16, v101
    v_and_b32 v115, 0xffff0000, v101
    v_lshlrev_b32 v116, 16, v102
    v_and_b32 v117, 0xffff0000, v102
    v_lshlrev_b32 v118, 16, v103
    v_and_b32 v119, 0xffff0000, v103
    v_pk_mul_f32 v[112:113], v[112:113], v[48:49] op_sel_hi:[1,0]
    v_pk_mul_f32 v[114:115], v[114:115], v[48:49] op_sel_hi:[1,0]
    v_pk_mul_f32 v[116:117], v[116:117], v[48:49] op_sel_hi:[1,0]
    v_pk_mul_f32 v[118:119], v[118:119], v[48:49] op_sel_hi:[1,0]
    v_cvt_pk_bf16_f32 v100, v112, v113
    v_cvt_pk_bf16_f32 v101, v114, v115
    v_cvt_pk_bf16_f32 v102, v116, v117
    v_cvt_pk_bf16_f32 v103, v118, v119
    v_lshlrev_b32 v112, 16, v100
    v_and_b32 v113, 0xffff0000, v100
    v_lshlrev_b32 v114, 16, v101
    v_and_b32 v115, 0xffff0000, v101
    v_lshlrev_b32 v116, 16, v102
    v_and_b32 v117, 0xffff0000, v102
    v_lshlrev_b32 v118, 16, v103
    v_and_b32 v119, 0xffff0000, v103
    v_pk_add_f32 v[112:113], v[112:113], v[40:41]
    v_pk_add_f32 v[114:115], v[114:115], v[42:43]
    v_pk_add_f32 v[116:117], v[116:117], v[44:45]
    v_pk_add_f32 v[118:119], v[118:119], v[46:47]
    v_cvt_pk_bf16_f32 v100, v112, v113
    v_cvt_pk_bf16_f32 v101, v114, v115
    v_cvt_pk_bf16_f32 v102, v116, v117
    v_cvt_pk_bf16_f32 v103, v118, v119
    v_mov_b32 v104, v100
    v_mov_b32 v105, v101
    v_mov_b32 v106, v102
    v_mov_b32 v107, v103
    v_mov_b32_dpp v100, v96 row_ror:8 row_mask:0xf bank_mask:0x3
    v_mov_b32_dpp v101, v97 row_ror:8 row_mask:0xf bank_mask:0x3
    v_mov_b32_dpp v102, v98 row_ror:8 row_mask:0xf bank_mask:0x3
    v_mov_b32_dpp v103, v99 row_ror:8 row_mask:0xf bank_mask:0x3
    v_mov_b32_dpp v96, v104 row_ror:8 row_mask:0xf bank_mask:0xc
    v_mov_b32_dpp v97, v105 row_ror:8 row_mask:0xf bank_mask:0xc
    v_mov_b32_dpp v98, v106 row_ror:8 row_mask:0xf bank_mask:0xc
    v_mov_b32_dpp v99, v107 row_ror:8 row_mask:0xf bank_mask:0xc
    buffer_store_dwordx4 v[96:99], v7, s[68:71], 0 offen sc1
    buffer_store_dwordx4 v[100:103], v7, s[68:71], s12 offen sc1
    s_endpgm
L_own:
    s_mov_b32 s13, 0
L_b_y:
    s_waitcnt vmcnt(0)
    v_msad_u8 v240, v224, s76, 0
    v_msad_u8 v240, v225, s77, v240
    v_msad_u8 v240, v226, s78, v240
    v_msad_u8 v240, v227, s79, v240
    v_msad_u8 v240, v228, s76, v240
    v_msad_u8 v240, v229, s77, v240
    v_msad_u8 v240, v230, s78, v240
    v_msad_u8 v240, v231, s79, v240
    v_msad_u8 v240, v232, s76, v240
    v_msad_u8 v240, v233, s77, v240
    v_msad_u8 v240, v234, s78, v240
    v_msad_u8 v240, v235, s79, v240
    v_msad_u8 v240, v236, s76, v240
    v_msad_u8 v240, v237, s77, v240
    v_msad_u8 v240, v238, s78, v240
    v_msad_u8 v240, v239, s79, v240
    v_cmp_ne_u32 vcc, 0, v240
    s_nop 1
    s_or_b32 s46, vcc_lo, vcc_hi
    s_cbranch_scc0 L_b_yok
    s_cmp_eq_u32 s45, 0
    s_cbranch_scc1 L_b_yok
    s_lshl_b32 s12, s89, 12
    s_add_u32 s12, s12, 458752
    buffer_load_dwordx4 v[224:227], v22, s[32:35], s12 offen offset:0 sc1
    buffer_load_dwordx4 v[228:231], v22, s[32:35], s12 offen offset:16 sc1
    buffer_load_dwordx4 v[232:235], v22, s[32:35], s12 offen offset:64 sc1
    buffer_load_dwordx4 v[236:239], v22, s[32:35], s12 offen offset:80 sc1
    s_add_u32 s13, s13, 1
    s_cmp_lt_u32 s13, 16384
    s_cbranch_scc1 L_b_y
    s_waitcnt vmcnt(0)
    s_mov_b32 s46, 0
L_b_yok:
    v_add_f32_dpp v224, v224, v224 row_ror:1 row_mask:0xf bank_mask:0xf
    v_add_f32_dpp v225, v225, v225 row_ror:1 row_mask:0xf bank_mask:0xf
    v_add_f32_dpp v226, v226, v226 row_ror:1 row_mask:0xf bank_mask:0xf
    v_add_f32_dpp v227, v227, v227 row_ror:1 row_mask:0xf bank_mask:0xf
    v_add_f32_dpp v228, v228, v228 row_ror:1 row_mask:0xf bank_mask:0xf
    v_add_f32_dpp v229, v229, v229 row_ror:1 row_mask:0xf bank_mask:0xf
    v_add_f32_dpp v230, v230, v230 row_ror:1 row_mask:0xf bank_mask:0xf
    v_add_f32_dpp v231, v231, v231 row_ror:1 row_mask:0xf bank_mask:0xf
    v_add_f32_dpp v232, v232, v232 row_ror:1 row_mask:0xf bank_mask:0xf
    v_add_f32_dpp v233, v233, v233 row_ror:1 row_mask:0xf bank_mask:0xf
    v_add_f32_dpp v234, v234, v234 row_ror:1 row_mask:0xf bank_mask:0xf
    v_add_f32_dpp v235, v235, v235 row_ror:1 row_mask:0xf bank_mask:0xf
    v_add_f32_dpp v236, v236, v236 row_ror:1 row_mask:0xf bank_mask:0xf
    v_add_f32_dpp v237, v237, v237 row_ror:1 row_mask:0xf bank_mask:0xf
    v_add_f32_dpp v238, v238, v238 row_ror:1 row_mask:0xf bank_mask:0xf
    v_add_f32_dpp v239, v239, v239 row_ror:1 row_mask:0xf bank_mask:0xf
    v_add_f32_dpp v224, v224, v224 row_ror:2 row_mask:0xf bank_mask:0xf
    v_add_f32_dpp v225, v225, v225 row_ror:2 row_mask:0xf bank_mask:0xf
    v_add_f32_dpp v226, v226, v226 row_ror:2 row_mask:0xf bank_mask:0xf
    v_add_f32_dpp v227, v227, v227 row_ror:2 row_mask:0xf bank_mask:0xf
    v_add_f32_dpp v228, v228, v228 row_ror:2 row_mask:0xf bank_mask:0xf
    v_add_f32_dpp v229, v229, v229 row_ror:2 row_mask:0xf bank_mask:0xf
    v_add_f32_dpp v230, v230, v230 row_ror:2 row_mask:0xf bank_mask:0xf
    v_add_f32_dpp v231, v231, v231 row_ror:2 row_mask:0xf bank_mask:0xf
    v_add_f32_dpp v232, v232, v232 row_ror:2 row_mask:0xf bank_mask:0xf
    v_add_f32_dpp v233, v233, v233 row_ror:2 row_mask:0xf bank_mask:0xf
    v_add_f32_dpp v234, v234, v234 row_ror:2 row_mask:0xf bank_mask:0xf
    v_add_f32_dpp v235, v235, v235 row_ror:2 row_mask:0xf bank_mask:0xf
    v_add_f32_dpp v236, v236, v236 row_ror:2 row_mask:0xf bank_mask:0xf
    v_add_f32_dpp v237, v237, v237 row_ror:2 row_mask:0xf bank_mask:0xf
    v_add_f32_dpp v238, v238, v238 row_ror:2 row_mask:0xf bank_mask:0xf
    v_add_f32_dpp v239, v239, v239 row_ror:2 row_mask:0xf bank_mask:0xf
    v_add_f32_dpp v224, v224, v224 row_ror:4 row_mask:0xf bank_mask:0xf
    v_add_f32_dpp v225, v225, v225 row_ror:4 row_mask:0xf bank_mask:0xf
    v_add_f32_dpp v226, v226, v226 row_ror:4 row_mask:0xf bank_mask:0xf
    v_add_f32_dpp v227, v227, v227 row_ror:4 row_mask:0xf bank_mask:0xf
    v_add_f32_dpp v228, v228, v228 row_ror:4 row_mask:0xf bank_mask:0xf
    v_add_f32_dpp v229, v229, v229 row_ror:4 row_mask:0xf bank_mask:0xf
    v_add_f32_dpp v230, v230, v230 row_ror:4 row_mask:0xf bank_mask:0xf
    v_add_f32_dpp v231, v231, v231 row_ror:4 row_mask:0xf bank_mask:0xf
    v_add_f32_dpp v232, v232, v232 row_ror:4 row_mask:0xf bank_mask:0xf
    v_add_f32_dpp v233, v233, v233 row_ror:4 row_mask:0xf bank_mask:0xf
    v_add_f32_dpp v234, v234, v234 row_ror:4 row_mask:0xf bank_mask:0xf
    v_add_f32_dpp v235, v235, v235 row_ror:4 row_mask:0xf bank_mask:0xf
    v_add_f32_dpp v236, v236, v236 row_ror:4 row_mask:0xf bank_mask:0xf
    v_add_f32_dpp v237, v237, v237 row_ror:4 row_mask:0xf bank_mask:0xf
    v_add_f32_dpp v238, v238, v238 row_ror:4 row_mask:0xf bank_mask:0xf
    v_add_f32_dpp v239, v239, v239 row_ror:4 row_mask:0xf bank_mask:0xf
    v_add_f32_dpp v224, v224, v224 row_ror:8 row_mask:0xf bank_mask:0xf
    v_add_f32_dpp v225, v225, v225 row_ror:8 row_mask:0xf bank_mask:0xf
    v_add_f32_dpp v226, v226, v226 row_ror:8 row_mask:0xf bank_mask:0xf
    v_add_f32_dpp v227, v227, v227 row_ror:8 row_mask:0xf bank_mask:0xf
    v_add_f32_dpp v228, v228, v228 row_ror:8 row_mask:0xf bank_mask:0xf
    v_add_f32_dpp v229, v229, v229 row_ror:8 row_mask:0xf bank_mask:0xf
    v_add_f32_dpp v230, v230, v230 row_ror:8 row_mask:0xf bank_mask:0xf
    v_add_f32_dpp v231, v231, v231 row_ror:8 row_mask:0xf bank_mask:0xf
    v_add_f32_dpp v232, v232, v232 row_ror:8 row_mask:0xf bank_mask:0xf
    v_add_f32_dpp v233, v233, v233 row_ror:8 row_mask:0xf bank_mask:0xf
    v_add_f32_dpp v234, v234, v234 row_ror:8 row_mask:0xf bank_mask:0xf
    v_add_f32_dpp v235, v235, v235 row_ror:8 row_mask:0xf bank_mask:0xf
    v_add_f32_dpp v236, v236, v236 row_ror:8 row_mask:0xf bank_mask:0xf
    v_add_f32_dpp v237, v237, v237 row_ror:8 row_mask:0xf bank_mask:0xf
    v_add_f32_dpp v238, v238, v238 row_ror:8 row_mask:0xf bank_mask:0xf
    v_add_f32_dpp v239, v239, v239 row_ror:8 row_mask:0xf bank_mask:0xf
    v_cvt_pk_bf16_f32 v240, v224, v225
    v_cvt_pk_bf16_f32 v241, v226, v227
    v_cvt_pk_bf16_f32 v242, v228, v229
    v_cvt_pk_bf16_f32 v243, v230, v231
    v_cvt_pk_bf16_f32 v244, v232, v233
    v_cvt_pk_bf16_f32 v245, v234, v235
    v_cvt_pk_bf16_f32 v246, v236, v237
    v_cvt_pk_bf16_f32 v247, v238, v239
    v_lshlrev_b32 v224, 16, v240
    v_and_b32 v225, 0xffff0000, v240
    v_lshlrev_b32 v226, 16, v241
    v_and_b32 v227, 0xffff0000, v241
    v_lshlrev_b32 v228, 16, v242
    v_and_b32 v229, 0xffff0000, v242
    v_lshlrev_b32 v230, 16, v243
    v_and_b32 v231, 0xffff0000, v243
    v_lshlrev_b32 v232, 16, v244
    v_and_b32 v233, 0xffff0000, v244
    v_lshlrev_b32 v234, 16, v245
    v_and_b32 v235, 0xffff0000, v245
    v_lshlrev_b32 v236, 16, v246
    v_and_b32 v237, 0xffff0000, v246
    v_lshlrev_b32 v238, 16, v247
    v_and_b32 v239, 0xffff0000, v247
    v_pk_mul_f32 v[224:225], v[224:225], s[22:23] op_sel_hi:[1,0]
    v_pk_mul_f32 v[226:227], v[226:227], s[22:23] op_sel_hi:[1,0]
    v_pk_mul_f32 v[228:229], v[228:229], s[22:23] op_sel_hi:[1,0]
    v_pk_mul_f32 v[230:231], v[230:231], s[22:23] op_sel_hi:[1,0]
    v_pk_mul_f32 v[232:233], v[232:233], s[22:23] op_sel_hi:[1,0]
    v_pk_mul_f32 v[234:235], v[234:235], s[22:23] op_sel_hi:[1,0]
    v_pk_mul_f32 v[236:237], v[236:237], s[22:23] op_sel_hi:[1,0]
    v_pk_mul_f32 v[238:239], v[238:239], s[22:23] op_sel_hi:[1,0]
    v_cvt_pk_bf16_f32 v240, v224, v225
    v_cvt_pk_bf16_f32 v241, v226, v227
    v_cvt_pk_bf16_f32 v242, v228, v229
    v_cvt_pk_bf16_f32 v243, v230, v231
    v_cvt_pk_bf16_f32 v244, v232, v233
    v_cvt_pk_bf16_f32 v245, v234, v235
    v_cvt_pk_bf16_f32 v246, v236, v237
    v_cvt_pk_bf16_f32 v247, v238, v239
    v_lshlrev_b32 v224, 16, v240
    v_and_b32 v225, 0xffff0000, v240
    v_lshlrev_b32 v226, 16, v241
    v_and_b32 v227, 0xffff0000, v241
    v_lshlrev_b32 v228, 16, v242
    v_and_b32 v229, 0xffff0000, v242
    v_lshlrev_b32 v230, 16, v243
    v_and_b32 v231, 0xffff0000, v243
    v_lshlrev_b32 v232, 16, v244
    v_and_b32 v233, 0xffff0000, v244
    v_lshlrev_b32 v234, 16, v245
    v_and_b32 v235, 0xffff0000, v245
    v_lshlrev_b32 v236, 16, v246
    v_and_b32 v237, 0xffff0000, v246
    v_lshlrev_b32 v238, 16, v247
    v_and_b32 v239, 0xffff0000, v247
    v_lshlrev_b32 v32, 16, v24
    v_and_b32 v33, 0xffff0000, v24
    v_lshlrev_b32 v34, 16, v25
    v_and_b32 v35, 0xffff0000, v25
    v_lshlrev_b32 v36, 16, v26
    v_and_b32 v37, 0xffff0000, v26
    v_lshlrev_b32 v38, 16, v27
    v_and_b32 v39, 0xffff0000, v27
    v_lshlrev_b32 v40, 16, v28
    v_and_b32 v41, 0xffff0000, v28
    v_lshlrev_b32 v42, 16, v29
    v_and_b32 v43, 0xffff0000, v29
    v_lshlrev_b32 v44, 16, v30
    v_and_b32 v45, 0xffff0000, v30
    v_lshlrev_b32 v46, 16, v31
    v_and_b32 v47, 0xffff0000, v31
    v_pk_add_f32 v[224:225], v[224:225], v[32:33]
    v_pk_add_f32 v[226:227], v[226:227], v[34:35]
    v_pk_add_f32 v[228:229], v[228:229], v[36:37]
    v_pk_add_f32 v[230:231], v[230:231], v[38:39]
    v_pk_add_f32 v[232:233], v[232:233], v[40:41]
    v_pk_add_f32 v[234:235], v[234:235], v[42:43]
    v_pk_add_f32 v[236:237], v[236:237], v[44:45]
    v_pk_add_f32 v[238:239], v[238:239], v[46:47]
    v_cvt_pk_bf16_f32 v240, v224, v225
    v_cvt_pk_bf16_f32 v241, v226, v227
    v_cvt_pk_bf16_f32 v242, v228, v229
    v_cvt_pk_bf16_f32 v243, v230, v231
    v_cvt_pk_bf16_f32 v244, v232, v233
    v_cvt_pk_bf16_f32 v245, v234, v235
    v_cvt_pk_bf16_f32 v246, v236, v237
    v_cvt_pk_bf16_f32 v247, v238, v239
    s_cmp_eq_u32 s46, 0
    s_cselect_b32 s12, s21, -1
    v_cmp_eq_u32 vcc, s12, v6
    s_nop 1
    v_cndmask_b32 v24, v24, v240, vcc
    v_cndmask_b32 v25, v25, v241, vcc
    v_cndmask_b32 v26, v26, v242, vcc
    v_cndmask_b32 v27, v27, v243, vcc
    v_cndmask_b32 v28, v28, v244, vcc
    v_cndmask_b32 v29, v29, v245, vcc
    v_cndmask_b32 v30, v30, v246, vcc
    v_cndmask_b32 v31, v31, v247, vcc
    v_lshlrev_b32 v32, 16, v24
    v_and_b32 v33, 0xffff0000, v24
    v_lshlrev_b32 v34, 16, v25
    v_and_b32 v35, 0xffff0000, v25
    v_lshlrev_b32 v36, 16, v26
    v_and_b32 v37, 0xffff0000, v26
    v_lshlrev_b32 v38, 16, v27
    v_and_b32 v39, 0xffff0000, v27
    v_lshlrev_b32 v40, 16, v28
    v_and_b32 v41, 0xffff0000, v28
    v_lshlrev_b32 v42, 16, v29
    v_and_b32 v43, 0xffff0000, v29
    v_lshlrev_b32 v44, 16, v30
    v_and_b32 v45, 0xffff0000, v30
    v_lshlrev_b32 v46, 16, v31
    v_and_b32 v47, 0xffff0000, v31
    v_pk_mul_f32 v[32:33], v[32:33], v[50:51] op_sel_hi:[1,0]
    v_pk_mul_f32 v[34:35], v[34:35], v[50:51] op_sel_hi:[1,0]
    v_pk_mul_f32 v[36:37], v[36:37], v[50:51] op_sel_hi:[1,0]
    v_pk_mul_f32 v[38:39], v[38:39], v[50:51] op_sel_hi:[1,0]
    v_pk_mul_f32 v[40:41], v[40:41], v[50:51] op_sel_hi:[1,0]
    v_pk_mul_f32 v[42:43], v[42:43], v[50:51] op_sel_hi:[1,0]
    v_pk_mul_f32 v[44:45], v[44:45], v[50:51] op_sel_hi:[1,0]
    v_pk_mul_f32 v[46:47], v[46:47], v[50:51] op_sel_hi:[1,0]
    v_cvt_pk_bf16_f32 v33, v32, v33
    v_cvt_pk_bf16_f32 v35, v34, v35
    v_cvt_pk_bf16_f32 v37, v36, v37
    v_cvt_pk_bf16_f32 v39, v38, v39
    v_cvt_pk_bf16_f32 v41, v40, v41
    v_cvt_pk_bf16_f32 v43, v42, v43
    v_cvt_pk_bf16_f32 v45, v44, v45
    v_cvt_pk_bf16_f32 v47, v46, v47
    v_lshlrev_b32 v32, 16, v33
    v_and_b32 v33, 0xffff0000, v33
    v_lshlrev_b32 v34, 16, v35
    v_and_b32 v35, 0xffff0000, v35
    v_lshlrev_b32 v36, 16, v37
    v_and_b32 v37, 0xffff0000, v37
    v_lshlrev_b32 v38, 16, v39
    v_and_b32 v39, 0xffff0000, v39
    v_lshlrev_b32 v40, 16, v41
    v_and_b32 v41, 0xffff0000, v41
    v_lshlrev_b32 v42, 16, v43
    v_and_b32 v43, 0xffff0000, v43
    v_lshlrev_b32 v44, 16, v45
    v_and_b32 v45, 0xffff0000, v45
    v_lshlrev_b32 v46, 16, v47
    v_and_b32 v47, 0xffff0000, v47
    s_cmp_eq_u32 s45, 0
    s_cbranch_scc1 L_own_r0
    s_branch L_own_r1
L_end:
    s_endpgm
.section .rodata,"a"
.p2align 6
.amdhsa_kernel gated_mix__linear_kernel_hedgehog__moe_arch_mod__prompt_kernel
  .amdhsa_next_free_vgpr 256
  .amdhsa_next_free_sgpr 102
  .amdhsa_accum_offset 256
  .amdhsa_group_segment_fixed_size 0
  .amdhsa_kernarg_size 104
  .amdhsa_user_sgpr_count 2
  .amdhsa_user_sgpr_kernarg_segment_ptr 1
  .amdhsa_system_sgpr_workgroup_id_x 1
.end_amdhsa_kernel
```

```asm
; @launch grid=(256,1,1) block=(512,1,1) lds=163840
.amdgcn_target "amdgcn-amd-amdhsa--gfx950"
.text
.globl gated_mix__linear_kernel_hedgehog__moe_arch_mod__prompt_kernel
.p2align 8
.type gated_mix__linear_kernel_hedgehog__moe_arch_mod__prompt_kernel,@function
gated_mix__linear_kernel_hedgehog__moe_arch_mod__prompt_kernel:
    s_cmp_ge_u32 s2, 256
    s_cbranch_scc1 L_end
    s_load_dwordx4 s[4:7], s[0:1], 0
    s_load_dwordx4 s[8:11], s[0:1], 16
    s_load_dwordx16 s[48:63], s[0:1], 40
    v_lshrrev_b32 v1, 6, v0
    v_and_b32 v2, 63, v0
    v_readfirstlane_b32 s20, v1
    s_and_b32 s16, s2, 7
    s_lshr_b32 s17, s2, 3
    s_and_b32 s18, s16, 1
    s_lshl_b32 s18, s18, 3
    s_and_b32 s19, s17, 7
    s_add_u32 s18, s18, s19
    s_lshr_b32 s19, s16, 1
    s_lshl_b32 s19, s19, 2
    s_lshr_b32 s12, s17, 3
    s_add_u32 s19, s19, s12
    v_lshlrev_b32 v5, 4, v2
    s_cmp_lt_u32 s20, 4
    s_cbranch_scc1 L_compute
    s_sub_u32 s21, s20, 4
    s_mov_b32 s68, 0x76543210
    s_mov_b32 s69, 0xfedcba98
    s_lshl_b32 s12, s16, 1
    s_mul_i32 s12, s12, 0x11111111
    s_xor_b32 s68, s68, s12
    s_xor_b32 s69, s69, s12
    v_lshrrev_b32 v4, 3, v2
    v_lshlrev_b32 v9, 11, v4
    v_and_b32 v6, 7, v2
    v_lshrrev_b32 v7, 4, v2
    v_xor_b32 v8, v6, v7
    v_lshl_add_u32 v10, v8, 4, v9
    v_xor_b32 v8, 4, v8
    v_lshl_add_u32 v11, v8, 4, v9
    v_mul_u32_u24 v12, 6144, v4
    v_and_b32 v7, 1, v7
    v_lshlrev_b32 v7, 2, v7
    v_xor_b32 v8, v6, v7
    v_lshl_add_u32 v12, v8, 4, v12
    s_lshl_b32 s12, s18, 18
    s_lshl_b32 s13, s21, 16
    s_add_u32 s12, s12, s13
    s_add_u32 s13, s12, 0
    v_add_u32 v20, s13, v10
    s_add_u32 s13, s12, 15360
    v_add_u32 v21, s13, v11
    s_add_u32 s13, s12, 30720
    v_add_u32 v22, s13, v10
    s_add_u32 s13, s12, 46080
    v_add_u32 v23, s13, v11
    s_lshl_b32 s12, s19, 7
    s_mul_i32 s14, s21, 6
    s_add_u32 s13, s14, 0
    s_and_b32 s15, s13, 7
    s_mul_i32 s15, s15, 49152
    s_lshr_b32 s13, s13, 3
    s_lshl_b32 s13, s13, 11
    s_add_u32 s13, s13, s15
    s_add_u32 s13, s13, s12
    s_sub_u32 s13, s13, 0
    v_add_u32 v24, s13, v12
    s_add_u32 s13, s14, 1
    s_and_b32 s15, s13, 7
    s_mul_i32 s15, s15, 49152
    s_lshr_b32 s13, s13, 3
    s_lshl_b32 s13, s13, 11
    s_add_u32 s13, s13, s15
    s_add_u32 s13, s13, s12
    s_sub_u32 s13, s13, 1024
    v_add_u32 v25, s13, v12
    s_add_u32 s13, s14, 2
    s_and_b32 s15, s13, 7
    s_mul_i32 s15, s15, 49152
    s_lshr_b32 s13, s13, 3
    s_lshl_b32 s13, s13, 11
    s_add_u32 s13, s13, s15
    s_add_u32 s13, s13, s12
    s_sub_u32 s13, s13, 2048
    v_add_u32 v26, s13, v12
    s_add_u32 s13, s14, 3
    s_and_b32 s15, s13, 7
    s_mul_i32 s15, s15, 49152
    s_lshr_b32 s13, s13, 3
    s_lshl_b32 s13, s13, 11
    s_add_u32 s13, s13, s15
    s_add_u32 s13, s13, s12
    s_sub_u32 s13, s13, 0
    v_add_u32 v27, s13, v12
    s_add_u32 s13, s14, 4
    s_and_b32 s15, s13, 7
    s_mul_i32 s15, s15, 49152
    s_lshr_b32 s13, s13, 3
    s_lshl_b32 s13, s13, 11
    s_add_u32 s13, s13, s15
    s_add_u32 s13, s13, s12
    s_sub_u32 s13, s13, 1024
    v_add_u32 v28, s13, v12
    s_add_u32 s13, s14, 5
    s_and_b32 s15, s13, 7
    s_mul_i32 s15, s15, 49152
    s_lshr_b32 s13, s13, 3
    s_lshl_b32 s13, s13, 11
    s_add_u32 s13, s13, s15
    s_add_u32 s13, s13, s12
    s_sub_u32 s13, s13, 2048
    v_add_u32 v29, s13, v12
    s_lshl_b32 s94, s21, 12
    s_mul_i32 s95, s21, 6144
    s_add_u32 s95, s95, 16384
    s_waitcnt lgkmcnt(0)
    s_mov_b32 s24, s4
    s_and_b32 s25, s5, 0xffff
    s_mov_b32 s26, 4194304
    s_mov_b32 s27, 0x00020000
    s_mov_b32 s28, s6
    s_and_b32 s29, s7, 0xffff
    s_mov_b32 s30, 6291456
    s_mov_b32 s31, 0x00020000
    s_bfe_u32 s91, s68, 0x40000
    s_lshl_b32 s92, s91, 7
    s_mul_i32 s93, s91, 393216
    s_add_u32 m0, s94, 0
    s_nop 0
    buffer_load_dwordx4 v20, s[24:27], s92 offen offset:0 lds
    buffer_load_dwordx4 v21, s[24:27], s92 offen offset:1024 lds
    buffer_load_dwordx4 v22, s[24:27], s92 offen offset:2048 lds
    buffer_load_dwordx4 v23, s[24:27], s92 offen offset:3072 lds
    s_add_u32 m0, s95, 0
    s_nop 0
    buffer_load_dwordx4 v24, s[28:31], s93 offen offset:0 lds
    buffer_load_dwordx4 v25, s[28:31], s93 offen offset:1024 lds
    buffer_load_dwordx4 v26, s[28:31], s93 offen offset:2048 lds
    s_add_u32 m0, s95, 3072
    s_nop 0
    buffer_load_dwordx4 v27, s[28:31], s93 offen offset:0 lds
    buffer_load_dwordx4 v28, s[28:31], s93 offen offset:1024 lds
    buffer_load_dwordx4 v29, s[28:31], s93 offen offset:2048 lds
    s_bfe_u32 s91, s68, 0x40004
    s_lshl_b32 s92, s91, 7
    s_mul_i32 s93, s91, 393216
    s_add_u32 m0, s94, 40960
    s_nop 0
    buffer_load_dwordx4 v20, s[24:27], s92 offen offset:0 lds
    buffer_load_dwordx4 v21, s[24:27], s92 offen offset:1024 lds
    buffer_load_dwordx4 v22, s[24:27], s92 offen offset:2048 lds
    buffer_load_dwordx4 v23, s[24:27], s92 offen offset:3072 lds
    s_add_u32 m0, s95, 40960
    s_nop 0
    buffer_load_dwordx4 v24, s[28:31], s93 offen offset:0 lds
    buffer_load_dwordx4 v25, s[28:31], s93 offen offset:1024 lds
    s_mov_b32 s32, s62
    s_and_b32 s33, s63, 0xffff
    s_mov_b32 s34, 33554432
    s_mov_b32 s35, 0x00020000
    s_mov_b32 s36, s10
    s_and_b32 s37, s11, 0xffff
    s_mov_b32 s38, 2097152
    s_mov_b32 s39, 0x00020000
    s_mov_b32 s40, s50
    s_and_b32 s41, s51, 0xffff
    s_mov_b32 s42, 7340032
    s_mov_b32 s43, 0x00020000
    s_mov_b32 s44, s52
    s_and_b32 s45, s53, 0xffff
    s_mov_b32 s46, 7340032
    s_mov_b32 s47, 0x00020000
    s_mov_b32 s64, s54
    s_and_b32 s65, s55, 0xffff
    s_mov_b32 s66, 7340032
    s_mov_b32 s67, 0x00020000
    s_mov_b32 s72, s60
    s_and_b32 s73, s61, 0xffff
    s_mov_b32 s74, 256
    s_mov_b32 s75, 0x00020000
    s_mov_b32 s76, s8
    s_and_b32 s77, s9, 0xffff
    s_mov_b32 s78, 65536
    s_mov_b32 s79, 0x00020000
    s_mov_b32 s80, s48
    s_and_b32 s81, s49, 0xffff
    s_mov_b32 s82, 2048
    s_mov_b32 s83, 0x00020000
    s_mov_b32 s84, s56
    s_and_b32 s85, s57, 0xffff
    s_mov_b32 s86, 2048
    s_mov_b32 s87, 0x00020000
    s_cmp_gt_u32 s19, 3
    s_subb_u32 s10, s19, 0
    s_cmp_gt_u32 s19, 11
    s_subb_u32 s10, s10, 0
    s_lshl_b32 s10, s10, 4
    s_add_u32 s10, s10, s18
    s_and_b32 s12, s19, 7
    s_cmp_eq_u32 s12, 3
    s_cselect_b32 s10, 224, s10
    s_xor_b32 s11, s18, 2
    s_lshl_b32 s11, s11, 4
    s_add_u32 s11, s11, s19
    s_lshl_b32 s11, s19, 4
    s_add_u32 s11, s11, s18
    s_cmp_lt_u32 s10, 224
    s_cselect_b32 s42, s42, 0
    s_cselect_b32 s46, s46, 0
    s_and_b32 s88, s16, 1
    s_lshl_b32 s88, s88, 3
    s_lshr_b32 s89, s16, 1
    s_lshl_b32 s89, s89, 1
    s_add_u32 s88, s88, s89
    s_lshr_b32 s89, s17, 4
    s_add_u32 s88, s88, s89
    s_and_b32 s89, s17, 15
    v_mov_b32 v13, 0
    v_mul_u32_u24 v30, 57344, v4
    v_lshl_add_u32 v30, v6, 4, v30
    v_lshl_add_u32 v31, v6, 4, v9
    v_lshl_add_u32 v33, v8, 4, v9
    s_lshl_b32 s12, s89, 7
    v_add_u32 v33, s12, v33
    v_lshlrev_b32 v34, 4, v4
    s_and_b32 s12, s10, 3
    s_lshl_b32 s12, s12, 8
    s_lshl_b32 s13, s21, 6
    s_add_u32 s70, s12, s13
    s_mul_i32 s71, s70, 7168
    s_lshr_b32 s12, s10, 2
    s_lshl_b32 s12, s12, 7
    s_add_u32 s71, s71, s12
    s_and_b32 s12, s11, 15
    s_mul_i32 s12, s12, 224
    s_mul_i32 s13, s21, 56
    s_add_u32 s96, s12, s13
    s_lshl_b32 s97, s96, 11
    s_lshr_b32 s12, s11, 4
    s_lshl_b32 s12, s12, 7
    s_add_u32 s97, s97, s12
    s_lshl_b32 s22, s18, 7
    s_lshl_b32 s12, s19, 3
    s_add_u32 s22, s22, s12
    s_lshl_b32 s12, s21, 1
    s_add_u32 s22, s22, s12
    s_xor_b32 s9, s71, 512
    s_and_b32 s12, s18, 7
    s_lshl_b32 s12, s12, 2
    s_add_u32 s12, s12, s21
    s_mul_i32 s12, s12, 6
    v_add_u32 v32, s12, v2
    v_lshrrev_b32 v11, 6, v32
    v_and_b32 v32, 63, v32
    v_mul_u32_u24 v32, 6144, v32
    v_lshl_add_u32 v32, v11, 11, v32
    s_lshl_b32 s12, s19, 7
    v_add_u32 v32, s12, v32
    s_lshl_b32 s12, s2, 6
    s_lshl_b32 s13, s21, 4
    s_add_u32 s12, s12, s13
    v_add_u32 v10, s12, v2
    v_lshlrev_b32 v10, 7, v10
    s_lshl_b32 s12, s17, 6
    s_add_u32 s12, s12, s13
    s_sub_u32 s12, s12, 16
    v_add_u32 v11, s12, v2
    v_and_b32 v12, 1, v11
    v_lshrrev_b32 v11, 1, v11
    v_lshlrev_b32 v11, 11, v11
    v_lshl_add_u32 v11, v12, 10, v11
    v_add_u32 v11, 384, v11
    v_cmp_gt_u32 vcc, 16, v2
    s_nop 1
    v_cndmask_b32 v10, v11, v10, vcc
    s_mul_i32 s12, s2, 13108
    s_lshr_b32 s12, s12, 16
    s_mul_i32 s12, s12, 5
    s_sub_u32 s3, s2, s12
    s_cmp_ge_u32 s10, 224
    s_cselect_b32 s3, 0, s3
    s_waitcnt vmcnt(6)
    s_barrier
    s_cmp_eq_u32 s3, 1
    s_cbranch_scc1 L_var1
    s_cmp_eq_u32 s3, 2
    s_cbranch_scc1 L_var2
    s_cmp_eq_u32 s3, 3
    s_cbranch_scc1 L_var3
    s_cmp_eq_u32 s3, 4
    s_cbranch_scc1 L_var4
L_var0:
    s_nop 0
    s_add_u32 m0, s95, 40960
    s_nop 0
    buffer_load_dwordx4 v26, s[28:31], s93 offen offset:2048 lds
    s_add_u32 m0, s95, 44032
    s_nop 0
    buffer_load_dwordx4 v27, s[28:31], s93 offen offset:0 lds
    buffer_load_dwordx4 v28, s[28:31], s93 offen offset:1024 lds
    buffer_load_dwordx4 v29, s[28:31], s93 offen offset:2048 lds
    s_bfe_u32 s91, s68, 0x40008
    s_lshl_b32 s92, s91, 7
    s_mul_i32 s93, s91, 393216
    s_add_u32 m0, s94, 81920
    s_nop 0
    buffer_load_dwordx4 v20, s[24:27], s92 offen offset:0 lds
    buffer_load_dwordx4 v21, s[24:27], s92 offen offset:1024 lds
    buffer_load_dwordx4 v22, s[24:27], s92 offen offset:2048 lds
    buffer_load_dwordx4 v23, s[24:27], s92 offen offset:3072 lds
    s_add_u32 m0, s95, 81920
    s_nop 0
    buffer_load_dwordx4 v24, s[28:31], s93 offen offset:0 lds
    buffer_load_dwordx4 v25, s[28:31], s93 offen offset:1024 lds
    buffer_load_dwordx4 v26, s[28:31], s93 offen offset:2048 lds
    s_add_u32 m0, s95, 84992
    s_nop 0
    buffer_load_dwordx4 v27, s[28:31], s93 offen offset:0 lds
    buffer_load_dwordx4 v28, s[28:31], s93 offen offset:1024 lds
    buffer_load_dwordx4 v29, s[28:31], s93 offen offset:2048 lds
    s_lshl_b32 s12, s19, 2
    s_add_u32 s12, s12, s21
    s_lshl_b32 s12, s12, 10
    s_lshl_b32 s13, s21, 10
    s_add_u32 m0, s13, 155648
    s_nop 0
    buffer_load_dwordx4 v5, s[76:79], s12 offen lds
    s_lshl_b32 s12, s22, 11
    buffer_load_dwordx4 v[40:43], v5, s[24:27], s12 offen offset:0
    buffer_load_dwordx4 v[44:47], v5, s[24:27], s12 offen offset:1024
    buffer_load_dwordx4 v[48:51], v5, s[24:27], s12 offen offset:2048
    buffer_load_dwordx4 v[52:55], v5, s[24:27], s12 offen offset:3072
    buffer_load_dwordx4 v[56:59], v5, s[80:83], 0 offen offset:0
    buffer_load_dwordx4 v[60:63], v5, s[80:83], 0 offen offset:1024
    buffer_load_dwordx4 v[64:67], v5, s[84:87], 0 offen offset:0
    buffer_load_dwordx4 v[68:71], v5, s[84:87], 0 offen offset:1024
    s_cmp_ge_u32 s10, 224
    s_cbranch_scc1 L_p30_0
    s_add_u32 s12, s71, 0
    buffer_load_dwordx4 v[128:131], v30, s[40:43], s12 offen nt
    s_add_u32 s12, s71, 7168
    buffer_load_dwordx4 v[132:135], v30, s[40:43], s12 offen nt
    s_add_u32 s12, s71, 14336
    buffer_load_dwordx4 v[136:139], v30, s[40:43], s12 offen nt
    s_add_u32 s12, s71, 21504
    buffer_load_dwordx4 v[140:143], v30, s[40:43], s12 offen nt
    s_add_u32 s12, s71, 28672
    buffer_load_dwordx4 v[144:147], v30, s[40:43], s12 offen nt
    s_add_u32 s12, s71, 35840
    buffer_load_dwordx4 v[148:151], v30, s[40:43], s12 offen nt
    s_add_u32 s12, s71, 43008
    buffer_load_dwordx4 v[152:155], v30, s[40:43], s12 offen nt
    s_add_u32 s12, s71, 50176
    buffer_load_dwordx4 v[156:159], v30, s[40:43], s12 offen nt
    s_branch L_p3e0_0
L_p30_0:
    s_mov_b64 exec, 63
    s_bfe_u32 s12, s68, 0x4000c
    s_mul_i32 s12, s12, 393216
    buffer_load_dword v128, v32, s[28:31], s12 offen
    s_bfe_u32 s12, s68, 0x40010
    s_mul_i32 s12, s12, 393216
    buffer_load_dword v132, v32, s[28:31], s12 offen
    s_bfe_u32 s12, s68, 0x40014
    s_mul_i32 s12, s12, 393216
    buffer_load_dword v136, v32, s[28:31], s12 offen
    s_bfe_u32 s12, s68, 0x40018
    s_mul_i32 s12, s12, 393216
    buffer_load_dword v140, v32, s[28:31], s12 offen
    s_bfe_u32 s12, s68, 0x4001c
    s_mul_i32 s12, s12, 393216
    buffer_load_dword v144, v32, s[28:31], s12 offen
    s_bfe_u32 s12, s69, 0x40000
    s_mul_i32 s12, s12, 393216
    buffer_load_dword v148, v32, s[28:31], s12 offen
    s_bfe_u32 s12, s69, 0x40004
    s_mul_i32 s12, s12, 393216
    buffer_load_dword v152, v32, s[28:31], s12 offen
    s_bfe_u32 s12, s69, 0x40008
    s_mul_i32 s12, s12, 393216
    buffer_load_dword v156, v32, s[28:31], s12 offen
    s_mov_b64 exec, -1
L_p3e0_0:
    s_waitcnt vmcnt(27)
    s_barrier
    s_bfe_u32 s91, s68, 0x4000c
    s_lshl_b32 s92, s91, 7
    s_mul_i32 s93, s91, 393216
    s_add_u32 m0, s94, 0
    s_nop 0
    buffer_load_dwordx4 v20, s[24:27], s92 offen offset:0 lds
    s_waitcnt vmcnt(9)
    s_mov_b32 s8, 0xffff0000
    v_lshlrev_b32 v72, 16, v56
    v_and_b32 v56, s8, v56
    v_lshlrev_b32 v73, 16, v64
    v_and_b32 v64, s8, v64
    v_lshlrev_b32 v112, 16, v40
    buffer_load_dwordx4 v21, s[24:27], s92 offen offset:1024 lds
    v_and_b32 v40, s8, v40
    v_lshlrev_b32 v116, 16, v48
    v_and_b32 v48, s8, v48
    v_mul_f32 v113, v112, v73
    v_mul_f32 v114, v40, v64
    v_mul_f32 v90, v112, v72
    v_mul_f32 v117, v116, v73
    buffer_load_dwordx4 v22, s[24:27], s92 offen offset:2048 lds
    v_mul_f32 v118, v48, v64
    v_mul_f32 v92, v116, v72
    v_cvt_pk_bf16_f32 v113, 0, v113
    v_cvt_pk_bf16_f32 v114, 0, v114
    v_fmac_f32 v90, v40, v56
    v_cvt_pk_bf16_f32 v117, 0, v117
    v_cvt_pk_bf16_f32 v118, 0, v118
    buffer_load_dwordx4 v23, s[24:27], s92 offen offset:3072 lds
    v_fmac_f32 v92, v48, v56
    v_add_f32 v91, v113, v114
    v_add_f32 v93, v117, v118
    v_lshlrev_b32 v72, 16, v57
    v_and_b32 v57, s8, v57
    v_lshlrev_b32 v73, 16, v65
    v_and_b32 v65, s8, v65
    s_add_u32 m0, s95, 0
    s_nop 0
    buffer_load_dwordx4 v24, s[28:31], s93 offen offset:0 lds
    v_lshlrev_b32 v112, 16, v41
    v_and_b32 v41, s8, v41
    v_lshlrev_b32 v116, 16, v49
    v_and_b32 v49, s8, v49
    v_mul_f32 v113, v112, v73
    v_mul_f32 v114, v41, v65
    v_fmac_f32 v90, v112, v72
    s_cmp_lg_u32 s21, 0
    s_cbranch_scc1 L_noclr_0
    v_mov_b32 v104, -1
    v_mov_b32 v105, -1
    v_mov_b32 v106, -1
    v_mov_b32 v107, -1
    s_lshl_b32 s12, s19, 13
    s_lshl_b32 s13, s18, 9
    s_add_u32 s12, s12, s13
    s_add_u32 s12, s12, 32768
    s_lshl_b32 s13, s19, 11
    s_lshl_b32 s90, s18, 7
    s_add_u32 s13, s13, s90
    s_add_u32 s13, s13, 163840
    s_mov_b32 exec_hi, 0
    buffer_store_dwordx4 v[104:107], v5, s[32:35], s12 offen sc1
    s_mov_b32 exec_lo, 255
    buffer_store_dwordx4 v[104:107], v5, s[32:35], s13 offen sc1
    s_mov_b64 exec, -1
L_noclr_0:
    v_mul_f32 v117, v116, v73
    v_mul_f32 v118, v49, v65
    v_fmac_f32 v92, v116, v72
    v_cvt_pk_bf16_f32 v113, 0, v113
    v_cvt_pk_bf16_f32 v114, 0, v114
    v_fmac_f32 v90, v41, v57
    v_cvt_pk_bf16_f32 v117, 0, v117
    v_cvt_pk_bf16_f32 v118, 0, v118
    v_fmac_f32 v92, v49, v57
    v_add_f32 v91, v91, v113
    v_add_f32 v93, v93, v117
    v_add_f32 v91, v91, v114
    v_add_f32 v93, v93, v118
    v_lshlrev_b32 v72, 16, v58
    v_and_b32 v58, s8, v58
    v_lshlrev_b32 v73, 16, v66
    v_and_b32 v66, s8, v66
    v_lshlrev_b32 v112, 16, v42
    v_and_b32 v42, s8, v42
    v_lshlrev_b32 v116, 16, v50
    v_and_b32 v50, s8, v50
    v_mul_f32 v113, v112, v73
    v_mul_f32 v114, v42, v66
    v_fmac_f32 v90, v112, v72
    v_mul_f32 v117, v116, v73
    s_barrier
    s_add_u32 m0, s95, 0
    s_nop 0
    buffer_load_dwordx4 v25, s[28:31], s93 offen offset:1024 lds
    v_mul_f32 v118, v50, v66
    v_fmac_f32 v92, v116, v72
    v_cvt_pk_bf16_f32 v113, 0, v113
    v_cvt_pk_bf16_f32 v114, 0, v114
    v_fmac_f32 v90, v42, v58
    v_cvt_pk_bf16_f32 v117, 0, v117
    v_cvt_pk_bf16_f32 v118, 0, v118
    buffer_load_dwordx4 v26, s[28:31], s93 offen offset:2048 lds
    v_fmac_f32 v92, v50, v58
    v_add_f32 v91, v91, v113
    v_add_f32 v93, v93, v117
    v_add_f32 v91, v91, v114
    v_add_f32 v93, v93, v118
    v_lshlrev_b32 v72, 16, v59
    v_and_b32 v59, s8, v59
    s_add_u32 m0, s95, 3072
    s_nop 0
    buffer_load_dwordx4 v27, s[28:31], s93 offen offset:0 lds
    v_lshlrev_b32 v73, 16, v67
    v_and_b32 v67, s8, v67
    v_lshlrev_b32 v112, 16, v43
    v_and_b32 v43, s8, v43
    v_lshlrev_b32 v116, 16, v51
    v_and_b32 v51, s8, v51
    v_mul_f32 v113, v112, v73
    buffer_load_dwordx4 v28, s[28:31], s93 offen offset:1024 lds
    v_mul_f32 v114, v43, v67
    v_fmac_f32 v90, v112, v72
    v_mul_f32 v117, v116, v73
    v_mul_f32 v118, v51, v67
    v_fmac_f32 v92, v116, v72
    v_cvt_pk_bf16_f32 v113, 0, v113
    v_cvt_pk_bf16_f32 v114, 0, v114
    buffer_load_dwordx4 v29, s[28:31], s93 offen offset:2048 lds
    v_fmac_f32 v90, v43, v59
    v_cvt_pk_bf16_f32 v117, 0, v117
    v_cvt_pk_bf16_f32 v118, 0, v118
    v_fmac_f32 v92, v51, v59
    v_add_f32 v91, v91, v113
    v_add_f32 v93, v93, v117
    v_add_f32 v91, v91, v114
    s_bfe_u32 s91, s68, 0x40010
    s_lshl_b32 s92, s91, 7
    s_mul_i32 s93, s91, 393216
    s_add_u32 m0, s94, 40960
    s_nop 0
    buffer_load_dwordx4 v20, s[24:27], s92 offen offset:0 lds
    v_add_f32 v93, v93, v118
    v_lshlrev_b32 v72, 16, v60
    v_and_b32 v60, s8, v60
    v_lshlrev_b32 v73, 16, v68
    v_and_b32 v68, s8, v68
    v_lshlrev_b32 v112, 16, v44
    v_and_b32 v44, s8, v44
    buffer_load_dwordx4 v21, s[24:27], s92 offen offset:1024 lds
    v_lshlrev_b32 v116, 16, v52
    v_and_b32 v52, s8, v52
    v_mul_f32 v113, v112, v73
    v_mul_f32 v114, v44, v68
    v_fmac_f32 v90, v112, v72
    v_mul_f32 v117, v116, v73
    v_mul_f32 v118, v52, v68
    buffer_load_dwordx4 v22, s[24:27], s92 offen offset:2048 lds
    v_fmac_f32 v92, v116, v72
    v_cvt_pk_bf16_f32 v113, 0, v113
    v_cvt_pk_bf16_f32 v114, 0, v114
    v_fmac_f32 v90, v44, v60
    v_cvt_pk_bf16_f32 v117, 0, v117
    v_cvt_pk_bf16_f32 v118, 0, v118
    v_fmac_f32 v92, v52, v60
    buffer_load_dwordx4 v23, s[24:27], s92 offen offset:3072 lds
    v_add_f32 v91, v91, v113
    v_add_f32 v93, v93, v117
    v_add_f32 v91, v91, v114
    v_add_f32 v93, v93, v118
    v_lshlrev_b32 v72, 16, v61
    v_and_b32 v61, s8, v61
    v_lshlrev_b32 v73, 16, v69
    s_add_u32 m0, s95, 40960
    s_nop 0
    buffer_load_dwordx4 v24, s[28:31], s93 offen offset:0 lds
    v_and_b32 v69, s8, v69
    v_lshlrev_b32 v112, 16, v45
    v_and_b32 v45, s8, v45
    v_lshlrev_b32 v116, 16, v53
    v_and_b32 v53, s8, v53
    v_mul_f32 v113, v112, v73
    v_mul_f32 v114, v45, v69
    buffer_load_dwordx4 v25, s[28:31], s93 offen offset:1024 lds
    v_fmac_f32 v90, v112, v72
    v_mul_f32 v117, v116, v73
    v_mul_f32 v118, v53, v69
    v_fmac_f32 v92, v116, v72
    v_cvt_pk_bf16_f32 v113, 0, v113
    v_cvt_pk_bf16_f32 v114, 0, v114
    v_fmac_f32 v90, v45, v61
    buffer_load_dwordx4 v26, s[28:31], s93 offen offset:2048 lds
    v_cvt_pk_bf16_f32 v117, 0, v117
    v_cvt_pk_bf16_f32 v118, 0, v118
    v_fmac_f32 v92, v53, v61
    v_add_f32 v91, v91, v113
    v_add_f32 v93, v93, v117
    v_add_f32 v91, v91, v114
    v_add_f32 v93, v93, v118
    buffer_load_dword v15, v13, s[72:75], 0 offen offset:4 sc1
    v_lshlrev_b32 v72, 16, v62
    v_and_b32 v62, s8, v62
    v_lshlrev_b32 v73, 16, v70
    v_and_b32 v70, s8, v70
    v_lshlrev_b32 v112, 16, v46
    v_and_b32 v46, s8, v46
    v_lshlrev_b32 v116, 16, v54
    v_and_b32 v54, s8, v54
    v_mul_f32 v113, v112, v73
    v_mul_f32 v114, v46, v70
    v_fmac_f32 v90, v112, v72
    v_mul_f32 v117, v116, v73
    v_mul_f32 v118, v54, v70
    v_fmac_f32 v92, v116, v72
    v_cvt_pk_bf16_f32 v113, 0, v113
    v_cvt_pk_bf16_f32 v114, 0, v114
    v_fmac_f32 v90, v46, v62
    v_cvt_pk_bf16_f32 v117, 0, v117
    v_cvt_pk_bf16_f32 v118, 0, v118
    v_fmac_f32 v92, v54, v62
    v_add_f32 v91, v91, v113
    v_add_f32 v93, v93, v117
    v_add_f32 v91, v91, v114
    v_add_f32 v93, v93, v118
    v_lshlrev_b32 v72, 16, v63
    s_waitcnt vmcnt(8)
    s_barrier
    s_add_u32 m0, s95, 44032
    s_nop 0
    buffer_load_dwordx4 v27, s[28:31], s93 offen offset:0 lds
    v_and_b32 v63, s8, v63
    v_lshlrev_b32 v73, 16, v71
    v_and_b32 v71, s8, v71
    v_lshlrev_b32 v112, 16, v47
    v_and_b32 v47, s8, v47
    v_lshlrev_b32 v116, 16, v55
    v_and_b32 v55, s8, v55
    buffer_load_dwordx4 v28, s[28:31], s93 offen offset:1024 lds
    v_mul_f32 v113, v112, v73
    v_mul_f32 v114, v47, v71
    v_fmac_f32 v90, v112, v72
    v_mul_f32 v117, v116, v73
    v_mul_f32 v118, v55, v71
    v_fmac_f32 v92, v116, v72
    v_cvt_pk_bf16_f32 v113, 0, v113
    buffer_load_dwordx4 v29, s[28:31], s93 offen offset:2048 lds
    v_cvt_pk_bf16_f32 v114, 0, v114
    v_fmac_f32 v90, v47, v63
    v_cvt_pk_bf16_f32 v117, 0, v117
    v_cvt_pk_bf16_f32 v118, 0, v118
    v_fmac_f32 v92, v55, v63
    v_add_f32 v91, v91, v113
    v_add_f32 v93, v93, v117
    s_bfe_u32 s91, s68, 0x40014
    s_lshl_b32 s92, s91, 7
    s_mul_i32 s93, s91, 393216
    s_add_u32 m0, s94, 81920
    s_nop 0
    buffer_load_dwordx4 v20, s[24:27], s92 offen offset:0 lds
    v_add_f32 v91, v91, v114
    v_add_f32 v93, v93, v118
    v_add_f32_dpp v90, v90, v90 row_shr:1 row_mask:0xf bank_mask:0xf
    v_add_f32_dpp v91, v91, v91 row_shr:1 row_mask:0xf bank_mask:0xf
    v_add_f32_dpp v92, v92, v92 row_shr:1 row_mask:0xf bank_mask:0xf
    v_add_f32_dpp v93, v93, v93 row_shr:1 row_mask:0xf bank_mask:0xf
    v_add_f32_dpp v90, v90, v90 row_shr:2 row_mask:0xf bank_mask:0xf
    buffer_load_dwordx4 v21, s[24:27], s92 offen offset:1024 lds
    v_add_f32_dpp v91, v91, v91 row_shr:2 row_mask:0xf bank_mask:0xf
    v_add_f32_dpp v92, v92, v92 row_shr:2 row_mask:0xf bank_mask:0xf
    v_add_f32_dpp v93, v93, v93 row_shr:2 row_mask:0xf bank_mask:0xf
    v_add_f32_dpp v90, v90, v90 row_shr:4 row_mask:0xf bank_mask:0xf
    v_add_f32_dpp v91, v91, v91 row_shr:4 row_mask:0xf bank_mask:0xf
    v_add_f32_dpp v92, v92, v92 row_shr:4 row_mask:0xf bank_mask:0xf
    v_add_f32_dpp v93, v93, v93 row_shr:4 row_mask:0xf bank_mask:0xf
    buffer_load_dwordx4 v22, s[24:27], s92 offen offset:2048 lds
    v_add_f32_dpp v90, v90, v90 row_shr:8 row_mask:0xf bank_mask:0xf
    v_add_f32_dpp v91, v91, v91 row_shr:8 row_mask:0xf bank_mask:0xf
    v_add_f32_dpp v92, v92, v92 row_shr:8 row_mask:0xf bank_mask:0xf
    v_add_f32_dpp v93, v93, v93 row_shr:8 row_mask:0xf bank_mask:0xf
    v_add_f32_dpp v90, v90, v90 row_bcast:15 row_mask:0xa bank_mask:0xf
    v_add_f32_dpp v91, v91, v91 row_bcast:15 row_mask:0xa bank_mask:0xf
    v_add_f32_dpp v92, v92, v92 row_bcast:15 row_mask:0xa bank_mask:0xf
    buffer_load_dwordx4 v23, s[24:27], s92 offen offset:3072 lds
    v_add_f32_dpp v93, v93, v93 row_bcast:15 row_mask:0xa bank_mask:0xf
    v_add_f32_dpp v90, v90, v90 row_bcast:31 row_mask:0xc bank_mask:0xf
    v_add_f32_dpp v91, v91, v91 row_bcast:31 row_mask:0xc bank_mask:0xf
    v_add_f32_dpp v92, v92, v92 row_bcast:31 row_mask:0xc bank_mask:0xf
    v_add_f32_dpp v93, v93, v93 row_bcast:31 row_mask:0xc bank_mask:0xf
    v_mov_b32 v97, 0x8000
    v_mov_b32 v98, 0xffff
    s_add_u32 m0, s95, 81920
    s_nop 0
    buffer_load_dwordx4 v24, s[28:31], s93 offen offset:0 lds
    v_cvt_pk_bf16_f32 v94, v90, v91
    v_cvt_pk_bf16_f32 v104, v92, v93
    v_and_b32 v95, 0xffff, v94
    v_and_b32 v96, 0x8000, v94
    v_and_b32 v94, 0xffff0000, v94
    v_cmp_ne_u32 vcc, 0, v96
    v_mul_f32 v94, 0xbfb8aa3b, v94
    buffer_load_dwordx4 v25, s[28:31], s93 offen offset:1024 lds
    v_exp_f32 v94, v94
    v_cndmask_b32 v96, v97, v98, vcc
    v_xor_b32 v95, v95, v96
    v_add_f32 v94, 1.0, v94
    v_lshlrev_b32 v95, 11, v95
    v_rcp_f32 v94, v94
    s_sub_u32 s12, 2047, s22
    v_or_b32 v100, s12, v95
    buffer_load_dwordx4 v26, s[28:31], s93 offen offset:2048 lds
    v_cvt_pk_bf16_f32 v94, v94, v94
    v_lshlrev_b32 v102, 16, v94
    v_and_b32 v105, 0xffff, v104
    v_and_b32 v106, 0x8000, v104
    v_and_b32 v104, 0xffff0000, v104
    v_cmp_ne_u32 vcc, 0, v106
    v_mul_f32 v104, 0xbfb8aa3b, v104
    s_add_u32 m0, s95, 84992
    s_nop 0
    buffer_load_dwordx4 v27, s[28:31], s93 offen offset:0 lds
    v_exp_f32 v104, v104
    v_cndmask_b32 v106, v97, v98, vcc
    v_xor_b32 v105, v105, v106
    v_add_f32 v104, 1.0, v104
    v_lshlrev_b32 v105, 11, v105
    v_rcp_f32 v104, v104
    s_sub_u32 s12, 2046, s22
    v_or_b32 v101, s12, v105
    buffer_load_dwordx4 v28, s[28:31], s93 offen offset:1024 lds
    v_cvt_pk_bf16_f32 v104, v104, v104
    v_lshlrev_b32 v103, 16, v104
    v_max_u32 v100, v100, v101
    s_lshl_b32 s12, s22, 2
    s_add_u32 s12, s12, 4096
    s_lshl_b32 s13, s21, 2
    s_add_u32 s13, s13, 162880
    v_mov_b32 v14, s13
    s_mov_b32 exec_lo, 0
    s_mov_b32 exec_hi, 0x80000000
    buffer_store_dwordx2 v[102:103], v13, s[32:35], s12 offen sc1
    ds_write_b32 v14, v100
    s_mov_b64 exec, -1
    s_waitcnt lgkmcnt(0)
    s_waitcnt vmcnt(10)
    s_barrier
    s_add_u32 m0, s95, 84992
    s_nop 0
    buffer_load_dwordx4 v29, s[28:31], s93 offen offset:2048 lds
    s_bfe_u32 s91, s68, 0x40018
    s_lshl_b32 s92, s91, 7
    s_mul_i32 s93, s91, 393216
    s_add_u32 m0, s94, 0
    s_nop 0
    buffer_load_dwordx4 v20, s[24:27], s92 offen offset:0 lds
    buffer_load_dwordx4 v21, s[24:27], s92 offen offset:1024 lds
    buffer_load_dwordx4 v22, s[24:27], s92 offen offset:2048 lds
    buffer_load_dwordx4 v23, s[24:27], s92 offen offset:3072 lds
    s_add_u32 m0, s95, 0
    s_nop 0
    buffer_load_dwordx4 v24, s[28:31], s93 offen offset:0 lds
    buffer_load_dwordx4 v25, s[28:31], s93 offen offset:1024 lds
    buffer_load_dwordx4 v26, s[28:31], s93 offen offset:2048 lds
    s_add_u32 m0, s95, 3072
    s_nop 0
    buffer_load_dwordx4 v27, s[28:31], s93 offen offset:0 lds
    buffer_load_dwordx4 v28, s[28:31], s93 offen offset:1024 lds
    buffer_load_dwordx4 v29, s[28:31], s93 offen offset:2048 lds
    s_waitcnt vmcnt(11)
    s_waitcnt vmcnt(10)
    s_barrier
    s_bfe_u32 s91, s68, 0x4001c
    s_lshl_b32 s92, s91, 7
    s_mul_i32 s93, s91, 393216
    s_add_u32 m0, s94, 40960
    s_nop 0
    buffer_load_dwordx4 v20, s[24:27], s92 offen offset:0 lds
    buffer_load_dwordx4 v21, s[24:27], s92 offen offset:1024 lds
    buffer_load_dwordx4 v22, s[24:27], s92 offen offset:2048 lds
    buffer_load_dwordx4 v23, s[24:27], s92 offen offset:3072 lds
    s_add_u32 m0, s95, 40960
    s_nop 0
    buffer_load_dwordx4 v24, s[28:31], s93 offen offset:0 lds
    buffer_load_dwordx4 v25, s[28:31], s93 offen offset:1024 lds
    buffer_load_dwordx4 v26, s[28:31], s93 offen offset:2048 lds
    s_add_u32 m0, s95, 44032
    s_nop 0
    buffer_load_dwordx4 v27, s[28:31], s93 offen offset:0 lds
    buffer_load_dwordx4 v28, s[28:31], s93 offen offset:1024 lds
    buffer_load_dwordx4 v29, s[28:31], s93 offen offset:2048 lds
    s_cmp_ge_u32 s10, 224
    s_cbranch_scc1 L_p31_0
    s_add_u32 s12, s9, 0
    buffer_load_dwordx4 v[160:163], v30, s[44:47], s12 offen nt
    s_add_u32 s12, s9, 7168
    buffer_load_dwordx4 v[164:167], v30, s[44:47], s12 offen nt
    s_add_u32 s12, s9, 14336
    buffer_load_dwordx4 v[168:171], v30, s[44:47], s12 offen nt
    s_add_u32 s12, s9, 21504
    buffer_load_dwordx4 v[172:175], v30, s[44:47], s12 offen nt
    s_add_u32 s12, s9, 28672
    buffer_load_dwordx4 v[176:179], v30, s[44:47], s12 offen nt
    s_add_u32 s12, s9, 35840
    buffer_load_dwordx4 v[180:183], v30, s[44:47], s12 offen nt
    s_add_u32 s12, s9, 43008
    buffer_load_dwordx4 v[184:187], v30, s[44:47], s12 offen nt
    s_add_u32 s12, s9, 50176
    buffer_load_dwordx4 v[188:191], v30, s[44:47], s12 offen nt
    s_branch L_p3e1_0
L_p31_0:
    s_mov_b64 exec, 63
    s_bfe_u32 s12, s69, 0x4000c
    s_mul_i32 s12, s12, 393216
    buffer_load_dword v160, v32, s[28:31], s12 offen
    s_bfe_u32 s12, s69, 0x40010
    s_mul_i32 s12, s12, 393216
    buffer_load_dword v164, v32, s[28:31], s12 offen
    s_bfe_u32 s12, s69, 0x40014
    s_mul_i32 s12, s12, 393216
    buffer_load_dword v168, v32, s[28:31], s12 offen
    s_bfe_u32 s12, s69, 0x40018
    s_mul_i32 s12, s12, 393216
    buffer_load_dword v172, v32, s[28:31], s12 offen
    s_bfe_u32 s12, s69, 0x4001c
    s_mul_i32 s12, s12, 393216
    buffer_load_dword v176, v32, s[28:31], s12 offen
    s_mov_b64 exec, 1
    s_bfe_u32 s12, s69, 0x4001c
    s_mul_i32 s12, s12, 393216
    buffer_load_dword v180, v32, s[28:31], s12 offen
    s_bfe_u32 s12, s69, 0x4001c
    s_mul_i32 s12, s12, 393216
    buffer_load_dword v184, v32, s[28:31], s12 offen
    s_bfe_u32 s12, s69, 0x4001c
    s_mul_i32 s12, s12, 393216
    buffer_load_dword v188, v32, s[28:31], s12 offen
    s_mov_b64 exec, -1
L_p3e1_0:
    s_mov_b32 exec_lo, 0xffff0000
    s_mov_b32 exec_hi, 0
    buffer_load_dword v19, v10, s[36:39], 0 offen
    s_mov_b64 exec, -1
    s_mov_b32 s13, 0
L_tagchk_0:
    v_readfirstlane_b32 s23, v15
    s_nop 1
    s_cmp_lg_u32 s23, 0
    s_cbranch_scc1 L_tagok_0
    s_add_u32 s13, s13, 1
    s_cmp_ge_u32 s13, 16384
    s_cbranch_scc1 L_tagok_0
    buffer_load_dword v15, v13, s[72:75], 0 offen offset:4 sc1
    s_waitcnt vmcnt(0)
    s_branch L_tagchk_0
L_tagok_0:
    s_and_b32 s76, s23, 0xff
    s_bfe_u32 s77, s23, 0x80008
    s_bfe_u32 s78, s23, 0x80010
    s_lshr_b32 s79, s23, 24
    v_and_b32 v35, 3, v2
    v_lshlrev_b32 v35, 3, v35
    v_bfe_u32 v35, s23, v35, 8
    s_cmp_lg_u32 s21, 0
    s_cbranch_scc1 L_nopub_0
    v_mov_b32 v14, 162880
    ds_read_b128 v[104:107], v14
    s_lshl_b32 s12, s2, 3
    s_add_u32 s12, s12, 0
    s_waitcnt lgkmcnt(0)
    v_max3_u32 v104, v104, v105, v106
    v_max_u32 v104, v104, v107
    v_mov_b32 v105, s23
    s_mov_b64 exec, 1
    buffer_store_dwordx2 v[104:105], v13, s[32:35], s12 offen sc1
    s_mov_b64 exec, -1
L_nopub_0:
    s_waitcnt vmcnt(19)
    s_barrier
    s_bfe_u32 s91, s69, 0x40000
    s_lshl_b32 s92, s91, 7
    s_mul_i32 s93, s91, 393216
    s_add_u32 m0, s94, 81920
    s_nop 0
    buffer_load_dwordx4 v20, s[24:27], s92 offen offset:0 lds
    buffer_load_dwordx4 v21, s[24:27], s92 offen offset:1024 lds
    buffer_load_dwordx4 v22, s[24:27], s92 offen offset:2048 lds
    buffer_load_dwordx4 v23, s[24:27], s92 offen offset:3072 lds
    s_add_u32 m0, s95, 81920
    s_nop 0
    buffer_load_dwordx4 v24, s[28:31], s93 offen offset:0 lds
    s_waitcnt vmcnt(14)
    s_barrier
    s_add_u32 m0, s95, 81920
    s_nop 0
    buffer_load_dwordx4 v25, s[28:31], s93 offen offset:1024 lds
    buffer_load_dwordx4 v26, s[28:31], s93 offen offset:2048 lds
    s_add_u32 m0, s95, 84992
    s_nop 0
    buffer_load_dwordx4 v27, s[28:31], s93 offen offset:0 lds
    buffer_load_dwordx4 v28, s[28:31], s93 offen offset:1024 lds
    buffer_load_dwordx4 v29, s[28:31], s93 offen offset:2048 lds
    s_bfe_u32 s91, s69, 0x40004
    s_lshl_b32 s92, s91, 7
    s_mul_i32 s93, s91, 393216
    s_add_u32 m0, s94, 0
    s_nop 0
    buffer_load_dwordx4 v20, s[24:27], s92 offen offset:0 lds
    buffer_load_dwordx4 v21, s[24:27], s92 offen offset:1024 lds
    buffer_load_dwordx4 v22, s[24:27], s92 offen offset:2048 lds
    buffer_load_dwordx4 v23, s[24:27], s92 offen offset:3072 lds
    s_add_u32 m0, s95, 0
    s_nop 0
    buffer_load_dwordx4 v24, s[28:31], s93 offen offset:0 lds
    buffer_load_dwordx4 v25, s[28:31], s93 offen offset:1024 lds
    buffer_load_dwordx4 v26, s[28:31], s93 offen offset:2048 lds
    s_waitcnt vmcnt(7)
    s_barrier
    s_add_u32 m0, s95, 3072
    s_nop 0
    buffer_load_dwordx4 v27, s[28:31], s93 offen offset:0 lds
    buffer_load_dwordx4 v28, s[28:31], s93 offen offset:1024 lds
    buffer_load_dwordx4 v29, s[28:31], s93 offen offset:2048 lds
    s_bfe_u32 s91, s69, 0x40008
    s_lshl_b32 s92, s91, 7
    s_mul_i32 s93, s91, 393216
    s_add_u32 m0, s94, 40960
    s_nop 0
    buffer_load_dwordx4 v20, s[24:27], s92 offen offset:0 lds
    buffer_load_dwordx4 v21, s[24:27], s92 offen offset:1024 lds
    buffer_load_dwordx4 v22, s[24:27], s92 offen offset:2048 lds
    buffer_load_dwordx4 v23, s[24:27], s92 offen offset:3072 lds
    s_add_u32 m0, s95, 40960
    s_nop 0
    buffer_load_dwordx4 v24, s[28:31], s93 offen offset:0 lds
    buffer_load_dwordx4 v25, s[28:31], s93 offen offset:1024 lds
    buffer_load_dwordx4 v26, s[28:31], s93 offen offset:2048 lds
    s_add_u32 m0, s95, 44032
    s_nop 0
    buffer_load_dwordx4 v27, s[28:31], s93 offen offset:0 lds
    buffer_load_dwordx4 v28, s[28:31], s93 offen offset:1024 lds
    s_waitcnt vmcnt(9)
    s_barrier
    s_add_u32 m0, s95, 44032
    s_nop 0
    buffer_load_dwordx4 v29, s[28:31], s93 offen offset:2048 lds
    s_bfe_u32 s91, s69, 0x4000c
    s_lshl_b32 s92, s91, 7
    s_mul_i32 s93, s91, 393216
    s_add_u32 m0, s94, 81920
    s_nop 0
    buffer_load_dwordx4 v20, s[24:27], s92 offen offset:0 lds
    buffer_load_dwordx4 v21, s[24:27], s92 offen offset:1024 lds
    buffer_load_dwordx4 v22, s[24:27], s92 offen offset:2048 lds
    buffer_load_dwordx4 v23, s[24:27], s92 offen offset:3072 lds
    s_add_u32 m0, s95, 81920
    s_nop 0
    buffer_load_dwordx4 v24, s[28:31], s93 offen offset:0 lds
    buffer_load_dwordx4 v25, s[28:31], s93 offen offset:1024 lds
    buffer_load_dwordx4 v26, s[28:31], s93 offen offset:2048 lds
    s_add_u32 m0, s95, 84992
    s_nop 0
    buffer_load_dwordx4 v27, s[28:31], s93 offen offset:0 lds
    buffer_load_dwordx4 v28, s[28:31], s93 offen offset:1024 lds
    buffer_load_dwordx4 v29, s[28:31], s93 offen offset:2048 lds
    s_mov_b32 s12, 0
    buffer_load_dwordx4 v[104:107], v5, s[32:35], s12 offen offset:0 sc1
    buffer_load_dwordx4 v[108:111], v5, s[32:35], s12 offen offset:1024 sc1
    s_waitcnt vmcnt(12)
    s_barrier
    s_bfe_u32 s91, s69, 0x40010
    s_lshl_b32 s92, s91, 7
    s_mul_i32 s93, s91, 393216
    s_add_u32 m0, s94, 0
    s_nop 0
    buffer_load_dwordx4 v20, s[24:27], s92 offen offset:0 lds
    buffer_load_dwordx4 v21, s[24:27], s92 offen offset:1024 lds
    buffer_load_dwordx4 v22, s[24:27], s92 offen offset:2048 lds
    buffer_load_dwordx4 v23, s[24:27], s92 offen offset:3072 lds
    s_add_u32 m0, s95, 0
    s_nop 0
    buffer_load_dwordx4 v24, s[28:31], s93 offen offset:0 lds
    buffer_load_dwordx4 v25, s[28:31], s93 offen offset:1024 lds
    buffer_load_dwordx4 v26, s[28:31], s93 offen offset:2048 lds
    s_add_u32 m0, s95, 3072
    s_nop 0
    buffer_load_dwordx4 v27, s[28:31], s93 offen offset:0 lds
    buffer_load_dwordx4 v28, s[28:31], s93 offen offset:1024 lds
    buffer_load_dwordx4 v29, s[28:31], s93 offen offset:2048 lds
    s_add_u32 s12, s97, 0
    buffer_load_dwordx4 v[192:195], v31, s[64:67], s12 offen nt
    s_add_u32 s12, s97, 16384
    buffer_load_dwordx4 v[196:199], v31, s[64:67], s12 offen nt
    s_add_u32 s12, s97, 32768
    buffer_load_dwordx4 v[200:203], v31, s[64:67], s12 offen nt
    s_add_u32 s12, s97, 49152
    buffer_load_dwordx4 v[204:207], v31, s[64:67], s12 offen nt
    s_add_u32 s12, s97, 65536
    buffer_load_dwordx4 v[208:211], v31, s[64:67], s12 offen nt
    s_add_u32 s12, s97, 81920
    buffer_load_dwordx4 v[212:215], v31, s[64:67], s12 offen nt
    s_add_u32 s12, s97, 98304
    buffer_load_dwordx4 v[216:219], v31, s[64:67], s12 offen nt
    s_waitcnt vmcnt(19)
    s_barrier
    s_bfe_u32 s91, s69, 0x40014
    s_lshl_b32 s92, s91, 7
    s_mul_i32 s93, s91, 393216
    s_add_u32 m0, s94, 40960
    s_nop 0
    buffer_load_dwordx4 v20, s[24:27], s92 offen offset:0 lds
    s_waitcnt vmcnt(18)
    s_mov_b32 s13, 0
    v_xor_b32 v105, s23, v105
    v_xor_b32 v107, s23, v107
    v_xor_b32 v109, s23, v109
    v_xor_b32 v111, s23, v111
    v_or3_b32 v105, v105, v107, v109
    v_or_b32 v105, v105, v111
    v_cmp_ne_u32 vcc, 0, v105
    s_cbranch_vccnz L_keyre_0
L_keyok_0:
    buffer_load_dwordx4 v21, s[24:27], s92 offen offset:1024 lds
    v_max3_u32 v104, v104, v106, v108
    v_max_u32 v104, v104, v110
    s_nop 1
    v_max_u32_dpp v104, v104, v104 row_shr:1 row_mask:0xf bank_mask:0xf
    s_nop 1
    v_max_u32_dpp v104, v104, v104 row_shr:2 row_mask:0xf bank_mask:0xf
    s_nop 1
    v_max_u32_dpp v104, v104, v104 row_shr:4 row_mask:0xf bank_mask:0xf
    s_nop 1
    v_max_u32_dpp v104, v104, v104 row_shr:8 row_mask:0xf bank_mask:0xf
    s_nop 1
    v_max_u32_dpp v104, v104, v104 row_bcast:15 row_mask:0xa bank_mask:0xf
    buffer_load_dwordx4 v22, s[24:27], s92 offen offset:2048 lds
    s_nop 0
    v_max_u32_dpp v104, v104, v104 row_bcast:31 row_mask:0xc bank_mask:0xf
    s_nop 0
    v_readlane_b32 s14, v104, 63
    s_nop 1
    s_and_b32 s15, s14, 2047
    s_sub_u32 s15, 2047, s15
    s_lshl_b32 s12, s15, 11
    s_lshl_b32 s13, s70, 1
    s_add_u32 s12, s12, s13
    buffer_load_dwordx4 v[36:39], v34, s[24:27], s12 offen
    s_lshr_b32 s12, s14, 11
    s_and_b32 s13, s12, 0x8000
    s_cmp_lg_u32 s13, 0
    s_mov_b32 s13, 0xffff
    s_cselect_b32 s13, 0x8000, s13
    s_xor_b32 s12, s12, s13
    s_lshl_b32 s12, s12, 16
    v_mov_b32 v105, s12
    buffer_load_dwordx4 v23, s[24:27], s92 offen offset:3072 lds
    v_mul_f32 v105, 0xbfb8aa3b, v105
    v_exp_f32 v105, v105
    s_nop 0
    v_add_f32 v105, 1.0, v105
    v_rcp_f32 v105, v105
    s_nop 0
    v_cvt_pk_bf16_f32 v105, v105, v105
    v_lshlrev_b32 v105, 16, v105
    s_add_u32 s12, s15, 1
    v_mov_b32 v104, s12
    s_add_u32 m0, s95, 40960
    s_nop 0
    buffer_load_dwordx4 v24, s[28:31], s93 offen offset:0 lds
    v_mov_b32 v106, s23
    v_readfirstlane_b32 s14, v105
    v_mov_b32 v14, 162864
    s_mov_b64 exec, 1
    ds_write_b96 v14, v[104:106]
    s_mov_b64 exec, -1
    s_waitcnt lgkmcnt(0)
    s_waitcnt vmcnt(13)
    s_barrier
    s_add_u32 m0, s95, 40960
    s_nop 0
    buffer_load_dwordx4 v25, s[28:31], s93 offen offset:1024 lds
    s_waitcnt vmcnt(3)
    s_mov_b32 s8, 0xffff0000
    v_lshlrev_b32 v40, 16, v36
    v_and_b32 v41, s8, v36
    v_lshlrev_b32 v42, 16, v37
    v_and_b32 v43, s8, v37
    v_lshlrev_b32 v44, 16, v38
    buffer_load_dwordx4 v26, s[28:31], s93 offen offset:2048 lds
    v_and_b32 v45, s8, v38
    v_lshlrev_b32 v46, 16, v39
    v_and_b32 v47, s8, v39
    v_lshlrev_b32 v48, 16, v128
    v_lshlrev_b32 v49, 16, v129
    v_and_b32 v128, s8, v128
    v_and_b32 v129, s8, v129
    s_add_u32 m0, s95, 44032
    s_nop 0
    buffer_load_dwordx4 v27, s[28:31], s93 offen offset:0 lds
    v_mul_f32 v220, v48, v40
    v_mul_f32 v222, v49, v40
    v_mul_f32 v221, v128, v40
    v_mul_f32 v223, v129, v40
    v_lshlrev_b32 v50, 16, v130
    v_lshlrev_b32 v51, 16, v131
    v_and_b32 v130, s8, v130
    buffer_load_dwordx4 v28, s[28:31], s93 offen offset:1024 lds
    v_and_b32 v131, s8, v131
    v_mul_f32 v224, v50, v40
    v_mul_f32 v226, v51, v40
    v_mul_f32 v225, v130, v40
    v_mul_f32 v227, v131, v40
    v_lshlrev_b32 v48, 16, v160
    v_lshlrev_b32 v49, 16, v161
    buffer_load_dwordx4 v29, s[28:31], s93 offen offset:2048 lds
    v_and_b32 v160, s8, v160
    v_and_b32 v161, s8, v161
    v_mul_f32 v228, v48, v40
    v_mul_f32 v230, v49, v40
    v_mul_f32 v229, v160, v40
    v_mul_f32 v231, v161, v40
    v_lshlrev_b32 v50, 16, v162
    s_bfe_u32 s91, s69, 0x40018
    s_lshl_b32 s92, s91, 7
    s_mul_i32 s93, s91, 393216
    s_add_u32 m0, s94, 81920
    s_nop 0
    buffer_load_dwordx4 v20, s[24:27], s92 offen offset:0 lds
    v_lshlrev_b32 v51, 16, v163
    v_and_b32 v162, s8, v162
    v_and_b32 v163, s8, v163
    v_mul_f32 v232, v50, v40
    v_mul_f32 v234, v51, v40
    v_mul_f32 v233, v162, v40
    v_mul_f32 v235, v163, v40
    buffer_load_dwordx4 v21, s[24:27], s92 offen offset:1024 lds
    v_lshlrev_b32 v48, 16, v132
    v_lshlrev_b32 v49, 16, v133
    v_and_b32 v132, s8, v132
    v_and_b32 v133, s8, v133
    v_fmac_f32 v220, v48, v41
    v_fmac_f32 v222, v49, v41
    v_fmac_f32 v221, v132, v41
    buffer_load_dwordx4 v22, s[24:27], s92 offen offset:2048 lds
    v_fmac_f32 v223, v133, v41
    v_lshlrev_b32 v50, 16, v134
    v_lshlrev_b32 v51, 16, v135
    v_and_b32 v134, s8, v134
    v_and_b32 v135, s8, v135
    v_fmac_f32 v224, v50, v41
    v_fmac_f32 v226, v51, v41
    buffer_load_dwordx4 v23, s[24:27], s92 offen offset:3072 lds
    v_fmac_f32 v225, v134, v41
    v_fmac_f32 v227, v135, v41
    v_lshlrev_b32 v48, 16, v164
    v_lshlrev_b32 v49, 16, v165
    v_and_b32 v164, s8, v164
    v_and_b32 v165, s8, v165
    v_fmac_f32 v228, v48, v41
    s_add_u32 m0, s95, 81920
    s_nop 0
    buffer_load_dwordx4 v24, s[28:31], s93 offen offset:0 lds
    v_fmac_f32 v230, v49, v41
    v_fmac_f32 v229, v164, v41
    v_fmac_f32 v231, v165, v41
    v_lshlrev_b32 v50, 16, v166
    v_lshlrev_b32 v51, 16, v167
    v_and_b32 v166, s8, v166
    v_and_b32 v167, s8, v167
    buffer_load_dwordx4 v25, s[28:31], s93 offen offset:1024 lds
    v_fmac_f32 v232, v50, v41
    v_fmac_f32 v234, v51, v41
    v_fmac_f32 v233, v166, v41
    v_fmac_f32 v235, v167, v41
    v_lshlrev_b32 v48, 16, v136
    v_lshlrev_b32 v49, 16, v137
    v_and_b32 v136, s8, v136
    buffer_load_dwordx4 v26, s[28:31], s93 offen offset:2048 lds
    v_and_b32 v137, s8, v137
    v_fmac_f32 v220, v48, v42
    v_fmac_f32 v222, v49, v42
    v_fmac_f32 v221, v136, v42
    v_fmac_f32 v223, v137, v42
    v_lshlrev_b32 v50, 16, v138
    v_lshlrev_b32 v51, 16, v139
    v_and_b32 v138, s8, v138
    v_and_b32 v139, s8, v139
    v_fmac_f32 v224, v50, v42
    v_fmac_f32 v226, v51, v42
    v_fmac_f32 v225, v138, v42
    v_fmac_f32 v227, v139, v42
    v_lshlrev_b32 v48, 16, v168
    v_lshlrev_b32 v49, 16, v169
    v_and_b32 v168, s8, v168
    v_and_b32 v169, s8, v169
    v_fmac_f32 v228, v48, v42
    v_fmac_f32 v230, v49, v42
    v_fmac_f32 v229, v168, v42
    v_fmac_f32 v231, v169, v42
    v_lshlrev_b32 v50, 16, v170
    v_lshlrev_b32 v51, 16, v171
    v_and_b32 v170, s8, v170
    v_and_b32 v171, s8, v171
    v_fmac_f32 v232, v50, v42
    v_fmac_f32 v234, v51, v42
    v_fmac_f32 v233, v170, v42
    v_fmac_f32 v235, v171, v42
    v_lshlrev_b32 v48, 16, v140
    v_lshlrev_b32 v49, 16, v141
    v_and_b32 v140, s8, v140
    s_waitcnt vmcnt(7)
    s_barrier
    s_add_u32 m0, s95, 84992
    s_nop 0
    buffer_load_dwordx4 v27, s[28:31], s93 offen offset:0 lds
    v_and_b32 v141, s8, v141
    v_fmac_f32 v220, v48, v43
    v_fmac_f32 v222, v49, v43
    v_fmac_f32 v221, v140, v43
    v_fmac_f32 v223, v141, v43
    v_lshlrev_b32 v50, 16, v142
    v_lshlrev_b32 v51, 16, v143
    buffer_load_dwordx4 v28, s[28:31], s93 offen offset:1024 lds
    v_and_b32 v142, s8, v142
    v_and_b32 v143, s8, v143
    v_fmac_f32 v224, v50, v43
    v_fmac_f32 v226, v51, v43
    v_fmac_f32 v225, v142, v43
    v_fmac_f32 v227, v143, v43
    v_lshlrev_b32 v48, 16, v172
    buffer_load_dwordx4 v29, s[28:31], s93 offen offset:2048 lds
    v_lshlrev_b32 v49, 16, v173
    v_and_b32 v172, s8, v172
    v_and_b32 v173, s8, v173
    v_fmac_f32 v228, v48, v43
    v_fmac_f32 v230, v49, v43
    v_fmac_f32 v229, v172, v43
    v_fmac_f32 v231, v173, v43
    s_bfe_u32 s91, s69, 0x4001c
    s_lshl_b32 s92, s91, 7
    s_mul_i32 s93, s91, 393216
    s_add_u32 m0, s94, 0
    s_nop 0
    buffer_load_dwordx4 v20, s[24:27], s92 offen offset:0 lds
    v_lshlrev_b32 v50, 16, v174
    v_lshlrev_b32 v51, 16, v175
    v_and_b32 v174, s8, v174
    v_and_b32 v175, s8, v175
    v_fmac_f32 v232, v50, v43
    v_fmac_f32 v234, v51, v43
    v_fmac_f32 v233, v174, v43
    buffer_load_dwordx4 v21, s[24:27], s92 offen offset:1024 lds
    v_fmac_f32 v235, v175, v43
    v_lshlrev_b32 v48, 16, v144
    v_lshlrev_b32 v49, 16, v145
    v_and_b32 v144, s8, v144
    v_and_b32 v145, s8, v145
    v_fmac_f32 v220, v48, v44
    v_fmac_f32 v222, v49, v44
    buffer_load_dwordx4 v22, s[24:27], s92 offen offset:2048 lds
    v_fmac_f32 v221, v144, v44
    v_fmac_f32 v223, v145, v44
    v_lshlrev_b32 v50, 16, v146
    v_lshlrev_b32 v51, 16, v147
    v_and_b32 v146, s8, v146
    v_and_b32 v147, s8, v147
    v_fmac_f32 v224, v50, v44
    buffer_load_dwordx4 v23, s[24:27], s92 offen offset:3072 lds
    v_fmac_f32 v226, v51, v44
    v_fmac_f32 v225, v146, v44
    v_fmac_f32 v227, v147, v44
    v_lshlrev_b32 v48, 16, v176
    v_lshlrev_b32 v49, 16, v177
    v_and_b32 v176, s8, v176
    v_and_b32 v177, s8, v177
    s_add_u32 m0, s95, 0
    s_nop 0
    buffer_load_dwordx4 v24, s[28:31], s93 offen offset:0 lds
    v_fmac_f32 v228, v48, v44
    v_fmac_f32 v230, v49, v44
    v_fmac_f32 v229, v176, v44
    v_fmac_f32 v231, v177, v44
    v_lshlrev_b32 v50, 16, v178
    v_lshlrev_b32 v51, 16, v179
    v_and_b32 v178, s8, v178
    buffer_load_dwordx4 v25, s[28:31], s93 offen offset:1024 lds
    v_and_b32 v179, s8, v179
    v_fmac_f32 v232, v50, v44
    v_fmac_f32 v234, v51, v44
    v_fmac_f32 v233, v178, v44
    v_fmac_f32 v235, v179, v44
    v_lshlrev_b32 v48, 16, v148
    v_lshlrev_b32 v49, 16, v149
    buffer_load_dwordx4 v26, s[28:31], s93 offen offset:2048 lds
    v_and_b32 v148, s8, v148
    v_and_b32 v149, s8, v149
    v_fmac_f32 v220, v48, v45
    v_fmac_f32 v222, v49, v45
    v_fmac_f32 v221, v148, v45
    v_fmac_f32 v223, v149, v45
    v_lshlrev_b32 v50, 16, v150
    s_add_u32 m0, s95, 3072
    s_nop 0
    buffer_load_dwordx4 v27, s[28:31], s93 offen offset:0 lds
    v_lshlrev_b32 v51, 16, v151
    v_and_b32 v150, s8, v150
    v_and_b32 v151, s8, v151
    v_fmac_f32 v224, v50, v45
    v_fmac_f32 v226, v51, v45
    v_fmac_f32 v225, v150, v45
    v_fmac_f32 v227, v151, v45
    buffer_load_dwordx4 v28, s[28:31], s93 offen offset:1024 lds
    v_lshlrev_b32 v48, 16, v180
    v_lshlrev_b32 v49, 16, v181
    v_and_b32 v180, s8, v180
    v_and_b32 v181, s8, v181
    v_fmac_f32 v228, v48, v45
    v_fmac_f32 v230, v49, v45
    v_fmac_f32 v229, v180, v45
    v_fmac_f32 v231, v181, v45
    v_lshlrev_b32 v50, 16, v182
    v_lshlrev_b32 v51, 16, v183
    v_and_b32 v182, s8, v182
    v_and_b32 v183, s8, v183
    v_fmac_f32 v232, v50, v45
    v_fmac_f32 v234, v51, v45
    v_fmac_f32 v233, v182, v45
    v_fmac_f32 v235, v183, v45
    v_lshlrev_b32 v48, 16, v152
    v_lshlrev_b32 v49, 16, v153
    v_and_b32 v152, s8, v152
    v_and_b32 v153, s8, v153
    v_fmac_f32 v220, v48, v46
    v_fmac_f32 v222, v49, v46
    v_fmac_f32 v221, v152, v46
    v_fmac_f32 v223, v153, v46
    v_lshlrev_b32 v50, 16, v154
    v_lshlrev_b32 v51, 16, v155
    v_and_b32 v154, s8, v154
    v_and_b32 v155, s8, v155
    v_fmac_f32 v224, v50, v46
    v_fmac_f32 v226, v51, v46
    v_fmac_f32 v225, v154, v46
    v_fmac_f32 v227, v155, v46
    s_waitcnt vmcnt(9)
    s_barrier
    s_add_u32 m0, s95, 3072
    s_nop 0
    buffer_load_dwordx4 v29, s[28:31], s93 offen offset:2048 lds
    v_lshlrev_b32 v48, 16, v184
    v_lshlrev_b32 v49, 16, v185
    v_and_b32 v184, s8, v184
    v_and_b32 v185, s8, v185
    v_fmac_f32 v228, v48, v46
    v_fmac_f32 v230, v49, v46
    v_fmac_f32 v229, v184, v46
    s_mul_i32 s12, s21, 8
    s_add_u32 s12, s12, 96
    s_lshl_b32 s13, s12, 10
    s_lshl_b32 s12, s12, 14
    s_add_u32 m0, s13, 24576
    s_add_u32 s90, s12, 0
    buffer_load_dwordx4 v33, s[36:39], s90 offen lds
    s_add_u32 m0, s13, 25600
    s_add_u32 s90, s12, 16384
    buffer_load_dwordx4 v33, s[36:39], s90 offen lds
    s_add_u32 m0, s13, 26624
    s_add_u32 s90, s12, 32768
    buffer_load_dwordx4 v33, s[36:39], s90 offen lds
    s_add_u32 m0, s13, 27648
    s_add_u32 s90, s12, 49152
    buffer_load_dwordx4 v33, s[36:39], s90 offen lds
    s_add_u32 m0, s13, 28672
    s_add_u32 s90, s12, 65536
    buffer_load_dwordx4 v33, s[36:39], s90 offen lds
    s_add_u32 m0, s13, 29696
    s_add_u32 s90, s12, 81920
    buffer_load_dwordx4 v33, s[36:39], s90 offen lds
    s_add_u32 m0, s13, 30720
    s_add_u32 s90, s12, 98304
    buffer_load_dwordx4 v33, s[36:39], s90 offen lds
    s_add_u32 m0, s13, 31744
    s_add_u32 s90, s12, 114688
    buffer_load_dwordx4 v33, s[36:39], s90 offen lds
    v_fmac_f32 v231, v185, v46
    v_lshlrev_b32 v50, 16, v186
    v_lshlrev_b32 v51, 16, v187
    v_and_b32 v186, s8, v186
    v_and_b32 v187, s8, v187
    v_fmac_f32 v232, v50, v46
    v_fmac_f32 v234, v51, v46
    v_fmac_f32 v233, v186, v46
    v_fmac_f32 v235, v187, v46
    v_lshlrev_b32 v48, 16, v156
    v_lshlrev_b32 v49, 16, v157
    v_and_b32 v156, s8, v156
    v_and_b32 v157, s8, v157
    v_fmac_f32 v220, v48, v47
    v_fmac_f32 v222, v49, v47
    v_fmac_f32 v221, v156, v47
    v_fmac_f32 v223, v157, v47
    v_lshlrev_b32 v50, 16, v158
    v_lshlrev_b32 v51, 16, v159
    v_and_b32 v158, s8, v158
    v_and_b32 v159, s8, v159
    v_fmac_f32 v224, v50, v47
    v_fmac_f32 v226, v51, v47
    v_fmac_f32 v225, v158, v47
    v_fmac_f32 v227, v159, v47
    s_waitcnt vmcnt(8)
    s_barrier
    v_lshlrev_b32 v48, 16, v188
    v_lshlrev_b32 v49, 16, v189
    v_and_b32 v188, s8, v188
    v_and_b32 v189, s8, v189
    v_fmac_f32 v228, v48, v47
    v_fmac_f32 v230, v49, v47
    v_fmac_f32 v229, v188, v47
    v_fmac_f32 v231, v189, v47
    v_lshlrev_b32 v50, 16, v190
    v_lshlrev_b32 v51, 16, v191
    v_and_b32 v190, s8, v190
    v_and_b32 v191, s8, v191
    v_fmac_f32 v232, v50, v47
    v_fmac_f32 v234, v51, v47
    v_fmac_f32 v233, v190, v47
    v_fmac_f32 v235, v191, v47
    v_permlane32_swap_b32 v220, v228
    v_permlane32_swap_b32 v221, v229
    v_permlane32_swap_b32 v222, v230
    v_permlane32_swap_b32 v223, v231
    v_permlane32_swap_b32 v224, v232
    v_permlane32_swap_b32 v225, v233
    v_permlane32_swap_b32 v226, v234
    v_permlane32_swap_b32 v227, v235
    v_add_f32 v220, v220, v228
    v_add_f32 v221, v221, v229
    v_add_f32 v222, v222, v230
    v_add_f32 v223, v223, v231
    v_add_f32 v224, v224, v232
    v_add_f32 v225, v225, v233
    v_add_f32 v226, v226, v234
    v_add_f32 v227, v227, v235
    v_permlane16_swap_b32 v220, v224
    v_permlane16_swap_b32 v221, v225
    v_permlane16_swap_b32 v222, v226
    v_permlane16_swap_b32 v223, v227
    v_add_f32 v220, v220, v224
    v_add_f32 v221, v221, v225
    v_add_f32 v222, v222, v226
    v_add_f32 v223, v223, v227
    v_add_f32_dpp v220, v220, v220 row_ror:8 row_mask:0xf bank_mask:0xf
    v_add_f32_dpp v221, v221, v221 row_ror:8 row_mask:0xf bank_mask:0xf
    v_add_f32_dpp v222, v222, v222 row_ror:8 row_mask:0xf bank_mask:0xf
    v_add_f32_dpp v223, v223, v223 row_ror:8 row_mask:0xf bank_mask:0xf
    s_branch L_varend
L_var1:
    s_nop 0
    s_add_u32 m0, s95, 40960
    s_nop 0
    buffer_load_dwordx4 v26, s[28:31], s93 offen offset:2048 lds
    s_add_u32 m0, s95, 44032
    s_nop 0
    buffer_load_dwordx4 v27, s[28:31], s93 offen offset:0 lds
    buffer_load_dwordx4 v28, s[28:31], s93 offen offset:1024 lds
    buffer_load_dwordx4 v29, s[28:31], s93 offen offset:2048 lds
    s_bfe_u32 s91, s68, 0x40008
    s_lshl_b32 s92, s91, 7
    s_mul_i32 s93, s91, 393216
    s_add_u32 m0, s94, 81920
    s_nop 0
    buffer_load_dwordx4 v20, s[24:27], s92 offen offset:0 lds
    buffer_load_dwordx4 v21, s[24:27], s92 offen offset:1024 lds
    buffer_load_dwordx4 v22, s[24:27], s92 offen offset:2048 lds
    buffer_load_dwordx4 v23, s[24:27], s92 offen offset:3072 lds
    s_add_u32 m0, s95, 81920
    s_nop 0
    buffer_load_dwordx4 v24, s[28:31], s93 offen offset:0 lds
    buffer_load_dwordx4 v25, s[28:31], s93 offen offset:1024 lds
    buffer_load_dwordx4 v26, s[28:31], s93 offen offset:2048 lds
    s_add_u32 m0, s95, 84992
    s_nop 0
    buffer_load_dwordx4 v27, s[28:31], s93 offen offset:0 lds
    buffer_load_dwordx4 v28, s[28:31], s93 offen offset:1024 lds
    buffer_load_dwordx4 v29, s[28:31], s93 offen offset:2048 lds
    s_lshl_b32 s12, s19, 2
    s_add_u32 s12, s12, s21
    s_lshl_b32 s12, s12, 10
    s_lshl_b32 s13, s21, 10
    s_add_u32 m0, s13, 155648
    s_nop 0
    buffer_load_dwordx4 v5, s[76:79], s12 offen lds
    s_lshl_b32 s12, s22, 11
    buffer_load_dwordx4 v[40:43], v5, s[24:27], s12 offen offset:0
    buffer_load_dwordx4 v[44:47], v5, s[24:27], s12 offen offset:1024
    buffer_load_dwordx4 v[48:51], v5, s[24:27], s12 offen offset:2048
    buffer_load_dwordx4 v[52:55], v5, s[24:27], s12 offen offset:3072
    buffer_load_dwordx4 v[56:59], v5, s[80:83], 0 offen offset:0
    buffer_load_dwordx4 v[60:63], v5, s[80:83], 0 offen offset:1024
    buffer_load_dwordx4 v[64:67], v5, s[84:87], 0 offen offset:0
    buffer_load_dwordx4 v[68:71], v5, s[84:87], 0 offen offset:1024
    s_waitcnt vmcnt(19)
    s_barrier
    s_bfe_u32 s91, s68, 0x4000c
    s_lshl_b32 s92, s91, 7
    s_mul_i32 s93, s91, 393216
    s_add_u32 m0, s94, 0
    s_nop 0
    buffer_load_dwordx4 v20, s[24:27], s92 offen offset:0 lds
    s_waitcnt vmcnt(1)
    s_mov_b32 s8, 0xffff0000
    v_lshlrev_b32 v72, 16, v56
    v_and_b32 v56, s8, v56
    v_lshlrev_b32 v73, 16, v64
    v_and_b32 v64, s8, v64
    v_lshlrev_b32 v112, 16, v40
    buffer_load_dwordx4 v21, s[24:27], s92 offen offset:1024 lds
    v_and_b32 v40, s8, v40
    v_lshlrev_b32 v116, 16, v48
    v_and_b32 v48, s8, v48
    v_mul_f32 v113, v112, v73
    v_mul_f32 v114, v40, v64
    v_mul_f32 v90, v112, v72
    v_mul_f32 v117, v116, v73
    buffer_load_dwordx4 v22, s[24:27], s92 offen offset:2048 lds
    v_mul_f32 v118, v48, v64
    v_mul_f32 v92, v116, v72
    v_cvt_pk_bf16_f32 v113, 0, v113
    v_cvt_pk_bf16_f32 v114, 0, v114
    v_fmac_f32 v90, v40, v56
    v_cvt_pk_bf16_f32 v117, 0, v117
    v_cvt_pk_bf16_f32 v118, 0, v118
    buffer_load_dwordx4 v23, s[24:27], s92 offen offset:3072 lds
    v_fmac_f32 v92, v48, v56
    v_add_f32 v91, v113, v114
    v_add_f32 v93, v117, v118
    v_lshlrev_b32 v72, 16, v57
    v_and_b32 v57, s8, v57
    v_lshlrev_b32 v73, 16, v65
    v_and_b32 v65, s8, v65
    s_add_u32 m0, s95, 0
    s_nop 0
    buffer_load_dwordx4 v24, s[28:31], s93 offen offset:0 lds
    v_lshlrev_b32 v112, 16, v41
    v_and_b32 v41, s8, v41
    v_lshlrev_b32 v116, 16, v49
    v_and_b32 v49, s8, v49
    v_mul_f32 v113, v112, v73
    v_mul_f32 v114, v41, v65
    v_fmac_f32 v90, v112, v72
    buffer_load_dwordx4 v25, s[28:31], s93 offen offset:1024 lds
    v_mul_f32 v117, v116, v73
    v_mul_f32 v118, v49, v65
    v_fmac_f32 v92, v116, v72
    v_cvt_pk_bf16_f32 v113, 0, v113
    v_cvt_pk_bf16_f32 v114, 0, v114
    v_fmac_f32 v90, v41, v57
    v_cvt_pk_bf16_f32 v117, 0, v117
    buffer_load_dwordx4 v26, s[28:31], s93 offen offset:2048 lds
    v_cvt_pk_bf16_f32 v118, 0, v118
    v_fmac_f32 v92, v49, v57
    v_add_f32 v91, v91, v113
    v_add_f32 v93, v93, v117
    v_add_f32 v91, v91, v114
    v_add_f32 v93, v93, v118
    v_lshlrev_b32 v72, 16, v58
    s_add_u32 m0, s95, 3072
    s_nop 0
    buffer_load_dwordx4 v27, s[28:31], s93 offen offset:0 lds
    v_and_b32 v58, s8, v58
    v_lshlrev_b32 v73, 16, v66
    v_and_b32 v66, s8, v66
    v_lshlrev_b32 v112, 16, v42
    v_and_b32 v42, s8, v42
    v_lshlrev_b32 v116, 16, v50
    v_and_b32 v50, s8, v50
    buffer_load_dwordx4 v28, s[28:31], s93 offen offset:1024 lds
    v_mul_f32 v113, v112, v73
    v_mul_f32 v114, v42, v66
    v_fmac_f32 v90, v112, v72
    v_mul_f32 v117, v116, v73
    v_mul_f32 v118, v50, v66
    v_fmac_f32 v92, v116, v72
    v_cvt_pk_bf16_f32 v113, 0, v113
    buffer_load_dwordx4 v29, s[28:31], s93 offen offset:2048 lds
    v_cvt_pk_bf16_f32 v114, 0, v114
    v_fmac_f32 v90, v42, v58
    v_cvt_pk_bf16_f32 v117, 0, v117
    v_cvt_pk_bf16_f32 v118, 0, v118
    v_fmac_f32 v92, v50, v58
    v_add_f32 v91, v91, v113
    v_add_f32 v93, v93, v117
    s_cmp_lg_u32 s21, 0
    s_cbranch_scc1 L_noclr_1
    v_mov_b32 v104, -1
    v_mov_b32 v105, -1
    v_mov_b32 v106, -1
    v_mov_b32 v107, -1
    s_lshl_b32 s12, s19, 13
    s_lshl_b32 s13, s18, 9
    s_add_u32 s12, s12, s13
    s_add_u32 s12, s12, 32768
    s_lshl_b32 s13, s19, 11
    s_lshl_b32 s90, s18, 7
    s_add_u32 s13, s13, s90
    s_add_u32 s13, s13, 163840
    s_mov_b32 exec_hi, 0
    buffer_store_dwordx4 v[104:107], v5, s[32:35], s12 offen sc1
    s_mov_b32 exec_lo, 255
    buffer_store_dwordx4 v[104:107], v5, s[32:35], s13 offen sc1
    s_mov_b64 exec, -1
L_noclr_1:
    s_cmp_ge_u32 s10, 224
    s_cbranch_scc1 L_p30_1
    s_add_u32 s12, s71, 0
    buffer_load_dwordx4 v[128:131], v30, s[40:43], s12 offen nt
    s_add_u32 s12, s71, 7168
    buffer_load_dwordx4 v[132:135], v30, s[40:43], s12 offen nt
    s_add_u32 s12, s71, 14336
    buffer_load_dwordx4 v[136:139], v30, s[40:43], s12 offen nt
    s_add_u32 s12, s71, 21504
    buffer_load_dwordx4 v[140:143], v30, s[40:43], s12 offen nt
    s_add_u32 s12, s71, 28672
    buffer_load_dwordx4 v[144:147], v30, s[40:43], s12 offen nt
    s_add_u32 s12, s71, 35840
    buffer_load_dwordx4 v[148:151], v30, s[40:43], s12 offen nt
    s_add_u32 s12, s71, 43008
    buffer_load_dwordx4 v[152:155], v30, s[40:43], s12 offen nt
    s_add_u32 s12, s71, 50176
    buffer_load_dwordx4 v[156:159], v30, s[40:43], s12 offen nt
    s_branch L_p3e0_1
L_p30_1:
    s_mov_b64 exec, 63
    s_bfe_u32 s12, s68, 0x4000c
    s_mul_i32 s12, s12, 393216
    buffer_load_dword v128, v32, s[28:31], s12 offen
    s_bfe_u32 s12, s68, 0x40010
    s_mul_i32 s12, s12, 393216
    buffer_load_dword v132, v32, s[28:31], s12 offen
    s_bfe_u32 s12, s68, 0x40014
    s_mul_i32 s12, s12, 393216
    buffer_load_dword v136, v32, s[28:31], s12 offen
    s_bfe_u32 s12, s68, 0x40018
    s_mul_i32 s12, s12, 393216
    buffer_load_dword v140, v32, s[28:31], s12 offen
    s_bfe_u32 s12, s68, 0x4001c
    s_mul_i32 s12, s12, 393216
    buffer_load_dword v144, v32, s[28:31], s12 offen
    s_bfe_u32 s12, s69, 0x40000
    s_mul_i32 s12, s12, 393216
    buffer_load_dword v148, v32, s[28:31], s12 offen
    s_bfe_u32 s12, s69, 0x40004
    s_mul_i32 s12, s12, 393216
    buffer_load_dword v152, v32, s[28:31], s12 offen
    s_bfe_u32 s12, s69, 0x40008
    s_mul_i32 s12, s12, 393216
    buffer_load_dword v156, v32, s[28:31], s12 offen
    s_mov_b64 exec, -1
L_p3e0_1:
    v_add_f32 v91, v91, v114
    v_add_f32 v93, v93, v118
    v_lshlrev_b32 v72, 16, v59
    v_and_b32 v59, s8, v59
    v_lshlrev_b32 v73, 16, v67
    v_and_b32 v67, s8, v67
    v_lshlrev_b32 v112, 16, v43
    v_and_b32 v43, s8, v43
    v_lshlrev_b32 v116, 16, v51
    v_and_b32 v51, s8, v51
    v_mul_f32 v113, v112, v73
    v_mul_f32 v114, v43, v67
    v_fmac_f32 v90, v112, v72
    v_mul_f32 v117, v116, v73
    v_mul_f32 v118, v51, v67
    v_fmac_f32 v92, v116, v72
    v_cvt_pk_bf16_f32 v113, 0, v113
    v_cvt_pk_bf16_f32 v114, 0, v114
    v_fmac_f32 v90, v43, v59
    v_cvt_pk_bf16_f32 v117, 0, v117
    v_cvt_pk_bf16_f32 v118, 0, v118
    v_fmac_f32 v92, v51, v59
    v_add_f32 v91, v91, v113
    v_add_f32 v93, v93, v117
    v_add_f32 v91, v91, v114
    s_barrier
    s_bfe_u32 s91, s68, 0x40010
    s_lshl_b32 s92, s91, 7
    s_mul_i32 s93, s91, 393216
    s_add_u32 m0, s94, 40960
    s_nop 0
    buffer_load_dwordx4 v20, s[24:27], s92 offen offset:0 lds
    v_add_f32 v93, v93, v118
    v_lshlrev_b32 v72, 16, v60
    v_and_b32 v60, s8, v60
    v_lshlrev_b32 v73, 16, v68
    v_and_b32 v68, s8, v68
    v_lshlrev_b32 v112, 16, v44
    v_and_b32 v44, s8, v44
    buffer_load_dwordx4 v21, s[24:27], s92 offen offset:1024 lds
    v_lshlrev_b32 v116, 16, v52
    v_and_b32 v52, s8, v52
    v_mul_f32 v113, v112, v73
    v_mul_f32 v114, v44, v68
    v_fmac_f32 v90, v112, v72
    v_mul_f32 v117, v116, v73
    v_mul_f32 v118, v52, v68
    buffer_load_dwordx4 v22, s[24:27], s92 offen offset:2048 lds
    v_fmac_f32 v92, v116, v72
    v_cvt_pk_bf16_f32 v113, 0, v113
    v_cvt_pk_bf16_f32 v114, 0, v114
    v_fmac_f32 v90, v44, v60
    v_cvt_pk_bf16_f32 v117, 0, v117
    v_cvt_pk_bf16_f32 v118, 0, v118
    v_fmac_f32 v92, v52, v60
    buffer_load_dwordx4 v23, s[24:27], s92 offen offset:3072 lds
    v_add_f32 v91, v91, v113
    v_add_f32 v93, v93, v117
    v_add_f32 v91, v91, v114
    v_add_f32 v93, v93, v118
    v_lshlrev_b32 v72, 16, v61
    v_and_b32 v61, s8, v61
    v_lshlrev_b32 v73, 16, v69
    s_add_u32 m0, s95, 40960
    s_nop 0
    buffer_load_dwordx4 v24, s[28:31], s93 offen offset:0 lds
    v_and_b32 v69, s8, v69
    v_lshlrev_b32 v112, 16, v45
    v_and_b32 v45, s8, v45
    v_lshlrev_b32 v116, 16, v53
    v_and_b32 v53, s8, v53
    v_mul_f32 v113, v112, v73
    v_mul_f32 v114, v45, v69
    buffer_load_dword v15, v13, s[72:75], 0 offen offset:4 sc1
    v_fmac_f32 v90, v112, v72
    v_mul_f32 v117, v116, v73
    v_mul_f32 v118, v53, v69
    v_fmac_f32 v92, v116, v72
    v_cvt_pk_bf16_f32 v113, 0, v113
    v_cvt_pk_bf16_f32 v114, 0, v114
    v_fmac_f32 v90, v45, v61
    v_cvt_pk_bf16_f32 v117, 0, v117
    v_cvt_pk_bf16_f32 v118, 0, v118
    v_fmac_f32 v92, v53, v61
    v_add_f32 v91, v91, v113
    v_add_f32 v93, v93, v117
    v_add_f32 v91, v91, v114
    v_add_f32 v93, v93, v118
    v_lshlrev_b32 v72, 16, v62
    v_and_b32 v62, s8, v62
    v_lshlrev_b32 v73, 16, v70
    v_and_b32 v70, s8, v70
    v_lshlrev_b32 v112, 16, v46
    v_and_b32 v46, s8, v46
    v_lshlrev_b32 v116, 16, v54
    v_and_b32 v54, s8, v54
    v_mul_f32 v113, v112, v73
    v_mul_f32 v114, v46, v70
    v_fmac_f32 v90, v112, v72
    s_waitcnt vmcnt(14)
    s_barrier
    s_add_u32 m0, s95, 40960
    s_nop 0
    buffer_load_dwordx4 v25, s[28:31], s93 offen offset:1024 lds
    v_mul_f32 v117, v116, v73
    v_mul_f32 v118, v54, v70
    v_fmac_f32 v92, v116, v72
    v_cvt_pk_bf16_f32 v113, 0, v113
    v_cvt_pk_bf16_f32 v114, 0, v114
    v_fmac_f32 v90, v46, v62
    v_cvt_pk_bf16_f32 v117, 0, v117
    buffer_load_dwordx4 v26, s[28:31], s93 offen offset:2048 lds
    v_cvt_pk_bf16_f32 v118, 0, v118
    v_fmac_f32 v92, v54, v62
    v_add_f32 v91, v91, v113
    v_add_f32 v93, v93, v117
    v_add_f32 v91, v91, v114
    v_add_f32 v93, v93, v118
    v_lshlrev_b32 v72, 16, v63
    s_add_u32 m0, s95, 44032
    s_nop 0
    buffer_load_dwordx4 v27, s[28:31], s93 offen offset:0 lds
    v_and_b32 v63, s8, v63
    v_lshlrev_b32 v73, 16, v71
    v_and_b32 v71, s8, v71
    v_lshlrev_b32 v112, 16, v47
    v_and_b32 v47, s8, v47
    v_lshlrev_b32 v116, 16, v55
    v_and_b32 v55, s8, v55
    buffer_load_dwordx4 v28, s[28:31], s93 offen offset:1024 lds
    v_mul_f32 v113, v112, v73
    v_mul_f32 v114, v47, v71
    v_fmac_f32 v90, v112, v72
    v_mul_f32 v117, v116, v73
    v_mul_f32 v118, v55, v71
    v_fmac_f32 v92, v116, v72
    v_cvt_pk_bf16_f32 v113, 0, v113
    buffer_load_dwordx4 v29, s[28:31], s93 offen offset:2048 lds
    v_cvt_pk_bf16_f32 v114, 0, v114
    v_fmac_f32 v90, v47, v63
    v_cvt_pk_bf16_f32 v117, 0, v117
    v_cvt_pk_bf16_f32 v118, 0, v118
    v_fmac_f32 v92, v55, v63
    v_add_f32 v91, v91, v113
    v_add_f32 v93, v93, v117
    s_bfe_u32 s91, s68, 0x40014
    s_lshl_b32 s92, s91, 7
    s_mul_i32 s93, s91, 393216
    s_add_u32 m0, s94, 81920
    s_nop 0
    buffer_load_dwordx4 v20, s[24:27], s92 offen offset:0 lds
    v_add_f32 v91, v91, v114
    v_add_f32 v93, v93, v118
    v_add_f32_dpp v90, v90, v90 row_shr:1 row_mask:0xf bank_mask:0xf
    v_add_f32_dpp v91, v91, v91 row_shr:1 row_mask:0xf bank_mask:0xf
    v_add_f32_dpp v92, v92, v92 row_shr:1 row_mask:0xf bank_mask:0xf
    v_add_f32_dpp v93, v93, v93 row_shr:1 row_mask:0xf bank_mask:0xf
    v_add_f32_dpp v90, v90, v90 row_shr:2 row_mask:0xf bank_mask:0xf
    buffer_load_dwordx4 v21, s[24:27], s92 offen offset:1024 lds
    v_add_f32_dpp v91, v91, v91 row_shr:2 row_mask:0xf bank_mask:0xf
    v_add_f32_dpp v92, v92, v92 row_shr:2 row_mask:0xf bank_mask:0xf
    v_add_f32_dpp v93, v93, v93 row_shr:2 row_mask:0xf bank_mask:0xf
    v_add_f32_dpp v90, v90, v90 row_shr:4 row_mask:0xf bank_mask:0xf
    v_add_f32_dpp v91, v91, v91 row_shr:4 row_mask:0xf bank_mask:0xf
    v_add_f32_dpp v92, v92, v92 row_shr:4 row_mask:0xf bank_mask:0xf
    v_add_f32_dpp v93, v93, v93 row_shr:4 row_mask:0xf bank_mask:0xf
    buffer_load_dwordx4 v22, s[24:27], s92 offen offset:2048 lds
    v_add_f32_dpp v90, v90, v90 row_shr:8 row_mask:0xf bank_mask:0xf
    v_add_f32_dpp v91, v91, v91 row_shr:8 row_mask:0xf bank_mask:0xf
    v_add_f32_dpp v92, v92, v92 row_shr:8 row_mask:0xf bank_mask:0xf
    v_add_f32_dpp v93, v93, v93 row_shr:8 row_mask:0xf bank_mask:0xf
    v_add_f32_dpp v90, v90, v90 row_bcast:15 row_mask:0xa bank_mask:0xf
    v_add_f32_dpp v91, v91, v91 row_bcast:15 row_mask:0xa bank_mask:0xf
    v_add_f32_dpp v92, v92, v92 row_bcast:15 row_mask:0xa bank_mask:0xf
    buffer_load_dwordx4 v23, s[24:27], s92 offen offset:3072 lds
    v_add_f32_dpp v93, v93, v93 row_bcast:15 row_mask:0xa bank_mask:0xf
    v_add_f32_dpp v90, v90, v90 row_bcast:31 row_mask:0xc bank_mask:0xf
    v_add_f32_dpp v91, v91, v91 row_bcast:31 row_mask:0xc bank_mask:0xf
    v_add_f32_dpp v92, v92, v92 row_bcast:31 row_mask:0xc bank_mask:0xf
    v_add_f32_dpp v93, v93, v93 row_bcast:31 row_mask:0xc bank_mask:0xf
    v_mov_b32 v97, 0x8000
    v_mov_b32 v98, 0xffff
    s_add_u32 m0, s95, 81920
    s_nop 0
    buffer_load_dwordx4 v24, s[28:31], s93 offen offset:0 lds
    v_cvt_pk_bf16_f32 v94, v90, v91
    v_cvt_pk_bf16_f32 v104, v92, v93
    v_and_b32 v95, 0xffff, v94
    v_and_b32 v96, 0x8000, v94
    v_and_b32 v94, 0xffff0000, v94
    v_cmp_ne_u32 vcc, 0, v96
    v_mul_f32 v94, 0xbfb8aa3b, v94
    buffer_load_dwordx4 v25, s[28:31], s93 offen offset:1024 lds
    v_exp_f32 v94, v94
    v_cndmask_b32 v96, v97, v98, vcc
    v_xor_b32 v95, v95, v96
    v_add_f32 v94, 1.0, v94
    v_lshlrev_b32 v95, 11, v95
    v_rcp_f32 v94, v94
    s_sub_u32 s12, 2047, s22
    v_or_b32 v100, s12, v95
    buffer_load_dwordx4 v26, s[28:31], s93 offen offset:2048 lds
    v_cvt_pk_bf16_f32 v94, v94, v94
    v_lshlrev_b32 v102, 16, v94
    v_and_b32 v105, 0xffff, v104
    v_and_b32 v106, 0x8000, v104
    v_and_b32 v104, 0xffff0000, v104
    v_cmp_ne_u32 vcc, 0, v106
    v_mul_f32 v104, 0xbfb8aa3b, v104
    v_exp_f32 v104, v104
    v_cndmask_b32 v106, v97, v98, vcc
    v_xor_b32 v105, v105, v106
    v_add_f32 v104, 1.0, v104
    v_lshlrev_b32 v105, 11, v105
    v_rcp_f32 v104, v104
    s_sub_u32 s12, 2046, s22
    v_or_b32 v101, s12, v105
    v_cvt_pk_bf16_f32 v104, v104, v104
    v_lshlrev_b32 v103, 16, v104
    v_max_u32 v100, v100, v101
    s_lshl_b32 s12, s22, 2
    s_add_u32 s12, s12, 4096
    s_lshl_b32 s13, s21, 2
    s_add_u32 s13, s13, 162880
    v_mov_b32 v14, s13
    s_mov_b32 exec_lo, 0
    s_mov_b32 exec_hi, 0x80000000
    buffer_store_dwordx2 v[102:103], v13, s[32:35], s12 offen sc1
    ds_write_b32 v14, v100
    s_mov_b64 exec, -1
    s_waitcnt lgkmcnt(0)
    s_waitcnt vmcnt(8)
    s_barrier
    s_add_u32 m0, s95, 84992
    s_nop 0
    buffer_load_dwordx4 v27, s[28:31], s93 offen offset:0 lds
    buffer_load_dwordx4 v28, s[28:31], s93 offen offset:1024 lds
    buffer_load_dwordx4 v29, s[28:31], s93 offen offset:2048 lds
    s_bfe_u32 s91, s68, 0x40018
    s_lshl_b32 s92, s91, 7
    s_mul_i32 s93, s91, 393216
    s_add_u32 m0, s94, 0
    s_nop 0
    buffer_load_dwordx4 v20, s[24:27], s92 offen offset:0 lds
    buffer_load_dwordx4 v21, s[24:27], s92 offen offset:1024 lds
    buffer_load_dwordx4 v22, s[24:27], s92 offen offset:2048 lds
    buffer_load_dwordx4 v23, s[24:27], s92 offen offset:3072 lds
    s_add_u32 m0, s95, 0
    s_nop 0
    buffer_load_dwordx4 v24, s[28:31], s93 offen offset:0 lds
    buffer_load_dwordx4 v25, s[28:31], s93 offen offset:1024 lds
    buffer_load_dwordx4 v26, s[28:31], s93 offen offset:2048 lds
    s_add_u32 m0, s95, 3072
    s_nop 0
    buffer_load_dwordx4 v27, s[28:31], s93 offen offset:0 lds
    buffer_load_dwordx4 v28, s[28:31], s93 offen offset:1024 lds
    s_waitcnt vmcnt(12)
    s_waitcnt vmcnt(9)
    s_barrier
    s_add_u32 m0, s95, 3072
    s_nop 0
    buffer_load_dwordx4 v29, s[28:31], s93 offen offset:2048 lds
    s_bfe_u32 s91, s68, 0x4001c
    s_lshl_b32 s92, s91, 7
    s_mul_i32 s93, s91, 393216
    s_add_u32 m0, s94, 40960
    s_nop 0
    buffer_load_dwordx4 v20, s[24:27], s92 offen offset:0 lds
    buffer_load_dwordx4 v21, s[24:27], s92 offen offset:1024 lds
    buffer_load_dwordx4 v22, s[24:27], s92 offen offset:2048 lds
    buffer_load_dwordx4 v23, s[24:27], s92 offen offset:3072 lds
    s_add_u32 m0, s95, 40960
    s_nop 0
    buffer_load_dwordx4 v24, s[28:31], s93 offen offset:0 lds
    buffer_load_dwordx4 v25, s[28:31], s93 offen offset:1024 lds
    buffer_load_dwordx4 v26, s[28:31], s93 offen offset:2048 lds
    s_add_u32 m0, s95, 44032
    s_nop 0
    buffer_load_dwordx4 v27, s[28:31], s93 offen offset:0 lds
    buffer_load_dwordx4 v28, s[28:31], s93 offen offset:1024 lds
    buffer_load_dwordx4 v29, s[28:31], s93 offen offset:2048 lds
    s_mov_b32 s13, 0
L_tagchk_1:
    v_readfirstlane_b32 s23, v15
    s_nop 1
    s_cmp_lg_u32 s23, 0
    s_cbranch_scc1 L_tagok_1
    s_add_u32 s13, s13, 1
    s_cmp_ge_u32 s13, 16384
    s_cbranch_scc1 L_tagok_1
    buffer_load_dword v15, v13, s[72:75], 0 offen offset:4 sc1
    s_waitcnt vmcnt(0)
    s_branch L_tagchk_1
L_tagok_1:
    s_and_b32 s76, s23, 0xff
    s_bfe_u32 s77, s23, 0x80008
    s_bfe_u32 s78, s23, 0x80010
    s_lshr_b32 s79, s23, 24
    v_and_b32 v35, 3, v2
    v_lshlrev_b32 v35, 3, v35
    v_bfe_u32 v35, s23, v35, 8
    s_cmp_lg_u32 s21, 0
    s_cbranch_scc1 L_nopub_1
    v_mov_b32 v14, 162880
    ds_read_b128 v[104:107], v14
    s_lshl_b32 s12, s2, 3
    s_add_u32 s12, s12, 0
    s_waitcnt lgkmcnt(0)
    v_max3_u32 v104, v104, v105, v106
    v_max_u32 v104, v104, v107
    v_mov_b32 v105, s23
    s_mov_b64 exec, 1
    buffer_store_dwordx2 v[104:105], v13, s[32:35], s12 offen sc1
    s_mov_b64 exec, -1
L_nopub_1:
    s_waitcnt vmcnt(10)
    s_barrier
    s_bfe_u32 s91, s69, 0x40000
    s_lshl_b32 s92, s91, 7
    s_mul_i32 s93, s91, 393216
    s_add_u32 m0, s94, 81920
    s_nop 0
    buffer_load_dwordx4 v20, s[24:27], s92 offen offset:0 lds
    buffer_load_dwordx4 v21, s[24:27], s92 offen offset:1024 lds
    buffer_load_dwordx4 v22, s[24:27], s92 offen offset:2048 lds
    buffer_load_dwordx4 v23, s[24:27], s92 offen offset:3072 lds
    s_add_u32 m0, s95, 81920
    s_nop 0
    buffer_load_dwordx4 v24, s[28:31], s93 offen offset:0 lds
    buffer_load_dwordx4 v25, s[28:31], s93 offen offset:1024 lds
    buffer_load_dwordx4 v26, s[28:31], s93 offen offset:2048 lds
    s_add_u32 m0, s95, 84992
    s_nop 0
    buffer_load_dwordx4 v27, s[28:31], s93 offen offset:0 lds
    buffer_load_dwordx4 v28, s[28:31], s93 offen offset:1024 lds
    buffer_load_dwordx4 v29, s[28:31], s93 offen offset:2048 lds
    s_cmp_ge_u32 s10, 224
    s_cbranch_scc1 L_p31_1
    s_add_u32 s12, s9, 0
    buffer_load_dwordx4 v[160:163], v30, s[44:47], s12 offen nt
    s_add_u32 s12, s9, 7168
    buffer_load_dwordx4 v[164:167], v30, s[44:47], s12 offen nt
    s_add_u32 s12, s9, 14336
    buffer_load_dwordx4 v[168:171], v30, s[44:47], s12 offen nt
    s_add_u32 s12, s9, 21504
    buffer_load_dwordx4 v[172:175], v30, s[44:47], s12 offen nt
    s_add_u32 s12, s9, 28672
    buffer_load_dwordx4 v[176:179], v30, s[44:47], s12 offen nt
    s_add_u32 s12, s9, 35840
    buffer_load_dwordx4 v[180:183], v30, s[44:47], s12 offen nt
    s_add_u32 s12, s9, 43008
    buffer_load_dwordx4 v[184:187], v30, s[44:47], s12 offen nt
    s_add_u32 s12, s9, 50176
    buffer_load_dwordx4 v[188:191], v30, s[44:47], s12 offen nt
    s_branch L_p3e1_1
L_p31_1:
    s_mov_b64 exec, 63
    s_bfe_u32 s12, s69, 0x4000c
    s_mul_i32 s12, s12, 393216
    buffer_load_dword v160, v32, s[28:31], s12 offen
    s_bfe_u32 s12, s69, 0x40010
    s_mul_i32 s12, s12, 393216
    buffer_load_dword v164, v32, s[28:31], s12 offen
    s_bfe_u32 s12, s69, 0x40014
    s_mul_i32 s12, s12, 393216
    buffer_load_dword v168, v32, s[28:31], s12 offen
    s_bfe_u32 s12, s69, 0x40018
    s_mul_i32 s12, s12, 393216
    buffer_load_dword v172, v32, s[28:31], s12 offen
    s_bfe_u32 s12, s69, 0x4001c
    s_mul_i32 s12, s12, 393216
    buffer_load_dword v176, v32, s[28:31], s12 offen
    s_mov_b64 exec, 1
    s_bfe_u32 s12, s69, 0x4001c
    s_mul_i32 s12, s12, 393216
    buffer_load_dword v180, v32, s[28:31], s12 offen
    s_bfe_u32 s12, s69, 0x4001c
    s_mul_i32 s12, s12, 393216
    buffer_load_dword v184, v32, s[28:31], s12 offen
    s_bfe_u32 s12, s69, 0x4001c
    s_mul_i32 s12, s12, 393216
    buffer_load_dword v188, v32, s[28:31], s12 offen
    s_mov_b64 exec, -1
L_p3e1_1:
    s_mov_b32 exec_lo, 0xffff0000
    s_mov_b32 exec_hi, 0
    buffer_load_dword v19, v10, s[36:39], 0 offen
    s_mov_b64 exec, -1
    s_waitcnt vmcnt(19)
    s_barrier
    s_bfe_u32 s91, s69, 0x40004
    s_lshl_b32 s92, s91, 7
    s_mul_i32 s93, s91, 393216
    s_add_u32 m0, s94, 0
    s_nop 0
    buffer_load_dwordx4 v20, s[24:27], s92 offen offset:0 lds
    buffer_load_dwordx4 v21, s[24:27], s92 offen offset:1024 lds
    buffer_load_dwordx4 v22, s[24:27], s92 offen offset:2048 lds
    buffer_load_dwordx4 v23, s[24:27], s92 offen offset:3072 lds
    s_add_u32 m0, s95, 0
    s_nop 0
    buffer_load_dwordx4 v24, s[28:31], s93 offen offset:0 lds
    s_waitcnt vmcnt(14)
    s_barrier
    s_add_u32 m0, s95, 0
    s_nop 0
    buffer_load_dwordx4 v25, s[28:31], s93 offen offset:1024 lds
    buffer_load_dwordx4 v26, s[28:31], s93 offen offset:2048 lds
    s_add_u32 m0, s95, 3072
    s_nop 0
    buffer_load_dwordx4 v27, s[28:31], s93 offen offset:0 lds
    buffer_load_dwordx4 v28, s[28:31], s93 offen offset:1024 lds
    buffer_load_dwordx4 v29, s[28:31], s93 offen offset:2048 lds
    s_bfe_u32 s91, s69, 0x40008
    s_lshl_b32 s92, s91, 7
    s_mul_i32 s93, s91, 393216
    s_add_u32 m0, s94, 40960
    s_nop 0
    buffer_load_dwordx4 v20, s[24:27], s92 offen offset:0 lds
    buffer_load_dwordx4 v21, s[24:27], s92 offen offset:1024 lds
    buffer_load_dwordx4 v22, s[24:27], s92 offen offset:2048 lds
    buffer_load_dwordx4 v23, s[24:27], s92 offen offset:3072 lds
    s_add_u32 m0, s95, 40960
    s_nop 0
    buffer_load_dwordx4 v24, s[28:31], s93 offen offset:0 lds
    buffer_load_dwordx4 v25, s[28:31], s93 offen offset:1024 lds
    buffer_load_dwordx4 v26, s[28:31], s93 offen offset:2048 lds
    s_waitcnt vmcnt(7)
    s_barrier
    s_add_u32 m0, s95, 44032
    s_nop 0
    buffer_load_dwordx4 v27, s[28:31], s93 offen offset:0 lds
    buffer_load_dwordx4 v28, s[28:31], s93 offen offset:1024 lds
    buffer_load_dwordx4 v29, s[28:31], s93 offen offset:2048 lds
    s_bfe_u32 s91, s69, 0x4000c
    s_lshl_b32 s92, s91, 7
    s_mul_i32 s93, s91, 393216
    s_add_u32 m0, s94, 81920
    s_nop 0
    buffer_load_dwordx4 v20, s[24:27], s92 offen offset:0 lds
    buffer_load_dwordx4 v21, s[24:27], s92 offen offset:1024 lds
    buffer_load_dwordx4 v22, s[24:27], s92 offen offset:2048 lds
    buffer_load_dwordx4 v23, s[24:27], s92 offen offset:3072 lds
    s_add_u32 m0, s95, 81920
    s_nop 0
    buffer_load_dwordx4 v24, s[28:31], s93 offen offset:0 lds
    buffer_load_dwordx4 v25, s[28:31], s93 offen offset:1024 lds
    buffer_load_dwordx4 v26, s[28:31], s93 offen offset:2048 lds
    s_add_u32 m0, s95, 84992
    s_nop 0
    buffer_load_dwordx4 v27, s[28:31], s93 offen offset:0 lds
    buffer_load_dwordx4 v28, s[28:31], s93 offen offset:1024 lds
    s_mov_b32 s12, 0
    buffer_load_dwordx4 v[104:107], v5, s[32:35], s12 offen offset:0 sc1
    buffer_load_dwordx4 v[108:111], v5, s[32:35], s12 offen offset:1024 sc1
    s_waitcnt vmcnt(11)
    s_barrier
    s_add_u32 m0, s95, 84992
    s_nop 0
    buffer_load_dwordx4 v29, s[28:31], s93 offen offset:2048 lds
    s_bfe_u32 s91, s69, 0x40010
    s_lshl_b32 s92, s91, 7
    s_mul_i32 s93, s91, 393216
    s_add_u32 m0, s94, 0
    s_nop 0
    buffer_load_dwordx4 v20, s[24:27], s92 offen offset:0 lds
    buffer_load_dwordx4 v21, s[24:27], s92 offen offset:1024 lds
    buffer_load_dwordx4 v22, s[24:27], s92 offen offset:2048 lds
    buffer_load_dwordx4 v23, s[24:27], s92 offen offset:3072 lds
    s_add_u32 m0, s95, 0
    s_nop 0
    buffer_load_dwordx4 v24, s[28:31], s93 offen offset:0 lds
    buffer_load_dwordx4 v25, s[28:31], s93 offen offset:1024 lds
    buffer_load_dwordx4 v26, s[28:31], s93 offen offset:2048 lds
    s_add_u32 m0, s95, 3072
    s_nop 0
    buffer_load_dwordx4 v27, s[28:31], s93 offen offset:0 lds
    buffer_load_dwordx4 v28, s[28:31], s93 offen offset:1024 lds
    buffer_load_dwordx4 v29, s[28:31], s93 offen offset:2048 lds
    s_waitcnt vmcnt(10)
    s_barrier
    s_bfe_u32 s91, s69, 0x40014
    s_lshl_b32 s92, s91, 7
    s_mul_i32 s93, s91, 393216
    s_add_u32 m0, s94, 40960
    s_nop 0
    buffer_load_dwordx4 v20, s[24:27], s92 offen offset:0 lds
    s_mov_b32 s13, 0
    v_xor_b32 v105, s23, v105
    v_xor_b32 v107, s23, v107
    v_xor_b32 v109, s23, v109
    v_xor_b32 v111, s23, v111
    v_or3_b32 v105, v105, v107, v109
    v_or_b32 v105, v105, v111
    v_cmp_ne_u32 vcc, 0, v105
    s_cbranch_vccnz L_keyre_1
L_keyok_1:
    buffer_load_dwordx4 v21, s[24:27], s92 offen offset:1024 lds
    v_max3_u32 v104, v104, v106, v108
    v_max_u32 v104, v104, v110
    s_nop 1
    v_max_u32_dpp v104, v104, v104 row_shr:1 row_mask:0xf bank_mask:0xf
    s_nop 1
    v_max_u32_dpp v104, v104, v104 row_shr:2 row_mask:0xf bank_mask:0xf
    s_nop 1
    v_max_u32_dpp v104, v104, v104 row_shr:4 row_mask:0xf bank_mask:0xf
    s_nop 1
    v_max_u32_dpp v104, v104, v104 row_shr:8 row_mask:0xf bank_mask:0xf
    s_nop 1
    v_max_u32_dpp v104, v104, v104 row_bcast:15 row_mask:0xa bank_mask:0xf
    buffer_load_dwordx4 v22, s[24:27], s92 offen offset:2048 lds
    s_nop 0
    v_max_u32_dpp v104, v104, v104 row_bcast:31 row_mask:0xc bank_mask:0xf
    s_nop 0
    v_readlane_b32 s14, v104, 63
    s_nop 1
    s_and_b32 s15, s14, 2047
    s_sub_u32 s15, 2047, s15
    s_lshl_b32 s12, s15, 11
    s_lshl_b32 s13, s70, 1
    s_add_u32 s12, s12, s13
    buffer_load_dwordx4 v[36:39], v34, s[24:27], s12 offen
    s_lshr_b32 s12, s14, 11
    s_and_b32 s13, s12, 0x8000
    s_cmp_lg_u32 s13, 0
    s_mov_b32 s13, 0xffff
    s_cselect_b32 s13, 0x8000, s13
    s_xor_b32 s12, s12, s13
    s_lshl_b32 s12, s12, 16
    v_mov_b32 v105, s12
    buffer_load_dwordx4 v23, s[24:27], s92 offen offset:3072 lds
    v_mul_f32 v105, 0xbfb8aa3b, v105
    v_exp_f32 v105, v105
    s_nop 0
    v_add_f32 v105, 1.0, v105
    v_rcp_f32 v105, v105
    s_nop 0
    v_cvt_pk_bf16_f32 v105, v105, v105
    v_lshlrev_b32 v105, 16, v105
    s_add_u32 s12, s15, 1
    v_mov_b32 v104, s12
    s_add_u32 m0, s95, 40960
    s_nop 0
    buffer_load_dwordx4 v24, s[28:31], s93 offen offset:0 lds
    v_mov_b32 v106, s23
    v_readfirstlane_b32 s14, v105
    v_mov_b32 v14, 162864
    s_mov_b64 exec, 1
    ds_write_b96 v14, v[104:106]
    s_mov_b64 exec, -1
    s_waitcnt lgkmcnt(0)
    buffer_load_dwordx4 v25, s[28:31], s93 offen offset:1024 lds
    buffer_load_dwordx4 v26, s[28:31], s93 offen offset:2048 lds
    s_add_u32 m0, s95, 44032
    s_nop 0
    buffer_load_dwordx4 v27, s[28:31], s93 offen offset:0 lds
    buffer_load_dwordx4 v28, s[28:31], s93 offen offset:1024 lds
    buffer_load_dwordx4 v29, s[28:31], s93 offen offset:2048 lds
    s_add_u32 s12, s97, 0
    buffer_load_dwordx4 v[192:195], v31, s[64:67], s12 offen nt
    s_add_u32 s12, s97, 16384
    buffer_load_dwordx4 v[196:199], v31, s[64:67], s12 offen nt
    s_add_u32 s12, s97, 32768
    buffer_load_dwordx4 v[200:203], v31, s[64:67], s12 offen nt
    s_add_u32 s12, s97, 49152
    buffer_load_dwordx4 v[204:207], v31, s[64:67], s12 offen nt
    s_add_u32 s12, s97, 65536
    buffer_load_dwordx4 v[208:211], v31, s[64:67], s12 offen nt
    s_add_u32 s12, s97, 81920
    buffer_load_dwordx4 v[212:215], v31, s[64:67], s12 offen nt
    s_add_u32 s12, s97, 98304
    buffer_load_dwordx4 v[216:219], v31, s[64:67], s12 offen nt
    s_waitcnt vmcnt(18)
    s_barrier
    s_bfe_u32 s91, s69, 0x40018
    s_lshl_b32 s92, s91, 7
    s_mul_i32 s93, s91, 393216
    s_add_u32 m0, s94, 81920
    s_nop 0
    buffer_load_dwordx4 v20, s[24:27], s92 offen offset:0 lds
    s_waitcnt vmcnt(15)
    s_mov_b32 s8, 0xffff0000
    v_lshlrev_b32 v40, 16, v36
    v_and_b32 v41, s8, v36
    v_lshlrev_b32 v42, 16, v37
    v_and_b32 v43, s8, v37
    v_lshlrev_b32 v44, 16, v38
    buffer_load_dwordx4 v21, s[24:27], s92 offen offset:1024 lds
    v_and_b32 v45, s8, v38
    v_lshlrev_b32 v46, 16, v39
    v_and_b32 v47, s8, v39
    v_lshlrev_b32 v48, 16, v128
    v_lshlrev_b32 v49, 16, v129
    v_and_b32 v128, s8, v128
    v_and_b32 v129, s8, v129
    buffer_load_dwordx4 v22, s[24:27], s92 offen offset:2048 lds
    v_mul_f32 v220, v48, v40
    v_mul_f32 v222, v49, v40
    v_mul_f32 v221, v128, v40
    v_mul_f32 v223, v129, v40
    v_lshlrev_b32 v50, 16, v130
    v_lshlrev_b32 v51, 16, v131
    v_and_b32 v130, s8, v130
    buffer_load_dwordx4 v23, s[24:27], s92 offen offset:3072 lds
    v_and_b32 v131, s8, v131
    v_mul_f32 v224, v50, v40
    v_mul_f32 v226, v51, v40
    v_mul_f32 v225, v130, v40
    v_mul_f32 v227, v131, v40
    v_lshlrev_b32 v48, 16, v160
    v_lshlrev_b32 v49, 16, v161
    s_add_u32 m0, s95, 81920
    s_nop 0
    buffer_load_dwordx4 v24, s[28:31], s93 offen offset:0 lds
    v_and_b32 v160, s8, v160
    v_and_b32 v161, s8, v161
    v_mul_f32 v228, v48, v40
    v_mul_f32 v230, v49, v40
    v_mul_f32 v229, v160, v40
    v_mul_f32 v231, v161, v40
    v_lshlrev_b32 v50, 16, v162
    v_lshlrev_b32 v51, 16, v163
    v_and_b32 v162, s8, v162
    v_and_b32 v163, s8, v163
    v_mul_f32 v232, v50, v40
    v_mul_f32 v234, v51, v40
    v_mul_f32 v233, v162, v40
    v_mul_f32 v235, v163, v40
    v_lshlrev_b32 v48, 16, v132
    v_lshlrev_b32 v49, 16, v133
    v_and_b32 v132, s8, v132
    v_and_b32 v133, s8, v133
    v_fmac_f32 v220, v48, v41
    v_fmac_f32 v222, v49, v41
    v_fmac_f32 v221, v132, v41
    v_fmac_f32 v223, v133, v41
    v_lshlrev_b32 v50, 16, v134
    v_lshlrev_b32 v51, 16, v135
    v_and_b32 v134, s8, v134
    v_and_b32 v135, s8, v135
    v_fmac_f32 v224, v50, v41
    v_fmac_f32 v226, v51, v41
    v_fmac_f32 v225, v134, v41
    v_fmac_f32 v227, v135, v41
    v_lshlrev_b32 v48, 16, v164
    v_lshlrev_b32 v49, 16, v165
    s_waitcnt vmcnt(12)
    s_barrier
    s_add_u32 m0, s95, 81920
    s_nop 0
    buffer_load_dwordx4 v25, s[28:31], s93 offen offset:1024 lds
    v_and_b32 v164, s8, v164
    v_and_b32 v165, s8, v165
    v_fmac_f32 v228, v48, v41
    v_fmac_f32 v230, v49, v41
    v_fmac_f32 v229, v164, v41
    v_fmac_f32 v231, v165, v41
    v_lshlrev_b32 v50, 16, v166
    buffer_load_dwordx4 v26, s[28:31], s93 offen offset:2048 lds
    v_lshlrev_b32 v51, 16, v167
    v_and_b32 v166, s8, v166
    v_and_b32 v167, s8, v167
    v_fmac_f32 v232, v50, v41
    v_fmac_f32 v234, v51, v41
    v_fmac_f32 v233, v166, v41
    v_fmac_f32 v235, v167, v41
    s_add_u32 m0, s95, 84992
    s_nop 0
    buffer_load_dwordx4 v27, s[28:31], s93 offen offset:0 lds
    v_lshlrev_b32 v48, 16, v136
    v_lshlrev_b32 v49, 16, v137
    v_and_b32 v136, s8, v136
    v_and_b32 v137, s8, v137
    v_fmac_f32 v220, v48, v42
    v_fmac_f32 v222, v49, v42
    v_fmac_f32 v221, v136, v42
    buffer_load_dwordx4 v28, s[28:31], s93 offen offset:1024 lds
    v_fmac_f32 v223, v137, v42
    v_lshlrev_b32 v50, 16, v138
    v_lshlrev_b32 v51, 16, v139
    v_and_b32 v138, s8, v138
    v_and_b32 v139, s8, v139
    v_fmac_f32 v224, v50, v42
    v_fmac_f32 v226, v51, v42
    buffer_load_dwordx4 v29, s[28:31], s93 offen offset:2048 lds
    v_fmac_f32 v225, v138, v42
    v_fmac_f32 v227, v139, v42
    v_lshlrev_b32 v48, 16, v168
    v_lshlrev_b32 v49, 16, v169
    v_and_b32 v168, s8, v168
    v_and_b32 v169, s8, v169
    v_fmac_f32 v228, v48, v42
    s_bfe_u32 s91, s69, 0x4001c
    s_lshl_b32 s92, s91, 7
    s_mul_i32 s93, s91, 393216
    s_add_u32 m0, s94, 0
    s_nop 0
    buffer_load_dwordx4 v20, s[24:27], s92 offen offset:0 lds
    v_fmac_f32 v230, v49, v42
    v_fmac_f32 v229, v168, v42
    v_fmac_f32 v231, v169, v42
    v_lshlrev_b32 v50, 16, v170
    v_lshlrev_b32 v51, 16, v171
    v_and_b32 v170, s8, v170
    v_and_b32 v171, s8, v171
    buffer_load_dwordx4 v21, s[24:27], s92 offen offset:1024 lds
    v_fmac_f32 v232, v50, v42
    v_fmac_f32 v234, v51, v42
    v_fmac_f32 v233, v170, v42
    v_fmac_f32 v235, v171, v42
    v_lshlrev_b32 v48, 16, v140
    v_lshlrev_b32 v49, 16, v141
    v_and_b32 v140, s8, v140
    buffer_load_dwordx4 v22, s[24:27], s92 offen offset:2048 lds
    v_and_b32 v141, s8, v141
    v_fmac_f32 v220, v48, v43
    v_fmac_f32 v222, v49, v43
    v_fmac_f32 v221, v140, v43
    v_fmac_f32 v223, v141, v43
    v_lshlrev_b32 v50, 16, v142
    v_lshlrev_b32 v51, 16, v143
    buffer_load_dwordx4 v23, s[24:27], s92 offen offset:3072 lds
    v_and_b32 v142, s8, v142
    v_and_b32 v143, s8, v143
    v_fmac_f32 v224, v50, v43
    v_fmac_f32 v226, v51, v43
    v_fmac_f32 v225, v142, v43
    v_fmac_f32 v227, v143, v43
    v_lshlrev_b32 v48, 16, v172
    s_add_u32 m0, s95, 0
    s_nop 0
    buffer_load_dwordx4 v24, s[28:31], s93 offen offset:0 lds
    v_lshlrev_b32 v49, 16, v173
    v_and_b32 v172, s8, v172
    v_and_b32 v173, s8, v173
    v_fmac_f32 v228, v48, v43
    v_fmac_f32 v230, v49, v43
    v_fmac_f32 v229, v172, v43
    v_fmac_f32 v231, v173, v43
    buffer_load_dwordx4 v25, s[28:31], s93 offen offset:1024 lds
    v_lshlrev_b32 v50, 16, v174
    v_lshlrev_b32 v51, 16, v175
    v_and_b32 v174, s8, v174
    v_and_b32 v175, s8, v175
    v_fmac_f32 v232, v50, v43
    v_fmac_f32 v234, v51, v43
    v_fmac_f32 v233, v174, v43
    buffer_load_dwordx4 v26, s[28:31], s93 offen offset:2048 lds
    v_fmac_f32 v235, v175, v43
    v_lshlrev_b32 v48, 16, v144
    v_lshlrev_b32 v49, 16, v145
    v_and_b32 v144, s8, v144
    v_and_b32 v145, s8, v145
    v_fmac_f32 v220, v48, v44
    v_fmac_f32 v222, v49, v44
    v_fmac_f32 v221, v144, v44
    v_fmac_f32 v223, v145, v44
    v_lshlrev_b32 v50, 16, v146
    v_lshlrev_b32 v51, 16, v147
    v_and_b32 v146, s8, v146
    v_and_b32 v147, s8, v147
    v_fmac_f32 v224, v50, v44
    v_fmac_f32 v226, v51, v44
    v_fmac_f32 v225, v146, v44
    v_fmac_f32 v227, v147, v44
    v_lshlrev_b32 v48, 16, v176
    v_lshlrev_b32 v49, 16, v177
    v_and_b32 v176, s8, v176
    v_and_b32 v177, s8, v177
    v_fmac_f32 v228, v48, v44
    v_fmac_f32 v230, v49, v44
    v_fmac_f32 v229, v176, v44
    v_fmac_f32 v231, v177, v44
    v_lshlrev_b32 v50, 16, v178
    v_lshlrev_b32 v51, 16, v179
    v_and_b32 v178, s8, v178
    v_and_b32 v179, s8, v179
    v_fmac_f32 v232, v50, v44
    v_fmac_f32 v234, v51, v44
    v_fmac_f32 v233, v178, v44
    s_waitcnt vmcnt(7)
    s_barrier
    s_add_u32 m0, s95, 3072
    s_nop 0
    buffer_load_dwordx4 v27, s[28:31], s93 offen offset:0 lds
    v_fmac_f32 v235, v179, v44
    v_lshlrev_b32 v48, 16, v148
    v_lshlrev_b32 v49, 16, v149
    v_and_b32 v148, s8, v148
    v_and_b32 v149, s8, v149
    v_fmac_f32 v220, v48, v45
    v_fmac_f32 v222, v49, v45
    buffer_load_dwordx4 v28, s[28:31], s93 offen offset:1024 lds
    v_fmac_f32 v221, v148, v45
    v_fmac_f32 v223, v149, v45
    v_lshlrev_b32 v50, 16, v150
    v_lshlrev_b32 v51, 16, v151
    v_and_b32 v150, s8, v150
    v_and_b32 v151, s8, v151
    v_fmac_f32 v224, v50, v45
    buffer_load_dwordx4 v29, s[28:31], s93 offen offset:2048 lds
    v_fmac_f32 v226, v51, v45
    v_fmac_f32 v225, v150, v45
    v_fmac_f32 v227, v151, v45
    v_lshlrev_b32 v48, 16, v180
    v_lshlrev_b32 v49, 16, v181
    v_and_b32 v180, s8, v180
    v_and_b32 v181, s8, v181
    s_mul_i32 s12, s21, 8
    s_add_u32 s12, s12, 96
    s_lshl_b32 s13, s12, 10
    s_lshl_b32 s12, s12, 14
    s_add_u32 m0, s13, 24576
    s_add_u32 s90, s12, 0
    buffer_load_dwordx4 v33, s[36:39], s90 offen lds
    s_add_u32 m0, s13, 25600
    s_add_u32 s90, s12, 16384
    buffer_load_dwordx4 v33, s[36:39], s90 offen lds
    s_add_u32 m0, s13, 26624
    s_add_u32 s90, s12, 32768
    buffer_load_dwordx4 v33, s[36:39], s90 offen lds
    s_add_u32 m0, s13, 27648
    s_add_u32 s90, s12, 49152
    buffer_load_dwordx4 v33, s[36:39], s90 offen lds
    s_add_u32 m0, s13, 28672
    s_add_u32 s90, s12, 65536
    buffer_load_dwordx4 v33, s[36:39], s90 offen lds
    s_add_u32 m0, s13, 29696
    s_add_u32 s90, s12, 81920
    buffer_load_dwordx4 v33, s[36:39], s90 offen lds
    s_add_u32 m0, s13, 30720
    s_add_u32 s90, s12, 98304
    buffer_load_dwordx4 v33, s[36:39], s90 offen lds
    s_add_u32 m0, s13, 31744
    s_add_u32 s90, s12, 114688
    buffer_load_dwordx4 v33, s[36:39], s90 offen lds
    v_fmac_f32 v228, v48, v45
    v_fmac_f32 v230, v49, v45
    v_fmac_f32 v229, v180, v45
    v_fmac_f32 v231, v181, v45
    v_lshlrev_b32 v50, 16, v182
    v_lshlrev_b32 v51, 16, v183
    v_and_b32 v182, s8, v182
    v_and_b32 v183, s8, v183
    v_fmac_f32 v232, v50, v45
    v_fmac_f32 v234, v51, v45
    v_fmac_f32 v233, v182, v45
    v_fmac_f32 v235, v183, v45
    v_lshlrev_b32 v48, 16, v152
    v_lshlrev_b32 v49, 16, v153
    v_and_b32 v152, s8, v152
    v_and_b32 v153, s8, v153
    v_fmac_f32 v220, v48, v46
    v_fmac_f32 v222, v49, v46
    v_fmac_f32 v221, v152, v46
    v_fmac_f32 v223, v153, v46
    v_lshlrev_b32 v50, 16, v154
    v_lshlrev_b32 v51, 16, v155
    v_and_b32 v154, s8, v154
    v_and_b32 v155, s8, v155
    v_fmac_f32 v224, v50, v46
    s_waitcnt vmcnt(8)
    s_barrier
    v_fmac_f32 v226, v51, v46
    v_fmac_f32 v225, v154, v46
    v_fmac_f32 v227, v155, v46
    v_lshlrev_b32 v48, 16, v184
    v_lshlrev_b32 v49, 16, v185
    v_and_b32 v184, s8, v184
    v_and_b32 v185, s8, v185
    v_fmac_f32 v228, v48, v46
    v_fmac_f32 v230, v49, v46
    v_fmac_f32 v229, v184, v46
    v_fmac_f32 v231, v185, v46
    v_lshlrev_b32 v50, 16, v186
    v_lshlrev_b32 v51, 16, v187
    v_and_b32 v186, s8, v186
    v_and_b32 v187, s8, v187
    v_fmac_f32 v232, v50, v46
    v_fmac_f32 v234, v51, v46
    v_fmac_f32 v233, v186, v46
    v_fmac_f32 v235, v187, v46
    v_lshlrev_b32 v48, 16, v156
    v_lshlrev_b32 v49, 16, v157
    v_and_b32 v156, s8, v156
    v_and_b32 v157, s8, v157
    v_fmac_f32 v220, v48, v47
    v_fmac_f32 v222, v49, v47
    v_fmac_f32 v221, v156, v47
    v_fmac_f32 v223, v157, v47
    v_lshlrev_b32 v50, 16, v158
    v_lshlrev_b32 v51, 16, v159
    v_and_b32 v158, s8, v158
    v_and_b32 v159, s8, v159
    v_fmac_f32 v224, v50, v47
    v_fmac_f32 v226, v51, v47
    v_fmac_f32 v225, v158, v47
    v_fmac_f32 v227, v159, v47
    v_lshlrev_b32 v48, 16, v188
    v_lshlrev_b32 v49, 16, v189
    v_and_b32 v188, s8, v188
    v_and_b32 v189, s8, v189
    v_fmac_f32 v228, v48, v47
    v_fmac_f32 v230, v49, v47
    v_fmac_f32 v229, v188, v47
    v_fmac_f32 v231, v189, v47
    v_lshlrev_b32 v50, 16, v190
    v_lshlrev_b32 v51, 16, v191
    v_and_b32 v190, s8, v190
    v_and_b32 v191, s8, v191
    v_fmac_f32 v232, v50, v47
    v_fmac_f32 v234, v51, v47
    v_fmac_f32 v233, v190, v47
    v_fmac_f32 v235, v191, v47
    v_permlane32_swap_b32 v220, v228
    v_permlane32_swap_b32 v221, v229
    v_permlane32_swap_b32 v222, v230
    v_permlane32_swap_b32 v223, v231
    v_permlane32_swap_b32 v224, v232
    v_permlane32_swap_b32 v225, v233
    v_permlane32_swap_b32 v226, v234
    v_permlane32_swap_b32 v227, v235
    v_add_f32 v220, v220, v228
    v_add_f32 v221, v221, v229
    v_add_f32 v222, v222, v230
    v_add_f32 v223, v223, v231
    v_add_f32 v224, v224, v232
    v_add_f32 v225, v225, v233
    v_add_f32 v226, v226, v234
    v_add_f32 v227, v227, v235
    v_permlane16_swap_b32 v220, v224
    v_permlane16_swap_b32 v221, v225
    v_permlane16_swap_b32 v222, v226
    v_permlane16_swap_b32 v223, v227
    v_add_f32 v220, v220, v224
    v_add_f32 v221, v221, v225
    v_add_f32 v222, v222, v226
    v_add_f32 v223, v223, v227
    v_add_f32_dpp v220, v220, v220 row_ror:8 row_mask:0xf bank_mask:0xf
    v_add_f32_dpp v221, v221, v221 row_ror:8 row_mask:0xf bank_mask:0xf
    v_add_f32_dpp v222, v222, v222 row_ror:8 row_mask:0xf bank_mask:0xf
    v_add_f32_dpp v223, v223, v223 row_ror:8 row_mask:0xf bank_mask:0xf
    s_branch L_varend
L_var2:
    s_nop 0
    s_add_u32 m0, s95, 40960
    s_nop 0
    buffer_load_dwordx4 v26, s[28:31], s93 offen offset:2048 lds
    s_add_u32 m0, s95, 44032
    s_nop 0
    buffer_load_dwordx4 v27, s[28:31], s93 offen offset:0 lds
    buffer_load_dwordx4 v28, s[28:31], s93 offen offset:1024 lds
    buffer_load_dwordx4 v29, s[28:31], s93 offen offset:2048 lds
    s_bfe_u32 s91, s68, 0x40008
    s_lshl_b32 s92, s91, 7
    s_mul_i32 s93, s91, 393216
    s_add_u32 m0, s94, 81920
    s_nop 0
    buffer_load_dwordx4 v20, s[24:27], s92 offen offset:0 lds
    buffer_load_dwordx4 v21, s[24:27], s92 offen offset:1024 lds
    buffer_load_dwordx4 v22, s[24:27], s92 offen offset:2048 lds
    buffer_load_dwordx4 v23, s[24:27], s92 offen offset:3072 lds
    s_add_u32 m0, s95, 81920
    s_nop 0
    buffer_load_dwordx4 v24, s[28:31], s93 offen offset:0 lds
    buffer_load_dwordx4 v25, s[28:31], s93 offen offset:1024 lds
    buffer_load_dwordx4 v26, s[28:31], s93 offen offset:2048 lds
    s_add_u32 m0, s95, 84992
    s_nop 0
    buffer_load_dwordx4 v27, s[28:31], s93 offen offset:0 lds
    buffer_load_dwordx4 v28, s[28:31], s93 offen offset:1024 lds
    buffer_load_dwordx4 v29, s[28:31], s93 offen offset:2048 lds
    s_lshl_b32 s12, s19, 2
    s_add_u32 s12, s12, s21
    s_lshl_b32 s12, s12, 10
    s_lshl_b32 s13, s21, 10
    s_add_u32 m0, s13, 155648
    s_nop 0
    buffer_load_dwordx4 v5, s[76:79], s12 offen lds
    s_lshl_b32 s12, s22, 11
    buffer_load_dwordx4 v[40:43], v5, s[24:27], s12 offen offset:0
    buffer_load_dwordx4 v[44:47], v5, s[24:27], s12 offen offset:1024
    buffer_load_dwordx4 v[48:51], v5, s[24:27], s12 offen offset:2048
    buffer_load_dwordx4 v[52:55], v5, s[24:27], s12 offen offset:3072
    buffer_load_dwordx4 v[56:59], v5, s[80:83], 0 offen offset:0
    buffer_load_dwordx4 v[60:63], v5, s[80:83], 0 offen offset:1024
    buffer_load_dwordx4 v[64:67], v5, s[84:87], 0 offen offset:0
    buffer_load_dwordx4 v[68:71], v5, s[84:87], 0 offen offset:1024
    s_waitcnt vmcnt(19)
    s_barrier
    s_bfe_u32 s91, s68, 0x4000c
    s_lshl_b32 s92, s91, 7
    s_mul_i32 s93, s91, 393216
    s_add_u32 m0, s94, 0
    s_nop 0
    buffer_load_dwordx4 v20, s[24:27], s92 offen offset:0 lds
    s_waitcnt vmcnt(1)
    s_mov_b32 s8, 0xffff0000
    v_lshlrev_b32 v72, 16, v56
    v_and_b32 v56, s8, v56
    v_lshlrev_b32 v73, 16, v64
    v_and_b32 v64, s8, v64
    v_lshlrev_b32 v112, 16, v40
    buffer_load_dwordx4 v21, s[24:27], s92 offen offset:1024 lds
    v_and_b32 v40, s8, v40
    v_lshlrev_b32 v116, 16, v48
    v_and_b32 v48, s8, v48
    v_mul_f32 v113, v112, v73
    v_mul_f32 v114, v40, v64
    v_mul_f32 v90, v112, v72
    v_mul_f32 v117, v116, v73
    buffer_load_dwordx4 v22, s[24:27], s92 offen offset:2048 lds
    v_mul_f32 v118, v48, v64
    v_mul_f32 v92, v116, v72
    v_cvt_pk_bf16_f32 v113, 0, v113
    v_cvt_pk_bf16_f32 v114, 0, v114
    v_fmac_f32 v90, v40, v56
    v_cvt_pk_bf16_f32 v117, 0, v117
    v_cvt_pk_bf16_f32 v118, 0, v118
    buffer_load_dwordx4 v23, s[24:27], s92 offen offset:3072 lds
    v_fmac_f32 v92, v48, v56
    v_add_f32 v91, v113, v114
    v_add_f32 v93, v117, v118
    v_lshlrev_b32 v72, 16, v57
    v_and_b32 v57, s8, v57
    v_lshlrev_b32 v73, 16, v65
    v_and_b32 v65, s8, v65
    s_add_u32 m0, s95, 0
    s_nop 0
    buffer_load_dwordx4 v24, s[28:31], s93 offen offset:0 lds
    v_lshlrev_b32 v112, 16, v41
    v_and_b32 v41, s8, v41
    v_lshlrev_b32 v116, 16, v49
    v_and_b32 v49, s8, v49
    v_mul_f32 v113, v112, v73
    v_mul_f32 v114, v41, v65
    v_fmac_f32 v90, v112, v72
    buffer_load_dwordx4 v25, s[28:31], s93 offen offset:1024 lds
    v_mul_f32 v117, v116, v73
    v_mul_f32 v118, v49, v65
    v_fmac_f32 v92, v116, v72
    v_cvt_pk_bf16_f32 v113, 0, v113
    v_cvt_pk_bf16_f32 v114, 0, v114
    v_fmac_f32 v90, v41, v57
    v_cvt_pk_bf16_f32 v117, 0, v117
    buffer_load_dwordx4 v26, s[28:31], s93 offen offset:2048 lds
    v_cvt_pk_bf16_f32 v118, 0, v118
    v_fmac_f32 v92, v49, v57
    v_add_f32 v91, v91, v113
    v_add_f32 v93, v93, v117
    v_add_f32 v91, v91, v114
    v_add_f32 v93, v93, v118
    v_lshlrev_b32 v72, 16, v58
    s_add_u32 m0, s95, 3072
    s_nop 0
    buffer_load_dwordx4 v27, s[28:31], s93 offen offset:0 lds
    v_and_b32 v58, s8, v58
    v_lshlrev_b32 v73, 16, v66
    v_and_b32 v66, s8, v66
    v_lshlrev_b32 v112, 16, v42
    v_and_b32 v42, s8, v42
    v_lshlrev_b32 v116, 16, v50
    v_and_b32 v50, s8, v50
    buffer_load_dwordx4 v28, s[28:31], s93 offen offset:1024 lds
    v_mul_f32 v113, v112, v73
    v_mul_f32 v114, v42, v66
    v_fmac_f32 v90, v112, v72
    v_mul_f32 v117, v116, v73
    v_mul_f32 v118, v50, v66
    v_fmac_f32 v92, v116, v72
    v_cvt_pk_bf16_f32 v113, 0, v113
    buffer_load_dwordx4 v29, s[28:31], s93 offen offset:2048 lds
    v_cvt_pk_bf16_f32 v114, 0, v114
    v_fmac_f32 v90, v42, v58
    v_cvt_pk_bf16_f32 v117, 0, v117
    v_cvt_pk_bf16_f32 v118, 0, v118
    v_fmac_f32 v92, v50, v58
    v_add_f32 v91, v91, v113
    v_add_f32 v93, v93, v117
    s_cmp_lg_u32 s21, 0
    s_cbranch_scc1 L_noclr_2
    v_mov_b32 v104, -1
    v_mov_b32 v105, -1
    v_mov_b32 v106, -1
    v_mov_b32 v107, -1
    s_lshl_b32 s12, s19, 13
    s_lshl_b32 s13, s18, 9
    s_add_u32 s12, s12, s13
    s_add_u32 s12, s12, 32768
    s_lshl_b32 s13, s19, 11
    s_lshl_b32 s90, s18, 7
    s_add_u32 s13, s13, s90
    s_add_u32 s13, s13, 163840
    s_mov_b32 exec_hi, 0
    buffer_store_dwordx4 v[104:107], v5, s[32:35], s12 offen sc1
    s_mov_b32 exec_lo, 255
    buffer_store_dwordx4 v[104:107], v5, s[32:35], s13 offen sc1
    s_mov_b64 exec, -1
L_noclr_2:
    v_add_f32 v91, v91, v114
    v_add_f32 v93, v93, v118
    v_lshlrev_b32 v72, 16, v59
    v_and_b32 v59, s8, v59
    v_lshlrev_b32 v73, 16, v67
    v_and_b32 v67, s8, v67
    v_lshlrev_b32 v112, 16, v43
    v_and_b32 v43, s8, v43
    v_lshlrev_b32 v116, 16, v51
    v_and_b32 v51, s8, v51
    v_mul_f32 v113, v112, v73
    v_mul_f32 v114, v43, v67
    v_fmac_f32 v90, v112, v72
    v_mul_f32 v117, v116, v73
    v_mul_f32 v118, v51, v67
    v_fmac_f32 v92, v116, v72
    v_cvt_pk_bf16_f32 v113, 0, v113
    v_cvt_pk_bf16_f32 v114, 0, v114
    v_fmac_f32 v90, v43, v59
    v_cvt_pk_bf16_f32 v117, 0, v117
    v_cvt_pk_bf16_f32 v118, 0, v118
    v_fmac_f32 v92, v51, v59
    v_add_f32 v91, v91, v113
    v_add_f32 v93, v93, v117
    v_add_f32 v91, v91, v114
    s_barrier
    s_bfe_u32 s91, s68, 0x40010
    s_lshl_b32 s92, s91, 7
    s_mul_i32 s93, s91, 393216
    s_add_u32 m0, s94, 40960
    s_nop 0
    buffer_load_dwordx4 v20, s[24:27], s92 offen offset:0 lds
    v_add_f32 v93, v93, v118
    v_lshlrev_b32 v72, 16, v60
    v_and_b32 v60, s8, v60
    v_lshlrev_b32 v73, 16, v68
    v_and_b32 v68, s8, v68
    v_lshlrev_b32 v112, 16, v44
    v_and_b32 v44, s8, v44
    buffer_load_dwordx4 v21, s[24:27], s92 offen offset:1024 lds
    v_lshlrev_b32 v116, 16, v52
    v_and_b32 v52, s8, v52
    v_mul_f32 v113, v112, v73
    v_mul_f32 v114, v44, v68
    v_fmac_f32 v90, v112, v72
    v_mul_f32 v117, v116, v73
    v_mul_f32 v118, v52, v68
    buffer_load_dwordx4 v22, s[24:27], s92 offen offset:2048 lds
    v_fmac_f32 v92, v116, v72
    v_cvt_pk_bf16_f32 v113, 0, v113
    v_cvt_pk_bf16_f32 v114, 0, v114
    v_fmac_f32 v90, v44, v60
    v_cvt_pk_bf16_f32 v117, 0, v117
    v_cvt_pk_bf16_f32 v118, 0, v118
    v_fmac_f32 v92, v52, v60
    buffer_load_dwordx4 v23, s[24:27], s92 offen offset:3072 lds
    v_add_f32 v91, v91, v113
    v_add_f32 v93, v93, v117
    v_add_f32 v91, v91, v114
    v_add_f32 v93, v93, v118
    v_lshlrev_b32 v72, 16, v61
    v_and_b32 v61, s8, v61
    v_lshlrev_b32 v73, 16, v69
    s_add_u32 m0, s95, 40960
    s_nop 0
    buffer_load_dwordx4 v24, s[28:31], s93 offen offset:0 lds
    v_and_b32 v69, s8, v69
    v_lshlrev_b32 v112, 16, v45
    v_and_b32 v45, s8, v45
    v_lshlrev_b32 v116, 16, v53
    v_and_b32 v53, s8, v53
    v_mul_f32 v113, v112, v73
    v_mul_f32 v114, v45, v69
    buffer_load_dwordx4 v25, s[28:31], s93 offen offset:1024 lds
    v_fmac_f32 v90, v112, v72
    v_mul_f32 v117, v116, v73
    v_mul_f32 v118, v53, v69
    v_fmac_f32 v92, v116, v72
    v_cvt_pk_bf16_f32 v113, 0, v113
    v_cvt_pk_bf16_f32 v114, 0, v114
    v_fmac_f32 v90, v45, v61
    buffer_load_dwordx4 v26, s[28:31], s93 offen offset:2048 lds
    v_cvt_pk_bf16_f32 v117, 0, v117
    v_cvt_pk_bf16_f32 v118, 0, v118
    v_fmac_f32 v92, v53, v61
    v_add_f32 v91, v91, v113
    v_add_f32 v93, v93, v117
    v_add_f32 v91, v91, v114
    v_add_f32 v93, v93, v118
    s_add_u32 m0, s95, 44032
    s_nop 0
    buffer_load_dwordx4 v27, s[28:31], s93 offen offset:0 lds
    v_lshlrev_b32 v72, 16, v62
    v_and_b32 v62, s8, v62
    v_lshlrev_b32 v73, 16, v70
    v_and_b32 v70, s8, v70
    v_lshlrev_b32 v112, 16, v46
    v_and_b32 v46, s8, v46
    v_lshlrev_b32 v116, 16, v54
    buffer_load_dwordx4 v28, s[28:31], s93 offen offset:1024 lds
    v_and_b32 v54, s8, v54
    v_mul_f32 v113, v112, v73
    v_mul_f32 v114, v46, v70
    v_fmac_f32 v90, v112, v72
    v_mul_f32 v117, v116, v73
    v_mul_f32 v118, v54, v70
    v_fmac_f32 v92, v116, v72
    buffer_load_dwordx4 v29, s[28:31], s93 offen offset:2048 lds
    v_cvt_pk_bf16_f32 v113, 0, v113
    v_cvt_pk_bf16_f32 v114, 0, v114
    v_fmac_f32 v90, v46, v62
    v_cvt_pk_bf16_f32 v117, 0, v117
    v_cvt_pk_bf16_f32 v118, 0, v118
    v_fmac_f32 v92, v54, v62
    v_add_f32 v91, v91, v113
    s_cmp_ge_u32 s10, 224
    s_cbranch_scc1 L_p30_2
    s_add_u32 s12, s71, 0
    buffer_load_dwordx4 v[128:131], v30, s[40:43], s12 offen nt
    s_add_u32 s12, s71, 7168
    buffer_load_dwordx4 v[132:135], v30, s[40:43], s12 offen nt
    s_add_u32 s12, s71, 14336
    buffer_load_dwordx4 v[136:139], v30, s[40:43], s12 offen nt
    s_add_u32 s12, s71, 21504
    buffer_load_dwordx4 v[140:143], v30, s[40:43], s12 offen nt
    s_add_u32 s12, s71, 28672
    buffer_load_dwordx4 v[144:147], v30, s[40:43], s12 offen nt
    s_add_u32 s12, s71, 35840
    buffer_load_dwordx4 v[148:151], v30, s[40:43], s12 offen nt
    s_add_u32 s12, s71, 43008
    buffer_load_dwordx4 v[152:155], v30, s[40:43], s12 offen nt
    s_add_u32 s12, s71, 50176
    buffer_load_dwordx4 v[156:159], v30, s[40:43], s12 offen nt
    s_branch L_p3e0_2
L_p30_2:
    s_mov_b64 exec, 63
    s_bfe_u32 s12, s68, 0x4000c
    s_mul_i32 s12, s12, 393216
    buffer_load_dword v128, v32, s[28:31], s12 offen
    s_bfe_u32 s12, s68, 0x40010
    s_mul_i32 s12, s12, 393216
    buffer_load_dword v132, v32, s[28:31], s12 offen
    s_bfe_u32 s12, s68, 0x40014
    s_mul_i32 s12, s12, 393216
    buffer_load_dword v136, v32, s[28:31], s12 offen
    s_bfe_u32 s12, s68, 0x40018
    s_mul_i32 s12, s12, 393216
    buffer_load_dword v140, v32, s[28:31], s12 offen
    s_bfe_u32 s12, s68, 0x4001c
    s_mul_i32 s12, s12, 393216
    buffer_load_dword v144, v32, s[28:31], s12 offen
    s_bfe_u32 s12, s69, 0x40000
    s_mul_i32 s12, s12, 393216
    buffer_load_dword v148, v32, s[28:31], s12 offen
    s_bfe_u32 s12, s69, 0x40004
    s_mul_i32 s12, s12, 393216
    buffer_load_dword v152, v32, s[28:31], s12 offen
    s_bfe_u32 s12, s69, 0x40008
    s_mul_i32 s12, s12, 393216
    buffer_load_dword v156, v32, s[28:31], s12 offen
    s_mov_b64 exec, -1
L_p3e0_2:
    buffer_load_dword v15, v13, s[72:75], 0 offen offset:4 sc1
    v_add_f32 v93, v93, v117
    v_add_f32 v91, v91, v114
    v_add_f32 v93, v93, v118
    v_lshlrev_b32 v72, 16, v63
    v_and_b32 v63, s8, v63
    v_lshlrev_b32 v73, 16, v71
    v_and_b32 v71, s8, v71
    v_lshlrev_b32 v112, 16, v47
    v_and_b32 v47, s8, v47
    v_lshlrev_b32 v116, 16, v55
    v_and_b32 v55, s8, v55
    v_mul_f32 v113, v112, v73
    v_mul_f32 v114, v47, v71
    v_fmac_f32 v90, v112, v72
    v_mul_f32 v117, v116, v73
    v_mul_f32 v118, v55, v71
    v_fmac_f32 v92, v116, v72
    v_cvt_pk_bf16_f32 v113, 0, v113
    v_cvt_pk_bf16_f32 v114, 0, v114
    v_fmac_f32 v90, v47, v63
    v_cvt_pk_bf16_f32 v117, 0, v117
    v_cvt_pk_bf16_f32 v118, 0, v118
    v_fmac_f32 v92, v55, v63
    v_add_f32 v91, v91, v113
    v_add_f32 v93, v93, v117
    s_waitcnt vmcnt(19)
    s_barrier
    s_bfe_u32 s91, s68, 0x40014
    s_lshl_b32 s92, s91, 7
    s_mul_i32 s93, s91, 393216
    s_add_u32 m0, s94, 81920
    s_nop 0
    buffer_load_dwordx4 v20, s[24:27], s92 offen offset:0 lds
    v_add_f32 v91, v91, v114
    v_add_f32 v93, v93, v118
    v_add_f32_dpp v90, v90, v90 row_shr:1 row_mask:0xf bank_mask:0xf
    v_add_f32_dpp v91, v91, v91 row_shr:1 row_mask:0xf bank_mask:0xf
    v_add_f32_dpp v92, v92, v92 row_shr:1 row_mask:0xf bank_mask:0xf
    v_add_f32_dpp v93, v93, v93 row_shr:1 row_mask:0xf bank_mask:0xf
    v_add_f32_dpp v90, v90, v90 row_shr:2 row_mask:0xf bank_mask:0xf
    buffer_load_dwordx4 v21, s[24:27], s92 offen offset:1024 lds
    v_add_f32_dpp v91, v91, v91 row_shr:2 row_mask:0xf bank_mask:0xf
    v_add_f32_dpp v92, v92, v92 row_shr:2 row_mask:0xf bank_mask:0xf
    v_add_f32_dpp v93, v93, v93 row_shr:2 row_mask:0xf bank_mask:0xf
    v_add_f32_dpp v90, v90, v90 row_shr:4 row_mask:0xf bank_mask:0xf
    v_add_f32_dpp v91, v91, v91 row_shr:4 row_mask:0xf bank_mask:0xf
    v_add_f32_dpp v92, v92, v92 row_shr:4 row_mask:0xf bank_mask:0xf
    v_add_f32_dpp v93, v93, v93 row_shr:4 row_mask:0xf bank_mask:0xf
    buffer_load_dwordx4 v22, s[24:27], s92 offen offset:2048 lds
    v_add_f32_dpp v90, v90, v90 row_shr:8 row_mask:0xf bank_mask:0xf
    v_add_f32_dpp v91, v91, v91 row_shr:8 row_mask:0xf bank_mask:0xf
    v_add_f32_dpp v92, v92, v92 row_shr:8 row_mask:0xf bank_mask:0xf
    v_add_f32_dpp v93, v93, v93 row_shr:8 row_mask:0xf bank_mask:0xf
    v_add_f32_dpp v90, v90, v90 row_bcast:15 row_mask:0xa bank_mask:0xf
    v_add_f32_dpp v91, v91, v91 row_bcast:15 row_mask:0xa bank_mask:0xf
    v_add_f32_dpp v92, v92, v92 row_bcast:15 row_mask:0xa bank_mask:0xf
    buffer_load_dwordx4 v23, s[24:27], s92 offen offset:3072 lds
    v_add_f32_dpp v93, v93, v93 row_bcast:15 row_mask:0xa bank_mask:0xf
    v_add_f32_dpp v90, v90, v90 row_bcast:31 row_mask:0xc bank_mask:0xf
    v_add_f32_dpp v91, v91, v91 row_bcast:31 row_mask:0xc bank_mask:0xf
    v_add_f32_dpp v92, v92, v92 row_bcast:31 row_mask:0xc bank_mask:0xf
    v_add_f32_dpp v93, v93, v93 row_bcast:31 row_mask:0xc bank_mask:0xf
    v_mov_b32 v97, 0x8000
    v_mov_b32 v98, 0xffff
    s_add_u32 m0, s95, 81920
    s_nop 0
    buffer_load_dwordx4 v24, s[28:31], s93 offen offset:0 lds
    v_cvt_pk_bf16_f32 v94, v90, v91
    v_cvt_pk_bf16_f32 v104, v92, v93
    v_and_b32 v95, 0xffff, v94
    v_and_b32 v96, 0x8000, v94
    v_and_b32 v94, 0xffff0000, v94
    v_cmp_ne_u32 vcc, 0, v96
    v_mul_f32 v94, 0xbfb8aa3b, v94
    v_exp_f32 v94, v94
    v_cndmask_b32 v96, v97, v98, vcc
    v_xor_b32 v95, v95, v96
    v_add_f32 v94, 1.0, v94
    v_lshlrev_b32 v95, 11, v95
    v_rcp_f32 v94, v94
    s_sub_u32 s12, 2047, s22
    v_or_b32 v100, s12, v95
    v_cvt_pk_bf16_f32 v94, v94, v94
    v_lshlrev_b32 v102, 16, v94
    v_and_b32 v105, 0xffff, v104
    v_and_b32 v106, 0x8000, v104
    v_and_b32 v104, 0xffff0000, v104
    v_cmp_ne_u32 vcc, 0, v106
    v_mul_f32 v104, 0xbfb8aa3b, v104
    v_exp_f32 v104, v104
    v_cndmask_b32 v106, v97, v98, vcc
    v_xor_b32 v105, v105, v106
    v_add_f32 v104, 1.0, v104
    v_lshlrev_b32 v105, 11, v105
    v_rcp_f32 v104, v104
    s_sub_u32 s12, 2046, s22
    v_or_b32 v101, s12, v105
    v_cvt_pk_bf16_f32 v104, v104, v104
    v_lshlrev_b32 v103, 16, v104
    v_max_u32 v100, v100, v101
    s_lshl_b32 s12, s22, 2
    s_add_u32 s12, s12, 4096
    s_lshl_b32 s13, s21, 2
    s_add_u32 s13, s13, 162880
    v_mov_b32 v14, s13
    s_mov_b32 exec_lo, 0
    s_mov_b32 exec_hi, 0x80000000
    buffer_store_dwordx2 v[102:103], v13, s[32:35], s12 offen sc1
    ds_write_b32 v14, v100
    s_mov_b64 exec, -1
    s_waitcnt lgkmcnt(0)
    s_waitcnt vmcnt(15)
    s_barrier
    s_add_u32 m0, s95, 81920
    s_nop 0
    buffer_load_dwordx4 v25, s[28:31], s93 offen offset:1024 lds
    buffer_load_dwordx4 v26, s[28:31], s93 offen offset:2048 lds
    s_add_u32 m0, s95, 84992
    s_nop 0
    buffer_load_dwordx4 v27, s[28:31], s93 offen offset:0 lds
    buffer_load_dwordx4 v28, s[28:31], s93 offen offset:1024 lds
    buffer_load_dwordx4 v29, s[28:31], s93 offen offset:2048 lds
    s_bfe_u32 s91, s68, 0x40018
    s_lshl_b32 s92, s91, 7
    s_mul_i32 s93, s91, 393216
    s_add_u32 m0, s94, 0
    s_nop 0
    buffer_load_dwordx4 v20, s[24:27], s92 offen offset:0 lds
    buffer_load_dwordx4 v21, s[24:27], s92 offen offset:1024 lds
    buffer_load_dwordx4 v22, s[24:27], s92 offen offset:2048 lds
    buffer_load_dwordx4 v23, s[24:27], s92 offen offset:3072 lds
    s_add_u32 m0, s95, 0
    s_nop 0
    buffer_load_dwordx4 v24, s[28:31], s93 offen offset:0 lds
    buffer_load_dwordx4 v25, s[28:31], s93 offen offset:1024 lds
    buffer_load_dwordx4 v26, s[28:31], s93 offen offset:2048 lds
    s_waitcnt vmcnt(12)
    s_waitcnt vmcnt(7)
    s_barrier
    s_add_u32 m0, s95, 3072
    s_nop 0
    buffer_load_dwordx4 v27, s[28:31], s93 offen offset:0 lds
    buffer_load_dwordx4 v28, s[28:31], s93 offen offset:1024 lds
    buffer_load_dwordx4 v29, s[28:31], s93 offen offset:2048 lds
    s_bfe_u32 s91, s68, 0x4001c
    s_lshl_b32 s92, s91, 7
    s_mul_i32 s93, s91, 393216
    s_add_u32 m0, s94, 40960
    s_nop 0
    buffer_load_dwordx4 v20, s[24:27], s92 offen offset:0 lds
    buffer_load_dwordx4 v21, s[24:27], s92 offen offset:1024 lds
    buffer_load_dwordx4 v22, s[24:27], s92 offen offset:2048 lds
    buffer_load_dwordx4 v23, s[24:27], s92 offen offset:3072 lds
    s_add_u32 m0, s95, 40960
    s_nop 0
    buffer_load_dwordx4 v24, s[28:31], s93 offen offset:0 lds
    buffer_load_dwordx4 v25, s[28:31], s93 offen offset:1024 lds
    buffer_load_dwordx4 v26, s[28:31], s93 offen offset:2048 lds
    s_add_u32 m0, s95, 44032
    s_nop 0
    buffer_load_dwordx4 v27, s[28:31], s93 offen offset:0 lds
    buffer_load_dwordx4 v28, s[28:31], s93 offen offset:1024 lds
    s_mov_b32 s13, 0
L_tagchk_2:
    v_readfirstlane_b32 s23, v15
    s_nop 1
    s_cmp_lg_u32 s23, 0
    s_cbranch_scc1 L_tagok_2
    s_add_u32 s13, s13, 1
    s_cmp_ge_u32 s13, 16384
    s_cbranch_scc1 L_tagok_2
    buffer_load_dword v15, v13, s[72:75], 0 offen offset:4 sc1
    s_waitcnt vmcnt(0)
    s_branch L_tagchk_2
L_tagok_2:
    s_and_b32 s76, s23, 0xff
    s_bfe_u32 s77, s23, 0x80008
    s_bfe_u32 s78, s23, 0x80010
    s_lshr_b32 s79, s23, 24
    v_and_b32 v35, 3, v2
    v_lshlrev_b32 v35, 3, v35
    v_bfe_u32 v35, s23, v35, 8
    s_cmp_lg_u32 s21, 0
    s_cbranch_scc1 L_nopub_2
    v_mov_b32 v14, 162880
    ds_read_b128 v[104:107], v14
    s_lshl_b32 s12, s2, 3
    s_add_u32 s12, s12, 0
    s_waitcnt lgkmcnt(0)
    v_max3_u32 v104, v104, v105, v106
    v_max_u32 v104, v104, v107
    v_mov_b32 v105, s23
    s_mov_b64 exec, 1
    buffer_store_dwordx2 v[104:105], v13, s[32:35], s12 offen sc1
    s_mov_b64 exec, -1
L_nopub_2:
    s_waitcnt vmcnt(9)
    s_barrier
    s_add_u32 m0, s95, 44032
    s_nop 0
    buffer_load_dwordx4 v29, s[28:31], s93 offen offset:2048 lds
    s_bfe_u32 s91, s69, 0x40000
    s_lshl_b32 s92, s91, 7
    s_mul_i32 s93, s91, 393216
    s_add_u32 m0, s94, 81920
    s_nop 0
    buffer_load_dwordx4 v20, s[24:27], s92 offen offset:0 lds
    buffer_load_dwordx4 v21, s[24:27], s92 offen offset:1024 lds
    buffer_load_dwordx4 v22, s[24:27], s92 offen offset:2048 lds
    buffer_load_dwordx4 v23, s[24:27], s92 offen offset:3072 lds
    s_add_u32 m0, s95, 81920
    s_nop 0
    buffer_load_dwordx4 v24, s[28:31], s93 offen offset:0 lds
    buffer_load_dwordx4 v25, s[28:31], s93 offen offset:1024 lds
    buffer_load_dwordx4 v26, s[28:31], s93 offen offset:2048 lds
    s_add_u32 m0, s95, 84992
    s_nop 0
    buffer_load_dwordx4 v27, s[28:31], s93 offen offset:0 lds
    buffer_load_dwordx4 v28, s[28:31], s93 offen offset:1024 lds
    buffer_load_dwordx4 v29, s[28:31], s93 offen offset:2048 lds
    s_waitcnt vmcnt(10)
    s_barrier
    s_bfe_u32 s91, s69, 0x40004
    s_lshl_b32 s92, s91, 7
    s_mul_i32 s93, s91, 393216
    s_add_u32 m0, s94, 0
    s_nop 0
    buffer_load_dwordx4 v20, s[24:27], s92 offen offset:0 lds
    buffer_load_dwordx4 v21, s[24:27], s92 offen offset:1024 lds
    buffer_load_dwordx4 v22, s[24:27], s92 offen offset:2048 lds
    buffer_load_dwordx4 v23, s[24:27], s92 offen offset:3072 lds
    s_add_u32 m0, s95, 0
    s_nop 0
    buffer_load_dwordx4 v24, s[28:31], s93 offen offset:0 lds
    buffer_load_dwordx4 v25, s[28:31], s93 offen offset:1024 lds
    buffer_load_dwordx4 v26, s[28:31], s93 offen offset:2048 lds
    s_add_u32 m0, s95, 3072
    s_nop 0
    buffer_load_dwordx4 v27, s[28:31], s93 offen offset:0 lds
    buffer_load_dwordx4 v28, s[28:31], s93 offen offset:1024 lds
    buffer_load_dwordx4 v29, s[28:31], s93 offen offset:2048 lds
    s_cmp_ge_u32 s10, 224
    s_cbranch_scc1 L_p31_2
    s_add_u32 s12, s9, 0
    buffer_load_dwordx4 v[160:163], v30, s[44:47], s12 offen nt
    s_add_u32 s12, s9, 7168
    buffer_load_dwordx4 v[164:167], v30, s[44:47], s12 offen nt
    s_add_u32 s12, s9, 14336
    buffer_load_dwordx4 v[168:171], v30, s[44:47], s12 offen nt
    s_add_u32 s12, s9, 21504
    buffer_load_dwordx4 v[172:175], v30, s[44:47], s12 offen nt
    s_add_u32 s12, s9, 28672
    buffer_load_dwordx4 v[176:179], v30, s[44:47], s12 offen nt
    s_add_u32 s12, s9, 35840
    buffer_load_dwordx4 v[180:183], v30, s[44:47], s12 offen nt
    s_add_u32 s12, s9, 43008
    buffer_load_dwordx4 v[184:187], v30, s[44:47], s12 offen nt
    s_add_u32 s12, s9, 50176
    buffer_load_dwordx4 v[188:191], v30, s[44:47], s12 offen nt
    s_branch L_p3e1_2
L_p31_2:
    s_mov_b64 exec, 63
    s_bfe_u32 s12, s69, 0x4000c
    s_mul_i32 s12, s12, 393216
    buffer_load_dword v160, v32, s[28:31], s12 offen
    s_bfe_u32 s12, s69, 0x40010
    s_mul_i32 s12, s12, 393216
    buffer_load_dword v164, v32, s[28:31], s12 offen
    s_bfe_u32 s12, s69, 0x40014
    s_mul_i32 s12, s12, 393216
    buffer_load_dword v168, v32, s[28:31], s12 offen
    s_bfe_u32 s12, s69, 0x40018
    s_mul_i32 s12, s12, 393216
    buffer_load_dword v172, v32, s[28:31], s12 offen
    s_bfe_u32 s12, s69, 0x4001c
    s_mul_i32 s12, s12, 393216
    buffer_load_dword v176, v32, s[28:31], s12 offen
    s_mov_b64 exec, 1
    s_bfe_u32 s12, s69, 0x4001c
    s_mul_i32 s12, s12, 393216
    buffer_load_dword v180, v32, s[28:31], s12 offen
    s_bfe_u32 s12, s69, 0x4001c
    s_mul_i32 s12, s12, 393216
    buffer_load_dword v184, v32, s[28:31], s12 offen
    s_bfe_u32 s12, s69, 0x4001c
    s_mul_i32 s12, s12, 393216
    buffer_load_dword v188, v32, s[28:31], s12 offen
    s_mov_b64 exec, -1
L_p3e1_2:
    s_mov_b32 exec_lo, 0xffff0000
    s_mov_b32 exec_hi, 0
    buffer_load_dword v19, v10, s[36:39], 0 offen
    s_mov_b64 exec, -1
    s_waitcnt vmcnt(19)
    s_barrier
    s_bfe_u32 s91, s69, 0x40008
    s_lshl_b32 s92, s91, 7
    s_mul_i32 s93, s91, 393216
    s_add_u32 m0, s94, 40960
    s_nop 0
    buffer_load_dwordx4 v20, s[24:27], s92 offen offset:0 lds
    buffer_load_dwordx4 v21, s[24:27], s92 offen offset:1024 lds
    buffer_load_dwordx4 v22, s[24:27], s92 offen offset:2048 lds
    buffer_load_dwordx4 v23, s[24:27], s92 offen offset:3072 lds
    s_add_u32 m0, s95, 40960
    s_nop 0
    buffer_load_dwordx4 v24, s[28:31], s93 offen offset:0 lds
    s_waitcnt vmcnt(14)
    s_barrier
    s_add_u32 m0, s95, 40960
    s_nop 0
    buffer_load_dwordx4 v25, s[28:31], s93 offen offset:1024 lds
    buffer_load_dwordx4 v26, s[28:31], s93 offen offset:2048 lds
    s_add_u32 m0, s95, 44032
    s_nop 0
    buffer_load_dwordx4 v27, s[28:31], s93 offen offset:0 lds
    buffer_load_dwordx4 v28, s[28:31], s93 offen offset:1024 lds
    buffer_load_dwordx4 v29, s[28:31], s93 offen offset:2048 lds
    s_bfe_u32 s91, s69, 0x4000c
    s_lshl_b32 s92, s91, 7
    s_mul_i32 s93, s91, 393216
    s_add_u32 m0, s94, 81920
    s_nop 0
    buffer_load_dwordx4 v20, s[24:27], s92 offen offset:0 lds
    buffer_load_dwordx4 v21, s[24:27], s92 offen offset:1024 lds
    buffer_load_dwordx4 v22, s[24:27], s92 offen offset:2048 lds
    buffer_load_dwordx4 v23, s[24:27], s92 offen offset:3072 lds
    s_add_u32 m0, s95, 81920
    s_nop 0
    buffer_load_dwordx4 v24, s[28:31], s93 offen offset:0 lds
    buffer_load_dwordx4 v25, s[28:31], s93 offen offset:1024 lds
    buffer_load_dwordx4 v26, s[28:31], s93 offen offset:2048 lds
    s_mov_b32 s12, 0
    buffer_load_dwordx4 v[104:107], v5, s[32:35], s12 offen offset:0 sc1
    buffer_load_dwordx4 v[108:111], v5, s[32:35], s12 offen offset:1024 sc1
    s_waitcnt vmcnt(9)
    s_barrier
    s_add_u32 m0, s95, 84992
    s_nop 0
    buffer_load_dwordx4 v27, s[28:31], s93 offen offset:0 lds
    buffer_load_dwordx4 v28, s[28:31], s93 offen offset:1024 lds
    buffer_load_dwordx4 v29, s[28:31], s93 offen offset:2048 lds
    s_bfe_u32 s91, s69, 0x40010
    s_lshl_b32 s92, s91, 7
    s_mul_i32 s93, s91, 393216
    s_add_u32 m0, s94, 0
    s_nop 0
    buffer_load_dwordx4 v20, s[24:27], s92 offen offset:0 lds
    buffer_load_dwordx4 v21, s[24:27], s92 offen offset:1024 lds
    buffer_load_dwordx4 v22, s[24:27], s92 offen offset:2048 lds
    buffer_load_dwordx4 v23, s[24:27], s92 offen offset:3072 lds
    s_add_u32 m0, s95, 0
    s_nop 0
    buffer_load_dwordx4 v24, s[28:31], s93 offen offset:0 lds
    buffer_load_dwordx4 v25, s[28:31], s93 offen offset:1024 lds
    buffer_load_dwordx4 v26, s[28:31], s93 offen offset:2048 lds
    s_add_u32 m0, s95, 3072
    s_nop 0
    buffer_load_dwordx4 v27, s[28:31], s93 offen offset:0 lds
    buffer_load_dwordx4 v28, s[28:31], s93 offen offset:1024 lds
    s_waitcnt vmcnt(9)
    s_barrier
    s_add_u32 m0, s95, 3072
    s_nop 0
    buffer_load_dwordx4 v29, s[28:31], s93 offen offset:2048 lds
    s_mov_b32 s13, 0
    v_xor_b32 v105, s23, v105
    v_xor_b32 v107, s23, v107
    v_xor_b32 v109, s23, v109
    v_xor_b32 v111, s23, v111
    v_or3_b32 v105, v105, v107, v109
    v_or_b32 v105, v105, v111
    v_cmp_ne_u32 vcc, 0, v105
    s_cbranch_vccnz L_keyre_2
L_keyok_2:
    s_bfe_u32 s91, s69, 0x40014
    s_lshl_b32 s92, s91, 7
    s_mul_i32 s93, s91, 393216
    s_add_u32 m0, s94, 40960
    s_nop 0
    buffer_load_dwordx4 v20, s[24:27], s92 offen offset:0 lds
    v_max3_u32 v104, v104, v106, v108
    v_max_u32 v104, v104, v110
    s_nop 1
    v_max_u32_dpp v104, v104, v104 row_shr:1 row_mask:0xf bank_mask:0xf
    s_nop 1
    v_max_u32_dpp v104, v104, v104 row_shr:2 row_mask:0xf bank_mask:0xf
    s_nop 1
    v_max_u32_dpp v104, v104, v104 row_shr:4 row_mask:0xf bank_mask:0xf
    s_nop 1
    v_max_u32_dpp v104, v104, v104 row_shr:8 row_mask:0xf bank_mask:0xf
    s_nop 1
    v_max_u32_dpp v104, v104, v104 row_bcast:15 row_mask:0xa bank_mask:0xf
    buffer_load_dwordx4 v21, s[24:27], s92 offen offset:1024 lds
    s_nop 0
    v_max_u32_dpp v104, v104, v104 row_bcast:31 row_mask:0xc bank_mask:0xf
    s_nop 0
    v_readlane_b32 s14, v104, 63
    s_nop 1
    s_and_b32 s15, s14, 2047
    s_sub_u32 s15, 2047, s15
    s_lshl_b32 s12, s15, 11
    s_lshl_b32 s13, s70, 1
    s_add_u32 s12, s12, s13
    buffer_load_dwordx4 v[36:39], v34, s[24:27], s12 offen
    s_lshr_b32 s12, s14, 11
    s_and_b32 s13, s12, 0x8000
    s_cmp_lg_u32 s13, 0
    s_mov_b32 s13, 0xffff
    s_cselect_b32 s13, 0x8000, s13
    s_xor_b32 s12, s12, s13
    s_lshl_b32 s12, s12, 16
    v_mov_b32 v105, s12
    buffer_load_dwordx4 v22, s[24:27], s92 offen offset:2048 lds
    v_mul_f32 v105, 0xbfb8aa3b, v105
    v_exp_f32 v105, v105
    s_nop 0
    v_add_f32 v105, 1.0, v105
    v_rcp_f32 v105, v105
    s_nop 0
    v_cvt_pk_bf16_f32 v105, v105, v105
    v_lshlrev_b32 v105, 16, v105
    s_add_u32 s12, s15, 1
    v_mov_b32 v104, s12
    buffer_load_dwordx4 v23, s[24:27], s92 offen offset:3072 lds
    v_mov_b32 v106, s23
    v_readfirstlane_b32 s14, v105
    v_mov_b32 v14, 162864
    s_mov_b64 exec, 1
    ds_write_b96 v14, v[104:106]
    s_mov_b64 exec, -1
    s_waitcnt lgkmcnt(0)
    s_add_u32 m0, s95, 40960
    s_nop 0
    buffer_load_dwordx4 v24, s[28:31], s93 offen offset:0 lds
    buffer_load_dwordx4 v25, s[28:31], s93 offen offset:1024 lds
    buffer_load_dwordx4 v26, s[28:31], s93 offen offset:2048 lds
    s_add_u32 m0, s95, 44032
    s_nop 0
    buffer_load_dwordx4 v27, s[28:31], s93 offen offset:0 lds
    buffer_load_dwordx4 v28, s[28:31], s93 offen offset:1024 lds
    buffer_load_dwordx4 v29, s[28:31], s93 offen offset:2048 lds
    s_waitcnt vmcnt(11)
    s_barrier
    s_bfe_u32 s91, s69, 0x40018
    s_lshl_b32 s92, s91, 7
    s_mul_i32 s93, s91, 393216
    s_add_u32 m0, s94, 81920
    s_nop 0
    buffer_load_dwordx4 v20, s[24:27], s92 offen offset:0 lds
    s_waitcnt vmcnt(9)
    s_mov_b32 s8, 0xffff0000
    v_lshlrev_b32 v40, 16, v36
    v_and_b32 v41, s8, v36
    v_lshlrev_b32 v42, 16, v37
    v_and_b32 v43, s8, v37
    v_lshlrev_b32 v44, 16, v38
    buffer_load_dwordx4 v21, s[24:27], s92 offen offset:1024 lds
    v_and_b32 v45, s8, v38
    v_lshlrev_b32 v46, 16, v39
    v_and_b32 v47, s8, v39
    v_lshlrev_b32 v48, 16, v128
    v_lshlrev_b32 v49, 16, v129
    v_and_b32 v128, s8, v128
    v_and_b32 v129, s8, v129
    buffer_load_dwordx4 v22, s[24:27], s92 offen offset:2048 lds
    v_mul_f32 v220, v48, v40
    v_mul_f32 v222, v49, v40
    v_mul_f32 v221, v128, v40
    v_mul_f32 v223, v129, v40
    v_lshlrev_b32 v50, 16, v130
    v_lshlrev_b32 v51, 16, v131
    v_and_b32 v130, s8, v130
    buffer_load_dwordx4 v23, s[24:27], s92 offen offset:3072 lds
    v_and_b32 v131, s8, v131
    v_mul_f32 v224, v50, v40
    v_mul_f32 v226, v51, v40
    v_mul_f32 v225, v130, v40
    v_mul_f32 v227, v131, v40
    v_lshlrev_b32 v48, 16, v160
    v_lshlrev_b32 v49, 16, v161
    s_add_u32 m0, s95, 81920
    s_nop 0
    buffer_load_dwordx4 v24, s[28:31], s93 offen offset:0 lds
    v_and_b32 v160, s8, v160
    v_and_b32 v161, s8, v161
    v_mul_f32 v228, v48, v40
    v_mul_f32 v230, v49, v40
    v_mul_f32 v229, v160, v40
    v_mul_f32 v231, v161, v40
    v_lshlrev_b32 v50, 16, v162
    buffer_load_dwordx4 v25, s[28:31], s93 offen offset:1024 lds
    v_lshlrev_b32 v51, 16, v163
    v_and_b32 v162, s8, v162
    v_and_b32 v163, s8, v163
    v_mul_f32 v232, v50, v40
    v_mul_f32 v234, v51, v40
    v_mul_f32 v233, v162, v40
    v_mul_f32 v235, v163, v40
    buffer_load_dwordx4 v26, s[28:31], s93 offen offset:2048 lds
    v_lshlrev_b32 v48, 16, v132
    v_lshlrev_b32 v49, 16, v133
    v_and_b32 v132, s8, v132
    v_and_b32 v133, s8, v133
    v_fmac_f32 v220, v48, v41
    v_fmac_f32 v222, v49, v41
    v_fmac_f32 v221, v132, v41
    s_add_u32 m0, s95, 84992
    s_nop 0
    buffer_load_dwordx4 v27, s[28:31], s93 offen offset:0 lds
    v_fmac_f32 v223, v133, v41
    v_lshlrev_b32 v50, 16, v134
    v_lshlrev_b32 v51, 16, v135
    v_and_b32 v134, s8, v134
    v_and_b32 v135, s8, v135
    v_fmac_f32 v224, v50, v41
    v_fmac_f32 v226, v51, v41
    buffer_load_dwordx4 v28, s[28:31], s93 offen offset:1024 lds
    v_fmac_f32 v225, v134, v41
    v_fmac_f32 v227, v135, v41
    v_lshlrev_b32 v48, 16, v164
    v_lshlrev_b32 v49, 16, v165
    v_and_b32 v164, s8, v164
    v_and_b32 v165, s8, v165
    v_fmac_f32 v228, v48, v41
    buffer_load_dwordx4 v29, s[28:31], s93 offen offset:2048 lds
    v_fmac_f32 v230, v49, v41
    v_fmac_f32 v229, v164, v41
    v_fmac_f32 v231, v165, v41
    v_lshlrev_b32 v50, 16, v166
    v_lshlrev_b32 v51, 16, v167
    v_and_b32 v166, s8, v166
    v_and_b32 v167, s8, v167
    s_add_u32 s12, s97, 0
    buffer_load_dwordx4 v[192:195], v31, s[64:67], s12 offen nt
    s_add_u32 s12, s97, 16384
    buffer_load_dwordx4 v[196:199], v31, s[64:67], s12 offen nt
    s_add_u32 s12, s97, 32768
    buffer_load_dwordx4 v[200:203], v31, s[64:67], s12 offen nt
    s_add_u32 s12, s97, 49152
    buffer_load_dwordx4 v[204:207], v31, s[64:67], s12 offen nt
    s_add_u32 s12, s97, 65536
    buffer_load_dwordx4 v[208:211], v31, s[64:67], s12 offen nt
    s_add_u32 s12, s97, 81920
    buffer_load_dwordx4 v[212:215], v31, s[64:67], s12 offen nt
    s_add_u32 s12, s97, 98304
    buffer_load_dwordx4 v[216:219], v31, s[64:67], s12 offen nt
    v_fmac_f32 v232, v50, v41
    v_fmac_f32 v234, v51, v41
    v_fmac_f32 v233, v166, v41
    v_fmac_f32 v235, v167, v41
    v_lshlrev_b32 v48, 16, v136
    v_lshlrev_b32 v49, 16, v137
    v_and_b32 v136, s8, v136
    v_and_b32 v137, s8, v137
    v_fmac_f32 v220, v48, v42
    v_fmac_f32 v222, v49, v42
    v_fmac_f32 v221, v136, v42
    v_fmac_f32 v223, v137, v42
    v_lshlrev_b32 v50, 16, v138
    v_lshlrev_b32 v51, 16, v139
    v_and_b32 v138, s8, v138
    v_and_b32 v139, s8, v139
    v_fmac_f32 v224, v50, v42
    v_fmac_f32 v226, v51, v42
    v_fmac_f32 v225, v138, v42
    v_fmac_f32 v227, v139, v42
    v_lshlrev_b32 v48, 16, v168
    v_lshlrev_b32 v49, 16, v169
    v_and_b32 v168, s8, v168
    v_and_b32 v169, s8, v169
    v_fmac_f32 v228, v48, v42
    s_waitcnt vmcnt(17)
    s_barrier
    s_bfe_u32 s91, s69, 0x4001c
    s_lshl_b32 s92, s91, 7
    s_mul_i32 s93, s91, 393216
    s_add_u32 m0, s94, 0
    s_nop 0
    buffer_load_dwordx4 v20, s[24:27], s92 offen offset:0 lds
    v_fmac_f32 v230, v49, v42
    v_fmac_f32 v229, v168, v42
    v_fmac_f32 v231, v169, v42
    v_lshlrev_b32 v50, 16, v170
    v_lshlrev_b32 v51, 16, v171
    v_and_b32 v170, s8, v170
    v_and_b32 v171, s8, v171
    buffer_load_dwordx4 v21, s[24:27], s92 offen offset:1024 lds
    v_fmac_f32 v232, v50, v42
    v_fmac_f32 v234, v51, v42
    v_fmac_f32 v233, v170, v42
    v_fmac_f32 v235, v171, v42
    v_lshlrev_b32 v48, 16, v140
    v_lshlrev_b32 v49, 16, v141
    v_and_b32 v140, s8, v140
    buffer_load_dwordx4 v22, s[24:27], s92 offen offset:2048 lds
    v_and_b32 v141, s8, v141
    v_fmac_f32 v220, v48, v43
    v_fmac_f32 v222, v49, v43
    v_fmac_f32 v221, v140, v43
    v_fmac_f32 v223, v141, v43
    v_lshlrev_b32 v50, 16, v142
    v_lshlrev_b32 v51, 16, v143
    buffer_load_dwordx4 v23, s[24:27], s92 offen offset:3072 lds
    v_and_b32 v142, s8, v142
    v_and_b32 v143, s8, v143
    v_fmac_f32 v224, v50, v43
    v_fmac_f32 v226, v51, v43
    v_fmac_f32 v225, v142, v43
    v_fmac_f32 v227, v143, v43
    v_lshlrev_b32 v48, 16, v172
    s_add_u32 m0, s95, 0
    s_nop 0
    buffer_load_dwordx4 v24, s[28:31], s93 offen offset:0 lds
    v_lshlrev_b32 v49, 16, v173
    v_and_b32 v172, s8, v172
    v_and_b32 v173, s8, v173
    v_fmac_f32 v228, v48, v43
    v_fmac_f32 v230, v49, v43
    v_fmac_f32 v229, v172, v43
    v_fmac_f32 v231, v173, v43
    v_lshlrev_b32 v50, 16, v174
    v_lshlrev_b32 v51, 16, v175
    v_and_b32 v174, s8, v174
    v_and_b32 v175, s8, v175
    v_fmac_f32 v232, v50, v43
    v_fmac_f32 v234, v51, v43
    v_fmac_f32 v233, v174, v43
    v_fmac_f32 v235, v175, v43
    v_lshlrev_b32 v48, 16, v144
    v_lshlrev_b32 v49, 16, v145
    v_and_b32 v144, s8, v144
    v_and_b32 v145, s8, v145
    v_fmac_f32 v220, v48, v44
    v_fmac_f32 v222, v49, v44
    v_fmac_f32 v221, v144, v44
    v_fmac_f32 v223, v145, v44
    v_lshlrev_b32 v50, 16, v146
    v_lshlrev_b32 v51, 16, v147
    v_and_b32 v146, s8, v146
    v_and_b32 v147, s8, v147
    v_fmac_f32 v224, v50, v44
    v_fmac_f32 v226, v51, v44
    v_fmac_f32 v225, v146, v44
    v_fmac_f32 v227, v147, v44
    v_lshlrev_b32 v48, 16, v176
    s_waitcnt vmcnt(12)
    s_barrier
    s_add_u32 m0, s95, 0
    s_nop 0
    buffer_load_dwordx4 v25, s[28:31], s93 offen offset:1024 lds
    v_lshlrev_b32 v49, 16, v177
    v_and_b32 v176, s8, v176
    v_and_b32 v177, s8, v177
    v_fmac_f32 v228, v48, v44
    v_fmac_f32 v230, v49, v44
    v_fmac_f32 v229, v176, v44
    v_fmac_f32 v231, v177, v44
    buffer_load_dwordx4 v26, s[28:31], s93 offen offset:2048 lds
    v_lshlrev_b32 v50, 16, v178
    v_lshlrev_b32 v51, 16, v179
    v_and_b32 v178, s8, v178
    v_and_b32 v179, s8, v179
    v_fmac_f32 v232, v50, v44
    v_fmac_f32 v234, v51, v44
    v_fmac_f32 v233, v178, v44
    s_add_u32 m0, s95, 3072
    s_nop 0
    buffer_load_dwordx4 v27, s[28:31], s93 offen offset:0 lds
    v_fmac_f32 v235, v179, v44
    v_lshlrev_b32 v48, 16, v148
    v_lshlrev_b32 v49, 16, v149
    v_and_b32 v148, s8, v148
    v_and_b32 v149, s8, v149
    v_fmac_f32 v220, v48, v45
    v_fmac_f32 v222, v49, v45
    buffer_load_dwordx4 v28, s[28:31], s93 offen offset:1024 lds
    v_fmac_f32 v221, v148, v45
    v_fmac_f32 v223, v149, v45
    v_lshlrev_b32 v50, 16, v150
    v_lshlrev_b32 v51, 16, v151
    v_and_b32 v150, s8, v150
    v_and_b32 v151, s8, v151
    v_fmac_f32 v224, v50, v45
    buffer_load_dwordx4 v29, s[28:31], s93 offen offset:2048 lds
    v_fmac_f32 v226, v51, v45
    v_fmac_f32 v225, v150, v45
    v_fmac_f32 v227, v151, v45
    v_lshlrev_b32 v48, 16, v180
    v_lshlrev_b32 v49, 16, v181
    v_and_b32 v180, s8, v180
    v_and_b32 v181, s8, v181
    s_mul_i32 s12, s21, 8
    s_add_u32 s12, s12, 96
    s_lshl_b32 s13, s12, 10
    s_lshl_b32 s12, s12, 14
    s_add_u32 m0, s13, 24576
    s_add_u32 s90, s12, 0
    buffer_load_dwordx4 v33, s[36:39], s90 offen lds
    s_add_u32 m0, s13, 25600
    s_add_u32 s90, s12, 16384
    buffer_load_dwordx4 v33, s[36:39], s90 offen lds
    s_add_u32 m0, s13, 26624
    s_add_u32 s90, s12, 32768
    buffer_load_dwordx4 v33, s[36:39], s90 offen lds
    s_add_u32 m0, s13, 27648
    s_add_u32 s90, s12, 49152
    buffer_load_dwordx4 v33, s[36:39], s90 offen lds
    s_add_u32 m0, s13, 28672
    s_add_u32 s90, s12, 65536
    buffer_load_dwordx4 v33, s[36:39], s90 offen lds
    s_add_u32 m0, s13, 29696
    s_add_u32 s90, s12, 81920
    buffer_load_dwordx4 v33, s[36:39], s90 offen lds
    s_add_u32 m0, s13, 30720
    s_add_u32 s90, s12, 98304
    buffer_load_dwordx4 v33, s[36:39], s90 offen lds
    s_add_u32 m0, s13, 31744
    s_add_u32 s90, s12, 114688
    buffer_load_dwordx4 v33, s[36:39], s90 offen lds
    v_fmac_f32 v228, v48, v45
    v_fmac_f32 v230, v49, v45
    v_fmac_f32 v229, v180, v45
    v_fmac_f32 v231, v181, v45
    v_lshlrev_b32 v50, 16, v182
    v_lshlrev_b32 v51, 16, v183
    v_and_b32 v182, s8, v182
    v_and_b32 v183, s8, v183
    v_fmac_f32 v232, v50, v45
    v_fmac_f32 v234, v51, v45
    v_fmac_f32 v233, v182, v45
    v_fmac_f32 v235, v183, v45
    v_lshlrev_b32 v48, 16, v152
    v_lshlrev_b32 v49, 16, v153
    v_and_b32 v152, s8, v152
    v_and_b32 v153, s8, v153
    v_fmac_f32 v220, v48, v46
    v_fmac_f32 v222, v49, v46
    v_fmac_f32 v221, v152, v46
    v_fmac_f32 v223, v153, v46
    v_lshlrev_b32 v50, 16, v154
    v_lshlrev_b32 v51, 16, v155
    v_and_b32 v154, s8, v154
    v_and_b32 v155, s8, v155
    v_fmac_f32 v224, v50, v46
    s_waitcnt vmcnt(8)
    s_barrier
    v_fmac_f32 v226, v51, v46
    v_fmac_f32 v225, v154, v46
    v_fmac_f32 v227, v155, v46
    v_lshlrev_b32 v48, 16, v184
    v_lshlrev_b32 v49, 16, v185
    v_and_b32 v184, s8, v184
    v_and_b32 v185, s8, v185
    v_fmac_f32 v228, v48, v46
    v_fmac_f32 v230, v49, v46
    v_fmac_f32 v229, v184, v46
    v_fmac_f32 v231, v185, v46
    v_lshlrev_b32 v50, 16, v186
    v_lshlrev_b32 v51, 16, v187
    v_and_b32 v186, s8, v186
    v_and_b32 v187, s8, v187
    v_fmac_f32 v232, v50, v46
    v_fmac_f32 v234, v51, v46
    v_fmac_f32 v233, v186, v46
    v_fmac_f32 v235, v187, v46
    v_lshlrev_b32 v48, 16, v156
    v_lshlrev_b32 v49, 16, v157
    v_and_b32 v156, s8, v156
    v_and_b32 v157, s8, v157
    v_fmac_f32 v220, v48, v47
    v_fmac_f32 v222, v49, v47
    v_fmac_f32 v221, v156, v47
    v_fmac_f32 v223, v157, v47
    v_lshlrev_b32 v50, 16, v158
    v_lshlrev_b32 v51, 16, v159
    v_and_b32 v158, s8, v158
    v_and_b32 v159, s8, v159
    v_fmac_f32 v224, v50, v47
    v_fmac_f32 v226, v51, v47
    v_fmac_f32 v225, v158, v47
    v_fmac_f32 v227, v159, v47
    v_lshlrev_b32 v48, 16, v188
    v_lshlrev_b32 v49, 16, v189
    v_and_b32 v188, s8, v188
    v_and_b32 v189, s8, v189
    v_fmac_f32 v228, v48, v47
    v_fmac_f32 v230, v49, v47
    v_fmac_f32 v229, v188, v47
    v_fmac_f32 v231, v189, v47
    v_lshlrev_b32 v50, 16, v190
    v_lshlrev_b32 v51, 16, v191
    v_and_b32 v190, s8, v190
    v_and_b32 v191, s8, v191
    v_fmac_f32 v232, v50, v47
    v_fmac_f32 v234, v51, v47
    v_fmac_f32 v233, v190, v47
    v_fmac_f32 v235, v191, v47
    v_permlane32_swap_b32 v220, v228
    v_permlane32_swap_b32 v221, v229
    v_permlane32_swap_b32 v222, v230
    v_permlane32_swap_b32 v223, v231
    v_permlane32_swap_b32 v224, v232
    v_permlane32_swap_b32 v225, v233
    v_permlane32_swap_b32 v226, v234
    v_permlane32_swap_b32 v227, v235
    v_add_f32 v220, v220, v228
    v_add_f32 v221, v221, v229
    v_add_f32 v222, v222, v230
    v_add_f32 v223, v223, v231
    v_add_f32 v224, v224, v232
    v_add_f32 v225, v225, v233
    v_add_f32 v226, v226, v234
    v_add_f32 v227, v227, v235
    v_permlane16_swap_b32 v220, v224
    v_permlane16_swap_b32 v221, v225
    v_permlane16_swap_b32 v222, v226
    v_permlane16_swap_b32 v223, v227
    v_add_f32 v220, v220, v224
    v_add_f32 v221, v221, v225
    v_add_f32 v222, v222, v226
    v_add_f32 v223, v223, v227
    v_add_f32_dpp v220, v220, v220 row_ror:8 row_mask:0xf bank_mask:0xf
    v_add_f32_dpp v221, v221, v221 row_ror:8 row_mask:0xf bank_mask:0xf
    v_add_f32_dpp v222, v222, v222 row_ror:8 row_mask:0xf bank_mask:0xf
    v_add_f32_dpp v223, v223, v223 row_ror:8 row_mask:0xf bank_mask:0xf
    s_branch L_varend
L_var3:
    s_nop 0
    s_add_u32 m0, s95, 40960
    s_nop 0
    buffer_load_dwordx4 v26, s[28:31], s93 offen offset:2048 lds
    s_add_u32 m0, s95, 44032
    s_nop 0
    buffer_load_dwordx4 v27, s[28:31], s93 offen offset:0 lds
    buffer_load_dwordx4 v28, s[28:31], s93 offen offset:1024 lds
    buffer_load_dwordx4 v29, s[28:31], s93 offen offset:2048 lds
    s_bfe_u32 s91, s68, 0x40008
    s_lshl_b32 s92, s91, 7
    s_mul_i32 s93, s91, 393216
    s_add_u32 m0, s94, 81920
    s_nop 0
    buffer_load_dwordx4 v20, s[24:27], s92 offen offset:0 lds
    buffer_load_dwordx4 v21, s[24:27], s92 offen offset:1024 lds
    buffer_load_dwordx4 v22, s[24:27], s92 offen offset:2048 lds
    buffer_load_dwordx4 v23, s[24:27], s92 offen offset:3072 lds
    s_add_u32 m0, s95, 81920
    s_nop 0
    buffer_load_dwordx4 v24, s[28:31], s93 offen offset:0 lds
    buffer_load_dwordx4 v25, s[28:31], s93 offen offset:1024 lds
    buffer_load_dwordx4 v26, s[28:31], s93 offen offset:2048 lds
    s_add_u32 m0, s95, 84992
    s_nop 0
    buffer_load_dwordx4 v27, s[28:31], s93 offen offset:0 lds
    buffer_load_dwordx4 v28, s[28:31], s93 offen offset:1024 lds
    buffer_load_dwordx4 v29, s[28:31], s93 offen offset:2048 lds
    s_lshl_b32 s12, s19, 2
    s_add_u32 s12, s12, s21
    s_lshl_b32 s12, s12, 10
    s_lshl_b32 s13, s21, 10
    s_add_u32 m0, s13, 155648
    s_nop 0
    buffer_load_dwordx4 v5, s[76:79], s12 offen lds
    s_lshl_b32 s12, s22, 11
    buffer_load_dwordx4 v[40:43], v5, s[24:27], s12 offen offset:0
    buffer_load_dwordx4 v[44:47], v5, s[24:27], s12 offen offset:1024
    buffer_load_dwordx4 v[48:51], v5, s[24:27], s12 offen offset:2048
    buffer_load_dwordx4 v[52:55], v5, s[24:27], s12 offen offset:3072
    buffer_load_dwordx4 v[56:59], v5, s[80:83], 0 offen offset:0
    buffer_load_dwordx4 v[60:63], v5, s[80:83], 0 offen offset:1024
    buffer_load_dwordx4 v[64:67], v5, s[84:87], 0 offen offset:0
    buffer_load_dwordx4 v[68:71], v5, s[84:87], 0 offen offset:1024
    s_waitcnt vmcnt(19)
    s_barrier
    s_bfe_u32 s91, s68, 0x4000c
    s_lshl_b32 s92, s91, 7
    s_mul_i32 s93, s91, 393216
    s_add_u32 m0, s94, 0
    s_nop 0
    buffer_load_dwordx4 v20, s[24:27], s92 offen offset:0 lds
    s_waitcnt vmcnt(1)
    s_mov_b32 s8, 0xffff0000
    v_lshlrev_b32 v72, 16, v56
    v_and_b32 v56, s8, v56
    v_lshlrev_b32 v73, 16, v64
    v_and_b32 v64, s8, v64
    v_lshlrev_b32 v112, 16, v40
    buffer_load_dwordx4 v21, s[24:27], s92 offen offset:1024 lds
    v_and_b32 v40, s8, v40
    v_lshlrev_b32 v116, 16, v48
    v_and_b32 v48, s8, v48
    v_mul_f32 v113, v112, v73
    v_mul_f32 v114, v40, v64
    v_mul_f32 v90, v112, v72
    v_mul_f32 v117, v116, v73
    buffer_load_dwordx4 v22, s[24:27], s92 offen offset:2048 lds
    v_mul_f32 v118, v48, v64
    v_mul_f32 v92, v116, v72
    v_cvt_pk_bf16_f32 v113, 0, v113
    v_cvt_pk_bf16_f32 v114, 0, v114
    v_fmac_f32 v90, v40, v56
    v_cvt_pk_bf16_f32 v117, 0, v117
    v_cvt_pk_bf16_f32 v118, 0, v118
    buffer_load_dwordx4 v23, s[24:27], s92 offen offset:3072 lds
    v_fmac_f32 v92, v48, v56
    v_add_f32 v91, v113, v114
    v_add_f32 v93, v117, v118
    v_lshlrev_b32 v72, 16, v57
    v_and_b32 v57, s8, v57
    v_lshlrev_b32 v73, 16, v65
    v_and_b32 v65, s8, v65
    s_add_u32 m0, s95, 0
    s_nop 0
    buffer_load_dwordx4 v24, s[28:31], s93 offen offset:0 lds
    v_lshlrev_b32 v112, 16, v41
    v_and_b32 v41, s8, v41
    v_lshlrev_b32 v116, 16, v49
    v_and_b32 v49, s8, v49
    v_mul_f32 v113, v112, v73
    v_mul_f32 v114, v41, v65
    v_fmac_f32 v90, v112, v72
    buffer_load_dwordx4 v25, s[28:31], s93 offen offset:1024 lds
    v_mul_f32 v117, v116, v73
    v_mul_f32 v118, v49, v65
    v_fmac_f32 v92, v116, v72
    v_cvt_pk_bf16_f32 v113, 0, v113
    v_cvt_pk_bf16_f32 v114, 0, v114
    v_fmac_f32 v90, v41, v57
    v_cvt_pk_bf16_f32 v117, 0, v117
    buffer_load_dwordx4 v26, s[28:31], s93 offen offset:2048 lds
    v_cvt_pk_bf16_f32 v118, 0, v118
    v_fmac_f32 v92, v49, v57
    v_add_f32 v91, v91, v113
    v_add_f32 v93, v93, v117
    v_add_f32 v91, v91, v114
    v_add_f32 v93, v93, v118
    v_lshlrev_b32 v72, 16, v58
    s_add_u32 m0, s95, 3072
    s_nop 0
    buffer_load_dwordx4 v27, s[28:31], s93 offen offset:0 lds
    v_and_b32 v58, s8, v58
    v_lshlrev_b32 v73, 16, v66
    v_and_b32 v66, s8, v66
    v_lshlrev_b32 v112, 16, v42
    v_and_b32 v42, s8, v42
    v_lshlrev_b32 v116, 16, v50
    v_and_b32 v50, s8, v50
    buffer_load_dwordx4 v28, s[28:31], s93 offen offset:1024 lds
    v_mul_f32 v113, v112, v73
    v_mul_f32 v114, v42, v66
    v_fmac_f32 v90, v112, v72
    v_mul_f32 v117, v116, v73
    v_mul_f32 v118, v50, v66
    v_fmac_f32 v92, v116, v72
    v_cvt_pk_bf16_f32 v113, 0, v113
    buffer_load_dwordx4 v29, s[28:31], s93 offen offset:2048 lds
    v_cvt_pk_bf16_f32 v114, 0, v114
    v_fmac_f32 v90, v42, v58
    v_cvt_pk_bf16_f32 v117, 0, v117
    v_cvt_pk_bf16_f32 v118, 0, v118
    v_fmac_f32 v92, v50, v58
    v_add_f32 v91, v91, v113
    v_add_f32 v93, v93, v117
    s_cmp_lg_u32 s21, 0
    s_cbranch_scc1 L_noclr_3
    v_mov_b32 v104, -1
    v_mov_b32 v105, -1
    v_mov_b32 v106, -1
    v_mov_b32 v107, -1
    s_lshl_b32 s12, s19, 13
    s_lshl_b32 s13, s18, 9
    s_add_u32 s12, s12, s13
    s_add_u32 s12, s12, 32768
    s_lshl_b32 s13, s19, 11
    s_lshl_b32 s90, s18, 7
    s_add_u32 s13, s13, s90
    s_add_u32 s13, s13, 163840
    s_mov_b32 exec_hi, 0
    buffer_store_dwordx4 v[104:107], v5, s[32:35], s12 offen sc1
    s_mov_b32 exec_lo, 255
    buffer_store_dwordx4 v[104:107], v5, s[32:35], s13 offen sc1
    s_mov_b64 exec, -1
L_noclr_3:
    v_add_f32 v91, v91, v114
    v_add_f32 v93, v93, v118
    v_lshlrev_b32 v72, 16, v59
    v_and_b32 v59, s8, v59
    v_lshlrev_b32 v73, 16, v67
    v_and_b32 v67, s8, v67
    v_lshlrev_b32 v112, 16, v43
    v_and_b32 v43, s8, v43
    v_lshlrev_b32 v116, 16, v51
    v_and_b32 v51, s8, v51
    v_mul_f32 v113, v112, v73
    v_mul_f32 v114, v43, v67
    v_fmac_f32 v90, v112, v72
    v_mul_f32 v117, v116, v73
    v_mul_f32 v118, v51, v67
    v_fmac_f32 v92, v116, v72
    v_cvt_pk_bf16_f32 v113, 0, v113
    v_cvt_pk_bf16_f32 v114, 0, v114
    v_fmac_f32 v90, v43, v59
    v_cvt_pk_bf16_f32 v117, 0, v117
    v_cvt_pk_bf16_f32 v118, 0, v118
    v_fmac_f32 v92, v51, v59
    v_add_f32 v91, v91, v113
    v_add_f32 v93, v93, v117
    v_add_f32 v91, v91, v114
    s_barrier
    s_bfe_u32 s91, s68, 0x40010
    s_lshl_b32 s92, s91, 7
    s_mul_i32 s93, s91, 393216
    s_add_u32 m0, s94, 40960
    s_nop 0
    buffer_load_dwordx4 v20, s[24:27], s92 offen offset:0 lds
    v_add_f32 v93, v93, v118
    v_lshlrev_b32 v72, 16, v60
    v_and_b32 v60, s8, v60
    v_lshlrev_b32 v73, 16, v68
    v_and_b32 v68, s8, v68
    v_lshlrev_b32 v112, 16, v44
    v_and_b32 v44, s8, v44
    buffer_load_dwordx4 v21, s[24:27], s92 offen offset:1024 lds
    v_lshlrev_b32 v116, 16, v52
    v_and_b32 v52, s8, v52
    v_mul_f32 v113, v112, v73
    v_mul_f32 v114, v44, v68
    v_fmac_f32 v90, v112, v72
    v_mul_f32 v117, v116, v73
    v_mul_f32 v118, v52, v68
    buffer_load_dwordx4 v22, s[24:27], s92 offen offset:2048 lds
    v_fmac_f32 v92, v116, v72
    v_cvt_pk_bf16_f32 v113, 0, v113
    v_cvt_pk_bf16_f32 v114, 0, v114
    v_fmac_f32 v90, v44, v60
    v_cvt_pk_bf16_f32 v117, 0, v117
    v_cvt_pk_bf16_f32 v118, 0, v118
    v_fmac_f32 v92, v52, v60
    buffer_load_dwordx4 v23, s[24:27], s92 offen offset:3072 lds
    v_add_f32 v91, v91, v113
    v_add_f32 v93, v93, v117
    v_add_f32 v91, v91, v114
    v_add_f32 v93, v93, v118
    v_lshlrev_b32 v72, 16, v61
    v_and_b32 v61, s8, v61
    v_lshlrev_b32 v73, 16, v69
    s_add_u32 m0, s95, 40960
    s_nop 0
    buffer_load_dwordx4 v24, s[28:31], s93 offen offset:0 lds
    v_and_b32 v69, s8, v69
    v_lshlrev_b32 v112, 16, v45
    v_and_b32 v45, s8, v45
    v_lshlrev_b32 v116, 16, v53
    v_and_b32 v53, s8, v53
    v_mul_f32 v113, v112, v73
    v_mul_f32 v114, v45, v69
    buffer_load_dwordx4 v25, s[28:31], s93 offen offset:1024 lds
    v_fmac_f32 v90, v112, v72
    v_mul_f32 v117, v116, v73
    v_mul_f32 v118, v53, v69
    v_fmac_f32 v92, v116, v72
    v_cvt_pk_bf16_f32 v113, 0, v113
    v_cvt_pk_bf16_f32 v114, 0, v114
    v_fmac_f32 v90, v45, v61
    buffer_load_dwordx4 v26, s[28:31], s93 offen offset:2048 lds
    v_cvt_pk_bf16_f32 v117, 0, v117
    v_cvt_pk_bf16_f32 v118, 0, v118
    v_fmac_f32 v92, v53, v61
    v_add_f32 v91, v91, v113
    v_add_f32 v93, v93, v117
    v_add_f32 v91, v91, v114
    v_add_f32 v93, v93, v118
    s_add_u32 m0, s95, 44032
    s_nop 0
    buffer_load_dwordx4 v27, s[28:31], s93 offen offset:0 lds
    v_lshlrev_b32 v72, 16, v62
    v_and_b32 v62, s8, v62
    v_lshlrev_b32 v73, 16, v70
    v_and_b32 v70, s8, v70
    v_lshlrev_b32 v112, 16, v46
    v_and_b32 v46, s8, v46
    v_lshlrev_b32 v116, 16, v54
    buffer_load_dwordx4 v28, s[28:31], s93 offen offset:1024 lds
    v_and_b32 v54, s8, v54
    v_mul_f32 v113, v112, v73
    v_mul_f32 v114, v46, v70
    v_fmac_f32 v90, v112, v72
    v_mul_f32 v117, v116, v73
    v_mul_f32 v118, v54, v70
    v_fmac_f32 v92, v116, v72
    buffer_load_dwordx4 v29, s[28:31], s93 offen offset:2048 lds
    v_cvt_pk_bf16_f32 v113, 0, v113
    v_cvt_pk_bf16_f32 v114, 0, v114
    v_fmac_f32 v90, v46, v62
    v_cvt_pk_bf16_f32 v117, 0, v117
    v_cvt_pk_bf16_f32 v118, 0, v118
    v_fmac_f32 v92, v54, v62
    v_add_f32 v91, v91, v113
    buffer_load_dword v15, v13, s[72:75], 0 offen offset:4 sc1
    v_add_f32 v93, v93, v117
    v_add_f32 v91, v91, v114
    v_add_f32 v93, v93, v118
    v_lshlrev_b32 v72, 16, v63
    v_and_b32 v63, s8, v63
    v_lshlrev_b32 v73, 16, v71
    v_and_b32 v71, s8, v71
    v_lshlrev_b32 v112, 16, v47
    v_and_b32 v47, s8, v47
    v_lshlrev_b32 v116, 16, v55
    v_and_b32 v55, s8, v55
    v_mul_f32 v113, v112, v73
    v_mul_f32 v114, v47, v71
    v_fmac_f32 v90, v112, v72
    v_mul_f32 v117, v116, v73
    v_mul_f32 v118, v55, v71
    v_fmac_f32 v92, v116, v72
    v_cvt_pk_bf16_f32 v113, 0, v113
    v_cvt_pk_bf16_f32 v114, 0, v114
    v_fmac_f32 v90, v47, v63
    v_cvt_pk_bf16_f32 v117, 0, v117
    v_cvt_pk_bf16_f32 v118, 0, v118
    v_fmac_f32 v92, v55, v63
    v_add_f32 v91, v91, v113
    v_add_f32 v93, v93, v117
    s_waitcnt vmcnt(11)
    s_barrier
    s_bfe_u32 s91, s68, 0x40014
    s_lshl_b32 s92, s91, 7
    s_mul_i32 s93, s91, 393216
    s_add_u32 m0, s94, 81920
    s_nop 0
    buffer_load_dwordx4 v20, s[24:27], s92 offen offset:0 lds
    v_add_f32 v91, v91, v114
    v_add_f32 v93, v93, v118
    v_add_f32_dpp v90, v90, v90 row_shr:1 row_mask:0xf bank_mask:0xf
    v_add_f32_dpp v91, v91, v91 row_shr:1 row_mask:0xf bank_mask:0xf
    v_add_f32_dpp v92, v92, v92 row_shr:1 row_mask:0xf bank_mask:0xf
    v_add_f32_dpp v93, v93, v93 row_shr:1 row_mask:0xf bank_mask:0xf
    v_add_f32_dpp v90, v90, v90 row_shr:2 row_mask:0xf bank_mask:0xf
    buffer_load_dwordx4 v21, s[24:27], s92 offen offset:1024 lds
    v_add_f32_dpp v91, v91, v91 row_shr:2 row_mask:0xf bank_mask:0xf
    v_add_f32_dpp v92, v92, v92 row_shr:2 row_mask:0xf bank_mask:0xf
    v_add_f32_dpp v93, v93, v93 row_shr:2 row_mask:0xf bank_mask:0xf
    v_add_f32_dpp v90, v90, v90 row_shr:4 row_mask:0xf bank_mask:0xf
    v_add_f32_dpp v91, v91, v91 row_shr:4 row_mask:0xf bank_mask:0xf
    v_add_f32_dpp v92, v92, v92 row_shr:4 row_mask:0xf bank_mask:0xf
    v_add_f32_dpp v93, v93, v93 row_shr:4 row_mask:0xf bank_mask:0xf
    buffer_load_dwordx4 v22, s[24:27], s92 offen offset:2048 lds
    v_add_f32_dpp v90, v90, v90 row_shr:8 row_mask:0xf bank_mask:0xf
    v_add_f32_dpp v91, v91, v91 row_shr:8 row_mask:0xf bank_mask:0xf
    v_add_f32_dpp v92, v92, v92 row_shr:8 row_mask:0xf bank_mask:0xf
    v_add_f32_dpp v93, v93, v93 row_shr:8 row_mask:0xf bank_mask:0xf
    v_add_f32_dpp v90, v90, v90 row_bcast:15 row_mask:0xa bank_mask:0xf
    v_add_f32_dpp v91, v91, v91 row_bcast:15 row_mask:0xa bank_mask:0xf
    v_add_f32_dpp v92, v92, v92 row_bcast:15 row_mask:0xa bank_mask:0xf
    buffer_load_dwordx4 v23, s[24:27], s92 offen offset:3072 lds
    v_add_f32_dpp v93, v93, v93 row_bcast:15 row_mask:0xa bank_mask:0xf
    v_add_f32_dpp v90, v90, v90 row_bcast:31 row_mask:0xc bank_mask:0xf
    v_add_f32_dpp v91, v91, v91 row_bcast:31 row_mask:0xc bank_mask:0xf
    v_add_f32_dpp v92, v92, v92 row_bcast:31 row_mask:0xc bank_mask:0xf
    v_add_f32_dpp v93, v93, v93 row_bcast:31 row_mask:0xc bank_mask:0xf
    v_mov_b32 v97, 0x8000
    v_mov_b32 v98, 0xffff
    s_add_u32 m0, s95, 81920
    s_nop 0
    buffer_load_dwordx4 v24, s[28:31], s93 offen offset:0 lds
    v_cvt_pk_bf16_f32 v94, v90, v91
    v_cvt_pk_bf16_f32 v104, v92, v93
    v_and_b32 v95, 0xffff, v94
    v_and_b32 v96, 0x8000, v94
    v_and_b32 v94, 0xffff0000, v94
    v_cmp_ne_u32 vcc, 0, v96
    v_mul_f32 v94, 0xbfb8aa3b, v94
    buffer_load_dwordx4 v25, s[28:31], s93 offen offset:1024 lds
    v_exp_f32 v94, v94
    v_cndmask_b32 v96, v97, v98, vcc
    v_xor_b32 v95, v95, v96
    v_add_f32 v94, 1.0, v94
    v_lshlrev_b32 v95, 11, v95
    v_rcp_f32 v94, v94
    s_sub_u32 s12, 2047, s22
    v_or_b32 v100, s12, v95
    buffer_load_dwordx4 v26, s[28:31], s93 offen offset:2048 lds
    v_cvt_pk_bf16_f32 v94, v94, v94
    v_lshlrev_b32 v102, 16, v94
    v_and_b32 v105, 0xffff, v104
    v_and_b32 v106, 0x8000, v104
    v_and_b32 v104, 0xffff0000, v104
    v_cmp_ne_u32 vcc, 0, v106
    v_mul_f32 v104, 0xbfb8aa3b, v104
    s_add_u32 m0, s95, 84992
    s_nop 0
    buffer_load_dwordx4 v27, s[28:31], s93 offen offset:0 lds
    v_exp_f32 v104, v104
    v_cndmask_b32 v106, v97, v98, vcc
    v_xor_b32 v105, v105, v106
    v_add_f32 v104, 1.0, v104
    v_lshlrev_b32 v105, 11, v105
    v_rcp_f32 v104, v104
    s_sub_u32 s12, 2046, s22
    v_or_b32 v101, s12, v105
    buffer_load_dwordx4 v28, s[28:31], s93 offen offset:1024 lds
    v_cvt_pk_bf16_f32 v104, v104, v104
    v_lshlrev_b32 v103, 16, v104
    v_max_u32 v100, v100, v101
    s_lshl_b32 s12, s22, 2
    s_add_u32 s12, s12, 4096
    s_lshl_b32 s13, s21, 2
    s_add_u32 s13, s13, 162880
    v_mov_b32 v14, s13
    s_mov_b32 exec_lo, 0
    s_mov_b32 exec_hi, 0x80000000
    buffer_store_dwordx2 v[102:103], v13, s[32:35], s12 offen sc1
    ds_write_b32 v14, v100
    s_mov_b64 exec, -1
    s_waitcnt lgkmcnt(0)
    buffer_load_dwordx4 v29, s[28:31], s93 offen offset:2048 lds
    s_cmp_ge_u32 s10, 224
    s_cbranch_scc1 L_p30_3
    s_add_u32 s12, s71, 0
    buffer_load_dwordx4 v[128:131], v30, s[40:43], s12 offen nt
    s_add_u32 s12, s71, 7168
    buffer_load_dwordx4 v[132:135], v30, s[40:43], s12 offen nt
    s_add_u32 s12, s71, 14336
    buffer_load_dwordx4 v[136:139], v30, s[40:43], s12 offen nt
    s_add_u32 s12, s71, 21504
    buffer_load_dwordx4 v[140:143], v30, s[40:43], s12 offen nt
    s_add_u32 s12, s71, 28672
    buffer_load_dwordx4 v[144:147], v30, s[40:43], s12 offen nt
    s_add_u32 s12, s71, 35840
    buffer_load_dwordx4 v[148:151], v30, s[40:43], s12 offen nt
    s_add_u32 s12, s71, 43008
    buffer_load_dwordx4 v[152:155], v30, s[40:43], s12 offen nt
    s_add_u32 s12, s71, 50176
    buffer_load_dwordx4 v[156:159], v30, s[40:43], s12 offen nt
    s_branch L_p3e0_3
L_p30_3:
    s_mov_b64 exec, 63
    s_bfe_u32 s12, s68, 0x4000c
    s_mul_i32 s12, s12, 393216
    buffer_load_dword v128, v32, s[28:31], s12 offen
    s_bfe_u32 s12, s68, 0x40010
    s_mul_i32 s12, s12, 393216
    buffer_load_dword v132, v32, s[28:31], s12 offen
    s_bfe_u32 s12, s68, 0x40014
    s_mul_i32 s12, s12, 393216
    buffer_load_dword v136, v32, s[28:31], s12 offen
    s_bfe_u32 s12, s68, 0x40018
    s_mul_i32 s12, s12, 393216
    buffer_load_dword v140, v32, s[28:31], s12 offen
    s_bfe_u32 s12, s68, 0x4001c
    s_mul_i32 s12, s12, 393216
    buffer_load_dword v144, v32, s[28:31], s12 offen
    s_bfe_u32 s12, s69, 0x40000
    s_mul_i32 s12, s12, 393216
    buffer_load_dword v148, v32, s[28:31], s12 offen
    s_bfe_u32 s12, s69, 0x40004
    s_mul_i32 s12, s12, 393216
    buffer_load_dword v152, v32, s[28:31], s12 offen
    s_bfe_u32 s12, s69, 0x40008
    s_mul_i32 s12, s12, 393216
    buffer_load_dword v156, v32, s[28:31], s12 offen
    s_mov_b64 exec, -1
L_p3e0_3:
    s_waitcnt vmcnt(20)
    s_barrier
    s_bfe_u32 s91, s68, 0x40018
    s_lshl_b32 s92, s91, 7
    s_mul_i32 s93, s91, 393216
    s_add_u32 m0, s94, 0
    s_nop 0
    buffer_load_dwordx4 v20, s[24:27], s92 offen offset:0 lds
    buffer_load_dwordx4 v21, s[24:27], s92 offen offset:1024 lds
    buffer_load_dwordx4 v22, s[24:27], s92 offen offset:2048 lds
    buffer_load_dwordx4 v23, s[24:27], s92 offen offset:3072 lds
    s_add_u32 m0, s95, 0
    s_nop 0
    buffer_load_dwordx4 v24, s[28:31], s93 offen offset:0 lds
    s_waitcnt vmcnt(14)
    s_waitcnt vmcnt(13)
    s_barrier
    s_add_u32 m0, s95, 0
    s_nop 0
    buffer_load_dwordx4 v25, s[28:31], s93 offen offset:1024 lds
    buffer_load_dwordx4 v26, s[28:31], s93 offen offset:2048 lds
    s_add_u32 m0, s95, 3072
    s_nop 0
    buffer_load_dwordx4 v27, s[28:31], s93 offen offset:0 lds
    buffer_load_dwordx4 v28, s[28:31], s93 offen offset:1024 lds
    buffer_load_dwordx4 v29, s[28:31], s93 offen offset:2048 lds
    s_bfe_u32 s91, s68, 0x4001c
    s_lshl_b32 s92, s91, 7
    s_mul_i32 s93, s91, 393216
    s_add_u32 m0, s94, 40960
    s_nop 0
    buffer_load_dwordx4 v20, s[24:27], s92 offen offset:0 lds
    buffer_load_dwordx4 v21, s[24:27], s92 offen offset:1024 lds
    buffer_load_dwordx4 v22, s[24:27], s92 offen offset:2048 lds
    buffer_load_dwordx4 v23, s[24:27], s92 offen offset:3072 lds
    s_add_u32 m0, s95, 40960
    s_nop 0
    buffer_load_dwordx4 v24, s[28:31], s93 offen offset:0 lds
    buffer_load_dwordx4 v25, s[28:31], s93 offen offset:1024 lds
    buffer_load_dwordx4 v26, s[28:31], s93 offen offset:2048 lds
    s_mov_b32 s13, 0
L_tagchk_3:
    v_readfirstlane_b32 s23, v15
    s_nop 1
    s_cmp_lg_u32 s23, 0
    s_cbranch_scc1 L_tagok_3
    s_add_u32 s13, s13, 1
    s_cmp_ge_u32 s13, 16384
    s_cbranch_scc1 L_tagok_3
    buffer_load_dword v15, v13, s[72:75], 0 offen offset:4 sc1
    s_waitcnt vmcnt(0)
    s_branch L_tagchk_3
L_tagok_3:
    s_and_b32 s76, s23, 0xff
    s_bfe_u32 s77, s23, 0x80008
    s_bfe_u32 s78, s23, 0x80010
    s_lshr_b32 s79, s23, 24
    v_and_b32 v35, 3, v2
    v_lshlrev_b32 v35, 3, v35
    v_bfe_u32 v35, s23, v35, 8
    s_cmp_lg_u32 s21, 0
    s_cbranch_scc1 L_nopub_3
    v_mov_b32 v14, 162880
    ds_read_b128 v[104:107], v14
    s_lshl_b32 s12, s2, 3
    s_add_u32 s12, s12, 0
    s_waitcnt lgkmcnt(0)
    v_max3_u32 v104, v104, v105, v106
    v_max_u32 v104, v104, v107
    v_mov_b32 v105, s23
    s_mov_b64 exec, 1
    buffer_store_dwordx2 v[104:105], v13, s[32:35], s12 offen sc1
    s_mov_b64 exec, -1
L_nopub_3:
    s_waitcnt vmcnt(7)
    s_barrier
    s_add_u32 m0, s95, 44032
    s_nop 0
    buffer_load_dwordx4 v27, s[28:31], s93 offen offset:0 lds
    buffer_load_dwordx4 v28, s[28:31], s93 offen offset:1024 lds
    buffer_load_dwordx4 v29, s[28:31], s93 offen offset:2048 lds
    s_bfe_u32 s91, s69, 0x40000
    s_lshl_b32 s92, s91, 7
    s_mul_i32 s93, s91, 393216
    s_add_u32 m0, s94, 81920
    s_nop 0
    buffer_load_dwordx4 v20, s[24:27], s92 offen offset:0 lds
    buffer_load_dwordx4 v21, s[24:27], s92 offen offset:1024 lds
    buffer_load_dwordx4 v22, s[24:27], s92 offen offset:2048 lds
    buffer_load_dwordx4 v23, s[24:27], s92 offen offset:3072 lds
    s_add_u32 m0, s95, 81920
    s_nop 0
    buffer_load_dwordx4 v24, s[28:31], s93 offen offset:0 lds
    buffer_load_dwordx4 v25, s[28:31], s93 offen offset:1024 lds
    buffer_load_dwordx4 v26, s[28:31], s93 offen offset:2048 lds
    s_add_u32 m0, s95, 84992
    s_nop 0
    buffer_load_dwordx4 v27, s[28:31], s93 offen offset:0 lds
    buffer_load_dwordx4 v28, s[28:31], s93 offen offset:1024 lds
    s_waitcnt vmcnt(9)
    s_barrier
    s_add_u32 m0, s95, 84992
    s_nop 0
    buffer_load_dwordx4 v29, s[28:31], s93 offen offset:2048 lds
    s_bfe_u32 s91, s69, 0x40004
    s_lshl_b32 s92, s91, 7
    s_mul_i32 s93, s91, 393216
    s_add_u32 m0, s94, 0
    s_nop 0
    buffer_load_dwordx4 v20, s[24:27], s92 offen offset:0 lds
    buffer_load_dwordx4 v21, s[24:27], s92 offen offset:1024 lds
    buffer_load_dwordx4 v22, s[24:27], s92 offen offset:2048 lds
    buffer_load_dwordx4 v23, s[24:27], s92 offen offset:3072 lds
    s_add_u32 m0, s95, 0
    s_nop 0
    buffer_load_dwordx4 v24, s[28:31], s93 offen offset:0 lds
    buffer_load_dwordx4 v25, s[28:31], s93 offen offset:1024 lds
    buffer_load_dwordx4 v26, s[28:31], s93 offen offset:2048 lds
    s_add_u32 m0, s95, 3072
    s_nop 0
    buffer_load_dwordx4 v27, s[28:31], s93 offen offset:0 lds
    buffer_load_dwordx4 v28, s[28:31], s93 offen offset:1024 lds
    buffer_load_dwordx4 v29, s[28:31], s93 offen offset:2048 lds
    s_waitcnt vmcnt(10)
    s_barrier
    s_bfe_u32 s91, s69, 0x40008
    s_lshl_b32 s92, s91, 7
    s_mul_i32 s93, s91, 393216
    s_add_u32 m0, s94, 40960
    s_nop 0
    buffer_load_dwordx4 v20, s[24:27], s92 offen offset:0 lds
    buffer_load_dwordx4 v21, s[24:27], s92 offen offset:1024 lds
    buffer_load_dwordx4 v22, s[24:27], s92 offen offset:2048 lds
    buffer_load_dwordx4 v23, s[24:27], s92 offen offset:3072 lds
    s_add_u32 m0, s95, 40960
    s_nop 0
    buffer_load_dwordx4 v24, s[28:31], s93 offen offset:0 lds
    buffer_load_dwordx4 v25, s[28:31], s93 offen offset:1024 lds
    buffer_load_dwordx4 v26, s[28:31], s93 offen offset:2048 lds
    s_add_u32 m0, s95, 44032
    s_nop 0
    buffer_load_dwordx4 v27, s[28:31], s93 offen offset:0 lds
    buffer_load_dwordx4 v28, s[28:31], s93 offen offset:1024 lds
    buffer_load_dwordx4 v29, s[28:31], s93 offen offset:2048 lds
    s_cmp_ge_u32 s10, 224
    s_cbranch_scc1 L_p31_3
    s_add_u32 s12, s9, 0
    buffer_load_dwordx4 v[160:163], v30, s[44:47], s12 offen nt
    s_add_u32 s12, s9, 7168
    buffer_load_dwordx4 v[164:167], v30, s[44:47], s12 offen nt
    s_add_u32 s12, s9, 14336
    buffer_load_dwordx4 v[168:171], v30, s[44:47], s12 offen nt
    s_add_u32 s12, s9, 21504
    buffer_load_dwordx4 v[172:175], v30, s[44:47], s12 offen nt
    s_add_u32 s12, s9, 28672
    buffer_load_dwordx4 v[176:179], v30, s[44:47], s12 offen nt
    s_add_u32 s12, s9, 35840
    buffer_load_dwordx4 v[180:183], v30, s[44:47], s12 offen nt
    s_add_u32 s12, s9, 43008
    buffer_load_dwordx4 v[184:187], v30, s[44:47], s12 offen nt
    s_add_u32 s12, s9, 50176
    buffer_load_dwordx4 v[188:191], v30, s[44:47], s12 offen nt
    s_branch L_p3e1_3
L_p31_3:
    s_mov_b64 exec, 63
    s_bfe_u32 s12, s69, 0x4000c
    s_mul_i32 s12, s12, 393216
    buffer_load_dword v160, v32, s[28:31], s12 offen
    s_bfe_u32 s12, s69, 0x40010
    s_mul_i32 s12, s12, 393216
    buffer_load_dword v164, v32, s[28:31], s12 offen
    s_bfe_u32 s12, s69, 0x40014
    s_mul_i32 s12, s12, 393216
    buffer_load_dword v168, v32, s[28:31], s12 offen
    s_bfe_u32 s12, s69, 0x40018
    s_mul_i32 s12, s12, 393216
    buffer_load_dword v172, v32, s[28:31], s12 offen
    s_bfe_u32 s12, s69, 0x4001c
    s_mul_i32 s12, s12, 393216
    buffer_load_dword v176, v32, s[28:31], s12 offen
    s_mov_b64 exec, 1
    s_bfe_u32 s12, s69, 0x4001c
    s_mul_i32 s12, s12, 393216
    buffer_load_dword v180, v32, s[28:31], s12 offen
    s_bfe_u32 s12, s69, 0x4001c
    s_mul_i32 s12, s12, 393216
    buffer_load_dword v184, v32, s[28:31], s12 offen
    s_bfe_u32 s12, s69, 0x4001c
    s_mul_i32 s12, s12, 393216
    buffer_load_dword v188, v32, s[28:31], s12 offen
    s_mov_b64 exec, -1
L_p3e1_3:
    s_mov_b32 exec_lo, 0xffff0000
    s_mov_b32 exec_hi, 0
    buffer_load_dword v19, v10, s[36:39], 0 offen
    s_mov_b64 exec, -1
    s_waitcnt vmcnt(19)
    s_barrier
    s_bfe_u32 s91, s69, 0x4000c
    s_lshl_b32 s92, s91, 7
    s_mul_i32 s93, s91, 393216
    s_add_u32 m0, s94, 81920
    s_nop 0
    buffer_load_dwordx4 v20, s[24:27], s92 offen offset:0 lds
    buffer_load_dwordx4 v21, s[24:27], s92 offen offset:1024 lds
    buffer_load_dwordx4 v22, s[24:27], s92 offen offset:2048 lds
    buffer_load_dwordx4 v23, s[24:27], s92 offen offset:3072 lds
    s_add_u32 m0, s95, 81920
    s_nop 0
    buffer_load_dwordx4 v24, s[28:31], s93 offen offset:0 lds
    s_mov_b32 s12, 0
    buffer_load_dwordx4 v[104:107], v5, s[32:35], s12 offen offset:0 sc1
    buffer_load_dwordx4 v[108:111], v5, s[32:35], s12 offen offset:1024 sc1
    s_waitcnt vmcnt(16)
    s_barrier
    s_add_u32 m0, s95, 81920
    s_nop 0
    buffer_load_dwordx4 v25, s[28:31], s93 offen offset:1024 lds
    buffer_load_dwordx4 v26, s[28:31], s93 offen offset:2048 lds
    s_add_u32 m0, s95, 84992
    s_nop 0
    buffer_load_dwordx4 v27, s[28:31], s93 offen offset:0 lds
    buffer_load_dwordx4 v28, s[28:31], s93 offen offset:1024 lds
    buffer_load_dwordx4 v29, s[28:31], s93 offen offset:2048 lds
    s_bfe_u32 s91, s69, 0x40010
    s_lshl_b32 s92, s91, 7
    s_mul_i32 s93, s91, 393216
    s_add_u32 m0, s94, 0
    s_nop 0
    buffer_load_dwordx4 v20, s[24:27], s92 offen offset:0 lds
    buffer_load_dwordx4 v21, s[24:27], s92 offen offset:1024 lds
    buffer_load_dwordx4 v22, s[24:27], s92 offen offset:2048 lds
    buffer_load_dwordx4 v23, s[24:27], s92 offen offset:3072 lds
    s_add_u32 m0, s95, 0
    s_nop 0
    buffer_load_dwordx4 v24, s[28:31], s93 offen offset:0 lds
    buffer_load_dwordx4 v25, s[28:31], s93 offen offset:1024 lds
    buffer_load_dwordx4 v26, s[28:31], s93 offen offset:2048 lds
    s_waitcnt vmcnt(7)
    s_barrier
    s_add_u32 m0, s95, 3072
    s_nop 0
    buffer_load_dwordx4 v27, s[28:31], s93 offen offset:0 lds
    s_mov_b32 s13, 0
    v_xor_b32 v105, s23, v105
    v_xor_b32 v107, s23, v107
    v_xor_b32 v109, s23, v109
    v_xor_b32 v111, s23, v111
    v_or3_b32 v105, v105, v107, v109
    v_or_b32 v105, v105, v111
    v_cmp_ne_u32 vcc, 0, v105
    s_cbranch_vccnz L_keyre_3
L_keyok_3:
    buffer_load_dwordx4 v28, s[28:31], s93 offen offset:1024 lds
    v_max3_u32 v104, v104, v106, v108
    v_max_u32 v104, v104, v110
    s_nop 1
    v_max_u32_dpp v104, v104, v104 row_shr:1 row_mask:0xf bank_mask:0xf
    s_nop 1
    v_max_u32_dpp v104, v104, v104 row_shr:2 row_mask:0xf bank_mask:0xf
    s_nop 1
    v_max_u32_dpp v104, v104, v104 row_shr:4 row_mask:0xf bank_mask:0xf
    s_nop 1
    v_max_u32_dpp v104, v104, v104 row_shr:8 row_mask:0xf bank_mask:0xf
    s_nop 1
    v_max_u32_dpp v104, v104, v104 row_bcast:15 row_mask:0xa bank_mask:0xf
    buffer_load_dwordx4 v29, s[28:31], s93 offen offset:2048 lds
    s_nop 0
    v_max_u32_dpp v104, v104, v104 row_bcast:31 row_mask:0xc bank_mask:0xf
    s_nop 0
    v_readlane_b32 s14, v104, 63
    s_nop 1
    s_and_b32 s15, s14, 2047
    s_sub_u32 s15, 2047, s15
    s_lshl_b32 s12, s15, 11
    s_lshl_b32 s13, s70, 1
    s_add_u32 s12, s12, s13
    buffer_load_dwordx4 v[36:39], v34, s[24:27], s12 offen
    s_lshr_b32 s12, s14, 11
    s_and_b32 s13, s12, 0x8000
    s_cmp_lg_u32 s13, 0
    s_mov_b32 s13, 0xffff
    s_cselect_b32 s13, 0x8000, s13
    s_xor_b32 s12, s12, s13
    s_lshl_b32 s12, s12, 16
    v_mov_b32 v105, s12
    s_bfe_u32 s91, s69, 0x40014
    s_lshl_b32 s92, s91, 7
    s_mul_i32 s93, s91, 393216
    s_add_u32 m0, s94, 40960
    s_nop 0
    buffer_load_dwordx4 v20, s[24:27], s92 offen offset:0 lds
    v_mul_f32 v105, 0xbfb8aa3b, v105
    v_exp_f32 v105, v105
    s_nop 0
    v_add_f32 v105, 1.0, v105
    v_rcp_f32 v105, v105
    s_nop 0
    v_cvt_pk_bf16_f32 v105, v105, v105
    v_lshlrev_b32 v105, 16, v105
    s_add_u32 s12, s15, 1
    v_mov_b32 v104, s12
    buffer_load_dwordx4 v21, s[24:27], s92 offen offset:1024 lds
    v_mov_b32 v106, s23
    v_readfirstlane_b32 s14, v105
    v_mov_b32 v14, 162864
    s_mov_b64 exec, 1
    ds_write_b96 v14, v[104:106]
    s_mov_b64 exec, -1
    s_waitcnt lgkmcnt(0)
    buffer_load_dwordx4 v22, s[24:27], s92 offen offset:2048 lds
    buffer_load_dwordx4 v23, s[24:27], s92 offen offset:3072 lds
    s_add_u32 m0, s95, 40960
    s_nop 0
    buffer_load_dwordx4 v24, s[28:31], s93 offen offset:0 lds
    buffer_load_dwordx4 v25, s[28:31], s93 offen offset:1024 lds
    buffer_load_dwordx4 v26, s[28:31], s93 offen offset:2048 lds
    s_add_u32 m0, s95, 44032
    s_nop 0
    buffer_load_dwordx4 v27, s[28:31], s93 offen offset:0 lds
    buffer_load_dwordx4 v28, s[28:31], s93 offen offset:1024 lds
    s_waitcnt vmcnt(10)
    s_barrier
    s_add_u32 m0, s95, 44032
    s_nop 0
    buffer_load_dwordx4 v29, s[28:31], s93 offen offset:2048 lds
    s_waitcnt vmcnt(10)
    s_mov_b32 s8, 0xffff0000
    v_lshlrev_b32 v40, 16, v36
    v_and_b32 v41, s8, v36
    v_lshlrev_b32 v42, 16, v37
    v_and_b32 v43, s8, v37
    v_lshlrev_b32 v44, 16, v38
    s_bfe_u32 s91, s69, 0x40018
    s_lshl_b32 s92, s91, 7
    s_mul_i32 s93, s91, 393216
    s_add_u32 m0, s94, 81920
    s_nop 0
    buffer_load_dwordx4 v20, s[24:27], s92 offen offset:0 lds
    v_and_b32 v45, s8, v38
    v_lshlrev_b32 v46, 16, v39
    v_and_b32 v47, s8, v39
    v_lshlrev_b32 v48, 16, v128
    v_lshlrev_b32 v49, 16, v129
    v_and_b32 v128, s8, v128
    v_and_b32 v129, s8, v129
    buffer_load_dwordx4 v21, s[24:27], s92 offen offset:1024 lds
    v_mul_f32 v220, v48, v40
    v_mul_f32 v222, v49, v40
    v_mul_f32 v221, v128, v40
    v_mul_f32 v223, v129, v40
    v_lshlrev_b32 v50, 16, v130
    v_lshlrev_b32 v51, 16, v131
    v_and_b32 v130, s8, v130
    buffer_load_dwordx4 v22, s[24:27], s92 offen offset:2048 lds
    v_and_b32 v131, s8, v131
    v_mul_f32 v224, v50, v40
    v_mul_f32 v226, v51, v40
    v_mul_f32 v225, v130, v40
    v_mul_f32 v227, v131, v40
    v_lshlrev_b32 v48, 16, v160
    v_lshlrev_b32 v49, 16, v161
    buffer_load_dwordx4 v23, s[24:27], s92 offen offset:3072 lds
    v_and_b32 v160, s8, v160
    v_and_b32 v161, s8, v161
    v_mul_f32 v228, v48, v40
    v_mul_f32 v230, v49, v40
    v_mul_f32 v229, v160, v40
    v_mul_f32 v231, v161, v40
    v_lshlrev_b32 v50, 16, v162
    s_add_u32 m0, s95, 81920
    s_nop 0
    buffer_load_dwordx4 v24, s[28:31], s93 offen offset:0 lds
    v_lshlrev_b32 v51, 16, v163
    v_and_b32 v162, s8, v162
    v_and_b32 v163, s8, v163
    v_mul_f32 v232, v50, v40
    v_mul_f32 v234, v51, v40
    v_mul_f32 v233, v162, v40
    v_mul_f32 v235, v163, v40
    buffer_load_dwordx4 v25, s[28:31], s93 offen offset:1024 lds
    v_lshlrev_b32 v48, 16, v132
    v_lshlrev_b32 v49, 16, v133
    v_and_b32 v132, s8, v132
    v_and_b32 v133, s8, v133
    v_fmac_f32 v220, v48, v41
    v_fmac_f32 v222, v49, v41
    v_fmac_f32 v221, v132, v41
    buffer_load_dwordx4 v26, s[28:31], s93 offen offset:2048 lds
    v_fmac_f32 v223, v133, v41
    v_lshlrev_b32 v50, 16, v134
    v_lshlrev_b32 v51, 16, v135
    v_and_b32 v134, s8, v134
    v_and_b32 v135, s8, v135
    v_fmac_f32 v224, v50, v41
    v_fmac_f32 v226, v51, v41
    s_add_u32 m0, s95, 84992
    s_nop 0
    buffer_load_dwordx4 v27, s[28:31], s93 offen offset:0 lds
    v_fmac_f32 v225, v134, v41
    v_fmac_f32 v227, v135, v41
    v_lshlrev_b32 v48, 16, v164
    v_lshlrev_b32 v49, 16, v165
    v_and_b32 v164, s8, v164
    v_and_b32 v165, s8, v165
    v_fmac_f32 v228, v48, v41
    buffer_load_dwordx4 v28, s[28:31], s93 offen offset:1024 lds
    v_fmac_f32 v230, v49, v41
    v_fmac_f32 v229, v164, v41
    v_fmac_f32 v231, v165, v41
    v_lshlrev_b32 v50, 16, v166
    v_lshlrev_b32 v51, 16, v167
    v_and_b32 v166, s8, v166
    v_and_b32 v167, s8, v167
    buffer_load_dwordx4 v29, s[28:31], s93 offen offset:2048 lds
    v_fmac_f32 v232, v50, v41
    v_fmac_f32 v234, v51, v41
    v_fmac_f32 v233, v166, v41
    v_fmac_f32 v235, v167, v41
    v_lshlrev_b32 v48, 16, v136
    v_lshlrev_b32 v49, 16, v137
    v_and_b32 v136, s8, v136
    v_and_b32 v137, s8, v137
    v_fmac_f32 v220, v48, v42
    v_fmac_f32 v222, v49, v42
    v_fmac_f32 v221, v136, v42
    v_fmac_f32 v223, v137, v42
    v_lshlrev_b32 v50, 16, v138
    v_lshlrev_b32 v51, 16, v139
    v_and_b32 v138, s8, v138
    v_and_b32 v139, s8, v139
    v_fmac_f32 v224, v50, v42
    v_fmac_f32 v226, v51, v42
    v_fmac_f32 v225, v138, v42
    v_fmac_f32 v227, v139, v42
    v_lshlrev_b32 v48, 16, v168
    v_lshlrev_b32 v49, 16, v169
    v_and_b32 v168, s8, v168
    v_and_b32 v169, s8, v169
    v_fmac_f32 v228, v48, v42
    v_fmac_f32 v230, v49, v42
    v_fmac_f32 v229, v168, v42
    v_fmac_f32 v231, v169, v42
    v_lshlrev_b32 v50, 16, v170
    v_lshlrev_b32 v51, 16, v171
    v_and_b32 v170, s8, v170
    v_and_b32 v171, s8, v171
    s_waitcnt vmcnt(10)
    s_barrier
    s_bfe_u32 s91, s69, 0x4001c
    s_lshl_b32 s92, s91, 7
    s_mul_i32 s93, s91, 393216
    s_add_u32 m0, s94, 0
    s_nop 0
    buffer_load_dwordx4 v20, s[24:27], s92 offen offset:0 lds
    v_fmac_f32 v232, v50, v42
    v_fmac_f32 v234, v51, v42
    v_fmac_f32 v233, v170, v42
    v_fmac_f32 v235, v171, v42
    v_lshlrev_b32 v48, 16, v140
    v_lshlrev_b32 v49, 16, v141
    v_and_b32 v140, s8, v140
    buffer_load_dwordx4 v21, s[24:27], s92 offen offset:1024 lds
    v_and_b32 v141, s8, v141
    v_fmac_f32 v220, v48, v43
    v_fmac_f32 v222, v49, v43
    v_fmac_f32 v221, v140, v43
    v_fmac_f32 v223, v141, v43
    v_lshlrev_b32 v50, 16, v142
    v_lshlrev_b32 v51, 16, v143
    buffer_load_dwordx4 v22, s[24:27], s92 offen offset:2048 lds
    v_and_b32 v142, s8, v142
    v_and_b32 v143, s8, v143
    v_fmac_f32 v224, v50, v43
    v_fmac_f32 v226, v51, v43
    v_fmac_f32 v225, v142, v43
    v_fmac_f32 v227, v143, v43
    v_lshlrev_b32 v48, 16, v172
    buffer_load_dwordx4 v23, s[24:27], s92 offen offset:3072 lds
    v_lshlrev_b32 v49, 16, v173
    v_and_b32 v172, s8, v172
    v_and_b32 v173, s8, v173
    v_fmac_f32 v228, v48, v43
    v_fmac_f32 v230, v49, v43
    v_fmac_f32 v229, v172, v43
    v_fmac_f32 v231, v173, v43
    s_add_u32 m0, s95, 0
    s_nop 0
    buffer_load_dwordx4 v24, s[28:31], s93 offen offset:0 lds
    v_lshlrev_b32 v50, 16, v174
    v_lshlrev_b32 v51, 16, v175
    v_and_b32 v174, s8, v174
    v_and_b32 v175, s8, v175
    v_fmac_f32 v232, v50, v43
    v_fmac_f32 v234, v51, v43
    v_fmac_f32 v233, v174, v43
    buffer_load_dwordx4 v25, s[28:31], s93 offen offset:1024 lds
    v_fmac_f32 v235, v175, v43
    v_lshlrev_b32 v48, 16, v144
    v_lshlrev_b32 v49, 16, v145
    v_and_b32 v144, s8, v144
    v_and_b32 v145, s8, v145
    v_fmac_f32 v220, v48, v44
    v_fmac_f32 v222, v49, v44
    buffer_load_dwordx4 v26, s[28:31], s93 offen offset:2048 lds
    v_fmac_f32 v221, v144, v44
    v_fmac_f32 v223, v145, v44
    v_lshlrev_b32 v50, 16, v146
    v_lshlrev_b32 v51, 16, v147
    v_and_b32 v146, s8, v146
    v_and_b32 v147, s8, v147
    v_fmac_f32 v224, v50, v44
    s_add_u32 m0, s95, 3072
    s_nop 0
    buffer_load_dwordx4 v27, s[28:31], s93 offen offset:0 lds
    v_fmac_f32 v226, v51, v44
    v_fmac_f32 v225, v146, v44
    v_fmac_f32 v227, v147, v44
    v_lshlrev_b32 v48, 16, v176
    v_lshlrev_b32 v49, 16, v177
    v_and_b32 v176, s8, v176
    v_and_b32 v177, s8, v177
    buffer_load_dwordx4 v28, s[28:31], s93 offen offset:1024 lds
    v_fmac_f32 v228, v48, v44
    v_fmac_f32 v230, v49, v44
    v_fmac_f32 v229, v176, v44
    v_fmac_f32 v231, v177, v44
    v_lshlrev_b32 v50, 16, v178
    v_lshlrev_b32 v51, 16, v179
    v_and_b32 v178, s8, v178
    buffer_load_dwordx4 v29, s[28:31], s93 offen offset:2048 lds
    v_and_b32 v179, s8, v179
    v_fmac_f32 v232, v50, v44
    v_fmac_f32 v234, v51, v44
    v_fmac_f32 v233, v178, v44
    v_fmac_f32 v235, v179, v44
    v_lshlrev_b32 v48, 16, v148
    v_lshlrev_b32 v49, 16, v149
    s_add_u32 s12, s97, 0
    buffer_load_dwordx4 v[192:195], v31, s[64:67], s12 offen nt
    s_add_u32 s12, s97, 16384
    buffer_load_dwordx4 v[196:199], v31, s[64:67], s12 offen nt
    s_add_u32 s12, s97, 32768
    buffer_load_dwordx4 v[200:203], v31, s[64:67], s12 offen nt
    s_add_u32 s12, s97, 49152
    buffer_load_dwordx4 v[204:207], v31, s[64:67], s12 offen nt
    s_add_u32 s12, s97, 65536
    buffer_load_dwordx4 v[208:211], v31, s[64:67], s12 offen nt
    s_add_u32 s12, s97, 81920
    buffer_load_dwordx4 v[212:215], v31, s[64:67], s12 offen nt
    s_add_u32 s12, s97, 98304
    buffer_load_dwordx4 v[216:219], v31, s[64:67], s12 offen nt
    v_and_b32 v148, s8, v148
    v_and_b32 v149, s8, v149
    v_fmac_f32 v220, v48, v45
    v_fmac_f32 v222, v49, v45
    v_fmac_f32 v221, v148, v45
    v_fmac_f32 v223, v149, v45
    v_lshlrev_b32 v50, 16, v150
    v_lshlrev_b32 v51, 16, v151
    v_and_b32 v150, s8, v150
    v_and_b32 v151, s8, v151
    v_fmac_f32 v224, v50, v45
    v_fmac_f32 v226, v51, v45
    v_fmac_f32 v225, v150, v45
    v_fmac_f32 v227, v151, v45
    v_lshlrev_b32 v48, 16, v180
    v_lshlrev_b32 v49, 16, v181
    v_and_b32 v180, s8, v180
    v_and_b32 v181, s8, v181
    v_fmac_f32 v228, v48, v45
    v_fmac_f32 v230, v49, v45
    v_fmac_f32 v229, v180, v45
    v_fmac_f32 v231, v181, v45
    v_lshlrev_b32 v50, 16, v182
    v_lshlrev_b32 v51, 16, v183
    v_and_b32 v182, s8, v182
    s_waitcnt vmcnt(17)
    s_barrier
    s_mul_i32 s12, s21, 8
    s_add_u32 s12, s12, 96
    s_lshl_b32 s13, s12, 10
    s_lshl_b32 s12, s12, 14
    s_add_u32 m0, s13, 24576
    s_add_u32 s90, s12, 0
    buffer_load_dwordx4 v33, s[36:39], s90 offen lds
    s_add_u32 m0, s13, 25600
    s_add_u32 s90, s12, 16384
    buffer_load_dwordx4 v33, s[36:39], s90 offen lds
    s_add_u32 m0, s13, 26624
    s_add_u32 s90, s12, 32768
    buffer_load_dwordx4 v33, s[36:39], s90 offen lds
    s_add_u32 m0, s13, 27648
    s_add_u32 s90, s12, 49152
    buffer_load_dwordx4 v33, s[36:39], s90 offen lds
    s_add_u32 m0, s13, 28672
    s_add_u32 s90, s12, 65536
    buffer_load_dwordx4 v33, s[36:39], s90 offen lds
    s_add_u32 m0, s13, 29696
    s_add_u32 s90, s12, 81920
    buffer_load_dwordx4 v33, s[36:39], s90 offen lds
    s_add_u32 m0, s13, 30720
    s_add_u32 s90, s12, 98304
    buffer_load_dwordx4 v33, s[36:39], s90 offen lds
    s_add_u32 m0, s13, 31744
    s_add_u32 s90, s12, 114688
    buffer_load_dwordx4 v33, s[36:39], s90 offen lds
    v_and_b32 v183, s8, v183
    v_fmac_f32 v232, v50, v45
    v_fmac_f32 v234, v51, v45
    v_fmac_f32 v233, v182, v45
    v_fmac_f32 v235, v183, v45
    v_lshlrev_b32 v48, 16, v152
    v_lshlrev_b32 v49, 16, v153
    v_and_b32 v152, s8, v152
    v_and_b32 v153, s8, v153
    v_fmac_f32 v220, v48, v46
    v_fmac_f32 v222, v49, v46
    v_fmac_f32 v221, v152, v46
    v_fmac_f32 v223, v153, v46
    v_lshlrev_b32 v50, 16, v154
    v_lshlrev_b32 v51, 16, v155
    v_and_b32 v154, s8, v154
    v_and_b32 v155, s8, v155
    v_fmac_f32 v224, v50, v46
    v_fmac_f32 v226, v51, v46
    v_fmac_f32 v225, v154, v46
    v_fmac_f32 v227, v155, v46
    v_lshlrev_b32 v48, 16, v184
    v_lshlrev_b32 v49, 16, v185
    v_and_b32 v184, s8, v184
    v_and_b32 v185, s8, v185
    s_waitcnt vmcnt(15)
    s_barrier
    v_fmac_f32 v228, v48, v46
    v_fmac_f32 v230, v49, v46
    v_fmac_f32 v229, v184, v46
    v_fmac_f32 v231, v185, v46
    v_lshlrev_b32 v50, 16, v186
    v_lshlrev_b32 v51, 16, v187
    v_and_b32 v186, s8, v186
    v_and_b32 v187, s8, v187
    v_fmac_f32 v232, v50, v46
    v_fmac_f32 v234, v51, v46
    v_fmac_f32 v233, v186, v46
    v_fmac_f32 v235, v187, v46
    v_lshlrev_b32 v48, 16, v156
    v_lshlrev_b32 v49, 16, v157
    v_and_b32 v156, s8, v156
    v_and_b32 v157, s8, v157
    v_fmac_f32 v220, v48, v47
    v_fmac_f32 v222, v49, v47
    v_fmac_f32 v221, v156, v47
    v_fmac_f32 v223, v157, v47
    v_lshlrev_b32 v50, 16, v158
    v_lshlrev_b32 v51, 16, v159
    v_and_b32 v158, s8, v158
    v_and_b32 v159, s8, v159
    v_fmac_f32 v224, v50, v47
    v_fmac_f32 v226, v51, v47
    v_fmac_f32 v225, v158, v47
    v_fmac_f32 v227, v159, v47
    v_lshlrev_b32 v48, 16, v188
    v_lshlrev_b32 v49, 16, v189
    v_and_b32 v188, s8, v188
    v_and_b32 v189, s8, v189
    v_fmac_f32 v228, v48, v47
    v_fmac_f32 v230, v49, v47
    v_fmac_f32 v229, v188, v47
    v_fmac_f32 v231, v189, v47
    v_lshlrev_b32 v50, 16, v190
    v_lshlrev_b32 v51, 16, v191
    v_and_b32 v190, s8, v190
    v_and_b32 v191, s8, v191
    v_fmac_f32 v232, v50, v47
    v_fmac_f32 v234, v51, v47
    v_fmac_f32 v233, v190, v47
    v_fmac_f32 v235, v191, v47
    v_permlane32_swap_b32 v220, v228
    v_permlane32_swap_b32 v221, v229
    v_permlane32_swap_b32 v222, v230
    v_permlane32_swap_b32 v223, v231
    v_permlane32_swap_b32 v224, v232
    v_permlane32_swap_b32 v225, v233
    v_permlane32_swap_b32 v226, v234
    v_permlane32_swap_b32 v227, v235
    v_add_f32 v220, v220, v228
    v_add_f32 v221, v221, v229
    v_add_f32 v222, v222, v230
    v_add_f32 v223, v223, v231
    v_add_f32 v224, v224, v232
    v_add_f32 v225, v225, v233
    v_add_f32 v226, v226, v234
    v_add_f32 v227, v227, v235
    v_permlane16_swap_b32 v220, v224
    v_permlane16_swap_b32 v221, v225
    v_permlane16_swap_b32 v222, v226
    v_permlane16_swap_b32 v223, v227
    v_add_f32 v220, v220, v224
    v_add_f32 v221, v221, v225
    v_add_f32 v222, v222, v226
    v_add_f32 v223, v223, v227
    v_add_f32_dpp v220, v220, v220 row_ror:8 row_mask:0xf bank_mask:0xf
    v_add_f32_dpp v221, v221, v221 row_ror:8 row_mask:0xf bank_mask:0xf
    v_add_f32_dpp v222, v222, v222 row_ror:8 row_mask:0xf bank_mask:0xf
    v_add_f32_dpp v223, v223, v223 row_ror:8 row_mask:0xf bank_mask:0xf
    s_branch L_varend
L_var4:
    s_nop 0
    s_add_u32 m0, s95, 40960
    s_nop 0
    buffer_load_dwordx4 v26, s[28:31], s93 offen offset:2048 lds
    s_add_u32 m0, s95, 44032
    s_nop 0
    buffer_load_dwordx4 v27, s[28:31], s93 offen offset:0 lds
    buffer_load_dwordx4 v28, s[28:31], s93 offen offset:1024 lds
    buffer_load_dwordx4 v29, s[28:31], s93 offen offset:2048 lds
    s_bfe_u32 s91, s68, 0x40008
    s_lshl_b32 s92, s91, 7
    s_mul_i32 s93, s91, 393216
    s_add_u32 m0, s94, 81920
    s_nop 0
    buffer_load_dwordx4 v20, s[24:27], s92 offen offset:0 lds
    buffer_load_dwordx4 v21, s[24:27], s92 offen offset:1024 lds
    buffer_load_dwordx4 v22, s[24:27], s92 offen offset:2048 lds
    buffer_load_dwordx4 v23, s[24:27], s92 offen offset:3072 lds
    s_add_u32 m0, s95, 81920
    s_nop 0
    buffer_load_dwordx4 v24, s[28:31], s93 offen offset:0 lds
    buffer_load_dwordx4 v25, s[28:31], s93 offen offset:1024 lds
    buffer_load_dwordx4 v26, s[28:31], s93 offen offset:2048 lds
    s_add_u32 m0, s95, 84992
    s_nop 0
    buffer_load_dwordx4 v27, s[28:31], s93 offen offset:0 lds
    buffer_load_dwordx4 v28, s[28:31], s93 offen offset:1024 lds
    buffer_load_dwordx4 v29, s[28:31], s93 offen offset:2048 lds
    s_lshl_b32 s12, s19, 2
    s_add_u32 s12, s12, s21
    s_lshl_b32 s12, s12, 10
    s_lshl_b32 s13, s21, 10
    s_add_u32 m0, s13, 155648
    s_nop 0
    buffer_load_dwordx4 v5, s[76:79], s12 offen lds
    s_lshl_b32 s12, s22, 11
    buffer_load_dwordx4 v[40:43], v5, s[24:27], s12 offen offset:0
    buffer_load_dwordx4 v[44:47], v5, s[24:27], s12 offen offset:1024
    buffer_load_dwordx4 v[48:51], v5, s[24:27], s12 offen offset:2048
    buffer_load_dwordx4 v[52:55], v5, s[24:27], s12 offen offset:3072
    buffer_load_dwordx4 v[56:59], v5, s[80:83], 0 offen offset:0
    buffer_load_dwordx4 v[60:63], v5, s[80:83], 0 offen offset:1024
    buffer_load_dwordx4 v[64:67], v5, s[84:87], 0 offen offset:0
    buffer_load_dwordx4 v[68:71], v5, s[84:87], 0 offen offset:1024
    s_waitcnt vmcnt(19)
    s_barrier
    s_bfe_u32 s91, s68, 0x4000c
    s_lshl_b32 s92, s91, 7
    s_mul_i32 s93, s91, 393216
    s_add_u32 m0, s94, 0
    s_nop 0
    buffer_load_dwordx4 v20, s[24:27], s92 offen offset:0 lds
    s_waitcnt vmcnt(1)
    s_mov_b32 s8, 0xffff0000
    v_lshlrev_b32 v72, 16, v56
    v_and_b32 v56, s8, v56
    v_lshlrev_b32 v73, 16, v64
    v_and_b32 v64, s8, v64
    v_lshlrev_b32 v112, 16, v40
    buffer_load_dwordx4 v21, s[24:27], s92 offen offset:1024 lds
    v_and_b32 v40, s8, v40
    v_lshlrev_b32 v116, 16, v48
    v_and_b32 v48, s8, v48
    v_mul_f32 v113, v112, v73
    v_mul_f32 v114, v40, v64
    v_mul_f32 v90, v112, v72
    v_mul_f32 v117, v116, v73
    buffer_load_dwordx4 v22, s[24:27], s92 offen offset:2048 lds
    v_mul_f32 v118, v48, v64
    v_mul_f32 v92, v116, v72
    v_cvt_pk_bf16_f32 v113, 0, v113
    v_cvt_pk_bf16_f32 v114, 0, v114
    v_fmac_f32 v90, v40, v56
    v_cvt_pk_bf16_f32 v117, 0, v117
    v_cvt_pk_bf16_f32 v118, 0, v118
    buffer_load_dwordx4 v23, s[24:27], s92 offen offset:3072 lds
    v_fmac_f32 v92, v48, v56
    v_add_f32 v91, v113, v114
    v_add_f32 v93, v117, v118
    v_lshlrev_b32 v72, 16, v57
    v_and_b32 v57, s8, v57
    v_lshlrev_b32 v73, 16, v65
    v_and_b32 v65, s8, v65
    s_add_u32 m0, s95, 0
    s_nop 0
    buffer_load_dwordx4 v24, s[28:31], s93 offen offset:0 lds
    v_lshlrev_b32 v112, 16, v41
    v_and_b32 v41, s8, v41
    v_lshlrev_b32 v116, 16, v49
    v_and_b32 v49, s8, v49
    v_mul_f32 v113, v112, v73
    v_mul_f32 v114, v41, v65
    v_fmac_f32 v90, v112, v72
    buffer_load_dwordx4 v25, s[28:31], s93 offen offset:1024 lds
    v_mul_f32 v117, v116, v73
    v_mul_f32 v118, v49, v65
    v_fmac_f32 v92, v116, v72
    v_cvt_pk_bf16_f32 v113, 0, v113
    v_cvt_pk_bf16_f32 v114, 0, v114
    v_fmac_f32 v90, v41, v57
    v_cvt_pk_bf16_f32 v117, 0, v117
    buffer_load_dwordx4 v26, s[28:31], s93 offen offset:2048 lds
    v_cvt_pk_bf16_f32 v118, 0, v118
    v_fmac_f32 v92, v49, v57
    v_add_f32 v91, v91, v113
    v_add_f32 v93, v93, v117
    v_add_f32 v91, v91, v114
    v_add_f32 v93, v93, v118
    v_lshlrev_b32 v72, 16, v58
    s_add_u32 m0, s95, 3072
    s_nop 0
    buffer_load_dwordx4 v27, s[28:31], s93 offen offset:0 lds
    v_and_b32 v58, s8, v58
    v_lshlrev_b32 v73, 16, v66
    v_and_b32 v66, s8, v66
    v_lshlrev_b32 v112, 16, v42
    v_and_b32 v42, s8, v42
    v_lshlrev_b32 v116, 16, v50
    v_and_b32 v50, s8, v50
    buffer_load_dwordx4 v28, s[28:31], s93 offen offset:1024 lds
    v_mul_f32 v113, v112, v73
    v_mul_f32 v114, v42, v66
    v_fmac_f32 v90, v112, v72
    v_mul_f32 v117, v116, v73
    v_mul_f32 v118, v50, v66
    v_fmac_f32 v92, v116, v72
    v_cvt_pk_bf16_f32 v113, 0, v113
    buffer_load_dwordx4 v29, s[28:31], s93 offen offset:2048 lds
    v_cvt_pk_bf16_f32 v114, 0, v114
    v_fmac_f32 v90, v42, v58
    v_cvt_pk_bf16_f32 v117, 0, v117
    v_cvt_pk_bf16_f32 v118, 0, v118
    v_fmac_f32 v92, v50, v58
    v_add_f32 v91, v91, v113
    v_add_f32 v93, v93, v117
    s_cmp_lg_u32 s21, 0
    s_cbranch_scc1 L_noclr_4
    v_mov_b32 v104, -1
    v_mov_b32 v105, -1
    v_mov_b32 v106, -1
    v_mov_b32 v107, -1
    s_lshl_b32 s12, s19, 13
    s_lshl_b32 s13, s18, 9
    s_add_u32 s12, s12, s13
    s_add_u32 s12, s12, 32768
    s_lshl_b32 s13, s19, 11
    s_lshl_b32 s90, s18, 7
    s_add_u32 s13, s13, s90
    s_add_u32 s13, s13, 163840
    s_mov_b32 exec_hi, 0
    buffer_store_dwordx4 v[104:107], v5, s[32:35], s12 offen sc1
    s_mov_b32 exec_lo, 255
    buffer_store_dwordx4 v[104:107], v5, s[32:35], s13 offen sc1
    s_mov_b64 exec, -1
L_noclr_4:
    v_add_f32 v91, v91, v114
    v_add_f32 v93, v93, v118
    v_lshlrev_b32 v72, 16, v59
    v_and_b32 v59, s8, v59
    v_lshlrev_b32 v73, 16, v67
    v_and_b32 v67, s8, v67
    v_lshlrev_b32 v112, 16, v43
    v_and_b32 v43, s8, v43
    v_lshlrev_b32 v116, 16, v51
    v_and_b32 v51, s8, v51
    v_mul_f32 v113, v112, v73
    v_mul_f32 v114, v43, v67
    v_fmac_f32 v90, v112, v72
    v_mul_f32 v117, v116, v73
    v_mul_f32 v118, v51, v67
    v_fmac_f32 v92, v116, v72
    v_cvt_pk_bf16_f32 v113, 0, v113
    v_cvt_pk_bf16_f32 v114, 0, v114
    v_fmac_f32 v90, v43, v59
    v_cvt_pk_bf16_f32 v117, 0, v117
    v_cvt_pk_bf16_f32 v118, 0, v118
    v_fmac_f32 v92, v51, v59
    v_add_f32 v91, v91, v113
    v_add_f32 v93, v93, v117
    v_add_f32 v91, v91, v114
    s_barrier
    s_bfe_u32 s91, s68, 0x40010
    s_lshl_b32 s92, s91, 7
    s_mul_i32 s93, s91, 393216
    s_add_u32 m0, s94, 40960
    s_nop 0
    buffer_load_dwordx4 v20, s[24:27], s92 offen offset:0 lds
    v_add_f32 v93, v93, v118
    v_lshlrev_b32 v72, 16, v60
    v_and_b32 v60, s8, v60
    v_lshlrev_b32 v73, 16, v68
    v_and_b32 v68, s8, v68
    v_lshlrev_b32 v112, 16, v44
    v_and_b32 v44, s8, v44
    buffer_load_dwordx4 v21, s[24:27], s92 offen offset:1024 lds
    v_lshlrev_b32 v116, 16, v52
    v_and_b32 v52, s8, v52
    v_mul_f32 v113, v112, v73
    v_mul_f32 v114, v44, v68
    v_fmac_f32 v90, v112, v72
    v_mul_f32 v117, v116, v73
    v_mul_f32 v118, v52, v68
    buffer_load_dwordx4 v22, s[24:27], s92 offen offset:2048 lds
    v_fmac_f32 v92, v116, v72
    v_cvt_pk_bf16_f32 v113, 0, v113
    v_cvt_pk_bf16_f32 v114, 0, v114
    v_fmac_f32 v90, v44, v60
    v_cvt_pk_bf16_f32 v117, 0, v117
    v_cvt_pk_bf16_f32 v118, 0, v118
    v_fmac_f32 v92, v52, v60
    buffer_load_dwordx4 v23, s[24:27], s92 offen offset:3072 lds
    v_add_f32 v91, v91, v113
    v_add_f32 v93, v93, v117
    v_add_f32 v91, v91, v114
    v_add_f32 v93, v93, v118
    v_lshlrev_b32 v72, 16, v61
    v_and_b32 v61, s8, v61
    v_lshlrev_b32 v73, 16, v69
    s_add_u32 m0, s95, 40960
    s_nop 0
    buffer_load_dwordx4 v24, s[28:31], s93 offen offset:0 lds
    v_and_b32 v69, s8, v69
    v_lshlrev_b32 v112, 16, v45
    v_and_b32 v45, s8, v45
    v_lshlrev_b32 v116, 16, v53
    v_and_b32 v53, s8, v53
    v_mul_f32 v113, v112, v73
    v_mul_f32 v114, v45, v69
    buffer_load_dwordx4 v25, s[28:31], s93 offen offset:1024 lds
    v_fmac_f32 v90, v112, v72
    v_mul_f32 v117, v116, v73
    v_mul_f32 v118, v53, v69
    v_fmac_f32 v92, v116, v72
    v_cvt_pk_bf16_f32 v113, 0, v113
    v_cvt_pk_bf16_f32 v114, 0, v114
    v_fmac_f32 v90, v45, v61
    buffer_load_dwordx4 v26, s[28:31], s93 offen offset:2048 lds
    v_cvt_pk_bf16_f32 v117, 0, v117
    v_cvt_pk_bf16_f32 v118, 0, v118
    v_fmac_f32 v92, v53, v61
    v_add_f32 v91, v91, v113
    v_add_f32 v93, v93, v117
    v_add_f32 v91, v91, v114
    v_add_f32 v93, v93, v118
    s_add_u32 m0, s95, 44032
    s_nop 0
    buffer_load_dwordx4 v27, s[28:31], s93 offen offset:0 lds
    v_lshlrev_b32 v72, 16, v62
    v_and_b32 v62, s8, v62
    v_lshlrev_b32 v73, 16, v70
    v_and_b32 v70, s8, v70
    v_lshlrev_b32 v112, 16, v46
    v_and_b32 v46, s8, v46
    v_lshlrev_b32 v116, 16, v54
    buffer_load_dwordx4 v28, s[28:31], s93 offen offset:1024 lds
    v_and_b32 v54, s8, v54
    v_mul_f32 v113, v112, v73
    v_mul_f32 v114, v46, v70
    v_fmac_f32 v90, v112, v72
    v_mul_f32 v117, v116, v73
    v_mul_f32 v118, v54, v70
    v_fmac_f32 v92, v116, v72
    buffer_load_dwordx4 v29, s[28:31], s93 offen offset:2048 lds
    v_cvt_pk_bf16_f32 v113, 0, v113
    v_cvt_pk_bf16_f32 v114, 0, v114
    v_fmac_f32 v90, v46, v62
    v_cvt_pk_bf16_f32 v117, 0, v117
    v_cvt_pk_bf16_f32 v118, 0, v118
    v_fmac_f32 v92, v54, v62
    v_add_f32 v91, v91, v113
    buffer_load_dword v15, v13, s[72:75], 0 offen offset:4 sc1
    v_add_f32 v93, v93, v117
    v_add_f32 v91, v91, v114
    v_add_f32 v93, v93, v118
    v_lshlrev_b32 v72, 16, v63
    v_and_b32 v63, s8, v63
    v_lshlrev_b32 v73, 16, v71
    v_and_b32 v71, s8, v71
    v_lshlrev_b32 v112, 16, v47
    v_and_b32 v47, s8, v47
    v_lshlrev_b32 v116, 16, v55
    v_and_b32 v55, s8, v55
    v_mul_f32 v113, v112, v73
    v_mul_f32 v114, v47, v71
    v_fmac_f32 v90, v112, v72
    v_mul_f32 v117, v116, v73
    v_mul_f32 v118, v55, v71
    v_fmac_f32 v92, v116, v72
    v_cvt_pk_bf16_f32 v113, 0, v113
    v_cvt_pk_bf16_f32 v114, 0, v114
    v_fmac_f32 v90, v47, v63
    v_cvt_pk_bf16_f32 v117, 0, v117
    v_cvt_pk_bf16_f32 v118, 0, v118
    v_fmac_f32 v92, v55, v63
    v_add_f32 v91, v91, v113
    v_add_f32 v93, v93, v117
    s_waitcnt vmcnt(11)
    s_barrier
    s_bfe_u32 s91, s68, 0x40014
    s_lshl_b32 s92, s91, 7
    s_mul_i32 s93, s91, 393216
    s_add_u32 m0, s94, 81920
    s_nop 0
    buffer_load_dwordx4 v20, s[24:27], s92 offen offset:0 lds
    v_add_f32 v91, v91, v114
    v_add_f32 v93, v93, v118
    v_add_f32_dpp v90, v90, v90 row_shr:1 row_mask:0xf bank_mask:0xf
    v_add_f32_dpp v91, v91, v91 row_shr:1 row_mask:0xf bank_mask:0xf
    v_add_f32_dpp v92, v92, v92 row_shr:1 row_mask:0xf bank_mask:0xf
    v_add_f32_dpp v93, v93, v93 row_shr:1 row_mask:0xf bank_mask:0xf
    v_add_f32_dpp v90, v90, v90 row_shr:2 row_mask:0xf bank_mask:0xf
    buffer_load_dwordx4 v21, s[24:27], s92 offen offset:1024 lds
    v_add_f32_dpp v91, v91, v91 row_shr:2 row_mask:0xf bank_mask:0xf
    v_add_f32_dpp v92, v92, v92 row_shr:2 row_mask:0xf bank_mask:0xf
    v_add_f32_dpp v93, v93, v93 row_shr:2 row_mask:0xf bank_mask:0xf
    v_add_f32_dpp v90, v90, v90 row_shr:4 row_mask:0xf bank_mask:0xf
    v_add_f32_dpp v91, v91, v91 row_shr:4 row_mask:0xf bank_mask:0xf
    v_add_f32_dpp v92, v92, v92 row_shr:4 row_mask:0xf bank_mask:0xf
    v_add_f32_dpp v93, v93, v93 row_shr:4 row_mask:0xf bank_mask:0xf
    buffer_load_dwordx4 v22, s[24:27], s92 offen offset:2048 lds
    v_add_f32_dpp v90, v90, v90 row_shr:8 row_mask:0xf bank_mask:0xf
    v_add_f32_dpp v91, v91, v91 row_shr:8 row_mask:0xf bank_mask:0xf
    v_add_f32_dpp v92, v92, v92 row_shr:8 row_mask:0xf bank_mask:0xf
    v_add_f32_dpp v93, v93, v93 row_shr:8 row_mask:0xf bank_mask:0xf
    v_add_f32_dpp v90, v90, v90 row_bcast:15 row_mask:0xa bank_mask:0xf
    v_add_f32_dpp v91, v91, v91 row_bcast:15 row_mask:0xa bank_mask:0xf
    v_add_f32_dpp v92, v92, v92 row_bcast:15 row_mask:0xa bank_mask:0xf
    buffer_load_dwordx4 v23, s[24:27], s92 offen offset:3072 lds
    v_add_f32_dpp v93, v93, v93 row_bcast:15 row_mask:0xa bank_mask:0xf
    v_add_f32_dpp v90, v90, v90 row_bcast:31 row_mask:0xc bank_mask:0xf
    v_add_f32_dpp v91, v91, v91 row_bcast:31 row_mask:0xc bank_mask:0xf
    v_add_f32_dpp v92, v92, v92 row_bcast:31 row_mask:0xc bank_mask:0xf
    v_add_f32_dpp v93, v93, v93 row_bcast:31 row_mask:0xc bank_mask:0xf
    v_mov_b32 v97, 0x8000
    v_mov_b32 v98, 0xffff
    s_add_u32 m0, s95, 81920
    s_nop 0
    buffer_load_dwordx4 v24, s[28:31], s93 offen offset:0 lds
    v_cvt_pk_bf16_f32 v94, v90, v91
    v_cvt_pk_bf16_f32 v104, v92, v93
    v_and_b32 v95, 0xffff, v94
    v_and_b32 v96, 0x8000, v94
    v_and_b32 v94, 0xffff0000, v94
    v_cmp_ne_u32 vcc, 0, v96
    v_mul_f32 v94, 0xbfb8aa3b, v94
    buffer_load_dwordx4 v25, s[28:31], s93 offen offset:1024 lds
    v_exp_f32 v94, v94
    v_cndmask_b32 v96, v97, v98, vcc
    v_xor_b32 v95, v95, v96
    v_add_f32 v94, 1.0, v94
    v_lshlrev_b32 v95, 11, v95
    v_rcp_f32 v94, v94
    s_sub_u32 s12, 2047, s22
    v_or_b32 v100, s12, v95
    buffer_load_dwordx4 v26, s[28:31], s93 offen offset:2048 lds
    v_cvt_pk_bf16_f32 v94, v94, v94
    v_lshlrev_b32 v102, 16, v94
    v_and_b32 v105, 0xffff, v104
    v_and_b32 v106, 0x8000, v104
    v_and_b32 v104, 0xffff0000, v104
    v_cmp_ne_u32 vcc, 0, v106
    v_mul_f32 v104, 0xbfb8aa3b, v104
    s_add_u32 m0, s95, 84992
    s_nop 0
    buffer_load_dwordx4 v27, s[28:31], s93 offen offset:0 lds
    v_exp_f32 v104, v104
    v_cndmask_b32 v106, v97, v98, vcc
    v_xor_b32 v105, v105, v106
    v_add_f32 v104, 1.0, v104
    v_lshlrev_b32 v105, 11, v105
    v_rcp_f32 v104, v104
    s_sub_u32 s12, 2046, s22
    v_or_b32 v101, s12, v105
    buffer_load_dwordx4 v28, s[28:31], s93 offen offset:1024 lds
    v_cvt_pk_bf16_f32 v104, v104, v104
    v_lshlrev_b32 v103, 16, v104
    v_max_u32 v100, v100, v101
    s_lshl_b32 s12, s22, 2
    s_add_u32 s12, s12, 4096
    s_lshl_b32 s13, s21, 2
    s_add_u32 s13, s13, 162880
    v_mov_b32 v14, s13
    s_mov_b32 exec_lo, 0
    s_mov_b32 exec_hi, 0x80000000
    buffer_store_dwordx2 v[102:103], v13, s[32:35], s12 offen sc1
    ds_write_b32 v14, v100
    s_mov_b64 exec, -1
    s_waitcnt lgkmcnt(0)
    buffer_load_dwordx4 v29, s[28:31], s93 offen offset:2048 lds
    s_waitcnt vmcnt(12)
    s_barrier
    s_bfe_u32 s91, s68, 0x40018
    s_lshl_b32 s92, s91, 7
    s_mul_i32 s93, s91, 393216
    s_add_u32 m0, s94, 0
    s_nop 0
    buffer_load_dwordx4 v20, s[24:27], s92 offen offset:0 lds
    buffer_load_dwordx4 v21, s[24:27], s92 offen offset:1024 lds
    buffer_load_dwordx4 v22, s[24:27], s92 offen offset:2048 lds
    buffer_load_dwordx4 v23, s[24:27], s92 offen offset:3072 lds
    s_add_u32 m0, s95, 0
    s_nop 0
    buffer_load_dwordx4 v24, s[28:31], s93 offen offset:0 lds
    buffer_load_dwordx4 v25, s[28:31], s93 offen offset:1024 lds
    buffer_load_dwordx4 v26, s[28:31], s93 offen offset:2048 lds
    s_add_u32 m0, s95, 3072
    s_nop 0
    buffer_load_dwordx4 v27, s[28:31], s93 offen offset:0 lds
    buffer_load_dwordx4 v28, s[28:31], s93 offen offset:1024 lds
    buffer_load_dwordx4 v29, s[28:31], s93 offen offset:2048 lds
    s_cmp_ge_u32 s10, 224
    s_cbranch_scc1 L_p30_4
    s_add_u32 s12, s71, 0
    buffer_load_dwordx4 v[128:131], v30, s[40:43], s12 offen nt
    s_add_u32 s12, s71, 7168
    buffer_load_dwordx4 v[132:135], v30, s[40:43], s12 offen nt
    s_add_u32 s12, s71, 14336
    buffer_load_dwordx4 v[136:139], v30, s[40:43], s12 offen nt
    s_add_u32 s12, s71, 21504
    buffer_load_dwordx4 v[140:143], v30, s[40:43], s12 offen nt
    s_add_u32 s12, s71, 28672
    buffer_load_dwordx4 v[144:147], v30, s[40:43], s12 offen nt
    s_add_u32 s12, s71, 35840
    buffer_load_dwordx4 v[148:151], v30, s[40:43], s12 offen nt
    s_add_u32 s12, s71, 43008
    buffer_load_dwordx4 v[152:155], v30, s[40:43], s12 offen nt
    s_add_u32 s12, s71, 50176
    buffer_load_dwordx4 v[156:159], v30, s[40:43], s12 offen nt
    s_branch L_p3e0_4
L_p30_4:
    s_mov_b64 exec, 63
    s_bfe_u32 s12, s68, 0x4000c
    s_mul_i32 s12, s12, 393216
    buffer_load_dword v128, v32, s[28:31], s12 offen
    s_bfe_u32 s12, s68, 0x40010
    s_mul_i32 s12, s12, 393216
    buffer_load_dword v132, v32, s[28:31], s12 offen
    s_bfe_u32 s12, s68, 0x40014
    s_mul_i32 s12, s12, 393216
    buffer_load_dword v136, v32, s[28:31], s12 offen
    s_bfe_u32 s12, s68, 0x40018
    s_mul_i32 s12, s12, 393216
    buffer_load_dword v140, v32, s[28:31], s12 offen
    s_bfe_u32 s12, s68, 0x4001c
    s_mul_i32 s12, s12, 393216
    buffer_load_dword v144, v32, s[28:31], s12 offen
    s_bfe_u32 s12, s69, 0x40000
    s_mul_i32 s12, s12, 393216
    buffer_load_dword v148, v32, s[28:31], s12 offen
    s_bfe_u32 s12, s69, 0x40004
    s_mul_i32 s12, s12, 393216
    buffer_load_dword v152, v32, s[28:31], s12 offen
    s_bfe_u32 s12, s69, 0x40008
    s_mul_i32 s12, s12, 393216
    buffer_load_dword v156, v32, s[28:31], s12 offen
    s_mov_b64 exec, -1
L_p3e0_4:
    s_waitcnt vmcnt(19)
    s_waitcnt vmcnt(18)
    s_barrier
    s_bfe_u32 s91, s68, 0x4001c
    s_lshl_b32 s92, s91, 7
    s_mul_i32 s93, s91, 393216
    s_add_u32 m0, s94, 40960
    s_nop 0
    buffer_load_dwordx4 v20, s[24:27], s92 offen offset:0 lds
    buffer_load_dwordx4 v21, s[24:27], s92 offen offset:1024 lds
    buffer_load_dwordx4 v22, s[24:27], s92 offen offset:2048 lds
    buffer_load_dwordx4 v23, s[24:27], s92 offen offset:3072 lds
    s_add_u32 m0, s95, 40960
    s_nop 0
    buffer_load_dwordx4 v24, s[28:31], s93 offen offset:0 lds
    s_mov_b32 s13, 0
L_tagchk_4:
    v_readfirstlane_b32 s23, v15
    s_nop 1
    s_cmp_lg_u32 s23, 0
    s_cbranch_scc1 L_tagok_4
    s_add_u32 s13, s13, 1
    s_cmp_ge_u32 s13, 16384
    s_cbranch_scc1 L_tagok_4
    buffer_load_dword v15, v13, s[72:75], 0 offen offset:4 sc1
    s_waitcnt vmcnt(0)
    s_branch L_tagchk_4
L_tagok_4:
    s_and_b32 s76, s23, 0xff
    s_bfe_u32 s77, s23, 0x80008
    s_bfe_u32 s78, s23, 0x80010
    s_lshr_b32 s79, s23, 24
    v_and_b32 v35, 3, v2
    v_lshlrev_b32 v35, 3, v35
    v_bfe_u32 v35, s23, v35, 8
    s_cmp_lg_u32 s21, 0
    s_cbranch_scc1 L_nopub_4
    v_mov_b32 v14, 162880
    ds_read_b128 v[104:107], v14
    s_lshl_b32 s12, s2, 3
    s_add_u32 s12, s12, 0
    s_waitcnt lgkmcnt(0)
    v_max3_u32 v104, v104, v105, v106
    v_max_u32 v104, v104, v107
    v_mov_b32 v105, s23
    s_mov_b64 exec, 1
    buffer_store_dwordx2 v[104:105], v13, s[32:35], s12 offen sc1
    s_mov_b64 exec, -1
L_nopub_4:
    s_waitcnt vmcnt(13)
    s_barrier
    s_add_u32 m0, s95, 40960
    s_nop 0
    buffer_load_dwordx4 v25, s[28:31], s93 offen offset:1024 lds
    buffer_load_dwordx4 v26, s[28:31], s93 offen offset:2048 lds
    s_add_u32 m0, s95, 44032
    s_nop 0
    buffer_load_dwordx4 v27, s[28:31], s93 offen offset:0 lds
    buffer_load_dwordx4 v28, s[28:31], s93 offen offset:1024 lds
    buffer_load_dwordx4 v29, s[28:31], s93 offen offset:2048 lds
    s_bfe_u32 s91, s69, 0x40000
    s_lshl_b32 s92, s91, 7
    s_mul_i32 s93, s91, 393216
    s_add_u32 m0, s94, 81920
    s_nop 0
    buffer_load_dwordx4 v20, s[24:27], s92 offen offset:0 lds
    buffer_load_dwordx4 v21, s[24:27], s92 offen offset:1024 lds
    buffer_load_dwordx4 v22, s[24:27], s92 offen offset:2048 lds
    buffer_load_dwordx4 v23, s[24:27], s92 offen offset:3072 lds
    s_add_u32 m0, s95, 81920
    s_nop 0
    buffer_load_dwordx4 v24, s[28:31], s93 offen offset:0 lds
    buffer_load_dwordx4 v25, s[28:31], s93 offen offset:1024 lds
    buffer_load_dwordx4 v26, s[28:31], s93 offen offset:2048 lds
    s_waitcnt vmcnt(7)
    s_barrier
    s_add_u32 m0, s95, 84992
    s_nop 0
    buffer_load_dwordx4 v27, s[28:31], s93 offen offset:0 lds
    buffer_load_dwordx4 v28, s[28:31], s93 offen offset:1024 lds
    buffer_load_dwordx4 v29, s[28:31], s93 offen offset:2048 lds
    s_bfe_u32 s91, s69, 0x40004
    s_lshl_b32 s92, s91, 7
    s_mul_i32 s93, s91, 393216
    s_add_u32 m0, s94, 0
    s_nop 0
    buffer_load_dwordx4 v20, s[24:27], s92 offen offset:0 lds
    buffer_load_dwordx4 v21, s[24:27], s92 offen offset:1024 lds
    buffer_load_dwordx4 v22, s[24:27], s92 offen offset:2048 lds
    buffer_load_dwordx4 v23, s[24:27], s92 offen offset:3072 lds
    s_add_u32 m0, s95, 0
    s_nop 0
    buffer_load_dwordx4 v24, s[28:31], s93 offen offset:0 lds
    buffer_load_dwordx4 v25, s[28:31], s93 offen offset:1024 lds
    buffer_load_dwordx4 v26, s[28:31], s93 offen offset:2048 lds
    s_add_u32 m0, s95, 3072
    s_nop 0
    buffer_load_dwordx4 v27, s[28:31], s93 offen offset:0 lds
    buffer_load_dwordx4 v28, s[28:31], s93 offen offset:1024 lds
    s_waitcnt vmcnt(9)
    s_barrier
    s_add_u32 m0, s95, 3072
    s_nop 0
    buffer_load_dwordx4 v29, s[28:31], s93 offen offset:2048 lds
    s_bfe_u32 s91, s69, 0x40008
    s_lshl_b32 s92, s91, 7
    s_mul_i32 s93, s91, 393216
    s_add_u32 m0, s94, 40960
    s_nop 0
    buffer_load_dwordx4 v20, s[24:27], s92 offen offset:0 lds
    buffer_load_dwordx4 v21, s[24:27], s92 offen offset:1024 lds
    buffer_load_dwordx4 v22, s[24:27], s92 offen offset:2048 lds
    buffer_load_dwordx4 v23, s[24:27], s92 offen offset:3072 lds
    s_add_u32 m0, s95, 40960
    s_nop 0
    buffer_load_dwordx4 v24, s[28:31], s93 offen offset:0 lds
    buffer_load_dwordx4 v25, s[28:31], s93 offen offset:1024 lds
    buffer_load_dwordx4 v26, s[28:31], s93 offen offset:2048 lds
    s_add_u32 m0, s95, 44032
    s_nop 0
    buffer_load_dwordx4 v27, s[28:31], s93 offen offset:0 lds
    buffer_load_dwordx4 v28, s[28:31], s93 offen offset:1024 lds
    buffer_load_dwordx4 v29, s[28:31], s93 offen offset:2048 lds
    s_waitcnt vmcnt(10)
    s_barrier
    s_bfe_u32 s91, s69, 0x4000c
    s_lshl_b32 s92, s91, 7
    s_mul_i32 s93, s91, 393216
    s_add_u32 m0, s94, 81920
    s_nop 0
    buffer_load_dwordx4 v20, s[24:27], s92 offen offset:0 lds
    buffer_load_dwordx4 v21, s[24:27], s92 offen offset:1024 lds
    buffer_load_dwordx4 v22, s[24:27], s92 offen offset:2048 lds
    buffer_load_dwordx4 v23, s[24:27], s92 offen offset:3072 lds
    s_add_u32 m0, s95, 81920
    s_nop 0
    buffer_load_dwordx4 v24, s[28:31], s93 offen offset:0 lds
    buffer_load_dwordx4 v25, s[28:31], s93 offen offset:1024 lds
    buffer_load_dwordx4 v26, s[28:31], s93 offen offset:2048 lds
    s_add_u32 m0, s95, 84992
    s_nop 0
    buffer_load_dwordx4 v27, s[28:31], s93 offen offset:0 lds
    buffer_load_dwordx4 v28, s[28:31], s93 offen offset:1024 lds
    buffer_load_dwordx4 v29, s[28:31], s93 offen offset:2048 lds
    s_cmp_ge_u32 s10, 224
    s_cbranch_scc1 L_p31_4
    s_add_u32 s12, s9, 0
    buffer_load_dwordx4 v[160:163], v30, s[44:47], s12 offen nt
    s_add_u32 s12, s9, 7168
    buffer_load_dwordx4 v[164:167], v30, s[44:47], s12 offen nt
    s_add_u32 s12, s9, 14336
    buffer_load_dwordx4 v[168:171], v30, s[44:47], s12 offen nt
    s_add_u32 s12, s9, 21504
    buffer_load_dwordx4 v[172:175], v30, s[44:47], s12 offen nt
    s_add_u32 s12, s9, 28672
    buffer_load_dwordx4 v[176:179], v30, s[44:47], s12 offen nt
    s_add_u32 s12, s9, 35840
    buffer_load_dwordx4 v[180:183], v30, s[44:47], s12 offen nt
    s_add_u32 s12, s9, 43008
    buffer_load_dwordx4 v[184:187], v30, s[44:47], s12 offen nt
    s_add_u32 s12, s9, 50176
    buffer_load_dwordx4 v[188:191], v30, s[44:47], s12 offen nt
    s_branch L_p3e1_4
L_p31_4:
    s_mov_b64 exec, 63
    s_bfe_u32 s12, s69, 0x4000c
    s_mul_i32 s12, s12, 393216
    buffer_load_dword v160, v32, s[28:31], s12 offen
    s_bfe_u32 s12, s69, 0x40010
    s_mul_i32 s12, s12, 393216
    buffer_load_dword v164, v32, s[28:31], s12 offen
    s_bfe_u32 s12, s69, 0x40014
    s_mul_i32 s12, s12, 393216
    buffer_load_dword v168, v32, s[28:31], s12 offen
    s_bfe_u32 s12, s69, 0x40018
    s_mul_i32 s12, s12, 393216
    buffer_load_dword v172, v32, s[28:31], s12 offen
    s_bfe_u32 s12, s69, 0x4001c
    s_mul_i32 s12, s12, 393216
    buffer_load_dword v176, v32, s[28:31], s12 offen
    s_mov_b64 exec, 1
    s_bfe_u32 s12, s69, 0x4001c
    s_mul_i32 s12, s12, 393216
    buffer_load_dword v180, v32, s[28:31], s12 offen
    s_bfe_u32 s12, s69, 0x4001c
    s_mul_i32 s12, s12, 393216
    buffer_load_dword v184, v32, s[28:31], s12 offen
    s_bfe_u32 s12, s69, 0x4001c
    s_mul_i32 s12, s12, 393216
    buffer_load_dword v188, v32, s[28:31], s12 offen
    s_mov_b64 exec, -1
L_p3e1_4:
    s_mov_b32 exec_lo, 0xffff0000
    s_mov_b32 exec_hi, 0
    buffer_load_dword v19, v10, s[36:39], 0 offen
    s_mov_b64 exec, -1
    s_mov_b32 s12, 0
    buffer_load_dwordx4 v[104:107], v5, s[32:35], s12 offen offset:0 sc1
    buffer_load_dwordx4 v[108:111], v5, s[32:35], s12 offen offset:1024 sc1
    s_waitcnt vmcnt(21)
    s_barrier
    s_bfe_u32 s91, s69, 0x40010
    s_lshl_b32 s92, s91, 7
    s_mul_i32 s93, s91, 393216
    s_add_u32 m0, s94, 0
    s_nop 0
    buffer_load_dwordx4 v20, s[24:27], s92 offen offset:0 lds
    buffer_load_dwordx4 v21, s[24:27], s92 offen offset:1024 lds
    buffer_load_dwordx4 v22, s[24:27], s92 offen offset:2048 lds
    buffer_load_dwordx4 v23, s[24:27], s92 offen offset:3072 lds
    s_add_u32 m0, s95, 0
    s_nop 0
    buffer_load_dwordx4 v24, s[28:31], s93 offen offset:0 lds
    s_waitcnt vmcnt(16)
    s_barrier
    s_add_u32 m0, s95, 0
    s_nop 0
    buffer_load_dwordx4 v25, s[28:31], s93 offen offset:1024 lds
    s_waitcnt vmcnt(6)
    s_mov_b32 s13, 0
    v_xor_b32 v105, s23, v105
    v_xor_b32 v107, s23, v107
    v_xor_b32 v109, s23, v109
    v_xor_b32 v111, s23, v111
    v_or3_b32 v105, v105, v107, v109
    v_or_b32 v105, v105, v111
    v_cmp_ne_u32 vcc, 0, v105
    s_cbranch_vccnz L_keyre_4
L_keyok_4:
    buffer_load_dwordx4 v26, s[28:31], s93 offen offset:2048 lds
    v_max3_u32 v104, v104, v106, v108
    v_max_u32 v104, v104, v110
    s_nop 1
    v_max_u32_dpp v104, v104, v104 row_shr:1 row_mask:0xf bank_mask:0xf
    s_nop 1
    v_max_u32_dpp v104, v104, v104 row_shr:2 row_mask:0xf bank_mask:0xf
    s_nop 1
    v_max_u32_dpp v104, v104, v104 row_shr:4 row_mask:0xf bank_mask:0xf
    s_nop 1
    v_max_u32_dpp v104, v104, v104 row_shr:8 row_mask:0xf bank_mask:0xf
    s_nop 1
    v_max_u32_dpp v104, v104, v104 row_bcast:15 row_mask:0xa bank_mask:0xf
    s_add_u32 m0, s95, 3072
    s_nop 0
    buffer_load_dwordx4 v27, s[28:31], s93 offen offset:0 lds
    v_max_u32_dpp v104, v104, v104 row_bcast:31 row_mask:0xc bank_mask:0xf
    s_nop 0
    v_readlane_b32 s14, v104, 63
    s_nop 1
    s_and_b32 s15, s14, 2047
    s_sub_u32 s15, 2047, s15
    s_lshl_b32 s12, s15, 11
    s_lshl_b32 s13, s70, 1
    s_add_u32 s12, s12, s13
    buffer_load_dwordx4 v[36:39], v34, s[24:27], s12 offen
    s_lshr_b32 s12, s14, 11
    s_and_b32 s13, s12, 0x8000
    s_cmp_lg_u32 s13, 0
    s_mov_b32 s13, 0xffff
    s_cselect_b32 s13, 0x8000, s13
    s_xor_b32 s12, s12, s13
    s_lshl_b32 s12, s12, 16
    v_mov_b32 v105, s12
    buffer_load_dwordx4 v28, s[28:31], s93 offen offset:1024 lds
    v_mul_f32 v105, 0xbfb8aa3b, v105
    v_exp_f32 v105, v105
    s_nop 0
    v_add_f32 v105, 1.0, v105
    v_rcp_f32 v105, v105
    s_nop 0
    v_cvt_pk_bf16_f32 v105, v105, v105
    v_lshlrev_b32 v105, 16, v105
    s_add_u32 s12, s15, 1
    v_mov_b32 v104, s12
    buffer_load_dwordx4 v29, s[28:31], s93 offen offset:2048 lds
    v_mov_b32 v106, s23
    v_readfirstlane_b32 s14, v105
    v_mov_b32 v14, 162864
    s_mov_b64 exec, 1
    ds_write_b96 v14, v[104:106]
    s_mov_b64 exec, -1
    s_waitcnt lgkmcnt(0)
    s_bfe_u32 s91, s69, 0x40014
    s_lshl_b32 s92, s91, 7
    s_mul_i32 s93, s91, 393216
    s_add_u32 m0, s94, 40960
    s_nop 0
    buffer_load_dwordx4 v20, s[24:27], s92 offen offset:0 lds
    buffer_load_dwordx4 v21, s[24:27], s92 offen offset:1024 lds
    buffer_load_dwordx4 v22, s[24:27], s92 offen offset:2048 lds
    buffer_load_dwordx4 v23, s[24:27], s92 offen offset:3072 lds
    s_add_u32 m0, s95, 40960
    s_nop 0
    buffer_load_dwordx4 v24, s[28:31], s93 offen offset:0 lds
    buffer_load_dwordx4 v25, s[28:31], s93 offen offset:1024 lds
    buffer_load_dwordx4 v26, s[28:31], s93 offen offset:2048 lds
    s_waitcnt vmcnt(7)
    s_barrier
    s_add_u32 m0, s95, 44032
    s_nop 0
    buffer_load_dwordx4 v27, s[28:31], s93 offen offset:0 lds
    s_mov_b32 s8, 0xffff0000
    v_lshlrev_b32 v40, 16, v36
    v_and_b32 v41, s8, v36
    v_lshlrev_b32 v42, 16, v37
    v_and_b32 v43, s8, v37
    v_lshlrev_b32 v44, 16, v38
    buffer_load_dwordx4 v28, s[28:31], s93 offen offset:1024 lds
    v_and_b32 v45, s8, v38
    v_lshlrev_b32 v46, 16, v39
    v_and_b32 v47, s8, v39
    v_lshlrev_b32 v48, 16, v128
    v_lshlrev_b32 v49, 16, v129
    v_and_b32 v128, s8, v128
    v_and_b32 v129, s8, v129
    buffer_load_dwordx4 v29, s[28:31], s93 offen offset:2048 lds
    v_mul_f32 v220, v48, v40
    v_mul_f32 v222, v49, v40
    v_mul_f32 v221, v128, v40
    v_mul_f32 v223, v129, v40
    v_lshlrev_b32 v50, 16, v130
    v_lshlrev_b32 v51, 16, v131
    v_and_b32 v130, s8, v130
    s_bfe_u32 s91, s69, 0x40018
    s_lshl_b32 s92, s91, 7
    s_mul_i32 s93, s91, 393216
    s_add_u32 m0, s94, 81920
    s_nop 0
    buffer_load_dwordx4 v20, s[24:27], s92 offen offset:0 lds
    v_and_b32 v131, s8, v131
    v_mul_f32 v224, v50, v40
    v_mul_f32 v226, v51, v40
    v_mul_f32 v225, v130, v40
    v_mul_f32 v227, v131, v40
    v_lshlrev_b32 v48, 16, v160
    v_lshlrev_b32 v49, 16, v161
    buffer_load_dwordx4 v21, s[24:27], s92 offen offset:1024 lds
    v_and_b32 v160, s8, v160
    v_and_b32 v161, s8, v161
    v_mul_f32 v228, v48, v40
    v_mul_f32 v230, v49, v40
    v_mul_f32 v229, v160, v40
    v_mul_f32 v231, v161, v40
    v_lshlrev_b32 v50, 16, v162
    buffer_load_dwordx4 v22, s[24:27], s92 offen offset:2048 lds
    v_lshlrev_b32 v51, 16, v163
    v_and_b32 v162, s8, v162
    v_and_b32 v163, s8, v163
    v_mul_f32 v232, v50, v40
    v_mul_f32 v234, v51, v40
    v_mul_f32 v233, v162, v40
    v_mul_f32 v235, v163, v40
    buffer_load_dwordx4 v23, s[24:27], s92 offen offset:3072 lds
    v_lshlrev_b32 v48, 16, v132
    v_lshlrev_b32 v49, 16, v133
    v_and_b32 v132, s8, v132
    v_and_b32 v133, s8, v133
    v_fmac_f32 v220, v48, v41
    v_fmac_f32 v222, v49, v41
    v_fmac_f32 v221, v132, v41
    s_add_u32 m0, s95, 81920
    s_nop 0
    buffer_load_dwordx4 v24, s[28:31], s93 offen offset:0 lds
    v_fmac_f32 v223, v133, v41
    v_lshlrev_b32 v50, 16, v134
    v_lshlrev_b32 v51, 16, v135
    v_and_b32 v134, s8, v134
    v_and_b32 v135, s8, v135
    v_fmac_f32 v224, v50, v41
    v_fmac_f32 v226, v51, v41
    buffer_load_dwordx4 v25, s[28:31], s93 offen offset:1024 lds
    v_fmac_f32 v225, v134, v41
    v_fmac_f32 v227, v135, v41
    v_lshlrev_b32 v48, 16, v164
    v_lshlrev_b32 v49, 16, v165
    v_and_b32 v164, s8, v164
    v_and_b32 v165, s8, v165
    v_fmac_f32 v228, v48, v41
    buffer_load_dwordx4 v26, s[28:31], s93 offen offset:2048 lds
    v_fmac_f32 v230, v49, v41
    v_fmac_f32 v229, v164, v41
    v_fmac_f32 v231, v165, v41
    v_lshlrev_b32 v50, 16, v166
    v_lshlrev_b32 v51, 16, v167
    v_and_b32 v166, s8, v166
    v_and_b32 v167, s8, v167
    s_add_u32 m0, s95, 84992
    s_nop 0
    buffer_load_dwordx4 v27, s[28:31], s93 offen offset:0 lds
    v_fmac_f32 v232, v50, v41
    v_fmac_f32 v234, v51, v41
    v_fmac_f32 v233, v166, v41
    v_fmac_f32 v235, v167, v41
    v_lshlrev_b32 v48, 16, v136
    v_lshlrev_b32 v49, 16, v137
    v_and_b32 v136, s8, v136
    buffer_load_dwordx4 v28, s[28:31], s93 offen offset:1024 lds
    v_and_b32 v137, s8, v137
    v_fmac_f32 v220, v48, v42
    v_fmac_f32 v222, v49, v42
    v_fmac_f32 v221, v136, v42
    v_fmac_f32 v223, v137, v42
    v_lshlrev_b32 v50, 16, v138
    v_lshlrev_b32 v51, 16, v139
    v_and_b32 v138, s8, v138
    v_and_b32 v139, s8, v139
    v_fmac_f32 v224, v50, v42
    v_fmac_f32 v226, v51, v42
    v_fmac_f32 v225, v138, v42
    v_fmac_f32 v227, v139, v42
    v_lshlrev_b32 v48, 16, v168
    v_lshlrev_b32 v49, 16, v169
    v_and_b32 v168, s8, v168
    v_and_b32 v169, s8, v169
    v_fmac_f32 v228, v48, v42
    v_fmac_f32 v230, v49, v42
    v_fmac_f32 v229, v168, v42
    v_fmac_f32 v231, v169, v42
    v_lshlrev_b32 v50, 16, v170
    v_lshlrev_b32 v51, 16, v171
    v_and_b32 v170, s8, v170
    v_and_b32 v171, s8, v171
    v_fmac_f32 v232, v50, v42
    v_fmac_f32 v234, v51, v42
    v_fmac_f32 v233, v170, v42
    v_fmac_f32 v235, v171, v42
    v_lshlrev_b32 v48, 16, v140
    v_lshlrev_b32 v49, 16, v141
    v_and_b32 v140, s8, v140
    s_waitcnt vmcnt(9)
    s_barrier
    s_add_u32 m0, s95, 84992
    s_nop 0
    buffer_load_dwordx4 v29, s[28:31], s93 offen offset:2048 lds
    v_and_b32 v141, s8, v141
    v_fmac_f32 v220, v48, v43
    v_fmac_f32 v222, v49, v43
    v_fmac_f32 v221, v140, v43
    v_fmac_f32 v223, v141, v43
    v_lshlrev_b32 v50, 16, v142
    v_lshlrev_b32 v51, 16, v143
    s_bfe_u32 s91, s69, 0x4001c
    s_lshl_b32 s92, s91, 7
    s_mul_i32 s93, s91, 393216
    s_add_u32 m0, s94, 0
    s_nop 0
    buffer_load_dwordx4 v20, s[24:27], s92 offen offset:0 lds
    v_and_b32 v142, s8, v142
    v_and_b32 v143, s8, v143
    v_fmac_f32 v224, v50, v43
    v_fmac_f32 v226, v51, v43
    v_fmac_f32 v225, v142, v43
    v_fmac_f32 v227, v143, v43
    v_lshlrev_b32 v48, 16, v172
    buffer_load_dwordx4 v21, s[24:27], s92 offen offset:1024 lds
    v_lshlrev_b32 v49, 16, v173
    v_and_b32 v172, s8, v172
    v_and_b32 v173, s8, v173
    v_fmac_f32 v228, v48, v43
    v_fmac_f32 v230, v49, v43
    v_fmac_f32 v229, v172, v43
    v_fmac_f32 v231, v173, v43
    buffer_load_dwordx4 v22, s[24:27], s92 offen offset:2048 lds
    v_lshlrev_b32 v50, 16, v174
    v_lshlrev_b32 v51, 16, v175
    v_and_b32 v174, s8, v174
    v_and_b32 v175, s8, v175
    v_fmac_f32 v232, v50, v43
    v_fmac_f32 v234, v51, v43
    v_fmac_f32 v233, v174, v43
    buffer_load_dwordx4 v23, s[24:27], s92 offen offset:3072 lds
    v_fmac_f32 v235, v175, v43
    v_lshlrev_b32 v48, 16, v144
    v_lshlrev_b32 v49, 16, v145
    v_and_b32 v144, s8, v144
    v_and_b32 v145, s8, v145
    v_fmac_f32 v220, v48, v44
    v_fmac_f32 v222, v49, v44
    s_add_u32 m0, s95, 0
    s_nop 0
    buffer_load_dwordx4 v24, s[28:31], s93 offen offset:0 lds
    v_fmac_f32 v221, v144, v44
    v_fmac_f32 v223, v145, v44
    v_lshlrev_b32 v50, 16, v146
    v_lshlrev_b32 v51, 16, v147
    v_and_b32 v146, s8, v146
    v_and_b32 v147, s8, v147
    v_fmac_f32 v224, v50, v44
    buffer_load_dwordx4 v25, s[28:31], s93 offen offset:1024 lds
    v_fmac_f32 v226, v51, v44
    v_fmac_f32 v225, v146, v44
    v_fmac_f32 v227, v147, v44
    v_lshlrev_b32 v48, 16, v176
    v_lshlrev_b32 v49, 16, v177
    v_and_b32 v176, s8, v176
    v_and_b32 v177, s8, v177
    buffer_load_dwordx4 v26, s[28:31], s93 offen offset:2048 lds
    v_fmac_f32 v228, v48, v44
    v_fmac_f32 v230, v49, v44
    v_fmac_f32 v229, v176, v44
    v_fmac_f32 v231, v177, v44
    v_lshlrev_b32 v50, 16, v178
    v_lshlrev_b32 v51, 16, v179
    v_and_b32 v178, s8, v178
    s_add_u32 m0, s95, 3072
    s_nop 0
    buffer_load_dwordx4 v27, s[28:31], s93 offen offset:0 lds
    v_and_b32 v179, s8, v179
    v_fmac_f32 v232, v50, v44
    v_fmac_f32 v234, v51, v44
    v_fmac_f32 v233, v178, v44
    v_fmac_f32 v235, v179, v44
    v_lshlrev_b32 v48, 16, v148
    v_lshlrev_b32 v49, 16, v149
    buffer_load_dwordx4 v28, s[28:31], s93 offen offset:1024 lds
    v_and_b32 v148, s8, v148
    v_and_b32 v149, s8, v149
    v_fmac_f32 v220, v48, v45
    v_fmac_f32 v222, v49, v45
    v_fmac_f32 v221, v148, v45
    v_fmac_f32 v223, v149, v45
    v_lshlrev_b32 v50, 16, v150
    buffer_load_dwordx4 v29, s[28:31], s93 offen offset:2048 lds
    v_lshlrev_b32 v51, 16, v151
    v_and_b32 v150, s8, v150
    v_and_b32 v151, s8, v151
    v_fmac_f32 v224, v50, v45
    v_fmac_f32 v226, v51, v45
    v_fmac_f32 v225, v150, v45
    v_fmac_f32 v227, v151, v45
    v_lshlrev_b32 v48, 16, v180
    v_lshlrev_b32 v49, 16, v181
    v_and_b32 v180, s8, v180
    v_and_b32 v181, s8, v181
    v_fmac_f32 v228, v48, v45
    v_fmac_f32 v230, v49, v45
    v_fmac_f32 v229, v180, v45
    v_fmac_f32 v231, v181, v45
    v_lshlrev_b32 v50, 16, v182
    v_lshlrev_b32 v51, 16, v183
    v_and_b32 v182, s8, v182
    v_and_b32 v183, s8, v183
    v_fmac_f32 v232, v50, v45
    v_fmac_f32 v234, v51, v45
    v_fmac_f32 v233, v182, v45
    v_fmac_f32 v235, v183, v45
    v_lshlrev_b32 v48, 16, v152
    v_lshlrev_b32 v49, 16, v153
    v_and_b32 v152, s8, v152
    v_and_b32 v153, s8, v153
    v_fmac_f32 v220, v48, v46
    v_fmac_f32 v222, v49, v46
    v_fmac_f32 v221, v152, v46
    v_fmac_f32 v223, v153, v46
    v_lshlrev_b32 v50, 16, v154
    s_waitcnt vmcnt(10)
    s_barrier
    s_add_u32 s12, s97, 0
    buffer_load_dwordx4 v[192:195], v31, s[64:67], s12 offen nt
    s_add_u32 s12, s97, 16384
    buffer_load_dwordx4 v[196:199], v31, s[64:67], s12 offen nt
    s_add_u32 s12, s97, 32768
    buffer_load_dwordx4 v[200:203], v31, s[64:67], s12 offen nt
    s_add_u32 s12, s97, 49152
    buffer_load_dwordx4 v[204:207], v31, s[64:67], s12 offen nt
    s_add_u32 s12, s97, 65536
    buffer_load_dwordx4 v[208:211], v31, s[64:67], s12 offen nt
    s_add_u32 s12, s97, 81920
    buffer_load_dwordx4 v[212:215], v31, s[64:67], s12 offen nt
    s_add_u32 s12, s97, 98304
    buffer_load_dwordx4 v[216:219], v31, s[64:67], s12 offen nt
    s_mul_i32 s12, s21, 8
    s_add_u32 s12, s12, 96
    s_lshl_b32 s13, s12, 10
    s_lshl_b32 s12, s12, 14
    s_add_u32 m0, s13, 24576
    s_add_u32 s90, s12, 0
    buffer_load_dwordx4 v33, s[36:39], s90 offen lds
    s_add_u32 m0, s13, 25600
    s_add_u32 s90, s12, 16384
    buffer_load_dwordx4 v33, s[36:39], s90 offen lds
    s_add_u32 m0, s13, 26624
    s_add_u32 s90, s12, 32768
    buffer_load_dwordx4 v33, s[36:39], s90 offen lds
    s_add_u32 m0, s13, 27648
    s_add_u32 s90, s12, 49152
    buffer_load_dwordx4 v33, s[36:39], s90 offen lds
    s_add_u32 m0, s13, 28672
    s_add_u32 s90, s12, 65536
    buffer_load_dwordx4 v33, s[36:39], s90 offen lds
    s_add_u32 m0, s13, 29696
    s_add_u32 s90, s12, 81920
    buffer_load_dwordx4 v33, s[36:39], s90 offen lds
    s_add_u32 m0, s13, 30720
    s_add_u32 s90, s12, 98304
    buffer_load_dwordx4 v33, s[36:39], s90 offen lds
    s_add_u32 m0, s13, 31744
    s_add_u32 s90, s12, 114688
    buffer_load_dwordx4 v33, s[36:39], s90 offen lds
    v_lshlrev_b32 v51, 16, v155
    v_and_b32 v154, s8, v154
    v_and_b32 v155, s8, v155
    v_fmac_f32 v224, v50, v46
    v_fmac_f32 v226, v51, v46
    v_fmac_f32 v225, v154, v46
    v_fmac_f32 v227, v155, v46
    v_lshlrev_b32 v48, 16, v184
    v_lshlrev_b32 v49, 16, v185
    v_and_b32 v184, s8, v184
    v_and_b32 v185, s8, v185
    v_fmac_f32 v228, v48, v46
    v_fmac_f32 v230, v49, v46
    v_fmac_f32 v229, v184, v46
    v_fmac_f32 v231, v185, v46
    v_lshlrev_b32 v50, 16, v186
    v_lshlrev_b32 v51, 16, v187
    v_and_b32 v186, s8, v186
    v_and_b32 v187, s8, v187
    v_fmac_f32 v232, v50, v46
    v_fmac_f32 v234, v51, v46
    v_fmac_f32 v233, v186, v46
    v_fmac_f32 v235, v187, v46
    v_lshlrev_b32 v48, 16, v156
    v_lshlrev_b32 v49, 16, v157
    s_waitcnt vmcnt(15)
    s_barrier
    v_and_b32 v156, s8, v156
    v_and_b32 v157, s8, v157
    v_fmac_f32 v220, v48, v47
    v_fmac_f32 v222, v49, v47
    v_fmac_f32 v221, v156, v47
    v_fmac_f32 v223, v157, v47
    v_lshlrev_b32 v50, 16, v158
    v_lshlrev_b32 v51, 16, v159
    v_and_b32 v158, s8, v158
    v_and_b32 v159, s8, v159
    v_fmac_f32 v224, v50, v47
    v_fmac_f32 v226, v51, v47
    v_fmac_f32 v225, v158, v47
    v_fmac_f32 v227, v159, v47
    v_lshlrev_b32 v48, 16, v188
    v_lshlrev_b32 v49, 16, v189
    v_and_b32 v188, s8, v188
    v_and_b32 v189, s8, v189
    v_fmac_f32 v228, v48, v47
    v_fmac_f32 v230, v49, v47
    v_fmac_f32 v229, v188, v47
    v_fmac_f32 v231, v189, v47
    v_lshlrev_b32 v50, 16, v190
    v_lshlrev_b32 v51, 16, v191
    v_and_b32 v190, s8, v190
    v_and_b32 v191, s8, v191
    v_fmac_f32 v232, v50, v47
    v_fmac_f32 v234, v51, v47
    v_fmac_f32 v233, v190, v47
    v_fmac_f32 v235, v191, v47
    v_permlane32_swap_b32 v220, v228
    v_permlane32_swap_b32 v221, v229
    v_permlane32_swap_b32 v222, v230
    v_permlane32_swap_b32 v223, v231
    v_permlane32_swap_b32 v224, v232
    v_permlane32_swap_b32 v225, v233
    v_permlane32_swap_b32 v226, v234
    v_permlane32_swap_b32 v227, v235
    v_add_f32 v220, v220, v228
    v_add_f32 v221, v221, v229
    v_add_f32 v222, v222, v230
    v_add_f32 v223, v223, v231
    v_add_f32 v224, v224, v232
    v_add_f32 v225, v225, v233
    v_add_f32 v226, v226, v234
    v_add_f32 v227, v227, v235
    v_permlane16_swap_b32 v220, v224
    v_permlane16_swap_b32 v221, v225
    v_permlane16_swap_b32 v222, v226
    v_permlane16_swap_b32 v223, v227
    v_add_f32 v220, v220, v224
    v_add_f32 v221, v221, v225
    v_add_f32 v222, v222, v226
    v_add_f32 v223, v223, v227
    v_add_f32_dpp v220, v220, v220 row_ror:8 row_mask:0xf bank_mask:0xf
    v_add_f32_dpp v221, v221, v221 row_ror:8 row_mask:0xf bank_mask:0xf
    v_add_f32_dpp v222, v222, v222 row_ror:8 row_mask:0xf bank_mask:0xf
    v_add_f32_dpp v223, v223, v223 row_ror:8 row_mask:0xf bank_mask:0xf
L_varend:
    s_nop 0
    v_lshrrev_b32 v14, 5, v2
    v_lshlrev_b32 v14, 8, v14
    v_lshl_add_u32 v14, v6, 5, v14
    v_and_b32 v16, 16, v2
    v_add_u32 v14, v14, v16
    s_lshl_b32 s12, s21, 9
    s_add_u32 s12, s12, 159744
    v_add_u32 v14, s12, v14
    ds_write_b128 v14, v[220:223]
    v_mov_b32 v14, 162848
    v_mov_b32 v16, 1
    s_mov_b64 exec, 1
    ds_add_rtn_u32 v17, v14, v16
    s_mov_b64 exec, -1
    s_waitcnt lgkmcnt(0)
    v_readfirstlane_b32 s12, v17
    s_nop 1
    s_cmp_lg_u32 s12, 3
    s_cbranch_scc1 L_nogu
    s_cmp_ge_u32 s10, 224
    s_cbranch_scc1 L_nogu
    v_lshlrev_b32 v14, 2, v2
    v_add_u32 v14, 159744, v14
    ds_read2st64_b32 v[220:221], v14 offset0:0 offset1:1
    ds_read2st64_b32 v[222:223], v14 offset0:2 offset1:3
    ds_read2st64_b32 v[224:225], v14 offset0:4 offset1:5
    ds_read2st64_b32 v[226:227], v14 offset0:6 offset1:7
    s_and_b32 s12, s10, 3
    s_mul_i32 s12, s12, 28672
    s_lshr_b32 s13, s10, 2
    s_lshl_b32 s13, s13, 8
    s_add_u32 s12, s12, 327680
    s_xor_b32 s90, s13, 1024
    s_add_u32 s90, s90, s12
    s_add_u32 s90, s90, 14336
    s_add_u32 s12, s12, s13
    v_lshlrev_b32 v14, 2, v2
    v_and_b32 v16, 1, v2
    v_lshlrev_b32 v16, 4, v16
    v_lshrrev_b32 v16, v16, s23
    v_bfe_u32 v17, v16, 8, 8
    v_and_b32 v16, 0xff, v16
    s_mov_b32 s13, 0xffffff00
    s_waitcnt lgkmcnt(0)
    v_pk_add_f32 v[220:221], v[220:221], v[222:223]
    v_pk_add_f32 v[224:225], v[224:225], v[226:227]
    v_pk_add_f32 v[220:221], v[220:221], v[224:225]
    v_and_or_b32 v220, v220, s13, v16
    v_and_or_b32 v221, v221, s13, v17
    buffer_store_dword v220, v14, s[32:35], s12 offen sc1
    buffer_store_dword v221, v14, s[32:35], s90 offen sc1
L_nogu:
    s_mul_i32 s12, s21, 4
    s_add_u32 s12, s12, 40
    s_lshl_b32 s13, s12, 10
    s_lshl_b32 s12, s12, 14
    s_add_u32 m0, s13, 24576
    s_add_u32 s90, s12, 0
    buffer_load_dwordx4 v33, s[36:39], s90 offen lds
    s_add_u32 m0, s13, 25600
    s_add_u32 s90, s12, 16384
    buffer_load_dwordx4 v33, s[36:39], s90 offen lds
    s_add_u32 m0, s13, 26624
    s_add_u32 s90, s12, 32768
    buffer_load_dwordx4 v33, s[36:39], s90 offen lds
    s_add_u32 m0, s13, 27648
    s_add_u32 s90, s12, 49152
    buffer_load_dwordx4 v33, s[36:39], s90 offen lds
    s_mul_i32 s12, s21, 10
    s_add_u32 s12, s12, 56
    s_lshl_b32 s13, s12, 10
    s_lshl_b32 s12, s12, 14
    s_add_u32 m0, s13, 24576
    s_add_u32 s90, s12, 0
    buffer_load_dwordx4 v33, s[36:39], s90 offen lds
    s_add_u32 m0, s13, 25600
    s_add_u32 s90, s12, 16384
    buffer_load_dwordx4 v33, s[36:39], s90 offen lds
    s_add_u32 m0, s13, 26624
    s_add_u32 s90, s12, 32768
    buffer_load_dwordx4 v33, s[36:39], s90 offen lds
    s_add_u32 m0, s13, 27648
    s_add_u32 s90, s12, 49152
    buffer_load_dwordx4 v33, s[36:39], s90 offen lds
    s_add_u32 m0, s13, 28672
    s_add_u32 s90, s12, 65536
    buffer_load_dwordx4 v33, s[36:39], s90 offen lds
    s_add_u32 m0, s13, 29696
    s_add_u32 s90, s12, 81920
    buffer_load_dwordx4 v33, s[36:39], s90 offen lds
    s_add_u32 m0, s13, 30720
    s_add_u32 s90, s12, 98304
    buffer_load_dwordx4 v33, s[36:39], s90 offen lds
    s_add_u32 m0, s13, 31744
    s_add_u32 s90, s12, 114688
    buffer_load_dwordx4 v33, s[36:39], s90 offen lds
    s_add_u32 m0, s13, 32768
    s_add_u32 s90, s12, 131072
    buffer_load_dwordx4 v33, s[36:39], s90 offen lds
    s_add_u32 m0, s13, 33792
    s_add_u32 s90, s12, 147456
    buffer_load_dwordx4 v33, s[36:39], s90 offen lds
    v_mov_b32 v14, 162816
    s_mov_b32 s13, 0
L_dspin_g:
    ds_read_b128 v[104:107], v14
    s_add_u32 s13, s13, 1
    s_cmp_ge_u32 s13, 262144
    s_cbranch_scc1 L_dok_g
    s_waitcnt lgkmcnt(0)
    v_and_b32 v104, v104, v105
    v_and_b32 v106, v106, v107
    v_and_b32 v104, v104, v106
    v_cmp_eq_u32 vcc, 1, v104
    s_cbranch_vccz L_dspin_g
L_dok_g:
    s_waitcnt lgkmcnt(0)
    s_mul_i32 s12, s21, 10
    s_add_u32 s12, s12, 0
    s_lshl_b32 s13, s12, 10
    s_lshl_b32 s12, s12, 14
    s_add_u32 m0, s13, 0
    s_add_u32 s90, s12, 0
    buffer_load_dwordx4 v33, s[36:39], s90 offen lds
    s_add_u32 m0, s13, 1024
    s_add_u32 s90, s12, 16384
    buffer_load_dwordx4 v33, s[36:39], s90 offen lds
    s_add_u32 m0, s13, 2048
    s_add_u32 s90, s12, 32768
    buffer_load_dwordx4 v33, s[36:39], s90 offen lds
    s_add_u32 m0, s13, 3072
    s_add_u32 s90, s12, 49152
    buffer_load_dwordx4 v33, s[36:39], s90 offen lds
    s_add_u32 m0, s13, 4096
    s_add_u32 s90, s12, 65536
    buffer_load_dwordx4 v33, s[36:39], s90 offen lds
    s_add_u32 m0, s13, 5120
    s_add_u32 s90, s12, 81920
    buffer_load_dwordx4 v33, s[36:39], s90 offen lds
    s_add_u32 m0, s13, 6144
    s_add_u32 s90, s12, 98304
    buffer_load_dwordx4 v33, s[36:39], s90 offen lds
    s_add_u32 m0, s13, 7168
    s_add_u32 s90, s12, 114688
    buffer_load_dwordx4 v33, s[36:39], s90 offen lds
    s_add_u32 m0, s13, 8192
    s_add_u32 s90, s12, 131072
    buffer_load_dwordx4 v33, s[36:39], s90 offen lds
    s_add_u32 m0, s13, 9216
    s_add_u32 s90, s12, 147456
    buffer_load_dwordx4 v33, s[36:39], s90 offen lds
    v_mov_b32 v62, v6
    v_mov_b32 v63, v35
    s_mov_b32 s86, s96
    s_mov_b32 s4, s15
    s_mov_b32 s5, s14
    v_mov_b32 v61, v33
    s_mov_b32 s68, s58
    s_and_b32 s69, s59, 0xffff
    s_mov_b32 s70, 4194304
    s_mov_b32 s71, 0x00020000
    s_and_b32 s90, s20, 3
    s_lshr_b32 s91, s20, 2
    s_lshl_b32 s12, s88, 3
    s_lshl_b32 s13, s90, 1
    s_add_u32 s12, s12, s13
    s_add_u32 s92, s12, s91
    s_lshl_b32 s12, s92, 4
    v_and_b32 v3, 15, v2
    v_add_u32 v6, s12, v3
    v_lshlrev_b32 v8, 2, v6
    v_bfe_u32 v9, v2, 4, 1
    v_lshrrev_b32 v10, 5, v2
    v_lshlrev_b32 v7, 11, v6
    v_lshl_add_u32 v7, v9, 6, v7
    v_lshl_add_u32 v7, v10, 4, v7
    s_lshl_b32 s12, s89, 7
    v_add_u32 v7, s12, v7
    s_mov_b32 s12, 4096
    buffer_load_dwordx4 v[24:27], v7, s[24:27], 0 offen
    buffer_load_dwordx4 v[28:31], v7, s[24:27], 0 offen offset:32
    buffer_load_dword v48, v8, s[32:35], s12 offen sc1
    v_lshlrev_b32 v22, 8, v3
    v_lshl_add_u32 v22, v9, 7, v22
    v_lshl_add_u32 v22, v10, 5, v22
    v_lshlrev_b32 v10, 9, v10
    v_bfe_u32 v11, v2, 2, 2
    v_lshl_add_u32 v10, v11, 7, v10
    v_bfe_u32 v11, v2, 3, 1
    v_lshl_add_u32 v10, v11, 6, v10
    v_lshl_add_u32 v10, v9, 5, v10
    v_and_b32 v11, 3, v2
    v_lshl_add_u32 v10, v11, 3, v10
    v_xor_b32 v11, 64, v10
    s_lshl_b32 s12, s91, 8
    v_xor_b32 v17, s12, v5
    v_lshlrev_b32 v8, 2, v3
    s_lshl_b32 s12, s20, 12
    s_mov_b32 s15, 40960
    s_cmp_lt_u32 s20, 6
    s_cselect_b32 s13, s15, 131072
    s_add_u32 s12, s12, s13
    v_add_u32 v20, s12, v5
    s_xor_b32 s14, s20, 4
    s_lshl_b32 s12, s14, 12
    s_cmp_lt_u32 s14, 6
    s_cselect_b32 s13, s15, 131072
    s_add_u32 s12, s12, s13
    v_add_u32 v21, s12, v5
    s_lshl_b32 s12, s88, 2
    s_add_u32 s12, s12, s90
    s_lshl_b32 s13, s12, 16
    s_lshl_b32 s14, s91, 15
    s_add_u32 s13, s13, s14
    s_add_u32 s95, s13, 8388608
    s_lshl_b32 s12, s88, 12
    s_lshl_b32 s13, s89, 8
    s_mul_i32 s13, s13, 1
    s_add_u32 s12, s12, s13
    s_lshr_b32 s13, s90, 1
    s_lshl_b32 s13, s13, 7
    s_add_u32 s12, s12, s13
    s_lshl_b32 s13, s91, 6
    s_add_u32 s12, s12, s13
    s_add_u32 s15, s12, 524288
    s_lshl_b32 s97, s91, 4
    v_lshlrev_b32 v8, 7, v3
    s_lshl_b32 s12, s88, 1
    s_lshr_b32 s13, s90, 1
    s_add_u32 s12, s12, s13
    s_lshl_b32 s12, s12, 12
    s_lshl_b32 s13, s91, 11
    s_add_u32 s12, s12, s13
    s_and_b32 s13, s89, 0
    s_lshl_b32 s13, s13, 17
    s_add_u32 s12, s12, s13
    s_add_u32 s15, s12, 6291456
    s_mov_b32 s93, s89
    s_cmp_lg_u32 s21, 0
    s_cbranch_scc0 L_hop
    s_waitcnt vmcnt(0)
    v_sub_f32 v50, 1.0, v48
    v_cvt_pk_bf16_f32 v50, v50, v50
    v_lshlrev_b32 v50, 16, v50
    v_lshlrev_b32 v32, 16, v24
    v_and_b32 v33, 0xffff0000, v24
    v_lshlrev_b32 v34, 16, v25
    v_and_b32 v35, 0xffff0000, v25
    v_lshlrev_b32 v36, 16, v26
    v_and_b32 v37, 0xffff0000, v26
    v_lshlrev_b32 v38, 16, v27
    v_and_b32 v39, 0xffff0000, v27
    v_lshlrev_b32 v40, 16, v28
    v_and_b32 v41, 0xffff0000, v28
    v_lshlrev_b32 v42, 16, v29
    v_and_b32 v43, 0xffff0000, v29
    v_lshlrev_b32 v44, 16, v30
    v_and_b32 v45, 0xffff0000, v30
    v_lshlrev_b32 v46, 16, v31
    v_and_b32 v47, 0xffff0000, v31
    v_pk_mul_f32 v[32:33], v[32:33], v[50:51] op_sel_hi:[1,0]
    v_pk_mul_f32 v[34:35], v[34:35], v[50:51] op_sel_hi:[1,0]
    v_pk_mul_f32 v[36:37], v[36:37], v[50:51] op_sel_hi:[1,0]
    v_pk_mul_f32 v[38:39], v[38:39], v[50:51] op_sel_hi:[1,0]
    v_pk_mul_f32 v[40:41], v[40:41], v[50:51] op_sel_hi:[1,0]
    v_pk_mul_f32 v[42:43], v[42:43], v[50:51] op_sel_hi:[1,0]
    v_pk_mul_f32 v[44:45], v[44:45], v[50:51] op_sel_hi:[1,0]
    v_pk_mul_f32 v[46:47], v[46:47], v[50:51] op_sel_hi:[1,0]
    v_cvt_pk_bf16_f32 v33, v32, v33
    v_cvt_pk_bf16_f32 v35, v34, v35
    v_cvt_pk_bf16_f32 v37, v36, v37
    v_cvt_pk_bf16_f32 v39, v38, v39
    v_cvt_pk_bf16_f32 v41, v40, v41
    v_cvt_pk_bf16_f32 v43, v42, v43
    v_cvt_pk_bf16_f32 v45, v44, v45
    v_cvt_pk_bf16_f32 v47, v46, v47
    v_lshlrev_b32 v32, 16, v33
    v_and_b32 v33, 0xffff0000, v33
    v_lshlrev_b32 v34, 16, v35
    v_and_b32 v35, 0xffff0000, v35
    v_lshlrev_b32 v36, 16, v37
    v_and_b32 v37, 0xffff0000, v37
    v_lshlrev_b32 v38, 16, v39
    v_and_b32 v39, 0xffff0000, v39
    v_lshlrev_b32 v40, 16, v41
    v_and_b32 v41, 0xffff0000, v41
    v_lshlrev_b32 v42, 16, v43
    v_and_b32 v43, 0xffff0000, v43
    v_lshlrev_b32 v44, 16, v45
    v_and_b32 v45, 0xffff0000, v45
    v_lshlrev_b32 v46, 16, v47
    v_and_b32 v47, 0xffff0000, v47
    v_mov_b32 v78, 162928
    s_mov_b32 s13, 0
L_gtu:
    ds_read_b128 v[104:107], v78
    s_add_u32 s13, s13, 1
    s_cmp_ge_u32 s13, 262144
    s_cbranch_scc1 L_gxu
    s_waitcnt lgkmcnt(0)
    v_and_b32 v104, v104, v105
    v_and_b32 v106, v106, v107
    v_and_b32 v104, v104, v106
    v_cmp_eq_u32 vcc, 1, v104
    s_cbranch_vccz L_gtu
L_gxu:
    s_waitcnt lgkmcnt(0)
    s_branch L_nohop
L_hop:
    v_mov_b32 v78, 162928
    s_mov_b32 s13, 0
L_gth:
    ds_read_b128 v[104:107], v78
    s_add_u32 s13, s13, 1
    s_cmp_ge_u32 s13, 262144
    s_cbranch_scc1 L_gxh
    s_waitcnt lgkmcnt(0)
    v_and_b32 v104, v104, v105
    v_and_b32 v106, v106, v107
    v_and_b32 v104, v104, v106
    v_cmp_eq_u32 vcc, 1, v104
    s_cbranch_vccz L_gth
L_gxh:
    s_waitcnt lgkmcnt(0)
    s_lshl_b32 s12, s19, 18
    s_lshl_b32 s13, s18, 14
    s_add_u32 s12, s12, s13
    s_add_u32 s80, s12, 1048576
    s_add_u32 s81, s80, 4096
    s_add_u32 s82, s80, 8192
    s_add_u32 s83, s80, 12288
    s_mov_b32 s13, 0
    s_lshl_b32 s12, s19, 13
    s_lshr_b32 s84, s18, 2
    s_lshl_b32 s84, s84, 11
    s_add_u32 s12, s12, s84
    s_bfe_u32 s84, s18, 0x10001
    s_lshl_b32 s84, s84, 6
    s_add_u32 s12, s12, s84
    s_and_b32 s84, s18, 1
    s_lshl_b32 s84, s84, 4
    s_add_u32 s12, s12, s84
    s_add_u32 s84, s12, 5242880
    v_and_b32 v80, 15, v2
    v_lshlrev_b32 v80, 7, v80
    v_lshrrev_b32 v78, 5, v2
    v_lshl_add_u32 v80, v78, 5, v80
    s_mov_b32 s87, 0
    s_mov_b32 s85, 0xffff
L_h1:
    buffer_load_dwordx4 v[104:107], v80, s[32:35], s84 offen sc1
    s_add_u32 s13, s13, 1
    s_cmp_ge_u32 s13, 16384
    s_cbranch_scc1 L_h1ok
    s_cmp_lg_u32 s87, 0
    s_cbranch_scc1 L_h1d
    s_waitcnt vmcnt(0)
    v_msad_u8 v108, v104, s76, 0
    v_msad_u8 v108, v105, s77, v108
    v_msad_u8 v108, v106, s78, v108
    v_msad_u8 v108, v107, s79, v108
    v_cmp_ne_u32 vcc, 0, v108
    s_nop 1
    s_or_b32 s12, vcc_lo, vcc_hi
    s_and_b32 s12, s12, 0xffff
    s_bcnt1_i32_b32 s12, s12
    s_cmp_le_u32 s12, 6
    s_cselect_b32 s87, 1, 0
    s_branch L_h1
L_h1d:
    s_bitcmp1_b32 s85, 0
    s_cselect_b64 exec, -1, 0
    buffer_load_dwordx4 v[128:131], v5, s[32:35], s80 offen offset:0 sc1
    s_bitcmp1_b32 s85, 1
    s_cselect_b64 exec, -1, 0
    buffer_load_dwordx4 v[132:135], v5, s[32:35], s80 offen offset:1024 sc1
    s_bitcmp1_b32 s85, 2
    s_cselect_b64 exec, -1, 0
    buffer_load_dwordx4 v[136:139], v5, s[32:35], s80 offen offset:2048 sc1
    s_bitcmp1_b32 s85, 3
    s_cselect_b64 exec, -1, 0
    buffer_load_dwordx4 v[140:143], v5, s[32:35], s80 offen offset:3072 sc1
    s_bitcmp1_b32 s85, 4
    s_cselect_b64 exec, -1, 0
    buffer_load_dwordx4 v[144:147], v5, s[32:35], s81 offen offset:0 sc1
    s_bitcmp1_b32 s85, 5
    s_cselect_b64 exec, -1, 0
    buffer_load_dwordx4 v[148:151], v5, s[32:35], s81 offen offset:1024 sc1
    s_bitcmp1_b32 s85, 6
    s_cselect_b64 exec, -1, 0
    buffer_load_dwordx4 v[152:155], v5, s[32:35], s81 offen offset:2048 sc1
    s_bitcmp1_b32 s85, 7
    s_cselect_b64 exec, -1, 0
    buffer_load_dwordx4 v[156:159], v5, s[32:35], s81 offen offset:3072 sc1
    s_bitcmp1_b32 s85, 8
    s_cselect_b64 exec, -1, 0
    buffer_load_dwordx4 v[160:163], v5, s[32:35], s82 offen offset:0 sc1
    s_bitcmp1_b32 s85, 9
    s_cselect_b64 exec, -1, 0
    buffer_load_dwordx4 v[164:167], v5, s[32:35], s82 offen offset:1024 sc1
    s_bitcmp1_b32 s85, 10
    s_cselect_b64 exec, -1, 0
    buffer_load_dwordx4 v[168:171], v5, s[32:35], s82 offen offset:2048 sc1
    s_bitcmp1_b32 s85, 11
    s_cselect_b64 exec, -1, 0
    buffer_load_dwordx4 v[172:175], v5, s[32:35], s82 offen offset:3072 sc1
    s_bitcmp1_b32 s85, 12
    s_cselect_b64 exec, -1, 0
    buffer_load_dwordx4 v[176:179], v5, s[32:35], s83 offen offset:0 sc1
    s_bitcmp1_b32 s85, 13
    s_cselect_b64 exec, -1, 0
    buffer_load_dwordx4 v[180:183], v5, s[32:35], s83 offen offset:1024 sc1
    s_bitcmp1_b32 s85, 14
    s_cselect_b64 exec, -1, 0
    buffer_load_dwordx4 v[184:187], v5, s[32:35], s83 offen offset:2048 sc1
    s_bitcmp1_b32 s85, 15
    s_cselect_b64 exec, -1, 0
    buffer_load_dwordx4 v[188:191], v5, s[32:35], s83 offen offset:3072 sc1
    s_mov_b64 exec, -1
    s_waitcnt vmcnt(16)
    v_msad_u8 v108, v104, s76, 0
    v_msad_u8 v108, v105, s77, v108
    v_msad_u8 v108, v106, s78, v108
    v_msad_u8 v108, v107, s79, v108
    v_cmp_ne_u32 vcc, 0, v108
    s_nop 1
    s_or_b32 s85, vcc_lo, vcc_hi
    s_and_b32 s85, s85, 0xffff
    s_bcnt1_i32_b32 s12, s85
    s_cmp_le_u32 s12, 6
    s_cselect_b32 s87, 1, 0
    s_cmp_lg_u32 s85, 0
    s_waitcnt vmcnt(0)
    s_cbranch_scc1 L_h1
    v_msad_u8 v108, v128, v63, 0
    v_msad_u8 v109, v132, v63, 0
    v_msad_u8 v108, v136, v63, v108
    v_msad_u8 v109, v140, v63, v109
    v_msad_u8 v108, v144, v63, v108
    v_msad_u8 v109, v148, v63, v109
    v_msad_u8 v108, v152, v63, v108
    v_msad_u8 v109, v156, v63, v109
    v_msad_u8 v108, v160, v63, v108
    v_msad_u8 v109, v164, v63, v109
    v_msad_u8 v108, v168, v63, v108
    v_msad_u8 v109, v172, v63, v109
    v_msad_u8 v108, v176, v63, v108
    v_msad_u8 v109, v180, v63, v109
    v_msad_u8 v108, v184, v63, v108
    v_msad_u8 v109, v188, v63, v109
    v_or_b32 v108, v108, v109
    v_cmp_ne_u32 vcc, 0, v108
    s_mov_b32 s85, 0xffff
    s_cbranch_vccnz L_h1
L_h1ok:
    s_waitcnt vmcnt(0)
    v_pk_add_f32 v[128:129], v[128:129], v[160:161]
    v_pk_add_f32 v[130:131], v[130:131], v[162:163]
    v_pk_add_f32 v[132:133], v[132:133], v[164:165]
    v_pk_add_f32 v[134:135], v[134:135], v[166:167]
    v_pk_add_f32 v[136:137], v[136:137], v[168:169]
    v_pk_add_f32 v[138:139], v[138:139], v[170:171]
    v_pk_add_f32 v[140:141], v[140:141], v[172:173]
    v_pk_add_f32 v[142:143], v[142:143], v[174:175]
    v_pk_add_f32 v[144:145], v[144:145], v[176:177]
    v_pk_add_f32 v[146:147], v[146:147], v[178:179]
    v_pk_add_f32 v[148:149], v[148:149], v[180:181]
    v_pk_add_f32 v[150:151], v[150:151], v[182:183]
    v_pk_add_f32 v[152:153], v[152:153], v[184:185]
    v_pk_add_f32 v[154:155], v[154:155], v[186:187]
    v_pk_add_f32 v[156:157], v[156:157], v[188:189]
    v_pk_add_f32 v[158:159], v[158:159], v[190:191]
    v_pk_add_f32 v[128:129], v[128:129], v[144:145]
    v_pk_add_f32 v[130:131], v[130:131], v[146:147]
    v_pk_add_f32 v[132:133], v[132:133], v[148:149]
    v_pk_add_f32 v[134:135], v[134:135], v[150:151]
    v_pk_add_f32 v[136:137], v[136:137], v[152:153]
    v_pk_add_f32 v[138:139], v[138:139], v[154:155]
    v_pk_add_f32 v[140:141], v[140:141], v[156:157]
    v_pk_add_f32 v[142:143], v[142:143], v[158:159]
    v_pk_add_f32 v[128:129], v[128:129], v[136:137]
    v_pk_add_f32 v[130:131], v[130:131], v[138:139]
    v_pk_add_f32 v[132:133], v[132:133], v[140:141]
    v_pk_add_f32 v[134:135], v[134:135], v[142:143]
    v_pk_add_f32 v[128:129], v[128:129], v[132:133]
    v_pk_add_f32 v[130:131], v[130:131], v[134:135]
    v_add_f32_dpp v104, v104, v104 row_ror:1 row_mask:0xf bank_mask:0xf
    v_add_f32_dpp v105, v105, v105 row_ror:1 row_mask:0xf bank_mask:0xf
    v_add_f32_dpp v106, v106, v106 row_ror:1 row_mask:0xf bank_mask:0xf
    v_add_f32_dpp v107, v107, v107 row_ror:1 row_mask:0xf bank_mask:0xf
    v_add_f32_dpp v104, v104, v104 row_ror:2 row_mask:0xf bank_mask:0xf
    v_add_f32_dpp v105, v105, v105 row_ror:2 row_mask:0xf bank_mask:0xf
    v_add_f32_dpp v106, v106, v106 row_ror:2 row_mask:0xf bank_mask:0xf
    v_add_f32_dpp v107, v107, v107 row_ror:2 row_mask:0xf bank_mask:0xf
    v_add_f32_dpp v104, v104, v104 row_ror:4 row_mask:0xf bank_mask:0xf
    v_add_f32_dpp v105, v105, v105 row_ror:4 row_mask:0xf bank_mask:0xf
    v_add_f32_dpp v106, v106, v106 row_ror:4 row_mask:0xf bank_mask:0xf
    v_add_f32_dpp v107, v107, v107 row_ror:4 row_mask:0xf bank_mask:0xf
    v_add_f32_dpp v104, v104, v104 row_ror:8 row_mask:0xf bank_mask:0xf
    v_add_f32_dpp v105, v105, v105 row_ror:8 row_mask:0xf bank_mask:0xf
    v_add_f32_dpp v106, v106, v106 row_ror:8 row_mask:0xf bank_mask:0xf
    v_add_f32_dpp v107, v107, v107 row_ror:8 row_mask:0xf bank_mask:0xf
    v_cvt_pk_bf16_f32 v108, v128, v129
    v_cvt_pk_bf16_f32 v109, v130, v131
    v_cvt_pk_bf16_f32 v112, v104, v105
    v_cvt_pk_bf16_f32 v113, v106, v107
    v_mov_b32 v110, v108
    v_mov_b32 v111, v109
    v_mov_b32 v114, v112
    v_mov_b32 v115, v113
    s_lshl_b32 s12, s19, 13
    s_lshl_b32 s13, s18, 9
    s_add_u32 s12, s12, s13
    s_add_u32 s12, s12, 32768
    s_lshl_b32 s13, s19, 11
    s_lshl_b32 s80, s18, 7
    s_add_u32 s13, s13, s80
    s_add_u32 s13, s13, 163840
    v_permlane32_swap_b32 v108, v110
    v_permlane32_swap_b32 v109, v111
    v_permlane32_swap_b32 v112, v114
    v_permlane32_swap_b32 v113, v115
    s_mov_b32 exec_hi, 0
    buffer_store_dwordx4 v[108:111], v5, s[32:35], s12 offen sc1
    s_mov_b32 exec_lo, 255
    buffer_store_dwordx4 v[112:115], v5, s[32:35], s13 offen sc1
    s_mov_b64 exec, -1
L_nohop:
    v_min_u32 v80, 6, v62
    v_lshl_add_u32 v80, v80, 3, v4
    v_lshlrev_b32 v80, 2, v80
    s_lshl_b32 s12, s86, 2
    s_add_u32 s80, s12, 327680
    s_add_u32 s81, s80, 28672
    s_add_u32 s82, s80, 57344
    s_add_u32 s83, s80, 86016
    v_and_b32 v78, 1, v4
    v_lshlrev_b32 v78, 4, v78
    v_lshrrev_b32 v78, v78, s23
    v_bfe_u32 v79, v78, 8, 8
    v_and_b32 v78, 0xff, v78
    s_mov_b32 s13, 0
    v_add_u32 v81, 14336, v80
L_gu:
    buffer_load_dword v104, v80, s[32:35], s80 offen sc1
    buffer_load_dword v105, v81, s[32:35], s80 offen sc1
    buffer_load_dword v106, v80, s[32:35], s81 offen sc1
    buffer_load_dword v107, v81, s[32:35], s81 offen sc1
    buffer_load_dword v108, v80, s[32:35], s82 offen sc1
    buffer_load_dword v109, v81, s[32:35], s82 offen sc1
    buffer_load_dword v110, v80, s[32:35], s83 offen sc1
    buffer_load_dword v111, v81, s[32:35], s83 offen sc1
    s_add_u32 s13, s13, 1
    s_cmp_lg_u32 s21, 0
    s_cbranch_scc1 L_nofl
    s_waitcnt vmcnt(8)
    v_mov_b32 v112, 162896
    v_mov_b32 v113, 1
    s_mov_b64 exec, 1
    ds_write_b32 v112, v113
    s_mov_b64 exec, -1
L_nofl:
    s_waitcnt vmcnt(0)
    v_msad_u8 v112, v104, v78, 0
    v_msad_u8 v112, v105, v79, v112
    v_msad_u8 v112, v106, v78, v112
    v_msad_u8 v112, v107, v79, v112
    v_msad_u8 v112, v108, v78, v112
    v_msad_u8 v112, v109, v79, v112
    v_msad_u8 v112, v110, v78, v112
    v_msad_u8 v112, v111, v79, v112
    v_cmp_ne_u32 vcc, 0, v112
    s_cbranch_vccz L_guok
    s_cmp_lt_u32 s13, 16384
    s_cbranch_scc1 L_gu
L_guok:
    v_pk_add_f32 v[104:105], v[104:105], v[106:107]
    v_pk_add_f32 v[108:109], v[108:109], v[110:111]
    v_pk_add_f32 v[104:105], v[104:105], v[108:109]
    v_cvt_pk_bf16_f32 v104, v104, v105
    v_and_b32 v105, 0xffff0000, v104
    v_lshlrev_b32 v104, 16, v104
    v_mul_f32 v106, 0xbfb8aa3b, v104
    v_exp_f32 v106, v106
    s_nop 0
    v_add_f32 v106, 1.0, v106
    v_rcp_f32 v106, v106
    s_nop 0
    v_mul_f32 v106, v106, v104
    v_cvt_pk_bf16_f32 v106, v106, v106
    v_lshlrev_b32 v106, 16, v106
    v_mul_f32 v106, v106, v105
    v_cvt_pk_bf16_f32 v106, v106, v106
    ds_swizzle_b32 v64, v106 offset:0x18
    ds_swizzle_b32 v66, v106 offset:0x38
    ds_swizzle_b32 v68, v106 offset:0x58
    ds_swizzle_b32 v70, v106 offset:0x78
    ds_swizzle_b32 v72, v106 offset:0x98
    ds_swizzle_b32 v74, v106 offset:0xb8
    ds_swizzle_b32 v76, v106 offset:0xd8
    s_waitcnt lgkmcnt(0)
    v_and_b32 v65, 0xffff0000, v64
    v_and_b32 v64, 0xffff, v64
    v_and_b32 v67, 0xffff0000, v66
    v_and_b32 v66, 0xffff, v66
    v_and_b32 v69, 0xffff0000, v68
    v_and_b32 v68, 0xffff, v68
    v_and_b32 v71, 0xffff0000, v70
    v_and_b32 v70, 0xffff, v70
    v_and_b32 v73, 0xffff0000, v72
    v_and_b32 v72, 0xffff, v72
    v_and_b32 v75, 0xffff0000, v74
    v_and_b32 v74, 0xffff, v74
    v_and_b32 v77, 0xffff0000, v76
    v_and_b32 v76, 0xffff, v76
    v_dot2_f32_bf16 v220, v192, v64, 0
    v_dot2_f32_bf16 v221, v192, v65, 0
    v_dot2_f32_bf16 v222, v193, v64, 0
    v_dot2_f32_bf16 v223, v193, v65, 0
    v_dot2_f32_bf16 v224, v194, v64, 0
    v_dot2_f32_bf16 v225, v194, v65, 0
    v_dot2_f32_bf16 v226, v195, v64, 0
    v_dot2_f32_bf16 v227, v195, v65, 0
    v_dot2_f32_bf16 v220, v196, v66, v220
    v_dot2_f32_bf16 v221, v196, v67, v221
    v_dot2_f32_bf16 v222, v197, v66, v222
    v_dot2_f32_bf16 v223, v197, v67, v223
    v_dot2_f32_bf16 v224, v198, v66, v224
    v_dot2_f32_bf16 v225, v198, v67, v225
    v_dot2_f32_bf16 v226, v199, v66, v226
    v_dot2_f32_bf16 v227, v199, v67, v227
    v_dot2_f32_bf16 v220, v200, v68, v220
    v_dot2_f32_bf16 v221, v200, v69, v221
    v_dot2_f32_bf16 v222, v201, v68, v222
    v_dot2_f32_bf16 v223, v201, v69, v223
    v_dot2_f32_bf16 v224, v202, v68, v224
    v_dot2_f32_bf16 v225, v202, v69, v225
    v_dot2_f32_bf16 v226, v203, v68, v226
    v_dot2_f32_bf16 v227, v203, v69, v227
    v_dot2_f32_bf16 v220, v204, v70, v220
    v_dot2_f32_bf16 v221, v204, v71, v221
    v_dot2_f32_bf16 v222, v205, v70, v222
    v_dot2_f32_bf16 v223, v205, v71, v223
    v_dot2_f32_bf16 v224, v206, v70, v224
    v_dot2_f32_bf16 v225, v206, v71, v225
    v_dot2_f32_bf16 v226, v207, v70, v226
    v_dot2_f32_bf16 v227, v207, v71, v227
    v_dot2_f32_bf16 v220, v208, v72, v220
    v_dot2_f32_bf16 v221, v208, v73, v221
    v_dot2_f32_bf16 v222, v209, v72, v222
    v_dot2_f32_bf16 v223, v209, v73, v223
    v_dot2_f32_bf16 v224, v210, v72, v224
    v_dot2_f32_bf16 v225, v210, v73, v225
    v_dot2_f32_bf16 v226, v211, v72, v226
    v_dot2_f32_bf16 v227, v211, v73, v227
    v_dot2_f32_bf16 v220, v212, v74, v220
    v_dot2_f32_bf16 v221, v212, v75, v221
    v_dot2_f32_bf16 v222, v213, v74, v222
    v_dot2_f32_bf16 v223, v213, v75, v223
    v_dot2_f32_bf16 v224, v214, v74, v224
    v_dot2_f32_bf16 v225, v214, v75, v225
    v_dot2_f32_bf16 v226, v215, v74, v226
    v_dot2_f32_bf16 v227, v215, v75, v227
    v_dot2_f32_bf16 v220, v216, v76, v220
    v_dot2_f32_bf16 v221, v216, v77, v221
    v_dot2_f32_bf16 v222, v217, v76, v222
    v_dot2_f32_bf16 v223, v217, v77, v223
    v_dot2_f32_bf16 v224, v218, v76, v224
    v_dot2_f32_bf16 v225, v218, v77, v225
    v_dot2_f32_bf16 v226, v219, v76, v226
    v_dot2_f32_bf16 v227, v219, v77, v227
    v_permlane32_swap_b32 v220, v224
    v_permlane32_swap_b32 v221, v225
    v_permlane32_swap_b32 v222, v226
    v_permlane32_swap_b32 v223, v227
    v_add_f32 v220, v220, v224
    v_add_f32 v221, v221, v225
    v_add_f32 v222, v222, v226
    v_add_f32 v223, v223, v227
    s_nop 0
    v_permlane16_swap_b32 v220, v222
    v_permlane16_swap_b32 v221, v223
    v_add_f32 v220, v220, v222
    v_add_f32 v221, v221, v223
    s_nop 0
    v_add_f32_dpp v220, v220, v220 row_ror:8 row_mask:0xf bank_mask:0xf
    v_add_f32_dpp v221, v221, v221 row_ror:8 row_mask:0xf bank_mask:0xf
    v_lshrrev_b32 v80, 4, v2
    v_lshlrev_b32 v80, 3, v80
    v_lshl_add_u32 v80, v62, 5, v80
    s_lshl_b32 s12, s21, 8
    s_add_u32 s12, s12, 161792
    v_add_u32 v80, s12, v80
    ds_write_b64 v80, v[220:221]
    v_mov_b32 v80, 162848
    v_mov_b32 v78, 1
    s_mov_b64 exec, 1
    ds_add_rtn_u32 v79, v80, v78 offset:4
    s_mov_b64 exec, -1
    s_waitcnt lgkmcnt(0)
    v_readfirstlane_b32 s12, v79
    s_nop 1
    s_cmp_lg_u32 s12, 3
    s_cbranch_scc1 L_noy
    v_lshlrev_b32 v78, 2, v2
    v_add_u32 v80, 161792, v78
    ds_read2st64_b32 v[220:221], v80 offset0:0 offset1:1
    ds_read2st64_b32 v[222:223], v80 offset0:2 offset1:3
    s_lshl_b32 s12, s11, 8
    s_add_u32 s12, s12, 458752
    s_mov_b32 s13, 0xffffff00
    s_waitcnt lgkmcnt(0)
    v_pk_add_f32 v[220:221], v[220:221], v[222:223]
    v_add_f32 v220, v220, v221
    v_and_or_b32 v220, v220, s13, v63
    buffer_store_dword v220, v78, s[32:35], s12 offen sc1
L_noy:
    s_cmp_lg_u32 s21, 0
    s_cbranch_scc1 L_prepd
    s_waitcnt vmcnt(0)
    v_sub_f32 v50, 1.0, v48
    v_cvt_pk_bf16_f32 v50, v50, v50
    v_lshlrev_b32 v50, 16, v50
    v_lshlrev_b32 v32, 16, v24
    v_and_b32 v33, 0xffff0000, v24
    v_lshlrev_b32 v34, 16, v25
    v_and_b32 v35, 0xffff0000, v25
    v_lshlrev_b32 v36, 16, v26
    v_and_b32 v37, 0xffff0000, v26
    v_lshlrev_b32 v38, 16, v27
    v_and_b32 v39, 0xffff0000, v27
    v_lshlrev_b32 v40, 16, v28
    v_and_b32 v41, 0xffff0000, v28
    v_lshlrev_b32 v42, 16, v29
    v_and_b32 v43, 0xffff0000, v29
    v_lshlrev_b32 v44, 16, v30
    v_and_b32 v45, 0xffff0000, v30
    v_lshlrev_b32 v46, 16, v31
    v_and_b32 v47, 0xffff0000, v31
    v_pk_mul_f32 v[32:33], v[32:33], v[50:51] op_sel_hi:[1,0]
    v_pk_mul_f32 v[34:35], v[34:35], v[50:51] op_sel_hi:[1,0]
    v_pk_mul_f32 v[36:37], v[36:37], v[50:51] op_sel_hi:[1,0]
    v_pk_mul_f32 v[38:39], v[38:39], v[50:51] op_sel_hi:[1,0]
    v_pk_mul_f32 v[40:41], v[40:41], v[50:51] op_sel_hi:[1,0]
    v_pk_mul_f32 v[42:43], v[42:43], v[50:51] op_sel_hi:[1,0]
    v_pk_mul_f32 v[44:45], v[44:45], v[50:51] op_sel_hi:[1,0]
    v_pk_mul_f32 v[46:47], v[46:47], v[50:51] op_sel_hi:[1,0]
    v_cvt_pk_bf16_f32 v33, v32, v33
    v_cvt_pk_bf16_f32 v35, v34, v35
    v_cvt_pk_bf16_f32 v37, v36, v37
    v_cvt_pk_bf16_f32 v39, v38, v39
    v_cvt_pk_bf16_f32 v41, v40, v41
    v_cvt_pk_bf16_f32 v43, v42, v43
    v_cvt_pk_bf16_f32 v45, v44, v45
    v_cvt_pk_bf16_f32 v47, v46, v47
    v_lshlrev_b32 v32, 16, v33
    v_and_b32 v33, 0xffff0000, v33
    v_lshlrev_b32 v34, 16, v35
    v_and_b32 v35, 0xffff0000, v35
    v_lshlrev_b32 v36, 16, v37
    v_and_b32 v37, 0xffff0000, v37
    v_lshlrev_b32 v38, 16, v39
    v_and_b32 v39, 0xffff0000, v39
    v_lshlrev_b32 v40, 16, v41
    v_and_b32 v41, 0xffff0000, v41
    v_lshlrev_b32 v42, 16, v43
    v_and_b32 v43, 0xffff0000, v43
    v_lshlrev_b32 v44, 16, v45
    v_and_b32 v45, 0xffff0000, v45
    v_lshlrev_b32 v46, 16, v47
    v_and_b32 v47, 0xffff0000, v47
L_prepd:
    s_mov_b32 s21, s4
    s_mov_b32 s22, s5
    s_mov_b32 s45, 0
    s_lshr_b32 s12, s21, 4
    s_cmp_eq_u32 s12, s92
    s_cselect_b32 s46, 1, 0
    s_cbranch_scc0 L_b_noownl
    s_lshl_b32 s12, s89, 12
    s_add_u32 s12, s12, 458752
    buffer_load_dwordx4 v[224:227], v22, s[32:35], s12 offen offset:0 sc1
    buffer_load_dwordx4 v[228:231], v22, s[32:35], s12 offen offset:16 sc1
    buffer_load_dwordx4 v[232:235], v22, s[32:35], s12 offen offset:64 sc1
    buffer_load_dwordx4 v[236:239], v22, s[32:35], s12 offen offset:80 sc1
L_b_noownl:
    s_branch L_phaseb
L_keyre_0:
    s_add_u32 s13, s13, 1
    s_cmp_ge_u32 s13, 16384
    s_cbranch_scc1 L_keyok_0
    s_mov_b32 s12, 0
    buffer_load_dwordx4 v[104:107], v5, s[32:35], s12 offen offset:0 sc1
    buffer_load_dwordx4 v[108:111], v5, s[32:35], s12 offen offset:1024 sc1
    s_waitcnt vmcnt(0)
    v_xor_b32 v105, s23, v105
    v_xor_b32 v107, s23, v107
    v_xor_b32 v109, s23, v109
    v_xor_b32 v111, s23, v111
    v_or3_b32 v105, v105, v107, v109
    v_or_b32 v105, v105, v111
    v_cmp_ne_u32 vcc, 0, v105
    s_cbranch_vccnz L_keyre_0
    s_branch L_keyok_0
L_keyre_1:
    s_add_u32 s13, s13, 1
    s_cmp_ge_u32 s13, 16384
    s_cbranch_scc1 L_keyok_1
    s_mov_b32 s12, 0
    buffer_load_dwordx4 v[104:107], v5, s[32:35], s12 offen offset:0 sc1
    buffer_load_dwordx4 v[108:111], v5, s[32:35], s12 offen offset:1024 sc1
    s_waitcnt vmcnt(0)
    v_xor_b32 v105, s23, v105
    v_xor_b32 v107, s23, v107
    v_xor_b32 v109, s23, v109
    v_xor_b32 v111, s23, v111
    v_or3_b32 v105, v105, v107, v109
    v_or_b32 v105, v105, v111
    v_cmp_ne_u32 vcc, 0, v105
    s_cbranch_vccnz L_keyre_1
    s_branch L_keyok_1
L_keyre_2:
    s_add_u32 s13, s13, 1
    s_cmp_ge_u32 s13, 16384
    s_cbranch_scc1 L_keyok_2
    s_mov_b32 s12, 0
    buffer_load_dwordx4 v[104:107], v5, s[32:35], s12 offen offset:0 sc1
    buffer_load_dwordx4 v[108:111], v5, s[32:35], s12 offen offset:1024 sc1
    s_waitcnt vmcnt(0)
    v_xor_b32 v105, s23, v105
    v_xor_b32 v107, s23, v107
    v_xor_b32 v109, s23, v109
    v_xor_b32 v111, s23, v111
    v_or3_b32 v105, v105, v107, v109
    v_or_b32 v105, v105, v111
    v_cmp_ne_u32 vcc, 0, v105
    s_cbranch_vccnz L_keyre_2
    s_branch L_keyok_2
L_keyre_3:
    s_add_u32 s13, s13, 1
    s_cmp_ge_u32 s13, 16384
    s_cbranch_scc1 L_keyok_3
    s_mov_b32 s12, 0
    buffer_load_dwordx4 v[104:107], v5, s[32:35], s12 offen offset:0 sc1
    buffer_load_dwordx4 v[108:111], v5, s[32:35], s12 offen offset:1024 sc1
    s_waitcnt vmcnt(0)
    v_xor_b32 v105, s23, v105
    v_xor_b32 v107, s23, v107
    v_xor_b32 v109, s23, v109
    v_xor_b32 v111, s23, v111
    v_or3_b32 v105, v105, v107, v109
    v_or_b32 v105, v105, v111
    v_cmp_ne_u32 vcc, 0, v105
    s_cbranch_vccnz L_keyre_3
    s_branch L_keyok_3
L_keyre_4:
    s_add_u32 s13, s13, 1
    s_cmp_ge_u32 s13, 16384
    s_cbranch_scc1 L_keyok_4
    s_mov_b32 s12, 0
    buffer_load_dwordx4 v[104:107], v5, s[32:35], s12 offen offset:0 sc1
    buffer_load_dwordx4 v[108:111], v5, s[32:35], s12 offen offset:1024 sc1
    s_waitcnt vmcnt(0)
    v_xor_b32 v105, s23, v105
    v_xor_b32 v107, s23, v107
    v_xor_b32 v109, s23, v109
    v_xor_b32 v111, s23, v111
    v_or3_b32 v105, v105, v107, v109
    v_or_b32 v105, v105, v111
    v_cmp_ne_u32 vcc, 0, v105
    s_cbranch_vccnz L_keyre_4
    s_branch L_keyok_4
L_compute:
    s_setprio 1
    s_lshr_b32 s21, s20, 1
    s_and_b32 s22, s20, 1
    v_lshrrev_b32 v3, 5, v2
    v_and_b32 v4, 31, v2
    s_lshl_b32 s12, s21, 13
    v_lshlrev_b32 v6, 7, v4
    v_add_u32 v6, s12, v6
    v_bfe_u32 v7, v2, 1, 3
    v_add_u32 v8, 0, v3
    v_xor_b32 v8, v8, v7
    v_lshl_add_u32 v20, v8, 4, v6
    v_add_u32 v8, 2, v3
    v_xor_b32 v8, v8, v7
    v_lshl_add_u32 v21, v8, 4, v6
    v_add_u32 v8, 4, v3
    v_xor_b32 v8, v8, v7
    v_lshl_add_u32 v22, v8, 4, v6
    v_add_u32 v8, 6, v3
    v_xor_b32 v8, v8, v7
    v_lshl_add_u32 v23, v8, 4, v6
    v_lshlrev_b32 v6, 10, v3
    v_bfe_u32 v7, v2, 2, 2
    v_lshl_add_u32 v6, v7, 7, v6
    v_bfe_u32 v8, v2, 3, 1
    v_xor_b32 v8, s22, v8
    v_lshl_add_u32 v6, v8, 6, v6
    v_bfe_u32 v8, v2, 4, 1
    v_lshlrev_b32 v8, 5, v8
    v_and_b32 v9, 3, v2
    v_lshl_add_u32 v8, v9, 3, v8
    v_add_u32 v6, v6, v8
    v_add_u32 v36, 16384, v6
    v_lshl_add_u32 v7, v3, 2, v7
    v_lshl_add_u32 v12, v7, 6, v8
    s_lshl_b32 s12, s22, 11
    s_add_u32 s12, s12, 155648
    v_add_u32 v12, s12, v12
    v_lshlrev_b32 v6, 14, v3
    v_lshl_add_u32 v6, v4, 4, v6
    v_lshlrev_b32 v7, 9, v3
    s_lshl_b32 s12, s22, 3
    s_lshl_b32 s13, s21, 2
    s_add_u32 s12, s12, s13
    s_lshl_b32 s13, s12, 14
    s_lshl_b32 s14, s19, 18
    s_add_u32 s13, s13, s14
    s_lshl_b32 s14, s18, 10
    s_add_u32 s13, s13, s14
    s_add_u32 s40, s13, 1048576
    s_add_u32 s41, s40, 32768
    s_lshl_b32 s13, s12, 9
    s_lshl_b32 s14, s19, 13
    s_add_u32 s13, s13, s14
    s_lshl_b32 s14, s18, 5
    s_add_u32 s13, s13, s14
    s_add_u32 s42, s13, 5242880
    s_add_u32 s43, s42, 1024
    s_lshl_b32 s13, s21, 4
    s_lshl_b32 s44, 1, s13
    s_xor_b32 s13, s13, 16
    s_lshl_b32 s45, 1, s13
    s_lshl_b32 s13, s22, 1
    s_add_u32 s13, s13, s21
    s_lshl_b32 s13, s13, 11
    s_lshl_b32 s14, s19, 13
    s_add_u32 s13, s13, s14
    s_lshl_b32 s14, s18, 7
    s_add_u32 s13, s13, s14
    s_add_u32 s42, s13, 5242880
    s_mov_b32 s45, 0x10001
    v_lshlrev_b32 v7, 2, v2
    v_mov_b32 v68, 0
    v_mov_b32 v69, 0
    v_mov_b32 v70, 0
    v_mov_b32 v71, 0
    v_mov_b32 v160, 0
    v_mov_b32 v161, 0
    v_mov_b32 v162, 0
    v_mov_b32 v163, 0
    v_mov_b32 v164, 0
    v_mov_b32 v165, 0
    v_mov_b32 v166, 0
    v_mov_b32 v167, 0
    v_mov_b32 v168, 0
    v_mov_b32 v169, 0
    v_mov_b32 v170, 0
    v_mov_b32 v171, 0
    v_mov_b32 v172, 0
    v_mov_b32 v173, 0
    v_mov_b32 v174, 0
    v_mov_b32 v175, 0
    v_mov_b32 v176, 0
    v_mov_b32 v177, 0
    v_mov_b32 v178, 0
    v_mov_b32 v179, 0
    v_mov_b32 v180, 0
    v_mov_b32 v181, 0
    v_mov_b32 v182, 0
    v_mov_b32 v183, 0
    v_mov_b32 v184, 0
    v_mov_b32 v185, 0
    v_mov_b32 v186, 0
    v_mov_b32 v187, 0
    v_mov_b32 v188, 0
    v_mov_b32 v189, 0
    v_mov_b32 v190, 0
    v_mov_b32 v191, 0
    v_mov_b32 v192, 0
    v_mov_b32 v193, 0
    v_mov_b32 v194, 0
    v_mov_b32 v195, 0
    v_mov_b32 v196, 0
    v_mov_b32 v197, 0
    v_mov_b32 v198, 0
    v_mov_b32 v199, 0
    v_mov_b32 v200, 0
    v_mov_b32 v201, 0
    v_mov_b32 v202, 0
    v_mov_b32 v203, 0
    v_mov_b32 v204, 0
    v_mov_b32 v205, 0
    v_mov_b32 v206, 0
    v_mov_b32 v207, 0
    v_mov_b32 v208, 0
    v_mov_b32 v209, 0
    v_mov_b32 v210, 0
    v_mov_b32 v211, 0
    v_mov_b32 v212, 0
    v_mov_b32 v213, 0
    v_mov_b32 v214, 0
    v_mov_b32 v215, 0
    v_mov_b32 v216, 0
    v_mov_b32 v217, 0
    v_mov_b32 v218, 0
    v_mov_b32 v219, 0
    v_mov_b32 v220, 0
    v_mov_b32 v221, 0
    v_mov_b32 v222, 0
    v_mov_b32 v223, 0
    v_mov_b32 v224, 0
    v_mov_b32 v225, 0
    v_mov_b32 v226, 0
    v_mov_b32 v227, 0
    v_mov_b32 v228, 0
    v_mov_b32 v229, 0
    v_mov_b32 v230, 0
    v_mov_b32 v231, 0
    v_mov_b32 v232, 0
    v_mov_b32 v233, 0
    v_mov_b32 v234, 0
    v_mov_b32 v235, 0
    v_mov_b32 v236, 0
    v_mov_b32 v237, 0
    v_mov_b32 v238, 0
    v_mov_b32 v239, 0
    v_mov_b32 v240, 0
    v_mov_b32 v241, 0
    v_mov_b32 v242, 0
    v_mov_b32 v243, 0
    v_mov_b32 v244, 0
    v_mov_b32 v245, 0
    v_mov_b32 v246, 0
    v_mov_b32 v247, 0
    v_mov_b32 v248, 0
    v_mov_b32 v249, 0
    v_mov_b32 v250, 0
    v_mov_b32 v251, 0
    v_mov_b32 v252, 0
    v_mov_b32 v253, 0
    v_mov_b32 v254, 0
    v_mov_b32 v255, 0
    v_lshlrev_b32 v8, 2, v3
    v_sub_u32 v8, v4, v8
    v_mov_b32 v9, 0x3f80
    v_mov_b32 v10, 0x3f800000
    v_cmp_eq_u32 vcc, 0, v8
    s_nop 1
    v_cndmask_b32 v11, 0, v9, vcc
    v_cmp_eq_u32 vcc, 1, v8
    s_nop 1
    v_cndmask_b32 v48, v11, v10, vcc
    v_cmp_eq_u32 vcc, 2, v8
    s_nop 1
    v_cndmask_b32 v11, 0, v9, vcc
    v_cmp_eq_u32 vcc, 3, v8
    s_nop 1
    v_cndmask_b32 v49, v11, v10, vcc
    v_cmp_eq_u32 vcc, 8, v8
    s_nop 1
    v_cndmask_b32 v11, 0, v9, vcc
    v_cmp_eq_u32 vcc, 9, v8
    s_nop 1
    v_cndmask_b32 v50, v11, v10, vcc
    v_cmp_eq_u32 vcc, 10, v8
    s_nop 1
    v_cndmask_b32 v11, 0, v9, vcc
    v_cmp_eq_u32 vcc, 11, v8
    s_nop 1
    v_cndmask_b32 v51, v11, v10, vcc
    v_cmp_eq_u32 vcc, 16, v8
    s_nop 1
    v_cndmask_b32 v11, 0, v9, vcc
    v_cmp_eq_u32 vcc, 17, v8
    s_nop 1
    v_cndmask_b32 v52, v11, v10, vcc
    v_cmp_eq_u32 vcc, 18, v8
    s_nop 1
    v_cndmask_b32 v11, 0, v9, vcc
    v_cmp_eq_u32 vcc, 19, v8
    s_nop 1
    v_cndmask_b32 v53, v11, v10, vcc
    v_cmp_eq_u32 vcc, 24, v8
    s_nop 1
    v_cndmask_b32 v11, 0, v9, vcc
    v_cmp_eq_u32 vcc, 25, v8
    s_nop 1
    v_cndmask_b32 v54, v11, v10, vcc
    v_cmp_eq_u32 vcc, 26, v8
    s_nop 1
    v_cndmask_b32 v11, 0, v9, vcc
    v_cmp_eq_u32 vcc, 27, v8
    s_nop 1
    v_cndmask_b32 v55, v11, v10, vcc
    v_mov_b32 v9, 0x3f803f80
    v_cmp_gt_u32 vcc, 16, v4
    s_nop 1
    v_cndmask_b32 v56, 0, v9, vcc
    v_cndmask_b32 v60, v9, 0, vcc
    v_cndmask_b32 v57, 0, v9, vcc
    v_cndmask_b32 v61, v9, 0, vcc
    v_cndmask_b32 v58, 0, v9, vcc
    v_cndmask_b32 v62, v9, 0, vcc
    v_cndmask_b32 v59, 0, v9, vcc
    v_cndmask_b32 v63, v9, 0, vcc
    s_waitcnt lgkmcnt(0)
    s_mov_b32 s32, s62
    s_and_b32 s33, s63, 0xffff
    s_mov_b32 s34, 33554432
    s_mov_b32 s35, 0x00020000
    s_mov_b32 s24, s4
    s_and_b32 s25, s5, 0xffff
    s_mov_b32 s26, 4194304
    s_mov_b32 s27, 0x00020000
    s_cmp_lg_u32 s20, 0
    s_cbranch_scc1 L_c_noinit
    v_add_u32 v8, 162816, v5
    s_mov_b64 exec, 0xff
    ds_write_b128 v8, v[68:71]
    s_mov_b64 exec, -1
    s_cmp_lg_u32 s2, 0
    s_cbranch_scc1 L_c_noinit
    s_mov_b32 s72, s60
    s_and_b32 s73, s61, 0xffff
    s_mov_b32 s74, 256
    s_mov_b32 s75, 0x00020000
    s_memrealtime s[14:15]
    s_waitcnt lgkmcnt(0)
    s_mul_i32 s14, s14, 0x9e3779b1
    s_or_b32 s14, s14, 0x01010101
    v_mov_b32 v8, s14
    s_mov_b64 exec, 1
    buffer_store_dword v8, v68, s[72:75], 0 offen offset:4 sc1
    s_mov_b64 exec, -1
L_c_noinit:
    s_lshl_b32 s14, s22, 1
    s_add_u32 s15, s14, s21
    s_xor_b32 s14, s15, 1
    s_mul_i32 s14, s14, 4352
    s_mul_i32 s15, s15, 4352
    s_add_u32 s14, s14, 40960
    s_add_u32 s15, s15, 40960
    v_add_u32 v8, s14, v5
    v_add_u32 v9, s15, v5
    v_lshlrev_b32 v11, 4, v3
    v_add_u32 v10, s14, v11
    v_add_u32 v11, s15, v11
    s_lshl_b32 s14, s20, 2
    s_add_u32 s15, s14, 162832
    v_mov_b32 v13, s15
    v_xor_b32 v14, 8, v13
    v_subrev_u32 v17, 16, v13
    v_mov_b32 v15, 1
    v_bfe_u32 v16, v2, 4, 1
    v_cmp_eq_u32 vcc, s21, v16
    s_nop 1
    v_cndmask_b32 v10, v10, v11, vcc
    s_lshl_b32 s14, s21, 7
    v_add_u32 v10, s14, v10
    v_lshrrev_b32 v11, 2, v5
    v_sub_u32 v16, v9, v5
    v_add_u32 v11, v16, v11
    s_waitcnt lgkmcnt(0)
    s_barrier
    ds_read_b128 v[100:103], v20
    ds_read_b64_tr_b16 v[108:109], v36 offset:0
    ds_read_b64_tr_b16 v[110:111], v36 offset:512
    ds_read_b128 v[104:107], v20 offset:4096
    ds_read_b64_tr_b16 v[112:113], v36 offset:8192
    ds_read_b64_tr_b16 v[114:115], v36 offset:8704
    ds_read_b64_tr_b16 v[116:117], v36 offset:16384
    ds_read_b64_tr_b16 v[118:119], v36 offset:16896
    s_mov_b32 s48, 0
    s_mov_b32 s49, 0
.p2align 3
L_c_loop:
    s_add_u32 s49, s49, 1
    s_cmp_eq_u32 s49, 3
    s_mov_b32 s50, 40960
    s_cselect_b32 s50, 4294885376, s50
    s_cselect_b32 s49, 0, s49
    s_waitcnt lgkmcnt(5)
    v_mfma_f32_32x32x16_bf16 v[160:175], v[108:111], v[100:103], v[160:175]
    ds_read_b128 v[120:123], v21
    ds_read_b64_tr_b16 v[128:129], v36 offset:2048
    s_waitcnt lgkmcnt(6)
    v_mfma_f32_32x32x16_bf16 v[176:191], v[108:111], v[104:107], v[176:191]
    ds_read_b64_tr_b16 v[130:131], v36 offset:2560
    s_waitcnt lgkmcnt(5)
    v_mfma_f32_32x32x16_bf16 v[192:207], v[112:115], v[100:103], v[192:207]
    ds_read_b128 v[124:127], v21 offset:4096
    v_mfma_f32_32x32x16_bf16 v[208:223], v[112:115], v[104:107], v[208:223]
    ds_read_b64_tr_b16 v[132:133], v36 offset:10240
    ds_read_b64_tr_b16 v[134:135], v36 offset:10752
    s_waitcnt lgkmcnt(6)
    v_mfma_f32_32x32x16_bf16 v[224:239], v[100:103], v[116:119], v[224:239]
    ds_read_b64_tr_b16 v[136:137], v36 offset:18432
    v_add_u32 v21, s50, v21
    v_mfma_f32_32x32x16_bf16 v[240:255], v[104:107], v[116:119], v[240:255]
    ds_read_b64_tr_b16 v[138:139], v36 offset:18944
    v_add_u32 v20, s50, v20
    s_waitcnt lgkmcnt(5)
    v_mfma_f32_32x32x16_bf16 v[160:175], v[128:131], v[120:123], v[160:175]
    ds_read_b128 v[100:103], v22
    ds_read_b64_tr_b16 v[108:109], v36 offset:4096
    s_waitcnt lgkmcnt(6)
    v_mfma_f32_32x32x16_bf16 v[176:191], v[128:131], v[124:127], v[176:191]
    ds_read_b64_tr_b16 v[110:111], v36 offset:4608
    s_waitcnt lgkmcnt(5)
    v_mfma_f32_32x32x16_bf16 v[192:207], v[132:135], v[120:123], v[192:207]
    ds_read_b128 v[104:107], v22 offset:4096
    v_mfma_f32_32x32x16_bf16 v[208:223], v[132:135], v[124:127], v[208:223]
    ds_read_b64_tr_b16 v[112:113], v36 offset:12288
    ds_read_b64_tr_b16 v[114:115], v36 offset:12800
    s_waitcnt lgkmcnt(6)
    v_mfma_f32_32x32x16_bf16 v[224:239], v[120:123], v[136:139], v[224:239]
    ds_read_b64_tr_b16 v[116:117], v36 offset:20480
    v_add_u32 v22, s50, v22
    v_mfma_f32_32x32x16_bf16 v[240:255], v[124:127], v[136:139], v[240:255]
    ds_read_b64_tr_b16 v[118:119], v36 offset:20992
    s_waitcnt lgkmcnt(5)
    v_mfma_f32_32x32x16_bf16 v[160:175], v[108:111], v[100:103], v[160:175]
    ds_read_b128 v[120:123], v23
    ds_read_b64_tr_b16 v[128:129], v36 offset:6144
    ds_read_b64_tr_b16 v[130:131], v36 offset:6656
    s_waitcnt lgkmcnt(7)
    v_mfma_f32_32x32x16_bf16 v[176:191], v[108:111], v[104:107], v[176:191]
    ds_read_b128 v[124:127], v23 offset:4096
    ds_read_b64_tr_b16 v[132:133], v36 offset:14336
    ds_read_b64_tr_b16 v[134:135], v36 offset:14848
    s_waitcnt lgkmcnt(8)
    v_mfma_f32_32x32x16_bf16 v[192:207], v[112:115], v[100:103], v[192:207]
    ds_read_b64_tr_b16 v[136:137], v36 offset:22528
    ds_read_b64_tr_b16 v[138:139], v36 offset:23040
    v_mfma_f32_32x32x16_bf16 v[208:223], v[112:115], v[104:107], v[208:223]
    s_waitcnt lgkmcnt(8)
    v_mfma_f32_32x32x16_bf16 v[224:239], v[100:103], v[116:119], v[224:239]
    v_add_u32 v23, s50, v23
    v_mfma_f32_32x32x16_bf16 v[240:255], v[104:107], v[116:119], v[240:255]
    v_add_u32 v36, s50, v36
    s_waitcnt lgkmcnt(0)
    v_mfma_f32_32x32x16_bf16 v[160:175], v[128:131], v[120:123], v[160:175]
    s_barrier
    ds_read_b128 v[100:103], v20
    ds_read_b64_tr_b16 v[108:109], v36 offset:0
    ds_read_b64_tr_b16 v[110:111], v36 offset:512
    v_mfma_f32_32x32x16_bf16 v[176:191], v[128:131], v[124:127], v[176:191]
    ds_read_b128 v[104:107], v20 offset:4096
    ds_read_b64_tr_b16 v[112:113], v36 offset:8192
    ds_read_b64_tr_b16 v[114:115], v36 offset:8704
    v_mfma_f32_32x32x16_bf16 v[192:207], v[132:135], v[120:123], v[192:207]
    ds_read_b64_tr_b16 v[116:117], v36 offset:16384
    ds_read_b64_tr_b16 v[118:119], v36 offset:16896
    v_mfma_f32_32x32x16_bf16 v[208:223], v[132:135], v[124:127], v[208:223]
    v_mfma_f32_32x32x16_bf16 v[224:239], v[120:123], v[136:139], v[224:239]
    s_add_u32 s48, s48, 1
    s_cmp_lt_u32 s48, 15
    v_mfma_f32_32x32x16_bf16 v[240:255], v[124:127], v[136:139], v[240:255]
    s_cbranch_scc1 L_c_loop
    s_waitcnt lgkmcnt(5)
    v_mfma_f32_32x32x16_bf16 v[160:175], v[108:111], v[100:103], v[160:175]
    ds_read_b128 v[120:123], v21
    ds_read_b64_tr_b16 v[128:129], v36 offset:2048
    s_waitcnt lgkmcnt(6)
    v_mfma_f32_32x32x16_bf16 v[176:191], v[108:111], v[104:107], v[176:191]
    ds_read_b64_tr_b16 v[130:131], v36 offset:2560
    s_waitcnt lgkmcnt(5)
    v_mfma_f32_32x32x16_bf16 v[192:207], v[112:115], v[100:103], v[192:207]
    ds_read_b128 v[124:127], v21 offset:4096
    v_mfma_f32_32x32x16_bf16 v[208:223], v[112:115], v[104:107], v[208:223]
    ds_read_b64_tr_b16 v[132:133], v36 offset:10240
    ds_read_b64_tr_b16 v[134:135], v36 offset:10752
    s_waitcnt lgkmcnt(6)
    v_mfma_f32_32x32x16_bf16 v[224:239], v[100:103], v[116:119], v[224:239]
    ds_read_b64_tr_b16 v[136:137], v36 offset:18432
    v_mfma_f32_32x32x16_bf16 v[240:255], v[104:107], v[116:119], v[240:255]
    ds_read_b64_tr_b16 v[138:139], v36 offset:18944
    s_waitcnt lgkmcnt(5)
    v_mfma_f32_32x32x16_bf16 v[160:175], v[128:131], v[120:123], v[160:175]
    ds_read_b128 v[100:103], v22
    ds_read_b64_tr_b16 v[108:109], v36 offset:4096
    s_waitcnt lgkmcnt(6)
    v_mfma_f32_32x32x16_bf16 v[176:191], v[128:131], v[124:127], v[176:191]
    ds_read_b64_tr_b16 v[110:111], v36 offset:4608
    s_waitcnt lgkmcnt(5)
    v_mfma_f32_32x32x16_bf16 v[192:207], v[132:135], v[120:123], v[192:207]
    ds_read_b128 v[104:107], v22 offset:4096
    v_mfma_f32_32x32x16_bf16 v[208:223], v[132:135], v[124:127], v[208:223]
    ds_read_b64_tr_b16 v[112:113], v36 offset:12288
    ds_read_b64_tr_b16 v[114:115], v36 offset:12800
    s_waitcnt lgkmcnt(6)
    v_mfma_f32_32x32x16_bf16 v[224:239], v[120:123], v[136:139], v[224:239]
    ds_read_b64_tr_b16 v[116:117], v36 offset:20480
    v_mfma_f32_32x32x16_bf16 v[240:255], v[124:127], v[136:139], v[240:255]
    ds_read_b64_tr_b16 v[118:119], v36 offset:20992
    s_waitcnt lgkmcnt(5)
    v_mfma_f32_32x32x16_bf16 v[160:175], v[108:111], v[100:103], v[160:175]
    ds_read_b128 v[120:123], v23
    ds_read_b64_tr_b16 v[128:129], v36 offset:6144
    ds_read_b64_tr_b16 v[130:131], v36 offset:6656
    s_waitcnt lgkmcnt(7)
    v_mfma_f32_32x32x16_bf16 v[176:191], v[108:111], v[104:107], v[176:191]
    ds_read_b128 v[124:127], v23 offset:4096
    ds_read_b64_tr_b16 v[132:133], v36 offset:14336
    ds_read_b64_tr_b16 v[134:135], v36 offset:14848
    s_waitcnt lgkmcnt(8)
    v_mfma_f32_32x32x16_bf16 v[192:207], v[112:115], v[100:103], v[192:207]
    ds_read_b64_tr_b16 v[136:137], v36 offset:22528
    ds_read_b64_tr_b16 v[138:139], v36 offset:23040
    v_mfma_f32_32x32x16_bf16 v[208:223], v[112:115], v[104:107], v[208:223]
    s_waitcnt lgkmcnt(8)
    v_mfma_f32_32x32x16_bf16 v[224:239], v[100:103], v[116:119], v[224:239]
    v_mfma_f32_32x32x16_bf16 v[240:255], v[104:107], v[116:119], v[240:255]
    s_waitcnt lgkmcnt(0)
    v_mfma_f32_32x32x16_bf16 v[160:175], v[128:131], v[120:123], v[160:175]
    s_mov_b64 exec, 1
    ds_write_b32 v17, v15
    s_mov_b64 exec, -1
    ds_read_b64_tr_b16 v[40:41], v12 offset:0
    ds_read_b64_tr_b16 v[42:43], v12 offset:512
    ds_read_b64_tr_b16 v[44:45], v12 offset:1024
    ds_read_b64_tr_b16 v[46:47], v12 offset:1536
    v_mov_b32 v16, 162864
    ds_read_b96 v[24:26], v16
    v_mfma_f32_32x32x16_bf16 v[176:191], v[128:131], v[124:127], v[176:191]
    v_mfma_f32_32x32x16_bf16 v[192:207], v[132:135], v[120:123], v[192:207]
    v_mfma_f32_32x32x16_bf16 v[208:223], v[132:135], v[124:127], v[208:223]
    v_mfma_f32_32x32x16_bf16 v[224:239], v[120:123], v[136:139], v[224:239]
    v_mfma_f32_32x32x16_bf16 v[240:255], v[124:127], v[136:139], v[240:255]
    s_mov_b32 s48, 0x3fb8aa3b
    s_mov_b32 s52, 0xbfb8aa3b
    s_nop 6
    v_cvt_pk_bf16_f32 v64, v192, v193
    v_cvt_pk_bf16_f32 v65, v194, v195
    v_cvt_pk_bf16_f32 v66, v196, v197
    v_cvt_pk_bf16_f32 v67, v198, v199
    v_cvt_pk_bf16_f32 v68, v200, v201
    v_cvt_pk_bf16_f32 v69, v202, v203
    v_cvt_pk_bf16_f32 v70, v204, v205
    v_cvt_pk_bf16_f32 v71, v206, v207
    s_waitcnt lgkmcnt(0)
    v_mfma_f32_32x32x16_bf16 v[192:207], v[40:43], v[64:67], 0
    v_mfma_f32_32x32x16_bf16 v[192:207], v[44:47], v[68:71], v[192:207]
    v_cvt_pk_bf16_f32 v72, v208, v209
    v_cvt_pk_bf16_f32 v73, v210, v211
    v_cvt_pk_bf16_f32 v74, v212, v213
    v_cvt_pk_bf16_f32 v75, v214, v215
    v_cvt_pk_bf16_f32 v76, v216, v217
    v_cvt_pk_bf16_f32 v77, v218, v219
    v_cvt_pk_bf16_f32 v78, v220, v221
    v_cvt_pk_bf16_f32 v79, v222, v223
    v_mfma_f32_32x32x16_bf16 v[208:223], v[40:43], v[72:75], 0
    s_nop 0
    v_mfma_f32_32x32x16_bf16 v[208:223], v[44:47], v[76:79], v[208:223]
    v_readfirstlane_b32 s72, v24
    v_readfirstlane_b32 s73, v25
    v_readfirstlane_b32 s74, v26
    v_and_b32 v27, 3, v2
    v_lshlrev_b32 v27, 3, v27
    v_bfe_u32 v27, v26, v27, 8
    v_mov_b32 v28, 0xffffff00
    s_and_b32 s76, s74, 0xff
    s_bfe_u32 s77, s74, 0x80008
    s_bfe_u32 s78, s74, 0x80010
    s_lshr_b32 s79, s74, 24
    v_cvt_pk_bf16_f32 v80, v224, v225
    v_cvt_pk_bf16_f32 v81, v226, v227
    v_cvt_pk_bf16_f32 v82, v228, v229
    v_cvt_pk_bf16_f32 v83, v230, v231
    v_cvt_pk_bf16_f32 v84, v232, v233
    v_cvt_pk_bf16_f32 v85, v234, v235
    v_cvt_pk_bf16_f32 v86, v236, v237
    v_cvt_pk_bf16_f32 v87, v238, v239
    v_cvt_pk_bf16_f32 v88, v240, v241
    v_cvt_pk_bf16_f32 v89, v242, v243
    v_cvt_pk_bf16_f32 v90, v244, v245
    v_cvt_pk_bf16_f32 v91, v246, v247
    v_cvt_pk_bf16_f32 v92, v248, v249
    v_cvt_pk_bf16_f32 v93, v250, v251
    v_cvt_pk_bf16_f32 v94, v252, v253
    v_cvt_pk_bf16_f32 v95, v254, v255
    v_cvt_pk_bf16_f32 v64, v192, v193
    v_cvt_pk_bf16_f32 v65, v194, v195
    v_cvt_pk_bf16_f32 v66, v196, v197
    v_cvt_pk_bf16_f32 v67, v198, v199
    v_cvt_pk_bf16_f32 v68, v200, v201
    v_cvt_pk_bf16_f32 v69, v202, v203
    v_cvt_pk_bf16_f32 v70, v204, v205
    v_cvt_pk_bf16_f32 v71, v206, v207
    v_lshlrev_b32 v192, 16, v64
    v_and_b32 v193, 0xffff0000, v64
    v_lshlrev_b32 v194, 16, v65
    v_and_b32 v195, 0xffff0000, v65
    v_lshlrev_b32 v196, 16, v66
    v_and_b32 v197, 0xffff0000, v66
    v_lshlrev_b32 v198, 16, v67
    v_and_b32 v199, 0xffff0000, v67
    v_lshlrev_b32 v200, 16, v68
    v_and_b32 v201, 0xffff0000, v68
    v_lshlrev_b32 v202, 16, v69
    v_and_b32 v203, 0xffff0000, v69
    v_lshlrev_b32 v204, 16, v70
    v_and_b32 v205, 0xffff0000, v70
    v_lshlrev_b32 v206, 16, v71
    v_and_b32 v207, 0xffff0000, v71
    v_cvt_pk_bf16_f32 v72, v208, v209
    v_cvt_pk_bf16_f32 v73, v210, v211
    v_cvt_pk_bf16_f32 v74, v212, v213
    v_cvt_pk_bf16_f32 v75, v214, v215
    v_cvt_pk_bf16_f32 v76, v216, v217
    v_cvt_pk_bf16_f32 v77, v218, v219
    v_cvt_pk_bf16_f32 v78, v220, v221
    v_cvt_pk_bf16_f32 v79, v222, v223
    v_lshlrev_b32 v208, 16, v72
    v_and_b32 v209, 0xffff0000, v72
    v_lshlrev_b32 v210, 16, v73
    v_and_b32 v211, 0xffff0000, v73
    v_lshlrev_b32 v212, 16, v74
    v_and_b32 v213, 0xffff0000, v74
    v_lshlrev_b32 v214, 16, v75
    v_and_b32 v215, 0xffff0000, v75
    v_lshlrev_b32 v216, 16, v76
    v_and_b32 v217, 0xffff0000, v76
    v_lshlrev_b32 v218, 16, v77
    v_and_b32 v219, 0xffff0000, v77
    v_lshlrev_b32 v220, 16, v78
    v_and_b32 v221, 0xffff0000, v78
    v_lshlrev_b32 v222, 16, v79
    v_and_b32 v223, 0xffff0000, v79
    v_max3_f32 v144, v192, v193, v194
    v_max3_f32 v145, v195, v196, v197
    v_max3_f32 v146, v198, v199, v200
    v_max3_f32 v147, v201, v202, v203
    v_max3_f32 v148, v204, v205, v206
    v_max3_f32 v144, v144, v145, v207
    v_max3_f32 v146, v146, v147, v148
    v_max_f32 v144, v144, v146
    v_min3_f32 v150, v192, v193, v194
    v_min3_f32 v151, v195, v196, v197
    v_min3_f32 v152, v198, v199, v200
    v_min3_f32 v153, v201, v202, v203
    v_min3_f32 v154, v204, v205, v206
    v_min3_f32 v150, v150, v151, v207
    v_min3_f32 v152, v152, v153, v154
    v_min_f32 v150, v150, v152
    v_mov_b32 v145, v144
    v_mov_b32 v151, v150
    s_nop 0
    v_permlane32_swap_b32 v144, v145
    v_permlane32_swap_b32 v150, v151
    v_max_f32 v144, v144, v145
    v_min_f32 v150, v150, v151
    v_mul_f32 v144, s52, v144
    v_mul_f32 v150, s48, v150
    v_pk_fma_f32 v[224:225], v[192:193], s[48:49], v[144:145] op_sel_hi:[1,0,0]
    v_pk_fma_f32 v[112:113], v[192:193], s[52:53], v[150:151] op_sel_hi:[1,0,0]
    v_pk_fma_f32 v[226:227], v[194:195], s[48:49], v[144:145] op_sel_hi:[1,0,0]
    v_pk_fma_f32 v[114:115], v[194:195], s[52:53], v[150:151] op_sel_hi:[1,0,0]
    v_pk_fma_f32 v[228:229], v[196:197], s[48:49], v[144:145] op_sel_hi:[1,0,0]
    v_pk_fma_f32 v[116:117], v[196:197], s[52:53], v[150:151] op_sel_hi:[1,0,0]
    v_pk_fma_f32 v[230:231], v[198:199], s[48:49], v[144:145] op_sel_hi:[1,0,0]
    v_pk_fma_f32 v[118:119], v[198:199], s[52:53], v[150:151] op_sel_hi:[1,0,0]
    v_pk_fma_f32 v[232:233], v[200:201], s[48:49], v[144:145] op_sel_hi:[1,0,0]
    v_pk_fma_f32 v[120:121], v[200:201], s[52:53], v[150:151] op_sel_hi:[1,0,0]
    v_pk_fma_f32 v[234:235], v[202:203], s[48:49], v[144:145] op_sel_hi:[1,0,0]
    v_pk_fma_f32 v[122:123], v[202:203], s[52:53], v[150:151] op_sel_hi:[1,0,0]
    v_pk_fma_f32 v[236:237], v[204:205], s[48:49], v[144:145] op_sel_hi:[1,0,0]
    v_pk_fma_f32 v[124:125], v[204:205], s[52:53], v[150:151] op_sel_hi:[1,0,0]
    v_pk_fma_f32 v[238:239], v[206:207], s[48:49], v[144:145] op_sel_hi:[1,0,0]
    v_pk_fma_f32 v[126:127], v[206:207], s[52:53], v[150:151] op_sel_hi:[1,0,0]
    v_exp_f32 v224, v224
    v_exp_f32 v112, v112
    v_exp_f32 v225, v225
    v_exp_f32 v113, v113
    v_exp_f32 v226, v226
    v_exp_f32 v114, v114
    v_exp_f32 v227, v227
    v_exp_f32 v115, v115
    v_exp_f32 v228, v228
    v_exp_f32 v116, v116
    v_exp_f32 v229, v229
    v_exp_f32 v117, v117
    v_exp_f32 v230, v230
    v_exp_f32 v118, v118
    v_exp_f32 v231, v231
    v_exp_f32 v119, v119
    v_exp_f32 v232, v232
    v_exp_f32 v120, v120
    v_exp_f32 v233, v233
    v_exp_f32 v121, v121
    v_exp_f32 v234, v234
    v_exp_f32 v122, v122
    v_exp_f32 v235, v235
    v_exp_f32 v123, v123
    v_exp_f32 v236, v236
    v_exp_f32 v124, v124
    v_exp_f32 v237, v237
    v_exp_f32 v125, v125
    v_exp_f32 v238, v238
    v_exp_f32 v126, v126
    v_exp_f32 v239, v239
    v_exp_f32 v127, v127
    v_pk_add_f32 v[144:145], v[224:225], v[226:227]
    v_pk_add_f32 v[146:147], v[228:229], v[230:231]
    v_pk_add_f32 v[148:149], v[232:233], v[234:235]
    v_pk_add_f32 v[150:151], v[112:113], v[114:115]
    v_pk_add_f32 v[152:153], v[116:117], v[118:119]
    v_pk_add_f32 v[154:155], v[120:121], v[122:123]
    v_pk_add_f32 v[144:145], v[144:145], v[236:237]
    v_pk_add_f32 v[146:147], v[146:147], v[238:239]
    v_pk_add_f32 v[150:151], v[150:151], v[124:125]
    v_pk_add_f32 v[152:153], v[152:153], v[126:127]
    v_pk_add_f32 v[144:145], v[144:145], v[148:149]
    v_pk_add_f32 v[150:151], v[150:151], v[154:155]
    v_pk_add_f32 v[144:145], v[144:145], v[146:147]
    v_pk_add_f32 v[150:151], v[150:151], v[152:153]
    v_add_f32 v144, v144, v145
    v_add_f32 v150, v150, v151
    v_mov_b32 v145, v144
    v_mov_b32 v151, v150
    s_nop 0
    v_permlane32_swap_b32 v144, v145
    v_permlane32_swap_b32 v150, v151
    v_add_f32 v144, v144, v145
    v_add_f32 v150, v150, v151
    v_rcp_f32 v144, v144
    v_rcp_f32 v150, v150
    v_pk_mul_f32 v[224:225], v[224:225], v[144:145] op_sel_hi:[1,0]
    v_pk_mul_f32 v[112:113], v[112:113], v[150:151] op_sel_hi:[1,0]
    v_pk_mul_f32 v[226:227], v[226:227], v[144:145] op_sel_hi:[1,0]
    v_pk_mul_f32 v[114:115], v[114:115], v[150:151] op_sel_hi:[1,0]
    v_pk_mul_f32 v[228:229], v[228:229], v[144:145] op_sel_hi:[1,0]
    v_pk_mul_f32 v[116:117], v[116:117], v[150:151] op_sel_hi:[1,0]
    v_pk_mul_f32 v[230:231], v[230:231], v[144:145] op_sel_hi:[1,0]
    v_pk_mul_f32 v[118:119], v[118:119], v[150:151] op_sel_hi:[1,0]
    v_pk_mul_f32 v[232:233], v[232:233], v[144:145] op_sel_hi:[1,0]
    v_pk_mul_f32 v[120:121], v[120:121], v[150:151] op_sel_hi:[1,0]
    v_pk_mul_f32 v[234:235], v[234:235], v[144:145] op_sel_hi:[1,0]
    v_pk_mul_f32 v[122:123], v[122:123], v[150:151] op_sel_hi:[1,0]
    v_pk_mul_f32 v[236:237], v[236:237], v[144:145] op_sel_hi:[1,0]
    v_pk_mul_f32 v[124:125], v[124:125], v[150:151] op_sel_hi:[1,0]
    v_pk_mul_f32 v[238:239], v[238:239], v[144:145] op_sel_hi:[1,0]
    v_pk_mul_f32 v[126:127], v[126:127], v[150:151] op_sel_hi:[1,0]
    v_cvt_pk_bf16_f32 v64, v224, v225
    v_cvt_pk_bf16_f32 v96, v112, v113
    v_cvt_pk_bf16_f32 v65, v226, v227
    v_cvt_pk_bf16_f32 v97, v114, v115
    v_cvt_pk_bf16_f32 v66, v228, v229
    v_cvt_pk_bf16_f32 v98, v116, v117
    v_cvt_pk_bf16_f32 v67, v230, v231
    v_cvt_pk_bf16_f32 v99, v118, v119
    v_cvt_pk_bf16_f32 v68, v232, v233
    v_cvt_pk_bf16_f32 v100, v120, v121
    v_cvt_pk_bf16_f32 v69, v234, v235
    v_cvt_pk_bf16_f32 v101, v122, v123
    v_cvt_pk_bf16_f32 v70, v236, v237
    v_cvt_pk_bf16_f32 v102, v124, v125
    v_cvt_pk_bf16_f32 v71, v238, v239
    v_cvt_pk_bf16_f32 v103, v126, v127
    v_mfma_f32_32x32x16_bf16 v[192:207], v[64:67], v[48:51], 0
    v_mfma_f32_32x32x16_bf16 v[192:207], v[68:71], v[52:55], v[192:207]
    v_mfma_f32_32x32x16_bf16 v[224:239], v[96:99], v[48:51], 0
    v_mfma_f32_32x32x16_bf16 v[224:239], v[100:103], v[52:55], v[224:239]
    v_max3_f32 v144, v208, v209, v210
    v_max3_f32 v145, v211, v212, v213
    v_max3_f32 v146, v214, v215, v216
    v_max3_f32 v147, v217, v218, v219
    v_max3_f32 v148, v220, v221, v222
    v_max3_f32 v144, v144, v145, v223
    v_max3_f32 v146, v146, v147, v148
    v_max_f32 v144, v144, v146
    v_min3_f32 v150, v208, v209, v210
    v_min3_f32 v151, v211, v212, v213
    v_min3_f32 v152, v214, v215, v216
    v_min3_f32 v153, v217, v218, v219
    v_min3_f32 v154, v220, v221, v222
    v_min3_f32 v150, v150, v151, v223
    v_min3_f32 v152, v152, v153, v154
    v_min_f32 v150, v150, v152
    v_mov_b32 v145, v144
    v_mov_b32 v151, v150
    s_nop 0
    v_permlane32_swap_b32 v144, v145
    v_permlane32_swap_b32 v150, v151
    v_max_f32 v144, v144, v145
    v_min_f32 v150, v150, v151
    v_mul_f32 v144, s52, v144
    v_mul_f32 v150, s48, v150
    v_pk_fma_f32 v[240:241], v[208:209], s[48:49], v[144:145] op_sel_hi:[1,0,0]
    v_pk_fma_f32 v[128:129], v[208:209], s[52:53], v[150:151] op_sel_hi:[1,0,0]
    v_pk_fma_f32 v[242:243], v[210:211], s[48:49], v[144:145] op_sel_hi:[1,0,0]
    v_pk_fma_f32 v[130:131], v[210:211], s[52:53], v[150:151] op_sel_hi:[1,0,0]
    v_pk_fma_f32 v[244:245], v[212:213], s[48:49], v[144:145] op_sel_hi:[1,0,0]
    v_pk_fma_f32 v[132:133], v[212:213], s[52:53], v[150:151] op_sel_hi:[1,0,0]
    v_pk_fma_f32 v[246:247], v[214:215], s[48:49], v[144:145] op_sel_hi:[1,0,0]
    v_pk_fma_f32 v[134:135], v[214:215], s[52:53], v[150:151] op_sel_hi:[1,0,0]
    v_pk_fma_f32 v[248:249], v[216:217], s[48:49], v[144:145] op_sel_hi:[1,0,0]
    v_pk_fma_f32 v[136:137], v[216:217], s[52:53], v[150:151] op_sel_hi:[1,0,0]
    v_pk_fma_f32 v[250:251], v[218:219], s[48:49], v[144:145] op_sel_hi:[1,0,0]
    v_pk_fma_f32 v[138:139], v[218:219], s[52:53], v[150:151] op_sel_hi:[1,0,0]
    v_pk_fma_f32 v[252:253], v[220:221], s[48:49], v[144:145] op_sel_hi:[1,0,0]
    v_pk_fma_f32 v[140:141], v[220:221], s[52:53], v[150:151] op_sel_hi:[1,0,0]
    v_pk_fma_f32 v[254:255], v[222:223], s[48:49], v[144:145] op_sel_hi:[1,0,0]
    v_pk_fma_f32 v[142:143], v[222:223], s[52:53], v[150:151] op_sel_hi:[1,0,0]
    v_exp_f32 v240, v240
    v_exp_f32 v128, v128
    v_exp_f32 v241, v241
    v_exp_f32 v129, v129
    v_exp_f32 v242, v242
    v_exp_f32 v130, v130
    v_exp_f32 v243, v243
    v_exp_f32 v131, v131
    v_exp_f32 v244, v244
    v_exp_f32 v132, v132
    v_exp_f32 v245, v245
    v_exp_f32 v133, v133
    v_exp_f32 v246, v246
    v_exp_f32 v134, v134
    v_exp_f32 v247, v247
    v_exp_f32 v135, v135
    v_exp_f32 v248, v248
    v_exp_f32 v136, v136
    v_exp_f32 v249, v249
    v_exp_f32 v137, v137
    v_exp_f32 v250, v250
    v_exp_f32 v138, v138
    v_exp_f32 v251, v251
    v_exp_f32 v139, v139
    v_exp_f32 v252, v252
    v_exp_f32 v140, v140
    v_exp_f32 v253, v253
    v_exp_f32 v141, v141
    v_exp_f32 v254, v254
    v_exp_f32 v142, v142
    v_exp_f32 v255, v255
    v_exp_f32 v143, v143
    v_pk_add_f32 v[144:145], v[240:241], v[242:243]
    v_pk_add_f32 v[146:147], v[244:245], v[246:247]
    v_pk_add_f32 v[148:149], v[248:249], v[250:251]
    v_pk_add_f32 v[150:151], v[128:129], v[130:131]
    v_pk_add_f32 v[152:153], v[132:133], v[134:135]
    v_pk_add_f32 v[154:155], v[136:137], v[138:139]
    v_pk_add_f32 v[144:145], v[144:145], v[252:253]
    v_pk_add_f32 v[146:147], v[146:147], v[254:255]
    v_pk_add_f32 v[150:151], v[150:151], v[140:141]
    v_pk_add_f32 v[152:153], v[152:153], v[142:143]
    v_pk_add_f32 v[144:145], v[144:145], v[148:149]
    v_pk_add_f32 v[150:151], v[150:151], v[154:155]
    v_pk_add_f32 v[144:145], v[144:145], v[146:147]
    v_pk_add_f32 v[150:151], v[150:151], v[152:153]
    v_add_f32 v144, v144, v145
    v_add_f32 v150, v150, v151
    v_mov_b32 v145, v144
    v_mov_b32 v151, v150
    s_nop 0
    v_permlane32_swap_b32 v144, v145
    v_permlane32_swap_b32 v150, v151
    v_add_f32 v144, v144, v145
    v_add_f32 v150, v150, v151
    v_rcp_f32 v144, v144
    v_rcp_f32 v150, v150
    v_pk_mul_f32 v[240:241], v[240:241], v[144:145] op_sel_hi:[1,0]
    v_pk_mul_f32 v[128:129], v[128:129], v[150:151] op_sel_hi:[1,0]
    v_pk_mul_f32 v[242:243], v[242:243], v[144:145] op_sel_hi:[1,0]
    v_pk_mul_f32 v[130:131], v[130:131], v[150:151] op_sel_hi:[1,0]
    v_pk_mul_f32 v[244:245], v[244:245], v[144:145] op_sel_hi:[1,0]
    v_pk_mul_f32 v[132:133], v[132:133], v[150:151] op_sel_hi:[1,0]
    v_pk_mul_f32 v[246:247], v[246:247], v[144:145] op_sel_hi:[1,0]
    v_pk_mul_f32 v[134:135], v[134:135], v[150:151] op_sel_hi:[1,0]
    v_pk_mul_f32 v[248:249], v[248:249], v[144:145] op_sel_hi:[1,0]
    v_pk_mul_f32 v[136:137], v[136:137], v[150:151] op_sel_hi:[1,0]
    v_pk_mul_f32 v[250:251], v[250:251], v[144:145] op_sel_hi:[1,0]
    v_pk_mul_f32 v[138:139], v[138:139], v[150:151] op_sel_hi:[1,0]
    v_pk_mul_f32 v[252:253], v[252:253], v[144:145] op_sel_hi:[1,0]
    v_pk_mul_f32 v[140:141], v[140:141], v[150:151] op_sel_hi:[1,0]
    v_pk_mul_f32 v[254:255], v[254:255], v[144:145] op_sel_hi:[1,0]
    v_pk_mul_f32 v[142:143], v[142:143], v[150:151] op_sel_hi:[1,0]
    v_cvt_pk_bf16_f32 v72, v240, v241
    v_cvt_pk_bf16_f32 v104, v128, v129
    v_cvt_pk_bf16_f32 v73, v242, v243
    v_cvt_pk_bf16_f32 v105, v130, v131
    v_cvt_pk_bf16_f32 v74, v244, v245
    v_cvt_pk_bf16_f32 v106, v132, v133
    v_cvt_pk_bf16_f32 v75, v246, v247
    v_cvt_pk_bf16_f32 v107, v134, v135
    v_cvt_pk_bf16_f32 v76, v248, v249
    v_cvt_pk_bf16_f32 v108, v136, v137
    v_cvt_pk_bf16_f32 v77, v250, v251
    v_cvt_pk_bf16_f32 v109, v138, v139
    v_cvt_pk_bf16_f32 v78, v252, v253
    v_cvt_pk_bf16_f32 v110, v140, v141
    v_cvt_pk_bf16_f32 v79, v254, v255
    v_cvt_pk_bf16_f32 v111, v142, v143
    v_mfma_f32_32x32x16_bf16 v[208:223], v[72:75], v[48:51], 0
    v_mfma_f32_32x32x16_bf16 v[208:223], v[76:79], v[52:55], v[208:223]
    v_mfma_f32_32x32x16_bf16 v[240:255], v[104:107], v[48:51], 0
    v_mfma_f32_32x32x16_bf16 v[240:255], v[108:111], v[52:55], v[240:255]
    v_cvt_pk_bf16_f32 v64, v192, v193
    v_cvt_pk_bf16_f32 v65, v194, v195
    v_cvt_pk_bf16_f32 v66, v196, v197
    v_cvt_pk_bf16_f32 v67, v198, v199
    v_cvt_pk_bf16_f32 v68, v200, v201
    v_cvt_pk_bf16_f32 v69, v202, v203
    v_cvt_pk_bf16_f32 v70, v204, v205
    v_cvt_pk_bf16_f32 v71, v206, v207
    v_cvt_pk_bf16_f32 v96, v224, v225
    v_cvt_pk_bf16_f32 v97, v226, v227
    v_cvt_pk_bf16_f32 v98, v228, v229
    v_cvt_pk_bf16_f32 v99, v230, v231
    v_cvt_pk_bf16_f32 v100, v232, v233
    v_cvt_pk_bf16_f32 v101, v234, v235
    v_cvt_pk_bf16_f32 v102, v236, v237
    v_cvt_pk_bf16_f32 v103, v238, v239
    v_mfma_f32_32x32x16_bf16 v[112:127], v[64:67], v[80:83], 0
    v_mfma_f32_32x32x16_bf16 v[112:127], v[68:71], v[84:87], v[112:127]
    v_mfma_f32_32x32x16_bf16 v[128:143], v[96:99], v[80:83], 0
    v_mfma_f32_32x32x16_bf16 v[128:143], v[100:103], v[84:87], v[128:143]
    v_mfma_f32_32x32x16_bf16 v[144:159], v[64:67], v[56:59], 0
    v_mfma_f32_32x32x16_bf16 v[144:159], v[68:71], v[56:59], v[144:159]
    v_mfma_f32_32x32x16_bf16 v[144:159], v[96:99], v[60:63], v[144:159]
    v_mfma_f32_32x32x16_bf16 v[144:159], v[100:103], v[60:63], v[144:159]
    v_cvt_pk_bf16_f32 v72, v208, v209
    v_cvt_pk_bf16_f32 v73, v210, v211
    v_cvt_pk_bf16_f32 v74, v212, v213
    v_cvt_pk_bf16_f32 v75, v214, v215
    v_cvt_pk_bf16_f32 v76, v216, v217
    v_cvt_pk_bf16_f32 v77, v218, v219
    v_cvt_pk_bf16_f32 v78, v220, v221
    v_cvt_pk_bf16_f32 v79, v222, v223
    v_cvt_pk_bf16_f32 v104, v240, v241
    v_cvt_pk_bf16_f32 v105, v242, v243
    v_cvt_pk_bf16_f32 v106, v244, v245
    v_cvt_pk_bf16_f32 v107, v246, v247
    v_cvt_pk_bf16_f32 v108, v248, v249
    v_cvt_pk_bf16_f32 v109, v250, v251
    v_cvt_pk_bf16_f32 v110, v252, v253
    v_cvt_pk_bf16_f32 v111, v254, v255
    v_mfma_f32_32x32x16_bf16 v[112:127], v[72:75], v[88:91], v[112:127]
    v_mfma_f32_32x32x16_bf16 v[112:127], v[76:79], v[92:95], v[112:127]
    v_mfma_f32_32x32x16_bf16 v[128:143], v[104:107], v[88:91], v[128:143]
    v_mfma_f32_32x32x16_bf16 v[128:143], v[108:111], v[92:95], v[128:143]
    v_mfma_f32_32x32x16_bf16 v[144:159], v[72:75], v[56:59], v[144:159]
    v_mfma_f32_32x32x16_bf16 v[144:159], v[76:79], v[56:59], v[144:159]
    v_mfma_f32_32x32x16_bf16 v[144:159], v[104:107], v[60:63], v[144:159]
    v_mfma_f32_32x32x16_bf16 v[144:159], v[108:111], v[60:63], v[144:159]
    s_cmp_eq_u32 s21, 0
    s_cbranch_scc0 L_c_rw1
    s_nop 5
    ds_write_b128 v8, v[128:131] offset:0
    ds_write_b128 v8, v[132:135] offset:1024
    ds_write_b128 v8, v[136:139] offset:2048
    ds_write_b128 v8, v[140:143] offset:3072
    s_mov_b32 exec_lo, s45
    s_mov_b32 exec_hi, s45
    ds_write_b128 v10, v[144:147] offset:4096
    ds_write_b128 v10, v[148:151] offset:4128
    ds_write_b128 v10, v[152:155] offset:4160
    ds_write_b128 v10, v[156:159] offset:4192
    ds_write_b32 v13, v15
    s_mov_b64 exec, -1
    s_mov_b32 s13, 0
L_c_x0:
    ds_read_b32 v16, v14
    ds_read_b128 v[192:195], v9 offset:0
    ds_read_b128 v[196:199], v9 offset:1024
    ds_read_b128 v[200:203], v9 offset:2048
    ds_read_b128 v[204:207], v9 offset:3072
    ds_read_b32 v208, v11 offset:4096
    ds_read_b32 v209, v11 offset:4224
    s_add_u32 s13, s13, 1
    s_cmp_ge_u32 s13, 262144
    s_cbranch_scc1 L_c_y0
    s_waitcnt lgkmcnt(6)
    v_cmp_eq_u32 vcc, 1, v16
    s_cbranch_vccz L_c_x0
L_c_y0:
    s_waitcnt lgkmcnt(2)
    v_pk_add_f32 v[112:113], v[112:113], v[192:193]
    v_pk_add_f32 v[114:115], v[114:115], v[194:195]
    v_pk_add_f32 v[116:117], v[116:117], v[196:197]
    v_pk_add_f32 v[118:119], v[118:119], v[198:199]
    v_pk_add_f32 v[120:121], v[120:121], v[200:201]
    v_pk_add_f32 v[122:123], v[122:123], v[202:203]
    v_pk_add_f32 v[124:125], v[124:125], v[204:205]
    v_pk_add_f32 v[126:127], v[126:127], v[206:207]
    v_and_or_b32 v112, v112, v28, v27
    buffer_store_dwordx4 v[112:115], v6, s[32:35], s40 offen offset:0 sc1
    v_and_or_b32 v116, v116, v28, v27
    buffer_store_dwordx4 v[116:119], v6, s[32:35], s40 offen offset:512 sc1
    v_and_or_b32 v120, v120, v28, v27
    buffer_store_dwordx4 v[120:123], v6, s[32:35], s41 offen offset:0 sc1
    v_and_or_b32 v124, v124, v28, v27
    buffer_store_dwordx4 v[124:127], v6, s[32:35], s41 offen offset:512 sc1
    s_branch L_c_zs
L_c_rw1:
    s_nop 7
    ds_write_b128 v8, v[112:115] offset:0
    ds_write_b128 v8, v[116:119] offset:1024
    ds_write_b128 v8, v[120:123] offset:2048
    ds_write_b128 v8, v[124:127] offset:3072
    s_mov_b32 exec_lo, s45
    s_mov_b32 exec_hi, s45
    ds_write_b128 v10, v[144:147] offset:4096
    ds_write_b128 v10, v[148:151] offset:4128
    ds_write_b128 v10, v[152:155] offset:4160
    ds_write_b128 v10, v[156:159] offset:4192
    ds_write_b32 v13, v15
    s_mov_b64 exec, -1
    s_mov_b32 s13, 0
L_c_x1:
    ds_read_b32 v16, v14
    ds_read_b128 v[192:195], v9 offset:0
    ds_read_b128 v[196:199], v9 offset:1024
    ds_read_b128 v[200:203], v9 offset:2048
    ds_read_b128 v[204:207], v9 offset:3072
    ds_read_b32 v208, v11 offset:4096
    ds_read_b32 v209, v11 offset:4224
    s_add_u32 s13, s13, 1
    s_cmp_ge_u32 s13, 262144
    s_cbranch_scc1 L_c_y1
    s_waitcnt lgkmcnt(6)
    v_cmp_eq_u32 vcc, 1, v16
    s_cbranch_vccz L_c_x1
L_c_y1:
    s_waitcnt lgkmcnt(2)
    v_pk_add_f32 v[128:129], v[128:129], v[192:193]
    v_pk_add_f32 v[130:131], v[130:131], v[194:195]
    v_pk_add_f32 v[132:133], v[132:133], v[196:197]
    v_pk_add_f32 v[134:135], v[134:135], v[198:199]
    v_pk_add_f32 v[136:137], v[136:137], v[200:201]
    v_pk_add_f32 v[138:139], v[138:139], v[202:203]
    v_pk_add_f32 v[140:141], v[140:141], v[204:205]
    v_pk_add_f32 v[142:143], v[142:143], v[206:207]
    v_and_or_b32 v128, v128, v28, v27
    buffer_store_dwordx4 v[128:131], v6, s[32:35], s40 offen offset:0 sc1
    v_and_or_b32 v132, v132, v28, v27
    buffer_store_dwordx4 v[132:135], v6, s[32:35], s40 offen offset:512 sc1
    v_and_or_b32 v136, v136, v28, v27
    buffer_store_dwordx4 v[136:139], v6, s[32:35], s41 offen offset:0 sc1
    v_and_or_b32 v140, v140, v28, v27
    buffer_store_dwordx4 v[140:143], v6, s[32:35], s41 offen offset:512 sc1
L_c_zs:
    s_waitcnt lgkmcnt(0)
    v_add_f32 v208, v208, v209
    v_and_or_b32 v208, v208, v28, v27
    s_mov_b32 exec_hi, 0
    buffer_store_dword v208, v7, s[32:35], s42 offen sc1
    s_mov_b32 exec_lo, 1
    ds_write_b32 v13, v15 offset:96
    s_mov_b64 exec, -1
    v_cvt_pk_bf16_f32 v64, v160, v161
    v_cvt_pk_bf16_f32 v65, v162, v163
    v_cvt_pk_bf16_f32 v66, v164, v165
    v_cvt_pk_bf16_f32 v67, v166, v167
    v_cvt_pk_bf16_f32 v68, v168, v169
    v_cvt_pk_bf16_f32 v69, v170, v171
    v_cvt_pk_bf16_f32 v70, v172, v173
    v_cvt_pk_bf16_f32 v71, v174, v175
    v_mfma_f32_32x32x16_bf16 v[160:175], v[40:43], v[64:67], 0
    s_nop 0
    v_mfma_f32_32x32x16_bf16 v[160:175], v[44:47], v[68:71], v[160:175]
    v_cvt_pk_bf16_f32 v72, v176, v177
    v_cvt_pk_bf16_f32 v73, v178, v179
    v_cvt_pk_bf16_f32 v74, v180, v181
    v_cvt_pk_bf16_f32 v75, v182, v183
    v_cvt_pk_bf16_f32 v76, v184, v185
    v_cvt_pk_bf16_f32 v77, v186, v187
    v_cvt_pk_bf16_f32 v78, v188, v189
    v_cvt_pk_bf16_f32 v79, v190, v191
    v_mfma_f32_32x32x16_bf16 v[176:191], v[40:43], v[72:75], 0
    s_nop 0
    v_mfma_f32_32x32x16_bf16 v[176:191], v[44:47], v[76:79], v[176:191]
    s_nop 0
    v_cvt_pk_bf16_f32 v64, v160, v161
    v_cvt_pk_bf16_f32 v65, v162, v163
    v_cvt_pk_bf16_f32 v66, v164, v165
    v_cvt_pk_bf16_f32 v67, v166, v167
    v_cvt_pk_bf16_f32 v68, v168, v169
    v_cvt_pk_bf16_f32 v69, v170, v171
    v_cvt_pk_bf16_f32 v70, v172, v173
    v_cvt_pk_bf16_f32 v71, v174, v175
    v_lshlrev_b32 v160, 16, v64
    v_and_b32 v161, 0xffff0000, v64
    v_lshlrev_b32 v162, 16, v65
    v_and_b32 v163, 0xffff0000, v65
    v_lshlrev_b32 v164, 16, v66
    v_and_b32 v165, 0xffff0000, v66
    v_lshlrev_b32 v166, 16, v67
    v_and_b32 v167, 0xffff0000, v67
    v_lshlrev_b32 v168, 16, v68
    v_and_b32 v169, 0xffff0000, v68
    v_lshlrev_b32 v170, 16, v69
    v_and_b32 v171, 0xffff0000, v69
    v_lshlrev_b32 v172, 16, v70
    v_and_b32 v173, 0xffff0000, v70
    v_lshlrev_b32 v174, 16, v71
    v_and_b32 v175, 0xffff0000, v71
    v_cvt_pk_bf16_f32 v72, v176, v177
    v_cvt_pk_bf16_f32 v73, v178, v179
    v_cvt_pk_bf16_f32 v74, v180, v181
    v_cvt_pk_bf16_f32 v75, v182, v183
    v_cvt_pk_bf16_f32 v76, v184, v185
    v_cvt_pk_bf16_f32 v77, v186, v187
    v_cvt_pk_bf16_f32 v78, v188, v189
    v_cvt_pk_bf16_f32 v79, v190, v191
    v_lshlrev_b32 v176, 16, v72
    v_and_b32 v177, 0xffff0000, v72
    v_lshlrev_b32 v178, 16, v73
    v_and_b32 v179, 0xffff0000, v73
    v_lshlrev_b32 v180, 16, v74
    v_and_b32 v181, 0xffff0000, v74
    v_lshlrev_b32 v182, 16, v75
    v_and_b32 v183, 0xffff0000, v75
    v_lshlrev_b32 v184, 16, v76
    v_and_b32 v185, 0xffff0000, v76
    v_lshlrev_b32 v186, 16, v77
    v_and_b32 v187, 0xffff0000, v77
    v_lshlrev_b32 v188, 16, v78
    v_and_b32 v189, 0xffff0000, v78
    v_lshlrev_b32 v190, 16, v79
    v_and_b32 v191, 0xffff0000, v79
    v_max3_f32 v24, v160, v161, v162
    v_max3_f32 v25, v163, v164, v165
    v_max3_f32 v26, v166, v167, v168
    v_max3_f32 v27, v169, v170, v171
    v_max3_f32 v28, v172, v173, v174
    v_max3_f32 v24, v24, v25, v175
    v_max3_f32 v26, v26, v27, v28
    v_max_f32 v24, v24, v26
    v_min3_f32 v30, v160, v161, v162
    v_min3_f32 v31, v163, v164, v165
    v_min3_f32 v32, v166, v167, v168
    v_min3_f32 v33, v169, v170, v171
    v_min3_f32 v34, v172, v173, v174
    v_min3_f32 v30, v30, v31, v175
    v_min3_f32 v32, v32, v33, v34
    v_min_f32 v30, v30, v32
    v_mov_b32 v25, v24
    v_mov_b32 v31, v30
    s_nop 0
    v_permlane32_swap_b32 v24, v25
    v_permlane32_swap_b32 v30, v31
    v_max_f32 v24, v24, v25
    v_min_f32 v30, v30, v31
    v_mul_f32 v24, s52, v24
    v_mul_f32 v30, s48, v30
    v_pk_fma_f32 v[192:193], v[160:161], s[48:49], v[24:25] op_sel_hi:[1,0,0]
    v_pk_fma_f32 v[224:225], v[160:161], s[52:53], v[30:31] op_sel_hi:[1,0,0]
    v_pk_fma_f32 v[194:195], v[162:163], s[48:49], v[24:25] op_sel_hi:[1,0,0]
    v_pk_fma_f32 v[226:227], v[162:163], s[52:53], v[30:31] op_sel_hi:[1,0,0]
    v_pk_fma_f32 v[196:197], v[164:165], s[48:49], v[24:25] op_sel_hi:[1,0,0]
    v_pk_fma_f32 v[228:229], v[164:165], s[52:53], v[30:31] op_sel_hi:[1,0,0]
    v_pk_fma_f32 v[198:199], v[166:167], s[48:49], v[24:25] op_sel_hi:[1,0,0]
    v_pk_fma_f32 v[230:231], v[166:167], s[52:53], v[30:31] op_sel_hi:[1,0,0]
    v_pk_fma_f32 v[200:201], v[168:169], s[48:49], v[24:25] op_sel_hi:[1,0,0]
    v_pk_fma_f32 v[232:233], v[168:169], s[52:53], v[30:31] op_sel_hi:[1,0,0]
    v_pk_fma_f32 v[202:203], v[170:171], s[48:49], v[24:25] op_sel_hi:[1,0,0]
    v_pk_fma_f32 v[234:235], v[170:171], s[52:53], v[30:31] op_sel_hi:[1,0,0]
    v_pk_fma_f32 v[204:205], v[172:173], s[48:49], v[24:25] op_sel_hi:[1,0,0]
    v_pk_fma_f32 v[236:237], v[172:173], s[52:53], v[30:31] op_sel_hi:[1,0,0]
    v_pk_fma_f32 v[206:207], v[174:175], s[48:49], v[24:25] op_sel_hi:[1,0,0]
    v_pk_fma_f32 v[238:239], v[174:175], s[52:53], v[30:31] op_sel_hi:[1,0,0]
    v_exp_f32 v192, v192
    v_exp_f32 v224, v224
    v_exp_f32 v193, v193
    v_exp_f32 v225, v225
    v_exp_f32 v194, v194
    v_exp_f32 v226, v226
    v_exp_f32 v195, v195
    v_exp_f32 v227, v227
    v_exp_f32 v196, v196
    v_exp_f32 v228, v228
    v_exp_f32 v197, v197
    v_exp_f32 v229, v229
    v_exp_f32 v198, v198
    v_exp_f32 v230, v230
    v_exp_f32 v199, v199
    v_exp_f32 v231, v231
    v_exp_f32 v200, v200
    v_exp_f32 v232, v232
    v_exp_f32 v201, v201
    v_exp_f32 v233, v233
    v_exp_f32 v202, v202
    v_exp_f32 v234, v234
    v_exp_f32 v203, v203
    v_exp_f32 v235, v235
    v_exp_f32 v204, v204
    v_exp_f32 v236, v236
    v_exp_f32 v205, v205
    v_exp_f32 v237, v237
    v_exp_f32 v206, v206
    v_exp_f32 v238, v238
    v_exp_f32 v207, v207
    v_exp_f32 v239, v239
    v_pk_add_f32 v[24:25], v[192:193], v[194:195]
    v_pk_add_f32 v[26:27], v[196:197], v[198:199]
    v_pk_add_f32 v[28:29], v[200:201], v[202:203]
    v_pk_add_f32 v[30:31], v[224:225], v[226:227]
    v_pk_add_f32 v[32:33], v[228:229], v[230:231]
    v_pk_add_f32 v[34:35], v[232:233], v[234:235]
    v_pk_add_f32 v[24:25], v[24:25], v[204:205]
    v_pk_add_f32 v[26:27], v[26:27], v[206:207]
    v_pk_add_f32 v[30:31], v[30:31], v[236:237]
    v_pk_add_f32 v[32:33], v[32:33], v[238:239]
    v_pk_add_f32 v[24:25], v[24:25], v[28:29]
    v_pk_add_f32 v[30:31], v[30:31], v[34:35]
    v_pk_add_f32 v[24:25], v[24:25], v[26:27]
    v_pk_add_f32 v[30:31], v[30:31], v[32:33]
    v_add_f32 v24, v24, v25
    v_add_f32 v30, v30, v31
    v_mov_b32 v25, v24
    v_mov_b32 v31, v30
    s_nop 0
    v_permlane32_swap_b32 v24, v25
    v_permlane32_swap_b32 v30, v31
    v_add_f32 v24, v24, v25
    v_add_f32 v30, v30, v31
    v_rcp_f32 v24, v24
    v_rcp_f32 v30, v30
    v_pk_mul_f32 v[192:193], v[192:193], v[24:25] op_sel_hi:[1,0]
    v_pk_mul_f32 v[224:225], v[224:225], v[30:31] op_sel_hi:[1,0]
    v_pk_mul_f32 v[194:195], v[194:195], v[24:25] op_sel_hi:[1,0]
    v_pk_mul_f32 v[226:227], v[226:227], v[30:31] op_sel_hi:[1,0]
    v_pk_mul_f32 v[196:197], v[196:197], v[24:25] op_sel_hi:[1,0]
    v_pk_mul_f32 v[228:229], v[228:229], v[30:31] op_sel_hi:[1,0]
    v_pk_mul_f32 v[198:199], v[198:199], v[24:25] op_sel_hi:[1,0]
    v_pk_mul_f32 v[230:231], v[230:231], v[30:31] op_sel_hi:[1,0]
    v_pk_mul_f32 v[200:201], v[200:201], v[24:25] op_sel_hi:[1,0]
    v_pk_mul_f32 v[232:233], v[232:233], v[30:31] op_sel_hi:[1,0]
    v_pk_mul_f32 v[202:203], v[202:203], v[24:25] op_sel_hi:[1,0]
    v_pk_mul_f32 v[234:235], v[234:235], v[30:31] op_sel_hi:[1,0]
    v_pk_mul_f32 v[204:205], v[204:205], v[24:25] op_sel_hi:[1,0]
    v_pk_mul_f32 v[236:237], v[236:237], v[30:31] op_sel_hi:[1,0]
    v_pk_mul_f32 v[206:207], v[206:207], v[24:25] op_sel_hi:[1,0]
    v_pk_mul_f32 v[238:239], v[238:239], v[30:31] op_sel_hi:[1,0]
    v_cvt_pk_bf16_f32 v80, v192, v193
    v_cvt_pk_bf16_f32 v88, v224, v225
    v_cvt_pk_bf16_f32 v81, v194, v195
    v_cvt_pk_bf16_f32 v89, v226, v227
    v_cvt_pk_bf16_f32 v82, v196, v197
    v_cvt_pk_bf16_f32 v90, v228, v229
    v_cvt_pk_bf16_f32 v83, v198, v199
    v_cvt_pk_bf16_f32 v91, v230, v231
    v_cvt_pk_bf16_f32 v84, v200, v201
    v_cvt_pk_bf16_f32 v92, v232, v233
    v_cvt_pk_bf16_f32 v85, v202, v203
    v_cvt_pk_bf16_f32 v93, v234, v235
    v_cvt_pk_bf16_f32 v86, v204, v205
    v_cvt_pk_bf16_f32 v94, v236, v237
    v_cvt_pk_bf16_f32 v87, v206, v207
    v_cvt_pk_bf16_f32 v95, v238, v239
    v_max3_f32 v24, v176, v177, v178
    v_max3_f32 v25, v179, v180, v181
    v_max3_f32 v26, v182, v183, v184
    v_max3_f32 v27, v185, v186, v187
    v_max3_f32 v28, v188, v189, v190
    v_max3_f32 v24, v24, v25, v191
    v_max3_f32 v26, v26, v27, v28
    v_max_f32 v24, v24, v26
    v_min3_f32 v30, v176, v177, v178
    v_min3_f32 v31, v179, v180, v181
    v_min3_f32 v32, v182, v183, v184
    v_min3_f32 v33, v185, v186, v187
    v_min3_f32 v34, v188, v189, v190
    v_min3_f32 v30, v30, v31, v191
    v_min3_f32 v32, v32, v33, v34
    v_min_f32 v30, v30, v32
    v_mov_b32 v25, v24
    v_mov_b32 v31, v30
    s_nop 0
    v_permlane32_swap_b32 v24, v25
    v_permlane32_swap_b32 v30, v31
    v_max_f32 v24, v24, v25
    v_min_f32 v30, v30, v31
    v_mul_f32 v24, s52, v24
    v_mul_f32 v30, s48, v30
    v_pk_fma_f32 v[208:209], v[176:177], s[48:49], v[24:25] op_sel_hi:[1,0,0]
    v_pk_fma_f32 v[240:241], v[176:177], s[52:53], v[30:31] op_sel_hi:[1,0,0]
    v_pk_fma_f32 v[210:211], v[178:179], s[48:49], v[24:25] op_sel_hi:[1,0,0]
    v_pk_fma_f32 v[242:243], v[178:179], s[52:53], v[30:31] op_sel_hi:[1,0,0]
    v_pk_fma_f32 v[212:213], v[180:181], s[48:49], v[24:25] op_sel_hi:[1,0,0]
    v_pk_fma_f32 v[244:245], v[180:181], s[52:53], v[30:31] op_sel_hi:[1,0,0]
    v_pk_fma_f32 v[214:215], v[182:183], s[48:49], v[24:25] op_sel_hi:[1,0,0]
    v_pk_fma_f32 v[246:247], v[182:183], s[52:53], v[30:31] op_sel_hi:[1,0,0]
    v_pk_fma_f32 v[216:217], v[184:185], s[48:49], v[24:25] op_sel_hi:[1,0,0]
    v_pk_fma_f32 v[248:249], v[184:185], s[52:53], v[30:31] op_sel_hi:[1,0,0]
    v_pk_fma_f32 v[218:219], v[186:187], s[48:49], v[24:25] op_sel_hi:[1,0,0]
    v_pk_fma_f32 v[250:251], v[186:187], s[52:53], v[30:31] op_sel_hi:[1,0,0]
    v_pk_fma_f32 v[220:221], v[188:189], s[48:49], v[24:25] op_sel_hi:[1,0,0]
    v_pk_fma_f32 v[252:253], v[188:189], s[52:53], v[30:31] op_sel_hi:[1,0,0]
    v_pk_fma_f32 v[222:223], v[190:191], s[48:49], v[24:25] op_sel_hi:[1,0,0]
    v_pk_fma_f32 v[254:255], v[190:191], s[52:53], v[30:31] op_sel_hi:[1,0,0]
    v_exp_f32 v208, v208
    v_exp_f32 v240, v240
    v_exp_f32 v209, v209
    v_exp_f32 v241, v241
    v_exp_f32 v210, v210
    v_exp_f32 v242, v242
    v_exp_f32 v211, v211
    v_exp_f32 v243, v243
    v_exp_f32 v212, v212
    v_exp_f32 v244, v244
    v_exp_f32 v213, v213
    v_exp_f32 v245, v245
    v_exp_f32 v214, v214
    v_exp_f32 v246, v246
    v_exp_f32 v215, v215
    v_exp_f32 v247, v247
    v_exp_f32 v216, v216
    v_exp_f32 v248, v248
    v_exp_f32 v217, v217
    v_exp_f32 v249, v249
    v_exp_f32 v218, v218
    v_exp_f32 v250, v250
    v_exp_f32 v219, v219
    v_exp_f32 v251, v251
    v_exp_f32 v220, v220
    v_exp_f32 v252, v252
    v_exp_f32 v221, v221
    v_exp_f32 v253, v253
    v_exp_f32 v222, v222
    v_exp_f32 v254, v254
    v_exp_f32 v223, v223
    v_exp_f32 v255, v255
    v_pk_add_f32 v[24:25], v[208:209], v[210:211]
    v_pk_add_f32 v[26:27], v[212:213], v[214:215]
    v_pk_add_f32 v[28:29], v[216:217], v[218:219]
    v_pk_add_f32 v[30:31], v[240:241], v[242:243]
    v_pk_add_f32 v[32:33], v[244:245], v[246:247]
    v_pk_add_f32 v[34:35], v[248:249], v[250:251]
    v_pk_add_f32 v[24:25], v[24:25], v[220:221]
    v_pk_add_f32 v[26:27], v[26:27], v[222:223]
    v_pk_add_f32 v[30:31], v[30:31], v[252:253]
    v_pk_add_f32 v[32:33], v[32:33], v[254:255]
    v_pk_add_f32 v[24:25], v[24:25], v[28:29]
    v_pk_add_f32 v[30:31], v[30:31], v[34:35]
    v_pk_add_f32 v[24:25], v[24:25], v[26:27]
    v_pk_add_f32 v[30:31], v[30:31], v[32:33]
    v_add_f32 v24, v24, v25
    v_add_f32 v30, v30, v31
    v_mov_b32 v25, v24
    v_mov_b32 v31, v30
    s_nop 0
    v_permlane32_swap_b32 v24, v25
    v_permlane32_swap_b32 v30, v31
    v_add_f32 v24, v24, v25
    v_add_f32 v30, v30, v31
    v_rcp_f32 v24, v24
    v_rcp_f32 v30, v30
    v_pk_mul_f32 v[208:209], v[208:209], v[24:25] op_sel_hi:[1,0]
    v_pk_mul_f32 v[240:241], v[240:241], v[30:31] op_sel_hi:[1,0]
    v_pk_mul_f32 v[210:211], v[210:211], v[24:25] op_sel_hi:[1,0]
    v_pk_mul_f32 v[242:243], v[242:243], v[30:31] op_sel_hi:[1,0]
    v_pk_mul_f32 v[212:213], v[212:213], v[24:25] op_sel_hi:[1,0]
    v_pk_mul_f32 v[244:245], v[244:245], v[30:31] op_sel_hi:[1,0]
    v_pk_mul_f32 v[214:215], v[214:215], v[24:25] op_sel_hi:[1,0]
    v_pk_mul_f32 v[246:247], v[246:247], v[30:31] op_sel_hi:[1,0]
    v_pk_mul_f32 v[216:217], v[216:217], v[24:25] op_sel_hi:[1,0]
    v_pk_mul_f32 v[248:249], v[248:249], v[30:31] op_sel_hi:[1,0]
    v_pk_mul_f32 v[218:219], v[218:219], v[24:25] op_sel_hi:[1,0]
    v_pk_mul_f32 v[250:251], v[250:251], v[30:31] op_sel_hi:[1,0]
    v_pk_mul_f32 v[220:221], v[220:221], v[24:25] op_sel_hi:[1,0]
    v_pk_mul_f32 v[252:253], v[252:253], v[30:31] op_sel_hi:[1,0]
    v_pk_mul_f32 v[222:223], v[222:223], v[24:25] op_sel_hi:[1,0]
    v_pk_mul_f32 v[254:255], v[254:255], v[30:31] op_sel_hi:[1,0]
    v_cvt_pk_bf16_f32 v96, v208, v209
    v_cvt_pk_bf16_f32 v104, v240, v241
    v_cvt_pk_bf16_f32 v97, v210, v211
    v_cvt_pk_bf16_f32 v105, v242, v243
    v_cvt_pk_bf16_f32 v98, v212, v213
    v_cvt_pk_bf16_f32 v106, v244, v245
    v_cvt_pk_bf16_f32 v99, v214, v215
    v_cvt_pk_bf16_f32 v107, v246, v247
    v_cvt_pk_bf16_f32 v100, v216, v217
    v_cvt_pk_bf16_f32 v108, v248, v249
    v_cvt_pk_bf16_f32 v101, v218, v219
    v_cvt_pk_bf16_f32 v109, v250, v251
    v_cvt_pk_bf16_f32 v102, v220, v221
    v_cvt_pk_bf16_f32 v110, v252, v253
    v_cvt_pk_bf16_f32 v103, v222, v223
    v_cvt_pk_bf16_f32 v111, v254, v255
    s_lshl_b32 s12, s19, 1
    s_add_u32 s23, s12, s22
    s_lshl_b32 s12, s23, 12
    s_add_u32 s43, s12, 32768
    s_lshl_b32 s14, s23, 10
    s_add_u32 s46, s14, 163840
    v_lshlrev_b32 v52, 7, v3
    v_lshrrev_b32 v53, 2, v4
    v_lshlrev_b32 v53, 7, v53
    s_lshl_b32 s40, s18, 1
    s_add_u32 s40, s40, s21
    s_lshl_b32 s41, s40, 6
    s_add_u32 s41, s41, s23
    s_lshl_b32 s41, s41, 11
    s_add_u32 s41, s41, 8388608
    s_add_u32 s42, s41, 65536
    s_lshl_b32 s12, s18, 10
    s_lshl_b32 s40, s21, 5
    s_add_u32 s40, s40, s12
    s_add_u32 s40, s40, s23
    s_lshl_b32 s40, s40, 2
    s_add_u32 s40, s40, 524288
    s_sub_u32 s21, s72, 1
    s_mov_b32 s22, s73
    s_mov_b32 s23, s74
    s_lshl_b32 s40, s18, 1
    s_lshr_b32 s12, s20, 1
    s_add_u32 s40, s40, s12
    s_lshl_b32 s40, s40, 5
    s_lshl_b32 s12, s19, 1
    s_add_u32 s40, s40, s12
    s_and_b32 s12, s20, 1
    s_add_u32 s40, s40, s12
    s_lshl_b32 s40, s40, 7
    s_add_u32 s40, s40, 6291456
    s_and_b32 s88, s16, 1
    s_lshl_b32 s88, s88, 3
    s_lshr_b32 s89, s16, 1
    s_lshl_b32 s89, s89, 1
    s_add_u32 s88, s88, s89
    s_lshr_b32 s89, s17, 4
    s_add_u32 s88, s88, s89
    s_and_b32 s89, s17, 15
    s_mov_b32 s68, s58
    s_and_b32 s69, s59, 0xffff
    s_mov_b32 s70, 4194304
    s_mov_b32 s71, 0x00020000
    s_and_b32 s90, s20, 3
    s_lshr_b32 s91, s20, 2
    s_lshl_b32 s12, s88, 3
    s_lshl_b32 s13, s90, 1
    s_add_u32 s12, s12, s13
    s_add_u32 s92, s12, s91
    s_lshl_b32 s12, s92, 4
    v_and_b32 v3, 15, v2
    v_add_u32 v6, s12, v3
    v_lshlrev_b32 v8, 2, v6
    v_bfe_u32 v9, v2, 4, 1
    v_lshrrev_b32 v10, 5, v2
    v_lshlrev_b32 v7, 11, v6
    v_lshl_add_u32 v7, v9, 6, v7
    v_lshl_add_u32 v7, v10, 4, v7
    s_lshl_b32 s12, s89, 7
    v_add_u32 v7, s12, v7
    s_mov_b32 s12, 4096
    buffer_load_dwordx4 v[24:27], v7, s[24:27], 0 offen
    buffer_load_dwordx4 v[28:31], v7, s[24:27], 0 offen offset:32
    buffer_load_dword v48, v8, s[32:35], s12 offen sc1
    v_lshlrev_b32 v22, 8, v3
    v_lshl_add_u32 v22, v9, 7, v22
    v_lshl_add_u32 v22, v10, 5, v22
    v_lshlrev_b32 v10, 9, v10
    v_bfe_u32 v11, v2, 2, 2
    v_lshl_add_u32 v10, v11, 7, v10
    v_bfe_u32 v11, v2, 3, 1
    v_lshl_add_u32 v10, v11, 6, v10
    v_lshl_add_u32 v10, v9, 5, v10
    v_and_b32 v11, 3, v2
    v_lshl_add_u32 v10, v11, 3, v10
    v_xor_b32 v11, 64, v10
    s_lshl_b32 s12, s91, 8
    v_xor_b32 v17, s12, v5
    v_lshlrev_b32 v8, 2, v3
    s_lshl_b32 s12, s20, 12
    s_mov_b32 s15, 40960
    s_cmp_lt_u32 s20, 6
    s_cselect_b32 s13, s15, 131072
    s_add_u32 s12, s12, s13
    v_add_u32 v20, s12, v5
    s_xor_b32 s14, s20, 4
    s_lshl_b32 s12, s14, 12
    s_cmp_lt_u32 s14, 6
    s_cselect_b32 s13, s15, 131072
    s_add_u32 s12, s12, s13
    v_add_u32 v21, s12, v5
    s_lshl_b32 s12, s88, 2
    s_add_u32 s12, s12, s90
    s_lshl_b32 s13, s12, 16
    s_lshl_b32 s14, s91, 15
    s_add_u32 s13, s13, s14
    s_add_u32 s95, s13, 8388608
    s_lshl_b32 s12, s88, 12
    s_lshl_b32 s13, s89, 8
    s_mul_i32 s13, s13, 1
    s_add_u32 s12, s12, s13
    s_lshr_b32 s13, s90, 1
    s_lshl_b32 s13, s13, 7
    s_add_u32 s12, s12, s13
    s_lshl_b32 s13, s91, 6
    s_add_u32 s12, s12, s13
    s_add_u32 s15, s12, 524288
    s_lshl_b32 s97, s91, 4
    v_lshlrev_b32 v8, 7, v3
    s_lshl_b32 s12, s88, 1
    s_lshr_b32 s13, s90, 1
    s_add_u32 s12, s12, s13
    s_lshl_b32 s12, s12, 12
    s_lshl_b32 s13, s91, 11
    s_add_u32 s12, s12, s13
    s_and_b32 s13, s89, 0
    s_lshl_b32 s13, s13, 17
    s_add_u32 s12, s12, s13
    s_add_u32 s15, s12, 6291456
    s_mov_b32 s93, s89
    s_waitcnt vmcnt(0)
    v_sub_f32 v50, 1.0, v48
    v_cvt_pk_bf16_f32 v50, v50, v50
    v_lshlrev_b32 v50, 16, v50
    v_lshlrev_b32 v32, 16, v24
    v_and_b32 v33, 0xffff0000, v24
    v_lshlrev_b32 v34, 16, v25
    v_and_b32 v35, 0xffff0000, v25
    v_lshlrev_b32 v36, 16, v26
    v_and_b32 v37, 0xffff0000, v26
    v_lshlrev_b32 v38, 16, v27
    v_and_b32 v39, 0xffff0000, v27
    v_lshlrev_b32 v40, 16, v28
    v_and_b32 v41, 0xffff0000, v28
    v_lshlrev_b32 v42, 16, v29
    v_and_b32 v43, 0xffff0000, v29
    v_lshlrev_b32 v44, 16, v30
    v_and_b32 v45, 0xffff0000, v30
    v_lshlrev_b32 v46, 16, v31
    v_and_b32 v47, 0xffff0000, v31
    v_pk_mul_f32 v[32:33], v[32:33], v[50:51] op_sel_hi:[1,0]
    v_pk_mul_f32 v[34:35], v[34:35], v[50:51] op_sel_hi:[1,0]
    v_pk_mul_f32 v[36:37], v[36:37], v[50:51] op_sel_hi:[1,0]
    v_pk_mul_f32 v[38:39], v[38:39], v[50:51] op_sel_hi:[1,0]
    v_pk_mul_f32 v[40:41], v[40:41], v[50:51] op_sel_hi:[1,0]
    v_pk_mul_f32 v[42:43], v[42:43], v[50:51] op_sel_hi:[1,0]
    v_pk_mul_f32 v[44:45], v[44:45], v[50:51] op_sel_hi:[1,0]
    v_pk_mul_f32 v[46:47], v[46:47], v[50:51] op_sel_hi:[1,0]
    v_cvt_pk_bf16_f32 v33, v32, v33
    v_cvt_pk_bf16_f32 v35, v34, v35
    v_cvt_pk_bf16_f32 v37, v36, v37
    v_cvt_pk_bf16_f32 v39, v38, v39
    v_cvt_pk_bf16_f32 v41, v40, v41
    v_cvt_pk_bf16_f32 v43, v42, v43
    v_cvt_pk_bf16_f32 v45, v44, v45
    v_cvt_pk_bf16_f32 v47, v46, v47
    v_lshlrev_b32 v32, 16, v33
    v_and_b32 v33, 0xffff0000, v33
    v_lshlrev_b32 v34, 16, v35
    v_and_b32 v35, 0xffff0000, v35
    v_lshlrev_b32 v36, 16, v37
    v_and_b32 v37, 0xffff0000, v37
    v_lshlrev_b32 v38, 16, v39
    v_and_b32 v39, 0xffff0000, v39
    v_lshlrev_b32 v40, 16, v41
    v_and_b32 v41, 0xffff0000, v41
    v_lshlrev_b32 v42, 16, v43
    v_and_b32 v43, 0xffff0000, v43
    v_lshlrev_b32 v44, 16, v45
    v_and_b32 v45, 0xffff0000, v45
    v_lshlrev_b32 v46, 16, v47
    v_and_b32 v47, 0xffff0000, v47
    s_mov_b32 s13, 0
    v_mov_b32 v54, 162896
L_c_kz:
    ds_read_b32 v55, v54
    s_add_u32 s13, s13, 1
    s_cmp_ge_u32 s13, 262144
    s_cbranch_scc1 L_c_kzok
    s_waitcnt lgkmcnt(0)
    v_cmp_eq_u32 vcc, 1, v55
    s_cbranch_vccz L_c_kz
L_c_kzok:
    s_mov_b32 s13, 0
L_c_kv:
    buffer_load_dwordx4 v[112:115], v5, s[32:35], s43 offen offset:0 sc1
    buffer_load_dwordx4 v[116:119], v5, s[32:35], s43 offen offset:1024 sc1
    buffer_load_dwordx4 v[120:123], v5, s[32:35], s43 offen offset:2048 sc1
    buffer_load_dwordx4 v[124:127], v5, s[32:35], s43 offen offset:3072 sc1
    buffer_load_dwordx4 v[128:131], v52, s[32:35], s46 offen offset:0 sc1
    buffer_load_dwordx4 v[132:135], v52, s[32:35], s46 offen offset:256 sc1
    buffer_load_dwordx4 v[136:139], v52, s[32:35], s46 offen offset:512 sc1
    buffer_load_dwordx4 v[140:143], v52, s[32:35], s46 offen offset:768 sc1
    s_add_u32 s13, s13, 1
    s_waitcnt vmcnt(0)
    v_max3_u32 v55, v112, v113, v114
    v_max3_u32 v55, v55, v115, v116
    v_max3_u32 v55, v55, v117, v118
    v_max3_u32 v55, v55, v119, v120
    v_max3_u32 v55, v55, v121, v122
    v_max3_u32 v55, v55, v123, v124
    v_max3_u32 v55, v55, v125, v126
    v_max3_u32 v55, v55, v127, v128
    v_max3_u32 v55, v55, v129, v130
    v_max3_u32 v55, v55, v131, v132
    v_max3_u32 v55, v55, v133, v134
    v_max3_u32 v55, v55, v135, v136
    v_max3_u32 v55, v55, v137, v138
    v_max3_u32 v55, v55, v139, v140
    v_max3_u32 v55, v55, v141, v142
    v_max_u32 v55, v55, v143
    v_cmp_eq_u32 vcc, -1, v55
    s_cbranch_vccz L_c_kvok
    s_cmp_lt_u32 s13, 16384
    s_cbranch_scc1 L_c_kv
L_c_kvok:
    v_mfma_f32_32x32x16_bf16 v[192:207], v[128:131], v[80:83], 0
    v_mfma_f32_32x32x16_bf16 v[160:175], v[112:115], v[80:83], 0
    v_mfma_f32_32x32x16_bf16 v[192:207], v[132:135], v[84:87], v[192:207]
    v_mfma_f32_32x32x16_bf16 v[160:175], v[116:119], v[84:87], v[160:175]
    v_mfma_f32_32x32x16_bf16 v[192:207], v[136:139], v[88:91], v[192:207]
    v_mfma_f32_32x32x16_bf16 v[160:175], v[120:123], v[88:91], v[160:175]
    v_mfma_f32_32x32x16_bf16 v[192:207], v[140:143], v[92:95], v[192:207]
    v_mfma_f32_32x32x16_bf16 v[160:175], v[124:127], v[92:95], v[160:175]
    v_mfma_f32_32x32x16_bf16 v[208:223], v[128:131], v[96:99], 0
    v_mfma_f32_32x32x16_bf16 v[176:191], v[112:115], v[96:99], 0
    v_mfma_f32_32x32x16_bf16 v[208:223], v[132:135], v[100:103], v[208:223]
    v_mfma_f32_32x32x16_bf16 v[176:191], v[116:119], v[100:103], v[176:191]
    v_mfma_f32_32x32x16_bf16 v[208:223], v[136:139], v[104:107], v[208:223]
    v_mfma_f32_32x32x16_bf16 v[176:191], v[120:123], v[104:107], v[176:191]
    v_mfma_f32_32x32x16_bf16 v[208:223], v[140:143], v[108:111], v[208:223]
    v_mfma_f32_32x32x16_bf16 v[176:191], v[124:127], v[108:111], v[176:191]
    s_nop 2
    v_cvt_pk_bf16_f32 v56, v192, v192
    v_lshlrev_b32 v56, 16, v56
    v_add_f32 v56, 0x358637bd, v56
    v_cvt_pk_bf16_f32 v56, v56, v56
    v_lshlrev_b32 v56, 16, v56
    v_rcp_f32 v56, v56
    v_cvt_pk_bf16_f32 v64, v160, v161
    v_cvt_pk_bf16_f32 v65, v162, v163
    v_cvt_pk_bf16_f32 v66, v164, v165
    v_cvt_pk_bf16_f32 v67, v166, v167
    v_cvt_pk_bf16_f32 v68, v168, v169
    v_cvt_pk_bf16_f32 v69, v170, v171
    v_cvt_pk_bf16_f32 v70, v172, v173
    v_cvt_pk_bf16_f32 v71, v174, v175
    v_lshlrev_b32 v160, 16, v64
    v_and_b32 v161, 0xffff0000, v64
    v_lshlrev_b32 v162, 16, v65
    v_and_b32 v163, 0xffff0000, v65
    v_lshlrev_b32 v164, 16, v66
    v_and_b32 v165, 0xffff0000, v66
    v_lshlrev_b32 v166, 16, v67
    v_and_b32 v167, 0xffff0000, v67
    v_lshlrev_b32 v168, 16, v68
    v_and_b32 v169, 0xffff0000, v68
    v_lshlrev_b32 v170, 16, v69
    v_and_b32 v171, 0xffff0000, v69
    v_lshlrev_b32 v172, 16, v70
    v_and_b32 v173, 0xffff0000, v70
    v_lshlrev_b32 v174, 16, v71
    v_and_b32 v175, 0xffff0000, v71
    v_pk_mul_f32 v[160:161], v[160:161], v[56:57] op_sel_hi:[1,0]
    v_pk_mul_f32 v[162:163], v[162:163], v[56:57] op_sel_hi:[1,0]
    v_pk_mul_f32 v[164:165], v[164:165], v[56:57] op_sel_hi:[1,0]
    v_pk_mul_f32 v[166:167], v[166:167], v[56:57] op_sel_hi:[1,0]
    v_pk_mul_f32 v[168:169], v[168:169], v[56:57] op_sel_hi:[1,0]
    v_pk_mul_f32 v[170:171], v[170:171], v[56:57] op_sel_hi:[1,0]
    v_pk_mul_f32 v[172:173], v[172:173], v[56:57] op_sel_hi:[1,0]
    v_pk_mul_f32 v[174:175], v[174:175], v[56:57] op_sel_hi:[1,0]
    v_cvt_pk_bf16_f32 v64, v160, v161
    v_cvt_pk_bf16_f32 v65, v162, v163
    v_cvt_pk_bf16_f32 v66, v164, v165
    v_cvt_pk_bf16_f32 v67, v166, v167
    v_cvt_pk_bf16_f32 v68, v168, v169
    v_cvt_pk_bf16_f32 v69, v170, v171
    v_cvt_pk_bf16_f32 v70, v172, v173
    v_cvt_pk_bf16_f32 v71, v174, v175
    buffer_store_dwordx4 v[64:67], v5, s[32:35], s41 offen sc1
    buffer_store_dwordx4 v[68:71], v5, s[32:35], s41 offen offset:1024 sc1
    v_cvt_pk_bf16_f32 v58, v208, v208
    v_lshlrev_b32 v58, 16, v58
    v_add_f32 v58, 0x358637bd, v58
    v_cvt_pk_bf16_f32 v58, v58, v58
    v_lshlrev_b32 v58, 16, v58
    v_rcp_f32 v58, v58
    v_cvt_pk_bf16_f32 v72, v176, v177
    v_cvt_pk_bf16_f32 v73, v178, v179
    v_cvt_pk_bf16_f32 v74, v180, v181
    v_cvt_pk_bf16_f32 v75, v182, v183
    v_cvt_pk_bf16_f32 v76, v184, v185
    v_cvt_pk_bf16_f32 v77, v186, v187
    v_cvt_pk_bf16_f32 v78, v188, v189
    v_cvt_pk_bf16_f32 v79, v190, v191
    v_lshlrev_b32 v176, 16, v72
    v_and_b32 v177, 0xffff0000, v72
    v_lshlrev_b32 v178, 16, v73
    v_and_b32 v179, 0xffff0000, v73
    v_lshlrev_b32 v180, 16, v74
    v_and_b32 v181, 0xffff0000, v74
    v_lshlrev_b32 v182, 16, v75
    v_and_b32 v183, 0xffff0000, v75
    v_lshlrev_b32 v184, 16, v76
    v_and_b32 v185, 0xffff0000, v76
    v_lshlrev_b32 v186, 16, v77
    v_and_b32 v187, 0xffff0000, v77
    v_lshlrev_b32 v188, 16, v78
    v_and_b32 v189, 0xffff0000, v78
    v_lshlrev_b32 v190, 16, v79
    v_and_b32 v191, 0xffff0000, v79
    v_pk_mul_f32 v[176:177], v[176:177], v[58:59] op_sel_hi:[1,0]
    v_pk_mul_f32 v[178:179], v[178:179], v[58:59] op_sel_hi:[1,0]
    v_pk_mul_f32 v[180:181], v[180:181], v[58:59] op_sel_hi:[1,0]
    v_pk_mul_f32 v[182:183], v[182:183], v[58:59] op_sel_hi:[1,0]
    v_pk_mul_f32 v[184:185], v[184:185], v[58:59] op_sel_hi:[1,0]
    v_pk_mul_f32 v[186:187], v[186:187], v[58:59] op_sel_hi:[1,0]
    v_pk_mul_f32 v[188:189], v[188:189], v[58:59] op_sel_hi:[1,0]
    v_pk_mul_f32 v[190:191], v[190:191], v[58:59] op_sel_hi:[1,0]
    v_cvt_pk_bf16_f32 v72, v176, v177
    v_cvt_pk_bf16_f32 v73, v178, v179
    v_cvt_pk_bf16_f32 v74, v180, v181
    v_cvt_pk_bf16_f32 v75, v182, v183
    v_cvt_pk_bf16_f32 v76, v184, v185
    v_cvt_pk_bf16_f32 v77, v186, v187
    v_cvt_pk_bf16_f32 v78, v188, v189
    v_cvt_pk_bf16_f32 v79, v190, v191
    buffer_store_dwordx4 v[72:75], v5, s[32:35], s42 offen sc1
    buffer_store_dwordx4 v[76:79], v5, s[32:35], s42 offen offset:1024 sc1
    v_mov_b32 v56, s23
    v_mov_b32 v57, s23
    v_mov_b32 v58, s23
    v_mov_b32 v59, s23
    v_lshrrev_b32 v60, 3, v2
    v_lshlrev_b32 v60, 17, v60
    v_and_b32 v61, 0x70, v5
    v_add_u32 v60, v60, v61
    s_mov_b32 s45, 0
    s_lshr_b32 s12, s21, 4
    s_cmp_eq_u32 s12, s92
    s_cselect_b32 s46, 1, 0
    s_cbranch_scc0 L_b_noownc
    s_lshl_b32 s12, s89, 12
    s_add_u32 s12, s12, 458752
    buffer_load_dwordx4 v[224:227], v22, s[32:35], s12 offen offset:0 sc1
    buffer_load_dwordx4 v[228:231], v22, s[32:35], s12 offen offset:16 sc1
    buffer_load_dwordx4 v[232:235], v22, s[32:35], s12 offen offset:64 sc1
    buffer_load_dwordx4 v[236:239], v22, s[32:35], s12 offen offset:80 sc1
L_b_noownc:
    s_waitcnt vmcnt(0)
    s_mov_b32 exec_lo, 0xff
    s_mov_b32 exec_hi, 0
    buffer_store_dwordx4 v[56:59], v60, s[32:35], s40 offen sc1
    s_mov_b64 exec, -1
L_phaseb:
    s_setprio 0
    s_nop 4
    s_cmp_lg_u32 s46, 0
    s_cbranch_scc1 L_own
L_own_r0:
    s_nop 0
    s_barrier
    s_mov_b32 s14, 0xffff0000
    s_mov_b32 s47, 0
    s_mov_b32 s96, 0
    s_cmp_lg_u32 s96, 0
    s_cbranch_scc1 L_pk0
L_pl0:
    buffer_load_dword v52, v8, s[32:35], s15 offen sc1
    s_add_u32 s47, s47, 1
    s_cmp_ge_u32 s47, 16384
    s_cselect_b32 s12, -1, 0
    s_waitcnt vmcnt(0)
    v_cmp_eq_u32 vcc, s23, v52
    s_nop 1
    s_or_b32 s12, s12, vcc_lo
    s_lshr_b32 s12, s12, s93
    s_or_b32 s96, s96, s12
    s_andn2_b32 s96, s96, s14
    s_cbranch_scc0 L_pl0
L_pk0:
    s_ff1_i32_b32 s12, s96
    s_bitset0_b32 s96, s12
    s_bitset1_b32 s14, s12
    s_add_u32 s12, s12, s93
    s_and_b32 s80, s12, 15
    s_lshl_b32 s94, s80, 11
    s_add_u32 s94, s94, s95
    buffer_load_dwordx4 v[96:99], v17, s[32:35], s94 offen
    buffer_load_dwordx4 v[100:103], v17, s[32:35], s94 offen offset:1024
    s_add_u32 s12, s80, s97
    s_lshl_b32 s13, s12, 12
    s_cmp_ge_u32 s12, 10
    s_cselect_b32 s12, 24576, 0
    s_add_u32 s13, s13, s12
    v_add_u32 v12, s13, v10
    v_add_u32 v13, s13, v11
    ds_read_b64_tr_b16 v[120:121], v12 offset:0
    ds_read_b64_tr_b16 v[122:123], v12 offset:1024
    ds_read_b64_tr_b16 v[124:125], v13 offset:0
    ds_read_b64_tr_b16 v[126:127], v13 offset:1024
    ds_read_b64_tr_b16 v[128:129], v12 offset:2048
    ds_read_b64_tr_b16 v[130:131], v12 offset:3072
    ds_read_b64_tr_b16 v[132:133], v13 offset:2048
    ds_read_b64_tr_b16 v[134:135], v13 offset:3072
    s_cmp_lg_u32 s96, 0
    s_cbranch_scc1 L_pk1
L_pl1:
    buffer_load_dword v53, v8, s[32:35], s15 offen sc1
    s_add_u32 s47, s47, 1
    s_cmp_ge_u32 s47, 16384
    s_cselect_b32 s12, -1, 0
    s_waitcnt vmcnt(0)
    v_cmp_eq_u32 vcc, s23, v53
    s_nop 1
    s_or_b32 s12, s12, vcc_lo
    s_lshr_b32 s12, s12, s93
    s_or_b32 s96, s96, s12
    s_andn2_b32 s96, s96, s14
    s_cbranch_scc0 L_pl1
L_pk1:
    s_ff1_i32_b32 s12, s96
    s_bitset0_b32 s96, s12
    s_bitset1_b32 s14, s12
    s_add_u32 s12, s12, s93
    s_and_b32 s81, s12, 15
    s_lshl_b32 s94, s81, 11
    s_add_u32 s94, s94, s95
    buffer_load_dwordx4 v[104:107], v17, s[32:35], s94 offen
    buffer_load_dwordx4 v[108:111], v17, s[32:35], s94 offen offset:1024
    s_cmp_lg_u32 s96, 0
    s_cbranch_scc1 L_pk2
L_pl2:
    buffer_load_dword v54, v8, s[32:35], s15 offen sc1
    s_add_u32 s47, s47, 1
    s_cmp_ge_u32 s47, 16384
    s_cselect_b32 s12, -1, 0
    s_waitcnt vmcnt(0)
    v_cmp_eq_u32 vcc, s23, v54
    s_nop 1
    s_or_b32 s12, s12, vcc_lo
    s_lshr_b32 s12, s12, s93
    s_or_b32 s96, s96, s12
    s_andn2_b32 s96, s96, s14
    s_cbranch_scc0 L_pl2
L_pk2:
    s_ff1_i32_b32 s12, s96
    s_bitset0_b32 s96, s12
    s_bitset1_b32 s14, s12
    s_add_u32 s12, s12, s93
    s_and_b32 s82, s12, 15
    s_lshl_b32 s94, s82, 11
    s_add_u32 s94, s94, s95
    buffer_load_dwordx4 v[112:115], v17, s[32:35], s94 offen
    buffer_load_dwordx4 v[116:119], v17, s[32:35], s94 offen offset:1024
    s_add_u32 s12, s81, s97
    s_lshl_b32 s13, s12, 12
    s_cmp_ge_u32 s12, 10
    s_cselect_b32 s12, 24576, 0
    s_add_u32 s13, s13, s12
    v_add_u32 v14, s13, v10
    v_add_u32 v15, s13, v11
    s_waitcnt vmcnt(4)
    s_waitcnt lgkmcnt(6)
    v_mfma_f32_32x32x16_bf16 v[64:79], v[120:123], v[96:99], 0
    ds_read_b64_tr_b16 v[136:137], v14 offset:0
    ds_read_b64_tr_b16 v[138:139], v14 offset:1024
    s_waitcnt lgkmcnt(6)
    v_mfma_f32_32x32x16_bf16 v[80:95], v[124:127], v[96:99], 0
    ds_read_b64_tr_b16 v[140:141], v15 offset:0
    ds_read_b64_tr_b16 v[142:143], v15 offset:1024
    s_waitcnt lgkmcnt(6)
    v_mfma_f32_32x32x16_bf16 v[64:79], v[128:131], v[100:103], v[64:79]
    ds_read_b64_tr_b16 v[144:145], v14 offset:2048
    ds_read_b64_tr_b16 v[146:147], v14 offset:3072
    s_waitcnt lgkmcnt(6)
    v_mfma_f32_32x32x16_bf16 v[80:95], v[132:135], v[100:103], v[80:95]
    ds_read_b64_tr_b16 v[148:149], v15 offset:2048
    ds_read_b64_tr_b16 v[150:151], v15 offset:3072
    s_cmp_lg_u32 s96, 0
    s_cbranch_scc1 L_pk3
L_pl3:
    buffer_load_dword v55, v8, s[32:35], s15 offen sc1
    s_add_u32 s47, s47, 1
    s_cmp_ge_u32 s47, 16384
    s_cselect_b32 s12, -1, 0
    s_waitcnt vmcnt(0)
    v_cmp_eq_u32 vcc, s23, v55
    s_nop 1
    s_or_b32 s12, s12, vcc_lo
    s_lshr_b32 s12, s12, s93
    s_or_b32 s96, s96, s12
    s_andn2_b32 s96, s96, s14
    s_cbranch_scc0 L_pl3
L_pk3:
    s_ff1_i32_b32 s12, s96
    s_bitset0_b32 s96, s12
    s_bitset1_b32 s14, s12
    s_add_u32 s12, s12, s93
    s_and_b32 s83, s12, 15
    s_lshl_b32 s94, s83, 11
    s_add_u32 s94, s94, s95
    buffer_load_dwordx4 v[96:99], v17, s[32:35], s94 offen
    buffer_load_dwordx4 v[100:103], v17, s[32:35], s94 offen offset:1024
    s_add_u32 s12, s82, s97
    s_lshl_b32 s13, s12, 12
    s_cmp_ge_u32 s12, 10
    s_cselect_b32 s12, 24576, 0
    s_add_u32 s13, s13, s12
    v_add_u32 v12, s13, v10
    v_add_u32 v13, s13, v11
    s_waitcnt vmcnt(4)
    s_waitcnt lgkmcnt(6)
    v_mfma_f32_32x32x16_bf16 v[64:79], v[136:139], v[104:107], v[64:79]
    ds_read_b64_tr_b16 v[120:121], v12 offset:0
    ds_read_b64_tr_b16 v[122:123], v12 offset:1024
    s_waitcnt lgkmcnt(6)
    v_mfma_f32_32x32x16_bf16 v[80:95], v[140:143], v[104:107], v[80:95]
    ds_read_b64_tr_b16 v[124:125], v13 offset:0
    ds_read_b64_tr_b16 v[126:127], v13 offset:1024
    s_waitcnt lgkmcnt(6)
    v_mfma_f32_32x32x16_bf16 v[64:79], v[144:147], v[108:111], v[64:79]
    ds_read_b64_tr_b16 v[128:129], v12 offset:2048
    ds_read_b64_tr_b16 v[130:131], v12 offset:3072
    s_waitcnt lgkmcnt(6)
    v_mfma_f32_32x32x16_bf16 v[80:95], v[148:151], v[108:111], v[80:95]
    ds_read_b64_tr_b16 v[132:133], v13 offset:2048
    ds_read_b64_tr_b16 v[134:135], v13 offset:3072
    s_cmp_lg_u32 s96, 0
    s_cbranch_scc1 L_pk4
L_pl4:
    buffer_load_dword v56, v8, s[32:35], s15 offen sc1
    s_add_u32 s47, s47, 1
    s_cmp_ge_u32 s47, 16384
    s_cselect_b32 s12, -1, 0
    s_waitcnt vmcnt(0)
    v_cmp_eq_u32 vcc, s23, v56
    s_nop 1
    s_or_b32 s12, s12, vcc_lo
    s_lshr_b32 s12, s12, s93
    s_or_b32 s96, s96, s12
    s_andn2_b32 s96, s96, s14
    s_cbranch_scc0 L_pl4
L_pk4:
    s_ff1_i32_b32 s12, s96
    s_bitset0_b32 s96, s12
    s_bitset1_b32 s14, s12
    s_add_u32 s12, s12, s93
    s_and_b32 s84, s12, 15
    s_lshl_b32 s94, s84, 11
    s_add_u32 s94, s94, s95
    buffer_load_dwordx4 v[104:107], v17, s[32:35], s94 offen
    buffer_load_dwordx4 v[108:111], v17, s[32:35], s94 offen offset:1024
    s_add_u32 s12, s83, s97
    s_lshl_b32 s13, s12, 12
    s_cmp_ge_u32 s12, 10
    s_cselect_b32 s12, 24576, 0
    s_add_u32 s13, s13, s12
    v_add_u32 v14, s13, v10
    v_add_u32 v15, s13, v11
    s_waitcnt vmcnt(4)
    s_waitcnt lgkmcnt(6)
    v_mfma_f32_32x32x16_bf16 v[64:79], v[120:123], v[112:115], v[64:79]
    ds_read_b64_tr_b16 v[136:137], v14 offset:0
    ds_read_b64_tr_b16 v[138:139], v14 offset:1024
    s_waitcnt lgkmcnt(6)
    v_mfma_f32_32x32x16_bf16 v[80:95], v[124:127], v[112:115], v[80:95]
    ds_read_b64_tr_b16 v[140:141], v15 offset:0
    ds_read_b64_tr_b16 v[142:143], v15 offset:1024
    s_waitcnt lgkmcnt(6)
    v_mfma_f32_32x32x16_bf16 v[64:79], v[128:131], v[116:119], v[64:79]
    ds_read_b64_tr_b16 v[144:145], v14 offset:2048
    ds_read_b64_tr_b16 v[146:147], v14 offset:3072
    s_waitcnt lgkmcnt(6)
    v_mfma_f32_32x32x16_bf16 v[80:95], v[132:135], v[116:119], v[80:95]
    ds_read_b64_tr_b16 v[148:149], v15 offset:2048
    ds_read_b64_tr_b16 v[150:151], v15 offset:3072
    s_cmp_lg_u32 s96, 0
    s_cbranch_scc1 L_pk5
L_pl5:
    buffer_load_dword v57, v8, s[32:35], s15 offen sc1
    s_add_u32 s47, s47, 1
    s_cmp_ge_u32 s47, 16384
    s_cselect_b32 s12, -1, 0
    s_waitcnt vmcnt(0)
    v_cmp_eq_u32 vcc, s23, v57
    s_nop 1
    s_or_b32 s12, s12, vcc_lo
    s_lshr_b32 s12, s12, s93
    s_or_b32 s96, s96, s12
    s_andn2_b32 s96, s96, s14
    s_cbranch_scc0 L_pl5
L_pk5:
    s_ff1_i32_b32 s12, s96
    s_bitset0_b32 s96, s12
    s_bitset1_b32 s14, s12
    s_add_u32 s12, s12, s93
    s_and_b32 s85, s12, 15
    s_lshl_b32 s94, s85, 11
    s_add_u32 s94, s94, s95
    buffer_load_dwordx4 v[112:115], v17, s[32:35], s94 offen
    buffer_load_dwordx4 v[116:119], v17, s[32:35], s94 offen offset:1024
    s_add_u32 s12, s84, s97
    s_lshl_b32 s13, s12, 12
    s_cmp_ge_u32 s12, 10
    s_cselect_b32 s12, 24576, 0
    s_add_u32 s13, s13, s12
    v_add_u32 v12, s13, v10
    v_add_u32 v13, s13, v11
    s_waitcnt vmcnt(4)
    s_waitcnt lgkmcnt(6)
    v_mfma_f32_32x32x16_bf16 v[64:79], v[136:139], v[96:99], v[64:79]
    ds_read_b64_tr_b16 v[120:121], v12 offset:0
    ds_read_b64_tr_b16 v[122:123], v12 offset:1024
    s_waitcnt lgkmcnt(6)
    v_mfma_f32_32x32x16_bf16 v[80:95], v[140:143], v[96:99], v[80:95]
    ds_read_b64_tr_b16 v[124:125], v13 offset:0
    ds_read_b64_tr_b16 v[126:127], v13 offset:1024
    s_waitcnt lgkmcnt(6)
    v_mfma_f32_32x32x16_bf16 v[64:79], v[144:147], v[100:103], v[64:79]
    ds_read_b64_tr_b16 v[128:129], v12 offset:2048
    ds_read_b64_tr_b16 v[130:131], v12 offset:3072
    s_waitcnt lgkmcnt(6)
    v_mfma_f32_32x32x16_bf16 v[80:95], v[148:151], v[100:103], v[80:95]
    ds_read_b64_tr_b16 v[132:133], v13 offset:2048
    ds_read_b64_tr_b16 v[134:135], v13 offset:3072
    s_cmp_lg_u32 s96, 0
    s_cbranch_scc1 L_pk6
L_pl6:
    buffer_load_dword v58, v8, s[32:35], s15 offen sc1
    s_add_u32 s47, s47, 1
    s_cmp_ge_u32 s47, 16384
    s_cselect_b32 s12, -1, 0
    s_waitcnt vmcnt(0)
    v_cmp_eq_u32 vcc, s23, v58
    s_nop 1
    s_or_b32 s12, s12, vcc_lo
    s_lshr_b32 s12, s12, s93
    s_or_b32 s96, s96, s12
    s_andn2_b32 s96, s96, s14
    s_cbranch_scc0 L_pl6
L_pk6:
    s_ff1_i32_b32 s12, s96
    s_bitset0_b32 s96, s12
    s_bitset1_b32 s14, s12
    s_add_u32 s12, s12, s93
    s_and_b32 s86, s12, 15
    s_lshl_b32 s94, s86, 11
    s_add_u32 s94, s94, s95
    buffer_load_dwordx4 v[96:99], v17, s[32:35], s94 offen
    buffer_load_dwordx4 v[100:103], v17, s[32:35], s94 offen offset:1024
    s_add_u32 s12, s85, s97
    s_lshl_b32 s13, s12, 12
    s_cmp_ge_u32 s12, 10
    s_cselect_b32 s12, 24576, 0
    s_add_u32 s13, s13, s12
    v_add_u32 v14, s13, v10
    v_add_u32 v15, s13, v11
    s_waitcnt vmcnt(4)
    s_waitcnt lgkmcnt(6)
    v_mfma_f32_32x32x16_bf16 v[64:79], v[120:123], v[104:107], v[64:79]
    ds_read_b64_tr_b16 v[136:137], v14 offset:0
    ds_read_b64_tr_b16 v[138:139], v14 offset:1024
    s_waitcnt lgkmcnt(6)
    v_mfma_f32_32x32x16_bf16 v[80:95], v[124:127], v[104:107], v[80:95]
    ds_read_b64_tr_b16 v[140:141], v15 offset:0
    ds_read_b64_tr_b16 v[142:143], v15 offset:1024
    s_waitcnt lgkmcnt(6)
    v_mfma_f32_32x32x16_bf16 v[64:79], v[128:131], v[108:111], v[64:79]
    ds_read_b64_tr_b16 v[144:145], v14 offset:2048
    ds_read_b64_tr_b16 v[146:147], v14 offset:3072
    s_waitcnt lgkmcnt(6)
    v_mfma_f32_32x32x16_bf16 v[80:95], v[132:135], v[108:111], v[80:95]
    ds_read_b64_tr_b16 v[148:149], v15 offset:2048
    ds_read_b64_tr_b16 v[150:151], v15 offset:3072
    s_cmp_lg_u32 s96, 0
    s_cbranch_scc1 L_pk7
L_pl7:
    buffer_load_dword v59, v8, s[32:35], s15 offen sc1
    s_add_u32 s47, s47, 1
    s_cmp_ge_u32 s47, 16384
    s_cselect_b32 s12, -1, 0
    s_waitcnt vmcnt(0)
    v_cmp_eq_u32 vcc, s23, v59
    s_nop 1
    s_or_b32 s12, s12, vcc_lo
    s_lshr_b32 s12, s12, s93
    s_or_b32 s96, s96, s12
    s_andn2_b32 s96, s96, s14
    s_cbranch_scc0 L_pl7
L_pk7:
    s_ff1_i32_b32 s12, s96
    s_bitset0_b32 s96, s12
    s_bitset1_b32 s14, s12
    s_add_u32 s12, s12, s93
    s_and_b32 s87, s12, 15
    s_lshl_b32 s94, s87, 11
    s_add_u32 s94, s94, s95
    buffer_load_dwordx4 v[104:107], v17, s[32:35], s94 offen
    buffer_load_dwordx4 v[108:111], v17, s[32:35], s94 offen offset:1024
    s_add_u32 s12, s86, s97
    s_lshl_b32 s13, s12, 12
    s_cmp_ge_u32 s12, 10
    s_cselect_b32 s12, 24576, 0
    s_add_u32 s13, s13, s12
    v_add_u32 v12, s13, v10
    v_add_u32 v13, s13, v11
    s_waitcnt vmcnt(4)
    s_waitcnt lgkmcnt(6)
    v_mfma_f32_32x32x16_bf16 v[64:79], v[136:139], v[112:115], v[64:79]
    ds_read_b64_tr_b16 v[120:121], v12 offset:0
    ds_read_b64_tr_b16 v[122:123], v12 offset:1024
    s_waitcnt lgkmcnt(6)
    v_mfma_f32_32x32x16_bf16 v[80:95], v[140:143], v[112:115], v[80:95]
    ds_read_b64_tr_b16 v[124:125], v13 offset:0
    ds_read_b64_tr_b16 v[126:127], v13 offset:1024
    s_waitcnt lgkmcnt(6)
    v_mfma_f32_32x32x16_bf16 v[64:79], v[144:147], v[116:119], v[64:79]
    ds_read_b64_tr_b16 v[128:129], v12 offset:2048
    ds_read_b64_tr_b16 v[130:131], v12 offset:3072
    s_waitcnt lgkmcnt(6)
    v_mfma_f32_32x32x16_bf16 v[80:95], v[148:151], v[116:119], v[80:95]
    ds_read_b64_tr_b16 v[132:133], v13 offset:2048
    ds_read_b64_tr_b16 v[134:135], v13 offset:3072
    s_cmp_lg_u32 s96, 0
    s_cbranch_scc1 L_pk8
L_pl8:
    buffer_load_dword v52, v8, s[32:35], s15 offen sc1
    s_add_u32 s47, s47, 1
    s_cmp_ge_u32 s47, 16384
    s_cselect_b32 s12, -1, 0
    s_waitcnt vmcnt(0)
    v_cmp_eq_u32 vcc, s23, v52
    s_nop 1
    s_or_b32 s12, s12, vcc_lo
    s_lshr_b32 s12, s12, s93
    s_or_b32 s96, s96, s12
    s_andn2_b32 s96, s96, s14
    s_cbranch_scc0 L_pl8
L_pk8:
    s_ff1_i32_b32 s12, s96
    s_bitset0_b32 s96, s12
    s_bitset1_b32 s14, s12
    s_add_u32 s12, s12, s93
    s_and_b32 s80, s12, 15
    s_lshl_b32 s94, s80, 11
    s_add_u32 s94, s94, s95
    buffer_load_dwordx4 v[112:115], v17, s[32:35], s94 offen
    buffer_load_dwordx4 v[116:119], v17, s[32:35], s94 offen offset:1024
    s_add_u32 s12, s87, s97
    s_lshl_b32 s13, s12, 12
    s_cmp_ge_u32 s12, 10
    s_cselect_b32 s12, 24576, 0
    s_add_u32 s13, s13, s12
    v_add_u32 v14, s13, v10
    v_add_u32 v15, s13, v11
    s_waitcnt vmcnt(4)
    s_waitcnt lgkmcnt(6)
    v_mfma_f32_32x32x16_bf16 v[64:79], v[120:123], v[96:99], v[64:79]
    ds_read_b64_tr_b16 v[136:137], v14 offset:0
    ds_read_b64_tr_b16 v[138:139], v14 offset:1024
    s_waitcnt lgkmcnt(6)
    v_mfma_f32_32x32x16_bf16 v[80:95], v[124:127], v[96:99], v[80:95]
    ds_read_b64_tr_b16 v[140:141], v15 offset:0
    ds_read_b64_tr_b16 v[142:143], v15 offset:1024
    s_waitcnt lgkmcnt(6)
    v_mfma_f32_32x32x16_bf16 v[64:79], v[128:131], v[100:103], v[64:79]
    ds_read_b64_tr_b16 v[144:145], v14 offset:2048
    ds_read_b64_tr_b16 v[146:147], v14 offset:3072
    s_waitcnt lgkmcnt(6)
    v_mfma_f32_32x32x16_bf16 v[80:95], v[132:135], v[100:103], v[80:95]
    ds_read_b64_tr_b16 v[148:149], v15 offset:2048
    ds_read_b64_tr_b16 v[150:151], v15 offset:3072
    s_cmp_lg_u32 s96, 0
    s_cbranch_scc1 L_pk9
L_pl9:
    buffer_load_dword v53, v8, s[32:35], s15 offen sc1
    s_add_u32 s47, s47, 1
    s_cmp_ge_u32 s47, 16384
    s_cselect_b32 s12, -1, 0
    s_waitcnt vmcnt(0)
    v_cmp_eq_u32 vcc, s23, v53
    s_nop 1
    s_or_b32 s12, s12, vcc_lo
    s_lshr_b32 s12, s12, s93
    s_or_b32 s96, s96, s12
    s_andn2_b32 s96, s96, s14
    s_cbranch_scc0 L_pl9
L_pk9:
    s_ff1_i32_b32 s12, s96
    s_bitset0_b32 s96, s12
    s_bitset1_b32 s14, s12
    s_add_u32 s12, s12, s93
    s_and_b32 s81, s12, 15
    s_lshl_b32 s94, s81, 11
    s_add_u32 s94, s94, s95
    buffer_load_dwordx4 v[96:99], v17, s[32:35], s94 offen
    buffer_load_dwordx4 v[100:103], v17, s[32:35], s94 offen offset:1024
    s_add_u32 s12, s80, s97
    s_lshl_b32 s13, s12, 12
    s_cmp_ge_u32 s12, 10
    s_cselect_b32 s12, 24576, 0
    s_add_u32 s13, s13, s12
    v_add_u32 v12, s13, v10
    v_add_u32 v13, s13, v11
    s_waitcnt vmcnt(4)
    s_waitcnt lgkmcnt(6)
    v_mfma_f32_32x32x16_bf16 v[64:79], v[136:139], v[104:107], v[64:79]
    ds_read_b64_tr_b16 v[120:121], v12 offset:0
    ds_read_b64_tr_b16 v[122:123], v12 offset:1024
    s_waitcnt lgkmcnt(6)
    v_mfma_f32_32x32x16_bf16 v[80:95], v[140:143], v[104:107], v[80:95]
    ds_read_b64_tr_b16 v[124:125], v13 offset:0
    ds_read_b64_tr_b16 v[126:127], v13 offset:1024
    s_waitcnt lgkmcnt(6)
    v_mfma_f32_32x32x16_bf16 v[64:79], v[144:147], v[108:111], v[64:79]
    ds_read_b64_tr_b16 v[128:129], v12 offset:2048
    ds_read_b64_tr_b16 v[130:131], v12 offset:3072
    s_waitcnt lgkmcnt(6)
    v_mfma_f32_32x32x16_bf16 v[80:95], v[148:151], v[108:111], v[80:95]
    ds_read_b64_tr_b16 v[132:133], v13 offset:2048
    ds_read_b64_tr_b16 v[134:135], v13 offset:3072
    s_cmp_lg_u32 s96, 0
    s_cbranch_scc1 L_pk10
L_pl10:
    buffer_load_dword v54, v8, s[32:35], s15 offen sc1
    s_add_u32 s47, s47, 1
    s_cmp_ge_u32 s47, 16384
    s_cselect_b32 s12, -1, 0
    s_waitcnt vmcnt(0)
    v_cmp_eq_u32 vcc, s23, v54
    s_nop 1
    s_or_b32 s12, s12, vcc_lo
    s_lshr_b32 s12, s12, s93
    s_or_b32 s96, s96, s12
    s_andn2_b32 s96, s96, s14
    s_cbranch_scc0 L_pl10
L_pk10:
    s_ff1_i32_b32 s12, s96
    s_bitset0_b32 s96, s12
    s_bitset1_b32 s14, s12
    s_add_u32 s12, s12, s93
    s_and_b32 s82, s12, 15
    s_lshl_b32 s94, s82, 11
    s_add_u32 s94, s94, s95
    buffer_load_dwordx4 v[104:107], v17, s[32:35], s94 offen
    buffer_load_dwordx4 v[108:111], v17, s[32:35], s94 offen offset:1024
    s_add_u32 s12, s81, s97
    s_lshl_b32 s13, s12, 12
    s_cmp_ge_u32 s12, 10
    s_cselect_b32 s12, 24576, 0
    s_add_u32 s13, s13, s12
    v_add_u32 v14, s13, v10
    v_add_u32 v15, s13, v11
    s_waitcnt vmcnt(4)
    s_waitcnt lgkmcnt(6)
    v_mfma_f32_32x32x16_bf16 v[64:79], v[120:123], v[112:115], v[64:79]
    ds_read_b64_tr_b16 v[136:137], v14 offset:0
    ds_read_b64_tr_b16 v[138:139], v14 offset:1024
    s_waitcnt lgkmcnt(6)
    v_mfma_f32_32x32x16_bf16 v[80:95], v[124:127], v[112:115], v[80:95]
    ds_read_b64_tr_b16 v[140:141], v15 offset:0
    ds_read_b64_tr_b16 v[142:143], v15 offset:1024
    s_waitcnt lgkmcnt(6)
    v_mfma_f32_32x32x16_bf16 v[64:79], v[128:131], v[116:119], v[64:79]
    ds_read_b64_tr_b16 v[144:145], v14 offset:2048
    ds_read_b64_tr_b16 v[146:147], v14 offset:3072
    s_waitcnt lgkmcnt(6)
    v_mfma_f32_32x32x16_bf16 v[80:95], v[132:135], v[116:119], v[80:95]
    ds_read_b64_tr_b16 v[148:149], v15 offset:2048
    ds_read_b64_tr_b16 v[150:151], v15 offset:3072
    s_cmp_lg_u32 s96, 0
    s_cbranch_scc1 L_pk11
L_pl11:
    buffer_load_dword v55, v8, s[32:35], s15 offen sc1
    s_add_u32 s47, s47, 1
    s_cmp_ge_u32 s47, 16384
    s_cselect_b32 s12, -1, 0
    s_waitcnt vmcnt(0)
    v_cmp_eq_u32 vcc, s23, v55
    s_nop 1
    s_or_b32 s12, s12, vcc_lo
    s_lshr_b32 s12, s12, s93
    s_or_b32 s96, s96, s12
    s_andn2_b32 s96, s96, s14
    s_cbranch_scc0 L_pl11
L_pk11:
    s_ff1_i32_b32 s12, s96
    s_bitset0_b32 s96, s12
    s_bitset1_b32 s14, s12
    s_add_u32 s12, s12, s93
    s_and_b32 s83, s12, 15
    s_lshl_b32 s94, s83, 11
    s_add_u32 s94, s94, s95
    buffer_load_dwordx4 v[112:115], v17, s[32:35], s94 offen
    buffer_load_dwordx4 v[116:119], v17, s[32:35], s94 offen offset:1024
    s_add_u32 s12, s82, s97
    s_lshl_b32 s13, s12, 12
    s_cmp_ge_u32 s12, 10
    s_cselect_b32 s12, 24576, 0
    s_add_u32 s13, s13, s12
    v_add_u32 v12, s13, v10
    v_add_u32 v13, s13, v11
    s_waitcnt vmcnt(4)
    s_waitcnt lgkmcnt(6)
    v_mfma_f32_32x32x16_bf16 v[64:79], v[136:139], v[96:99], v[64:79]
    ds_read_b64_tr_b16 v[120:121], v12 offset:0
    ds_read_b64_tr_b16 v[122:123], v12 offset:1024
    s_waitcnt lgkmcnt(6)
    v_mfma_f32_32x32x16_bf16 v[80:95], v[140:143], v[96:99], v[80:95]
    ds_read_b64_tr_b16 v[124:125], v13 offset:0
    ds_read_b64_tr_b16 v[126:127], v13 offset:1024
    s_waitcnt lgkmcnt(6)
    v_mfma_f32_32x32x16_bf16 v[64:79], v[144:147], v[100:103], v[64:79]
    ds_read_b64_tr_b16 v[128:129], v12 offset:2048
    ds_read_b64_tr_b16 v[130:131], v12 offset:3072
    s_waitcnt lgkmcnt(6)
    v_mfma_f32_32x32x16_bf16 v[80:95], v[148:151], v[100:103], v[80:95]
    ds_read_b64_tr_b16 v[132:133], v13 offset:2048
    ds_read_b64_tr_b16 v[134:135], v13 offset:3072
    s_cmp_lg_u32 s96, 0
    s_cbranch_scc1 L_pk12
L_pl12:
    buffer_load_dword v56, v8, s[32:35], s15 offen sc1
    s_add_u32 s47, s47, 1
    s_cmp_ge_u32 s47, 16384
    s_cselect_b32 s12, -1, 0
    s_waitcnt vmcnt(0)
    v_cmp_eq_u32 vcc, s23, v56
    s_nop 1
    s_or_b32 s12, s12, vcc_lo
    s_lshr_b32 s12, s12, s93
    s_or_b32 s96, s96, s12
    s_andn2_b32 s96, s96, s14
    s_cbranch_scc0 L_pl12
L_pk12:
    s_ff1_i32_b32 s12, s96
    s_bitset0_b32 s96, s12
    s_bitset1_b32 s14, s12
    s_add_u32 s12, s12, s93
    s_and_b32 s84, s12, 15
    s_lshl_b32 s94, s84, 11
    s_add_u32 s94, s94, s95
    buffer_load_dwordx4 v[96:99], v17, s[32:35], s94 offen
    buffer_load_dwordx4 v[100:103], v17, s[32:35], s94 offen offset:1024
    s_add_u32 s12, s83, s97
    s_lshl_b32 s13, s12, 12
    s_cmp_ge_u32 s12, 10
    s_cselect_b32 s12, 24576, 0
    s_add_u32 s13, s13, s12
    v_add_u32 v14, s13, v10
    v_add_u32 v15, s13, v11
    s_waitcnt vmcnt(4)
    s_waitcnt lgkmcnt(6)
    v_mfma_f32_32x32x16_bf16 v[64:79], v[120:123], v[104:107], v[64:79]
    ds_read_b64_tr_b16 v[136:137], v14 offset:0
    ds_read_b64_tr_b16 v[138:139], v14 offset:1024
    s_waitcnt lgkmcnt(6)
    v_mfma_f32_32x32x16_bf16 v[80:95], v[124:127], v[104:107], v[80:95]
    ds_read_b64_tr_b16 v[140:141], v15 offset:0
    ds_read_b64_tr_b16 v[142:143], v15 offset:1024
    s_waitcnt lgkmcnt(6)
    v_mfma_f32_32x32x16_bf16 v[64:79], v[128:131], v[108:111], v[64:79]
    ds_read_b64_tr_b16 v[144:145], v14 offset:2048
    ds_read_b64_tr_b16 v[146:147], v14 offset:3072
    s_waitcnt lgkmcnt(6)
    v_mfma_f32_32x32x16_bf16 v[80:95], v[132:135], v[108:111], v[80:95]
    ds_read_b64_tr_b16 v[148:149], v15 offset:2048
    ds_read_b64_tr_b16 v[150:151], v15 offset:3072
    s_cmp_lg_u32 s96, 0
    s_cbranch_scc1 L_pk13
L_pl13:
    buffer_load_dword v57, v8, s[32:35], s15 offen sc1
    s_add_u32 s47, s47, 1
    s_cmp_ge_u32 s47, 16384
    s_cselect_b32 s12, -1, 0
    s_waitcnt vmcnt(0)
    v_cmp_eq_u32 vcc, s23, v57
    s_nop 1
    s_or_b32 s12, s12, vcc_lo
    s_lshr_b32 s12, s12, s93
    s_or_b32 s96, s96, s12
    s_andn2_b32 s96, s96, s14
    s_cbranch_scc0 L_pl13
L_pk13:
    s_ff1_i32_b32 s12, s96
    s_bitset0_b32 s96, s12
    s_bitset1_b32 s14, s12
    s_add_u32 s12, s12, s93
    s_and_b32 s85, s12, 15
    s_lshl_b32 s94, s85, 11
    s_add_u32 s94, s94, s95
    buffer_load_dwordx4 v[104:107], v17, s[32:35], s94 offen
    buffer_load_dwordx4 v[108:111], v17, s[32:35], s94 offen offset:1024
    s_add_u32 s12, s84, s97
    s_lshl_b32 s13, s12, 12
    s_cmp_ge_u32 s12, 10
    s_cselect_b32 s12, 24576, 0
    s_add_u32 s13, s13, s12
    v_add_u32 v12, s13, v10
    v_add_u32 v13, s13, v11
    s_waitcnt vmcnt(4)
    s_waitcnt lgkmcnt(6)
    v_mfma_f32_32x32x16_bf16 v[64:79], v[136:139], v[112:115], v[64:79]
    ds_read_b64_tr_b16 v[120:121], v12 offset:0
    ds_read_b64_tr_b16 v[122:123], v12 offset:1024
    s_waitcnt lgkmcnt(6)
    v_mfma_f32_32x32x16_bf16 v[80:95], v[140:143], v[112:115], v[80:95]
    ds_read_b64_tr_b16 v[124:125], v13 offset:0
    ds_read_b64_tr_b16 v[126:127], v13 offset:1024
    s_waitcnt lgkmcnt(6)
    v_mfma_f32_32x32x16_bf16 v[64:79], v[144:147], v[116:119], v[64:79]
    ds_read_b64_tr_b16 v[128:129], v12 offset:2048
    ds_read_b64_tr_b16 v[130:131], v12 offset:3072
    s_waitcnt lgkmcnt(6)
    v_mfma_f32_32x32x16_bf16 v[80:95], v[148:151], v[116:119], v[80:95]
    ds_read_b64_tr_b16 v[132:133], v13 offset:2048
    ds_read_b64_tr_b16 v[134:135], v13 offset:3072
    s_cmp_lg_u32 s96, 0
    s_cbranch_scc1 L_pk14
L_pl14:
    buffer_load_dword v58, v8, s[32:35], s15 offen sc1
    s_add_u32 s47, s47, 1
    s_cmp_ge_u32 s47, 16384
    s_cselect_b32 s12, -1, 0
    s_waitcnt vmcnt(0)
    v_cmp_eq_u32 vcc, s23, v58
    s_nop 1
    s_or_b32 s12, s12, vcc_lo
    s_lshr_b32 s12, s12, s93
    s_or_b32 s96, s96, s12
    s_andn2_b32 s96, s96, s14
    s_cbranch_scc0 L_pl14
L_pk14:
    s_ff1_i32_b32 s12, s96
    s_bitset0_b32 s96, s12
    s_bitset1_b32 s14, s12
    s_add_u32 s12, s12, s93
    s_and_b32 s86, s12, 15
    s_lshl_b32 s94, s86, 11
    s_add_u32 s94, s94, s95
    buffer_load_dwordx4 v[112:115], v17, s[32:35], s94 offen
    buffer_load_dwordx4 v[116:119], v17, s[32:35], s94 offen offset:1024
    s_add_u32 s12, s85, s97
    s_lshl_b32 s13, s12, 12
    s_cmp_ge_u32 s12, 10
    s_cselect_b32 s12, 24576, 0
    s_add_u32 s13, s13, s12
    v_add_u32 v14, s13, v10
    v_add_u32 v15, s13, v11
    s_waitcnt vmcnt(4)
    s_waitcnt lgkmcnt(6)
    v_mfma_f32_32x32x16_bf16 v[64:79], v[120:123], v[96:99], v[64:79]
    ds_read_b64_tr_b16 v[136:137], v14 offset:0
    ds_read_b64_tr_b16 v[138:139], v14 offset:1024
    s_waitcnt lgkmcnt(6)
    v_mfma_f32_32x32x16_bf16 v[80:95], v[124:127], v[96:99], v[80:95]
    ds_read_b64_tr_b16 v[140:141], v15 offset:0
    ds_read_b64_tr_b16 v[142:143], v15 offset:1024
    s_waitcnt lgkmcnt(6)
    v_mfma_f32_32x32x16_bf16 v[64:79], v[128:131], v[100:103], v[64:79]
    ds_read_b64_tr_b16 v[144:145], v14 offset:2048
    ds_read_b64_tr_b16 v[146:147], v14 offset:3072
    s_waitcnt lgkmcnt(6)
    v_mfma_f32_32x32x16_bf16 v[80:95], v[132:135], v[100:103], v[80:95]
    ds_read_b64_tr_b16 v[148:149], v15 offset:2048
    ds_read_b64_tr_b16 v[150:151], v15 offset:3072
    s_cmp_lg_u32 s96, 0
    s_cbranch_scc1 L_pk15
L_pl15:
    buffer_load_dword v59, v8, s[32:35], s15 offen sc1
    s_add_u32 s47, s47, 1
    s_cmp_ge_u32 s47, 16384
    s_cselect_b32 s12, -1, 0
    s_waitcnt vmcnt(0)
    v_cmp_eq_u32 vcc, s23, v59
    s_nop 1
    s_or_b32 s12, s12, vcc_lo
    s_lshr_b32 s12, s12, s93
    s_or_b32 s96, s96, s12
    s_andn2_b32 s96, s96, s14
    s_cbranch_scc0 L_pl15
L_pk15:
    s_ff1_i32_b32 s12, s96
    s_bitset0_b32 s96, s12
    s_bitset1_b32 s14, s12
    s_add_u32 s12, s12, s93
    s_and_b32 s87, s12, 15
    s_lshl_b32 s94, s87, 11
    s_add_u32 s94, s94, s95
    buffer_load_dwordx4 v[96:99], v17, s[32:35], s94 offen
    buffer_load_dwordx4 v[100:103], v17, s[32:35], s94 offen offset:1024
    s_mov_b32 s45, 1
    s_cmp_eq_u32 s46, 0
    s_cbranch_scc1 L_b_nold
    s_lshl_b32 s12, s89, 12
    s_add_u32 s12, s12, 458752
    buffer_load_dwordx4 v[224:227], v22, s[32:35], s12 offen offset:0 sc1
    buffer_load_dwordx4 v[228:231], v22, s[32:35], s12 offen offset:16 sc1
    buffer_load_dwordx4 v[232:235], v22, s[32:35], s12 offen offset:64 sc1
    buffer_load_dwordx4 v[236:239], v22, s[32:35], s12 offen offset:80 sc1
L_b_nold:
    s_add_u32 s12, s86, s97
    s_lshl_b32 s13, s12, 12
    s_cmp_ge_u32 s12, 10
    s_cselect_b32 s12, 24576, 0
    s_add_u32 s13, s13, s12
    v_add_u32 v12, s13, v10
    v_add_u32 v13, s13, v11
    s_waitcnt vmcnt(4)
    s_waitcnt lgkmcnt(6)
    v_mfma_f32_32x32x16_bf16 v[64:79], v[136:139], v[104:107], v[64:79]
    ds_read_b64_tr_b16 v[120:121], v12 offset:0
    ds_read_b64_tr_b16 v[122:123], v12 offset:1024
    s_waitcnt lgkmcnt(6)
    v_mfma_f32_32x32x16_bf16 v[80:95], v[140:143], v[104:107], v[80:95]
    ds_read_b64_tr_b16 v[124:125], v13 offset:0
    ds_read_b64_tr_b16 v[126:127], v13 offset:1024
    s_waitcnt lgkmcnt(6)
    v_mfma_f32_32x32x16_bf16 v[64:79], v[144:147], v[108:111], v[64:79]
    ds_read_b64_tr_b16 v[128:129], v12 offset:2048
    ds_read_b64_tr_b16 v[130:131], v12 offset:3072
    s_waitcnt lgkmcnt(6)
    v_mfma_f32_32x32x16_bf16 v[80:95], v[148:151], v[108:111], v[80:95]
    ds_read_b64_tr_b16 v[132:133], v13 offset:2048
    ds_read_b64_tr_b16 v[134:135], v13 offset:3072
    s_add_u32 s12, s87, s97
    s_lshl_b32 s13, s12, 12
    s_cmp_ge_u32 s12, 10
    s_cselect_b32 s12, 24576, 0
    s_add_u32 s13, s13, s12
    v_add_u32 v14, s13, v10
    v_add_u32 v15, s13, v11
    s_waitcnt vmcnt(2)
    s_waitcnt lgkmcnt(6)
    v_mfma_f32_32x32x16_bf16 v[64:79], v[120:123], v[112:115], v[64:79]
    ds_read_b64_tr_b16 v[136:137], v14 offset:0
    ds_read_b64_tr_b16 v[138:139], v14 offset:1024
    s_waitcnt lgkmcnt(6)
    v_mfma_f32_32x32x16_bf16 v[80:95], v[124:127], v[112:115], v[80:95]
    ds_read_b64_tr_b16 v[140:141], v15 offset:0
    ds_read_b64_tr_b16 v[142:143], v15 offset:1024
    s_waitcnt lgkmcnt(6)
    v_mfma_f32_32x32x16_bf16 v[64:79], v[128:131], v[116:119], v[64:79]
    ds_read_b64_tr_b16 v[144:145], v14 offset:2048
    ds_read_b64_tr_b16 v[146:147], v14 offset:3072
    s_waitcnt lgkmcnt(6)
    v_mfma_f32_32x32x16_bf16 v[80:95], v[132:135], v[116:119], v[80:95]
    ds_read_b64_tr_b16 v[148:149], v15 offset:2048
    ds_read_b64_tr_b16 v[150:151], v15 offset:3072
    s_waitcnt vmcnt(0)
    s_waitcnt lgkmcnt(6)
    v_mfma_f32_32x32x16_bf16 v[64:79], v[136:139], v[96:99], v[64:79]
    s_waitcnt lgkmcnt(4)
    v_mfma_f32_32x32x16_bf16 v[80:95], v[140:143], v[96:99], v[80:95]
    s_waitcnt lgkmcnt(2)
    v_mfma_f32_32x32x16_bf16 v[64:79], v[144:147], v[100:103], v[64:79]
    s_waitcnt lgkmcnt(0)
    v_mfma_f32_32x32x16_bf16 v[80:95], v[148:151], v[100:103], v[80:95]
    s_cmp_lg_u32 s46, 0
    s_cbranch_scc1 L_own
L_own_r1:
    s_nop 0
    s_nop 8
    v_permlane16_swap_b32 v64, v80
    v_permlane16_swap_b32 v65, v81
    v_permlane16_swap_b32 v66, v82
    v_permlane16_swap_b32 v67, v83
    v_permlane16_swap_b32 v68, v84
    v_permlane16_swap_b32 v69, v85
    v_permlane16_swap_b32 v70, v86
    v_permlane16_swap_b32 v71, v87
    v_permlane16_swap_b32 v72, v88
    v_permlane16_swap_b32 v73, v89
    v_permlane16_swap_b32 v74, v90
    v_permlane16_swap_b32 v75, v91
    v_permlane16_swap_b32 v76, v92
    v_permlane16_swap_b32 v77, v93
    v_permlane16_swap_b32 v78, v94
    v_permlane16_swap_b32 v79, v95
    ds_write_b128 v20, v[80:83] offset:0
    ds_write_b128 v20, v[84:87] offset:1024
    ds_write_b128 v20, v[88:91] offset:2048
    ds_write_b128 v20, v[92:95] offset:3072
    s_waitcnt lgkmcnt(0)
    v_bfe_u32 v9, v2, 3, 1
    v_mul_u32_u24 v9, 16352, v9
    v_sub_u32 v7, v7, v9
    s_mov_b32 s12, 16384
    s_barrier
    ds_read_b128 v[80:83], v21 offset:0
    ds_read_b128 v[84:87], v21 offset:1024
    ds_read_b128 v[88:91], v21 offset:2048
    ds_read_b128 v[92:95], v21 offset:3072
    s_waitcnt lgkmcnt(3)
    v_pk_add_f32 v[64:65], v[64:65], v[80:81]
    v_pk_add_f32 v[66:67], v[66:67], v[82:83]
    v_cvt_pk_bf16_f32 v96, v64, v65
    v_cvt_pk_bf16_f32 v97, v66, v67
    s_waitcnt lgkmcnt(2)
    v_pk_add_f32 v[68:69], v[68:69], v[84:85]
    v_pk_add_f32 v[70:71], v[70:71], v[86:87]
    v_cvt_pk_bf16_f32 v98, v68, v69
    v_cvt_pk_bf16_f32 v99, v70, v71
    s_waitcnt lgkmcnt(1)
    v_pk_add_f32 v[72:73], v[72:73], v[88:89]
    v_pk_add_f32 v[74:75], v[74:75], v[90:91]
    v_cvt_pk_bf16_f32 v100, v72, v73
    v_cvt_pk_bf16_f32 v101, v74, v75
    s_waitcnt lgkmcnt(0)
    v_pk_add_f32 v[76:77], v[76:77], v[92:93]
    v_pk_add_f32 v[78:79], v[78:79], v[94:95]
    v_cvt_pk_bf16_f32 v102, v76, v77
    v_cvt_pk_bf16_f32 v103, v78, v79
    v_permlane32_swap_b32 v96, v98
    v_permlane32_swap_b32 v97, v99
    v_permlane32_swap_b32 v100, v102
    v_permlane32_swap_b32 v101, v103
    v_lshlrev_b32 v104, 16, v96
    v_and_b32 v105, 0xffff0000, v96
    v_lshlrev_b32 v106, 16, v97
    v_and_b32 v107, 0xffff0000, v97
    v_lshlrev_b32 v108, 16, v98
    v_and_b32 v109, 0xffff0000, v98
    v_lshlrev_b32 v110, 16, v99
    v_and_b32 v111, 0xffff0000, v99
    v_pk_mul_f32 v[104:105], v[104:105], v[48:49] op_sel_hi:[1,0]
    v_pk_mul_f32 v[106:107], v[106:107], v[48:49] op_sel_hi:[1,0]
    v_pk_mul_f32 v[108:109], v[108:109], v[48:49] op_sel_hi:[1,0]
    v_pk_mul_f32 v[110:111], v[110:111], v[48:49] op_sel_hi:[1,0]
    v_cvt_pk_bf16_f32 v96, v104, v105
    v_cvt_pk_bf16_f32 v97, v106, v107
    v_cvt_pk_bf16_f32 v98, v108, v109
    v_cvt_pk_bf16_f32 v99, v110, v111
    v_lshlrev_b32 v104, 16, v96
    v_and_b32 v105, 0xffff0000, v96
    v_lshlrev_b32 v106, 16, v97
    v_and_b32 v107, 0xffff0000, v97
    v_lshlrev_b32 v108, 16, v98
    v_and_b32 v109, 0xffff0000, v98
    v_lshlrev_b32 v110, 16, v99
    v_and_b32 v111, 0xffff0000, v99
    v_pk_add_f32 v[104:105], v[104:105], v[32:33]
    v_pk_add_f32 v[106:107], v[106:107], v[34:35]
    v_pk_add_f32 v[108:109], v[108:109], v[36:37]
    v_pk_add_f32 v[110:111], v[110:111], v[38:39]
    v_cvt_pk_bf16_f32 v96, v104, v105
    v_cvt_pk_bf16_f32 v97, v106, v107
    v_cvt_pk_bf16_f32 v98, v108, v109
    v_cvt_pk_bf16_f32 v99, v110, v111
    v_lshlrev_b32 v112, 16, v100
    v_and_b32 v113, 0xffff0000, v100
    v_lshlrev_b32 v114, 16, v101
    v_and_b32 v115, 0xffff0000, v101
    v_lshlrev_b32 v116, 16, v102
    v_and_b32 v117, 0xffff0000, v102
    v_lshlrev_b32 v118, 16, v103
    v_and_b32 v119, 0xffff0000, v103
    v_pk_mul_f32 v[112:113], v[112:113], v[48:49] op_sel_hi:[1,0]
    v_pk_mul_f32 v[114:115], v[114:115], v[48:49] op_sel_hi:[1,0]
    v_pk_mul_f32 v[116:117], v[116:117], v[48:49] op_sel_hi:[1,0]
    v_pk_mul_f32 v[118:119], v[118:119], v[48:49] op_sel_hi:[1,0]
    v_cvt_pk_bf16_f32 v100, v112, v113
    v_cvt_pk_bf16_f32 v101, v114, v115
    v_cvt_pk_bf16_f32 v102, v116, v117
    v_cvt_pk_bf16_f32 v103, v118, v119
    v_lshlrev_b32 v112, 16, v100
    v_and_b32 v113, 0xffff0000, v100
    v_lshlrev_b32 v114, 16, v101
    v_and_b32 v115, 0xffff0000, v101
    v_lshlrev_b32 v116, 16, v102
    v_and_b32 v117, 0xffff0000, v102
    v_lshlrev_b32 v118, 16, v103
    v_and_b32 v119, 0xffff0000, v103
    v_pk_add_f32 v[112:113], v[112:113], v[40:41]
    v_pk_add_f32 v[114:115], v[114:115], v[42:43]
    v_pk_add_f32 v[116:117], v[116:117], v[44:45]
    v_pk_add_f32 v[118:119], v[118:119], v[46:47]
    v_cvt_pk_bf16_f32 v100, v112, v113
    v_cvt_pk_bf16_f32 v101, v114, v115
    v_cvt_pk_bf16_f32 v102, v116, v117
    v_cvt_pk_bf16_f32 v103, v118, v119
    v_mov_b32 v104, v100
    v_mov_b32 v105, v101
    v_mov_b32 v106, v102
    v_mov_b32 v107, v103
    v_mov_b32_dpp v100, v96 row_ror:8 row_mask:0xf bank_mask:0x3
    v_mov_b32_dpp v101, v97 row_ror:8 row_mask:0xf bank_mask:0x3
    v_mov_b32_dpp v102, v98 row_ror:8 row_mask:0xf bank_mask:0x3
    v_mov_b32_dpp v103, v99 row_ror:8 row_mask:0xf bank_mask:0x3
    v_mov_b32_dpp v96, v104 row_ror:8 row_mask:0xf bank_mask:0xc
    v_mov_b32_dpp v97, v105 row_ror:8 row_mask:0xf bank_mask:0xc
    v_mov_b32_dpp v98, v106 row_ror:8 row_mask:0xf bank_mask:0xc
    v_mov_b32_dpp v99, v107 row_ror:8 row_mask:0xf bank_mask:0xc
    buffer_store_dwordx4 v[96:99], v7, s[68:71], 0 offen sc1
    buffer_store_dwordx4 v[100:103], v7, s[68:71], s12 offen sc1
    s_endpgm
L_own:
    s_mov_b32 s13, 0
L_b_y:
    s_waitcnt vmcnt(0)
    v_msad_u8 v240, v224, s76, 0
    v_msad_u8 v240, v225, s77, v240
    v_msad_u8 v240, v226, s78, v240
    v_msad_u8 v240, v227, s79, v240
    v_msad_u8 v240, v228, s76, v240
    v_msad_u8 v240, v229, s77, v240
    v_msad_u8 v240, v230, s78, v240
    v_msad_u8 v240, v231, s79, v240
    v_msad_u8 v240, v232, s76, v240
    v_msad_u8 v240, v233, s77, v240
    v_msad_u8 v240, v234, s78, v240
    v_msad_u8 v240, v235, s79, v240
    v_msad_u8 v240, v236, s76, v240
    v_msad_u8 v240, v237, s77, v240
    v_msad_u8 v240, v238, s78, v240
    v_msad_u8 v240, v239, s79, v240
    v_cmp_ne_u32 vcc, 0, v240
    s_nop 1
    s_or_b32 s46, vcc_lo, vcc_hi
    s_cbranch_scc0 L_b_yok
    s_cmp_eq_u32 s45, 0
    s_cbranch_scc1 L_b_yok
    s_lshl_b32 s12, s89, 12
    s_add_u32 s12, s12, 458752
    buffer_load_dwordx4 v[224:227], v22, s[32:35], s12 offen offset:0 sc1
    buffer_load_dwordx4 v[228:231], v22, s[32:35], s12 offen offset:16 sc1
    buffer_load_dwordx4 v[232:235], v22, s[32:35], s12 offen offset:64 sc1
    buffer_load_dwordx4 v[236:239], v22, s[32:35], s12 offen offset:80 sc1
    s_add_u32 s13, s13, 1
    s_cmp_lt_u32 s13, 16384
    s_cbranch_scc1 L_b_y
    s_waitcnt vmcnt(0)
    s_mov_b32 s46, 0
L_b_yok:
    v_add_f32_dpp v224, v224, v224 row_ror:1 row_mask:0xf bank_mask:0xf
    v_add_f32_dpp v225, v225, v225 row_ror:1 row_mask:0xf bank_mask:0xf
    v_add_f32_dpp v226, v226, v226 row_ror:1 row_mask:0xf bank_mask:0xf
    v_add_f32_dpp v227, v227, v227 row_ror:1 row_mask:0xf bank_mask:0xf
    v_add_f32_dpp v228, v228, v228 row_ror:1 row_mask:0xf bank_mask:0xf
    v_add_f32_dpp v229, v229, v229 row_ror:1 row_mask:0xf bank_mask:0xf
    v_add_f32_dpp v230, v230, v230 row_ror:1 row_mask:0xf bank_mask:0xf
    v_add_f32_dpp v231, v231, v231 row_ror:1 row_mask:0xf bank_mask:0xf
    v_add_f32_dpp v232, v232, v232 row_ror:1 row_mask:0xf bank_mask:0xf
    v_add_f32_dpp v233, v233, v233 row_ror:1 row_mask:0xf bank_mask:0xf
    v_add_f32_dpp v234, v234, v234 row_ror:1 row_mask:0xf bank_mask:0xf
    v_add_f32_dpp v235, v235, v235 row_ror:1 row_mask:0xf bank_mask:0xf
    v_add_f32_dpp v236, v236, v236 row_ror:1 row_mask:0xf bank_mask:0xf
    v_add_f32_dpp v237, v237, v237 row_ror:1 row_mask:0xf bank_mask:0xf
    v_add_f32_dpp v238, v238, v238 row_ror:1 row_mask:0xf bank_mask:0xf
    v_add_f32_dpp v239, v239, v239 row_ror:1 row_mask:0xf bank_mask:0xf
    v_add_f32_dpp v224, v224, v224 row_ror:2 row_mask:0xf bank_mask:0xf
    v_add_f32_dpp v225, v225, v225 row_ror:2 row_mask:0xf bank_mask:0xf
    v_add_f32_dpp v226, v226, v226 row_ror:2 row_mask:0xf bank_mask:0xf
    v_add_f32_dpp v227, v227, v227 row_ror:2 row_mask:0xf bank_mask:0xf
    v_add_f32_dpp v228, v228, v228 row_ror:2 row_mask:0xf bank_mask:0xf
    v_add_f32_dpp v229, v229, v229 row_ror:2 row_mask:0xf bank_mask:0xf
    v_add_f32_dpp v230, v230, v230 row_ror:2 row_mask:0xf bank_mask:0xf
    v_add_f32_dpp v231, v231, v231 row_ror:2 row_mask:0xf bank_mask:0xf
    v_add_f32_dpp v232, v232, v232 row_ror:2 row_mask:0xf bank_mask:0xf
    v_add_f32_dpp v233, v233, v233 row_ror:2 row_mask:0xf bank_mask:0xf
    v_add_f32_dpp v234, v234, v234 row_ror:2 row_mask:0xf bank_mask:0xf
    v_add_f32_dpp v235, v235, v235 row_ror:2 row_mask:0xf bank_mask:0xf
    v_add_f32_dpp v236, v236, v236 row_ror:2 row_mask:0xf bank_mask:0xf
    v_add_f32_dpp v237, v237, v237 row_ror:2 row_mask:0xf bank_mask:0xf
    v_add_f32_dpp v238, v238, v238 row_ror:2 row_mask:0xf bank_mask:0xf
    v_add_f32_dpp v239, v239, v239 row_ror:2 row_mask:0xf bank_mask:0xf
    v_add_f32_dpp v224, v224, v224 row_ror:4 row_mask:0xf bank_mask:0xf
    v_add_f32_dpp v225, v225, v225 row_ror:4 row_mask:0xf bank_mask:0xf
    v_add_f32_dpp v226, v226, v226 row_ror:4 row_mask:0xf bank_mask:0xf
    v_add_f32_dpp v227, v227, v227 row_ror:4 row_mask:0xf bank_mask:0xf
    v_add_f32_dpp v228, v228, v228 row_ror:4 row_mask:0xf bank_mask:0xf
    v_add_f32_dpp v229, v229, v229 row_ror:4 row_mask:0xf bank_mask:0xf
    v_add_f32_dpp v230, v230, v230 row_ror:4 row_mask:0xf bank_mask:0xf
    v_add_f32_dpp v231, v231, v231 row_ror:4 row_mask:0xf bank_mask:0xf
    v_add_f32_dpp v232, v232, v232 row_ror:4 row_mask:0xf bank_mask:0xf
    v_add_f32_dpp v233, v233, v233 row_ror:4 row_mask:0xf bank_mask:0xf
    v_add_f32_dpp v234, v234, v234 row_ror:4 row_mask:0xf bank_mask:0xf
    v_add_f32_dpp v235, v235, v235 row_ror:4 row_mask:0xf bank_mask:0xf
    v_add_f32_dpp v236, v236, v236 row_ror:4 row_mask:0xf bank_mask:0xf
    v_add_f32_dpp v237, v237, v237 row_ror:4 row_mask:0xf bank_mask:0xf
    v_add_f32_dpp v238, v238, v238 row_ror:4 row_mask:0xf bank_mask:0xf
    v_add_f32_dpp v239, v239, v239 row_ror:4 row_mask:0xf bank_mask:0xf
    v_add_f32_dpp v224, v224, v224 row_ror:8 row_mask:0xf bank_mask:0xf
    v_add_f32_dpp v225, v225, v225 row_ror:8 row_mask:0xf bank_mask:0xf
    v_add_f32_dpp v226, v226, v226 row_ror:8 row_mask:0xf bank_mask:0xf
    v_add_f32_dpp v227, v227, v227 row_ror:8 row_mask:0xf bank_mask:0xf
    v_add_f32_dpp v228, v228, v228 row_ror:8 row_mask:0xf bank_mask:0xf
    v_add_f32_dpp v229, v229, v229 row_ror:8 row_mask:0xf bank_mask:0xf
    v_add_f32_dpp v230, v230, v230 row_ror:8 row_mask:0xf bank_mask:0xf
    v_add_f32_dpp v231, v231, v231 row_ror:8 row_mask:0xf bank_mask:0xf
    v_add_f32_dpp v232, v232, v232 row_ror:8 row_mask:0xf bank_mask:0xf
    v_add_f32_dpp v233, v233, v233 row_ror:8 row_mask:0xf bank_mask:0xf
    v_add_f32_dpp v234, v234, v234 row_ror:8 row_mask:0xf bank_mask:0xf
    v_add_f32_dpp v235, v235, v235 row_ror:8 row_mask:0xf bank_mask:0xf
    v_add_f32_dpp v236, v236, v236 row_ror:8 row_mask:0xf bank_mask:0xf
    v_add_f32_dpp v237, v237, v237 row_ror:8 row_mask:0xf bank_mask:0xf
    v_add_f32_dpp v238, v238, v238 row_ror:8 row_mask:0xf bank_mask:0xf
    v_add_f32_dpp v239, v239, v239 row_ror:8 row_mask:0xf bank_mask:0xf
    v_cvt_pk_bf16_f32 v240, v224, v225
    v_cvt_pk_bf16_f32 v241, v226, v227
    v_cvt_pk_bf16_f32 v242, v228, v229
    v_cvt_pk_bf16_f32 v243, v230, v231
    v_cvt_pk_bf16_f32 v244, v232, v233
    v_cvt_pk_bf16_f32 v245, v234, v235
    v_cvt_pk_bf16_f32 v246, v236, v237
    v_cvt_pk_bf16_f32 v247, v238, v239
    v_lshlrev_b32 v224, 16, v240
    v_and_b32 v225, 0xffff0000, v240
    v_lshlrev_b32 v226, 16, v241
    v_and_b32 v227, 0xffff0000, v241
    v_lshlrev_b32 v228, 16, v242
    v_and_b32 v229, 0xffff0000, v242
    v_lshlrev_b32 v230, 16, v243
    v_and_b32 v231, 0xffff0000, v243
    v_lshlrev_b32 v232, 16, v244
    v_and_b32 v233, 0xffff0000, v244
    v_lshlrev_b32 v234, 16, v245
    v_and_b32 v235, 0xffff0000, v245
    v_lshlrev_b32 v236, 16, v246
    v_and_b32 v237, 0xffff0000, v246
    v_lshlrev_b32 v238, 16, v247
    v_and_b32 v239, 0xffff0000, v247
    v_pk_mul_f32 v[224:225], v[224:225], s[22:23] op_sel_hi:[1,0]
    v_pk_mul_f32 v[226:227], v[226:227], s[22:23] op_sel_hi:[1,0]
    v_pk_mul_f32 v[228:229], v[228:229], s[22:23] op_sel_hi:[1,0]
    v_pk_mul_f32 v[230:231], v[230:231], s[22:23] op_sel_hi:[1,0]
    v_pk_mul_f32 v[232:233], v[232:233], s[22:23] op_sel_hi:[1,0]
    v_pk_mul_f32 v[234:235], v[234:235], s[22:23] op_sel_hi:[1,0]
    v_pk_mul_f32 v[236:237], v[236:237], s[22:23] op_sel_hi:[1,0]
    v_pk_mul_f32 v[238:239], v[238:239], s[22:23] op_sel_hi:[1,0]
    v_cvt_pk_bf16_f32 v240, v224, v225
    v_cvt_pk_bf16_f32 v241, v226, v227
    v_cvt_pk_bf16_f32 v242, v228, v229
    v_cvt_pk_bf16_f32 v243, v230, v231
    v_cvt_pk_bf16_f32 v244, v232, v233
    v_cvt_pk_bf16_f32 v245, v234, v235
    v_cvt_pk_bf16_f32 v246, v236, v237
    v_cvt_pk_bf16_f32 v247, v238, v239
    v_lshlrev_b32 v224, 16, v240
    v_and_b32 v225, 0xffff0000, v240
    v_lshlrev_b32 v226, 16, v241
    v_and_b32 v227, 0xffff0000, v241
    v_lshlrev_b32 v228, 16, v242
    v_and_b32 v229, 0xffff0000, v242
    v_lshlrev_b32 v230, 16, v243
    v_and_b32 v231, 0xffff0000, v243
    v_lshlrev_b32 v232, 16, v244
    v_and_b32 v233, 0xffff0000, v244
    v_lshlrev_b32 v234, 16, v245
    v_and_b32 v235, 0xffff0000, v245
    v_lshlrev_b32 v236, 16, v246
    v_and_b32 v237, 0xffff0000, v246
    v_lshlrev_b32 v238, 16, v247
    v_and_b32 v239, 0xffff0000, v247
    v_lshlrev_b32 v32, 16, v24
    v_and_b32 v33, 0xffff0000, v24
    v_lshlrev_b32 v34, 16, v25
    v_and_b32 v35, 0xffff0000, v25
    v_lshlrev_b32 v36, 16, v26
    v_and_b32 v37, 0xffff0000, v26
    v_lshlrev_b32 v38, 16, v27
    v_and_b32 v39, 0xffff0000, v27
    v_lshlrev_b32 v40, 16, v28
    v_and_b32 v41, 0xffff0000, v28
    v_lshlrev_b32 v42, 16, v29
    v_and_b32 v43, 0xffff0000, v29
    v_lshlrev_b32 v44, 16, v30
    v_and_b32 v45, 0xffff0000, v30
    v_lshlrev_b32 v46, 16, v31
    v_and_b32 v47, 0xffff0000, v31
    v_pk_add_f32 v[224:225], v[224:225], v[32:33]
    v_pk_add_f32 v[226:227], v[226:227], v[34:35]
    v_pk_add_f32 v[228:229], v[228:229], v[36:37]
    v_pk_add_f32 v[230:231], v[230:231], v[38:39]
    v_pk_add_f32 v[232:233], v[232:233], v[40:41]
    v_pk_add_f32 v[234:235], v[234:235], v[42:43]
    v_pk_add_f32 v[236:237], v[236:237], v[44:45]
    v_pk_add_f32 v[238:239], v[238:239], v[46:47]
    v_cvt_pk_bf16_f32 v240, v224, v225
    v_cvt_pk_bf16_f32 v241, v226, v227
    v_cvt_pk_bf16_f32 v242, v228, v229
    v_cvt_pk_bf16_f32 v243, v230, v231
    v_cvt_pk_bf16_f32 v244, v232, v233
    v_cvt_pk_bf16_f32 v245, v234, v235
    v_cvt_pk_bf16_f32 v246, v236, v237
    v_cvt_pk_bf16_f32 v247, v238, v239
    s_cmp_eq_u32 s46, 0
    s_cselect_b32 s12, s21, -1
    v_cmp_eq_u32 vcc, s12, v6
    s_nop 1
    v_cndmask_b32 v24, v24, v240, vcc
    v_cndmask_b32 v25, v25, v241, vcc
    v_cndmask_b32 v26, v26, v242, vcc
    v_cndmask_b32 v27, v27, v243, vcc
    v_cndmask_b32 v28, v28, v244, vcc
    v_cndmask_b32 v29, v29, v245, vcc
    v_cndmask_b32 v30, v30, v246, vcc
    v_cndmask_b32 v31, v31, v247, vcc
    v_lshlrev_b32 v32, 16, v24
    v_and_b32 v33, 0xffff0000, v24
    v_lshlrev_b32 v34, 16, v25
    v_and_b32 v35, 0xffff0000, v25
    v_lshlrev_b32 v36, 16, v26
    v_and_b32 v37, 0xffff0000, v26
    v_lshlrev_b32 v38, 16, v27
    v_and_b32 v39, 0xffff0000, v27
    v_lshlrev_b32 v40, 16, v28
    v_and_b32 v41, 0xffff0000, v28
    v_lshlrev_b32 v42, 16, v29
    v_and_b32 v43, 0xffff0000, v29
    v_lshlrev_b32 v44, 16, v30
    v_and_b32 v45, 0xffff0000, v30
    v_lshlrev_b32 v46, 16, v31
    v_and_b32 v47, 0xffff0000, v31
    v_pk_mul_f32 v[32:33], v[32:33], v[50:51] op_sel_hi:[1,0]
    v_pk_mul_f32 v[34:35], v[34:35], v[50:51] op_sel_hi:[1,0]
    v_pk_mul_f32 v[36:37], v[36:37], v[50:51] op_sel_hi:[1,0]
    v_pk_mul_f32 v[38:39], v[38:39], v[50:51] op_sel_hi:[1,0]
    v_pk_mul_f32 v[40:41], v[40:41], v[50:51] op_sel_hi:[1,0]
    v_pk_mul_f32 v[42:43], v[42:43], v[50:51] op_sel_hi:[1,0]
    v_pk_mul_f32 v[44:45], v[44:45], v[50:51] op_sel_hi:[1,0]
    v_pk_mul_f32 v[46:47], v[46:47], v[50:51] op_sel_hi:[1,0]
    v_cvt_pk_bf16_f32 v33, v32, v33
    v_cvt_pk_bf16_f32 v35, v34, v35
    v_cvt_pk_bf16_f32 v37, v36, v37
    v_cvt_pk_bf16_f32 v39, v38, v39
    v_cvt_pk_bf16_f32 v41, v40, v41
    v_cvt_pk_bf16_f32 v43, v42, v43
    v_cvt_pk_bf16_f32 v45, v44, v45
    v_cvt_pk_bf16_f32 v47, v46, v47
    v_lshlrev_b32 v32, 16, v33
    v_and_b32 v33, 0xffff0000, v33
    v_lshlrev_b32 v34, 16, v35
    v_and_b32 v35, 0xffff0000, v35
    v_lshlrev_b32 v36, 16, v37
    v_and_b32 v37, 0xffff0000, v37
    v_lshlrev_b32 v38, 16, v39
    v_and_b32 v39, 0xffff0000, v39
    v_lshlrev_b32 v40, 16, v41
    v_and_b32 v41, 0xffff0000, v41
    v_lshlrev_b32 v42, 16, v43
    v_and_b32 v43, 0xffff0000, v43
    v_lshlrev_b32 v44, 16, v45
    v_and_b32 v45, 0xffff0000, v45
    v_lshlrev_b32 v46, 16, v47
    v_and_b32 v47, 0xffff0000, v47
    s_cmp_eq_u32 s45, 0
    s_cbranch_scc1 L_own_r0
    s_branch L_own_r1
L_end:
    s_endpgm
.section .rodata,"a"
.p2align 6
.amdhsa_kernel gated_mix__linear_kernel_hedgehog__moe_arch_mod__prompt_kernel
  .amdhsa_next_free_vgpr 256
  .amdhsa_next_free_sgpr 102
  .amdhsa_accum_offset 256
  .amdhsa_group_segment_fixed_size 0
  .amdhsa_kernarg_size 104
  .amdhsa_user_sgpr_count 2
  .amdhsa_user_sgpr_kernarg_segment_ptr 1
  .amdhsa_system_sgpr_workgroup_id_x 1
.end_amdhsa_kernel
```

```asm
; @launch grid=(256,1,1) block=(512,1,1) lds=163840
.amdgcn_target "amdgcn-amd-amdhsa--gfx950"
.text
.globl gated_mix__linear_kernel_hedgehog__moe_arch_mod__prompt_kernel
.p2align 12
.p2align 8
.type gated_mix__linear_kernel_hedgehog__moe_arch_mod__prompt_kernel,@function
gated_mix__linear_kernel_hedgehog__moe_arch_mod__prompt_kernel:
    s_cmp_ge_u32 s2, 256
    s_cbranch_scc1 L_end
    s_load_dwordx4 s[4:7], s[0:1], 0
    s_load_dwordx4 s[8:11], s[0:1], 16
    s_load_dwordx16 s[48:63], s[0:1], 40
    v_lshrrev_b32 v1, 6, v0
    v_and_b32 v2, 63, v0
    v_readfirstlane_b32 s20, v1
    s_and_b32 s16, s2, 7
    s_lshr_b32 s17, s2, 3
    s_and_b32 s18, s16, 1
    s_lshl_b32 s18, s18, 3
    s_and_b32 s19, s17, 7
    s_add_u32 s18, s18, s19
    s_lshr_b32 s19, s16, 1
    s_lshl_b32 s19, s19, 2
    s_lshr_b32 s12, s17, 3
    s_add_u32 s19, s19, s12
    v_lshlrev_b32 v5, 4, v2
    s_cmp_lt_u32 s20, 4
    s_cbranch_scc1 L_compute
    s_sub_u32 s21, s20, 4
    s_mov_b32 s68, 0x76543210
    s_mov_b32 s69, 0xfedcba98
    s_lshl_b32 s12, s16, 1
    s_mul_i32 s12, s12, 0x11111111
    s_xor_b32 s68, s68, s12
    s_xor_b32 s69, s69, s12
    v_lshrrev_b32 v4, 3, v2
    v_lshlrev_b32 v9, 11, v4
    v_and_b32 v6, 7, v2
    v_lshrrev_b32 v7, 4, v2
    v_xor_b32 v8, v6, v7
    v_lshl_add_u32 v10, v8, 4, v9
    v_xor_b32 v8, 4, v8
    v_lshl_add_u32 v11, v8, 4, v9
    v_mul_u32_u24 v12, 6144, v4
    v_and_b32 v7, 1, v7
    v_lshlrev_b32 v7, 2, v7
    v_xor_b32 v8, v6, v7
    v_lshl_add_u32 v12, v8, 4, v12
    s_lshl_b32 s12, s18, 18
    s_lshl_b32 s13, s21, 16
    s_add_u32 s12, s12, s13
    s_add_u32 s13, s12, 0
    v_add_u32 v20, s13, v10
    s_add_u32 s13, s12, 15360
    v_add_u32 v21, s13, v11
    s_add_u32 s13, s12, 30720
    v_add_u32 v22, s13, v10
    s_add_u32 s13, s12, 46080
    v_add_u32 v23, s13, v11
    s_lshl_b32 s12, s19, 7
    s_mul_i32 s14, s21, 6
    s_mul_i32 s14, s21, 98304
    s_add_u32 s14, s14, s12
    s_add_u32 s13, s14, 2048
    v_add_u32 v24, s13, v12
    s_add_u32 s13, s14, 50176
    v_add_u32 v25, s13, v12
    s_add_u32 s13, s14, 4096
    v_add_u32 v26, s13, v12
    s_add_u32 s13, s14, 52224
    v_add_u32 v27, s13, v12
    s_add_u32 s13, s14, 0
    v_add_u32 v28, s13, v12
    s_add_u32 s13, s14, 48128
    v_add_u32 v29, s13, v12
    s_lshl_b32 s94, s21, 12
    s_mul_i32 s95, s21, 6144
    s_add_u32 s95, s95, 16384
    s_lshl_b32 s95, s21, 11
    s_waitcnt lgkmcnt(0)
    s_mov_b32 s24, s4
    s_and_b32 s25, s5, 0xffff
    s_mov_b32 s26, 4194304
    s_mov_b32 s27, 0x00020000
    s_mov_b32 s28, s6
    s_and_b32 s29, s7, 0xffff
    s_mov_b32 s30, 6291456
    s_mov_b32 s31, 0x00020000
    s_bfe_u32 s91, s68, 0x40000
    s_lshl_b32 s92, s91, 7
    s_mul_i32 s93, s91, 393216
    s_add_u32 m0, s94, 0
    s_nop 0
    buffer_load_dwordx4 v20, s[24:27], s92 offen offset:0 lds
    buffer_load_dwordx4 v21, s[24:27], s92 offen offset:1024 lds
    buffer_load_dwordx4 v22, s[24:27], s92 offen offset:2048 lds
    buffer_load_dwordx4 v23, s[24:27], s92 offen offset:3072 lds
    s_add_u32 m0, s95, 24576
    s_nop 0
    buffer_load_dwordx4 v24, s[28:31], s93 offen offset:0 lds
    buffer_load_dwordx4 v25, s[28:31], s93 offen offset:1024 lds
    s_add_u32 m0, s95, 32768
    s_nop 0
    buffer_load_dwordx4 v26, s[28:31], s93 offen offset:0 lds
    buffer_load_dwordx4 v27, s[28:31], s93 offen offset:1024 lds
    s_add_u32 m0, s95, 16384
    s_nop 0
    buffer_load_dwordx4 v28, s[28:31], s93 offen offset:0 lds
    buffer_load_dwordx4 v29, s[28:31], s93 offen offset:1024 lds
    s_bfe_u32 s91, s68, 0x40004
    s_lshl_b32 s92, s91, 7
    s_mul_i32 s93, s91, 393216
    s_add_u32 m0, s94, 40960
    s_nop 0
    buffer_load_dwordx4 v20, s[24:27], s92 offen offset:0 lds
    buffer_load_dwordx4 v21, s[24:27], s92 offen offset:1024 lds
    buffer_load_dwordx4 v22, s[24:27], s92 offen offset:2048 lds
    buffer_load_dwordx4 v23, s[24:27], s92 offen offset:3072 lds
    s_add_u32 m0, s95, 65536
    s_nop 0
    buffer_load_dwordx4 v24, s[28:31], s93 offen offset:0 lds
    buffer_load_dwordx4 v25, s[28:31], s93 offen offset:1024 lds
    s_mov_b32 s32, s62
    s_and_b32 s33, s63, 0xffff
    s_mov_b32 s34, 33554432
    s_mov_b32 s35, 0x00020000
    s_mov_b32 s36, s10
    s_and_b32 s37, s11, 0xffff
    s_mov_b32 s38, 2097152
    s_mov_b32 s39, 0x00020000
    s_mov_b32 s40, s50
    s_and_b32 s41, s51, 0xffff
    s_mov_b32 s42, 7340032
    s_mov_b32 s43, 0x00020000
    s_mov_b32 s44, s52
    s_and_b32 s45, s53, 0xffff
    s_mov_b32 s46, 7340032
    s_mov_b32 s47, 0x00020000
    s_mov_b32 s64, s54
    s_and_b32 s65, s55, 0xffff
    s_mov_b32 s66, 7340032
    s_mov_b32 s67, 0x00020000
    s_mov_b32 s72, s60
    s_and_b32 s73, s61, 0xffff
    s_mov_b32 s74, 256
    s_mov_b32 s75, 0x00020000
    s_mov_b32 s76, s8
    s_and_b32 s77, s9, 0xffff
    s_mov_b32 s78, 65536
    s_mov_b32 s79, 0x00020000
    s_mov_b32 s80, s48
    s_and_b32 s81, s49, 0xffff
    s_mov_b32 s82, 2048
    s_mov_b32 s83, 0x00020000
    s_mov_b32 s84, s56
    s_and_b32 s85, s57, 0xffff
    s_mov_b32 s86, 2048
    s_mov_b32 s87, 0x00020000
    s_cmp_gt_u32 s19, 3
    s_subb_u32 s10, s19, 0
    s_cmp_gt_u32 s19, 11
    s_subb_u32 s10, s10, 0
    s_lshl_b32 s10, s10, 4
    s_add_u32 s10, s10, s18
    s_and_b32 s12, s19, 7
    s_cmp_eq_u32 s12, 3
    s_cselect_b32 s10, 224, s10
    s_xor_b32 s11, s18, 2
    s_lshl_b32 s11, s11, 4
    s_add_u32 s11, s11, s19
    s_lshl_b32 s11, s19, 4
    s_add_u32 s11, s11, s18
    s_cmp_lt_u32 s10, 224
    s_cselect_b32 s42, s42, 0
    s_cselect_b32 s46, s46, 0
    s_and_b32 s88, s16, 1
    s_lshl_b32 s88, s88, 3
    s_lshr_b32 s89, s16, 1
    s_lshl_b32 s89, s89, 1
    s_add_u32 s88, s88, s89
    s_lshr_b32 s89, s17, 4
    s_add_u32 s88, s88, s89
    s_and_b32 s89, s17, 15
    v_mov_b32 v13, 0
    v_mul_u32_u24 v30, 57344, v4
    v_lshl_add_u32 v30, v6, 4, v30
    v_lshl_add_u32 v31, v6, 4, v9
    v_lshl_add_u32 v33, v8, 4, v9
    s_lshl_b32 s12, s89, 7
    v_add_u32 v33, s12, v33
    v_lshlrev_b32 v34, 4, v4
    s_and_b32 s12, s10, 3
    s_lshl_b32 s12, s12, 8
    s_lshl_b32 s13, s21, 6
    s_add_u32 s70, s12, s13
    s_mul_i32 s71, s70, 7168
    s_lshr_b32 s12, s10, 2
    s_lshl_b32 s12, s12, 7
    s_add_u32 s71, s71, s12
    s_and_b32 s12, s11, 15
    s_mul_i32 s12, s12, 224
    s_mul_i32 s13, s21, 56
    s_add_u32 s96, s12, s13
    s_lshl_b32 s97, s96, 11
    s_lshr_b32 s12, s11, 4
    s_lshl_b32 s12, s12, 7
    s_add_u32 s97, s97, s12
    s_lshl_b32 s22, s18, 7
    s_lshl_b32 s12, s19, 3
    s_add_u32 s22, s22, s12
    s_lshl_b32 s12, s21, 1
    s_add_u32 s22, s22, s12
    s_xor_b32 s9, s71, 512
    s_and_b32 s12, s18, 7
    s_lshl_b32 s12, s12, 2
    s_add_u32 s12, s12, s21
    s_mul_i32 s12, s12, 6
    v_add_u32 v32, s12, v2
    v_lshrrev_b32 v11, 6, v32
    v_and_b32 v32, 63, v32
    v_mul_u32_u24 v32, 6144, v32
    v_lshl_add_u32 v32, v11, 11, v32
    s_lshl_b32 s12, s19, 7
    v_add_u32 v32, s12, v32
    s_lshl_b32 s12, s2, 6
    s_lshl_b32 s13, s21, 4
    s_add_u32 s12, s12, s13
    v_add_u32 v10, s12, v2
    v_lshlrev_b32 v10, 7, v10
    s_lshl_b32 s12, s17, 6
    s_add_u32 s12, s12, s13
    s_sub_u32 s12, s12, 16
    v_add_u32 v11, s12, v2
    v_and_b32 v12, 1, v11
    v_lshrrev_b32 v11, 1, v11
    v_lshlrev_b32 v11, 11, v11
    v_lshl_add_u32 v11, v12, 10, v11
    v_add_u32 v11, 384, v11
    v_cmp_gt_u32 vcc, 16, v2
    s_nop 1
    v_cndmask_b32 v10, v11, v10, vcc
    s_mul_i32 s12, s2, 13108
    s_lshr_b32 s12, s12, 16
    s_mul_i32 s12, s12, 5
    s_sub_u32 s3, s2, s12
    s_cmp_ge_u32 s10, 224
    s_cselect_b32 s3, 0, s3
    s_waitcnt vmcnt(6)
    s_barrier
    s_cmp_eq_u32 s3, 1
    s_cbranch_scc1 L_var1
    s_cmp_eq_u32 s3, 2
    s_cbranch_scc1 L_var2
    s_cmp_eq_u32 s3, 3
    s_cbranch_scc1 L_var3
    s_cmp_eq_u32 s3, 4
    s_cbranch_scc1 L_var4
L_var0:
    s_nop 0
    s_add_u32 m0, s95, 73728
    s_nop 0
    buffer_load_dwordx4 v26, s[28:31], s93 offen offset:0 lds
    buffer_load_dwordx4 v27, s[28:31], s93 offen offset:1024 lds
    s_add_u32 m0, s95, 57344
    s_nop 0
    buffer_load_dwordx4 v28, s[28:31], s93 offen offset:0 lds
    buffer_load_dwordx4 v29, s[28:31], s93 offen offset:1024 lds
    s_bfe_u32 s91, s68, 0x40008
    s_lshl_b32 s92, s91, 7
    s_mul_i32 s93, s91, 393216
    s_add_u32 m0, s94, 81920
    s_nop 0
    buffer_load_dwordx4 v20, s[24:27], s92 offen offset:0 lds
    buffer_load_dwordx4 v21, s[24:27], s92 offen offset:1024 lds
    buffer_load_dwordx4 v22, s[24:27], s92 offen offset:2048 lds
    buffer_load_dwordx4 v23, s[24:27], s92 offen offset:3072 lds
    s_add_u32 m0, s95, 106496
    s_nop 0
    buffer_load_dwordx4 v24, s[28:31], s93 offen offset:0 lds
    buffer_load_dwordx4 v25, s[28:31], s93 offen offset:1024 lds
    s_add_u32 m0, s95, 114688
    s_nop 0
    buffer_load_dwordx4 v26, s[28:31], s93 offen offset:0 lds
    buffer_load_dwordx4 v27, s[28:31], s93 offen offset:1024 lds
    s_add_u32 m0, s95, 98304
    s_nop 0
    buffer_load_dwordx4 v28, s[28:31], s93 offen offset:0 lds
    buffer_load_dwordx4 v29, s[28:31], s93 offen offset:1024 lds
    s_lshl_b32 s12, s19, 2
    s_add_u32 s12, s12, s21
    s_lshl_b32 s12, s12, 10
    s_lshl_b32 s13, s21, 10
    s_add_u32 m0, s13, 155648
    s_nop 0
    buffer_load_dwordx4 v5, s[76:79], s12 offen lds
    s_lshl_b32 s12, s22, 11
    buffer_load_dwordx4 v[40:43], v5, s[24:27], s12 offen offset:0
    buffer_load_dwordx4 v[44:47], v5, s[24:27], s12 offen offset:1024
    buffer_load_dwordx4 v[48:51], v5, s[24:27], s12 offen offset:2048
    buffer_load_dwordx4 v[52:55], v5, s[24:27], s12 offen offset:3072
    buffer_load_dwordx4 v[56:59], v5, s[80:83], 0 offen offset:0
    buffer_load_dwordx4 v[60:63], v5, s[80:83], 0 offen offset:1024
    buffer_load_dwordx4 v[64:67], v5, s[84:87], 0 offen offset:0
    buffer_load_dwordx4 v[68:71], v5, s[84:87], 0 offen offset:1024
    s_cmp_ge_u32 s10, 224
    s_cbranch_scc1 L_p30_0
    s_add_u32 s12, s71, 0
    buffer_load_dwordx4 v[128:131], v30, s[40:43], s12 offen nt
    s_add_u32 s12, s71, 7168
    buffer_load_dwordx4 v[132:135], v30, s[40:43], s12 offen nt
    s_add_u32 s12, s71, 14336
    buffer_load_dwordx4 v[136:139], v30, s[40:43], s12 offen nt
    s_add_u32 s12, s71, 21504
    buffer_load_dwordx4 v[140:143], v30, s[40:43], s12 offen nt
    s_add_u32 s12, s71, 28672
    buffer_load_dwordx4 v[144:147], v30, s[40:43], s12 offen nt
    s_add_u32 s12, s71, 35840
    buffer_load_dwordx4 v[148:151], v30, s[40:43], s12 offen nt
    s_add_u32 s12, s71, 43008
    buffer_load_dwordx4 v[152:155], v30, s[40:43], s12 offen nt
    s_add_u32 s12, s71, 50176
    buffer_load_dwordx4 v[156:159], v30, s[40:43], s12 offen nt
    s_branch L_p3e0_0
L_p30_0:
    s_mov_b64 exec, 63
    s_bfe_u32 s12, s68, 0x4000c
    s_mul_i32 s12, s12, 393216
    buffer_load_dword v128, v32, s[28:31], s12 offen
    s_bfe_u32 s12, s68, 0x40010
    s_mul_i32 s12, s12, 393216
    buffer_load_dword v132, v32, s[28:31], s12 offen
    s_bfe_u32 s12, s68, 0x40014
    s_mul_i32 s12, s12, 393216
    buffer_load_dword v136, v32, s[28:31], s12 offen
    s_bfe_u32 s12, s68, 0x40018
    s_mul_i32 s12, s12, 393216
    buffer_load_dword v140, v32, s[28:31], s12 offen
    s_bfe_u32 s12, s68, 0x4001c
    s_mul_i32 s12, s12, 393216
    buffer_load_dword v144, v32, s[28:31], s12 offen
    s_bfe_u32 s12, s69, 0x40000
    s_mul_i32 s12, s12, 393216
    buffer_load_dword v148, v32, s[28:31], s12 offen
    s_bfe_u32 s12, s69, 0x40004
    s_mul_i32 s12, s12, 393216
    buffer_load_dword v152, v32, s[28:31], s12 offen
    s_bfe_u32 s12, s69, 0x40008
    s_mul_i32 s12, s12, 393216
    buffer_load_dword v156, v32, s[28:31], s12 offen
    s_mov_b64 exec, -1
L_p3e0_0:
    s_waitcnt vmcnt(27)
    s_barrier
    s_bfe_u32 s91, s68, 0x4000c
    s_lshl_b32 s92, s91, 7
    s_mul_i32 s93, s91, 393216
    s_add_u32 m0, s94, 0
    s_nop 0
    buffer_load_dwordx4 v20, s[24:27], s92 offen offset:0 lds
    s_waitcnt vmcnt(9)
    s_mov_b32 s8, 0xffff0000
    v_lshlrev_b32 v72, 16, v56
    v_and_b32 v56, s8, v56
    v_lshlrev_b32 v73, 16, v64
    v_and_b32 v64, s8, v64
    v_lshlrev_b32 v112, 16, v40
    buffer_load_dwordx4 v21, s[24:27], s92 offen offset:1024 lds
    v_and_b32 v40, s8, v40
    v_lshlrev_b32 v116, 16, v48
    v_and_b32 v48, s8, v48
    v_mul_f32 v113, v112, v73
    v_mul_f32 v114, v40, v64
    v_mul_f32 v90, v112, v72
    v_mul_f32 v117, v116, v73
    buffer_load_dwordx4 v22, s[24:27], s92 offen offset:2048 lds
    v_mul_f32 v118, v48, v64
    v_mul_f32 v92, v116, v72
    v_cvt_pk_bf16_f32 v113, 0, v113
    v_cvt_pk_bf16_f32 v114, 0, v114
    v_fmac_f32 v90, v40, v56
    v_cvt_pk_bf16_f32 v117, 0, v117
    v_cvt_pk_bf16_f32 v118, 0, v118
    buffer_load_dwordx4 v23, s[24:27], s92 offen offset:3072 lds
    v_fmac_f32 v92, v48, v56
    v_add_f32 v91, v113, v114
    v_add_f32 v93, v117, v118
    v_lshlrev_b32 v72, 16, v57
    v_and_b32 v57, s8, v57
    v_lshlrev_b32 v73, 16, v65
    v_and_b32 v65, s8, v65
    s_add_u32 m0, s95, 24576
    s_nop 0
    buffer_load_dwordx4 v24, s[28:31], s93 offen offset:0 lds
    v_lshlrev_b32 v112, 16, v41
    v_and_b32 v41, s8, v41
    v_lshlrev_b32 v116, 16, v49
    v_and_b32 v49, s8, v49
    v_mul_f32 v113, v112, v73
    v_mul_f32 v114, v41, v65
    v_fmac_f32 v90, v112, v72
    s_cmp_lg_u32 s21, 0
    s_cbranch_scc1 L_noclr_0
    v_mov_b32 v104, -1
    v_mov_b32 v105, -1
    v_mov_b32 v106, -1
    v_mov_b32 v107, -1
    s_lshl_b32 s12, s19, 13
    s_lshl_b32 s13, s18, 9
    s_add_u32 s12, s12, s13
    s_add_u32 s12, s12, 32768
    s_lshl_b32 s13, s19, 11
    s_lshl_b32 s90, s18, 7
    s_add_u32 s13, s13, s90
    s_add_u32 s13, s13, 163840
    s_mov_b32 exec_hi, 0
    buffer_store_dwordx4 v[104:107], v5, s[32:35], s12 offen sc1
    s_mov_b32 exec_lo, 255
    buffer_store_dwordx4 v[104:107], v5, s[32:35], s13 offen sc1
    s_mov_b64 exec, -1
L_noclr_0:
    v_mul_f32 v117, v116, v73
    v_mul_f32 v118, v49, v65
    v_fmac_f32 v92, v116, v72
    v_cvt_pk_bf16_f32 v113, 0, v113
    v_cvt_pk_bf16_f32 v114, 0, v114
    v_fmac_f32 v90, v41, v57
    v_cvt_pk_bf16_f32 v117, 0, v117
    v_cvt_pk_bf16_f32 v118, 0, v118
    v_fmac_f32 v92, v49, v57
    v_add_f32 v91, v91, v113
    v_add_f32 v93, v93, v117
    v_add_f32 v91, v91, v114
    v_add_f32 v93, v93, v118
    v_lshlrev_b32 v72, 16, v58
    v_and_b32 v58, s8, v58
    v_lshlrev_b32 v73, 16, v66
    v_and_b32 v66, s8, v66
    v_lshlrev_b32 v112, 16, v42
    v_and_b32 v42, s8, v42
    v_lshlrev_b32 v116, 16, v50
    v_and_b32 v50, s8, v50
    v_mul_f32 v113, v112, v73
    v_mul_f32 v114, v42, v66
    v_fmac_f32 v90, v112, v72
    v_mul_f32 v117, v116, v73
    s_barrier
    s_add_u32 m0, s95, 24576
    s_nop 0
    buffer_load_dwordx4 v25, s[28:31], s93 offen offset:1024 lds
    v_mul_f32 v118, v50, v66
    v_fmac_f32 v92, v116, v72
    v_cvt_pk_bf16_f32 v113, 0, v113
    v_cvt_pk_bf16_f32 v114, 0, v114
    v_fmac_f32 v90, v42, v58
    v_cvt_pk_bf16_f32 v117, 0, v117
    v_cvt_pk_bf16_f32 v118, 0, v118
    s_add_u32 m0, s95, 32768
    s_nop 0
    buffer_load_dwordx4 v26, s[28:31], s93 offen offset:0 lds
    v_fmac_f32 v92, v50, v58
    v_add_f32 v91, v91, v113
    v_add_f32 v93, v93, v117
    v_add_f32 v91, v91, v114
    v_add_f32 v93, v93, v118
    v_lshlrev_b32 v72, 16, v59
    v_and_b32 v59, s8, v59
    buffer_load_dwordx4 v27, s[28:31], s93 offen offset:1024 lds
    v_lshlrev_b32 v73, 16, v67
    v_and_b32 v67, s8, v67
    v_lshlrev_b32 v112, 16, v43
    v_and_b32 v43, s8, v43
    v_lshlrev_b32 v116, 16, v51
    v_and_b32 v51, s8, v51
    v_mul_f32 v113, v112, v73
    s_add_u32 m0, s95, 16384
    s_nop 0
    buffer_load_dwordx4 v28, s[28:31], s93 offen offset:0 lds
    v_mul_f32 v114, v43, v67
    v_fmac_f32 v90, v112, v72
    v_mul_f32 v117, v116, v73
    v_mul_f32 v118, v51, v67
    v_fmac_f32 v92, v116, v72
    v_cvt_pk_bf16_f32 v113, 0, v113
    v_cvt_pk_bf16_f32 v114, 0, v114
    buffer_load_dwordx4 v29, s[28:31], s93 offen offset:1024 lds
    v_fmac_f32 v90, v43, v59
    v_cvt_pk_bf16_f32 v117, 0, v117
    v_cvt_pk_bf16_f32 v118, 0, v118
    v_fmac_f32 v92, v51, v59
    v_add_f32 v91, v91, v113
    v_add_f32 v93, v93, v117
    v_add_f32 v91, v91, v114
    s_bfe_u32 s91, s68, 0x40010
    s_lshl_b32 s92, s91, 7
    s_mul_i32 s93, s91, 393216
    s_add_u32 m0, s94, 40960
    s_nop 0
    buffer_load_dwordx4 v20, s[24:27], s92 offen offset:0 lds
    v_add_f32 v93, v93, v118
    v_lshlrev_b32 v72, 16, v60
    v_and_b32 v60, s8, v60
    v_lshlrev_b32 v73, 16, v68
    v_and_b32 v68, s8, v68
    v_lshlrev_b32 v112, 16, v44
    v_and_b32 v44, s8, v44
    buffer_load_dwordx4 v21, s[24:27], s92 offen offset:1024 lds
    v_lshlrev_b32 v116, 16, v52
    v_and_b32 v52, s8, v52
    v_mul_f32 v113, v112, v73
    v_mul_f32 v114, v44, v68
    v_fmac_f32 v90, v112, v72
    v_mul_f32 v117, v116, v73
    v_mul_f32 v118, v52, v68
    buffer_load_dwordx4 v22, s[24:27], s92 offen offset:2048 lds
    v_fmac_f32 v92, v116, v72
    v_cvt_pk_bf16_f32 v113, 0, v113
    v_cvt_pk_bf16_f32 v114, 0, v114
    v_fmac_f32 v90, v44, v60
    v_cvt_pk_bf16_f32 v117, 0, v117
    v_cvt_pk_bf16_f32 v118, 0, v118
    v_fmac_f32 v92, v52, v60
    buffer_load_dwordx4 v23, s[24:27], s92 offen offset:3072 lds
    v_add_f32 v91, v91, v113
    v_add_f32 v93, v93, v117
    v_add_f32 v91, v91, v114
    v_add_f32 v93, v93, v118
    v_lshlrev_b32 v72, 16, v61
    v_and_b32 v61, s8, v61
    v_lshlrev_b32 v73, 16, v69
    s_add_u32 m0, s95, 65536
    s_nop 0
    buffer_load_dwordx4 v24, s[28:31], s93 offen offset:0 lds
    v_and_b32 v69, s8, v69
    v_lshlrev_b32 v112, 16, v45
    v_and_b32 v45, s8, v45
    v_lshlrev_b32 v116, 16, v53
    v_and_b32 v53, s8, v53
    v_mul_f32 v113, v112, v73
    v_mul_f32 v114, v45, v69
    buffer_load_dwordx4 v25, s[28:31], s93 offen offset:1024 lds
    v_fmac_f32 v90, v112, v72
    v_mul_f32 v117, v116, v73
    v_mul_f32 v118, v53, v69
    v_fmac_f32 v92, v116, v72
    v_cvt_pk_bf16_f32 v113, 0, v113
    v_cvt_pk_bf16_f32 v114, 0, v114
    v_fmac_f32 v90, v45, v61
    s_add_u32 m0, s95, 73728
    s_nop 0
    buffer_load_dwordx4 v26, s[28:31], s93 offen offset:0 lds
    v_cvt_pk_bf16_f32 v117, 0, v117
    v_cvt_pk_bf16_f32 v118, 0, v118
    v_fmac_f32 v92, v53, v61
    v_add_f32 v91, v91, v113
    v_add_f32 v93, v93, v117
    v_add_f32 v91, v91, v114
    v_add_f32 v93, v93, v118
    buffer_load_dword v15, v13, s[72:75], 0 offen offset:4 sc1
    v_lshlrev_b32 v72, 16, v62
    v_and_b32 v62, s8, v62
    v_lshlrev_b32 v73, 16, v70
    v_and_b32 v70, s8, v70
    v_lshlrev_b32 v112, 16, v46
    v_and_b32 v46, s8, v46
    v_lshlrev_b32 v116, 16, v54
    v_and_b32 v54, s8, v54
    v_mul_f32 v113, v112, v73
    v_mul_f32 v114, v46, v70
    v_fmac_f32 v90, v112, v72
    v_mul_f32 v117, v116, v73
    v_mul_f32 v118, v54, v70
    v_fmac_f32 v92, v116, v72
    v_cvt_pk_bf16_f32 v113, 0, v113
    v_cvt_pk_bf16_f32 v114, 0, v114
    v_fmac_f32 v90, v46, v62
    v_cvt_pk_bf16_f32 v117, 0, v117
    v_cvt_pk_bf16_f32 v118, 0, v118
    v_fmac_f32 v92, v54, v62
    v_add_f32 v91, v91, v113
    v_add_f32 v93, v93, v117
    v_add_f32 v91, v91, v114
    v_add_f32 v93, v93, v118
    v_lshlrev_b32 v72, 16, v63
    s_waitcnt vmcnt(8)
    s_barrier
    s_add_u32 m0, s95, 73728
    s_nop 0
    buffer_load_dwordx4 v27, s[28:31], s93 offen offset:1024 lds
    v_and_b32 v63, s8, v63
    v_lshlrev_b32 v73, 16, v71
    v_and_b32 v71, s8, v71
    v_lshlrev_b32 v112, 16, v47
    v_and_b32 v47, s8, v47
    v_lshlrev_b32 v116, 16, v55
    v_and_b32 v55, s8, v55
    s_add_u32 m0, s95, 57344
    s_nop 0
    buffer_load_dwordx4 v28, s[28:31], s93 offen offset:0 lds
    v_mul_f32 v113, v112, v73
    v_mul_f32 v114, v47, v71
    v_fmac_f32 v90, v112, v72
    v_mul_f32 v117, v116, v73
    v_mul_f32 v118, v55, v71
    v_fmac_f32 v92, v116, v72
    v_cvt_pk_bf16_f32 v113, 0, v113
    buffer_load_dwordx4 v29, s[28:31], s93 offen offset:1024 lds
    v_cvt_pk_bf16_f32 v114, 0, v114
    v_fmac_f32 v90, v47, v63
    v_cvt_pk_bf16_f32 v117, 0, v117
    v_cvt_pk_bf16_f32 v118, 0, v118
    v_fmac_f32 v92, v55, v63
    v_add_f32 v91, v91, v113
    v_add_f32 v93, v93, v117
    s_bfe_u32 s91, s68, 0x40014
    s_lshl_b32 s92, s91, 7
    s_mul_i32 s93, s91, 393216
    s_add_u32 m0, s94, 81920
    s_nop 0
    buffer_load_dwordx4 v20, s[24:27], s92 offen offset:0 lds
    v_add_f32 v91, v91, v114
    v_add_f32 v93, v93, v118
    v_add_f32_dpp v90, v90, v90 row_shr:1 row_mask:0xf bank_mask:0xf
    v_add_f32_dpp v91, v91, v91 row_shr:1 row_mask:0xf bank_mask:0xf
    v_add_f32_dpp v92, v92, v92 row_shr:1 row_mask:0xf bank_mask:0xf
    v_add_f32_dpp v93, v93, v93 row_shr:1 row_mask:0xf bank_mask:0xf
    v_add_f32_dpp v90, v90, v90 row_shr:2 row_mask:0xf bank_mask:0xf
    buffer_load_dwordx4 v21, s[24:27], s92 offen offset:1024 lds
    v_add_f32_dpp v91, v91, v91 row_shr:2 row_mask:0xf bank_mask:0xf
    v_add_f32_dpp v92, v92, v92 row_shr:2 row_mask:0xf bank_mask:0xf
    v_add_f32_dpp v93, v93, v93 row_shr:2 row_mask:0xf bank_mask:0xf
    v_add_f32_dpp v90, v90, v90 row_shr:4 row_mask:0xf bank_mask:0xf
    v_add_f32_dpp v91, v91, v91 row_shr:4 row_mask:0xf bank_mask:0xf
    v_add_f32_dpp v92, v92, v92 row_shr:4 row_mask:0xf bank_mask:0xf
    v_add_f32_dpp v93, v93, v93 row_shr:4 row_mask:0xf bank_mask:0xf
    buffer_load_dwordx4 v22, s[24:27], s92 offen offset:2048 lds
    v_add_f32_dpp v90, v90, v90 row_shr:8 row_mask:0xf bank_mask:0xf
    v_add_f32_dpp v91, v91, v91 row_shr:8 row_mask:0xf bank_mask:0xf
    v_add_f32_dpp v92, v92, v92 row_shr:8 row_mask:0xf bank_mask:0xf
    v_add_f32_dpp v93, v93, v93 row_shr:8 row_mask:0xf bank_mask:0xf
    v_add_f32_dpp v90, v90, v90 row_bcast:15 row_mask:0xa bank_mask:0xf
    v_add_f32_dpp v91, v91, v91 row_bcast:15 row_mask:0xa bank_mask:0xf
    v_add_f32_dpp v92, v92, v92 row_bcast:15 row_mask:0xa bank_mask:0xf
    buffer_load_dwordx4 v23, s[24:27], s92 offen offset:3072 lds
    v_add_f32_dpp v93, v93, v93 row_bcast:15 row_mask:0xa bank_mask:0xf
    v_add_f32_dpp v90, v90, v90 row_bcast:31 row_mask:0xc bank_mask:0xf
    v_add_f32_dpp v91, v91, v91 row_bcast:31 row_mask:0xc bank_mask:0xf
    v_add_f32_dpp v92, v92, v92 row_bcast:31 row_mask:0xc bank_mask:0xf
    v_add_f32_dpp v93, v93, v93 row_bcast:31 row_mask:0xc bank_mask:0xf
    v_mov_b32 v97, 0x8000
    v_mov_b32 v98, 0xffff
    s_add_u32 m0, s95, 106496
    s_nop 0
    buffer_load_dwordx4 v24, s[28:31], s93 offen offset:0 lds
    v_cvt_pk_bf16_f32 v94, v90, v91
    v_cvt_pk_bf16_f32 v104, v92, v93
    v_and_b32 v95, 0xffff, v94
    v_and_b32 v96, 0x8000, v94
    v_and_b32 v94, 0xffff0000, v94
    v_cmp_ne_u32 vcc, 0, v96
    v_mul_f32 v94, 0xbfb8aa3b, v94
    buffer_load_dwordx4 v25, s[28:31], s93 offen offset:1024 lds
    v_exp_f32 v94, v94
    v_cndmask_b32 v96, v97, v98, vcc
    v_xor_b32 v95, v95, v96
    v_add_f32 v94, 1.0, v94
    v_lshlrev_b32 v95, 11, v95
    v_rcp_f32 v94, v94
    s_sub_u32 s12, 2047, s22
    v_or_b32 v100, s12, v95
    s_add_u32 m0, s95, 114688
    s_nop 0
    buffer_load_dwordx4 v26, s[28:31], s93 offen offset:0 lds
    v_cvt_pk_bf16_f32 v94, v94, v94
    v_lshlrev_b32 v102, 16, v94
    v_and_b32 v105, 0xffff, v104
    v_and_b32 v106, 0x8000, v104
    v_and_b32 v104, 0xffff0000, v104
    v_cmp_ne_u32 vcc, 0, v106
    v_mul_f32 v104, 0xbfb8aa3b, v104
    buffer_load_dwordx4 v27, s[28:31], s93 offen offset:1024 lds
    v_exp_f32 v104, v104
    v_cndmask_b32 v106, v97, v98, vcc
    v_xor_b32 v105, v105, v106
    v_add_f32 v104, 1.0, v104
    v_lshlrev_b32 v105, 11, v105
    v_rcp_f32 v104, v104
    s_sub_u32 s12, 2046, s22
    v_or_b32 v101, s12, v105
    s_add_u32 m0, s95, 98304
    s_nop 0
    buffer_load_dwordx4 v28, s[28:31], s93 offen offset:0 lds
    v_cvt_pk_bf16_f32 v104, v104, v104
    v_lshlrev_b32 v103, 16, v104
    v_max_u32 v100, v100, v101
    s_lshl_b32 s12, s22, 2
    s_add_u32 s12, s12, 4096
    s_lshl_b32 s13, s21, 2
    s_add_u32 s13, s13, 162880
    v_mov_b32 v14, s13
    s_mov_b32 exec_lo, 0
    s_mov_b32 exec_hi, 0x80000000
    buffer_store_dwordx2 v[102:103], v13, s[32:35], s12 offen sc1
    ds_write_b32 v14, v100
    s_mov_b64 exec, -1
    s_waitcnt lgkmcnt(0)
    s_waitcnt vmcnt(10)
    s_barrier
    s_add_u32 m0, s95, 98304
    s_nop 0
    buffer_load_dwordx4 v29, s[28:31], s93 offen offset:1024 lds
    s_bfe_u32 s91, s68, 0x40018
    s_lshl_b32 s92, s91, 7
    s_mul_i32 s93, s91, 393216
    s_add_u32 m0, s94, 0
    s_nop 0
    buffer_load_dwordx4 v20, s[24:27], s92 offen offset:0 lds
    buffer_load_dwordx4 v21, s[24:27], s92 offen offset:1024 lds
    buffer_load_dwordx4 v22, s[24:27], s92 offen offset:2048 lds
    buffer_load_dwordx4 v23, s[24:27], s92 offen offset:3072 lds
    s_add_u32 m0, s95, 24576
    s_nop 0
    buffer_load_dwordx4 v24, s[28:31], s93 offen offset:0 lds
    buffer_load_dwordx4 v25, s[28:31], s93 offen offset:1024 lds
    s_add_u32 m0, s95, 32768
    s_nop 0
    buffer_load_dwordx4 v26, s[28:31], s93 offen offset:0 lds
    buffer_load_dwordx4 v27, s[28:31], s93 offen offset:1024 lds
    s_add_u32 m0, s95, 16384
    s_nop 0
    buffer_load_dwordx4 v28, s[28:31], s93 offen offset:0 lds
    buffer_load_dwordx4 v29, s[28:31], s93 offen offset:1024 lds
    s_waitcnt vmcnt(11)
    s_waitcnt vmcnt(10)
    s_barrier
    s_bfe_u32 s91, s68, 0x4001c
    s_lshl_b32 s92, s91, 7
    s_mul_i32 s93, s91, 393216
    s_add_u32 m0, s94, 40960
    s_nop 0
    buffer_load_dwordx4 v20, s[24:27], s92 offen offset:0 lds
    buffer_load_dwordx4 v21, s[24:27], s92 offen offset:1024 lds
    buffer_load_dwordx4 v22, s[24:27], s92 offen offset:2048 lds
    buffer_load_dwordx4 v23, s[24:27], s92 offen offset:3072 lds
    s_add_u32 m0, s95, 65536
    s_nop 0
    buffer_load_dwordx4 v24, s[28:31], s93 offen offset:0 lds
    buffer_load_dwordx4 v25, s[28:31], s93 offen offset:1024 lds
    s_add_u32 m0, s95, 73728
    s_nop 0
    buffer_load_dwordx4 v26, s[28:31], s93 offen offset:0 lds
    buffer_load_dwordx4 v27, s[28:31], s93 offen offset:1024 lds
    s_add_u32 m0, s95, 57344
    s_nop 0
    buffer_load_dwordx4 v28, s[28:31], s93 offen offset:0 lds
    buffer_load_dwordx4 v29, s[28:31], s93 offen offset:1024 lds
    s_cmp_ge_u32 s10, 224
    s_cbranch_scc1 L_p31_0
    s_add_u32 s12, s9, 0
    buffer_load_dwordx4 v[160:163], v30, s[44:47], s12 offen nt
    s_add_u32 s12, s9, 7168
    buffer_load_dwordx4 v[164:167], v30, s[44:47], s12 offen nt
    s_add_u32 s12, s9, 14336
    buffer_load_dwordx4 v[168:171], v30, s[44:47], s12 offen nt
    s_add_u32 s12, s9, 21504
    buffer_load_dwordx4 v[172:175], v30, s[44:47], s12 offen nt
    s_add_u32 s12, s9, 28672
    buffer_load_dwordx4 v[176:179], v30, s[44:47], s12 offen nt
    s_add_u32 s12, s9, 35840
    buffer_load_dwordx4 v[180:183], v30, s[44:47], s12 offen nt
    s_add_u32 s12, s9, 43008
    buffer_load_dwordx4 v[184:187], v30, s[44:47], s12 offen nt
    s_add_u32 s12, s9, 50176
    buffer_load_dwordx4 v[188:191], v30, s[44:47], s12 offen nt
    s_branch L_p3e1_0
L_p31_0:
    s_mov_b64 exec, 63
    s_bfe_u32 s12, s69, 0x4000c
    s_mul_i32 s12, s12, 393216
    buffer_load_dword v160, v32, s[28:31], s12 offen
    s_bfe_u32 s12, s69, 0x40010
    s_mul_i32 s12, s12, 393216
    buffer_load_dword v164, v32, s[28:31], s12 offen
    s_bfe_u32 s12, s69, 0x40014
    s_mul_i32 s12, s12, 393216
    buffer_load_dword v168, v32, s[28:31], s12 offen
    s_bfe_u32 s12, s69, 0x40018
    s_mul_i32 s12, s12, 393216
    buffer_load_dword v172, v32, s[28:31], s12 offen
    s_bfe_u32 s12, s69, 0x4001c
    s_mul_i32 s12, s12, 393216
    buffer_load_dword v176, v32, s[28:31], s12 offen
    s_mov_b64 exec, 1
    s_bfe_u32 s12, s69, 0x4001c
    s_mul_i32 s12, s12, 393216
    buffer_load_dword v180, v32, s[28:31], s12 offen
    s_bfe_u32 s12, s69, 0x4001c
    s_mul_i32 s12, s12, 393216
    buffer_load_dword v184, v32, s[28:31], s12 offen
    s_bfe_u32 s12, s69, 0x4001c
    s_mul_i32 s12, s12, 393216
    buffer_load_dword v188, v32, s[28:31], s12 offen
    s_mov_b64 exec, -1
L_p3e1_0:
    s_mov_b32 exec_lo, 0xffff0000
    s_mov_b32 exec_hi, 0
    buffer_load_dword v19, v10, s[36:39], 0 offen
    s_mov_b64 exec, -1
    s_mov_b32 s13, 0
L_tagchk_0:
    v_readfirstlane_b32 s23, v15
    s_nop 1
    s_cmp_lg_u32 s23, 0
    s_cbranch_scc1 L_tagok_0
    s_add_u32 s13, s13, 1
    s_cmp_ge_u32 s13, 16384
    s_cbranch_scc1 L_tagok_0
    buffer_load_dword v15, v13, s[72:75], 0 offen offset:4 sc1
    s_waitcnt vmcnt(0)
    s_branch L_tagchk_0
L_tagok_0:
    s_and_b32 s76, s23, 0xff
    s_bfe_u32 s77, s23, 0x80008
    s_bfe_u32 s78, s23, 0x80010
    s_lshr_b32 s79, s23, 24
    v_and_b32 v35, 3, v2
    v_lshlrev_b32 v35, 3, v35
    v_bfe_u32 v35, s23, v35, 8
    s_cmp_lg_u32 s21, 0
    s_cbranch_scc1 L_nopub_0
    v_mov_b32 v14, 162880
    ds_read_b128 v[104:107], v14
    s_lshl_b32 s12, s2, 3
    s_add_u32 s12, s12, 0
    s_waitcnt lgkmcnt(0)
    v_max3_u32 v104, v104, v105, v106
    v_max_u32 v104, v104, v107
    v_mov_b32 v105, s23
    s_mov_b64 exec, 1
    buffer_store_dwordx2 v[104:105], v13, s[32:35], s12 offen sc1
    s_mov_b64 exec, -1
L_nopub_0:
    s_waitcnt vmcnt(19)
    s_barrier
    s_bfe_u32 s91, s69, 0x40000
    s_lshl_b32 s92, s91, 7
    s_mul_i32 s93, s91, 393216
    s_add_u32 m0, s94, 81920
    s_nop 0
    buffer_load_dwordx4 v20, s[24:27], s92 offen offset:0 lds
    buffer_load_dwordx4 v21, s[24:27], s92 offen offset:1024 lds
    buffer_load_dwordx4 v22, s[24:27], s92 offen offset:2048 lds
    buffer_load_dwordx4 v23, s[24:27], s92 offen offset:3072 lds
    s_add_u32 m0, s95, 106496
    s_nop 0
    buffer_load_dwordx4 v24, s[28:31], s93 offen offset:0 lds
    s_waitcnt vmcnt(14)
    s_barrier
    s_add_u32 m0, s95, 106496
    s_nop 0
    buffer_load_dwordx4 v25, s[28:31], s93 offen offset:1024 lds
    s_add_u32 m0, s95, 114688
    s_nop 0
    buffer_load_dwordx4 v26, s[28:31], s93 offen offset:0 lds
    buffer_load_dwordx4 v27, s[28:31], s93 offen offset:1024 lds
    s_add_u32 m0, s95, 98304
    s_nop 0
    buffer_load_dwordx4 v28, s[28:31], s93 offen offset:0 lds
    buffer_load_dwordx4 v29, s[28:31], s93 offen offset:1024 lds
    s_bfe_u32 s91, s69, 0x40004
    s_lshl_b32 s92, s91, 7
    s_mul_i32 s93, s91, 393216
    s_add_u32 m0, s94, 0
    s_nop 0
    buffer_load_dwordx4 v20, s[24:27], s92 offen offset:0 lds
    buffer_load_dwordx4 v21, s[24:27], s92 offen offset:1024 lds
    buffer_load_dwordx4 v22, s[24:27], s92 offen offset:2048 lds
    buffer_load_dwordx4 v23, s[24:27], s92 offen offset:3072 lds
    s_add_u32 m0, s95, 24576
    s_nop 0
    buffer_load_dwordx4 v24, s[28:31], s93 offen offset:0 lds
    buffer_load_dwordx4 v25, s[28:31], s93 offen offset:1024 lds
    s_add_u32 m0, s95, 32768
    s_nop 0
    buffer_load_dwordx4 v26, s[28:31], s93 offen offset:0 lds
    s_waitcnt vmcnt(7)
    s_barrier
    s_add_u32 m0, s95, 32768
    s_nop 0
    buffer_load_dwordx4 v27, s[28:31], s93 offen offset:1024 lds
    s_add_u32 m0, s95, 16384
    s_nop 0
    buffer_load_dwordx4 v28, s[28:31], s93 offen offset:0 lds
    buffer_load_dwordx4 v29, s[28:31], s93 offen offset:1024 lds
    s_bfe_u32 s91, s69, 0x40008
    s_lshl_b32 s92, s91, 7
    s_mul_i32 s93, s91, 393216
    s_add_u32 m0, s94, 40960
    s_nop 0
    buffer_load_dwordx4 v20, s[24:27], s92 offen offset:0 lds
    buffer_load_dwordx4 v21, s[24:27], s92 offen offset:1024 lds
    buffer_load_dwordx4 v22, s[24:27], s92 offen offset:2048 lds
    buffer_load_dwordx4 v23, s[24:27], s92 offen offset:3072 lds
    s_add_u32 m0, s95, 65536
    s_nop 0
    buffer_load_dwordx4 v24, s[28:31], s93 offen offset:0 lds
    buffer_load_dwordx4 v25, s[28:31], s93 offen offset:1024 lds
    s_add_u32 m0, s95, 73728
    s_nop 0
    buffer_load_dwordx4 v26, s[28:31], s93 offen offset:0 lds
    buffer_load_dwordx4 v27, s[28:31], s93 offen offset:1024 lds
    s_add_u32 m0, s95, 57344
    s_nop 0
    buffer_load_dwordx4 v28, s[28:31], s93 offen offset:0 lds
    s_waitcnt vmcnt(9)
    s_barrier
    s_add_u32 m0, s95, 57344
    s_nop 0
    buffer_load_dwordx4 v29, s[28:31], s93 offen offset:1024 lds
    s_bfe_u32 s91, s69, 0x4000c
    s_lshl_b32 s92, s91, 7
    s_mul_i32 s93, s91, 393216
    s_add_u32 m0, s94, 122880
    s_nop 0
    buffer_load_dwordx4 v20, s[24:27], s92 offen offset:0 lds
    buffer_load_dwordx4 v21, s[24:27], s92 offen offset:1024 lds
    buffer_load_dwordx4 v22, s[24:27], s92 offen offset:2048 lds
    buffer_load_dwordx4 v23, s[24:27], s92 offen offset:3072 lds
    s_add_u32 m0, s95, 106496
    s_nop 0
    buffer_load_dwordx4 v24, s[28:31], s93 offen offset:0 lds
    buffer_load_dwordx4 v25, s[28:31], s93 offen offset:1024 lds
    s_add_u32 m0, s95, 114688
    s_nop 0
    buffer_load_dwordx4 v26, s[28:31], s93 offen offset:0 lds
    buffer_load_dwordx4 v27, s[28:31], s93 offen offset:1024 lds
    s_mov_b32 s12, 0
    buffer_load_dwordx4 v[104:107], v5, s[32:35], s12 offen offset:0 sc1
    buffer_load_dwordx4 v[108:111], v5, s[32:35], s12 offen offset:1024 sc1
    s_waitcnt vmcnt(10)
    s_barrier
    s_bfe_u32 s91, s69, 0x40010
    s_lshl_b32 s92, s91, 7
    s_mul_i32 s93, s91, 393216
    s_add_u32 m0, s94, 139264
    s_nop 0
    buffer_load_dwordx4 v20, s[24:27], s92 offen offset:0 lds
    buffer_load_dwordx4 v21, s[24:27], s92 offen offset:1024 lds
    buffer_load_dwordx4 v22, s[24:27], s92 offen offset:2048 lds
    buffer_load_dwordx4 v23, s[24:27], s92 offen offset:3072 lds
    s_add_u32 m0, s95, 24576
    s_nop 0
    buffer_load_dwordx4 v24, s[28:31], s93 offen offset:0 lds
    buffer_load_dwordx4 v25, s[28:31], s93 offen offset:1024 lds
    s_add_u32 m0, s95, 32768
    s_nop 0
    buffer_load_dwordx4 v26, s[28:31], s93 offen offset:0 lds
    buffer_load_dwordx4 v27, s[28:31], s93 offen offset:1024 lds
    s_add_u32 s12, s97, 0
    buffer_load_dwordx4 v[192:195], v31, s[64:67], s12 offen nt
    s_add_u32 s12, s97, 16384
    buffer_load_dwordx4 v[196:199], v31, s[64:67], s12 offen nt
    s_add_u32 s12, s97, 32768
    buffer_load_dwordx4 v[200:203], v31, s[64:67], s12 offen nt
    s_add_u32 s12, s97, 49152
    buffer_load_dwordx4 v[204:207], v31, s[64:67], s12 offen nt
    s_add_u32 s12, s97, 65536
    buffer_load_dwordx4 v[208:211], v31, s[64:67], s12 offen nt
    s_add_u32 s12, s97, 81920
    buffer_load_dwordx4 v[212:215], v31, s[64:67], s12 offen nt
    s_add_u32 s12, s97, 98304
    buffer_load_dwordx4 v[216:219], v31, s[64:67], s12 offen nt
    s_waitcnt vmcnt(17)
    s_barrier
    s_bfe_u32 s91, s69, 0x40014
    s_lshl_b32 s92, s91, 7
    s_mul_i32 s93, s91, 393216
    s_add_u32 m0, s94, 40960
    s_nop 0
    buffer_load_dwordx4 v20, s[24:27], s92 offen offset:0 lds
    s_waitcnt vmcnt(16)
    s_mov_b32 s13, 0
    v_xor_b32 v105, s23, v105
    v_xor_b32 v107, s23, v107
    v_xor_b32 v109, s23, v109
    v_xor_b32 v111, s23, v111
    v_or3_b32 v105, v105, v107, v109
    v_or_b32 v105, v105, v111
    v_cmp_ne_u32 vcc, 0, v105
    s_cbranch_vccnz L_keyre_0
L_keyok_0:
    buffer_load_dwordx4 v21, s[24:27], s92 offen offset:1024 lds
    v_max3_u32 v104, v104, v106, v108
    v_max_u32 v104, v104, v110
    s_nop 1
    v_max_u32_dpp v104, v104, v104 row_shr:1 row_mask:0xf bank_mask:0xf
    s_nop 1
    v_max_u32_dpp v104, v104, v104 row_shr:2 row_mask:0xf bank_mask:0xf
    s_nop 1
    v_max_u32_dpp v104, v104, v104 row_shr:4 row_mask:0xf bank_mask:0xf
    s_nop 1
    v_max_u32_dpp v104, v104, v104 row_shr:8 row_mask:0xf bank_mask:0xf
    s_nop 1
    v_max_u32_dpp v104, v104, v104 row_bcast:15 row_mask:0xa bank_mask:0xf
    buffer_load_dwordx4 v22, s[24:27], s92 offen offset:2048 lds
    s_nop 0
    v_max_u32_dpp v104, v104, v104 row_bcast:31 row_mask:0xc bank_mask:0xf
    s_nop 0
    v_readlane_b32 s14, v104, 63
    s_nop 1
    s_and_b32 s15, s14, 2047
    s_sub_u32 s15, 2047, s15
    s_lshl_b32 s12, s15, 11
    s_lshl_b32 s13, s70, 1
    s_add_u32 s12, s12, s13
    buffer_load_dwordx4 v[36:39], v34, s[24:27], s12 offen
    s_lshr_b32 s12, s14, 11
    s_and_b32 s13, s12, 0x8000
    s_cmp_lg_u32 s13, 0
    s_mov_b32 s13, 0xffff
    s_cselect_b32 s13, 0x8000, s13
    s_xor_b32 s12, s12, s13
    s_lshl_b32 s12, s12, 16
    v_mov_b32 v105, s12
    buffer_load_dwordx4 v23, s[24:27], s92 offen offset:3072 lds
    v_mul_f32 v105, 0xbfb8aa3b, v105
    v_exp_f32 v105, v105
    s_nop 0
    v_add_f32 v105, 1.0, v105
    v_rcp_f32 v105, v105
    s_nop 0
    v_cvt_pk_bf16_f32 v105, v105, v105
    v_lshlrev_b32 v105, 16, v105
    s_add_u32 s12, s15, 1
    v_mov_b32 v104, s12
    s_add_u32 m0, s95, 65536
    s_nop 0
    buffer_load_dwordx4 v24, s[28:31], s93 offen offset:0 lds
    v_mov_b32 v106, s23
    v_readfirstlane_b32 s14, v105
    v_mov_b32 v14, 162864
    s_mov_b64 exec, 1
    ds_write_b96 v14, v[104:106]
    s_mov_b64 exec, -1
    s_waitcnt lgkmcnt(0)
    s_waitcnt vmcnt(13)
    s_barrier
    s_add_u32 m0, s95, 65536
    s_nop 0
    buffer_load_dwordx4 v25, s[28:31], s93 offen offset:1024 lds
    s_waitcnt vmcnt(3)
    s_mov_b32 s8, 0xffff0000
    v_lshlrev_b32 v40, 16, v36
    v_and_b32 v41, s8, v36
    v_lshlrev_b32 v42, 16, v37
    v_and_b32 v43, s8, v37
    v_lshlrev_b32 v44, 16, v38
    s_add_u32 m0, s95, 73728
    s_nop 0
    buffer_load_dwordx4 v26, s[28:31], s93 offen offset:0 lds
    v_and_b32 v45, s8, v38
    v_lshlrev_b32 v46, 16, v39
    v_and_b32 v47, s8, v39
    v_lshlrev_b32 v48, 16, v128
    v_lshlrev_b32 v49, 16, v129
    v_and_b32 v128, s8, v128
    v_and_b32 v129, s8, v129
    v_mul_f32 v220, v48, v40
    v_mul_f32 v222, v49, v40
    v_mul_f32 v221, v128, v40
    v_mul_f32 v223, v129, v40
    v_lshlrev_b32 v50, 16, v130
    v_lshlrev_b32 v51, 16, v131
    v_and_b32 v130, s8, v130
    buffer_load_dwordx4 v27, s[28:31], s93 offen offset:1024 lds
    v_and_b32 v131, s8, v131
    v_mul_f32 v224, v50, v40
    v_mul_f32 v226, v51, v40
    v_mul_f32 v225, v130, v40
    v_mul_f32 v227, v131, v40
    v_lshlrev_b32 v48, 16, v160
    v_lshlrev_b32 v49, 16, v161
    v_and_b32 v160, s8, v160
    v_and_b32 v161, s8, v161
    v_mul_f32 v228, v48, v40
    v_mul_f32 v230, v49, v40
    v_mul_f32 v229, v160, v40
    v_mul_f32 v231, v161, v40
    v_lshlrev_b32 v50, 16, v162
    s_bfe_u32 s91, s69, 0x40018
    s_lshl_b32 s92, s91, 7
    s_mul_i32 s93, s91, 393216
    s_add_u32 m0, s94, 81920
    s_nop 0
    buffer_load_dwordx4 v20, s[24:27], s92 offen offset:0 lds
    v_lshlrev_b32 v51, 16, v163
    v_and_b32 v162, s8, v162
    v_and_b32 v163, s8, v163
    v_mul_f32 v232, v50, v40
    v_mul_f32 v234, v51, v40
    v_mul_f32 v233, v162, v40
    v_mul_f32 v235, v163, v40
    buffer_load_dwordx4 v21, s[24:27], s92 offen offset:1024 lds
    v_lshlrev_b32 v48, 16, v132
    v_lshlrev_b32 v49, 16, v133
    v_and_b32 v132, s8, v132
    v_and_b32 v133, s8, v133
    v_fmac_f32 v220, v48, v41
    v_fmac_f32 v222, v49, v41
    v_fmac_f32 v221, v132, v41
    buffer_load_dwordx4 v22, s[24:27], s92 offen offset:2048 lds
    v_fmac_f32 v223, v133, v41
    v_lshlrev_b32 v50, 16, v134
    v_lshlrev_b32 v51, 16, v135
    v_and_b32 v134, s8, v134
    v_and_b32 v135, s8, v135
    v_fmac_f32 v224, v50, v41
    v_fmac_f32 v226, v51, v41
    buffer_load_dwordx4 v23, s[24:27], s92 offen offset:3072 lds
    v_fmac_f32 v225, v134, v41
    v_fmac_f32 v227, v135, v41
    v_lshlrev_b32 v48, 16, v164
    v_lshlrev_b32 v49, 16, v165
    v_and_b32 v164, s8, v164
    v_and_b32 v165, s8, v165
    v_fmac_f32 v228, v48, v41
    s_add_u32 m0, s95, 106496
    s_nop 0
    buffer_load_dwordx4 v24, s[28:31], s93 offen offset:0 lds
    v_fmac_f32 v230, v49, v41
    v_fmac_f32 v229, v164, v41
    v_fmac_f32 v231, v165, v41
    v_lshlrev_b32 v50, 16, v166
    v_lshlrev_b32 v51, 16, v167
    v_and_b32 v166, s8, v166
    v_and_b32 v167, s8, v167
    buffer_load_dwordx4 v25, s[28:31], s93 offen offset:1024 lds
    v_fmac_f32 v232, v50, v41
    v_fmac_f32 v234, v51, v41
    v_fmac_f32 v233, v166, v41
    v_fmac_f32 v235, v167, v41
    v_lshlrev_b32 v48, 16, v136
    v_lshlrev_b32 v49, 16, v137
    v_and_b32 v136, s8, v136
    s_add_u32 m0, s95, 114688
    s_nop 0
    buffer_load_dwordx4 v26, s[28:31], s93 offen offset:0 lds
    v_and_b32 v137, s8, v137
    v_fmac_f32 v220, v48, v42
    v_fmac_f32 v222, v49, v42
    v_fmac_f32 v221, v136, v42
    v_fmac_f32 v223, v137, v42
    v_lshlrev_b32 v50, 16, v138
    v_lshlrev_b32 v51, 16, v139
    v_and_b32 v138, s8, v138
    v_and_b32 v139, s8, v139
    v_fmac_f32 v224, v50, v42
    v_fmac_f32 v226, v51, v42
    v_fmac_f32 v225, v138, v42
    v_fmac_f32 v227, v139, v42
    v_lshlrev_b32 v48, 16, v168
    v_lshlrev_b32 v49, 16, v169
    v_and_b32 v168, s8, v168
    v_and_b32 v169, s8, v169
    v_fmac_f32 v228, v48, v42
    v_fmac_f32 v230, v49, v42
    v_fmac_f32 v229, v168, v42
    v_fmac_f32 v231, v169, v42
    v_lshlrev_b32 v50, 16, v170
    v_lshlrev_b32 v51, 16, v171
    v_and_b32 v170, s8, v170
    v_and_b32 v171, s8, v171
    v_fmac_f32 v232, v50, v42
    v_fmac_f32 v234, v51, v42
    v_fmac_f32 v233, v170, v42
    v_fmac_f32 v235, v171, v42
    v_lshlrev_b32 v48, 16, v140
    v_lshlrev_b32 v49, 16, v141
    v_and_b32 v140, s8, v140
    v_and_b32 v141, s8, v141
    v_fmac_f32 v220, v48, v43
    v_fmac_f32 v222, v49, v43
    v_fmac_f32 v221, v140, v43
    v_fmac_f32 v223, v141, v43
    v_lshlrev_b32 v50, 16, v142
    v_lshlrev_b32 v51, 16, v143
    s_waitcnt vmcnt(7)
    s_barrier
    s_add_u32 m0, s95, 114688
    s_nop 0
    buffer_load_dwordx4 v27, s[28:31], s93 offen offset:1024 lds
    v_and_b32 v142, s8, v142
    v_and_b32 v143, s8, v143
    v_fmac_f32 v224, v50, v43
    v_fmac_f32 v226, v51, v43
    v_fmac_f32 v225, v142, v43
    v_fmac_f32 v227, v143, v43
    v_lshlrev_b32 v48, 16, v172
    v_lshlrev_b32 v49, 16, v173
    v_and_b32 v172, s8, v172
    v_and_b32 v173, s8, v173
    v_fmac_f32 v228, v48, v43
    v_fmac_f32 v230, v49, v43
    v_fmac_f32 v229, v172, v43
    v_fmac_f32 v231, v173, v43
    s_bfe_u32 s91, s69, 0x4001c
    s_lshl_b32 s92, s91, 7
    s_mul_i32 s93, s91, 393216
    s_add_u32 m0, s94, 0
    s_nop 0
    buffer_load_dwordx4 v20, s[24:27], s92 offen offset:0 lds
    v_lshlrev_b32 v50, 16, v174
    v_lshlrev_b32 v51, 16, v175
    v_and_b32 v174, s8, v174
    v_and_b32 v175, s8, v175
    v_fmac_f32 v232, v50, v43
    v_fmac_f32 v234, v51, v43
    v_fmac_f32 v233, v174, v43
    buffer_load_dwordx4 v21, s[24:27], s92 offen offset:1024 lds
    v_fmac_f32 v235, v175, v43
    v_lshlrev_b32 v48, 16, v144
    v_lshlrev_b32 v49, 16, v145
    v_and_b32 v144, s8, v144
    v_and_b32 v145, s8, v145
    v_fmac_f32 v220, v48, v44
    v_fmac_f32 v222, v49, v44
    buffer_load_dwordx4 v22, s[24:27], s92 offen offset:2048 lds
    v_fmac_f32 v221, v144, v44
    v_fmac_f32 v223, v145, v44
    v_lshlrev_b32 v50, 16, v146
    v_lshlrev_b32 v51, 16, v147
    v_and_b32 v146, s8, v146
    v_and_b32 v147, s8, v147
    v_fmac_f32 v224, v50, v44
    buffer_load_dwordx4 v23, s[24:27], s92 offen offset:3072 lds
    v_fmac_f32 v226, v51, v44
    v_fmac_f32 v225, v146, v44
    v_fmac_f32 v227, v147, v44
    v_lshlrev_b32 v48, 16, v176
    v_lshlrev_b32 v49, 16, v177
    v_and_b32 v176, s8, v176
    v_and_b32 v177, s8, v177
    s_add_u32 m0, s95, 24576
    s_nop 0
    buffer_load_dwordx4 v24, s[28:31], s93 offen offset:0 lds
    v_fmac_f32 v228, v48, v44
    v_fmac_f32 v230, v49, v44
    v_fmac_f32 v229, v176, v44
    v_fmac_f32 v231, v177, v44
    v_lshlrev_b32 v50, 16, v178
    v_lshlrev_b32 v51, 16, v179
    v_and_b32 v178, s8, v178
    buffer_load_dwordx4 v25, s[28:31], s93 offen offset:1024 lds
    v_and_b32 v179, s8, v179
    v_fmac_f32 v232, v50, v44
    v_fmac_f32 v234, v51, v44
    v_fmac_f32 v233, v178, v44
    v_fmac_f32 v235, v179, v44
    v_lshlrev_b32 v48, 16, v148
    v_lshlrev_b32 v49, 16, v149
    s_add_u32 m0, s95, 32768
    s_nop 0
    buffer_load_dwordx4 v26, s[28:31], s93 offen offset:0 lds
    v_and_b32 v148, s8, v148
    v_and_b32 v149, s8, v149
    v_fmac_f32 v220, v48, v45
    v_fmac_f32 v222, v49, v45
    v_fmac_f32 v221, v148, v45
    v_fmac_f32 v223, v149, v45
    v_lshlrev_b32 v50, 16, v150
    v_lshlrev_b32 v51, 16, v151
    v_and_b32 v150, s8, v150
    v_and_b32 v151, s8, v151
    v_fmac_f32 v224, v50, v45
    v_fmac_f32 v226, v51, v45
    v_fmac_f32 v225, v150, v45
    v_fmac_f32 v227, v151, v45
    buffer_load_dwordx4 v27, s[28:31], s93 offen offset:1024 lds
    v_lshlrev_b32 v48, 16, v180
    v_lshlrev_b32 v49, 16, v181
    v_and_b32 v180, s8, v180
    v_and_b32 v181, s8, v181
    v_fmac_f32 v228, v48, v45
    v_fmac_f32 v230, v49, v45
    v_fmac_f32 v229, v180, v45
    v_fmac_f32 v231, v181, v45
    v_lshlrev_b32 v50, 16, v182
    v_lshlrev_b32 v51, 16, v183
    v_and_b32 v182, s8, v182
    v_and_b32 v183, s8, v183
    v_fmac_f32 v232, v50, v45
    v_fmac_f32 v234, v51, v45
    v_fmac_f32 v233, v182, v45
    v_fmac_f32 v235, v183, v45
    v_lshlrev_b32 v48, 16, v152
    v_lshlrev_b32 v49, 16, v153
    v_and_b32 v152, s8, v152
    v_and_b32 v153, s8, v153
    v_fmac_f32 v220, v48, v46
    v_fmac_f32 v222, v49, v46
    v_fmac_f32 v221, v152, v46
    v_fmac_f32 v223, v153, v46
    v_lshlrev_b32 v50, 16, v154
    v_lshlrev_b32 v51, 16, v155
    v_and_b32 v154, s8, v154
    v_and_b32 v155, s8, v155
    v_fmac_f32 v224, v50, v46
    v_fmac_f32 v226, v51, v46
    v_fmac_f32 v225, v154, v46
    v_fmac_f32 v227, v155, v46
    v_lshlrev_b32 v48, 16, v184
    v_lshlrev_b32 v49, 16, v185
    v_and_b32 v184, s8, v184
    v_and_b32 v185, s8, v185
    v_fmac_f32 v228, v48, v46
    v_fmac_f32 v230, v49, v46
    v_fmac_f32 v229, v184, v46
    s_waitcnt vmcnt(8)
    s_barrier
    s_bfe_u32 s12, s69, 0x4000c
    s_mul_i32 s12, s12, 393216
    s_add_u32 m0, s95, 16384
    s_nop 0
    buffer_load_dwordx4 v28, s[28:31], s12 offen offset:0 lds
    buffer_load_dwordx4 v29, s[28:31], s12 offen offset:1024 lds
    s_bfe_u32 s12, s69, 0x40010
    s_mul_i32 s12, s12, 393216
    s_add_u32 m0, s95, 57344
    s_nop 0
    buffer_load_dwordx4 v28, s[28:31], s12 offen offset:0 lds
    buffer_load_dwordx4 v29, s[28:31], s12 offen offset:1024 lds
    s_mul_i32 s12, s21, 16
    s_add_u32 s12, s12, 0
    s_and_b32 s90, s88, 1
    s_lshl_b32 s90, s90, 6
    s_xor_b32 s12, s12, s90
    s_lshl_b32 s12, s12, 14
    s_add_u32 s90, s12, 0
    buffer_load_dwordx4 v[84:87], v33, s[36:39], s90 offen
    s_add_u32 s90, s12, 16384
    buffer_load_dwordx4 v[88:91], v33, s[36:39], s90 offen
    s_add_u32 s90, s12, 32768
    buffer_load_dwordx4 v[92:95], v33, s[36:39], s90 offen
    s_add_u32 s90, s12, 49152
    buffer_load_dwordx4 v[96:99], v33, s[36:39], s90 offen
    s_add_u32 s90, s12, 65536
    buffer_load_dwordx4 v[100:103], v33, s[36:39], s90 offen
    s_add_u32 s90, s12, 81920
    buffer_load_dwordx4 v[116:119], v33, s[36:39], s90 offen
    s_add_u32 s90, s12, 98304
    buffer_load_dwordx4 v[120:123], v33, s[36:39], s90 offen
    s_add_u32 s90, s12, 114688
    buffer_load_dwordx4 v[124:127], v33, s[36:39], s90 offen
    s_add_u32 s90, s12, 131072
    buffer_load_dwordx4 v[64:67], v33, s[36:39], s90 offen
    v_fmac_f32 v231, v185, v46
    v_lshlrev_b32 v50, 16, v186
    v_lshlrev_b32 v51, 16, v187
    v_and_b32 v186, s8, v186
    v_and_b32 v187, s8, v187
    v_fmac_f32 v232, v50, v46
    v_fmac_f32 v234, v51, v46
    v_fmac_f32 v233, v186, v46
    v_fmac_f32 v235, v187, v46
    v_lshlrev_b32 v48, 16, v156
    v_lshlrev_b32 v49, 16, v157
    v_and_b32 v156, s8, v156
    v_and_b32 v157, s8, v157
    v_fmac_f32 v220, v48, v47
    v_fmac_f32 v222, v49, v47
    v_fmac_f32 v221, v156, v47
    v_fmac_f32 v223, v157, v47
    v_lshlrev_b32 v50, 16, v158
    v_lshlrev_b32 v51, 16, v159
    v_and_b32 v158, s8, v158
    v_and_b32 v159, s8, v159
    v_fmac_f32 v224, v50, v47
    v_fmac_f32 v226, v51, v47
    v_fmac_f32 v225, v158, v47
    v_fmac_f32 v227, v159, v47
    s_waitcnt vmcnt(13)
    s_barrier
    v_lshlrev_b32 v48, 16, v188
    v_lshlrev_b32 v49, 16, v189
    v_and_b32 v188, s8, v188
    v_and_b32 v189, s8, v189
    v_fmac_f32 v228, v48, v47
    v_fmac_f32 v230, v49, v47
    v_fmac_f32 v229, v188, v47
    v_fmac_f32 v231, v189, v47
    v_lshlrev_b32 v50, 16, v190
    v_lshlrev_b32 v51, 16, v191
    v_and_b32 v190, s8, v190
    v_and_b32 v191, s8, v191
    v_fmac_f32 v232, v50, v47
    v_fmac_f32 v234, v51, v47
    v_fmac_f32 v233, v190, v47
    v_fmac_f32 v235, v191, v47
    v_permlane32_swap_b32 v220, v228
    v_permlane32_swap_b32 v221, v229
    v_permlane32_swap_b32 v222, v230
    v_permlane32_swap_b32 v223, v231
    v_permlane32_swap_b32 v224, v232
    v_permlane32_swap_b32 v225, v233
    v_permlane32_swap_b32 v226, v234
    v_permlane32_swap_b32 v227, v235
    v_add_f32 v220, v220, v228
    v_add_f32 v221, v221, v229
    v_add_f32 v222, v222, v230
    v_add_f32 v223, v223, v231
    v_add_f32 v224, v224, v232
    v_add_f32 v225, v225, v233
    v_add_f32 v226, v226, v234
    v_add_f32 v227, v227, v235
    v_permlane16_swap_b32 v220, v224
    v_permlane16_swap_b32 v221, v225
    v_permlane16_swap_b32 v222, v226
    v_permlane16_swap_b32 v223, v227
    v_add_f32 v220, v220, v224
    v_add_f32 v221, v221, v225
    v_add_f32 v222, v222, v226
    v_add_f32 v223, v223, v227
    v_add_f32_dpp v220, v220, v220 row_ror:8 row_mask:0xf bank_mask:0xf
    v_add_f32_dpp v221, v221, v221 row_ror:8 row_mask:0xf bank_mask:0xf
    v_add_f32_dpp v222, v222, v222 row_ror:8 row_mask:0xf bank_mask:0xf
    v_add_f32_dpp v223, v223, v223 row_ror:8 row_mask:0xf bank_mask:0xf
    s_branch L_varend
L_var1:
    s_nop 0
    s_add_u32 m0, s95, 73728
    s_nop 0
    buffer_load_dwordx4 v26, s[28:31], s93 offen offset:0 lds
    buffer_load_dwordx4 v27, s[28:31], s93 offen offset:1024 lds
    s_add_u32 m0, s95, 57344
    s_nop 0
    buffer_load_dwordx4 v28, s[28:31], s93 offen offset:0 lds
    buffer_load_dwordx4 v29, s[28:31], s93 offen offset:1024 lds
    s_bfe_u32 s91, s68, 0x40008
    s_lshl_b32 s92, s91, 7
    s_mul_i32 s93, s91, 393216
    s_add_u32 m0, s94, 81920
    s_nop 0
    buffer_load_dwordx4 v20, s[24:27], s92 offen offset:0 lds
    buffer_load_dwordx4 v21, s[24:27], s92 offen offset:1024 lds
    buffer_load_dwordx4 v22, s[24:27], s92 offen offset:2048 lds
    buffer_load_dwordx4 v23, s[24:27], s92 offen offset:3072 lds
    s_add_u32 m0, s95, 106496
    s_nop 0
    buffer_load_dwordx4 v24, s[28:31], s93 offen offset:0 lds
    buffer_load_dwordx4 v25, s[28:31], s93 offen offset:1024 lds
    s_add_u32 m0, s95, 114688
    s_nop 0
    buffer_load_dwordx4 v26, s[28:31], s93 offen offset:0 lds
    buffer_load_dwordx4 v27, s[28:31], s93 offen offset:1024 lds
    s_add_u32 m0, s95, 98304
    s_nop 0
    buffer_load_dwordx4 v28, s[28:31], s93 offen offset:0 lds
    buffer_load_dwordx4 v29, s[28:31], s93 offen offset:1024 lds
    s_lshl_b32 s12, s19, 2
    s_add_u32 s12, s12, s21
    s_lshl_b32 s12, s12, 10
    s_lshl_b32 s13, s21, 10
    s_add_u32 m0, s13, 155648
    s_nop 0
    buffer_load_dwordx4 v5, s[76:79], s12 offen lds
    s_lshl_b32 s12, s22, 11
    buffer_load_dwordx4 v[40:43], v5, s[24:27], s12 offen offset:0
    buffer_load_dwordx4 v[44:47], v5, s[24:27], s12 offen offset:1024
    buffer_load_dwordx4 v[48:51], v5, s[24:27], s12 offen offset:2048
    buffer_load_dwordx4 v[52:55], v5, s[24:27], s12 offen offset:3072
    buffer_load_dwordx4 v[56:59], v5, s[80:83], 0 offen offset:0
    buffer_load_dwordx4 v[60:63], v5, s[80:83], 0 offen offset:1024
    buffer_load_dwordx4 v[64:67], v5, s[84:87], 0 offen offset:0
    buffer_load_dwordx4 v[68:71], v5, s[84:87], 0 offen offset:1024
    s_waitcnt vmcnt(19)
    s_barrier
    s_bfe_u32 s91, s68, 0x4000c
    s_lshl_b32 s92, s91, 7
    s_mul_i32 s93, s91, 393216
    s_add_u32 m0, s94, 0
    s_nop 0
    buffer_load_dwordx4 v20, s[24:27], s92 offen offset:0 lds
    s_waitcnt vmcnt(1)
    s_mov_b32 s8, 0xffff0000
    v_lshlrev_b32 v72, 16, v56
    v_and_b32 v56, s8, v56
    v_lshlrev_b32 v73, 16, v64
    v_and_b32 v64, s8, v64
    v_lshlrev_b32 v112, 16, v40
    buffer_load_dwordx4 v21, s[24:27], s92 offen offset:1024 lds
    v_and_b32 v40, s8, v40
    v_lshlrev_b32 v116, 16, v48
    v_and_b32 v48, s8, v48
    v_mul_f32 v113, v112, v73
    v_mul_f32 v114, v40, v64
    v_mul_f32 v90, v112, v72
    v_mul_f32 v117, v116, v73
    buffer_load_dwordx4 v22, s[24:27], s92 offen offset:2048 lds
    v_mul_f32 v118, v48, v64
    v_mul_f32 v92, v116, v72
    v_cvt_pk_bf16_f32 v113, 0, v113
    v_cvt_pk_bf16_f32 v114, 0, v114
    v_fmac_f32 v90, v40, v56
    v_cvt_pk_bf16_f32 v117, 0, v117
    v_cvt_pk_bf16_f32 v118, 0, v118
    buffer_load_dwordx4 v23, s[24:27], s92 offen offset:3072 lds
    v_fmac_f32 v92, v48, v56
    v_add_f32 v91, v113, v114
    v_add_f32 v93, v117, v118
    v_lshlrev_b32 v72, 16, v57
    v_and_b32 v57, s8, v57
    v_lshlrev_b32 v73, 16, v65
    v_and_b32 v65, s8, v65
    s_add_u32 m0, s95, 24576
    s_nop 0
    buffer_load_dwordx4 v24, s[28:31], s93 offen offset:0 lds
    v_lshlrev_b32 v112, 16, v41
    v_and_b32 v41, s8, v41
    v_lshlrev_b32 v116, 16, v49
    v_and_b32 v49, s8, v49
    v_mul_f32 v113, v112, v73
    v_mul_f32 v114, v41, v65
    v_fmac_f32 v90, v112, v72
    buffer_load_dwordx4 v25, s[28:31], s93 offen offset:1024 lds
    v_mul_f32 v117, v116, v73
    v_mul_f32 v118, v49, v65
    v_fmac_f32 v92, v116, v72
    v_cvt_pk_bf16_f32 v113, 0, v113
    v_cvt_pk_bf16_f32 v114, 0, v114
    v_fmac_f32 v90, v41, v57
    v_cvt_pk_bf16_f32 v117, 0, v117
    s_add_u32 m0, s95, 32768
    s_nop 0
    buffer_load_dwordx4 v26, s[28:31], s93 offen offset:0 lds
    v_cvt_pk_bf16_f32 v118, 0, v118
    v_fmac_f32 v92, v49, v57
    v_add_f32 v91, v91, v113
    v_add_f32 v93, v93, v117
    v_add_f32 v91, v91, v114
    v_add_f32 v93, v93, v118
    v_lshlrev_b32 v72, 16, v58
    buffer_load_dwordx4 v27, s[28:31], s93 offen offset:1024 lds
    v_and_b32 v58, s8, v58
    v_lshlrev_b32 v73, 16, v66
    v_and_b32 v66, s8, v66
    v_lshlrev_b32 v112, 16, v42
    v_and_b32 v42, s8, v42
    v_lshlrev_b32 v116, 16, v50
    v_and_b32 v50, s8, v50
    s_add_u32 m0, s95, 16384
    s_nop 0
    buffer_load_dwordx4 v28, s[28:31], s93 offen offset:0 lds
    v_mul_f32 v113, v112, v73
    v_mul_f32 v114, v42, v66
    v_fmac_f32 v90, v112, v72
    v_mul_f32 v117, v116, v73
    v_mul_f32 v118, v50, v66
    v_fmac_f32 v92, v116, v72
    v_cvt_pk_bf16_f32 v113, 0, v113
    buffer_load_dwordx4 v29, s[28:31], s93 offen offset:1024 lds
    v_cvt_pk_bf16_f32 v114, 0, v114
    v_fmac_f32 v90, v42, v58
    v_cvt_pk_bf16_f32 v117, 0, v117
    v_cvt_pk_bf16_f32 v118, 0, v118
    v_fmac_f32 v92, v50, v58
    v_add_f32 v91, v91, v113
    v_add_f32 v93, v93, v117
    s_cmp_lg_u32 s21, 0
    s_cbranch_scc1 L_noclr_1
    v_mov_b32 v104, -1
    v_mov_b32 v105, -1
    v_mov_b32 v106, -1
    v_mov_b32 v107, -1
    s_lshl_b32 s12, s19, 13
    s_lshl_b32 s13, s18, 9
    s_add_u32 s12, s12, s13
    s_add_u32 s12, s12, 32768
    s_lshl_b32 s13, s19, 11
    s_lshl_b32 s90, s18, 7
    s_add_u32 s13, s13, s90
    s_add_u32 s13, s13, 163840
    s_mov_b32 exec_hi, 0
    buffer_store_dwordx4 v[104:107], v5, s[32:35], s12 offen sc1
    s_mov_b32 exec_lo, 255
    buffer_store_dwordx4 v[104:107], v5, s[32:35], s13 offen sc1
    s_mov_b64 exec, -1
L_noclr_1:
    s_cmp_ge_u32 s10, 224
    s_cbranch_scc1 L_p30_1
    s_add_u32 s12, s71, 0
    buffer_load_dwordx4 v[128:131], v30, s[40:43], s12 offen nt
    s_add_u32 s12, s71, 7168
    buffer_load_dwordx4 v[132:135], v30, s[40:43], s12 offen nt
    s_add_u32 s12, s71, 14336
    buffer_load_dwordx4 v[136:139], v30, s[40:43], s12 offen nt
    s_add_u32 s12, s71, 21504
    buffer_load_dwordx4 v[140:143], v30, s[40:43], s12 offen nt
    s_add_u32 s12, s71, 28672
    buffer_load_dwordx4 v[144:147], v30, s[40:43], s12 offen nt
    s_add_u32 s12, s71, 35840
    buffer_load_dwordx4 v[148:151], v30, s[40:43], s12 offen nt
    s_add_u32 s12, s71, 43008
    buffer_load_dwordx4 v[152:155], v30, s[40:43], s12 offen nt
    s_add_u32 s12, s71, 50176
    buffer_load_dwordx4 v[156:159], v30, s[40:43], s12 offen nt
    s_branch L_p3e0_1
L_p30_1:
    s_mov_b64 exec, 63
    s_bfe_u32 s12, s68, 0x4000c
    s_mul_i32 s12, s12, 393216
    buffer_load_dword v128, v32, s[28:31], s12 offen
    s_bfe_u32 s12, s68, 0x40010
    s_mul_i32 s12, s12, 393216
    buffer_load_dword v132, v32, s[28:31], s12 offen
    s_bfe_u32 s12, s68, 0x40014
    s_mul_i32 s12, s12, 393216
    buffer_load_dword v136, v32, s[28:31], s12 offen
    s_bfe_u32 s12, s68, 0x40018
    s_mul_i32 s12, s12, 393216
    buffer_load_dword v140, v32, s[28:31], s12 offen
    s_bfe_u32 s12, s68, 0x4001c
    s_mul_i32 s12, s12, 393216
    buffer_load_dword v144, v32, s[28:31], s12 offen
    s_bfe_u32 s12, s69, 0x40000
    s_mul_i32 s12, s12, 393216
    buffer_load_dword v148, v32, s[28:31], s12 offen
    s_bfe_u32 s12, s69, 0x40004
    s_mul_i32 s12, s12, 393216
    buffer_load_dword v152, v32, s[28:31], s12 offen
    s_bfe_u32 s12, s69, 0x40008
    s_mul_i32 s12, s12, 393216
    buffer_load_dword v156, v32, s[28:31], s12 offen
    s_mov_b64 exec, -1
L_p3e0_1:
    v_add_f32 v91, v91, v114
    v_add_f32 v93, v93, v118
    v_lshlrev_b32 v72, 16, v59
    v_and_b32 v59, s8, v59
    v_lshlrev_b32 v73, 16, v67
    v_and_b32 v67, s8, v67
    v_lshlrev_b32 v112, 16, v43
    v_and_b32 v43, s8, v43
    v_lshlrev_b32 v116, 16, v51
    v_and_b32 v51, s8, v51
    v_mul_f32 v113, v112, v73
    v_mul_f32 v114, v43, v67
    v_fmac_f32 v90, v112, v72
    v_mul_f32 v117, v116, v73
    v_mul_f32 v118, v51, v67
    v_fmac_f32 v92, v116, v72
    v_cvt_pk_bf16_f32 v113, 0, v113
    v_cvt_pk_bf16_f32 v114, 0, v114
    v_fmac_f32 v90, v43, v59
    v_cvt_pk_bf16_f32 v117, 0, v117
    v_cvt_pk_bf16_f32 v118, 0, v118
    v_fmac_f32 v92, v51, v59
    v_add_f32 v91, v91, v113
    v_add_f32 v93, v93, v117
    v_add_f32 v91, v91, v114
    s_barrier
    s_bfe_u32 s91, s68, 0x40010
    s_lshl_b32 s92, s91, 7
    s_mul_i32 s93, s91, 393216
    s_add_u32 m0, s94, 40960
    s_nop 0
    buffer_load_dwordx4 v20, s[24:27], s92 offen offset:0 lds
    v_add_f32 v93, v93, v118
    v_lshlrev_b32 v72, 16, v60
    v_and_b32 v60, s8, v60
    v_lshlrev_b32 v73, 16, v68
    v_and_b32 v68, s8, v68
    v_lshlrev_b32 v112, 16, v44
    v_and_b32 v44, s8, v44
    buffer_load_dwordx4 v21, s[24:27], s92 offen offset:1024 lds
    v_lshlrev_b32 v116, 16, v52
    v_and_b32 v52, s8, v52
    v_mul_f32 v113, v112, v73
    v_mul_f32 v114, v44, v68
    v_fmac_f32 v90, v112, v72
    v_mul_f32 v117, v116, v73
    v_mul_f32 v118, v52, v68
    buffer_load_dwordx4 v22, s[24:27], s92 offen offset:2048 lds
    v_fmac_f32 v92, v116, v72
    v_cvt_pk_bf16_f32 v113, 0, v113
    v_cvt_pk_bf16_f32 v114, 0, v114
    v_fmac_f32 v90, v44, v60
    v_cvt_pk_bf16_f32 v117, 0, v117
    v_cvt_pk_bf16_f32 v118, 0, v118
    v_fmac_f32 v92, v52, v60
    buffer_load_dwordx4 v23, s[24:27], s92 offen offset:3072 lds
    v_add_f32 v91, v91, v113
    v_add_f32 v93, v93, v117
    v_add_f32 v91, v91, v114
    v_add_f32 v93, v93, v118
    v_lshlrev_b32 v72, 16, v61
    v_and_b32 v61, s8, v61
    v_lshlrev_b32 v73, 16, v69
    s_add_u32 m0, s95, 65536
    s_nop 0
    buffer_load_dwordx4 v24, s[28:31], s93 offen offset:0 lds
    v_and_b32 v69, s8, v69
    v_lshlrev_b32 v112, 16, v45
    v_and_b32 v45, s8, v45
    v_lshlrev_b32 v116, 16, v53
    v_and_b32 v53, s8, v53
    v_mul_f32 v113, v112, v73
    v_mul_f32 v114, v45, v69
    buffer_load_dword v15, v13, s[72:75], 0 offen offset:4 sc1
    v_fmac_f32 v90, v112, v72
    v_mul_f32 v117, v116, v73
    v_mul_f32 v118, v53, v69
    v_fmac_f32 v92, v116, v72
    v_cvt_pk_bf16_f32 v113, 0, v113
    v_cvt_pk_bf16_f32 v114, 0, v114
    v_fmac_f32 v90, v45, v61
    v_cvt_pk_bf16_f32 v117, 0, v117
    v_cvt_pk_bf16_f32 v118, 0, v118
    v_fmac_f32 v92, v53, v61
    v_add_f32 v91, v91, v113
    v_add_f32 v93, v93, v117
    v_add_f32 v91, v91, v114
    v_add_f32 v93, v93, v118
    v_lshlrev_b32 v72, 16, v62
    v_and_b32 v62, s8, v62
    v_lshlrev_b32 v73, 16, v70
    v_and_b32 v70, s8, v70
    v_lshlrev_b32 v112, 16, v46
    v_and_b32 v46, s8, v46
    v_lshlrev_b32 v116, 16, v54
    v_and_b32 v54, s8, v54
    v_mul_f32 v113, v112, v73
    v_mul_f32 v114, v46, v70
    v_fmac_f32 v90, v112, v72
    s_waitcnt vmcnt(14)
    s_barrier
    s_add_u32 m0, s95, 65536
    s_nop 0
    buffer_load_dwordx4 v25, s[28:31], s93 offen offset:1024 lds
    v_mul_f32 v117, v116, v73
    v_mul_f32 v118, v54, v70
    v_fmac_f32 v92, v116, v72
    v_cvt_pk_bf16_f32 v113, 0, v113
    v_cvt_pk_bf16_f32 v114, 0, v114
    v_fmac_f32 v90, v46, v62
    v_cvt_pk_bf16_f32 v117, 0, v117
    s_add_u32 m0, s95, 73728
    s_nop 0
    buffer_load_dwordx4 v26, s[28:31], s93 offen offset:0 lds
    v_cvt_pk_bf16_f32 v118, 0, v118
    v_fmac_f32 v92, v54, v62
    v_add_f32 v91, v91, v113
    v_add_f32 v93, v93, v117
    v_add_f32 v91, v91, v114
    v_add_f32 v93, v93, v118
    v_lshlrev_b32 v72, 16, v63
    buffer_load_dwordx4 v27, s[28:31], s93 offen offset:1024 lds
    v_and_b32 v63, s8, v63
    v_lshlrev_b32 v73, 16, v71
    v_and_b32 v71, s8, v71
    v_lshlrev_b32 v112, 16, v47
    v_and_b32 v47, s8, v47
    v_lshlrev_b32 v116, 16, v55
    v_and_b32 v55, s8, v55
    s_add_u32 m0, s95, 57344
    s_nop 0
    buffer_load_dwordx4 v28, s[28:31], s93 offen offset:0 lds
    v_mul_f32 v113, v112, v73
    v_mul_f32 v114, v47, v71
    v_fmac_f32 v90, v112, v72
    v_mul_f32 v117, v116, v73
    v_mul_f32 v118, v55, v71
    v_fmac_f32 v92, v116, v72
    v_cvt_pk_bf16_f32 v113, 0, v113
    buffer_load_dwordx4 v29, s[28:31], s93 offen offset:1024 lds
    v_cvt_pk_bf16_f32 v114, 0, v114
    v_fmac_f32 v90, v47, v63
    v_cvt_pk_bf16_f32 v117, 0, v117
    v_cvt_pk_bf16_f32 v118, 0, v118
    v_fmac_f32 v92, v55, v63
    v_add_f32 v91, v91, v113
    v_add_f32 v93, v93, v117
    s_bfe_u32 s91, s68, 0x40014
    s_lshl_b32 s92, s91, 7
    s_mul_i32 s93, s91, 393216
    s_add_u32 m0, s94, 81920
    s_nop 0
    buffer_load_dwordx4 v20, s[24:27], s92 offen offset:0 lds
    v_add_f32 v91, v91, v114
    v_add_f32 v93, v93, v118
    v_add_f32_dpp v90, v90, v90 row_shr:1 row_mask:0xf bank_mask:0xf
    v_add_f32_dpp v91, v91, v91 row_shr:1 row_mask:0xf bank_mask:0xf
    v_add_f32_dpp v92, v92, v92 row_shr:1 row_mask:0xf bank_mask:0xf
    v_add_f32_dpp v93, v93, v93 row_shr:1 row_mask:0xf bank_mask:0xf
    v_add_f32_dpp v90, v90, v90 row_shr:2 row_mask:0xf bank_mask:0xf
    buffer_load_dwordx4 v21, s[24:27], s92 offen offset:1024 lds
    v_add_f32_dpp v91, v91, v91 row_shr:2 row_mask:0xf bank_mask:0xf
    v_add_f32_dpp v92, v92, v92 row_shr:2 row_mask:0xf bank_mask:0xf
    v_add_f32_dpp v93, v93, v93 row_shr:2 row_mask:0xf bank_mask:0xf
    v_add_f32_dpp v90, v90, v90 row_shr:4 row_mask:0xf bank_mask:0xf
    v_add_f32_dpp v91, v91, v91 row_shr:4 row_mask:0xf bank_mask:0xf
    v_add_f32_dpp v92, v92, v92 row_shr:4 row_mask:0xf bank_mask:0xf
    v_add_f32_dpp v93, v93, v93 row_shr:4 row_mask:0xf bank_mask:0xf
    buffer_load_dwordx4 v22, s[24:27], s92 offen offset:2048 lds
    v_add_f32_dpp v90, v90, v90 row_shr:8 row_mask:0xf bank_mask:0xf
    v_add_f32_dpp v91, v91, v91 row_shr:8 row_mask:0xf bank_mask:0xf
    v_add_f32_dpp v92, v92, v92 row_shr:8 row_mask:0xf bank_mask:0xf
    v_add_f32_dpp v93, v93, v93 row_shr:8 row_mask:0xf bank_mask:0xf
    v_add_f32_dpp v90, v90, v90 row_bcast:15 row_mask:0xa bank_mask:0xf
    v_add_f32_dpp v91, v91, v91 row_bcast:15 row_mask:0xa bank_mask:0xf
    v_add_f32_dpp v92, v92, v92 row_bcast:15 row_mask:0xa bank_mask:0xf
    buffer_load_dwordx4 v23, s[24:27], s92 offen offset:3072 lds
    v_add_f32_dpp v93, v93, v93 row_bcast:15 row_mask:0xa bank_mask:0xf
    v_add_f32_dpp v90, v90, v90 row_bcast:31 row_mask:0xc bank_mask:0xf
    v_add_f32_dpp v91, v91, v91 row_bcast:31 row_mask:0xc bank_mask:0xf
    v_add_f32_dpp v92, v92, v92 row_bcast:31 row_mask:0xc bank_mask:0xf
    v_add_f32_dpp v93, v93, v93 row_bcast:31 row_mask:0xc bank_mask:0xf
    v_mov_b32 v97, 0x8000
    v_mov_b32 v98, 0xffff
    s_add_u32 m0, s95, 106496
    s_nop 0
    buffer_load_dwordx4 v24, s[28:31], s93 offen offset:0 lds
    v_cvt_pk_bf16_f32 v94, v90, v91
    v_cvt_pk_bf16_f32 v104, v92, v93
    v_and_b32 v95, 0xffff, v94
    v_and_b32 v96, 0x8000, v94
    v_and_b32 v94, 0xffff0000, v94
    v_cmp_ne_u32 vcc, 0, v96
    v_mul_f32 v94, 0xbfb8aa3b, v94
    buffer_load_dwordx4 v25, s[28:31], s93 offen offset:1024 lds
    v_exp_f32 v94, v94
    v_cndmask_b32 v96, v97, v98, vcc
    v_xor_b32 v95, v95, v96
    v_add_f32 v94, 1.0, v94
    v_lshlrev_b32 v95, 11, v95
    v_rcp_f32 v94, v94
    s_sub_u32 s12, 2047, s22
    v_or_b32 v100, s12, v95
    s_add_u32 m0, s95, 114688
    s_nop 0
    buffer_load_dwordx4 v26, s[28:31], s93 offen offset:0 lds
    v_cvt_pk_bf16_f32 v94, v94, v94
    v_lshlrev_b32 v102, 16, v94
    v_and_b32 v105, 0xffff, v104
    v_and_b32 v106, 0x8000, v104
    v_and_b32 v104, 0xffff0000, v104
    v_cmp_ne_u32 vcc, 0, v106
    v_mul_f32 v104, 0xbfb8aa3b, v104
    v_exp_f32 v104, v104
    v_cndmask_b32 v106, v97, v98, vcc
    v_xor_b32 v105, v105, v106
    v_add_f32 v104, 1.0, v104
    v_lshlrev_b32 v105, 11, v105
    v_rcp_f32 v104, v104
    s_sub_u32 s12, 2046, s22
    v_or_b32 v101, s12, v105
    v_cvt_pk_bf16_f32 v104, v104, v104
    v_lshlrev_b32 v103, 16, v104
    v_max_u32 v100, v100, v101
    s_lshl_b32 s12, s22, 2
    s_add_u32 s12, s12, 4096
    s_lshl_b32 s13, s21, 2
    s_add_u32 s13, s13, 162880
    v_mov_b32 v14, s13
    s_mov_b32 exec_lo, 0
    s_mov_b32 exec_hi, 0x80000000
    buffer_store_dwordx2 v[102:103], v13, s[32:35], s12 offen sc1
    ds_write_b32 v14, v100
    s_mov_b64 exec, -1
    s_waitcnt lgkmcnt(0)
    s_waitcnt vmcnt(8)
    s_barrier
    s_add_u32 m0, s95, 114688
    s_nop 0
    buffer_load_dwordx4 v27, s[28:31], s93 offen offset:1024 lds
    s_add_u32 m0, s95, 98304
    s_nop 0
    buffer_load_dwordx4 v28, s[28:31], s93 offen offset:0 lds
    buffer_load_dwordx4 v29, s[28:31], s93 offen offset:1024 lds
    s_bfe_u32 s91, s68, 0x40018
    s_lshl_b32 s92, s91, 7
    s_mul_i32 s93, s91, 393216
    s_add_u32 m0, s94, 0
    s_nop 0
    buffer_load_dwordx4 v20, s[24:27], s92 offen offset:0 lds
    buffer_load_dwordx4 v21, s[24:27], s92 offen offset:1024 lds
    buffer_load_dwordx4 v22, s[24:27], s92 offen offset:2048 lds
    buffer_load_dwordx4 v23, s[24:27], s92 offen offset:3072 lds
    s_add_u32 m0, s95, 24576
    s_nop 0
    buffer_load_dwordx4 v24, s[28:31], s93 offen offset:0 lds
    buffer_load_dwordx4 v25, s[28:31], s93 offen offset:1024 lds
    s_add_u32 m0, s95, 32768
    s_nop 0
    buffer_load_dwordx4 v26, s[28:31], s93 offen offset:0 lds
    buffer_load_dwordx4 v27, s[28:31], s93 offen offset:1024 lds
    s_add_u32 m0, s95, 16384
    s_nop 0
    buffer_load_dwordx4 v28, s[28:31], s93 offen offset:0 lds
    s_waitcnt vmcnt(12)
    s_waitcnt vmcnt(9)
    s_barrier
    s_add_u32 m0, s95, 16384
    s_nop 0
    buffer_load_dwordx4 v29, s[28:31], s93 offen offset:1024 lds
    s_bfe_u32 s91, s68, 0x4001c
    s_lshl_b32 s92, s91, 7
    s_mul_i32 s93, s91, 393216
    s_add_u32 m0, s94, 40960
    s_nop 0
    buffer_load_dwordx4 v20, s[24:27], s92 offen offset:0 lds
    buffer_load_dwordx4 v21, s[24:27], s92 offen offset:1024 lds
    buffer_load_dwordx4 v22, s[24:27], s92 offen offset:2048 lds
    buffer_load_dwordx4 v23, s[24:27], s92 offen offset:3072 lds
    s_add_u32 m0, s95, 65536
    s_nop 0
    buffer_load_dwordx4 v24, s[28:31], s93 offen offset:0 lds
    buffer_load_dwordx4 v25, s[28:31], s93 offen offset:1024 lds
    s_add_u32 m0, s95, 73728
    s_nop 0
    buffer_load_dwordx4 v26, s[28:31], s93 offen offset:0 lds
    buffer_load_dwordx4 v27, s[28:31], s93 offen offset:1024 lds
    s_add_u32 m0, s95, 57344
    s_nop 0
    buffer_load_dwordx4 v28, s[28:31], s93 offen offset:0 lds
    buffer_load_dwordx4 v29, s[28:31], s93 offen offset:1024 lds
    s_mov_b32 s13, 0
L_tagchk_1:
    v_readfirstlane_b32 s23, v15
    s_nop 1
    s_cmp_lg_u32 s23, 0
    s_cbranch_scc1 L_tagok_1
    s_add_u32 s13, s13, 1
    s_cmp_ge_u32 s13, 16384
    s_cbranch_scc1 L_tagok_1
    buffer_load_dword v15, v13, s[72:75], 0 offen offset:4 sc1
    s_waitcnt vmcnt(0)
    s_branch L_tagchk_1
L_tagok_1:
    s_and_b32 s76, s23, 0xff
    s_bfe_u32 s77, s23, 0x80008
    s_bfe_u32 s78, s23, 0x80010
    s_lshr_b32 s79, s23, 24
    v_and_b32 v35, 3, v2
    v_lshlrev_b32 v35, 3, v35
    v_bfe_u32 v35, s23, v35, 8
    s_cmp_lg_u32 s21, 0
    s_cbranch_scc1 L_nopub_1
    v_mov_b32 v14, 162880
    ds_read_b128 v[104:107], v14
    s_lshl_b32 s12, s2, 3
    s_add_u32 s12, s12, 0
    s_waitcnt lgkmcnt(0)
    v_max3_u32 v104, v104, v105, v106
    v_max_u32 v104, v104, v107
    v_mov_b32 v105, s23
    s_mov_b64 exec, 1
    buffer_store_dwordx2 v[104:105], v13, s[32:35], s12 offen sc1
    s_mov_b64 exec, -1
L_nopub_1:
    s_waitcnt vmcnt(10)
    s_barrier
    s_bfe_u32 s91, s69, 0x40000
    s_lshl_b32 s92, s91, 7
    s_mul_i32 s93, s91, 393216
    s_add_u32 m0, s94, 81920
    s_nop 0
    buffer_load_dwordx4 v20, s[24:27], s92 offen offset:0 lds
    buffer_load_dwordx4 v21, s[24:27], s92 offen offset:1024 lds
    buffer_load_dwordx4 v22, s[24:27], s92 offen offset:2048 lds
    buffer_load_dwordx4 v23, s[24:27], s92 offen offset:3072 lds
    s_add_u32 m0, s95, 106496
    s_nop 0
    buffer_load_dwordx4 v24, s[28:31], s93 offen offset:0 lds
    buffer_load_dwordx4 v25, s[28:31], s93 offen offset:1024 lds
    s_add_u32 m0, s95, 114688
    s_nop 0
    buffer_load_dwordx4 v26, s[28:31], s93 offen offset:0 lds
    buffer_load_dwordx4 v27, s[28:31], s93 offen offset:1024 lds
    s_add_u32 m0, s95, 98304
    s_nop 0
    buffer_load_dwordx4 v28, s[28:31], s93 offen offset:0 lds
    buffer_load_dwordx4 v29, s[28:31], s93 offen offset:1024 lds
    s_cmp_ge_u32 s10, 224
    s_cbranch_scc1 L_p31_1
    s_add_u32 s12, s9, 0
    buffer_load_dwordx4 v[160:163], v30, s[44:47], s12 offen nt
    s_add_u32 s12, s9, 7168
    buffer_load_dwordx4 v[164:167], v30, s[44:47], s12 offen nt
    s_add_u32 s12, s9, 14336
    buffer_load_dwordx4 v[168:171], v30, s[44:47], s12 offen nt
    s_add_u32 s12, s9, 21504
    buffer_load_dwordx4 v[172:175], v30, s[44:47], s12 offen nt
    s_add_u32 s12, s9, 28672
    buffer_load_dwordx4 v[176:179], v30, s[44:47], s12 offen nt
    s_add_u32 s12, s9, 35840
    buffer_load_dwordx4 v[180:183], v30, s[44:47], s12 offen nt
    s_add_u32 s12, s9, 43008
    buffer_load_dwordx4 v[184:187], v30, s[44:47], s12 offen nt
    s_add_u32 s12, s9, 50176
    buffer_load_dwordx4 v[188:191], v30, s[44:47], s12 offen nt
    s_branch L_p3e1_1
L_p31_1:
    s_mov_b64 exec, 63
    s_bfe_u32 s12, s69, 0x4000c
    s_mul_i32 s12, s12, 393216
    buffer_load_dword v160, v32, s[28:31], s12 offen
    s_bfe_u32 s12, s69, 0x40010
    s_mul_i32 s12, s12, 393216
    buffer_load_dword v164, v32, s[28:31], s12 offen
    s_bfe_u32 s12, s69, 0x40014
    s_mul_i32 s12, s12, 393216
    buffer_load_dword v168, v32, s[28:31], s12 offen
    s_bfe_u32 s12, s69, 0x40018
    s_mul_i32 s12, s12, 393216
    buffer_load_dword v172, v32, s[28:31], s12 offen
    s_bfe_u32 s12, s69, 0x4001c
    s_mul_i32 s12, s12, 393216
    buffer_load_dword v176, v32, s[28:31], s12 offen
    s_mov_b64 exec, 1
    s_bfe_u32 s12, s69, 0x4001c
    s_mul_i32 s12, s12, 393216
    buffer_load_dword v180, v32, s[28:31], s12 offen
    s_bfe_u32 s12, s69, 0x4001c
    s_mul_i32 s12, s12, 393216
    buffer_load_dword v184, v32, s[28:31], s12 offen
    s_bfe_u32 s12, s69, 0x4001c
    s_mul_i32 s12, s12, 393216
    buffer_load_dword v188, v32, s[28:31], s12 offen
    s_mov_b64 exec, -1
L_p3e1_1:
    s_mov_b32 exec_lo, 0xffff0000
    s_mov_b32 exec_hi, 0
    buffer_load_dword v19, v10, s[36:39], 0 offen
    s_mov_b64 exec, -1
    s_waitcnt vmcnt(19)
    s_barrier
    s_bfe_u32 s91, s69, 0x40004
    s_lshl_b32 s92, s91, 7
    s_mul_i32 s93, s91, 393216
    s_add_u32 m0, s94, 0
    s_nop 0
    buffer_load_dwordx4 v20, s[24:27], s92 offen offset:0 lds
    buffer_load_dwordx4 v21, s[24:27], s92 offen offset:1024 lds
    buffer_load_dwordx4 v22, s[24:27], s92 offen offset:2048 lds
    buffer_load_dwordx4 v23, s[24:27], s92 offen offset:3072 lds
    s_add_u32 m0, s95, 24576
    s_nop 0
    buffer_load_dwordx4 v24, s[28:31], s93 offen offset:0 lds
    s_waitcnt vmcnt(14)
    s_barrier
    s_add_u32 m0, s95, 24576
    s_nop 0
    buffer_load_dwordx4 v25, s[28:31], s93 offen offset:1024 lds
    s_add_u32 m0, s95, 32768
    s_nop 0
    buffer_load_dwordx4 v26, s[28:31], s93 offen offset:0 lds
    buffer_load_dwordx4 v27, s[28:31], s93 offen offset:1024 lds
    s_add_u32 m0, s95, 16384
    s_nop 0
    buffer_load_dwordx4 v28, s[28:31], s93 offen offset:0 lds
    buffer_load_dwordx4 v29, s[28:31], s93 offen offset:1024 lds
    s_bfe_u32 s91, s69, 0x40008
    s_lshl_b32 s92, s91, 7
    s_mul_i32 s93, s91, 393216
    s_add_u32 m0, s94, 40960
    s_nop 0
    buffer_load_dwordx4 v20, s[24:27], s92 offen offset:0 lds
    buffer_load_dwordx4 v21, s[24:27], s92 offen offset:1024 lds
    buffer_load_dwordx4 v22, s[24:27], s92 offen offset:2048 lds
    buffer_load_dwordx4 v23, s[24:27], s92 offen offset:3072 lds
    s_add_u32 m0, s95, 65536
    s_nop 0
    buffer_load_dwordx4 v24, s[28:31], s93 offen offset:0 lds
    buffer_load_dwordx4 v25, s[28:31], s93 offen offset:1024 lds
    s_add_u32 m0, s95, 73728
    s_nop 0
    buffer_load_dwordx4 v26, s[28:31], s93 offen offset:0 lds
    s_waitcnt vmcnt(7)
    s_barrier
    s_add_u32 m0, s95, 73728
    s_nop 0
    buffer_load_dwordx4 v27, s[28:31], s93 offen offset:1024 lds
    s_add_u32 m0, s95, 57344
    s_nop 0
    buffer_load_dwordx4 v28, s[28:31], s93 offen offset:0 lds
    buffer_load_dwordx4 v29, s[28:31], s93 offen offset:1024 lds
    s_bfe_u32 s91, s69, 0x4000c
    s_lshl_b32 s92, s91, 7
    s_mul_i32 s93, s91, 393216
    s_add_u32 m0, s94, 122880
    s_nop 0
    buffer_load_dwordx4 v20, s[24:27], s92 offen offset:0 lds
    buffer_load_dwordx4 v21, s[24:27], s92 offen offset:1024 lds
    buffer_load_dwordx4 v22, s[24:27], s92 offen offset:2048 lds
    buffer_load_dwordx4 v23, s[24:27], s92 offen offset:3072 lds
    s_add_u32 m0, s95, 106496
    s_nop 0
    buffer_load_dwordx4 v24, s[28:31], s93 offen offset:0 lds
    buffer_load_dwordx4 v25, s[28:31], s93 offen offset:1024 lds
    s_add_u32 m0, s95, 114688
    s_nop 0
    buffer_load_dwordx4 v26, s[28:31], s93 offen offset:0 lds
    buffer_load_dwordx4 v27, s[28:31], s93 offen offset:1024 lds
    s_mov_b32 s12, 0
    buffer_load_dwordx4 v[104:107], v5, s[32:35], s12 offen offset:0 sc1
    buffer_load_dwordx4 v[108:111], v5, s[32:35], s12 offen offset:1024 sc1
    s_waitcnt vmcnt(10)
    s_barrier
    s_bfe_u32 s91, s69, 0x40010
    s_lshl_b32 s92, s91, 7
    s_mul_i32 s93, s91, 393216
    s_add_u32 m0, s94, 139264
    s_nop 0
    buffer_load_dwordx4 v20, s[24:27], s92 offen offset:0 lds
    buffer_load_dwordx4 v21, s[24:27], s92 offen offset:1024 lds
    buffer_load_dwordx4 v22, s[24:27], s92 offen offset:2048 lds
    buffer_load_dwordx4 v23, s[24:27], s92 offen offset:3072 lds
    s_add_u32 m0, s95, 24576
    s_nop 0
    buffer_load_dwordx4 v24, s[28:31], s93 offen offset:0 lds
    buffer_load_dwordx4 v25, s[28:31], s93 offen offset:1024 lds
    s_add_u32 m0, s95, 32768
    s_nop 0
    buffer_load_dwordx4 v26, s[28:31], s93 offen offset:0 lds
    buffer_load_dwordx4 v27, s[28:31], s93 offen offset:1024 lds
    s_waitcnt vmcnt(10)
    s_barrier
    s_bfe_u32 s91, s69, 0x40014
    s_lshl_b32 s92, s91, 7
    s_mul_i32 s93, s91, 393216
    s_add_u32 m0, s94, 40960
    s_nop 0
    buffer_load_dwordx4 v20, s[24:27], s92 offen offset:0 lds
    s_waitcnt vmcnt(9)
    s_mov_b32 s13, 0
    v_xor_b32 v105, s23, v105
    v_xor_b32 v107, s23, v107
    v_xor_b32 v109, s23, v109
    v_xor_b32 v111, s23, v111
    v_or3_b32 v105, v105, v107, v109
    v_or_b32 v105, v105, v111
    v_cmp_ne_u32 vcc, 0, v105
    s_cbranch_vccnz L_keyre_1
L_keyok_1:
    buffer_load_dwordx4 v21, s[24:27], s92 offen offset:1024 lds
    v_max3_u32 v104, v104, v106, v108
    v_max_u32 v104, v104, v110
    s_nop 1
    v_max_u32_dpp v104, v104, v104 row_shr:1 row_mask:0xf bank_mask:0xf
    s_nop 1
    v_max_u32_dpp v104, v104, v104 row_shr:2 row_mask:0xf bank_mask:0xf
    s_nop 1
    v_max_u32_dpp v104, v104, v104 row_shr:4 row_mask:0xf bank_mask:0xf
    s_nop 1
    v_max_u32_dpp v104, v104, v104 row_shr:8 row_mask:0xf bank_mask:0xf
    s_nop 1
    v_max_u32_dpp v104, v104, v104 row_bcast:15 row_mask:0xa bank_mask:0xf
    buffer_load_dwordx4 v22, s[24:27], s92 offen offset:2048 lds
    s_nop 0
    v_max_u32_dpp v104, v104, v104 row_bcast:31 row_mask:0xc bank_mask:0xf
    s_nop 0
    v_readlane_b32 s14, v104, 63
    s_nop 1
    s_and_b32 s15, s14, 2047
    s_sub_u32 s15, 2047, s15
    s_lshl_b32 s12, s15, 11
    s_lshl_b32 s13, s70, 1
    s_add_u32 s12, s12, s13
    buffer_load_dwordx4 v[36:39], v34, s[24:27], s12 offen
    s_lshr_b32 s12, s14, 11
    s_and_b32 s13, s12, 0x8000
    s_cmp_lg_u32 s13, 0
    s_mov_b32 s13, 0xffff
    s_cselect_b32 s13, 0x8000, s13
    s_xor_b32 s12, s12, s13
    s_lshl_b32 s12, s12, 16
    v_mov_b32 v105, s12
    buffer_load_dwordx4 v23, s[24:27], s92 offen offset:3072 lds
    v_mul_f32 v105, 0xbfb8aa3b, v105
    v_exp_f32 v105, v105
    s_nop 0
    v_add_f32 v105, 1.0, v105
    v_rcp_f32 v105, v105
    s_nop 0
    v_cvt_pk_bf16_f32 v105, v105, v105
    v_lshlrev_b32 v105, 16, v105
    s_add_u32 s12, s15, 1
    v_mov_b32 v104, s12
    s_add_u32 m0, s95, 65536
    s_nop 0
    buffer_load_dwordx4 v24, s[28:31], s93 offen offset:0 lds
    v_mov_b32 v106, s23
    v_readfirstlane_b32 s14, v105
    v_mov_b32 v14, 162864
    s_mov_b64 exec, 1
    ds_write_b96 v14, v[104:106]
    s_mov_b64 exec, -1
    s_waitcnt lgkmcnt(0)
    buffer_load_dwordx4 v25, s[28:31], s93 offen offset:1024 lds
    s_add_u32 m0, s95, 73728
    s_nop 0
    buffer_load_dwordx4 v26, s[28:31], s93 offen offset:0 lds
    buffer_load_dwordx4 v27, s[28:31], s93 offen offset:1024 lds
    s_add_u32 s12, s97, 0
    buffer_load_dwordx4 v[192:195], v31, s[64:67], s12 offen nt
    s_add_u32 s12, s97, 16384
    buffer_load_dwordx4 v[196:199], v31, s[64:67], s12 offen nt
    s_add_u32 s12, s97, 32768
    buffer_load_dwordx4 v[200:203], v31, s[64:67], s12 offen nt
    s_add_u32 s12, s97, 49152
    buffer_load_dwordx4 v[204:207], v31, s[64:67], s12 offen nt
    s_add_u32 s12, s97, 65536
    buffer_load_dwordx4 v[208:211], v31, s[64:67], s12 offen nt
    s_add_u32 s12, s97, 81920
    buffer_load_dwordx4 v[212:215], v31, s[64:67], s12 offen nt
    s_add_u32 s12, s97, 98304
    buffer_load_dwordx4 v[216:219], v31, s[64:67], s12 offen nt
    s_waitcnt vmcnt(16)
    s_barrier
    s_bfe_u32 s91, s69, 0x40018
    s_lshl_b32 s92, s91, 7
    s_mul_i32 s93, s91, 393216
    s_add_u32 m0, s94, 81920
    s_nop 0
    buffer_load_dwordx4 v20, s[24:27], s92 offen offset:0 lds
    s_waitcnt vmcnt(13)
    s_mov_b32 s8, 0xffff0000
    v_lshlrev_b32 v40, 16, v36
    v_and_b32 v41, s8, v36
    v_lshlrev_b32 v42, 16, v37
    v_and_b32 v43, s8, v37
    v_lshlrev_b32 v44, 16, v38
    buffer_load_dwordx4 v21, s[24:27], s92 offen offset:1024 lds
    v_and_b32 v45, s8, v38
    v_lshlrev_b32 v46, 16, v39
    v_and_b32 v47, s8, v39
    v_lshlrev_b32 v48, 16, v128
    v_lshlrev_b32 v49, 16, v129
    v_and_b32 v128, s8, v128
    v_and_b32 v129, s8, v129
    buffer_load_dwordx4 v22, s[24:27], s92 offen offset:2048 lds
    v_mul_f32 v220, v48, v40
    v_mul_f32 v222, v49, v40
    v_mul_f32 v221, v128, v40
    v_mul_f32 v223, v129, v40
    v_lshlrev_b32 v50, 16, v130
    v_lshlrev_b32 v51, 16, v131
    v_and_b32 v130, s8, v130
    buffer_load_dwordx4 v23, s[24:27], s92 offen offset:3072 lds
    v_and_b32 v131, s8, v131
    v_mul_f32 v224, v50, v40
    v_mul_f32 v226, v51, v40
    v_mul_f32 v225, v130, v40
    v_mul_f32 v227, v131, v40
    v_lshlrev_b32 v48, 16, v160
    v_lshlrev_b32 v49, 16, v161
    s_add_u32 m0, s95, 106496
    s_nop 0
    buffer_load_dwordx4 v24, s[28:31], s93 offen offset:0 lds
    v_and_b32 v160, s8, v160
    v_and_b32 v161, s8, v161
    v_mul_f32 v228, v48, v40
    v_mul_f32 v230, v49, v40
    v_mul_f32 v229, v160, v40
    v_mul_f32 v231, v161, v40
    v_lshlrev_b32 v50, 16, v162
    v_lshlrev_b32 v51, 16, v163
    v_and_b32 v162, s8, v162
    v_and_b32 v163, s8, v163
    v_mul_f32 v232, v50, v40
    v_mul_f32 v234, v51, v40
    v_mul_f32 v233, v162, v40
    v_mul_f32 v235, v163, v40
    v_lshlrev_b32 v48, 16, v132
    v_lshlrev_b32 v49, 16, v133
    v_and_b32 v132, s8, v132
    v_and_b32 v133, s8, v133
    v_fmac_f32 v220, v48, v41
    v_fmac_f32 v222, v49, v41
    v_fmac_f32 v221, v132, v41
    v_fmac_f32 v223, v133, v41
    v_lshlrev_b32 v50, 16, v134
    v_lshlrev_b32 v51, 16, v135
    v_and_b32 v134, s8, v134
    v_and_b32 v135, s8, v135
    v_fmac_f32 v224, v50, v41
    v_fmac_f32 v226, v51, v41
    v_fmac_f32 v225, v134, v41
    v_fmac_f32 v227, v135, v41
    v_lshlrev_b32 v48, 16, v164
    v_lshlrev_b32 v49, 16, v165
    s_waitcnt vmcnt(12)
    s_barrier
    s_add_u32 m0, s95, 106496
    s_nop 0
    buffer_load_dwordx4 v25, s[28:31], s93 offen offset:1024 lds
    v_and_b32 v164, s8, v164
    v_and_b32 v165, s8, v165
    v_fmac_f32 v228, v48, v41
    v_fmac_f32 v230, v49, v41
    v_fmac_f32 v229, v164, v41
    v_fmac_f32 v231, v165, v41
    v_lshlrev_b32 v50, 16, v166
    s_add_u32 m0, s95, 114688
    s_nop 0
    buffer_load_dwordx4 v26, s[28:31], s93 offen offset:0 lds
    v_lshlrev_b32 v51, 16, v167
    v_and_b32 v166, s8, v166
    v_and_b32 v167, s8, v167
    v_fmac_f32 v232, v50, v41
    v_fmac_f32 v234, v51, v41
    v_fmac_f32 v233, v166, v41
    v_fmac_f32 v235, v167, v41
    v_lshlrev_b32 v48, 16, v136
    v_lshlrev_b32 v49, 16, v137
    v_and_b32 v136, s8, v136
    v_and_b32 v137, s8, v137
    v_fmac_f32 v220, v48, v42
    v_fmac_f32 v222, v49, v42
    v_fmac_f32 v221, v136, v42
    buffer_load_dwordx4 v27, s[28:31], s93 offen offset:1024 lds
    v_fmac_f32 v223, v137, v42
    v_lshlrev_b32 v50, 16, v138
    v_lshlrev_b32 v51, 16, v139
    v_and_b32 v138, s8, v138
    v_and_b32 v139, s8, v139
    v_fmac_f32 v224, v50, v42
    v_fmac_f32 v226, v51, v42
    v_fmac_f32 v225, v138, v42
    v_fmac_f32 v227, v139, v42
    v_lshlrev_b32 v48, 16, v168
    v_lshlrev_b32 v49, 16, v169
    v_and_b32 v168, s8, v168
    v_and_b32 v169, s8, v169
    v_fmac_f32 v228, v48, v42
    s_bfe_u32 s91, s69, 0x4001c
    s_lshl_b32 s92, s91, 7
    s_mul_i32 s93, s91, 393216
    s_add_u32 m0, s94, 0
    s_nop 0
    buffer_load_dwordx4 v20, s[24:27], s92 offen offset:0 lds
    v_fmac_f32 v230, v49, v42
    v_fmac_f32 v229, v168, v42
    v_fmac_f32 v231, v169, v42
    v_lshlrev_b32 v50, 16, v170
    v_lshlrev_b32 v51, 16, v171
    v_and_b32 v170, s8, v170
    v_and_b32 v171, s8, v171
    buffer_load_dwordx4 v21, s[24:27], s92 offen offset:1024 lds
    v_fmac_f32 v232, v50, v42
    v_fmac_f32 v234, v51, v42
    v_fmac_f32 v233, v170, v42
    v_fmac_f32 v235, v171, v42
    v_lshlrev_b32 v48, 16, v140
    v_lshlrev_b32 v49, 16, v141
    v_and_b32 v140, s8, v140
    buffer_load_dwordx4 v22, s[24:27], s92 offen offset:2048 lds
    v_and_b32 v141, s8, v141
    v_fmac_f32 v220, v48, v43
    v_fmac_f32 v222, v49, v43
    v_fmac_f32 v221, v140, v43
    v_fmac_f32 v223, v141, v43
    v_lshlrev_b32 v50, 16, v142
    v_lshlrev_b32 v51, 16, v143
    buffer_load_dwordx4 v23, s[24:27], s92 offen offset:3072 lds
    v_and_b32 v142, s8, v142
    v_and_b32 v143, s8, v143
    v_fmac_f32 v224, v50, v43
    v_fmac_f32 v226, v51, v43
    v_fmac_f32 v225, v142, v43
    v_fmac_f32 v227, v143, v43
    v_lshlrev_b32 v48, 16, v172
    s_add_u32 m0, s95, 24576
    s_nop 0
    buffer_load_dwordx4 v24, s[28:31], s93 offen offset:0 lds
    v_lshlrev_b32 v49, 16, v173
    v_and_b32 v172, s8, v172
    v_and_b32 v173, s8, v173
    v_fmac_f32 v228, v48, v43
    v_fmac_f32 v230, v49, v43
    v_fmac_f32 v229, v172, v43
    v_fmac_f32 v231, v173, v43
    buffer_load_dwordx4 v25, s[28:31], s93 offen offset:1024 lds
    v_lshlrev_b32 v50, 16, v174
    v_lshlrev_b32 v51, 16, v175
    v_and_b32 v174, s8, v174
    v_and_b32 v175, s8, v175
    v_fmac_f32 v232, v50, v43
    v_fmac_f32 v234, v51, v43
    v_fmac_f32 v233, v174, v43
    s_add_u32 m0, s95, 32768
    s_nop 0
    buffer_load_dwordx4 v26, s[28:31], s93 offen offset:0 lds
    v_fmac_f32 v235, v175, v43
    v_lshlrev_b32 v48, 16, v144
    v_lshlrev_b32 v49, 16, v145
    v_and_b32 v144, s8, v144
    v_and_b32 v145, s8, v145
    v_fmac_f32 v220, v48, v44
    v_fmac_f32 v222, v49, v44
    v_fmac_f32 v221, v144, v44
    v_fmac_f32 v223, v145, v44
    v_lshlrev_b32 v50, 16, v146
    v_lshlrev_b32 v51, 16, v147
    v_and_b32 v146, s8, v146
    v_and_b32 v147, s8, v147
    v_fmac_f32 v224, v50, v44
    v_fmac_f32 v226, v51, v44
    v_fmac_f32 v225, v146, v44
    v_fmac_f32 v227, v147, v44
    v_lshlrev_b32 v48, 16, v176
    v_lshlrev_b32 v49, 16, v177
    v_and_b32 v176, s8, v176
    v_and_b32 v177, s8, v177
    v_fmac_f32 v228, v48, v44
    v_fmac_f32 v230, v49, v44
    v_fmac_f32 v229, v176, v44
    v_fmac_f32 v231, v177, v44
    v_lshlrev_b32 v50, 16, v178
    v_lshlrev_b32 v51, 16, v179
    v_and_b32 v178, s8, v178
    v_and_b32 v179, s8, v179
    v_fmac_f32 v232, v50, v44
    v_fmac_f32 v234, v51, v44
    v_fmac_f32 v233, v178, v44
    v_fmac_f32 v235, v179, v44
    v_lshlrev_b32 v48, 16, v148
    v_lshlrev_b32 v49, 16, v149
    v_and_b32 v148, s8, v148
    v_and_b32 v149, s8, v149
    v_fmac_f32 v220, v48, v45
    v_fmac_f32 v222, v49, v45
    s_waitcnt vmcnt(7)
    s_barrier
    s_add_u32 m0, s95, 32768
    s_nop 0
    buffer_load_dwordx4 v27, s[28:31], s93 offen offset:1024 lds
    v_fmac_f32 v221, v148, v45
    v_fmac_f32 v223, v149, v45
    v_lshlrev_b32 v50, 16, v150
    v_lshlrev_b32 v51, 16, v151
    v_and_b32 v150, s8, v150
    v_and_b32 v151, s8, v151
    v_fmac_f32 v224, v50, v45
    v_fmac_f32 v226, v51, v45
    v_fmac_f32 v225, v150, v45
    v_fmac_f32 v227, v151, v45
    v_lshlrev_b32 v48, 16, v180
    v_lshlrev_b32 v49, 16, v181
    v_and_b32 v180, s8, v180
    v_and_b32 v181, s8, v181
    s_bfe_u32 s12, s69, 0x4000c
    s_mul_i32 s12, s12, 393216
    s_add_u32 m0, s95, 16384
    s_nop 0
    buffer_load_dwordx4 v28, s[28:31], s12 offen offset:0 lds
    buffer_load_dwordx4 v29, s[28:31], s12 offen offset:1024 lds
    s_bfe_u32 s12, s69, 0x40010
    s_mul_i32 s12, s12, 393216
    s_add_u32 m0, s95, 57344
    s_nop 0
    buffer_load_dwordx4 v28, s[28:31], s12 offen offset:0 lds
    buffer_load_dwordx4 v29, s[28:31], s12 offen offset:1024 lds
    s_mul_i32 s12, s21, 16
    s_add_u32 s12, s12, 0
    s_and_b32 s90, s88, 1
    s_lshl_b32 s90, s90, 6
    s_xor_b32 s12, s12, s90
    s_lshl_b32 s12, s12, 14
    s_add_u32 s90, s12, 0
    buffer_load_dwordx4 v[84:87], v33, s[36:39], s90 offen
    s_add_u32 s90, s12, 16384
    buffer_load_dwordx4 v[88:91], v33, s[36:39], s90 offen
    s_add_u32 s90, s12, 32768
    buffer_load_dwordx4 v[92:95], v33, s[36:39], s90 offen
    s_add_u32 s90, s12, 49152
    buffer_load_dwordx4 v[96:99], v33, s[36:39], s90 offen
    s_add_u32 s90, s12, 65536
    buffer_load_dwordx4 v[100:103], v33, s[36:39], s90 offen
    s_add_u32 s90, s12, 81920
    buffer_load_dwordx4 v[116:119], v33, s[36:39], s90 offen
    s_add_u32 s90, s12, 98304
    buffer_load_dwordx4 v[120:123], v33, s[36:39], s90 offen
    s_add_u32 s90, s12, 114688
    buffer_load_dwordx4 v[124:127], v33, s[36:39], s90 offen
    s_add_u32 s90, s12, 131072
    buffer_load_dwordx4 v[64:67], v33, s[36:39], s90 offen
    v_fmac_f32 v228, v48, v45
    v_fmac_f32 v230, v49, v45
    v_fmac_f32 v229, v180, v45
    v_fmac_f32 v231, v181, v45
    v_lshlrev_b32 v50, 16, v182
    v_lshlrev_b32 v51, 16, v183
    v_and_b32 v182, s8, v182
    v_and_b32 v183, s8, v183
    v_fmac_f32 v232, v50, v45
    v_fmac_f32 v234, v51, v45
    v_fmac_f32 v233, v182, v45
    v_fmac_f32 v235, v183, v45
    v_lshlrev_b32 v48, 16, v152
    v_lshlrev_b32 v49, 16, v153
    v_and_b32 v152, s8, v152
    v_and_b32 v153, s8, v153
    v_fmac_f32 v220, v48, v46
    v_fmac_f32 v222, v49, v46
    v_fmac_f32 v221, v152, v46
    v_fmac_f32 v223, v153, v46
    v_lshlrev_b32 v50, 16, v154
    v_lshlrev_b32 v51, 16, v155
    v_and_b32 v154, s8, v154
    v_and_b32 v155, s8, v155
    v_fmac_f32 v224, v50, v46
    s_waitcnt vmcnt(13)
    s_barrier
    v_fmac_f32 v226, v51, v46
    v_fmac_f32 v225, v154, v46
    v_fmac_f32 v227, v155, v46
    v_lshlrev_b32 v48, 16, v184
    v_lshlrev_b32 v49, 16, v185
    v_and_b32 v184, s8, v184
    v_and_b32 v185, s8, v185
    v_fmac_f32 v228, v48, v46
    v_fmac_f32 v230, v49, v46
    v_fmac_f32 v229, v184, v46
    v_fmac_f32 v231, v185, v46
    v_lshlrev_b32 v50, 16, v186
    v_lshlrev_b32 v51, 16, v187
    v_and_b32 v186, s8, v186
    v_and_b32 v187, s8, v187
    v_fmac_f32 v232, v50, v46
    v_fmac_f32 v234, v51, v46
    v_fmac_f32 v233, v186, v46
    v_fmac_f32 v235, v187, v46
    v_lshlrev_b32 v48, 16, v156
    v_lshlrev_b32 v49, 16, v157
    v_and_b32 v156, s8, v156
    v_and_b32 v157, s8, v157
    v_fmac_f32 v220, v48, v47
    v_fmac_f32 v222, v49, v47
    v_fmac_f32 v221, v156, v47
    v_fmac_f32 v223, v157, v47
    v_lshlrev_b32 v50, 16, v158
    v_lshlrev_b32 v51, 16, v159
    v_and_b32 v158, s8, v158
    v_and_b32 v159, s8, v159
    v_fmac_f32 v224, v50, v47
    v_fmac_f32 v226, v51, v47
    v_fmac_f32 v225, v158, v47
    v_fmac_f32 v227, v159, v47
    v_lshlrev_b32 v48, 16, v188
    v_lshlrev_b32 v49, 16, v189
    v_and_b32 v188, s8, v188
    v_and_b32 v189, s8, v189
    v_fmac_f32 v228, v48, v47
    v_fmac_f32 v230, v49, v47
    v_fmac_f32 v229, v188, v47
    v_fmac_f32 v231, v189, v47
    v_lshlrev_b32 v50, 16, v190
    v_lshlrev_b32 v51, 16, v191
    v_and_b32 v190, s8, v190
    v_and_b32 v191, s8, v191
    v_fmac_f32 v232, v50, v47
    v_fmac_f32 v234, v51, v47
    v_fmac_f32 v233, v190, v47
    v_fmac_f32 v235, v191, v47
    v_permlane32_swap_b32 v220, v228
    v_permlane32_swap_b32 v221, v229
    v_permlane32_swap_b32 v222, v230
    v_permlane32_swap_b32 v223, v231
    v_permlane32_swap_b32 v224, v232
    v_permlane32_swap_b32 v225, v233
    v_permlane32_swap_b32 v226, v234
    v_permlane32_swap_b32 v227, v235
    v_add_f32 v220, v220, v228
    v_add_f32 v221, v221, v229
    v_add_f32 v222, v222, v230
    v_add_f32 v223, v223, v231
    v_add_f32 v224, v224, v232
    v_add_f32 v225, v225, v233
    v_add_f32 v226, v226, v234
    v_add_f32 v227, v227, v235
    v_permlane16_swap_b32 v220, v224
    v_permlane16_swap_b32 v221, v225
    v_permlane16_swap_b32 v222, v226
    v_permlane16_swap_b32 v223, v227
    v_add_f32 v220, v220, v224
    v_add_f32 v221, v221, v225
    v_add_f32 v222, v222, v226
    v_add_f32 v223, v223, v227
    v_add_f32_dpp v220, v220, v220 row_ror:8 row_mask:0xf bank_mask:0xf
    v_add_f32_dpp v221, v221, v221 row_ror:8 row_mask:0xf bank_mask:0xf
    v_add_f32_dpp v222, v222, v222 row_ror:8 row_mask:0xf bank_mask:0xf
    v_add_f32_dpp v223, v223, v223 row_ror:8 row_mask:0xf bank_mask:0xf
    s_branch L_varend
L_var2:
    s_nop 0
    s_add_u32 m0, s95, 73728
    s_nop 0
    buffer_load_dwordx4 v26, s[28:31], s93 offen offset:0 lds
    buffer_load_dwordx4 v27, s[28:31], s93 offen offset:1024 lds
    s_add_u32 m0, s95, 57344
    s_nop 0
    buffer_load_dwordx4 v28, s[28:31], s93 offen offset:0 lds
    buffer_load_dwordx4 v29, s[28:31], s93 offen offset:1024 lds
    s_bfe_u32 s91, s68, 0x40008
    s_lshl_b32 s92, s91, 7
    s_mul_i32 s93, s91, 393216
    s_add_u32 m0, s94, 81920
    s_nop 0
    buffer_load_dwordx4 v20, s[24:27], s92 offen offset:0 lds
    buffer_load_dwordx4 v21, s[24:27], s92 offen offset:1024 lds
    buffer_load_dwordx4 v22, s[24:27], s92 offen offset:2048 lds
    buffer_load_dwordx4 v23, s[24:27], s92 offen offset:3072 lds
    s_add_u32 m0, s95, 106496
    s_nop 0
    buffer_load_dwordx4 v24, s[28:31], s93 offen offset:0 lds
    buffer_load_dwordx4 v25, s[28:31], s93 offen offset:1024 lds
    s_add_u32 m0, s95, 114688
    s_nop 0
    buffer_load_dwordx4 v26, s[28:31], s93 offen offset:0 lds
    buffer_load_dwordx4 v27, s[28:31], s93 offen offset:1024 lds
    s_add_u32 m0, s95, 98304
    s_nop 0
    buffer_load_dwordx4 v28, s[28:31], s93 offen offset:0 lds
    buffer_load_dwordx4 v29, s[28:31], s93 offen offset:1024 lds
    s_lshl_b32 s12, s19, 2
    s_add_u32 s12, s12, s21
    s_lshl_b32 s12, s12, 10
    s_lshl_b32 s13, s21, 10
    s_add_u32 m0, s13, 155648
    s_nop 0
    buffer_load_dwordx4 v5, s[76:79], s12 offen lds
    s_lshl_b32 s12, s22, 11
    buffer_load_dwordx4 v[40:43], v5, s[24:27], s12 offen offset:0
    buffer_load_dwordx4 v[44:47], v5, s[24:27], s12 offen offset:1024
    buffer_load_dwordx4 v[48:51], v5, s[24:27], s12 offen offset:2048
    buffer_load_dwordx4 v[52:55], v5, s[24:27], s12 offen offset:3072
    buffer_load_dwordx4 v[56:59], v5, s[80:83], 0 offen offset:0
    buffer_load_dwordx4 v[60:63], v5, s[80:83], 0 offen offset:1024
    buffer_load_dwordx4 v[64:67], v5, s[84:87], 0 offen offset:0
    buffer_load_dwordx4 v[68:71], v5, s[84:87], 0 offen offset:1024
    s_waitcnt vmcnt(19)
    s_barrier
    s_bfe_u32 s91, s68, 0x4000c
    s_lshl_b32 s92, s91, 7
    s_mul_i32 s93, s91, 393216
    s_add_u32 m0, s94, 0
    s_nop 0
    buffer_load_dwordx4 v20, s[24:27], s92 offen offset:0 lds
    s_waitcnt vmcnt(1)
    s_mov_b32 s8, 0xffff0000
    v_lshlrev_b32 v72, 16, v56
    v_and_b32 v56, s8, v56
    v_lshlrev_b32 v73, 16, v64
    v_and_b32 v64, s8, v64
    v_lshlrev_b32 v112, 16, v40
    buffer_load_dwordx4 v21, s[24:27], s92 offen offset:1024 lds
    v_and_b32 v40, s8, v40
    v_lshlrev_b32 v116, 16, v48
    v_and_b32 v48, s8, v48
    v_mul_f32 v113, v112, v73
    v_mul_f32 v114, v40, v64
    v_mul_f32 v90, v112, v72
    v_mul_f32 v117, v116, v73
    buffer_load_dwordx4 v22, s[24:27], s92 offen offset:2048 lds
    v_mul_f32 v118, v48, v64
    v_mul_f32 v92, v116, v72
    v_cvt_pk_bf16_f32 v113, 0, v113
    v_cvt_pk_bf16_f32 v114, 0, v114
    v_fmac_f32 v90, v40, v56
    v_cvt_pk_bf16_f32 v117, 0, v117
    v_cvt_pk_bf16_f32 v118, 0, v118
    buffer_load_dwordx4 v23, s[24:27], s92 offen offset:3072 lds
    v_fmac_f32 v92, v48, v56
    v_add_f32 v91, v113, v114
    v_add_f32 v93, v117, v118
    v_lshlrev_b32 v72, 16, v57
    v_and_b32 v57, s8, v57
    v_lshlrev_b32 v73, 16, v65
    v_and_b32 v65, s8, v65
    s_add_u32 m0, s95, 24576
    s_nop 0
    buffer_load_dwordx4 v24, s[28:31], s93 offen offset:0 lds
    v_lshlrev_b32 v112, 16, v41
    v_and_b32 v41, s8, v41
    v_lshlrev_b32 v116, 16, v49
    v_and_b32 v49, s8, v49
    v_mul_f32 v113, v112, v73
    v_mul_f32 v114, v41, v65
    v_fmac_f32 v90, v112, v72
    buffer_load_dwordx4 v25, s[28:31], s93 offen offset:1024 lds
    v_mul_f32 v117, v116, v73
    v_mul_f32 v118, v49, v65
    v_fmac_f32 v92, v116, v72
    v_cvt_pk_bf16_f32 v113, 0, v113
    v_cvt_pk_bf16_f32 v114, 0, v114
    v_fmac_f32 v90, v41, v57
    v_cvt_pk_bf16_f32 v117, 0, v117
    s_add_u32 m0, s95, 32768
    s_nop 0
    buffer_load_dwordx4 v26, s[28:31], s93 offen offset:0 lds
    v_cvt_pk_bf16_f32 v118, 0, v118
    v_fmac_f32 v92, v49, v57
    v_add_f32 v91, v91, v113
    v_add_f32 v93, v93, v117
    v_add_f32 v91, v91, v114
    v_add_f32 v93, v93, v118
    v_lshlrev_b32 v72, 16, v58
    buffer_load_dwordx4 v27, s[28:31], s93 offen offset:1024 lds
    v_and_b32 v58, s8, v58
    v_lshlrev_b32 v73, 16, v66
    v_and_b32 v66, s8, v66
    v_lshlrev_b32 v112, 16, v42
    v_and_b32 v42, s8, v42
    v_lshlrev_b32 v116, 16, v50
    v_and_b32 v50, s8, v50
    s_add_u32 m0, s95, 16384
    s_nop 0
    buffer_load_dwordx4 v28, s[28:31], s93 offen offset:0 lds
    v_mul_f32 v113, v112, v73
    v_mul_f32 v114, v42, v66
    v_fmac_f32 v90, v112, v72
    v_mul_f32 v117, v116, v73
    v_mul_f32 v118, v50, v66
    v_fmac_f32 v92, v116, v72
    v_cvt_pk_bf16_f32 v113, 0, v113
    buffer_load_dwordx4 v29, s[28:31], s93 offen offset:1024 lds
    v_cvt_pk_bf16_f32 v114, 0, v114
    v_fmac_f32 v90, v42, v58
    v_cvt_pk_bf16_f32 v117, 0, v117
    v_cvt_pk_bf16_f32 v118, 0, v118
    v_fmac_f32 v92, v50, v58
    v_add_f32 v91, v91, v113
    v_add_f32 v93, v93, v117
    s_cmp_lg_u32 s21, 0
    s_cbranch_scc1 L_noclr_2
    v_mov_b32 v104, -1
    v_mov_b32 v105, -1
    v_mov_b32 v106, -1
    v_mov_b32 v107, -1
    s_lshl_b32 s12, s19, 13
    s_lshl_b32 s13, s18, 9
    s_add_u32 s12, s12, s13
    s_add_u32 s12, s12, 32768
    s_lshl_b32 s13, s19, 11
    s_lshl_b32 s90, s18, 7
    s_add_u32 s13, s13, s90
    s_add_u32 s13, s13, 163840
    s_mov_b32 exec_hi, 0
    buffer_store_dwordx4 v[104:107], v5, s[32:35], s12 offen sc1
    s_mov_b32 exec_lo, 255
    buffer_store_dwordx4 v[104:107], v5, s[32:35], s13 offen sc1
    s_mov_b64 exec, -1
L_noclr_2:
    v_add_f32 v91, v91, v114
    v_add_f32 v93, v93, v118
    v_lshlrev_b32 v72, 16, v59
    v_and_b32 v59, s8, v59
    v_lshlrev_b32 v73, 16, v67
    v_and_b32 v67, s8, v67
    v_lshlrev_b32 v112, 16, v43
    v_and_b32 v43, s8, v43
    v_lshlrev_b32 v116, 16, v51
    v_and_b32 v51, s8, v51
    v_mul_f32 v113, v112, v73
    v_mul_f32 v114, v43, v67
    v_fmac_f32 v90, v112, v72
    v_mul_f32 v117, v116, v73
    v_mul_f32 v118, v51, v67
    v_fmac_f32 v92, v116, v72
    v_cvt_pk_bf16_f32 v113, 0, v113
    v_cvt_pk_bf16_f32 v114, 0, v114
    v_fmac_f32 v90, v43, v59
    v_cvt_pk_bf16_f32 v117, 0, v117
    v_cvt_pk_bf16_f32 v118, 0, v118
    v_fmac_f32 v92, v51, v59
    v_add_f32 v91, v91, v113
    v_add_f32 v93, v93, v117
    v_add_f32 v91, v91, v114
    s_barrier
    s_bfe_u32 s91, s68, 0x40010
    s_lshl_b32 s92, s91, 7
    s_mul_i32 s93, s91, 393216
    s_add_u32 m0, s94, 40960
    s_nop 0
    buffer_load_dwordx4 v20, s[24:27], s92 offen offset:0 lds
    v_add_f32 v93, v93, v118
    v_lshlrev_b32 v72, 16, v60
    v_and_b32 v60, s8, v60
    v_lshlrev_b32 v73, 16, v68
    v_and_b32 v68, s8, v68
    v_lshlrev_b32 v112, 16, v44
    v_and_b32 v44, s8, v44
    buffer_load_dwordx4 v21, s[24:27], s92 offen offset:1024 lds
    v_lshlrev_b32 v116, 16, v52
    v_and_b32 v52, s8, v52
    v_mul_f32 v113, v112, v73
    v_mul_f32 v114, v44, v68
    v_fmac_f32 v90, v112, v72
    v_mul_f32 v117, v116, v73
    v_mul_f32 v118, v52, v68
    buffer_load_dwordx4 v22, s[24:27], s92 offen offset:2048 lds
    v_fmac_f32 v92, v116, v72
    v_cvt_pk_bf16_f32 v113, 0, v113
    v_cvt_pk_bf16_f32 v114, 0, v114
    v_fmac_f32 v90, v44, v60
    v_cvt_pk_bf16_f32 v117, 0, v117
    v_cvt_pk_bf16_f32 v118, 0, v118
    v_fmac_f32 v92, v52, v60
    buffer_load_dwordx4 v23, s[24:27], s92 offen offset:3072 lds
    v_add_f32 v91, v91, v113
    v_add_f32 v93, v93, v117
    v_add_f32 v91, v91, v114
    v_add_f32 v93, v93, v118
    v_lshlrev_b32 v72, 16, v61
    v_and_b32 v61, s8, v61
    v_lshlrev_b32 v73, 16, v69
    s_add_u32 m0, s95, 65536
    s_nop 0
    buffer_load_dwordx4 v24, s[28:31], s93 offen offset:0 lds
    v_and_b32 v69, s8, v69
    v_lshlrev_b32 v112, 16, v45
    v_and_b32 v45, s8, v45
    v_lshlrev_b32 v116, 16, v53
    v_and_b32 v53, s8, v53
    v_mul_f32 v113, v112, v73
    v_mul_f32 v114, v45, v69
    buffer_load_dwordx4 v25, s[28:31], s93 offen offset:1024 lds
    v_fmac_f32 v90, v112, v72
    v_mul_f32 v117, v116, v73
    v_mul_f32 v118, v53, v69
    v_fmac_f32 v92, v116, v72
    v_cvt_pk_bf16_f32 v113, 0, v113
    v_cvt_pk_bf16_f32 v114, 0, v114
    v_fmac_f32 v90, v45, v61
    s_add_u32 m0, s95, 73728
    s_nop 0
    buffer_load_dwordx4 v26, s[28:31], s93 offen offset:0 lds
    v_cvt_pk_bf16_f32 v117, 0, v117
    v_cvt_pk_bf16_f32 v118, 0, v118
    v_fmac_f32 v92, v53, v61
    v_add_f32 v91, v91, v113
    v_add_f32 v93, v93, v117
    v_add_f32 v91, v91, v114
    v_add_f32 v93, v93, v118
    buffer_load_dwordx4 v27, s[28:31], s93 offen offset:1024 lds
    v_lshlrev_b32 v72, 16, v62
    v_and_b32 v62, s8, v62
    v_lshlrev_b32 v73, 16, v70
    v_and_b32 v70, s8, v70
    v_lshlrev_b32 v112, 16, v46
    v_and_b32 v46, s8, v46
    v_lshlrev_b32 v116, 16, v54
    s_add_u32 m0, s95, 57344
    s_nop 0
    buffer_load_dwordx4 v28, s[28:31], s93 offen offset:0 lds
    v_and_b32 v54, s8, v54
    v_mul_f32 v113, v112, v73
    v_mul_f32 v114, v46, v70
    v_fmac_f32 v90, v112, v72
    v_mul_f32 v117, v116, v73
    v_mul_f32 v118, v54, v70
    v_fmac_f32 v92, v116, v72
    buffer_load_dwordx4 v29, s[28:31], s93 offen offset:1024 lds
    v_cvt_pk_bf16_f32 v113, 0, v113
    v_cvt_pk_bf16_f32 v114, 0, v114
    v_fmac_f32 v90, v46, v62
    v_cvt_pk_bf16_f32 v117, 0, v117
    v_cvt_pk_bf16_f32 v118, 0, v118
    v_fmac_f32 v92, v54, v62
    v_add_f32 v91, v91, v113
    s_cmp_ge_u32 s10, 224
    s_cbranch_scc1 L_p30_2
    s_add_u32 s12, s71, 0
    buffer_load_dwordx4 v[128:131], v30, s[40:43], s12 offen nt
    s_add_u32 s12, s71, 7168
    buffer_load_dwordx4 v[132:135], v30, s[40:43], s12 offen nt
    s_add_u32 s12, s71, 14336
    buffer_load_dwordx4 v[136:139], v30, s[40:43], s12 offen nt
    s_add_u32 s12, s71, 21504
    buffer_load_dwordx4 v[140:143], v30, s[40:43], s12 offen nt
    s_add_u32 s12, s71, 28672
    buffer_load_dwordx4 v[144:147], v30, s[40:43], s12 offen nt
    s_add_u32 s12, s71, 35840
    buffer_load_dwordx4 v[148:151], v30, s[40:43], s12 offen nt
    s_add_u32 s12, s71, 43008
    buffer_load_dwordx4 v[152:155], v30, s[40:43], s12 offen nt
    s_add_u32 s12, s71, 50176
    buffer_load_dwordx4 v[156:159], v30, s[40:43], s12 offen nt
    s_branch L_p3e0_2
L_p30_2:
    s_mov_b64 exec, 63
    s_bfe_u32 s12, s68, 0x4000c
    s_mul_i32 s12, s12, 393216
    buffer_load_dword v128, v32, s[28:31], s12 offen
    s_bfe_u32 s12, s68, 0x40010
    s_mul_i32 s12, s12, 393216
    buffer_load_dword v132, v32, s[28:31], s12 offen
    s_bfe_u32 s12, s68, 0x40014
    s_mul_i32 s12, s12, 393216
    buffer_load_dword v136, v32, s[28:31], s12 offen
    s_bfe_u32 s12, s68, 0x40018
    s_mul_i32 s12, s12, 393216
    buffer_load_dword v140, v32, s[28:31], s12 offen
    s_bfe_u32 s12, s68, 0x4001c
    s_mul_i32 s12, s12, 393216
    buffer_load_dword v144, v32, s[28:31], s12 offen
    s_bfe_u32 s12, s69, 0x40000
    s_mul_i32 s12, s12, 393216
    buffer_load_dword v148, v32, s[28:31], s12 offen
    s_bfe_u32 s12, s69, 0x40004
    s_mul_i32 s12, s12, 393216
    buffer_load_dword v152, v32, s[28:31], s12 offen
    s_bfe_u32 s12, s69, 0x40008
    s_mul_i32 s12, s12, 393216
    buffer_load_dword v156, v32, s[28:31], s12 offen
    s_mov_b64 exec, -1
L_p3e0_2:
    buffer_load_dword v15, v13, s[72:75], 0 offen offset:4 sc1
    v_add_f32 v93, v93, v117
    v_add_f32 v91, v91, v114
    v_add_f32 v93, v93, v118
    v_lshlrev_b32 v72, 16, v63
    v_and_b32 v63, s8, v63
    v_lshlrev_b32 v73, 16, v71
    v_and_b32 v71, s8, v71
    v_lshlrev_b32 v112, 16, v47
    v_and_b32 v47, s8, v47
    v_lshlrev_b32 v116, 16, v55
    v_and_b32 v55, s8, v55
    v_mul_f32 v113, v112, v73
    v_mul_f32 v114, v47, v71
    v_fmac_f32 v90, v112, v72
    v_mul_f32 v117, v116, v73
    v_mul_f32 v118, v55, v71
    v_fmac_f32 v92, v116, v72
    v_cvt_pk_bf16_f32 v113, 0, v113
    v_cvt_pk_bf16_f32 v114, 0, v114
    v_fmac_f32 v90, v47, v63
    v_cvt_pk_bf16_f32 v117, 0, v117
    v_cvt_pk_bf16_f32 v118, 0, v118
    v_fmac_f32 v92, v55, v63
    v_add_f32 v91, v91, v113
    v_add_f32 v93, v93, v117
    s_waitcnt vmcnt(19)
    s_barrier
    s_bfe_u32 s91, s68, 0x40014
    s_lshl_b32 s92, s91, 7
    s_mul_i32 s93, s91, 393216
    s_add_u32 m0, s94, 81920
    s_nop 0
    buffer_load_dwordx4 v20, s[24:27], s92 offen offset:0 lds
    v_add_f32 v91, v91, v114
    v_add_f32 v93, v93, v118
    v_add_f32_dpp v90, v90, v90 row_shr:1 row_mask:0xf bank_mask:0xf
    v_add_f32_dpp v91, v91, v91 row_shr:1 row_mask:0xf bank_mask:0xf
    v_add_f32_dpp v92, v92, v92 row_shr:1 row_mask:0xf bank_mask:0xf
    v_add_f32_dpp v93, v93, v93 row_shr:1 row_mask:0xf bank_mask:0xf
    v_add_f32_dpp v90, v90, v90 row_shr:2 row_mask:0xf bank_mask:0xf
    buffer_load_dwordx4 v21, s[24:27], s92 offen offset:1024 lds
    v_add_f32_dpp v91, v91, v91 row_shr:2 row_mask:0xf bank_mask:0xf
    v_add_f32_dpp v92, v92, v92 row_shr:2 row_mask:0xf bank_mask:0xf
    v_add_f32_dpp v93, v93, v93 row_shr:2 row_mask:0xf bank_mask:0xf
    v_add_f32_dpp v90, v90, v90 row_shr:4 row_mask:0xf bank_mask:0xf
    v_add_f32_dpp v91, v91, v91 row_shr:4 row_mask:0xf bank_mask:0xf
    v_add_f32_dpp v92, v92, v92 row_shr:4 row_mask:0xf bank_mask:0xf
    v_add_f32_dpp v93, v93, v93 row_shr:4 row_mask:0xf bank_mask:0xf
    buffer_load_dwordx4 v22, s[24:27], s92 offen offset:2048 lds
    v_add_f32_dpp v90, v90, v90 row_shr:8 row_mask:0xf bank_mask:0xf
    v_add_f32_dpp v91, v91, v91 row_shr:8 row_mask:0xf bank_mask:0xf
    v_add_f32_dpp v92, v92, v92 row_shr:8 row_mask:0xf bank_mask:0xf
    v_add_f32_dpp v93, v93, v93 row_shr:8 row_mask:0xf bank_mask:0xf
    v_add_f32_dpp v90, v90, v90 row_bcast:15 row_mask:0xa bank_mask:0xf
    v_add_f32_dpp v91, v91, v91 row_bcast:15 row_mask:0xa bank_mask:0xf
    v_add_f32_dpp v92, v92, v92 row_bcast:15 row_mask:0xa bank_mask:0xf
    buffer_load_dwordx4 v23, s[24:27], s92 offen offset:3072 lds
    v_add_f32_dpp v93, v93, v93 row_bcast:15 row_mask:0xa bank_mask:0xf
    v_add_f32_dpp v90, v90, v90 row_bcast:31 row_mask:0xc bank_mask:0xf
    v_add_f32_dpp v91, v91, v91 row_bcast:31 row_mask:0xc bank_mask:0xf
    v_add_f32_dpp v92, v92, v92 row_bcast:31 row_mask:0xc bank_mask:0xf
    v_add_f32_dpp v93, v93, v93 row_bcast:31 row_mask:0xc bank_mask:0xf
    v_mov_b32 v97, 0x8000
    v_mov_b32 v98, 0xffff
    s_add_u32 m0, s95, 106496
    s_nop 0
    buffer_load_dwordx4 v24, s[28:31], s93 offen offset:0 lds
    v_cvt_pk_bf16_f32 v94, v90, v91
    v_cvt_pk_bf16_f32 v104, v92, v93
    v_and_b32 v95, 0xffff, v94
    v_and_b32 v96, 0x8000, v94
    v_and_b32 v94, 0xffff0000, v94
    v_cmp_ne_u32 vcc, 0, v96
    v_mul_f32 v94, 0xbfb8aa3b, v94
    v_exp_f32 v94, v94
    v_cndmask_b32 v96, v97, v98, vcc
    v_xor_b32 v95, v95, v96
    v_add_f32 v94, 1.0, v94
    v_lshlrev_b32 v95, 11, v95
    v_rcp_f32 v94, v94
    s_sub_u32 s12, 2047, s22
    v_or_b32 v100, s12, v95
    v_cvt_pk_bf16_f32 v94, v94, v94
    v_lshlrev_b32 v102, 16, v94
    v_and_b32 v105, 0xffff, v104
    v_and_b32 v106, 0x8000, v104
    v_and_b32 v104, 0xffff0000, v104
    v_cmp_ne_u32 vcc, 0, v106
    v_mul_f32 v104, 0xbfb8aa3b, v104
    v_exp_f32 v104, v104
    v_cndmask_b32 v106, v97, v98, vcc
    v_xor_b32 v105, v105, v106
    v_add_f32 v104, 1.0, v104
    v_lshlrev_b32 v105, 11, v105
    v_rcp_f32 v104, v104
    s_sub_u32 s12, 2046, s22
    v_or_b32 v101, s12, v105
    v_cvt_pk_bf16_f32 v104, v104, v104
    v_lshlrev_b32 v103, 16, v104
    v_max_u32 v100, v100, v101
    s_lshl_b32 s12, s22, 2
    s_add_u32 s12, s12, 4096
    s_lshl_b32 s13, s21, 2
    s_add_u32 s13, s13, 162880
    v_mov_b32 v14, s13
    s_mov_b32 exec_lo, 0
    s_mov_b32 exec_hi, 0x80000000
    buffer_store_dwordx2 v[102:103], v13, s[32:35], s12 offen sc1
    ds_write_b32 v14, v100
    s_mov_b64 exec, -1
    s_waitcnt lgkmcnt(0)
    s_waitcnt vmcnt(15)
    s_barrier
    s_add_u32 m0, s95, 106496
    s_nop 0
    buffer_load_dwordx4 v25, s[28:31], s93 offen offset:1024 lds
    s_add_u32 m0, s95, 114688
    s_nop 0
    buffer_load_dwordx4 v26, s[28:31], s93 offen offset:0 lds
    buffer_load_dwordx4 v27, s[28:31], s93 offen offset:1024 lds
    s_add_u32 m0, s95, 98304
    s_nop 0
    buffer_load_dwordx4 v28, s[28:31], s93 offen offset:0 lds
    buffer_load_dwordx4 v29, s[28:31], s93 offen offset:1024 lds
    s_bfe_u32 s91, s68, 0x40018
    s_lshl_b32 s92, s91, 7
    s_mul_i32 s93, s91, 393216
    s_add_u32 m0, s94, 0
    s_nop 0
    buffer_load_dwordx4 v20, s[24:27], s92 offen offset:0 lds
    buffer_load_dwordx4 v21, s[24:27], s92 offen offset:1024 lds
    buffer_load_dwordx4 v22, s[24:27], s92 offen offset:2048 lds
    buffer_load_dwordx4 v23, s[24:27], s92 offen offset:3072 lds
    s_add_u32 m0, s95, 24576
    s_nop 0
    buffer_load_dwordx4 v24, s[28:31], s93 offen offset:0 lds
    buffer_load_dwordx4 v25, s[28:31], s93 offen offset:1024 lds
    s_add_u32 m0, s95, 32768
    s_nop 0
    buffer_load_dwordx4 v26, s[28:31], s93 offen offset:0 lds
    s_waitcnt vmcnt(12)
    s_waitcnt vmcnt(7)
    s_barrier
    s_add_u32 m0, s95, 32768
    s_nop 0
    buffer_load_dwordx4 v27, s[28:31], s93 offen offset:1024 lds
    s_add_u32 m0, s95, 16384
    s_nop 0
    buffer_load_dwordx4 v28, s[28:31], s93 offen offset:0 lds
    buffer_load_dwordx4 v29, s[28:31], s93 offen offset:1024 lds
    s_bfe_u32 s91, s68, 0x4001c
    s_lshl_b32 s92, s91, 7
    s_mul_i32 s93, s91, 393216
    s_add_u32 m0, s94, 40960
    s_nop 0
    buffer_load_dwordx4 v20, s[24:27], s92 offen offset:0 lds
    buffer_load_dwordx4 v21, s[24:27], s92 offen offset:1024 lds
    buffer_load_dwordx4 v22, s[24:27], s92 offen offset:2048 lds
    buffer_load_dwordx4 v23, s[24:27], s92 offen offset:3072 lds
    s_add_u32 m0, s95, 65536
    s_nop 0
    buffer_load_dwordx4 v24, s[28:31], s93 offen offset:0 lds
    buffer_load_dwordx4 v25, s[28:31], s93 offen offset:1024 lds
    s_add_u32 m0, s95, 73728
    s_nop 0
    buffer_load_dwordx4 v26, s[28:31], s93 offen offset:0 lds
    buffer_load_dwordx4 v27, s[28:31], s93 offen offset:1024 lds
    s_add_u32 m0, s95, 57344
    s_nop 0
    buffer_load_dwordx4 v28, s[28:31], s93 offen offset:0 lds
    s_mov_b32 s13, 0
L_tagchk_2:
    v_readfirstlane_b32 s23, v15
    s_nop 1
    s_cmp_lg_u32 s23, 0
    s_cbranch_scc1 L_tagok_2
    s_add_u32 s13, s13, 1
    s_cmp_ge_u32 s13, 16384
    s_cbranch_scc1 L_tagok_2
    buffer_load_dword v15, v13, s[72:75], 0 offen offset:4 sc1
    s_waitcnt vmcnt(0)
    s_branch L_tagchk_2
L_tagok_2:
    s_and_b32 s76, s23, 0xff
    s_bfe_u32 s77, s23, 0x80008
    s_bfe_u32 s78, s23, 0x80010
    s_lshr_b32 s79, s23, 24
    v_and_b32 v35, 3, v2
    v_lshlrev_b32 v35, 3, v35
    v_bfe_u32 v35, s23, v35, 8
    s_cmp_lg_u32 s21, 0
    s_cbranch_scc1 L_nopub_2
    v_mov_b32 v14, 162880
    ds_read_b128 v[104:107], v14
    s_lshl_b32 s12, s2, 3
    s_add_u32 s12, s12, 0
    s_waitcnt lgkmcnt(0)
    v_max3_u32 v104, v104, v105, v106
    v_max_u32 v104, v104, v107
    v_mov_b32 v105, s23
    s_mov_b64 exec, 1
    buffer_store_dwordx2 v[104:105], v13, s[32:35], s12 offen sc1
    s_mov_b64 exec, -1
L_nopub_2:
    s_waitcnt vmcnt(9)
    s_barrier
    s_add_u32 m0, s95, 57344
    s_nop 0
    buffer_load_dwordx4 v29, s[28:31], s93 offen offset:1024 lds
    s_bfe_u32 s91, s69, 0x40000
    s_lshl_b32 s92, s91, 7
    s_mul_i32 s93, s91, 393216
    s_add_u32 m0, s94, 81920
    s_nop 0
    buffer_load_dwordx4 v20, s[24:27], s92 offen offset:0 lds
    buffer_load_dwordx4 v21, s[24:27], s92 offen offset:1024 lds
    buffer_load_dwordx4 v22, s[24:27], s92 offen offset:2048 lds
    buffer_load_dwordx4 v23, s[24:27], s92 offen offset:3072 lds
    s_add_u32 m0, s95, 106496
    s_nop 0
    buffer_load_dwordx4 v24, s[28:31], s93 offen offset:0 lds
    buffer_load_dwordx4 v25, s[28:31], s93 offen offset:1024 lds
    s_add_u32 m0, s95, 114688
    s_nop 0
    buffer_load_dwordx4 v26, s[28:31], s93 offen offset:0 lds
    buffer_load_dwordx4 v27, s[28:31], s93 offen offset:1024 lds
    s_add_u32 m0, s95, 98304
    s_nop 0
    buffer_load_dwordx4 v28, s[28:31], s93 offen offset:0 lds
    buffer_load_dwordx4 v29, s[28:31], s93 offen offset:1024 lds
    s_waitcnt vmcnt(10)
    s_barrier
    s_bfe_u32 s91, s69, 0x40004
    s_lshl_b32 s92, s91, 7
    s_mul_i32 s93, s91, 393216
    s_add_u32 m0, s94, 0
    s_nop 0
    buffer_load_dwordx4 v20, s[24:27], s92 offen offset:0 lds
    buffer_load_dwordx4 v21, s[24:27], s92 offen offset:1024 lds
    buffer_load_dwordx4 v22, s[24:27], s92 offen offset:2048 lds
    buffer_load_dwordx4 v23, s[24:27], s92 offen offset:3072 lds
    s_add_u32 m0, s95, 24576
    s_nop 0
    buffer_load_dwordx4 v24, s[28:31], s93 offen offset:0 lds
    buffer_load_dwordx4 v25, s[28:31], s93 offen offset:1024 lds
    s_add_u32 m0, s95, 32768
    s_nop 0
    buffer_load_dwordx4 v26, s[28:31], s93 offen offset:0 lds
    buffer_load_dwordx4 v27, s[28:31], s93 offen offset:1024 lds
    s_add_u32 m0, s95, 16384
    s_nop 0
    buffer_load_dwordx4 v28, s[28:31], s93 offen offset:0 lds
    buffer_load_dwordx4 v29, s[28:31], s93 offen offset:1024 lds
    s_cmp_ge_u32 s10, 224
    s_cbranch_scc1 L_p31_2
    s_add_u32 s12, s9, 0
    buffer_load_dwordx4 v[160:163], v30, s[44:47], s12 offen nt
    s_add_u32 s12, s9, 7168
    buffer_load_dwordx4 v[164:167], v30, s[44:47], s12 offen nt
    s_add_u32 s12, s9, 14336
    buffer_load_dwordx4 v[168:171], v30, s[44:47], s12 offen nt
    s_add_u32 s12, s9, 21504
    buffer_load_dwordx4 v[172:175], v30, s[44:47], s12 offen nt
    s_add_u32 s12, s9, 28672
    buffer_load_dwordx4 v[176:179], v30, s[44:47], s12 offen nt
    s_add_u32 s12, s9, 35840
    buffer_load_dwordx4 v[180:183], v30, s[44:47], s12 offen nt
    s_add_u32 s12, s9, 43008
    buffer_load_dwordx4 v[184:187], v30, s[44:47], s12 offen nt
    s_add_u32 s12, s9, 50176
    buffer_load_dwordx4 v[188:191], v30, s[44:47], s12 offen nt
    s_branch L_p3e1_2
L_p31_2:
    s_mov_b64 exec, 63
    s_bfe_u32 s12, s69, 0x4000c
    s_mul_i32 s12, s12, 393216
    buffer_load_dword v160, v32, s[28:31], s12 offen
    s_bfe_u32 s12, s69, 0x40010
    s_mul_i32 s12, s12, 393216
    buffer_load_dword v164, v32, s[28:31], s12 offen
    s_bfe_u32 s12, s69, 0x40014
    s_mul_i32 s12, s12, 393216
    buffer_load_dword v168, v32, s[28:31], s12 offen
    s_bfe_u32 s12, s69, 0x40018
    s_mul_i32 s12, s12, 393216
    buffer_load_dword v172, v32, s[28:31], s12 offen
    s_bfe_u32 s12, s69, 0x4001c
    s_mul_i32 s12, s12, 393216
    buffer_load_dword v176, v32, s[28:31], s12 offen
    s_mov_b64 exec, 1
    s_bfe_u32 s12, s69, 0x4001c
    s_mul_i32 s12, s12, 393216
    buffer_load_dword v180, v32, s[28:31], s12 offen
    s_bfe_u32 s12, s69, 0x4001c
    s_mul_i32 s12, s12, 393216
    buffer_load_dword v184, v32, s[28:31], s12 offen
    s_bfe_u32 s12, s69, 0x4001c
    s_mul_i32 s12, s12, 393216
    buffer_load_dword v188, v32, s[28:31], s12 offen
    s_mov_b64 exec, -1
L_p3e1_2:
    s_mov_b32 exec_lo, 0xffff0000
    s_mov_b32 exec_hi, 0
    buffer_load_dword v19, v10, s[36:39], 0 offen
    s_mov_b64 exec, -1
    s_waitcnt vmcnt(19)
    s_barrier
    s_bfe_u32 s91, s69, 0x40008
    s_lshl_b32 s92, s91, 7
    s_mul_i32 s93, s91, 393216
    s_add_u32 m0, s94, 40960
    s_nop 0
    buffer_load_dwordx4 v20, s[24:27], s92 offen offset:0 lds
    buffer_load_dwordx4 v21, s[24:27], s92 offen offset:1024 lds
    buffer_load_dwordx4 v22, s[24:27], s92 offen offset:2048 lds
    buffer_load_dwordx4 v23, s[24:27], s92 offen offset:3072 lds
    s_add_u32 m0, s95, 65536
    s_nop 0
    buffer_load_dwordx4 v24, s[28:31], s93 offen offset:0 lds
    s_waitcnt vmcnt(14)
    s_barrier
    s_add_u32 m0, s95, 65536
    s_nop 0
    buffer_load_dwordx4 v25, s[28:31], s93 offen offset:1024 lds
    s_add_u32 m0, s95, 73728
    s_nop 0
    buffer_load_dwordx4 v26, s[28:31], s93 offen offset:0 lds
    buffer_load_dwordx4 v27, s[28:31], s93 offen offset:1024 lds
    s_add_u32 m0, s95, 57344
    s_nop 0
    buffer_load_dwordx4 v28, s[28:31], s93 offen offset:0 lds
    buffer_load_dwordx4 v29, s[28:31], s93 offen offset:1024 lds
    s_bfe_u32 s91, s69, 0x4000c
    s_lshl_b32 s92, s91, 7
    s_mul_i32 s93, s91, 393216
    s_add_u32 m0, s94, 122880
    s_nop 0
    buffer_load_dwordx4 v20, s[24:27], s92 offen offset:0 lds
    buffer_load_dwordx4 v21, s[24:27], s92 offen offset:1024 lds
    buffer_load_dwordx4 v22, s[24:27], s92 offen offset:2048 lds
    buffer_load_dwordx4 v23, s[24:27], s92 offen offset:3072 lds
    s_add_u32 m0, s95, 106496
    s_nop 0
    buffer_load_dwordx4 v24, s[28:31], s93 offen offset:0 lds
    buffer_load_dwordx4 v25, s[28:31], s93 offen offset:1024 lds
    s_add_u32 m0, s95, 114688
    s_nop 0
    buffer_load_dwordx4 v26, s[28:31], s93 offen offset:0 lds
    s_mov_b32 s12, 0
    buffer_load_dwordx4 v[104:107], v5, s[32:35], s12 offen offset:0 sc1
    buffer_load_dwordx4 v[108:111], v5, s[32:35], s12 offen offset:1024 sc1
    s_waitcnt vmcnt(9)
    s_barrier
    s_add_u32 m0, s95, 114688
    s_nop 0
    buffer_load_dwordx4 v27, s[28:31], s93 offen offset:1024 lds
    s_bfe_u32 s91, s69, 0x40010
    s_lshl_b32 s92, s91, 7
    s_mul_i32 s93, s91, 393216
    s_add_u32 m0, s94, 139264
    s_nop 0
    buffer_load_dwordx4 v20, s[24:27], s92 offen offset:0 lds
    buffer_load_dwordx4 v21, s[24:27], s92 offen offset:1024 lds
    buffer_load_dwordx4 v22, s[24:27], s92 offen offset:2048 lds
    buffer_load_dwordx4 v23, s[24:27], s92 offen offset:3072 lds
    s_add_u32 m0, s95, 24576
    s_nop 0
    buffer_load_dwordx4 v24, s[28:31], s93 offen offset:0 lds
    buffer_load_dwordx4 v25, s[28:31], s93 offen offset:1024 lds
    s_add_u32 m0, s95, 32768
    s_nop 0
    buffer_load_dwordx4 v26, s[28:31], s93 offen offset:0 lds
    buffer_load_dwordx4 v27, s[28:31], s93 offen offset:1024 lds
    s_waitcnt vmcnt(8)
    s_barrier
    s_bfe_u32 s91, s69, 0x40014
    s_lshl_b32 s92, s91, 7
    s_mul_i32 s93, s91, 393216
    s_add_u32 m0, s94, 40960
    s_nop 0
    buffer_load_dwordx4 v20, s[24:27], s92 offen offset:0 lds
    s_mov_b32 s13, 0
    v_xor_b32 v105, s23, v105
    v_xor_b32 v107, s23, v107
    v_xor_b32 v109, s23, v109
    v_xor_b32 v111, s23, v111
    v_or3_b32 v105, v105, v107, v109
    v_or_b32 v105, v105, v111
    v_cmp_ne_u32 vcc, 0, v105
    s_cbranch_vccnz L_keyre_2
L_keyok_2:
    buffer_load_dwordx4 v21, s[24:27], s92 offen offset:1024 lds
    v_max3_u32 v104, v104, v106, v108
    v_max_u32 v104, v104, v110
    s_nop 1
    v_max_u32_dpp v104, v104, v104 row_shr:1 row_mask:0xf bank_mask:0xf
    s_nop 1
    v_max_u32_dpp v104, v104, v104 row_shr:2 row_mask:0xf bank_mask:0xf
    s_nop 1
    v_max_u32_dpp v104, v104, v104 row_shr:4 row_mask:0xf bank_mask:0xf
    s_nop 1
    v_max_u32_dpp v104, v104, v104 row_shr:8 row_mask:0xf bank_mask:0xf
    s_nop 1
    v_max_u32_dpp v104, v104, v104 row_bcast:15 row_mask:0xa bank_mask:0xf
    buffer_load_dwordx4 v22, s[24:27], s92 offen offset:2048 lds
    s_nop 0
    v_max_u32_dpp v104, v104, v104 row_bcast:31 row_mask:0xc bank_mask:0xf
    s_nop 0
    v_readlane_b32 s14, v104, 63
    s_nop 1
    s_and_b32 s15, s14, 2047
    s_sub_u32 s15, 2047, s15
    s_lshl_b32 s12, s15, 11
    s_lshl_b32 s13, s70, 1
    s_add_u32 s12, s12, s13
    buffer_load_dwordx4 v[36:39], v34, s[24:27], s12 offen
    s_lshr_b32 s12, s14, 11
    s_and_b32 s13, s12, 0x8000
    s_cmp_lg_u32 s13, 0
    s_mov_b32 s13, 0xffff
    s_cselect_b32 s13, 0x8000, s13
    s_xor_b32 s12, s12, s13
    s_lshl_b32 s12, s12, 16
    v_mov_b32 v105, s12
    buffer_load_dwordx4 v23, s[24:27], s92 offen offset:3072 lds
    v_mul_f32 v105, 0xbfb8aa3b, v105
    v_exp_f32 v105, v105
    s_nop 0
    v_add_f32 v105, 1.0, v105
    v_rcp_f32 v105, v105
    s_nop 0
    v_cvt_pk_bf16_f32 v105, v105, v105
    v_lshlrev_b32 v105, 16, v105
    s_add_u32 s12, s15, 1
    v_mov_b32 v104, s12
    s_add_u32 m0, s95, 65536
    s_nop 0
    buffer_load_dwordx4 v24, s[28:31], s93 offen offset:0 lds
    v_mov_b32 v106, s23
    v_readfirstlane_b32 s14, v105
    v_mov_b32 v14, 162864
    s_mov_b64 exec, 1
    ds_write_b96 v14, v[104:106]
    s_mov_b64 exec, -1
    s_waitcnt lgkmcnt(0)
    buffer_load_dwordx4 v25, s[28:31], s93 offen offset:1024 lds
    s_add_u32 m0, s95, 73728
    s_nop 0
    buffer_load_dwordx4 v26, s[28:31], s93 offen offset:0 lds
    buffer_load_dwordx4 v27, s[28:31], s93 offen offset:1024 lds
    s_waitcnt vmcnt(9)
    s_barrier
    s_bfe_u32 s91, s69, 0x40018
    s_lshl_b32 s92, s91, 7
    s_mul_i32 s93, s91, 393216
    s_add_u32 m0, s94, 81920
    s_nop 0
    buffer_load_dwordx4 v20, s[24:27], s92 offen offset:0 lds
    s_waitcnt vmcnt(6)
    s_mov_b32 s8, 0xffff0000
    v_lshlrev_b32 v40, 16, v36
    v_and_b32 v41, s8, v36
    v_lshlrev_b32 v42, 16, v37
    v_and_b32 v43, s8, v37
    v_lshlrev_b32 v44, 16, v38
    buffer_load_dwordx4 v21, s[24:27], s92 offen offset:1024 lds
    v_and_b32 v45, s8, v38
    v_lshlrev_b32 v46, 16, v39
    v_and_b32 v47, s8, v39
    v_lshlrev_b32 v48, 16, v128
    v_lshlrev_b32 v49, 16, v129
    v_and_b32 v128, s8, v128
    v_and_b32 v129, s8, v129
    buffer_load_dwordx4 v22, s[24:27], s92 offen offset:2048 lds
    v_mul_f32 v220, v48, v40
    v_mul_f32 v222, v49, v40
    v_mul_f32 v221, v128, v40
    v_mul_f32 v223, v129, v40
    v_lshlrev_b32 v50, 16, v130
    v_lshlrev_b32 v51, 16, v131
    v_and_b32 v130, s8, v130
    buffer_load_dwordx4 v23, s[24:27], s92 offen offset:3072 lds
    v_and_b32 v131, s8, v131
    v_mul_f32 v224, v50, v40
    v_mul_f32 v226, v51, v40
    v_mul_f32 v225, v130, v40
    v_mul_f32 v227, v131, v40
    v_lshlrev_b32 v48, 16, v160
    v_lshlrev_b32 v49, 16, v161
    s_add_u32 m0, s95, 106496
    s_nop 0
    buffer_load_dwordx4 v24, s[28:31], s93 offen offset:0 lds
    v_and_b32 v160, s8, v160
    v_and_b32 v161, s8, v161
    v_mul_f32 v228, v48, v40
    v_mul_f32 v230, v49, v40
    v_mul_f32 v229, v160, v40
    v_mul_f32 v231, v161, v40
    v_lshlrev_b32 v50, 16, v162
    buffer_load_dwordx4 v25, s[28:31], s93 offen offset:1024 lds
    v_lshlrev_b32 v51, 16, v163
    v_and_b32 v162, s8, v162
    v_and_b32 v163, s8, v163
    v_mul_f32 v232, v50, v40
    v_mul_f32 v234, v51, v40
    v_mul_f32 v233, v162, v40
    v_mul_f32 v235, v163, v40
    s_add_u32 m0, s95, 114688
    s_nop 0
    buffer_load_dwordx4 v26, s[28:31], s93 offen offset:0 lds
    v_lshlrev_b32 v48, 16, v132
    v_lshlrev_b32 v49, 16, v133
    v_and_b32 v132, s8, v132
    v_and_b32 v133, s8, v133
    v_fmac_f32 v220, v48, v41
    v_fmac_f32 v222, v49, v41
    v_fmac_f32 v221, v132, v41
    v_fmac_f32 v223, v133, v41
    v_lshlrev_b32 v50, 16, v134
    v_lshlrev_b32 v51, 16, v135
    v_and_b32 v134, s8, v134
    v_and_b32 v135, s8, v135
    v_fmac_f32 v224, v50, v41
    v_fmac_f32 v226, v51, v41
    buffer_load_dwordx4 v27, s[28:31], s93 offen offset:1024 lds
    v_fmac_f32 v225, v134, v41
    v_fmac_f32 v227, v135, v41
    v_lshlrev_b32 v48, 16, v164
    v_lshlrev_b32 v49, 16, v165
    v_and_b32 v164, s8, v164
    v_and_b32 v165, s8, v165
    v_fmac_f32 v228, v48, v41
    v_fmac_f32 v230, v49, v41
    v_fmac_f32 v229, v164, v41
    v_fmac_f32 v231, v165, v41
    v_lshlrev_b32 v50, 16, v166
    v_lshlrev_b32 v51, 16, v167
    v_and_b32 v166, s8, v166
    v_and_b32 v167, s8, v167
    s_add_u32 s12, s97, 0
    buffer_load_dwordx4 v[192:195], v31, s[64:67], s12 offen nt
    s_add_u32 s12, s97, 16384
    buffer_load_dwordx4 v[196:199], v31, s[64:67], s12 offen nt
    s_add_u32 s12, s97, 32768
    buffer_load_dwordx4 v[200:203], v31, s[64:67], s12 offen nt
    s_add_u32 s12, s97, 49152
    buffer_load_dwordx4 v[204:207], v31, s[64:67], s12 offen nt
    s_add_u32 s12, s97, 65536
    buffer_load_dwordx4 v[208:211], v31, s[64:67], s12 offen nt
    s_add_u32 s12, s97, 81920
    buffer_load_dwordx4 v[212:215], v31, s[64:67], s12 offen nt
    s_add_u32 s12, s97, 98304
    buffer_load_dwordx4 v[216:219], v31, s[64:67], s12 offen nt
    v_fmac_f32 v232, v50, v41
    v_fmac_f32 v234, v51, v41
    v_fmac_f32 v233, v166, v41
    v_fmac_f32 v235, v167, v41
    v_lshlrev_b32 v48, 16, v136
    v_lshlrev_b32 v49, 16, v137
    v_and_b32 v136, s8, v136
    v_and_b32 v137, s8, v137
    v_fmac_f32 v220, v48, v42
    v_fmac_f32 v222, v49, v42
    v_fmac_f32 v221, v136, v42
    v_fmac_f32 v223, v137, v42
    v_lshlrev_b32 v50, 16, v138
    v_lshlrev_b32 v51, 16, v139
    v_and_b32 v138, s8, v138
    v_and_b32 v139, s8, v139
    v_fmac_f32 v224, v50, v42
    v_fmac_f32 v226, v51, v42
    v_fmac_f32 v225, v138, v42
    v_fmac_f32 v227, v139, v42
    v_lshlrev_b32 v48, 16, v168
    v_lshlrev_b32 v49, 16, v169
    v_and_b32 v168, s8, v168
    v_and_b32 v169, s8, v169
    v_fmac_f32 v228, v48, v42
    s_waitcnt vmcnt(15)
    s_barrier
    s_bfe_u32 s91, s69, 0x4001c
    s_lshl_b32 s92, s91, 7
    s_mul_i32 s93, s91, 393216
    s_add_u32 m0, s94, 0
    s_nop 0
    buffer_load_dwordx4 v20, s[24:27], s92 offen offset:0 lds
    v_fmac_f32 v230, v49, v42
    v_fmac_f32 v229, v168, v42
    v_fmac_f32 v231, v169, v42
    v_lshlrev_b32 v50, 16, v170
    v_lshlrev_b32 v51, 16, v171
    v_and_b32 v170, s8, v170
    v_and_b32 v171, s8, v171
    buffer_load_dwordx4 v21, s[24:27], s92 offen offset:1024 lds
    v_fmac_f32 v232, v50, v42
    v_fmac_f32 v234, v51, v42
    v_fmac_f32 v233, v170, v42
    v_fmac_f32 v235, v171, v42
    v_lshlrev_b32 v48, 16, v140
    v_lshlrev_b32 v49, 16, v141
    v_and_b32 v140, s8, v140
    buffer_load_dwordx4 v22, s[24:27], s92 offen offset:2048 lds
    v_and_b32 v141, s8, v141
    v_fmac_f32 v220, v48, v43
    v_fmac_f32 v222, v49, v43
    v_fmac_f32 v221, v140, v43
    v_fmac_f32 v223, v141, v43
    v_lshlrev_b32 v50, 16, v142
    v_lshlrev_b32 v51, 16, v143
    buffer_load_dwordx4 v23, s[24:27], s92 offen offset:3072 lds
    v_and_b32 v142, s8, v142
    v_and_b32 v143, s8, v143
    v_fmac_f32 v224, v50, v43
    v_fmac_f32 v226, v51, v43
    v_fmac_f32 v225, v142, v43
    v_fmac_f32 v227, v143, v43
    v_lshlrev_b32 v48, 16, v172
    s_add_u32 m0, s95, 24576
    s_nop 0
    buffer_load_dwordx4 v24, s[28:31], s93 offen offset:0 lds
    v_lshlrev_b32 v49, 16, v173
    v_and_b32 v172, s8, v172
    v_and_b32 v173, s8, v173
    v_fmac_f32 v228, v48, v43
    v_fmac_f32 v230, v49, v43
    v_fmac_f32 v229, v172, v43
    v_fmac_f32 v231, v173, v43
    v_lshlrev_b32 v50, 16, v174
    v_lshlrev_b32 v51, 16, v175
    v_and_b32 v174, s8, v174
    v_and_b32 v175, s8, v175
    v_fmac_f32 v232, v50, v43
    v_fmac_f32 v234, v51, v43
    v_fmac_f32 v233, v174, v43
    v_fmac_f32 v235, v175, v43
    v_lshlrev_b32 v48, 16, v144
    v_lshlrev_b32 v49, 16, v145
    v_and_b32 v144, s8, v144
    v_and_b32 v145, s8, v145
    v_fmac_f32 v220, v48, v44
    v_fmac_f32 v222, v49, v44
    v_fmac_f32 v221, v144, v44
    v_fmac_f32 v223, v145, v44
    v_lshlrev_b32 v50, 16, v146
    v_lshlrev_b32 v51, 16, v147
    v_and_b32 v146, s8, v146
    v_and_b32 v147, s8, v147
    v_fmac_f32 v224, v50, v44
    v_fmac_f32 v226, v51, v44
    v_fmac_f32 v225, v146, v44
    v_fmac_f32 v227, v147, v44
    v_lshlrev_b32 v48, 16, v176
    s_waitcnt vmcnt(12)
    s_barrier
    s_add_u32 m0, s95, 24576
    s_nop 0
    buffer_load_dwordx4 v25, s[28:31], s93 offen offset:1024 lds
    v_lshlrev_b32 v49, 16, v177
    v_and_b32 v176, s8, v176
    v_and_b32 v177, s8, v177
    v_fmac_f32 v228, v48, v44
    v_fmac_f32 v230, v49, v44
    v_fmac_f32 v229, v176, v44
    v_fmac_f32 v231, v177, v44
    s_add_u32 m0, s95, 32768
    s_nop 0
    buffer_load_dwordx4 v26, s[28:31], s93 offen offset:0 lds
    v_lshlrev_b32 v50, 16, v178
    v_lshlrev_b32 v51, 16, v179
    v_and_b32 v178, s8, v178
    v_and_b32 v179, s8, v179
    v_fmac_f32 v232, v50, v44
    v_fmac_f32 v234, v51, v44
    v_fmac_f32 v233, v178, v44
    v_fmac_f32 v235, v179, v44
    v_lshlrev_b32 v48, 16, v148
    v_lshlrev_b32 v49, 16, v149
    v_and_b32 v148, s8, v148
    v_and_b32 v149, s8, v149
    v_fmac_f32 v220, v48, v45
    v_fmac_f32 v222, v49, v45
    buffer_load_dwordx4 v27, s[28:31], s93 offen offset:1024 lds
    v_fmac_f32 v221, v148, v45
    v_fmac_f32 v223, v149, v45
    v_lshlrev_b32 v50, 16, v150
    v_lshlrev_b32 v51, 16, v151
    v_and_b32 v150, s8, v150
    v_and_b32 v151, s8, v151
    v_fmac_f32 v224, v50, v45
    v_fmac_f32 v226, v51, v45
    v_fmac_f32 v225, v150, v45
    v_fmac_f32 v227, v151, v45
    v_lshlrev_b32 v48, 16, v180
    v_lshlrev_b32 v49, 16, v181
    v_and_b32 v180, s8, v180
    v_and_b32 v181, s8, v181
    s_bfe_u32 s12, s69, 0x4000c
    s_mul_i32 s12, s12, 393216
    s_add_u32 m0, s95, 16384
    s_nop 0
    buffer_load_dwordx4 v28, s[28:31], s12 offen offset:0 lds
    buffer_load_dwordx4 v29, s[28:31], s12 offen offset:1024 lds
    s_bfe_u32 s12, s69, 0x40010
    s_mul_i32 s12, s12, 393216
    s_add_u32 m0, s95, 57344
    s_nop 0
    buffer_load_dwordx4 v28, s[28:31], s12 offen offset:0 lds
    buffer_load_dwordx4 v29, s[28:31], s12 offen offset:1024 lds
    s_mul_i32 s12, s21, 16
    s_add_u32 s12, s12, 0
    s_and_b32 s90, s88, 1
    s_lshl_b32 s90, s90, 6
    s_xor_b32 s12, s12, s90
    s_lshl_b32 s12, s12, 14
    s_add_u32 s90, s12, 0
    buffer_load_dwordx4 v[84:87], v33, s[36:39], s90 offen
    s_add_u32 s90, s12, 16384
    buffer_load_dwordx4 v[88:91], v33, s[36:39], s90 offen
    s_add_u32 s90, s12, 32768
    buffer_load_dwordx4 v[92:95], v33, s[36:39], s90 offen
    s_add_u32 s90, s12, 49152
    buffer_load_dwordx4 v[96:99], v33, s[36:39], s90 offen
    s_add_u32 s90, s12, 65536
    buffer_load_dwordx4 v[100:103], v33, s[36:39], s90 offen
    s_add_u32 s90, s12, 81920
    buffer_load_dwordx4 v[116:119], v33, s[36:39], s90 offen
    s_add_u32 s90, s12, 98304
    buffer_load_dwordx4 v[120:123], v33, s[36:39], s90 offen
    s_add_u32 s90, s12, 114688
    buffer_load_dwordx4 v[124:127], v33, s[36:39], s90 offen
    s_add_u32 s90, s12, 131072
    buffer_load_dwordx4 v[64:67], v33, s[36:39], s90 offen
    v_fmac_f32 v228, v48, v45
    v_fmac_f32 v230, v49, v45
    v_fmac_f32 v229, v180, v45
    v_fmac_f32 v231, v181, v45
    v_lshlrev_b32 v50, 16, v182
    v_lshlrev_b32 v51, 16, v183
    v_and_b32 v182, s8, v182
    v_and_b32 v183, s8, v183
    v_fmac_f32 v232, v50, v45
    v_fmac_f32 v234, v51, v45
    v_fmac_f32 v233, v182, v45
    v_fmac_f32 v235, v183, v45
    v_lshlrev_b32 v48, 16, v152
    v_lshlrev_b32 v49, 16, v153
    v_and_b32 v152, s8, v152
    v_and_b32 v153, s8, v153
    v_fmac_f32 v220, v48, v46
    v_fmac_f32 v222, v49, v46
    v_fmac_f32 v221, v152, v46
    v_fmac_f32 v223, v153, v46
    v_lshlrev_b32 v50, 16, v154
    v_lshlrev_b32 v51, 16, v155
    v_and_b32 v154, s8, v154
    v_and_b32 v155, s8, v155
    v_fmac_f32 v224, v50, v46
    s_waitcnt vmcnt(13)
    s_barrier
    v_fmac_f32 v226, v51, v46
    v_fmac_f32 v225, v154, v46
    v_fmac_f32 v227, v155, v46
    v_lshlrev_b32 v48, 16, v184
    v_lshlrev_b32 v49, 16, v185
    v_and_b32 v184, s8, v184
    v_and_b32 v185, s8, v185
    v_fmac_f32 v228, v48, v46
    v_fmac_f32 v230, v49, v46
    v_fmac_f32 v229, v184, v46
    v_fmac_f32 v231, v185, v46
    v_lshlrev_b32 v50, 16, v186
    v_lshlrev_b32 v51, 16, v187
    v_and_b32 v186, s8, v186
    v_and_b32 v187, s8, v187
    v_fmac_f32 v232, v50, v46
    v_fmac_f32 v234, v51, v46
    v_fmac_f32 v233, v186, v46
    v_fmac_f32 v235, v187, v46
    v_lshlrev_b32 v48, 16, v156
    v_lshlrev_b32 v49, 16, v157
    v_and_b32 v156, s8, v156
    v_and_b32 v157, s8, v157
    v_fmac_f32 v220, v48, v47
    v_fmac_f32 v222, v49, v47
    v_fmac_f32 v221, v156, v47
    v_fmac_f32 v223, v157, v47
    v_lshlrev_b32 v50, 16, v158
    v_lshlrev_b32 v51, 16, v159
    v_and_b32 v158, s8, v158
    v_and_b32 v159, s8, v159
    v_fmac_f32 v224, v50, v47
    v_fmac_f32 v226, v51, v47
    v_fmac_f32 v225, v158, v47
    v_fmac_f32 v227, v159, v47
    v_lshlrev_b32 v48, 16, v188
    v_lshlrev_b32 v49, 16, v189
    v_and_b32 v188, s8, v188
    v_and_b32 v189, s8, v189
    v_fmac_f32 v228, v48, v47
    v_fmac_f32 v230, v49, v47
    v_fmac_f32 v229, v188, v47
    v_fmac_f32 v231, v189, v47
    v_lshlrev_b32 v50, 16, v190
    v_lshlrev_b32 v51, 16, v191
    v_and_b32 v190, s8, v190
    v_and_b32 v191, s8, v191
    v_fmac_f32 v232, v50, v47
    v_fmac_f32 v234, v51, v47
    v_fmac_f32 v233, v190, v47
    v_fmac_f32 v235, v191, v47
    v_permlane32_swap_b32 v220, v228
    v_permlane32_swap_b32 v221, v229
    v_permlane32_swap_b32 v222, v230
    v_permlane32_swap_b32 v223, v231
    v_permlane32_swap_b32 v224, v232
    v_permlane32_swap_b32 v225, v233
    v_permlane32_swap_b32 v226, v234
    v_permlane32_swap_b32 v227, v235
    v_add_f32 v220, v220, v228
    v_add_f32 v221, v221, v229
    v_add_f32 v222, v222, v230
    v_add_f32 v223, v223, v231
    v_add_f32 v224, v224, v232
    v_add_f32 v225, v225, v233
    v_add_f32 v226, v226, v234
    v_add_f32 v227, v227, v235
    v_permlane16_swap_b32 v220, v224
    v_permlane16_swap_b32 v221, v225
    v_permlane16_swap_b32 v222, v226
    v_permlane16_swap_b32 v223, v227
    v_add_f32 v220, v220, v224
    v_add_f32 v221, v221, v225
    v_add_f32 v222, v222, v226
    v_add_f32 v223, v223, v227
    v_add_f32_dpp v220, v220, v220 row_ror:8 row_mask:0xf bank_mask:0xf
    v_add_f32_dpp v221, v221, v221 row_ror:8 row_mask:0xf bank_mask:0xf
    v_add_f32_dpp v222, v222, v222 row_ror:8 row_mask:0xf bank_mask:0xf
    v_add_f32_dpp v223, v223, v223 row_ror:8 row_mask:0xf bank_mask:0xf
    s_branch L_varend
L_var3:
    s_nop 0
    s_add_u32 m0, s95, 73728
    s_nop 0
    buffer_load_dwordx4 v26, s[28:31], s93 offen offset:0 lds
    buffer_load_dwordx4 v27, s[28:31], s93 offen offset:1024 lds
    s_add_u32 m0, s95, 57344
    s_nop 0
    buffer_load_dwordx4 v28, s[28:31], s93 offen offset:0 lds
    buffer_load_dwordx4 v29, s[28:31], s93 offen offset:1024 lds
    s_bfe_u32 s91, s68, 0x40008
    s_lshl_b32 s92, s91, 7
    s_mul_i32 s93, s91, 393216
    s_add_u32 m0, s94, 81920
    s_nop 0
    buffer_load_dwordx4 v20, s[24:27], s92 offen offset:0 lds
    buffer_load_dwordx4 v21, s[24:27], s92 offen offset:1024 lds
    buffer_load_dwordx4 v22, s[24:27], s92 offen offset:2048 lds
    buffer_load_dwordx4 v23, s[24:27], s92 offen offset:3072 lds
    s_add_u32 m0, s95, 106496
    s_nop 0
    buffer_load_dwordx4 v24, s[28:31], s93 offen offset:0 lds
    buffer_load_dwordx4 v25, s[28:31], s93 offen offset:1024 lds
    s_add_u32 m0, s95, 114688
    s_nop 0
    buffer_load_dwordx4 v26, s[28:31], s93 offen offset:0 lds
    buffer_load_dwordx4 v27, s[28:31], s93 offen offset:1024 lds
    s_add_u32 m0, s95, 98304
    s_nop 0
    buffer_load_dwordx4 v28, s[28:31], s93 offen offset:0 lds
    buffer_load_dwordx4 v29, s[28:31], s93 offen offset:1024 lds
    s_lshl_b32 s12, s19, 2
    s_add_u32 s12, s12, s21
    s_lshl_b32 s12, s12, 10
    s_lshl_b32 s13, s21, 10
    s_add_u32 m0, s13, 155648
    s_nop 0
    buffer_load_dwordx4 v5, s[76:79], s12 offen lds
    s_lshl_b32 s12, s22, 11
    buffer_load_dwordx4 v[40:43], v5, s[24:27], s12 offen offset:0
    buffer_load_dwordx4 v[44:47], v5, s[24:27], s12 offen offset:1024
    buffer_load_dwordx4 v[48:51], v5, s[24:27], s12 offen offset:2048
    buffer_load_dwordx4 v[52:55], v5, s[24:27], s12 offen offset:3072
    buffer_load_dwordx4 v[56:59], v5, s[80:83], 0 offen offset:0
    buffer_load_dwordx4 v[60:63], v5, s[80:83], 0 offen offset:1024
    buffer_load_dwordx4 v[64:67], v5, s[84:87], 0 offen offset:0
    buffer_load_dwordx4 v[68:71], v5, s[84:87], 0 offen offset:1024
    s_waitcnt vmcnt(19)
    s_barrier
    s_bfe_u32 s91, s68, 0x4000c
    s_lshl_b32 s92, s91, 7
    s_mul_i32 s93, s91, 393216
    s_add_u32 m0, s94, 0
    s_nop 0
    buffer_load_dwordx4 v20, s[24:27], s92 offen offset:0 lds
    s_waitcnt vmcnt(1)
    s_mov_b32 s8, 0xffff0000
    v_lshlrev_b32 v72, 16, v56
    v_and_b32 v56, s8, v56
    v_lshlrev_b32 v73, 16, v64
    v_and_b32 v64, s8, v64
    v_lshlrev_b32 v112, 16, v40
    buffer_load_dwordx4 v21, s[24:27], s92 offen offset:1024 lds
    v_and_b32 v40, s8, v40
    v_lshlrev_b32 v116, 16, v48
    v_and_b32 v48, s8, v48
    v_mul_f32 v113, v112, v73
    v_mul_f32 v114, v40, v64
    v_mul_f32 v90, v112, v72
    v_mul_f32 v117, v116, v73
    buffer_load_dwordx4 v22, s[24:27], s92 offen offset:2048 lds
    v_mul_f32 v118, v48, v64
    v_mul_f32 v92, v116, v72
    v_cvt_pk_bf16_f32 v113, 0, v113
    v_cvt_pk_bf16_f32 v114, 0, v114
    v_fmac_f32 v90, v40, v56
    v_cvt_pk_bf16_f32 v117, 0, v117
    v_cvt_pk_bf16_f32 v118, 0, v118
    buffer_load_dwordx4 v23, s[24:27], s92 offen offset:3072 lds
    v_fmac_f32 v92, v48, v56
    v_add_f32 v91, v113, v114
    v_add_f32 v93, v117, v118
    v_lshlrev_b32 v72, 16, v57
    v_and_b32 v57, s8, v57
    v_lshlrev_b32 v73, 16, v65
    v_and_b32 v65, s8, v65
    s_add_u32 m0, s95, 24576
    s_nop 0
    buffer_load_dwordx4 v24, s[28:31], s93 offen offset:0 lds
    v_lshlrev_b32 v112, 16, v41
    v_and_b32 v41, s8, v41
    v_lshlrev_b32 v116, 16, v49
    v_and_b32 v49, s8, v49
    v_mul_f32 v113, v112, v73
    v_mul_f32 v114, v41, v65
    v_fmac_f32 v90, v112, v72
    buffer_load_dwordx4 v25, s[28:31], s93 offen offset:1024 lds
    v_mul_f32 v117, v116, v73
    v_mul_f32 v118, v49, v65
    v_fmac_f32 v92, v116, v72
    v_cvt_pk_bf16_f32 v113, 0, v113
    v_cvt_pk_bf16_f32 v114, 0, v114
    v_fmac_f32 v90, v41, v57
    v_cvt_pk_bf16_f32 v117, 0, v117
    s_add_u32 m0, s95, 32768
    s_nop 0
    buffer_load_dwordx4 v26, s[28:31], s93 offen offset:0 lds
    v_cvt_pk_bf16_f32 v118, 0, v118
    v_fmac_f32 v92, v49, v57
    v_add_f32 v91, v91, v113
    v_add_f32 v93, v93, v117
    v_add_f32 v91, v91, v114
    v_add_f32 v93, v93, v118
    v_lshlrev_b32 v72, 16, v58
    buffer_load_dwordx4 v27, s[28:31], s93 offen offset:1024 lds
    v_and_b32 v58, s8, v58
    v_lshlrev_b32 v73, 16, v66
    v_and_b32 v66, s8, v66
    v_lshlrev_b32 v112, 16, v42
    v_and_b32 v42, s8, v42
    v_lshlrev_b32 v116, 16, v50
    v_and_b32 v50, s8, v50
    s_add_u32 m0, s95, 16384
    s_nop 0
    buffer_load_dwordx4 v28, s[28:31], s93 offen offset:0 lds
    v_mul_f32 v113, v112, v73
    v_mul_f32 v114, v42, v66
    v_fmac_f32 v90, v112, v72
    v_mul_f32 v117, v116, v73
    v_mul_f32 v118, v50, v66
    v_fmac_f32 v92, v116, v72
    v_cvt_pk_bf16_f32 v113, 0, v113
    buffer_load_dwordx4 v29, s[28:31], s93 offen offset:1024 lds
    v_cvt_pk_bf16_f32 v114, 0, v114
    v_fmac_f32 v90, v42, v58
    v_cvt_pk_bf16_f32 v117, 0, v117
    v_cvt_pk_bf16_f32 v118, 0, v118
    v_fmac_f32 v92, v50, v58
    v_add_f32 v91, v91, v113
    v_add_f32 v93, v93, v117
    s_cmp_lg_u32 s21, 0
    s_cbranch_scc1 L_noclr_3
    v_mov_b32 v104, -1
    v_mov_b32 v105, -1
    v_mov_b32 v106, -1
    v_mov_b32 v107, -1
    s_lshl_b32 s12, s19, 13
    s_lshl_b32 s13, s18, 9
    s_add_u32 s12, s12, s13
    s_add_u32 s12, s12, 32768
    s_lshl_b32 s13, s19, 11
    s_lshl_b32 s90, s18, 7
    s_add_u32 s13, s13, s90
    s_add_u32 s13, s13, 163840
    s_mov_b32 exec_hi, 0
    buffer_store_dwordx4 v[104:107], v5, s[32:35], s12 offen sc1
    s_mov_b32 exec_lo, 255
    buffer_store_dwordx4 v[104:107], v5, s[32:35], s13 offen sc1
    s_mov_b64 exec, -1
L_noclr_3:
    v_add_f32 v91, v91, v114
    v_add_f32 v93, v93, v118
    v_lshlrev_b32 v72, 16, v59
    v_and_b32 v59, s8, v59
    v_lshlrev_b32 v73, 16, v67
    v_and_b32 v67, s8, v67
    v_lshlrev_b32 v112, 16, v43
    v_and_b32 v43, s8, v43
    v_lshlrev_b32 v116, 16, v51
    v_and_b32 v51, s8, v51
    v_mul_f32 v113, v112, v73
    v_mul_f32 v114, v43, v67
    v_fmac_f32 v90, v112, v72
    v_mul_f32 v117, v116, v73
    v_mul_f32 v118, v51, v67
    v_fmac_f32 v92, v116, v72
    v_cvt_pk_bf16_f32 v113, 0, v113
    v_cvt_pk_bf16_f32 v114, 0, v114
    v_fmac_f32 v90, v43, v59
    v_cvt_pk_bf16_f32 v117, 0, v117
    v_cvt_pk_bf16_f32 v118, 0, v118
    v_fmac_f32 v92, v51, v59
    v_add_f32 v91, v91, v113
    v_add_f32 v93, v93, v117
    v_add_f32 v91, v91, v114
    s_barrier
    s_bfe_u32 s91, s68, 0x40010
    s_lshl_b32 s92, s91, 7
    s_mul_i32 s93, s91, 393216
    s_add_u32 m0, s94, 40960
    s_nop 0
    buffer_load_dwordx4 v20, s[24:27], s92 offen offset:0 lds
    v_add_f32 v93, v93, v118
    v_lshlrev_b32 v72, 16, v60
    v_and_b32 v60, s8, v60
    v_lshlrev_b32 v73, 16, v68
    v_and_b32 v68, s8, v68
    v_lshlrev_b32 v112, 16, v44
    v_and_b32 v44, s8, v44
    buffer_load_dwordx4 v21, s[24:27], s92 offen offset:1024 lds
    v_lshlrev_b32 v116, 16, v52
    v_and_b32 v52, s8, v52
    v_mul_f32 v113, v112, v73
    v_mul_f32 v114, v44, v68
    v_fmac_f32 v90, v112, v72
    v_mul_f32 v117, v116, v73
    v_mul_f32 v118, v52, v68
    buffer_load_dwordx4 v22, s[24:27], s92 offen offset:2048 lds
    v_fmac_f32 v92, v116, v72
    v_cvt_pk_bf16_f32 v113, 0, v113
    v_cvt_pk_bf16_f32 v114, 0, v114
    v_fmac_f32 v90, v44, v60
    v_cvt_pk_bf16_f32 v117, 0, v117
    v_cvt_pk_bf16_f32 v118, 0, v118
    v_fmac_f32 v92, v52, v60
    buffer_load_dwordx4 v23, s[24:27], s92 offen offset:3072 lds
    v_add_f32 v91, v91, v113
    v_add_f32 v93, v93, v117
    v_add_f32 v91, v91, v114
    v_add_f32 v93, v93, v118
    v_lshlrev_b32 v72, 16, v61
    v_and_b32 v61, s8, v61
    v_lshlrev_b32 v73, 16, v69
    s_add_u32 m0, s95, 65536
    s_nop 0
    buffer_load_dwordx4 v24, s[28:31], s93 offen offset:0 lds
    v_and_b32 v69, s8, v69
    v_lshlrev_b32 v112, 16, v45
    v_and_b32 v45, s8, v45
    v_lshlrev_b32 v116, 16, v53
    v_and_b32 v53, s8, v53
    v_mul_f32 v113, v112, v73
    v_mul_f32 v114, v45, v69
    buffer_load_dwordx4 v25, s[28:31], s93 offen offset:1024 lds
    v_fmac_f32 v90, v112, v72
    v_mul_f32 v117, v116, v73
    v_mul_f32 v118, v53, v69
    v_fmac_f32 v92, v116, v72
    v_cvt_pk_bf16_f32 v113, 0, v113
    v_cvt_pk_bf16_f32 v114, 0, v114
    v_fmac_f32 v90, v45, v61
    s_add_u32 m0, s95, 73728
    s_nop 0
    buffer_load_dwordx4 v26, s[28:31], s93 offen offset:0 lds
    v_cvt_pk_bf16_f32 v117, 0, v117
    v_cvt_pk_bf16_f32 v118, 0, v118
    v_fmac_f32 v92, v53, v61
    v_add_f32 v91, v91, v113
    v_add_f32 v93, v93, v117
    v_add_f32 v91, v91, v114
    v_add_f32 v93, v93, v118
    buffer_load_dwordx4 v27, s[28:31], s93 offen offset:1024 lds
    v_lshlrev_b32 v72, 16, v62
    v_and_b32 v62, s8, v62
    v_lshlrev_b32 v73, 16, v70
    v_and_b32 v70, s8, v70
    v_lshlrev_b32 v112, 16, v46
    v_and_b32 v46, s8, v46
    v_lshlrev_b32 v116, 16, v54
    s_add_u32 m0, s95, 57344
    s_nop 0
    buffer_load_dwordx4 v28, s[28:31], s93 offen offset:0 lds
    v_and_b32 v54, s8, v54
    v_mul_f32 v113, v112, v73
    v_mul_f32 v114, v46, v70
    v_fmac_f32 v90, v112, v72
    v_mul_f32 v117, v116, v73
    v_mul_f32 v118, v54, v70
    v_fmac_f32 v92, v116, v72
    buffer_load_dwordx4 v29, s[28:31], s93 offen offset:1024 lds
    v_cvt_pk_bf16_f32 v113, 0, v113
    v_cvt_pk_bf16_f32 v114, 0, v114
    v_fmac_f32 v90, v46, v62
    v_cvt_pk_bf16_f32 v117, 0, v117
    v_cvt_pk_bf16_f32 v118, 0, v118
    v_fmac_f32 v92, v54, v62
    v_add_f32 v91, v91, v113
    buffer_load_dword v15, v13, s[72:75], 0 offen offset:4 sc1
    v_add_f32 v93, v93, v117
    v_add_f32 v91, v91, v114
    v_add_f32 v93, v93, v118
    v_lshlrev_b32 v72, 16, v63
    v_and_b32 v63, s8, v63
    v_lshlrev_b32 v73, 16, v71
    v_and_b32 v71, s8, v71
    v_lshlrev_b32 v112, 16, v47
    v_and_b32 v47, s8, v47
    v_lshlrev_b32 v116, 16, v55
    v_and_b32 v55, s8, v55
    v_mul_f32 v113, v112, v73
    v_mul_f32 v114, v47, v71
    v_fmac_f32 v90, v112, v72
    v_mul_f32 v117, v116, v73
    v_mul_f32 v118, v55, v71
    v_fmac_f32 v92, v116, v72
    v_cvt_pk_bf16_f32 v113, 0, v113
    v_cvt_pk_bf16_f32 v114, 0, v114
    v_fmac_f32 v90, v47, v63
    v_cvt_pk_bf16_f32 v117, 0, v117
    v_cvt_pk_bf16_f32 v118, 0, v118
    v_fmac_f32 v92, v55, v63
    v_add_f32 v91, v91, v113
    v_add_f32 v93, v93, v117
    s_waitcnt vmcnt(11)
    s_barrier
    s_bfe_u32 s91, s68, 0x40014
    s_lshl_b32 s92, s91, 7
    s_mul_i32 s93, s91, 393216
    s_add_u32 m0, s94, 81920
    s_nop 0
    buffer_load_dwordx4 v20, s[24:27], s92 offen offset:0 lds
    v_add_f32 v91, v91, v114
    v_add_f32 v93, v93, v118
    v_add_f32_dpp v90, v90, v90 row_shr:1 row_mask:0xf bank_mask:0xf
    v_add_f32_dpp v91, v91, v91 row_shr:1 row_mask:0xf bank_mask:0xf
    v_add_f32_dpp v92, v92, v92 row_shr:1 row_mask:0xf bank_mask:0xf
    v_add_f32_dpp v93, v93, v93 row_shr:1 row_mask:0xf bank_mask:0xf
    v_add_f32_dpp v90, v90, v90 row_shr:2 row_mask:0xf bank_mask:0xf
    buffer_load_dwordx4 v21, s[24:27], s92 offen offset:1024 lds
    v_add_f32_dpp v91, v91, v91 row_shr:2 row_mask:0xf bank_mask:0xf
    v_add_f32_dpp v92, v92, v92 row_shr:2 row_mask:0xf bank_mask:0xf
    v_add_f32_dpp v93, v93, v93 row_shr:2 row_mask:0xf bank_mask:0xf
    v_add_f32_dpp v90, v90, v90 row_shr:4 row_mask:0xf bank_mask:0xf
    v_add_f32_dpp v91, v91, v91 row_shr:4 row_mask:0xf bank_mask:0xf
    v_add_f32_dpp v92, v92, v92 row_shr:4 row_mask:0xf bank_mask:0xf
    v_add_f32_dpp v93, v93, v93 row_shr:4 row_mask:0xf bank_mask:0xf
    buffer_load_dwordx4 v22, s[24:27], s92 offen offset:2048 lds
    v_add_f32_dpp v90, v90, v90 row_shr:8 row_mask:0xf bank_mask:0xf
    v_add_f32_dpp v91, v91, v91 row_shr:8 row_mask:0xf bank_mask:0xf
    v_add_f32_dpp v92, v92, v92 row_shr:8 row_mask:0xf bank_mask:0xf
    v_add_f32_dpp v93, v93, v93 row_shr:8 row_mask:0xf bank_mask:0xf
    v_add_f32_dpp v90, v90, v90 row_bcast:15 row_mask:0xa bank_mask:0xf
    v_add_f32_dpp v91, v91, v91 row_bcast:15 row_mask:0xa bank_mask:0xf
    v_add_f32_dpp v92, v92, v92 row_bcast:15 row_mask:0xa bank_mask:0xf
    buffer_load_dwordx4 v23, s[24:27], s92 offen offset:3072 lds
    v_add_f32_dpp v93, v93, v93 row_bcast:15 row_mask:0xa bank_mask:0xf
    v_add_f32_dpp v90, v90, v90 row_bcast:31 row_mask:0xc bank_mask:0xf
    v_add_f32_dpp v91, v91, v91 row_bcast:31 row_mask:0xc bank_mask:0xf
    v_add_f32_dpp v92, v92, v92 row_bcast:31 row_mask:0xc bank_mask:0xf
    v_add_f32_dpp v93, v93, v93 row_bcast:31 row_mask:0xc bank_mask:0xf
    v_mov_b32 v97, 0x8000
    v_mov_b32 v98, 0xffff
    s_add_u32 m0, s95, 106496
    s_nop 0
    buffer_load_dwordx4 v24, s[28:31], s93 offen offset:0 lds
    v_cvt_pk_bf16_f32 v94, v90, v91
    v_cvt_pk_bf16_f32 v104, v92, v93
    v_and_b32 v95, 0xffff, v94
    v_and_b32 v96, 0x8000, v94
    v_and_b32 v94, 0xffff0000, v94
    v_cmp_ne_u32 vcc, 0, v96
    v_mul_f32 v94, 0xbfb8aa3b, v94
    buffer_load_dwordx4 v25, s[28:31], s93 offen offset:1024 lds
    v_exp_f32 v94, v94
    v_cndmask_b32 v96, v97, v98, vcc
    v_xor_b32 v95, v95, v96
    v_add_f32 v94, 1.0, v94
    v_lshlrev_b32 v95, 11, v95
    v_rcp_f32 v94, v94
    s_sub_u32 s12, 2047, s22
    v_or_b32 v100, s12, v95
    s_add_u32 m0, s95, 114688
    s_nop 0
    buffer_load_dwordx4 v26, s[28:31], s93 offen offset:0 lds
    v_cvt_pk_bf16_f32 v94, v94, v94
    v_lshlrev_b32 v102, 16, v94
    v_and_b32 v105, 0xffff, v104
    v_and_b32 v106, 0x8000, v104
    v_and_b32 v104, 0xffff0000, v104
    v_cmp_ne_u32 vcc, 0, v106
    v_mul_f32 v104, 0xbfb8aa3b, v104
    buffer_load_dwordx4 v27, s[28:31], s93 offen offset:1024 lds
    v_exp_f32 v104, v104
    v_cndmask_b32 v106, v97, v98, vcc
    v_xor_b32 v105, v105, v106
    v_add_f32 v104, 1.0, v104
    v_lshlrev_b32 v105, 11, v105
    v_rcp_f32 v104, v104
    s_sub_u32 s12, 2046, s22
    v_or_b32 v101, s12, v105
    s_add_u32 m0, s95, 98304
    s_nop 0
    buffer_load_dwordx4 v28, s[28:31], s93 offen offset:0 lds
    v_cvt_pk_bf16_f32 v104, v104, v104
    v_lshlrev_b32 v103, 16, v104
    v_max_u32 v100, v100, v101
    s_lshl_b32 s12, s22, 2
    s_add_u32 s12, s12, 4096
    s_lshl_b32 s13, s21, 2
    s_add_u32 s13, s13, 162880
    v_mov_b32 v14, s13
    s_mov_b32 exec_lo, 0
    s_mov_b32 exec_hi, 0x80000000
    buffer_store_dwordx2 v[102:103], v13, s[32:35], s12 offen sc1
    ds_write_b32 v14, v100
    s_mov_b64 exec, -1
    s_waitcnt lgkmcnt(0)
    buffer_load_dwordx4 v29, s[28:31], s93 offen offset:1024 lds
    s_cmp_ge_u32 s10, 224
    s_cbranch_scc1 L_p30_3
    s_add_u32 s12, s71, 0
    buffer_load_dwordx4 v[128:131], v30, s[40:43], s12 offen nt
    s_add_u32 s12, s71, 7168
    buffer_load_dwordx4 v[132:135], v30, s[40:43], s12 offen nt
    s_add_u32 s12, s71, 14336
    buffer_load_dwordx4 v[136:139], v30, s[40:43], s12 offen nt
    s_add_u32 s12, s71, 21504
    buffer_load_dwordx4 v[140:143], v30, s[40:43], s12 offen nt
    s_add_u32 s12, s71, 28672
    buffer_load_dwordx4 v[144:147], v30, s[40:43], s12 offen nt
    s_add_u32 s12, s71, 35840
    buffer_load_dwordx4 v[148:151], v30, s[40:43], s12 offen nt
    s_add_u32 s12, s71, 43008
    buffer_load_dwordx4 v[152:155], v30, s[40:43], s12 offen nt
    s_add_u32 s12, s71, 50176
    buffer_load_dwordx4 v[156:159], v30, s[40:43], s12 offen nt
    s_branch L_p3e0_3
L_p30_3:
    s_mov_b64 exec, 63
    s_bfe_u32 s12, s68, 0x4000c
    s_mul_i32 s12, s12, 393216
    buffer_load_dword v128, v32, s[28:31], s12 offen
    s_bfe_u32 s12, s68, 0x40010
    s_mul_i32 s12, s12, 393216
    buffer_load_dword v132, v32, s[28:31], s12 offen
    s_bfe_u32 s12, s68, 0x40014
    s_mul_i32 s12, s12, 393216
    buffer_load_dword v136, v32, s[28:31], s12 offen
    s_bfe_u32 s12, s68, 0x40018
    s_mul_i32 s12, s12, 393216
    buffer_load_dword v140, v32, s[28:31], s12 offen
    s_bfe_u32 s12, s68, 0x4001c
    s_mul_i32 s12, s12, 393216
    buffer_load_dword v144, v32, s[28:31], s12 offen
    s_bfe_u32 s12, s69, 0x40000
    s_mul_i32 s12, s12, 393216
    buffer_load_dword v148, v32, s[28:31], s12 offen
    s_bfe_u32 s12, s69, 0x40004
    s_mul_i32 s12, s12, 393216
    buffer_load_dword v152, v32, s[28:31], s12 offen
    s_bfe_u32 s12, s69, 0x40008
    s_mul_i32 s12, s12, 393216
    buffer_load_dword v156, v32, s[28:31], s12 offen
    s_mov_b64 exec, -1
L_p3e0_3:
    s_waitcnt vmcnt(20)
    s_barrier
    s_bfe_u32 s91, s68, 0x40018
    s_lshl_b32 s92, s91, 7
    s_mul_i32 s93, s91, 393216
    s_add_u32 m0, s94, 0
    s_nop 0
    buffer_load_dwordx4 v20, s[24:27], s92 offen offset:0 lds
    buffer_load_dwordx4 v21, s[24:27], s92 offen offset:1024 lds
    buffer_load_dwordx4 v22, s[24:27], s92 offen offset:2048 lds
    buffer_load_dwordx4 v23, s[24:27], s92 offen offset:3072 lds
    s_add_u32 m0, s95, 24576
    s_nop 0
    buffer_load_dwordx4 v24, s[28:31], s93 offen offset:0 lds
    s_waitcnt vmcnt(14)
    s_waitcnt vmcnt(13)
    s_barrier
    s_add_u32 m0, s95, 24576
    s_nop 0
    buffer_load_dwordx4 v25, s[28:31], s93 offen offset:1024 lds
    s_add_u32 m0, s95, 32768
    s_nop 0
    buffer_load_dwordx4 v26, s[28:31], s93 offen offset:0 lds
    buffer_load_dwordx4 v27, s[28:31], s93 offen offset:1024 lds
    s_add_u32 m0, s95, 16384
    s_nop 0
    buffer_load_dwordx4 v28, s[28:31], s93 offen offset:0 lds
    buffer_load_dwordx4 v29, s[28:31], s93 offen offset:1024 lds
    s_bfe_u32 s91, s68, 0x4001c
    s_lshl_b32 s92, s91, 7
    s_mul_i32 s93, s91, 393216
    s_add_u32 m0, s94, 40960
    s_nop 0
    buffer_load_dwordx4 v20, s[24:27], s92 offen offset:0 lds
    buffer_load_dwordx4 v21, s[24:27], s92 offen offset:1024 lds
    buffer_load_dwordx4 v22, s[24:27], s92 offen offset:2048 lds
    buffer_load_dwordx4 v23, s[24:27], s92 offen offset:3072 lds
    s_add_u32 m0, s95, 65536
    s_nop 0
    buffer_load_dwordx4 v24, s[28:31], s93 offen offset:0 lds
    buffer_load_dwordx4 v25, s[28:31], s93 offen offset:1024 lds
    s_add_u32 m0, s95, 73728
    s_nop 0
    buffer_load_dwordx4 v26, s[28:31], s93 offen offset:0 lds
    s_mov_b32 s13, 0
L_tagchk_3:
    v_readfirstlane_b32 s23, v15
    s_nop 1
    s_cmp_lg_u32 s23, 0
    s_cbranch_scc1 L_tagok_3
    s_add_u32 s13, s13, 1
    s_cmp_ge_u32 s13, 16384
    s_cbranch_scc1 L_tagok_3
    buffer_load_dword v15, v13, s[72:75], 0 offen offset:4 sc1
    s_waitcnt vmcnt(0)
    s_branch L_tagchk_3
L_tagok_3:
    s_and_b32 s76, s23, 0xff
    s_bfe_u32 s77, s23, 0x80008
    s_bfe_u32 s78, s23, 0x80010
    s_lshr_b32 s79, s23, 24
    v_and_b32 v35, 3, v2
    v_lshlrev_b32 v35, 3, v35
    v_bfe_u32 v35, s23, v35, 8
    s_cmp_lg_u32 s21, 0
    s_cbranch_scc1 L_nopub_3
    v_mov_b32 v14, 162880
    ds_read_b128 v[104:107], v14
    s_lshl_b32 s12, s2, 3
    s_add_u32 s12, s12, 0
    s_waitcnt lgkmcnt(0)
    v_max3_u32 v104, v104, v105, v106
    v_max_u32 v104, v104, v107
    v_mov_b32 v105, s23
    s_mov_b64 exec, 1
    buffer_store_dwordx2 v[104:105], v13, s[32:35], s12 offen sc1
    s_mov_b64 exec, -1
L_nopub_3:
    s_waitcnt vmcnt(7)
    s_barrier
    s_add_u32 m0, s95, 73728
    s_nop 0
    buffer_load_dwordx4 v27, s[28:31], s93 offen offset:1024 lds
    s_add_u32 m0, s95, 57344
    s_nop 0
    buffer_load_dwordx4 v28, s[28:31], s93 offen offset:0 lds
    buffer_load_dwordx4 v29, s[28:31], s93 offen offset:1024 lds
    s_bfe_u32 s91, s69, 0x40000
    s_lshl_b32 s92, s91, 7
    s_mul_i32 s93, s91, 393216
    s_add_u32 m0, s94, 81920
    s_nop 0
    buffer_load_dwordx4 v20, s[24:27], s92 offen offset:0 lds
    buffer_load_dwordx4 v21, s[24:27], s92 offen offset:1024 lds
    buffer_load_dwordx4 v22, s[24:27], s92 offen offset:2048 lds
    buffer_load_dwordx4 v23, s[24:27], s92 offen offset:3072 lds
    s_add_u32 m0, s95, 106496
    s_nop 0
    buffer_load_dwordx4 v24, s[28:31], s93 offen offset:0 lds
    buffer_load_dwordx4 v25, s[28:31], s93 offen offset:1024 lds
    s_add_u32 m0, s95, 114688
    s_nop 0
    buffer_load_dwordx4 v26, s[28:31], s93 offen offset:0 lds
    buffer_load_dwordx4 v27, s[28:31], s93 offen offset:1024 lds
    s_add_u32 m0, s95, 98304
    s_nop 0
    buffer_load_dwordx4 v28, s[28:31], s93 offen offset:0 lds
    s_waitcnt vmcnt(9)
    s_barrier
    s_add_u32 m0, s95, 98304
    s_nop 0
    buffer_load_dwordx4 v29, s[28:31], s93 offen offset:1024 lds
    s_bfe_u32 s91, s69, 0x40004
    s_lshl_b32 s92, s91, 7
    s_mul_i32 s93, s91, 393216
    s_add_u32 m0, s94, 0
    s_nop 0
    buffer_load_dwordx4 v20, s[24:27], s92 offen offset:0 lds
    buffer_load_dwordx4 v21, s[24:27], s92 offen offset:1024 lds
    buffer_load_dwordx4 v22, s[24:27], s92 offen offset:2048 lds
    buffer_load_dwordx4 v23, s[24:27], s92 offen offset:3072 lds
    s_add_u32 m0, s95, 24576
    s_nop 0
    buffer_load_dwordx4 v24, s[28:31], s93 offen offset:0 lds
    buffer_load_dwordx4 v25, s[28:31], s93 offen offset:1024 lds
    s_add_u32 m0, s95, 32768
    s_nop 0
    buffer_load_dwordx4 v26, s[28:31], s93 offen offset:0 lds
    buffer_load_dwordx4 v27, s[28:31], s93 offen offset:1024 lds
    s_add_u32 m0, s95, 16384
    s_nop 0
    buffer_load_dwordx4 v28, s[28:31], s93 offen offset:0 lds
    buffer_load_dwordx4 v29, s[28:31], s93 offen offset:1024 lds
    s_waitcnt vmcnt(10)
    s_barrier
    s_bfe_u32 s91, s69, 0x40008
    s_lshl_b32 s92, s91, 7
    s_mul_i32 s93, s91, 393216
    s_add_u32 m0, s94, 40960
    s_nop 0
    buffer_load_dwordx4 v20, s[24:27], s92 offen offset:0 lds
    buffer_load_dwordx4 v21, s[24:27], s92 offen offset:1024 lds
    buffer_load_dwordx4 v22, s[24:27], s92 offen offset:2048 lds
    buffer_load_dwordx4 v23, s[24:27], s92 offen offset:3072 lds
    s_add_u32 m0, s95, 65536
    s_nop 0
    buffer_load_dwordx4 v24, s[28:31], s93 offen offset:0 lds
    buffer_load_dwordx4 v25, s[28:31], s93 offen offset:1024 lds
    s_add_u32 m0, s95, 73728
    s_nop 0
    buffer_load_dwordx4 v26, s[28:31], s93 offen offset:0 lds
    buffer_load_dwordx4 v27, s[28:31], s93 offen offset:1024 lds
    s_add_u32 m0, s95, 57344
    s_nop 0
    buffer_load_dwordx4 v28, s[28:31], s93 offen offset:0 lds
    buffer_load_dwordx4 v29, s[28:31], s93 offen offset:1024 lds
    s_cmp_ge_u32 s10, 224
    s_cbranch_scc1 L_p31_3
    s_add_u32 s12, s9, 0
    buffer_load_dwordx4 v[160:163], v30, s[44:47], s12 offen nt
    s_add_u32 s12, s9, 7168
    buffer_load_dwordx4 v[164:167], v30, s[44:47], s12 offen nt
    s_add_u32 s12, s9, 14336
    buffer_load_dwordx4 v[168:171], v30, s[44:47], s12 offen nt
    s_add_u32 s12, s9, 21504
    buffer_load_dwordx4 v[172:175], v30, s[44:47], s12 offen nt
    s_add_u32 s12, s9, 28672
    buffer_load_dwordx4 v[176:179], v30, s[44:47], s12 offen nt
    s_add_u32 s12, s9, 35840
    buffer_load_dwordx4 v[180:183], v30, s[44:47], s12 offen nt
    s_add_u32 s12, s9, 43008
    buffer_load_dwordx4 v[184:187], v30, s[44:47], s12 offen nt
    s_add_u32 s12, s9, 50176
    buffer_load_dwordx4 v[188:191], v30, s[44:47], s12 offen nt
    s_branch L_p3e1_3
L_p31_3:
    s_mov_b64 exec, 63
    s_bfe_u32 s12, s69, 0x4000c
    s_mul_i32 s12, s12, 393216
    buffer_load_dword v160, v32, s[28:31], s12 offen
    s_bfe_u32 s12, s69, 0x40010
    s_mul_i32 s12, s12, 393216
    buffer_load_dword v164, v32, s[28:31], s12 offen
    s_bfe_u32 s12, s69, 0x40014
    s_mul_i32 s12, s12, 393216
    buffer_load_dword v168, v32, s[28:31], s12 offen
    s_bfe_u32 s12, s69, 0x40018
    s_mul_i32 s12, s12, 393216
    buffer_load_dword v172, v32, s[28:31], s12 offen
    s_bfe_u32 s12, s69, 0x4001c
    s_mul_i32 s12, s12, 393216
    buffer_load_dword v176, v32, s[28:31], s12 offen
    s_mov_b64 exec, 1
    s_bfe_u32 s12, s69, 0x4001c
    s_mul_i32 s12, s12, 393216
    buffer_load_dword v180, v32, s[28:31], s12 offen
    s_bfe_u32 s12, s69, 0x4001c
    s_mul_i32 s12, s12, 393216
    buffer_load_dword v184, v32, s[28:31], s12 offen
    s_bfe_u32 s12, s69, 0x4001c
    s_mul_i32 s12, s12, 393216
    buffer_load_dword v188, v32, s[28:31], s12 offen
    s_mov_b64 exec, -1
L_p3e1_3:
    s_mov_b32 exec_lo, 0xffff0000
    s_mov_b32 exec_hi, 0
    buffer_load_dword v19, v10, s[36:39], 0 offen
    s_mov_b64 exec, -1
    s_waitcnt vmcnt(19)
    s_barrier
    s_bfe_u32 s91, s69, 0x4000c
    s_lshl_b32 s92, s91, 7
    s_mul_i32 s93, s91, 393216
    s_add_u32 m0, s94, 122880
    s_nop 0
    buffer_load_dwordx4 v20, s[24:27], s92 offen offset:0 lds
    buffer_load_dwordx4 v21, s[24:27], s92 offen offset:1024 lds
    buffer_load_dwordx4 v22, s[24:27], s92 offen offset:2048 lds
    buffer_load_dwordx4 v23, s[24:27], s92 offen offset:3072 lds
    s_add_u32 m0, s95, 106496
    s_nop 0
    buffer_load_dwordx4 v24, s[28:31], s93 offen offset:0 lds
    s_mov_b32 s12, 0
    buffer_load_dwordx4 v[104:107], v5, s[32:35], s12 offen offset:0 sc1
    buffer_load_dwordx4 v[108:111], v5, s[32:35], s12 offen offset:1024 sc1
    s_waitcnt vmcnt(16)
    s_barrier
    s_add_u32 m0, s95, 106496
    s_nop 0
    buffer_load_dwordx4 v25, s[28:31], s93 offen offset:1024 lds
    s_add_u32 m0, s95, 114688
    s_nop 0
    buffer_load_dwordx4 v26, s[28:31], s93 offen offset:0 lds
    buffer_load_dwordx4 v27, s[28:31], s93 offen offset:1024 lds
    s_bfe_u32 s91, s69, 0x40010
    s_lshl_b32 s92, s91, 7
    s_mul_i32 s93, s91, 393216
    s_add_u32 m0, s94, 139264
    s_nop 0
    buffer_load_dwordx4 v20, s[24:27], s92 offen offset:0 lds
    buffer_load_dwordx4 v21, s[24:27], s92 offen offset:1024 lds
    buffer_load_dwordx4 v22, s[24:27], s92 offen offset:2048 lds
    buffer_load_dwordx4 v23, s[24:27], s92 offen offset:3072 lds
    s_add_u32 m0, s95, 24576
    s_nop 0
    buffer_load_dwordx4 v24, s[28:31], s93 offen offset:0 lds
    buffer_load_dwordx4 v25, s[28:31], s93 offen offset:1024 lds
    s_add_u32 m0, s95, 32768
    s_nop 0
    buffer_load_dwordx4 v26, s[28:31], s93 offen offset:0 lds
    s_waitcnt vmcnt(7)
    s_barrier
    s_add_u32 m0, s95, 32768
    s_nop 0
    buffer_load_dwordx4 v27, s[28:31], s93 offen offset:1024 lds
    s_mov_b32 s13, 0
    v_xor_b32 v105, s23, v105
    v_xor_b32 v107, s23, v107
    v_xor_b32 v109, s23, v109
    v_xor_b32 v111, s23, v111
    v_or3_b32 v105, v105, v107, v109
    v_or_b32 v105, v105, v111
    v_cmp_ne_u32 vcc, 0, v105
    s_cbranch_vccnz L_keyre_3
L_keyok_3:
    v_max3_u32 v104, v104, v106, v108
    v_max_u32 v104, v104, v110
    s_nop 1
    v_max_u32_dpp v104, v104, v104 row_shr:1 row_mask:0xf bank_mask:0xf
    s_nop 1
    v_max_u32_dpp v104, v104, v104 row_shr:2 row_mask:0xf bank_mask:0xf
    s_nop 1
    v_max_u32_dpp v104, v104, v104 row_shr:4 row_mask:0xf bank_mask:0xf
    s_bfe_u32 s91, s69, 0x40014
    s_lshl_b32 s92, s91, 7
    s_mul_i32 s93, s91, 393216
    s_add_u32 m0, s94, 40960
    s_nop 0
    buffer_load_dwordx4 v20, s[24:27], s92 offen offset:0 lds
    v_max_u32_dpp v104, v104, v104 row_shr:8 row_mask:0xf bank_mask:0xf
    s_nop 1
    v_max_u32_dpp v104, v104, v104 row_bcast:15 row_mask:0xa bank_mask:0xf
    s_nop 1
    v_max_u32_dpp v104, v104, v104 row_bcast:31 row_mask:0xc bank_mask:0xf
    s_nop 0
    v_readlane_b32 s14, v104, 63
    s_nop 1
    s_and_b32 s15, s14, 2047
    s_sub_u32 s15, 2047, s15
    s_lshl_b32 s12, s15, 11
    s_lshl_b32 s13, s70, 1
    s_add_u32 s12, s12, s13
    buffer_load_dwordx4 v[36:39], v34, s[24:27], s12 offen
    buffer_load_dwordx4 v21, s[24:27], s92 offen offset:1024 lds
    s_lshr_b32 s12, s14, 11
    s_and_b32 s13, s12, 0x8000
    s_cmp_lg_u32 s13, 0
    s_mov_b32 s13, 0xffff
    s_cselect_b32 s13, 0x8000, s13
    s_xor_b32 s12, s12, s13
    s_lshl_b32 s12, s12, 16
    v_mov_b32 v105, s12
    buffer_load_dwordx4 v22, s[24:27], s92 offen offset:2048 lds
    v_mul_f32 v105, 0xbfb8aa3b, v105
    v_exp_f32 v105, v105
    s_nop 0
    v_add_f32 v105, 1.0, v105
    v_rcp_f32 v105, v105
    s_nop 0
    v_cvt_pk_bf16_f32 v105, v105, v105
    v_lshlrev_b32 v105, 16, v105
    s_add_u32 s12, s15, 1
    v_mov_b32 v104, s12
    buffer_load_dwordx4 v23, s[24:27], s92 offen offset:3072 lds
    v_mov_b32 v106, s23
    v_readfirstlane_b32 s14, v105
    v_mov_b32 v14, 162864
    s_mov_b64 exec, 1
    ds_write_b96 v14, v[104:106]
    s_mov_b64 exec, -1
    s_waitcnt lgkmcnt(0)
    s_add_u32 m0, s95, 65536
    s_nop 0
    buffer_load_dwordx4 v24, s[28:31], s93 offen offset:0 lds
    buffer_load_dwordx4 v25, s[28:31], s93 offen offset:1024 lds
    s_add_u32 m0, s95, 73728
    s_nop 0
    buffer_load_dwordx4 v26, s[28:31], s93 offen offset:0 lds
    buffer_load_dwordx4 v27, s[28:31], s93 offen offset:1024 lds
    s_waitcnt vmcnt(9)
    s_barrier
    s_bfe_u32 s91, s69, 0x40018
    s_lshl_b32 s92, s91, 7
    s_mul_i32 s93, s91, 393216
    s_add_u32 m0, s94, 81920
    s_nop 0
    buffer_load_dwordx4 v20, s[24:27], s92 offen offset:0 lds
    s_waitcnt vmcnt(8)
    s_mov_b32 s8, 0xffff0000
    v_lshlrev_b32 v40, 16, v36
    v_and_b32 v41, s8, v36
    v_lshlrev_b32 v42, 16, v37
    v_and_b32 v43, s8, v37
    v_lshlrev_b32 v44, 16, v38
    buffer_load_dwordx4 v21, s[24:27], s92 offen offset:1024 lds
    v_and_b32 v45, s8, v38
    v_lshlrev_b32 v46, 16, v39
    v_and_b32 v47, s8, v39
    v_lshlrev_b32 v48, 16, v128
    v_lshlrev_b32 v49, 16, v129
    v_and_b32 v128, s8, v128
    v_and_b32 v129, s8, v129
    buffer_load_dwordx4 v22, s[24:27], s92 offen offset:2048 lds
    v_mul_f32 v220, v48, v40
    v_mul_f32 v222, v49, v40
    v_mul_f32 v221, v128, v40
    v_mul_f32 v223, v129, v40
    v_lshlrev_b32 v50, 16, v130
    v_lshlrev_b32 v51, 16, v131
    v_and_b32 v130, s8, v130
    buffer_load_dwordx4 v23, s[24:27], s92 offen offset:3072 lds
    v_and_b32 v131, s8, v131
    v_mul_f32 v224, v50, v40
    v_mul_f32 v226, v51, v40
    v_mul_f32 v225, v130, v40
    v_mul_f32 v227, v131, v40
    v_lshlrev_b32 v48, 16, v160
    v_lshlrev_b32 v49, 16, v161
    s_add_u32 m0, s95, 106496
    s_nop 0
    buffer_load_dwordx4 v24, s[28:31], s93 offen offset:0 lds
    v_and_b32 v160, s8, v160
    v_and_b32 v161, s8, v161
    v_mul_f32 v228, v48, v40
    v_mul_f32 v230, v49, v40
    v_mul_f32 v229, v160, v40
    v_mul_f32 v231, v161, v40
    v_lshlrev_b32 v50, 16, v162
    buffer_load_dwordx4 v25, s[28:31], s93 offen offset:1024 lds
    v_lshlrev_b32 v51, 16, v163
    v_and_b32 v162, s8, v162
    v_and_b32 v163, s8, v163
    v_mul_f32 v232, v50, v40
    v_mul_f32 v234, v51, v40
    v_mul_f32 v233, v162, v40
    v_mul_f32 v235, v163, v40
    s_add_u32 m0, s95, 114688
    s_nop 0
    buffer_load_dwordx4 v26, s[28:31], s93 offen offset:0 lds
    v_lshlrev_b32 v48, 16, v132
    v_lshlrev_b32 v49, 16, v133
    v_and_b32 v132, s8, v132
    v_and_b32 v133, s8, v133
    v_fmac_f32 v220, v48, v41
    v_fmac_f32 v222, v49, v41
    v_fmac_f32 v221, v132, v41
    v_fmac_f32 v223, v133, v41
    v_lshlrev_b32 v50, 16, v134
    v_lshlrev_b32 v51, 16, v135
    v_and_b32 v134, s8, v134
    v_and_b32 v135, s8, v135
    v_fmac_f32 v224, v50, v41
    v_fmac_f32 v226, v51, v41
    buffer_load_dwordx4 v27, s[28:31], s93 offen offset:1024 lds
    v_fmac_f32 v225, v134, v41
    v_fmac_f32 v227, v135, v41
    v_lshlrev_b32 v48, 16, v164
    v_lshlrev_b32 v49, 16, v165
    v_and_b32 v164, s8, v164
    v_and_b32 v165, s8, v165
    v_fmac_f32 v228, v48, v41
    v_fmac_f32 v230, v49, v41
    v_fmac_f32 v229, v164, v41
    v_fmac_f32 v231, v165, v41
    v_lshlrev_b32 v50, 16, v166
    v_lshlrev_b32 v51, 16, v167
    v_and_b32 v166, s8, v166
    v_and_b32 v167, s8, v167
    v_fmac_f32 v232, v50, v41
    v_fmac_f32 v234, v51, v41
    v_fmac_f32 v233, v166, v41
    v_fmac_f32 v235, v167, v41
    v_lshlrev_b32 v48, 16, v136
    v_lshlrev_b32 v49, 16, v137
    v_and_b32 v136, s8, v136
    v_and_b32 v137, s8, v137
    v_fmac_f32 v220, v48, v42
    v_fmac_f32 v222, v49, v42
    v_fmac_f32 v221, v136, v42
    v_fmac_f32 v223, v137, v42
    v_lshlrev_b32 v50, 16, v138
    v_lshlrev_b32 v51, 16, v139
    v_and_b32 v138, s8, v138
    v_and_b32 v139, s8, v139
    v_fmac_f32 v224, v50, v42
    v_fmac_f32 v226, v51, v42
    v_fmac_f32 v225, v138, v42
    v_fmac_f32 v227, v139, v42
    v_lshlrev_b32 v48, 16, v168
    v_lshlrev_b32 v49, 16, v169
    v_and_b32 v168, s8, v168
    v_and_b32 v169, s8, v169
    v_fmac_f32 v228, v48, v42
    s_waitcnt vmcnt(8)
    s_barrier
    s_bfe_u32 s91, s69, 0x4001c
    s_lshl_b32 s92, s91, 7
    s_mul_i32 s93, s91, 393216
    s_add_u32 m0, s94, 0
    s_nop 0
    buffer_load_dwordx4 v20, s[24:27], s92 offen offset:0 lds
    v_fmac_f32 v230, v49, v42
    v_fmac_f32 v229, v168, v42
    v_fmac_f32 v231, v169, v42
    v_lshlrev_b32 v50, 16, v170
    v_lshlrev_b32 v51, 16, v171
    v_and_b32 v170, s8, v170
    v_and_b32 v171, s8, v171
    buffer_load_dwordx4 v21, s[24:27], s92 offen offset:1024 lds
    v_fmac_f32 v232, v50, v42
    v_fmac_f32 v234, v51, v42
    v_fmac_f32 v233, v170, v42
    v_fmac_f32 v235, v171, v42
    v_lshlrev_b32 v48, 16, v140
    v_lshlrev_b32 v49, 16, v141
    v_and_b32 v140, s8, v140
    buffer_load_dwordx4 v22, s[24:27], s92 offen offset:2048 lds
    v_and_b32 v141, s8, v141
    v_fmac_f32 v220, v48, v43
    v_fmac_f32 v222, v49, v43
    v_fmac_f32 v221, v140, v43
    v_fmac_f32 v223, v141, v43
    v_lshlrev_b32 v50, 16, v142
    v_lshlrev_b32 v51, 16, v143
    buffer_load_dwordx4 v23, s[24:27], s92 offen offset:3072 lds
    v_and_b32 v142, s8, v142
    v_and_b32 v143, s8, v143
    v_fmac_f32 v224, v50, v43
    v_fmac_f32 v226, v51, v43
    v_fmac_f32 v225, v142, v43
    v_fmac_f32 v227, v143, v43
    v_lshlrev_b32 v48, 16, v172
    s_add_u32 m0, s95, 24576
    s_nop 0
    buffer_load_dwordx4 v24, s[28:31], s93 offen offset:0 lds
    v_lshlrev_b32 v49, 16, v173
    v_and_b32 v172, s8, v172
    v_and_b32 v173, s8, v173
    v_fmac_f32 v228, v48, v43
    v_fmac_f32 v230, v49, v43
    v_fmac_f32 v229, v172, v43
    v_fmac_f32 v231, v173, v43
    buffer_load_dwordx4 v25, s[28:31], s93 offen offset:1024 lds
    v_lshlrev_b32 v50, 16, v174
    v_lshlrev_b32 v51, 16, v175
    v_and_b32 v174, s8, v174
    v_and_b32 v175, s8, v175
    v_fmac_f32 v232, v50, v43
    v_fmac_f32 v234, v51, v43
    v_fmac_f32 v233, v174, v43
    s_add_u32 m0, s95, 32768
    s_nop 0
    buffer_load_dwordx4 v26, s[28:31], s93 offen offset:0 lds
    v_fmac_f32 v235, v175, v43
    v_lshlrev_b32 v48, 16, v144
    v_lshlrev_b32 v49, 16, v145
    v_and_b32 v144, s8, v144
    v_and_b32 v145, s8, v145
    v_fmac_f32 v220, v48, v44
    v_fmac_f32 v222, v49, v44
    v_fmac_f32 v221, v144, v44
    v_fmac_f32 v223, v145, v44
    v_lshlrev_b32 v50, 16, v146
    v_lshlrev_b32 v51, 16, v147
    v_and_b32 v146, s8, v146
    v_and_b32 v147, s8, v147
    v_fmac_f32 v224, v50, v44
    buffer_load_dwordx4 v27, s[28:31], s93 offen offset:1024 lds
    v_fmac_f32 v226, v51, v44
    v_fmac_f32 v225, v146, v44
    v_fmac_f32 v227, v147, v44
    v_lshlrev_b32 v48, 16, v176
    v_lshlrev_b32 v49, 16, v177
    v_and_b32 v176, s8, v176
    v_and_b32 v177, s8, v177
    v_fmac_f32 v228, v48, v44
    v_fmac_f32 v230, v49, v44
    v_fmac_f32 v229, v176, v44
    v_fmac_f32 v231, v177, v44
    v_lshlrev_b32 v50, 16, v178
    v_lshlrev_b32 v51, 16, v179
    v_and_b32 v178, s8, v178
    s_add_u32 s12, s97, 0
    buffer_load_dwordx4 v[192:195], v31, s[64:67], s12 offen nt
    s_add_u32 s12, s97, 16384
    buffer_load_dwordx4 v[196:199], v31, s[64:67], s12 offen nt
    s_add_u32 s12, s97, 32768
    buffer_load_dwordx4 v[200:203], v31, s[64:67], s12 offen nt
    s_add_u32 s12, s97, 49152
    buffer_load_dwordx4 v[204:207], v31, s[64:67], s12 offen nt
    s_add_u32 s12, s97, 65536
    buffer_load_dwordx4 v[208:211], v31, s[64:67], s12 offen nt
    s_add_u32 s12, s97, 81920
    buffer_load_dwordx4 v[212:215], v31, s[64:67], s12 offen nt
    s_add_u32 s12, s97, 98304
    buffer_load_dwordx4 v[216:219], v31, s[64:67], s12 offen nt
    v_and_b32 v179, s8, v179
    v_fmac_f32 v232, v50, v44
    v_fmac_f32 v234, v51, v44
    v_fmac_f32 v233, v178, v44
    v_fmac_f32 v235, v179, v44
    v_lshlrev_b32 v48, 16, v148
    v_lshlrev_b32 v49, 16, v149
    v_and_b32 v148, s8, v148
    v_and_b32 v149, s8, v149
    v_fmac_f32 v220, v48, v45
    v_fmac_f32 v222, v49, v45
    v_fmac_f32 v221, v148, v45
    v_fmac_f32 v223, v149, v45
    v_lshlrev_b32 v50, 16, v150
    v_lshlrev_b32 v51, 16, v151
    v_and_b32 v150, s8, v150
    v_and_b32 v151, s8, v151
    v_fmac_f32 v224, v50, v45
    v_fmac_f32 v226, v51, v45
    v_fmac_f32 v225, v150, v45
    v_fmac_f32 v227, v151, v45
    v_lshlrev_b32 v48, 16, v180
    v_lshlrev_b32 v49, 16, v181
    v_and_b32 v180, s8, v180
    v_and_b32 v181, s8, v181
    s_waitcnt vmcnt(15)
    s_barrier
    s_bfe_u32 s12, s69, 0x4000c
    s_mul_i32 s12, s12, 393216
    s_add_u32 m0, s95, 16384
    s_nop 0
    buffer_load_dwordx4 v28, s[28:31], s12 offen offset:0 lds
    buffer_load_dwordx4 v29, s[28:31], s12 offen offset:1024 lds
    s_bfe_u32 s12, s69, 0x40010
    s_mul_i32 s12, s12, 393216
    s_add_u32 m0, s95, 57344
    s_nop 0
    buffer_load_dwordx4 v28, s[28:31], s12 offen offset:0 lds
    buffer_load_dwordx4 v29, s[28:31], s12 offen offset:1024 lds
    s_mul_i32 s12, s21, 16
    s_add_u32 s12, s12, 0
    s_and_b32 s90, s88, 1
    s_lshl_b32 s90, s90, 6
    s_xor_b32 s12, s12, s90
    s_lshl_b32 s12, s12, 14
    s_add_u32 s90, s12, 0
    buffer_load_dwordx4 v[84:87], v33, s[36:39], s90 offen
    s_add_u32 s90, s12, 16384
    buffer_load_dwordx4 v[88:91], v33, s[36:39], s90 offen
    s_add_u32 s90, s12, 32768
    buffer_load_dwordx4 v[92:95], v33, s[36:39], s90 offen
    s_add_u32 s90, s12, 49152
    buffer_load_dwordx4 v[96:99], v33, s[36:39], s90 offen
    s_add_u32 s90, s12, 65536
    buffer_load_dwordx4 v[100:103], v33, s[36:39], s90 offen
    s_add_u32 s90, s12, 81920
    buffer_load_dwordx4 v[116:119], v33, s[36:39], s90 offen
    s_add_u32 s90, s12, 98304
    buffer_load_dwordx4 v[120:123], v33, s[36:39], s90 offen
    s_add_u32 s90, s12, 114688
    buffer_load_dwordx4 v[124:127], v33, s[36:39], s90 offen
    s_add_u32 s90, s12, 131072
    buffer_load_dwordx4 v[64:67], v33, s[36:39], s90 offen
    v_fmac_f32 v228, v48, v45
    v_fmac_f32 v230, v49, v45
    v_fmac_f32 v229, v180, v45
    v_fmac_f32 v231, v181, v45
    v_lshlrev_b32 v50, 16, v182
    v_lshlrev_b32 v51, 16, v183
    v_and_b32 v182, s8, v182
    v_and_b32 v183, s8, v183
    v_fmac_f32 v232, v50, v45
    v_fmac_f32 v234, v51, v45
    v_fmac_f32 v233, v182, v45
    v_fmac_f32 v235, v183, v45
    v_lshlrev_b32 v48, 16, v152
    v_lshlrev_b32 v49, 16, v153
    v_and_b32 v152, s8, v152
    v_and_b32 v153, s8, v153
    v_fmac_f32 v220, v48, v46
    v_fmac_f32 v222, v49, v46
    v_fmac_f32 v221, v152, v46
    v_fmac_f32 v223, v153, v46
    v_lshlrev_b32 v50, 16, v154
    v_lshlrev_b32 v51, 16, v155
    v_and_b32 v154, s8, v154
    v_and_b32 v155, s8, v155
    v_fmac_f32 v224, v50, v46
    s_waitcnt vmcnt(20)
    s_barrier
    v_fmac_f32 v226, v51, v46
    v_fmac_f32 v225, v154, v46
    v_fmac_f32 v227, v155, v46
    v_lshlrev_b32 v48, 16, v184
    v_lshlrev_b32 v49, 16, v185
    v_and_b32 v184, s8, v184
    v_and_b32 v185, s8, v185
    v_fmac_f32 v228, v48, v46
    v_fmac_f32 v230, v49, v46
    v_fmac_f32 v229, v184, v46
    v_fmac_f32 v231, v185, v46
    v_lshlrev_b32 v50, 16, v186
    v_lshlrev_b32 v51, 16, v187
    v_and_b32 v186, s8, v186
    v_and_b32 v187, s8, v187
    v_fmac_f32 v232, v50, v46
    v_fmac_f32 v234, v51, v46
    v_fmac_f32 v233, v186, v46
    v_fmac_f32 v235, v187, v46
    v_lshlrev_b32 v48, 16, v156
    v_lshlrev_b32 v49, 16, v157
    v_and_b32 v156, s8, v156
    v_and_b32 v157, s8, v157
    v_fmac_f32 v220, v48, v47
    v_fmac_f32 v222, v49, v47
    v_fmac_f32 v221, v156, v47
    v_fmac_f32 v223, v157, v47
    v_lshlrev_b32 v50, 16, v158
    v_lshlrev_b32 v51, 16, v159
    v_and_b32 v158, s8, v158
    v_and_b32 v159, s8, v159
    v_fmac_f32 v224, v50, v47
    v_fmac_f32 v226, v51, v47
    v_fmac_f32 v225, v158, v47
    v_fmac_f32 v227, v159, v47
    v_lshlrev_b32 v48, 16, v188
    v_lshlrev_b32 v49, 16, v189
    v_and_b32 v188, s8, v188
    v_and_b32 v189, s8, v189
    v_fmac_f32 v228, v48, v47
    v_fmac_f32 v230, v49, v47
    v_fmac_f32 v229, v188, v47
    v_fmac_f32 v231, v189, v47
    v_lshlrev_b32 v50, 16, v190
    v_lshlrev_b32 v51, 16, v191
    v_and_b32 v190, s8, v190
    v_and_b32 v191, s8, v191
    v_fmac_f32 v232, v50, v47
    v_fmac_f32 v234, v51, v47
    v_fmac_f32 v233, v190, v47
    v_fmac_f32 v235, v191, v47
    v_permlane32_swap_b32 v220, v228
    v_permlane32_swap_b32 v221, v229
    v_permlane32_swap_b32 v222, v230
    v_permlane32_swap_b32 v223, v231
    v_permlane32_swap_b32 v224, v232
    v_permlane32_swap_b32 v225, v233
    v_permlane32_swap_b32 v226, v234
    v_permlane32_swap_b32 v227, v235
    v_add_f32 v220, v220, v228
    v_add_f32 v221, v221, v229
    v_add_f32 v222, v222, v230
    v_add_f32 v223, v223, v231
    v_add_f32 v224, v224, v232
    v_add_f32 v225, v225, v233
    v_add_f32 v226, v226, v234
    v_add_f32 v227, v227, v235
    v_permlane16_swap_b32 v220, v224
    v_permlane16_swap_b32 v221, v225
    v_permlane16_swap_b32 v222, v226
    v_permlane16_swap_b32 v223, v227
    v_add_f32 v220, v220, v224
    v_add_f32 v221, v221, v225
    v_add_f32 v222, v222, v226
    v_add_f32 v223, v223, v227
    v_add_f32_dpp v220, v220, v220 row_ror:8 row_mask:0xf bank_mask:0xf
    v_add_f32_dpp v221, v221, v221 row_ror:8 row_mask:0xf bank_mask:0xf
    v_add_f32_dpp v222, v222, v222 row_ror:8 row_mask:0xf bank_mask:0xf
    v_add_f32_dpp v223, v223, v223 row_ror:8 row_mask:0xf bank_mask:0xf
    s_branch L_varend
L_var4:
    s_nop 0
    s_add_u32 m0, s95, 73728
    s_nop 0
    buffer_load_dwordx4 v26, s[28:31], s93 offen offset:0 lds
    buffer_load_dwordx4 v27, s[28:31], s93 offen offset:1024 lds
    s_add_u32 m0, s95, 57344
    s_nop 0
    buffer_load_dwordx4 v28, s[28:31], s93 offen offset:0 lds
    buffer_load_dwordx4 v29, s[28:31], s93 offen offset:1024 lds
    s_bfe_u32 s91, s68, 0x40008
    s_lshl_b32 s92, s91, 7
    s_mul_i32 s93, s91, 393216
    s_add_u32 m0, s94, 81920
    s_nop 0
    buffer_load_dwordx4 v20, s[24:27], s92 offen offset:0 lds
    buffer_load_dwordx4 v21, s[24:27], s92 offen offset:1024 lds
    buffer_load_dwordx4 v22, s[24:27], s92 offen offset:2048 lds
    buffer_load_dwordx4 v23, s[24:27], s92 offen offset:3072 lds
    s_add_u32 m0, s95, 106496
    s_nop 0
    buffer_load_dwordx4 v24, s[28:31], s93 offen offset:0 lds
    buffer_load_dwordx4 v25, s[28:31], s93 offen offset:1024 lds
    s_add_u32 m0, s95, 114688
    s_nop 0
    buffer_load_dwordx4 v26, s[28:31], s93 offen offset:0 lds
    buffer_load_dwordx4 v27, s[28:31], s93 offen offset:1024 lds
    s_add_u32 m0, s95, 98304
    s_nop 0
    buffer_load_dwordx4 v28, s[28:31], s93 offen offset:0 lds
    buffer_load_dwordx4 v29, s[28:31], s93 offen offset:1024 lds
    s_lshl_b32 s12, s19, 2
    s_add_u32 s12, s12, s21
    s_lshl_b32 s12, s12, 10
    s_lshl_b32 s13, s21, 10
    s_add_u32 m0, s13, 155648
    s_nop 0
    buffer_load_dwordx4 v5, s[76:79], s12 offen lds
    s_lshl_b32 s12, s22, 11
    buffer_load_dwordx4 v[40:43], v5, s[24:27], s12 offen offset:0
    buffer_load_dwordx4 v[44:47], v5, s[24:27], s12 offen offset:1024
    buffer_load_dwordx4 v[48:51], v5, s[24:27], s12 offen offset:2048
    buffer_load_dwordx4 v[52:55], v5, s[24:27], s12 offen offset:3072
    buffer_load_dwordx4 v[56:59], v5, s[80:83], 0 offen offset:0
    buffer_load_dwordx4 v[60:63], v5, s[80:83], 0 offen offset:1024
    buffer_load_dwordx4 v[64:67], v5, s[84:87], 0 offen offset:0
    buffer_load_dwordx4 v[68:71], v5, s[84:87], 0 offen offset:1024
    s_waitcnt vmcnt(19)
    s_barrier
    s_bfe_u32 s91, s68, 0x4000c
    s_lshl_b32 s92, s91, 7
    s_mul_i32 s93, s91, 393216
    s_add_u32 m0, s94, 0
    s_nop 0
    buffer_load_dwordx4 v20, s[24:27], s92 offen offset:0 lds
    s_waitcnt vmcnt(1)
    s_mov_b32 s8, 0xffff0000
    v_lshlrev_b32 v72, 16, v56
    v_and_b32 v56, s8, v56
    v_lshlrev_b32 v73, 16, v64
    v_and_b32 v64, s8, v64
    v_lshlrev_b32 v112, 16, v40
    buffer_load_dwordx4 v21, s[24:27], s92 offen offset:1024 lds
    v_and_b32 v40, s8, v40
    v_lshlrev_b32 v116, 16, v48
    v_and_b32 v48, s8, v48
    v_mul_f32 v113, v112, v73
    v_mul_f32 v114, v40, v64
    v_mul_f32 v90, v112, v72
    v_mul_f32 v117, v116, v73
    buffer_load_dwordx4 v22, s[24:27], s92 offen offset:2048 lds
    v_mul_f32 v118, v48, v64
    v_mul_f32 v92, v116, v72
    v_cvt_pk_bf16_f32 v113, 0, v113
    v_cvt_pk_bf16_f32 v114, 0, v114
    v_fmac_f32 v90, v40, v56
    v_cvt_pk_bf16_f32 v117, 0, v117
    v_cvt_pk_bf16_f32 v118, 0, v118
    buffer_load_dwordx4 v23, s[24:27], s92 offen offset:3072 lds
    v_fmac_f32 v92, v48, v56
    v_add_f32 v91, v113, v114
    v_add_f32 v93, v117, v118
    v_lshlrev_b32 v72, 16, v57
    v_and_b32 v57, s8, v57
    v_lshlrev_b32 v73, 16, v65
    v_and_b32 v65, s8, v65
    s_add_u32 m0, s95, 24576
    s_nop 0
    buffer_load_dwordx4 v24, s[28:31], s93 offen offset:0 lds
    v_lshlrev_b32 v112, 16, v41
    v_and_b32 v41, s8, v41
    v_lshlrev_b32 v116, 16, v49
    v_and_b32 v49, s8, v49
    v_mul_f32 v113, v112, v73
    v_mul_f32 v114, v41, v65
    v_fmac_f32 v90, v112, v72
    buffer_load_dwordx4 v25, s[28:31], s93 offen offset:1024 lds
    v_mul_f32 v117, v116, v73
    v_mul_f32 v118, v49, v65
    v_fmac_f32 v92, v116, v72
    v_cvt_pk_bf16_f32 v113, 0, v113
    v_cvt_pk_bf16_f32 v114, 0, v114
    v_fmac_f32 v90, v41, v57
    v_cvt_pk_bf16_f32 v117, 0, v117
    s_add_u32 m0, s95, 32768
    s_nop 0
    buffer_load_dwordx4 v26, s[28:31], s93 offen offset:0 lds
    v_cvt_pk_bf16_f32 v118, 0, v118
    v_fmac_f32 v92, v49, v57
    v_add_f32 v91, v91, v113
    v_add_f32 v93, v93, v117
    v_add_f32 v91, v91, v114
    v_add_f32 v93, v93, v118
    v_lshlrev_b32 v72, 16, v58
    buffer_load_dwordx4 v27, s[28:31], s93 offen offset:1024 lds
    v_and_b32 v58, s8, v58
    v_lshlrev_b32 v73, 16, v66
    v_and_b32 v66, s8, v66
    v_lshlrev_b32 v112, 16, v42
    v_and_b32 v42, s8, v42
    v_lshlrev_b32 v116, 16, v50
    v_and_b32 v50, s8, v50
    s_add_u32 m0, s95, 16384
    s_nop 0
    buffer_load_dwordx4 v28, s[28:31], s93 offen offset:0 lds
    v_mul_f32 v113, v112, v73
    v_mul_f32 v114, v42, v66
    v_fmac_f32 v90, v112, v72
    v_mul_f32 v117, v116, v73
    v_mul_f32 v118, v50, v66
    v_fmac_f32 v92, v116, v72
    v_cvt_pk_bf16_f32 v113, 0, v113
    buffer_load_dwordx4 v29, s[28:31], s93 offen offset:1024 lds
    v_cvt_pk_bf16_f32 v114, 0, v114
    v_fmac_f32 v90, v42, v58
    v_cvt_pk_bf16_f32 v117, 0, v117
    v_cvt_pk_bf16_f32 v118, 0, v118
    v_fmac_f32 v92, v50, v58
    v_add_f32 v91, v91, v113
    v_add_f32 v93, v93, v117
    s_cmp_lg_u32 s21, 0
    s_cbranch_scc1 L_noclr_4
    v_mov_b32 v104, -1
    v_mov_b32 v105, -1
    v_mov_b32 v106, -1
    v_mov_b32 v107, -1
    s_lshl_b32 s12, s19, 13
    s_lshl_b32 s13, s18, 9
    s_add_u32 s12, s12, s13
    s_add_u32 s12, s12, 32768
    s_lshl_b32 s13, s19, 11
    s_lshl_b32 s90, s18, 7
    s_add_u32 s13, s13, s90
    s_add_u32 s13, s13, 163840
    s_mov_b32 exec_hi, 0
    buffer_store_dwordx4 v[104:107], v5, s[32:35], s12 offen sc1
    s_mov_b32 exec_lo, 255
    buffer_store_dwordx4 v[104:107], v5, s[32:35], s13 offen sc1
    s_mov_b64 exec, -1
L_noclr_4:
    v_add_f32 v91, v91, v114
    v_add_f32 v93, v93, v118
    v_lshlrev_b32 v72, 16, v59
    v_and_b32 v59, s8, v59
    v_lshlrev_b32 v73, 16, v67
    v_and_b32 v67, s8, v67
    v_lshlrev_b32 v112, 16, v43
    v_and_b32 v43, s8, v43
    v_lshlrev_b32 v116, 16, v51
    v_and_b32 v51, s8, v51
    v_mul_f32 v113, v112, v73
    v_mul_f32 v114, v43, v67
    v_fmac_f32 v90, v112, v72
    v_mul_f32 v117, v116, v73
    v_mul_f32 v118, v51, v67
    v_fmac_f32 v92, v116, v72
    v_cvt_pk_bf16_f32 v113, 0, v113
    v_cvt_pk_bf16_f32 v114, 0, v114
    v_fmac_f32 v90, v43, v59
    v_cvt_pk_bf16_f32 v117, 0, v117
    v_cvt_pk_bf16_f32 v118, 0, v118
    v_fmac_f32 v92, v51, v59
    v_add_f32 v91, v91, v113
    v_add_f32 v93, v93, v117
    v_add_f32 v91, v91, v114
    s_barrier
    s_bfe_u32 s91, s68, 0x40010
    s_lshl_b32 s92, s91, 7
    s_mul_i32 s93, s91, 393216
    s_add_u32 m0, s94, 40960
    s_nop 0
    buffer_load_dwordx4 v20, s[24:27], s92 offen offset:0 lds
    v_add_f32 v93, v93, v118
    v_lshlrev_b32 v72, 16, v60
    v_and_b32 v60, s8, v60
    v_lshlrev_b32 v73, 16, v68
    v_and_b32 v68, s8, v68
    v_lshlrev_b32 v112, 16, v44
    v_and_b32 v44, s8, v44
    buffer_load_dwordx4 v21, s[24:27], s92 offen offset:1024 lds
    v_lshlrev_b32 v116, 16, v52
    v_and_b32 v52, s8, v52
    v_mul_f32 v113, v112, v73
    v_mul_f32 v114, v44, v68
    v_fmac_f32 v90, v112, v72
    v_mul_f32 v117, v116, v73
    v_mul_f32 v118, v52, v68
    buffer_load_dwordx4 v22, s[24:27], s92 offen offset:2048 lds
    v_fmac_f32 v92, v116, v72
    v_cvt_pk_bf16_f32 v113, 0, v113
    v_cvt_pk_bf16_f32 v114, 0, v114
    v_fmac_f32 v90, v44, v60
    v_cvt_pk_bf16_f32 v117, 0, v117
    v_cvt_pk_bf16_f32 v118, 0, v118
    v_fmac_f32 v92, v52, v60
    buffer_load_dwordx4 v23, s[24:27], s92 offen offset:3072 lds
    v_add_f32 v91, v91, v113
    v_add_f32 v93, v93, v117
    v_add_f32 v91, v91, v114
    v_add_f32 v93, v93, v118
    v_lshlrev_b32 v72, 16, v61
    v_and_b32 v61, s8, v61
    v_lshlrev_b32 v73, 16, v69
    s_add_u32 m0, s95, 65536
    s_nop 0
    buffer_load_dwordx4 v24, s[28:31], s93 offen offset:0 lds
    v_and_b32 v69, s8, v69
    v_lshlrev_b32 v112, 16, v45
    v_and_b32 v45, s8, v45
    v_lshlrev_b32 v116, 16, v53
    v_and_b32 v53, s8, v53
    v_mul_f32 v113, v112, v73
    v_mul_f32 v114, v45, v69
    buffer_load_dwordx4 v25, s[28:31], s93 offen offset:1024 lds
    v_fmac_f32 v90, v112, v72
    v_mul_f32 v117, v116, v73
    v_mul_f32 v118, v53, v69
    v_fmac_f32 v92, v116, v72
    v_cvt_pk_bf16_f32 v113, 0, v113
    v_cvt_pk_bf16_f32 v114, 0, v114
    v_fmac_f32 v90, v45, v61
    s_add_u32 m0, s95, 73728
    s_nop 0
    buffer_load_dwordx4 v26, s[28:31], s93 offen offset:0 lds
    v_cvt_pk_bf16_f32 v117, 0, v117
    v_cvt_pk_bf16_f32 v118, 0, v118
    v_fmac_f32 v92, v53, v61
    v_add_f32 v91, v91, v113
    v_add_f32 v93, v93, v117
    v_add_f32 v91, v91, v114
    v_add_f32 v93, v93, v118
    buffer_load_dwordx4 v27, s[28:31], s93 offen offset:1024 lds
    v_lshlrev_b32 v72, 16, v62
    v_and_b32 v62, s8, v62
    v_lshlrev_b32 v73, 16, v70
    v_and_b32 v70, s8, v70
    v_lshlrev_b32 v112, 16, v46
    v_and_b32 v46, s8, v46
    v_lshlrev_b32 v116, 16, v54
    s_add_u32 m0, s95, 57344
    s_nop 0
    buffer_load_dwordx4 v28, s[28:31], s93 offen offset:0 lds
    v_and_b32 v54, s8, v54
    v_mul_f32 v113, v112, v73
    v_mul_f32 v114, v46, v70
    v_fmac_f32 v90, v112, v72
    v_mul_f32 v117, v116, v73
    v_mul_f32 v118, v54, v70
    v_fmac_f32 v92, v116, v72
    buffer_load_dwordx4 v29, s[28:31], s93 offen offset:1024 lds
    v_cvt_pk_bf16_f32 v113, 0, v113
    v_cvt_pk_bf16_f32 v114, 0, v114
    v_fmac_f32 v90, v46, v62
    v_cvt_pk_bf16_f32 v117, 0, v117
    v_cvt_pk_bf16_f32 v118, 0, v118
    v_fmac_f32 v92, v54, v62
    v_add_f32 v91, v91, v113
    buffer_load_dword v15, v13, s[72:75], 0 offen offset:4 sc1
    v_add_f32 v93, v93, v117
    v_add_f32 v91, v91, v114
    v_add_f32 v93, v93, v118
    v_lshlrev_b32 v72, 16, v63
    v_and_b32 v63, s8, v63
    v_lshlrev_b32 v73, 16, v71
    v_and_b32 v71, s8, v71
    v_lshlrev_b32 v112, 16, v47
    v_and_b32 v47, s8, v47
    v_lshlrev_b32 v116, 16, v55
    v_and_b32 v55, s8, v55
    v_mul_f32 v113, v112, v73
    v_mul_f32 v114, v47, v71
    v_fmac_f32 v90, v112, v72
    v_mul_f32 v117, v116, v73
    v_mul_f32 v118, v55, v71
    v_fmac_f32 v92, v116, v72
    v_cvt_pk_bf16_f32 v113, 0, v113
    v_cvt_pk_bf16_f32 v114, 0, v114
    v_fmac_f32 v90, v47, v63
    v_cvt_pk_bf16_f32 v117, 0, v117
    v_cvt_pk_bf16_f32 v118, 0, v118
    v_fmac_f32 v92, v55, v63
    v_add_f32 v91, v91, v113
    v_add_f32 v93, v93, v117
    s_waitcnt vmcnt(11)
    s_barrier
    s_bfe_u32 s91, s68, 0x40014
    s_lshl_b32 s92, s91, 7
    s_mul_i32 s93, s91, 393216
    s_add_u32 m0, s94, 81920
    s_nop 0
    buffer_load_dwordx4 v20, s[24:27], s92 offen offset:0 lds
    v_add_f32 v91, v91, v114
    v_add_f32 v93, v93, v118
    v_add_f32_dpp v90, v90, v90 row_shr:1 row_mask:0xf bank_mask:0xf
    v_add_f32_dpp v91, v91, v91 row_shr:1 row_mask:0xf bank_mask:0xf
    v_add_f32_dpp v92, v92, v92 row_shr:1 row_mask:0xf bank_mask:0xf
    v_add_f32_dpp v93, v93, v93 row_shr:1 row_mask:0xf bank_mask:0xf
    v_add_f32_dpp v90, v90, v90 row_shr:2 row_mask:0xf bank_mask:0xf
    buffer_load_dwordx4 v21, s[24:27], s92 offen offset:1024 lds
    v_add_f32_dpp v91, v91, v91 row_shr:2 row_mask:0xf bank_mask:0xf
    v_add_f32_dpp v92, v92, v92 row_shr:2 row_mask:0xf bank_mask:0xf
    v_add_f32_dpp v93, v93, v93 row_shr:2 row_mask:0xf bank_mask:0xf
    v_add_f32_dpp v90, v90, v90 row_shr:4 row_mask:0xf bank_mask:0xf
    v_add_f32_dpp v91, v91, v91 row_shr:4 row_mask:0xf bank_mask:0xf
    v_add_f32_dpp v92, v92, v92 row_shr:4 row_mask:0xf bank_mask:0xf
    v_add_f32_dpp v93, v93, v93 row_shr:4 row_mask:0xf bank_mask:0xf
    buffer_load_dwordx4 v22, s[24:27], s92 offen offset:2048 lds
    v_add_f32_dpp v90, v90, v90 row_shr:8 row_mask:0xf bank_mask:0xf
    v_add_f32_dpp v91, v91, v91 row_shr:8 row_mask:0xf bank_mask:0xf
    v_add_f32_dpp v92, v92, v92 row_shr:8 row_mask:0xf bank_mask:0xf
    v_add_f32_dpp v93, v93, v93 row_shr:8 row_mask:0xf bank_mask:0xf
    v_add_f32_dpp v90, v90, v90 row_bcast:15 row_mask:0xa bank_mask:0xf
    v_add_f32_dpp v91, v91, v91 row_bcast:15 row_mask:0xa bank_mask:0xf
    v_add_f32_dpp v92, v92, v92 row_bcast:15 row_mask:0xa bank_mask:0xf
    buffer_load_dwordx4 v23, s[24:27], s92 offen offset:3072 lds
    v_add_f32_dpp v93, v93, v93 row_bcast:15 row_mask:0xa bank_mask:0xf
    v_add_f32_dpp v90, v90, v90 row_bcast:31 row_mask:0xc bank_mask:0xf
    v_add_f32_dpp v91, v91, v91 row_bcast:31 row_mask:0xc bank_mask:0xf
    v_add_f32_dpp v92, v92, v92 row_bcast:31 row_mask:0xc bank_mask:0xf
    v_add_f32_dpp v93, v93, v93 row_bcast:31 row_mask:0xc bank_mask:0xf
    v_mov_b32 v97, 0x8000
    v_mov_b32 v98, 0xffff
    s_add_u32 m0, s95, 106496
    s_nop 0
    buffer_load_dwordx4 v24, s[28:31], s93 offen offset:0 lds
    v_cvt_pk_bf16_f32 v94, v90, v91
    v_cvt_pk_bf16_f32 v104, v92, v93
    v_and_b32 v95, 0xffff, v94
    v_and_b32 v96, 0x8000, v94
    v_and_b32 v94, 0xffff0000, v94
    v_cmp_ne_u32 vcc, 0, v96
    v_mul_f32 v94, 0xbfb8aa3b, v94
    buffer_load_dwordx4 v25, s[28:31], s93 offen offset:1024 lds
    v_exp_f32 v94, v94
    v_cndmask_b32 v96, v97, v98, vcc
    v_xor_b32 v95, v95, v96
    v_add_f32 v94, 1.0, v94
    v_lshlrev_b32 v95, 11, v95
    v_rcp_f32 v94, v94
    s_sub_u32 s12, 2047, s22
    v_or_b32 v100, s12, v95
    s_add_u32 m0, s95, 114688
    s_nop 0
    buffer_load_dwordx4 v26, s[28:31], s93 offen offset:0 lds
    v_cvt_pk_bf16_f32 v94, v94, v94
    v_lshlrev_b32 v102, 16, v94
    v_and_b32 v105, 0xffff, v104
    v_and_b32 v106, 0x8000, v104
    v_and_b32 v104, 0xffff0000, v104
    v_cmp_ne_u32 vcc, 0, v106
    v_mul_f32 v104, 0xbfb8aa3b, v104
    buffer_load_dwordx4 v27, s[28:31], s93 offen offset:1024 lds
    v_exp_f32 v104, v104
    v_cndmask_b32 v106, v97, v98, vcc
    v_xor_b32 v105, v105, v106
    v_add_f32 v104, 1.0, v104
    v_lshlrev_b32 v105, 11, v105
    v_rcp_f32 v104, v104
    s_sub_u32 s12, 2046, s22
    v_or_b32 v101, s12, v105
    s_add_u32 m0, s95, 98304
    s_nop 0
    buffer_load_dwordx4 v28, s[28:31], s93 offen offset:0 lds
    v_cvt_pk_bf16_f32 v104, v104, v104
    v_lshlrev_b32 v103, 16, v104
    v_max_u32 v100, v100, v101
    s_lshl_b32 s12, s22, 2
    s_add_u32 s12, s12, 4096
    s_lshl_b32 s13, s21, 2
    s_add_u32 s13, s13, 162880
    v_mov_b32 v14, s13
    s_mov_b32 exec_lo, 0
    s_mov_b32 exec_hi, 0x80000000
    buffer_store_dwordx2 v[102:103], v13, s[32:35], s12 offen sc1
    ds_write_b32 v14, v100
    s_mov_b64 exec, -1
    s_waitcnt lgkmcnt(0)
    buffer_load_dwordx4 v29, s[28:31], s93 offen offset:1024 lds
    s_waitcnt vmcnt(12)
    s_barrier
    s_bfe_u32 s91, s68, 0x40018
    s_lshl_b32 s92, s91, 7
    s_mul_i32 s93, s91, 393216
    s_add_u32 m0, s94, 0
    s_nop 0
    buffer_load_dwordx4 v20, s[24:27], s92 offen offset:0 lds
    buffer_load_dwordx4 v21, s[24:27], s92 offen offset:1024 lds
    buffer_load_dwordx4 v22, s[24:27], s92 offen offset:2048 lds
    buffer_load_dwordx4 v23, s[24:27], s92 offen offset:3072 lds
    s_add_u32 m0, s95, 24576
    s_nop 0
    buffer_load_dwordx4 v24, s[28:31], s93 offen offset:0 lds
    buffer_load_dwordx4 v25, s[28:31], s93 offen offset:1024 lds
    s_add_u32 m0, s95, 32768
    s_nop 0
    buffer_load_dwordx4 v26, s[28:31], s93 offen offset:0 lds
    buffer_load_dwordx4 v27, s[28:31], s93 offen offset:1024 lds
    s_add_u32 m0, s95, 16384
    s_nop 0
    buffer_load_dwordx4 v28, s[28:31], s93 offen offset:0 lds
    buffer_load_dwordx4 v29, s[28:31], s93 offen offset:1024 lds
    s_cmp_ge_u32 s10, 224
    s_cbranch_scc1 L_p30_4
    s_add_u32 s12, s71, 0
    buffer_load_dwordx4 v[128:131], v30, s[40:43], s12 offen nt
    s_add_u32 s12, s71, 7168
    buffer_load_dwordx4 v[132:135], v30, s[40:43], s12 offen nt
    s_add_u32 s12, s71, 14336
    buffer_load_dwordx4 v[136:139], v30, s[40:43], s12 offen nt
    s_add_u32 s12, s71, 21504
    buffer_load_dwordx4 v[140:143], v30, s[40:43], s12 offen nt
    s_add_u32 s12, s71, 28672
    buffer_load_dwordx4 v[144:147], v30, s[40:43], s12 offen nt
    s_add_u32 s12, s71, 35840
    buffer_load_dwordx4 v[148:151], v30, s[40:43], s12 offen nt
    s_add_u32 s12, s71, 43008
    buffer_load_dwordx4 v[152:155], v30, s[40:43], s12 offen nt
    s_add_u32 s12, s71, 50176
    buffer_load_dwordx4 v[156:159], v30, s[40:43], s12 offen nt
    s_branch L_p3e0_4
L_p30_4:
    s_mov_b64 exec, 63
    s_bfe_u32 s12, s68, 0x4000c
    s_mul_i32 s12, s12, 393216
    buffer_load_dword v128, v32, s[28:31], s12 offen
    s_bfe_u32 s12, s68, 0x40010
    s_mul_i32 s12, s12, 393216
    buffer_load_dword v132, v32, s[28:31], s12 offen
    s_bfe_u32 s12, s68, 0x40014
    s_mul_i32 s12, s12, 393216
    buffer_load_dword v136, v32, s[28:31], s12 offen
    s_bfe_u32 s12, s68, 0x40018
    s_mul_i32 s12, s12, 393216
    buffer_load_dword v140, v32, s[28:31], s12 offen
    s_bfe_u32 s12, s68, 0x4001c
    s_mul_i32 s12, s12, 393216
    buffer_load_dword v144, v32, s[28:31], s12 offen
    s_bfe_u32 s12, s69, 0x40000
    s_mul_i32 s12, s12, 393216
    buffer_load_dword v148, v32, s[28:31], s12 offen
    s_bfe_u32 s12, s69, 0x40004
    s_mul_i32 s12, s12, 393216
    buffer_load_dword v152, v32, s[28:31], s12 offen
    s_bfe_u32 s12, s69, 0x40008
    s_mul_i32 s12, s12, 393216
    buffer_load_dword v156, v32, s[28:31], s12 offen
    s_mov_b64 exec, -1
L_p3e0_4:
    s_waitcnt vmcnt(19)
    s_waitcnt vmcnt(18)
    s_barrier
    s_bfe_u32 s91, s68, 0x4001c
    s_lshl_b32 s92, s91, 7
    s_mul_i32 s93, s91, 393216
    s_add_u32 m0, s94, 40960
    s_nop 0
    buffer_load_dwordx4 v20, s[24:27], s92 offen offset:0 lds
    buffer_load_dwordx4 v21, s[24:27], s92 offen offset:1024 lds
    buffer_load_dwordx4 v22, s[24:27], s92 offen offset:2048 lds
    buffer_load_dwordx4 v23, s[24:27], s92 offen offset:3072 lds
    s_add_u32 m0, s95, 65536
    s_nop 0
    buffer_load_dwordx4 v24, s[28:31], s93 offen offset:0 lds
    s_mov_b32 s13, 0
L_tagchk_4:
    v_readfirstlane_b32 s23, v15
    s_nop 1
    s_cmp_lg_u32 s23, 0
    s_cbranch_scc1 L_tagok_4
    s_add_u32 s13, s13, 1
    s_cmp_ge_u32 s13, 16384
    s_cbranch_scc1 L_tagok_4
    buffer_load_dword v15, v13, s[72:75], 0 offen offset:4 sc1
    s_waitcnt vmcnt(0)
    s_branch L_tagchk_4
L_tagok_4:
    s_and_b32 s76, s23, 0xff
    s_bfe_u32 s77, s23, 0x80008
    s_bfe_u32 s78, s23, 0x80010
    s_lshr_b32 s79, s23, 24
    v_and_b32 v35, 3, v2
    v_lshlrev_b32 v35, 3, v35
    v_bfe_u32 v35, s23, v35, 8
    s_cmp_lg_u32 s21, 0
    s_cbranch_scc1 L_nopub_4
    v_mov_b32 v14, 162880
    ds_read_b128 v[104:107], v14
    s_lshl_b32 s12, s2, 3
    s_add_u32 s12, s12, 0
    s_waitcnt lgkmcnt(0)
    v_max3_u32 v104, v104, v105, v106
    v_max_u32 v104, v104, v107
    v_mov_b32 v105, s23
    s_mov_b64 exec, 1
    buffer_store_dwordx2 v[104:105], v13, s[32:35], s12 offen sc1
    s_mov_b64 exec, -1
L_nopub_4:
    s_waitcnt vmcnt(13)
    s_barrier
    s_add_u32 m0, s95, 65536
    s_nop 0
    buffer_load_dwordx4 v25, s[28:31], s93 offen offset:1024 lds
    s_add_u32 m0, s95, 73728
    s_nop 0
    buffer_load_dwordx4 v26, s[28:31], s93 offen offset:0 lds
    buffer_load_dwordx4 v27, s[28:31], s93 offen offset:1024 lds
    s_add_u32 m0, s95, 57344
    s_nop 0
    buffer_load_dwordx4 v28, s[28:31], s93 offen offset:0 lds
    buffer_load_dwordx4 v29, s[28:31], s93 offen offset:1024 lds
    s_bfe_u32 s91, s69, 0x40000
    s_lshl_b32 s92, s91, 7
    s_mul_i32 s93, s91, 393216
    s_add_u32 m0, s94, 81920
    s_nop 0
    buffer_load_dwordx4 v20, s[24:27], s92 offen offset:0 lds
    buffer_load_dwordx4 v21, s[24:27], s92 offen offset:1024 lds
    buffer_load_dwordx4 v22, s[24:27], s92 offen offset:2048 lds
    buffer_load_dwordx4 v23, s[24:27], s92 offen offset:3072 lds
    s_add_u32 m0, s95, 106496
    s_nop 0
    buffer_load_dwordx4 v24, s[28:31], s93 offen offset:0 lds
    buffer_load_dwordx4 v25, s[28:31], s93 offen offset:1024 lds
    s_add_u32 m0, s95, 114688
    s_nop 0
    buffer_load_dwordx4 v26, s[28:31], s93 offen offset:0 lds
    s_waitcnt vmcnt(7)
    s_barrier
    s_add_u32 m0, s95, 114688
    s_nop 0
    buffer_load_dwordx4 v27, s[28:31], s93 offen offset:1024 lds
    s_add_u32 m0, s95, 98304
    s_nop 0
    buffer_load_dwordx4 v28, s[28:31], s93 offen offset:0 lds
    buffer_load_dwordx4 v29, s[28:31], s93 offen offset:1024 lds
    s_bfe_u32 s91, s69, 0x40004
    s_lshl_b32 s92, s91, 7
    s_mul_i32 s93, s91, 393216
    s_add_u32 m0, s94, 0
    s_nop 0
    buffer_load_dwordx4 v20, s[24:27], s92 offen offset:0 lds
    buffer_load_dwordx4 v21, s[24:27], s92 offen offset:1024 lds
    buffer_load_dwordx4 v22, s[24:27], s92 offen offset:2048 lds
    buffer_load_dwordx4 v23, s[24:27], s92 offen offset:3072 lds
    s_add_u32 m0, s95, 24576
    s_nop 0
    buffer_load_dwordx4 v24, s[28:31], s93 offen offset:0 lds
    buffer_load_dwordx4 v25, s[28:31], s93 offen offset:1024 lds
    s_add_u32 m0, s95, 32768
    s_nop 0
    buffer_load_dwordx4 v26, s[28:31], s93 offen offset:0 lds
    buffer_load_dwordx4 v27, s[28:31], s93 offen offset:1024 lds
    s_add_u32 m0, s95, 16384
    s_nop 0
    buffer_load_dwordx4 v28, s[28:31], s93 offen offset:0 lds
    s_waitcnt vmcnt(9)
    s_barrier
    s_add_u32 m0, s95, 16384
    s_nop 0
    buffer_load_dwordx4 v29, s[28:31], s93 offen offset:1024 lds
    s_bfe_u32 s91, s69, 0x40008
    s_lshl_b32 s92, s91, 7
    s_mul_i32 s93, s91, 393216
    s_add_u32 m0, s94, 40960
    s_nop 0
    buffer_load_dwordx4 v20, s[24:27], s92 offen offset:0 lds
    buffer_load_dwordx4 v21, s[24:27], s92 offen offset:1024 lds
    buffer_load_dwordx4 v22, s[24:27], s92 offen offset:2048 lds
    buffer_load_dwordx4 v23, s[24:27], s92 offen offset:3072 lds
    s_add_u32 m0, s95, 65536
    s_nop 0
    buffer_load_dwordx4 v24, s[28:31], s93 offen offset:0 lds
    buffer_load_dwordx4 v25, s[28:31], s93 offen offset:1024 lds
    s_add_u32 m0, s95, 73728
    s_nop 0
    buffer_load_dwordx4 v26, s[28:31], s93 offen offset:0 lds
    buffer_load_dwordx4 v27, s[28:31], s93 offen offset:1024 lds
    s_add_u32 m0, s95, 57344
    s_nop 0
    buffer_load_dwordx4 v28, s[28:31], s93 offen offset:0 lds
    buffer_load_dwordx4 v29, s[28:31], s93 offen offset:1024 lds
    s_waitcnt vmcnt(10)
    s_barrier
    s_bfe_u32 s91, s69, 0x4000c
    s_lshl_b32 s92, s91, 7
    s_mul_i32 s93, s91, 393216
    s_add_u32 m0, s94, 122880
    s_nop 0
    buffer_load_dwordx4 v20, s[24:27], s92 offen offset:0 lds
    buffer_load_dwordx4 v21, s[24:27], s92 offen offset:1024 lds
    buffer_load_dwordx4 v22, s[24:27], s92 offen offset:2048 lds
    buffer_load_dwordx4 v23, s[24:27], s92 offen offset:3072 lds
    s_add_u32 m0, s95, 106496
    s_nop 0
    buffer_load_dwordx4 v24, s[28:31], s93 offen offset:0 lds
    buffer_load_dwordx4 v25, s[28:31], s93 offen offset:1024 lds
    s_add_u32 m0, s95, 114688
    s_nop 0
    buffer_load_dwordx4 v26, s[28:31], s93 offen offset:0 lds
    buffer_load_dwordx4 v27, s[28:31], s93 offen offset:1024 lds
    s_cmp_ge_u32 s10, 224
    s_cbranch_scc1 L_p31_4
    s_add_u32 s12, s9, 0
    buffer_load_dwordx4 v[160:163], v30, s[44:47], s12 offen nt
    s_add_u32 s12, s9, 7168
    buffer_load_dwordx4 v[164:167], v30, s[44:47], s12 offen nt
    s_add_u32 s12, s9, 14336
    buffer_load_dwordx4 v[168:171], v30, s[44:47], s12 offen nt
    s_add_u32 s12, s9, 21504
    buffer_load_dwordx4 v[172:175], v30, s[44:47], s12 offen nt
    s_add_u32 s12, s9, 28672
    buffer_load_dwordx4 v[176:179], v30, s[44:47], s12 offen nt
    s_add_u32 s12, s9, 35840
    buffer_load_dwordx4 v[180:183], v30, s[44:47], s12 offen nt
    s_add_u32 s12, s9, 43008
    buffer_load_dwordx4 v[184:187], v30, s[44:47], s12 offen nt
    s_add_u32 s12, s9, 50176
    buffer_load_dwordx4 v[188:191], v30, s[44:47], s12 offen nt
    s_branch L_p3e1_4
L_p31_4:
    s_mov_b64 exec, 63
    s_bfe_u32 s12, s69, 0x4000c
    s_mul_i32 s12, s12, 393216
    buffer_load_dword v160, v32, s[28:31], s12 offen
    s_bfe_u32 s12, s69, 0x40010
    s_mul_i32 s12, s12, 393216
    buffer_load_dword v164, v32, s[28:31], s12 offen
    s_bfe_u32 s12, s69, 0x40014
    s_mul_i32 s12, s12, 393216
    buffer_load_dword v168, v32, s[28:31], s12 offen
    s_bfe_u32 s12, s69, 0x40018
    s_mul_i32 s12, s12, 393216
    buffer_load_dword v172, v32, s[28:31], s12 offen
    s_bfe_u32 s12, s69, 0x4001c
    s_mul_i32 s12, s12, 393216
    buffer_load_dword v176, v32, s[28:31], s12 offen
    s_mov_b64 exec, 1
    s_bfe_u32 s12, s69, 0x4001c
    s_mul_i32 s12, s12, 393216
    buffer_load_dword v180, v32, s[28:31], s12 offen
    s_bfe_u32 s12, s69, 0x4001c
    s_mul_i32 s12, s12, 393216
    buffer_load_dword v184, v32, s[28:31], s12 offen
    s_bfe_u32 s12, s69, 0x4001c
    s_mul_i32 s12, s12, 393216
    buffer_load_dword v188, v32, s[28:31], s12 offen
    s_mov_b64 exec, -1
L_p3e1_4:
    s_mov_b32 exec_lo, 0xffff0000
    s_mov_b32 exec_hi, 0
    buffer_load_dword v19, v10, s[36:39], 0 offen
    s_mov_b64 exec, -1
    s_mov_b32 s12, 0
    buffer_load_dwordx4 v[104:107], v5, s[32:35], s12 offen offset:0 sc1
    buffer_load_dwordx4 v[108:111], v5, s[32:35], s12 offen offset:1024 sc1
    s_waitcnt vmcnt(19)
    s_barrier
    s_bfe_u32 s91, s69, 0x40010
    s_lshl_b32 s92, s91, 7
    s_mul_i32 s93, s91, 393216
    s_add_u32 m0, s94, 139264
    s_nop 0
    buffer_load_dwordx4 v20, s[24:27], s92 offen offset:0 lds
    buffer_load_dwordx4 v21, s[24:27], s92 offen offset:1024 lds
    buffer_load_dwordx4 v22, s[24:27], s92 offen offset:2048 lds
    buffer_load_dwordx4 v23, s[24:27], s92 offen offset:3072 lds
    s_add_u32 m0, s95, 24576
    s_nop 0
    buffer_load_dwordx4 v24, s[28:31], s93 offen offset:0 lds
    s_waitcnt vmcnt(16)
    s_barrier
    s_add_u32 m0, s95, 24576
    s_nop 0
    buffer_load_dwordx4 v25, s[28:31], s93 offen offset:1024 lds
    s_waitcnt vmcnt(6)
    s_mov_b32 s13, 0
    v_xor_b32 v105, s23, v105
    v_xor_b32 v107, s23, v107
    v_xor_b32 v109, s23, v109
    v_xor_b32 v111, s23, v111
    v_or3_b32 v105, v105, v107, v109
    v_or_b32 v105, v105, v111
    v_cmp_ne_u32 vcc, 0, v105
    s_cbranch_vccnz L_keyre_4
L_keyok_4:
    s_add_u32 m0, s95, 32768
    s_nop 0
    buffer_load_dwordx4 v26, s[28:31], s93 offen offset:0 lds
    v_max3_u32 v104, v104, v106, v108
    v_max_u32 v104, v104, v110
    s_nop 1
    v_max_u32_dpp v104, v104, v104 row_shr:1 row_mask:0xf bank_mask:0xf
    s_nop 1
    v_max_u32_dpp v104, v104, v104 row_shr:2 row_mask:0xf bank_mask:0xf
    s_nop 1
    v_max_u32_dpp v104, v104, v104 row_shr:4 row_mask:0xf bank_mask:0xf
    s_nop 1
    v_max_u32_dpp v104, v104, v104 row_shr:8 row_mask:0xf bank_mask:0xf
    s_nop 1
    v_max_u32_dpp v104, v104, v104 row_bcast:15 row_mask:0xa bank_mask:0xf
    s_nop 1
    v_max_u32_dpp v104, v104, v104 row_bcast:31 row_mask:0xc bank_mask:0xf
    s_nop 0
    v_readlane_b32 s14, v104, 63
    s_nop 1
    s_and_b32 s15, s14, 2047
    s_sub_u32 s15, 2047, s15
    s_lshl_b32 s12, s15, 11
    s_lshl_b32 s13, s70, 1
    s_add_u32 s12, s12, s13
    buffer_load_dwordx4 v[36:39], v34, s[24:27], s12 offen
    s_lshr_b32 s12, s14, 11
    s_and_b32 s13, s12, 0x8000
    s_cmp_lg_u32 s13, 0
    s_mov_b32 s13, 0xffff
    s_cselect_b32 s13, 0x8000, s13
    s_xor_b32 s12, s12, s13
    s_lshl_b32 s12, s12, 16
    v_mov_b32 v105, s12
    buffer_load_dwordx4 v27, s[28:31], s93 offen offset:1024 lds
    v_mul_f32 v105, 0xbfb8aa3b, v105
    v_exp_f32 v105, v105
    s_nop 0
    v_add_f32 v105, 1.0, v105
    v_rcp_f32 v105, v105
    s_nop 0
    v_cvt_pk_bf16_f32 v105, v105, v105
    v_lshlrev_b32 v105, 16, v105
    s_add_u32 s12, s15, 1
    v_mov_b32 v104, s12
    v_mov_b32 v106, s23
    v_readfirstlane_b32 s14, v105
    v_mov_b32 v14, 162864
    s_mov_b64 exec, 1
    ds_write_b96 v14, v[104:106]
    s_mov_b64 exec, -1
    s_waitcnt lgkmcnt(0)
    s_bfe_u32 s91, s69, 0x40014
    s_lshl_b32 s92, s91, 7
    s_mul_i32 s93, s91, 393216
    s_add_u32 m0, s94, 40960
    s_nop 0
    buffer_load_dwordx4 v20, s[24:27], s92 offen offset:0 lds
    buffer_load_dwordx4 v21, s[24:27], s92 offen offset:1024 lds
    buffer_load_dwordx4 v22, s[24:27], s92 offen offset:2048 lds
    buffer_load_dwordx4 v23, s[24:27], s92 offen offset:3072 lds
    s_add_u32 m0, s95, 65536
    s_nop 0
    buffer_load_dwordx4 v24, s[28:31], s93 offen offset:0 lds
    buffer_load_dwordx4 v25, s[28:31], s93 offen offset:1024 lds
    s_add_u32 m0, s95, 73728
    s_nop 0
    buffer_load_dwordx4 v26, s[28:31], s93 offen offset:0 lds
    s_waitcnt vmcnt(7)
    s_barrier
    s_add_u32 m0, s95, 73728
    s_nop 0
    buffer_load_dwordx4 v27, s[28:31], s93 offen offset:1024 lds
    s_mov_b32 s8, 0xffff0000
    v_lshlrev_b32 v40, 16, v36
    v_and_b32 v41, s8, v36
    v_lshlrev_b32 v42, 16, v37
    v_and_b32 v43, s8, v37
    v_lshlrev_b32 v44, 16, v38
    v_and_b32 v45, s8, v38
    v_lshlrev_b32 v46, 16, v39
    v_and_b32 v47, s8, v39
    v_lshlrev_b32 v48, 16, v128
    v_lshlrev_b32 v49, 16, v129
    v_and_b32 v128, s8, v128
    v_and_b32 v129, s8, v129
    s_bfe_u32 s91, s69, 0x40018
    s_lshl_b32 s92, s91, 7
    s_mul_i32 s93, s91, 393216
    s_add_u32 m0, s94, 81920
    s_nop 0
    buffer_load_dwordx4 v20, s[24:27], s92 offen offset:0 lds
    v_mul_f32 v220, v48, v40
    v_mul_f32 v222, v49, v40
    v_mul_f32 v221, v128, v40
    v_mul_f32 v223, v129, v40
    v_lshlrev_b32 v50, 16, v130
    v_lshlrev_b32 v51, 16, v131
    v_and_b32 v130, s8, v130
    buffer_load_dwordx4 v21, s[24:27], s92 offen offset:1024 lds
    v_and_b32 v131, s8, v131
    v_mul_f32 v224, v50, v40
    v_mul_f32 v226, v51, v40
    v_mul_f32 v225, v130, v40
    v_mul_f32 v227, v131, v40
    v_lshlrev_b32 v48, 16, v160
    v_lshlrev_b32 v49, 16, v161
    buffer_load_dwordx4 v22, s[24:27], s92 offen offset:2048 lds
    v_and_b32 v160, s8, v160
    v_and_b32 v161, s8, v161
    v_mul_f32 v228, v48, v40
    v_mul_f32 v230, v49, v40
    v_mul_f32 v229, v160, v40
    v_mul_f32 v231, v161, v40
    v_lshlrev_b32 v50, 16, v162
    buffer_load_dwordx4 v23, s[24:27], s92 offen offset:3072 lds
    v_lshlrev_b32 v51, 16, v163
    v_and_b32 v162, s8, v162
    v_and_b32 v163, s8, v163
    v_mul_f32 v232, v50, v40
    v_mul_f32 v234, v51, v40
    v_mul_f32 v233, v162, v40
    v_mul_f32 v235, v163, v40
    s_add_u32 m0, s95, 106496
    s_nop 0
    buffer_load_dwordx4 v24, s[28:31], s93 offen offset:0 lds
    v_lshlrev_b32 v48, 16, v132
    v_lshlrev_b32 v49, 16, v133
    v_and_b32 v132, s8, v132
    v_and_b32 v133, s8, v133
    v_fmac_f32 v220, v48, v41
    v_fmac_f32 v222, v49, v41
    v_fmac_f32 v221, v132, v41
    buffer_load_dwordx4 v25, s[28:31], s93 offen offset:1024 lds
    v_fmac_f32 v223, v133, v41
    v_lshlrev_b32 v50, 16, v134
    v_lshlrev_b32 v51, 16, v135
    v_and_b32 v134, s8, v134
    v_and_b32 v135, s8, v135
    v_fmac_f32 v224, v50, v41
    v_fmac_f32 v226, v51, v41
    s_add_u32 m0, s95, 114688
    s_nop 0
    buffer_load_dwordx4 v26, s[28:31], s93 offen offset:0 lds
    v_fmac_f32 v225, v134, v41
    v_fmac_f32 v227, v135, v41
    v_lshlrev_b32 v48, 16, v164
    v_lshlrev_b32 v49, 16, v165
    v_and_b32 v164, s8, v164
    v_and_b32 v165, s8, v165
    v_fmac_f32 v228, v48, v41
    v_fmac_f32 v230, v49, v41
    v_fmac_f32 v229, v164, v41
    v_fmac_f32 v231, v165, v41
    v_lshlrev_b32 v50, 16, v166
    v_lshlrev_b32 v51, 16, v167
    v_and_b32 v166, s8, v166
    v_and_b32 v167, s8, v167
    buffer_load_dwordx4 v27, s[28:31], s93 offen offset:1024 lds
    v_fmac_f32 v232, v50, v41
    v_fmac_f32 v234, v51, v41
    v_fmac_f32 v233, v166, v41
    v_fmac_f32 v235, v167, v41
    v_lshlrev_b32 v48, 16, v136
    v_lshlrev_b32 v49, 16, v137
    v_and_b32 v136, s8, v136
    v_and_b32 v137, s8, v137
    v_fmac_f32 v220, v48, v42
    v_fmac_f32 v222, v49, v42
    v_fmac_f32 v221, v136, v42
    v_fmac_f32 v223, v137, v42
    v_lshlrev_b32 v50, 16, v138
    v_lshlrev_b32 v51, 16, v139
    v_and_b32 v138, s8, v138
    v_and_b32 v139, s8, v139
    v_fmac_f32 v224, v50, v42
    v_fmac_f32 v226, v51, v42
    v_fmac_f32 v225, v138, v42
    v_fmac_f32 v227, v139, v42
    v_lshlrev_b32 v48, 16, v168
    v_lshlrev_b32 v49, 16, v169
    v_and_b32 v168, s8, v168
    v_and_b32 v169, s8, v169
    v_fmac_f32 v228, v48, v42
    v_fmac_f32 v230, v49, v42
    v_fmac_f32 v229, v168, v42
    v_fmac_f32 v231, v169, v42
    v_lshlrev_b32 v50, 16, v170
    v_lshlrev_b32 v51, 16, v171
    v_and_b32 v170, s8, v170
    v_and_b32 v171, s8, v171
    v_fmac_f32 v232, v50, v42
    v_fmac_f32 v234, v51, v42
    v_fmac_f32 v233, v170, v42
    v_fmac_f32 v235, v171, v42
    v_lshlrev_b32 v48, 16, v140
    v_lshlrev_b32 v49, 16, v141
    v_and_b32 v140, s8, v140
    s_waitcnt vmcnt(8)
    s_barrier
    s_bfe_u32 s91, s69, 0x4001c
    s_lshl_b32 s92, s91, 7
    s_mul_i32 s93, s91, 393216
    s_add_u32 m0, s94, 0
    s_nop 0
    buffer_load_dwordx4 v20, s[24:27], s92 offen offset:0 lds
    v_and_b32 v141, s8, v141
    v_fmac_f32 v220, v48, v43
    v_fmac_f32 v222, v49, v43
    v_fmac_f32 v221, v140, v43
    v_fmac_f32 v223, v141, v43
    v_lshlrev_b32 v50, 16, v142
    v_lshlrev_b32 v51, 16, v143
    buffer_load_dwordx4 v21, s[24:27], s92 offen offset:1024 lds
    v_and_b32 v142, s8, v142
    v_and_b32 v143, s8, v143
    v_fmac_f32 v224, v50, v43
    v_fmac_f32 v226, v51, v43
    v_fmac_f32 v225, v142, v43
    v_fmac_f32 v227, v143, v43
    v_lshlrev_b32 v48, 16, v172
    buffer_load_dwordx4 v22, s[24:27], s92 offen offset:2048 lds
    v_lshlrev_b32 v49, 16, v173
    v_and_b32 v172, s8, v172
    v_and_b32 v173, s8, v173
    v_fmac_f32 v228, v48, v43
    v_fmac_f32 v230, v49, v43
    v_fmac_f32 v229, v172, v43
    v_fmac_f32 v231, v173, v43
    buffer_load_dwordx4 v23, s[24:27], s92 offen offset:3072 lds
    v_lshlrev_b32 v50, 16, v174
    v_lshlrev_b32 v51, 16, v175
    v_and_b32 v174, s8, v174
    v_and_b32 v175, s8, v175
    v_fmac_f32 v232, v50, v43
    v_fmac_f32 v234, v51, v43
    v_fmac_f32 v233, v174, v43
    s_add_u32 m0, s95, 24576
    s_nop 0
    buffer_load_dwordx4 v24, s[28:31], s93 offen offset:0 lds
    v_fmac_f32 v235, v175, v43
    v_lshlrev_b32 v48, 16, v144
    v_lshlrev_b32 v49, 16, v145
    v_and_b32 v144, s8, v144
    v_and_b32 v145, s8, v145
    v_fmac_f32 v220, v48, v44
    v_fmac_f32 v222, v49, v44
    buffer_load_dwordx4 v25, s[28:31], s93 offen offset:1024 lds
    v_fmac_f32 v221, v144, v44
    v_fmac_f32 v223, v145, v44
    v_lshlrev_b32 v50, 16, v146
    v_lshlrev_b32 v51, 16, v147
    v_and_b32 v146, s8, v146
    v_and_b32 v147, s8, v147
    v_fmac_f32 v224, v50, v44
    s_add_u32 m0, s95, 32768
    s_nop 0
    buffer_load_dwordx4 v26, s[28:31], s93 offen offset:0 lds
    v_fmac_f32 v226, v51, v44
    v_fmac_f32 v225, v146, v44
    v_fmac_f32 v227, v147, v44
    v_lshlrev_b32 v48, 16, v176
    v_lshlrev_b32 v49, 16, v177
    v_and_b32 v176, s8, v176
    v_and_b32 v177, s8, v177
    v_fmac_f32 v228, v48, v44
    v_fmac_f32 v230, v49, v44
    v_fmac_f32 v229, v176, v44
    v_fmac_f32 v231, v177, v44
    v_lshlrev_b32 v50, 16, v178
    v_lshlrev_b32 v51, 16, v179
    v_and_b32 v178, s8, v178
    buffer_load_dwordx4 v27, s[28:31], s93 offen offset:1024 lds
    v_and_b32 v179, s8, v179
    v_fmac_f32 v232, v50, v44
    v_fmac_f32 v234, v51, v44
    v_fmac_f32 v233, v178, v44
    v_fmac_f32 v235, v179, v44
    v_lshlrev_b32 v48, 16, v148
    v_lshlrev_b32 v49, 16, v149
    v_and_b32 v148, s8, v148
    v_and_b32 v149, s8, v149
    v_fmac_f32 v220, v48, v45
    v_fmac_f32 v222, v49, v45
    v_fmac_f32 v221, v148, v45
    v_fmac_f32 v223, v149, v45
    v_lshlrev_b32 v50, 16, v150
    v_lshlrev_b32 v51, 16, v151
    v_and_b32 v150, s8, v150
    v_and_b32 v151, s8, v151
    v_fmac_f32 v224, v50, v45
    v_fmac_f32 v226, v51, v45
    v_fmac_f32 v225, v150, v45
    v_fmac_f32 v227, v151, v45
    v_lshlrev_b32 v48, 16, v180
    v_lshlrev_b32 v49, 16, v181
    v_and_b32 v180, s8, v180
    v_and_b32 v181, s8, v181
    v_fmac_f32 v228, v48, v45
    v_fmac_f32 v230, v49, v45
    v_fmac_f32 v229, v180, v45
    v_fmac_f32 v231, v181, v45
    v_lshlrev_b32 v50, 16, v182
    v_lshlrev_b32 v51, 16, v183
    v_and_b32 v182, s8, v182
    v_and_b32 v183, s8, v183
    v_fmac_f32 v232, v50, v45
    v_fmac_f32 v234, v51, v45
    v_fmac_f32 v233, v182, v45
    v_fmac_f32 v235, v183, v45
    v_lshlrev_b32 v48, 16, v152
    v_lshlrev_b32 v49, 16, v153
    s_waitcnt vmcnt(8)
    s_barrier
    s_add_u32 s12, s97, 0
    buffer_load_dwordx4 v[192:195], v31, s[64:67], s12 offen nt
    s_add_u32 s12, s97, 16384
    buffer_load_dwordx4 v[196:199], v31, s[64:67], s12 offen nt
    s_add_u32 s12, s97, 32768
    buffer_load_dwordx4 v[200:203], v31, s[64:67], s12 offen nt
    s_add_u32 s12, s97, 49152
    buffer_load_dwordx4 v[204:207], v31, s[64:67], s12 offen nt
    s_add_u32 s12, s97, 65536
    buffer_load_dwordx4 v[208:211], v31, s[64:67], s12 offen nt
    s_add_u32 s12, s97, 81920
    buffer_load_dwordx4 v[212:215], v31, s[64:67], s12 offen nt
    s_add_u32 s12, s97, 98304
    buffer_load_dwordx4 v[216:219], v31, s[64:67], s12 offen nt
    s_bfe_u32 s12, s69, 0x4000c
    s_mul_i32 s12, s12, 393216
    s_add_u32 m0, s95, 16384
    s_nop 0
    buffer_load_dwordx4 v28, s[28:31], s12 offen offset:0 lds
    buffer_load_dwordx4 v29, s[28:31], s12 offen offset:1024 lds
    s_bfe_u32 s12, s69, 0x40010
    s_mul_i32 s12, s12, 393216
    s_add_u32 m0, s95, 57344
    s_nop 0
    buffer_load_dwordx4 v28, s[28:31], s12 offen offset:0 lds
    buffer_load_dwordx4 v29, s[28:31], s12 offen offset:1024 lds
    s_mul_i32 s12, s21, 16
    s_add_u32 s12, s12, 0
    s_and_b32 s90, s88, 1
    s_lshl_b32 s90, s90, 6
    s_xor_b32 s12, s12, s90
    s_lshl_b32 s12, s12, 14
    s_add_u32 s90, s12, 0
    buffer_load_dwordx4 v[84:87], v33, s[36:39], s90 offen
    s_add_u32 s90, s12, 16384
    buffer_load_dwordx4 v[88:91], v33, s[36:39], s90 offen
    s_add_u32 s90, s12, 32768
    buffer_load_dwordx4 v[92:95], v33, s[36:39], s90 offen
    s_add_u32 s90, s12, 49152
    buffer_load_dwordx4 v[96:99], v33, s[36:39], s90 offen
    s_add_u32 s90, s12, 65536
    buffer_load_dwordx4 v[100:103], v33, s[36:39], s90 offen
    s_add_u32 s90, s12, 81920
    buffer_load_dwordx4 v[116:119], v33, s[36:39], s90 offen
    s_add_u32 s90, s12, 98304
    buffer_load_dwordx4 v[120:123], v33, s[36:39], s90 offen
    s_add_u32 s90, s12, 114688
    buffer_load_dwordx4 v[124:127], v33, s[36:39], s90 offen
    s_add_u32 s90, s12, 131072
    buffer_load_dwordx4 v[64:67], v33, s[36:39], s90 offen
    v_and_b32 v152, s8, v152
    v_and_b32 v153, s8, v153
    v_fmac_f32 v220, v48, v46
    v_fmac_f32 v222, v49, v46
    v_fmac_f32 v221, v152, v46
    v_fmac_f32 v223, v153, v46
    v_lshlrev_b32 v50, 16, v154
    v_lshlrev_b32 v51, 16, v155
    v_and_b32 v154, s8, v154
    v_and_b32 v155, s8, v155
    v_fmac_f32 v224, v50, v46
    v_fmac_f32 v226, v51, v46
    v_fmac_f32 v225, v154, v46
    v_fmac_f32 v227, v155, v46
    v_lshlrev_b32 v48, 16, v184
    v_lshlrev_b32 v49, 16, v185
    v_and_b32 v184, s8, v184
    v_and_b32 v185, s8, v185
    v_fmac_f32 v228, v48, v46
    v_fmac_f32 v230, v49, v46
    v_fmac_f32 v229, v184, v46
    v_fmac_f32 v231, v185, v46
    v_lshlrev_b32 v50, 16, v186
    v_lshlrev_b32 v51, 16, v187
    v_and_b32 v186, s8, v186
    s_waitcnt vmcnt(20)
    s_barrier
    v_and_b32 v187, s8, v187
    v_fmac_f32 v232, v50, v46
    v_fmac_f32 v234, v51, v46
    v_fmac_f32 v233, v186, v46
    v_fmac_f32 v235, v187, v46
    v_lshlrev_b32 v48, 16, v156
    v_lshlrev_b32 v49, 16, v157
    v_and_b32 v156, s8, v156
    v_and_b32 v157, s8, v157
    v_fmac_f32 v220, v48, v47
    v_fmac_f32 v222, v49, v47
    v_fmac_f32 v221, v156, v47
    v_fmac_f32 v223, v157, v47
    v_lshlrev_b32 v50, 16, v158
    v_lshlrev_b32 v51, 16, v159
    v_and_b32 v158, s8, v158
    v_and_b32 v159, s8, v159
    v_fmac_f32 v224, v50, v47
    v_fmac_f32 v226, v51, v47
    v_fmac_f32 v225, v158, v47
    v_fmac_f32 v227, v159, v47
    v_lshlrev_b32 v48, 16, v188
    v_lshlrev_b32 v49, 16, v189
    v_and_b32 v188, s8, v188
    v_and_b32 v189, s8, v189
    v_fmac_f32 v228, v48, v47
    v_fmac_f32 v230, v49, v47
    v_fmac_f32 v229, v188, v47
    v_fmac_f32 v231, v189, v47
    v_lshlrev_b32 v50, 16, v190
    v_lshlrev_b32 v51, 16, v191
    v_and_b32 v190, s8, v190
    v_and_b32 v191, s8, v191
    v_fmac_f32 v232, v50, v47
    v_fmac_f32 v234, v51, v47
    v_fmac_f32 v233, v190, v47
    v_fmac_f32 v235, v191, v47
    v_permlane32_swap_b32 v220, v228
    v_permlane32_swap_b32 v221, v229
    v_permlane32_swap_b32 v222, v230
    v_permlane32_swap_b32 v223, v231
    v_permlane32_swap_b32 v224, v232
    v_permlane32_swap_b32 v225, v233
    v_permlane32_swap_b32 v226, v234
    v_permlane32_swap_b32 v227, v235
    v_add_f32 v220, v220, v228
    v_add_f32 v221, v221, v229
    v_add_f32 v222, v222, v230
    v_add_f32 v223, v223, v231
    v_add_f32 v224, v224, v232
    v_add_f32 v225, v225, v233
    v_add_f32 v226, v226, v234
    v_add_f32 v227, v227, v235
    v_permlane16_swap_b32 v220, v224
    v_permlane16_swap_b32 v221, v225
    v_permlane16_swap_b32 v222, v226
    v_permlane16_swap_b32 v223, v227
    v_add_f32 v220, v220, v224
    v_add_f32 v221, v221, v225
    v_add_f32 v222, v222, v226
    v_add_f32 v223, v223, v227
    v_add_f32_dpp v220, v220, v220 row_ror:8 row_mask:0xf bank_mask:0xf
    v_add_f32_dpp v221, v221, v221 row_ror:8 row_mask:0xf bank_mask:0xf
    v_add_f32_dpp v222, v222, v222 row_ror:8 row_mask:0xf bank_mask:0xf
    v_add_f32_dpp v223, v223, v223 row_ror:8 row_mask:0xf bank_mask:0xf
L_varend:
    s_nop 0
    v_lshrrev_b32 v14, 5, v2
    v_lshlrev_b32 v14, 8, v14
    v_lshl_add_u32 v14, v6, 5, v14
    v_and_b32 v16, 16, v2
    v_add_u32 v14, v14, v16
    s_lshl_b32 s12, s21, 9
    s_add_u32 s12, s12, 159744
    v_add_u32 v14, s12, v14
    ds_write_b128 v14, v[220:223]
    v_mov_b32 v14, 162848
    v_mov_b32 v16, 1
    s_mov_b64 exec, 1
    ds_add_rtn_u32 v17, v14, v16
    s_mov_b64 exec, -1
    s_waitcnt lgkmcnt(0)
    v_readfirstlane_b32 s12, v17
    s_nop 1
    s_cmp_lg_u32 s12, 3
    s_cbranch_scc1 L_nogu
    s_cmp_ge_u32 s10, 224
    s_cbranch_scc1 L_nogu
    v_lshlrev_b32 v14, 2, v2
    v_add_u32 v14, 159744, v14
    ds_read2st64_b32 v[220:221], v14 offset0:0 offset1:1
    ds_read2st64_b32 v[222:223], v14 offset0:2 offset1:3
    ds_read2st64_b32 v[224:225], v14 offset0:4 offset1:5
    ds_read2st64_b32 v[226:227], v14 offset0:6 offset1:7
    s_and_b32 s12, s10, 3
    s_mul_i32 s12, s12, 28672
    s_lshr_b32 s13, s10, 2
    s_lshl_b32 s13, s13, 8
    s_add_u32 s12, s12, 327680
    s_xor_b32 s90, s13, 1024
    s_add_u32 s90, s90, s12
    s_add_u32 s90, s90, 14336
    s_add_u32 s12, s12, s13
    v_lshlrev_b32 v14, 2, v2
    v_and_b32 v16, 1, v2
    v_lshlrev_b32 v16, 4, v16
    v_lshrrev_b32 v16, v16, s23
    v_bfe_u32 v17, v16, 8, 8
    v_and_b32 v16, 0xff, v16
    s_mov_b32 s13, 0xffffff00
    s_waitcnt lgkmcnt(0)
    v_pk_add_f32 v[220:221], v[220:221], v[222:223]
    v_pk_add_f32 v[224:225], v[224:225], v[226:227]
    v_pk_add_f32 v[220:221], v[220:221], v[224:225]
    v_and_or_b32 v220, v220, s13, v16
    v_and_or_b32 v221, v221, s13, v17
    buffer_store_dword v220, v14, s[32:35], s12 offen sc1
    buffer_store_dword v221, v14, s[32:35], s90 offen sc1
L_nogu:
    s_bfe_u32 s12, s69, 0x40014
    s_mul_i32 s12, s12, 393216
    s_add_u32 m0, s95, 65536
    s_nop 0
    buffer_load_dwordx4 v28, s[28:31], s12 offen offset:0 lds
    buffer_load_dwordx4 v29, s[28:31], s12 offen offset:1024 lds
    s_bfe_u32 s12, s69, 0x40018
    s_mul_i32 s12, s12, 393216
    s_add_u32 m0, s95, 73728
    s_nop 0
    buffer_load_dwordx4 v28, s[28:31], s12 offen offset:0 lds
    buffer_load_dwordx4 v29, s[28:31], s12 offen offset:1024 lds
    s_mul_i32 s12, s21, 16
    s_add_u32 s12, s12, 0
    s_and_b32 s90, s88, 1
    s_lshl_b32 s90, s90, 6
    s_xor_b32 s12, s12, s90
    s_lshl_b32 s12, s12, 14
    s_add_u32 s90, s12, 147456
    buffer_load_dwordx4 v[68:71], v33, s[36:39], s90 offen
    s_add_u32 s90, s12, 163840
    buffer_load_dwordx4 v[72:75], v33, s[36:39], s90 offen
    s_add_u32 s90, s12, 180224
    buffer_load_dwordx4 v[236:239], v33, s[36:39], s90 offen
    s_add_u32 s90, s12, 196608
    buffer_load_dwordx4 v[240:243], v33, s[36:39], s90 offen
    s_add_u32 s90, s12, 212992
    buffer_load_dwordx4 v[244:247], v33, s[36:39], s90 offen
    s_add_u32 s90, s12, 229376
    buffer_load_dwordx4 v[248:251], v33, s[36:39], s90 offen
    s_add_u32 s90, s12, 245760
    buffer_load_dwordx4 v[252:255], v33, s[36:39], s90 offen
    s_mul_i32 s12, s21, 4
    s_add_u32 s12, s12, 64
    s_and_b32 s90, s88, 1
    s_lshl_b32 s90, s90, 6
    s_xor_b32 s12, s12, s90
    s_lshl_b32 s12, s12, 14
    s_add_u32 s90, s12, 0
    buffer_load_dwordx4 v[220:223], v33, s[36:39], s90 offen
    s_add_u32 s90, s12, 16384
    buffer_load_dwordx4 v[224:227], v33, s[36:39], s90 offen
    s_add_u32 s90, s12, 32768
    buffer_load_dwordx4 v[228:231], v33, s[36:39], s90 offen
    s_add_u32 s90, s12, 49152
    buffer_load_dwordx4 v[232:235], v33, s[36:39], s90 offen
    v_mov_b32 v14, 162816
    s_mov_b32 s13, 0
L_dspin_g:
    ds_read_b128 v[104:107], v14
    s_add_u32 s13, s13, 1
    s_cmp_ge_u32 s13, 262144
    s_cbranch_scc1 L_dok_g
    s_waitcnt lgkmcnt(0)
    v_and_b32 v104, v104, v105
    v_and_b32 v106, v106, v107
    v_and_b32 v104, v104, v106
    v_cmp_eq_u32 vcc, 1, v104
    s_cbranch_vccz L_dspin_g
L_dok_g:
    s_waitcnt lgkmcnt(0)
    s_bfe_u32 s12, s69, 0x4001c
    s_mul_i32 s12, s12, 393216
    s_add_u32 m0, s95, 24576
    s_nop 0
    buffer_load_dwordx4 v28, s[28:31], s12 offen offset:0 lds
    buffer_load_dwordx4 v29, s[28:31], s12 offen offset:1024 lds
    s_cmp_eq_u32 s21, 0
    s_cbranch_scc1 L_nowrx
    s_mul_i32 s12, s21, 16
    s_add_u32 s12, s12, 64
    s_and_b32 s90, s88, 1
    s_lshl_b32 s90, s90, 6
    s_xor_b32 s12, s12, s90
    s_lshl_b32 s12, s12, 14
    s_add_u32 s90, s12, 0
    buffer_load_dwordx4 v[128:131], v33, s[36:39], s90 offen
    s_add_u32 s90, s12, 16384
    buffer_load_dwordx4 v[132:135], v33, s[36:39], s90 offen
    s_add_u32 s90, s12, 32768
    buffer_load_dwordx4 v[136:139], v33, s[36:39], s90 offen
    s_add_u32 s90, s12, 49152
    buffer_load_dwordx4 v[140:143], v33, s[36:39], s90 offen
    s_add_u32 s90, s12, 65536
    buffer_load_dwordx4 v[144:147], v33, s[36:39], s90 offen
    s_add_u32 s90, s12, 81920
    buffer_load_dwordx4 v[148:151], v33, s[36:39], s90 offen
    s_add_u32 s90, s12, 98304
    buffer_load_dwordx4 v[152:155], v33, s[36:39], s90 offen
    s_add_u32 s90, s12, 114688
    buffer_load_dwordx4 v[156:159], v33, s[36:39], s90 offen
    s_add_u32 s90, s12, 131072
    buffer_load_dwordx4 v[160:163], v33, s[36:39], s90 offen
    s_add_u32 s90, s12, 147456
    buffer_load_dwordx4 v[164:167], v33, s[36:39], s90 offen
    s_add_u32 s90, s12, 163840
    buffer_load_dwordx4 v[168:171], v33, s[36:39], s90 offen
    s_add_u32 s90, s12, 180224
    buffer_load_dwordx4 v[172:175], v33, s[36:39], s90 offen
    s_add_u32 s90, s12, 196608
    buffer_load_dwordx4 v[176:179], v33, s[36:39], s90 offen
    s_add_u32 s90, s12, 212992
    buffer_load_dwordx4 v[180:183], v33, s[36:39], s90 offen
    s_add_u32 s90, s12, 229376
    buffer_load_dwordx4 v[184:187], v33, s[36:39], s90 offen
    s_add_u32 s90, s12, 245760
    buffer_load_dwordx4 v[188:191], v33, s[36:39], s90 offen
L_nowrx:
    v_mov_b32 v62, v6
    v_mov_b32 v63, v35
    s_mov_b32 s86, s96
    s_mov_b32 s4, s15
    s_mov_b32 s5, s14
    v_mov_b32 v61, v33
    s_mov_b32 s68, s58
    s_and_b32 s69, s59, 0xffff
    s_mov_b32 s70, 4194304
    s_mov_b32 s71, 0x00020000
    s_and_b32 s90, s20, 3
    s_lshr_b32 s91, s20, 2
    s_lshl_b32 s12, s88, 3
    s_lshl_b32 s13, s90, 1
    s_add_u32 s12, s12, s13
    s_add_u32 s92, s12, s91
    s_lshl_b32 s12, s92, 4
    v_and_b32 v3, 15, v2
    v_add_u32 v6, s12, v3
    v_lshlrev_b32 v8, 2, v6
    v_bfe_u32 v9, v2, 4, 1
    v_lshrrev_b32 v10, 5, v2
    v_lshlrev_b32 v7, 11, v6
    v_lshl_add_u32 v7, v9, 6, v7
    v_lshl_add_u32 v7, v10, 4, v7
    s_lshl_b32 s12, s89, 7
    v_add_u32 v7, s12, v7
    s_mov_b32 s12, 4096
    buffer_load_dwordx4 v[24:27], v7, s[24:27], 0 offen
    buffer_load_dwordx4 v[28:31], v7, s[24:27], 0 offen offset:32
    buffer_load_dword v48, v8, s[32:35], s12 offen sc1
    v_lshlrev_b32 v22, 8, v3
    v_lshl_add_u32 v22, v9, 7, v22
    v_lshl_add_u32 v22, v10, 5, v22
    v_lshlrev_b32 v10, 9, v10
    v_bfe_u32 v11, v2, 2, 2
    v_lshl_add_u32 v10, v11, 7, v10
    v_bfe_u32 v11, v2, 3, 1
    v_lshl_add_u32 v10, v11, 6, v10
    v_lshl_add_u32 v10, v9, 5, v10
    v_and_b32 v11, 3, v2
    v_lshl_add_u32 v10, v11, 3, v10
    v_xor_b32 v11, 64, v10
    s_lshl_b32 s12, s91, 8
    v_xor_b32 v17, s12, v5
    v_lshlrev_b32 v8, 2, v3
    s_lshl_b32 s12, s20, 12
    s_mov_b32 s15, 32768
    s_cmp_lt_u32 s20, 6
    s_cselect_b32 s13, s15, 131072
    s_add_u32 s12, s12, s13
    v_add_u32 v20, s12, v5
    s_xor_b32 s14, s20, 4
    s_lshl_b32 s12, s14, 12
    s_cmp_lt_u32 s14, 6
    s_cselect_b32 s13, s15, 131072
    s_add_u32 s12, s12, s13
    v_add_u32 v21, s12, v5
    s_lshl_b32 s12, s88, 2
    s_add_u32 s12, s12, s90
    s_lshl_b32 s13, s12, 16
    s_lshl_b32 s14, s91, 15
    s_add_u32 s13, s13, s14
    s_add_u32 s95, s13, 8388608
    s_lshl_b32 s12, s88, 12
    s_lshl_b32 s13, s89, 8
    s_mul_i32 s13, s13, 1
    s_add_u32 s12, s12, s13
    s_lshr_b32 s13, s90, 1
    s_lshl_b32 s13, s13, 7
    s_add_u32 s12, s12, s13
    s_lshl_b32 s13, s91, 6
    s_add_u32 s12, s12, s13
    s_add_u32 s15, s12, 524288
    s_lshl_b32 s97, s91, 4
    v_lshlrev_b32 v8, 7, v3
    s_lshl_b32 s12, s88, 1
    s_lshr_b32 s13, s90, 1
    s_add_u32 s12, s12, s13
    s_lshl_b32 s12, s12, 12
    s_lshl_b32 s13, s91, 11
    s_add_u32 s12, s12, s13
    s_and_b32 s13, s89, 0
    s_lshl_b32 s13, s13, 17
    s_add_u32 s12, s12, s13
    s_add_u32 s15, s12, 6291456
    s_mov_b32 s93, s89
    s_lshl_b32 s12, s21, 2
    s_add_u32 s12, s12, 162960
    v_mov_b32 v78, s12
    v_mov_b32 v79, 1
    s_cmp_eq_u32 s21, 0
    s_cbranch_scc1 L_wqw0
    s_waitcnt vmcnt(19)
    s_branch L_wqw1
L_wqw0:
    s_waitcnt vmcnt(3)
L_wqw1:
    s_mov_b64 exec, 1
    ds_write_b32 v78, v79
    s_mov_b64 exec, -1
    s_cmp_lg_u32 s21, 0
    s_cbranch_scc0 L_hop
    s_waitcnt vmcnt(0)
    v_sub_f32 v50, 1.0, v48
    v_cvt_pk_bf16_f32 v50, v50, v50
    v_lshlrev_b32 v50, 16, v50
    v_lshlrev_b32 v32, 16, v24
    v_and_b32 v33, 0xffff0000, v24
    v_lshlrev_b32 v34, 16, v25
    v_and_b32 v35, 0xffff0000, v25
    v_lshlrev_b32 v36, 16, v26
    v_and_b32 v37, 0xffff0000, v26
    v_lshlrev_b32 v38, 16, v27
    v_and_b32 v39, 0xffff0000, v27
    v_lshlrev_b32 v40, 16, v28
    v_and_b32 v41, 0xffff0000, v28
    v_lshlrev_b32 v42, 16, v29
    v_and_b32 v43, 0xffff0000, v29
    v_lshlrev_b32 v44, 16, v30
    v_and_b32 v45, 0xffff0000, v30
    v_lshlrev_b32 v46, 16, v31
    v_and_b32 v47, 0xffff0000, v31
    v_pk_mul_f32 v[32:33], v[32:33], v[50:51] op_sel_hi:[1,0]
    v_pk_mul_f32 v[34:35], v[34:35], v[50:51] op_sel_hi:[1,0]
    v_pk_mul_f32 v[36:37], v[36:37], v[50:51] op_sel_hi:[1,0]
    v_pk_mul_f32 v[38:39], v[38:39], v[50:51] op_sel_hi:[1,0]
    v_pk_mul_f32 v[40:41], v[40:41], v[50:51] op_sel_hi:[1,0]
    v_pk_mul_f32 v[42:43], v[42:43], v[50:51] op_sel_hi:[1,0]
    v_pk_mul_f32 v[44:45], v[44:45], v[50:51] op_sel_hi:[1,0]
    v_pk_mul_f32 v[46:47], v[46:47], v[50:51] op_sel_hi:[1,0]
    v_cvt_pk_bf16_f32 v33, v32, v33
    v_cvt_pk_bf16_f32 v35, v34, v35
    v_cvt_pk_bf16_f32 v37, v36, v37
    v_cvt_pk_bf16_f32 v39, v38, v39
    v_cvt_pk_bf16_f32 v41, v40, v41
    v_cvt_pk_bf16_f32 v43, v42, v43
    v_cvt_pk_bf16_f32 v45, v44, v45
    v_cvt_pk_bf16_f32 v47, v46, v47
    v_lshlrev_b32 v32, 16, v33
    v_and_b32 v33, 0xffff0000, v33
    v_lshlrev_b32 v34, 16, v35
    v_and_b32 v35, 0xffff0000, v35
    v_lshlrev_b32 v36, 16, v37
    v_and_b32 v37, 0xffff0000, v37
    v_lshlrev_b32 v38, 16, v39
    v_and_b32 v39, 0xffff0000, v39
    v_lshlrev_b32 v40, 16, v41
    v_and_b32 v41, 0xffff0000, v41
    v_lshlrev_b32 v42, 16, v43
    v_and_b32 v43, 0xffff0000, v43
    v_lshlrev_b32 v44, 16, v45
    v_and_b32 v45, 0xffff0000, v45
    v_lshlrev_b32 v46, 16, v47
    v_and_b32 v47, 0xffff0000, v47
    v_mov_b32 v78, 162928
    s_mov_b32 s13, 0
L_gtu:
    ds_read_b128 v[104:107], v78
    s_add_u32 s13, s13, 1
    s_cmp_ge_u32 s13, 262144
    s_cbranch_scc1 L_gxu
    s_waitcnt lgkmcnt(0)
    v_and_b32 v104, v104, v105
    v_and_b32 v106, v106, v107
    v_and_b32 v104, v104, v106
    v_cmp_eq_u32 vcc, 1, v104
    s_cbranch_vccz L_gtu
L_gxu:
    s_waitcnt lgkmcnt(0)
    s_branch L_nohop
L_hop:
    v_mov_b32 v78, 162928
    s_mov_b32 s13, 0
L_gth:
    ds_read_b128 v[104:107], v78
    s_add_u32 s13, s13, 1
    s_cmp_ge_u32 s13, 262144
    s_cbranch_scc1 L_gxh
    s_waitcnt lgkmcnt(0)
    v_and_b32 v104, v104, v105
    v_and_b32 v106, v106, v107
    v_and_b32 v104, v104, v106
    v_cmp_eq_u32 vcc, 1, v104
    s_cbranch_vccz L_gth
L_gxh:
    s_waitcnt lgkmcnt(0)
    s_lshl_b32 s12, s19, 18
    s_lshl_b32 s13, s18, 14
    s_add_u32 s12, s12, s13
    s_add_u32 s80, s12, 1048576
    s_add_u32 s81, s80, 4096
    s_add_u32 s82, s80, 8192
    s_add_u32 s83, s80, 12288
    s_mov_b32 s13, 0
    s_lshl_b32 s12, s19, 13
    s_lshr_b32 s84, s18, 2
    s_lshl_b32 s84, s84, 11
    s_add_u32 s12, s12, s84
    s_bfe_u32 s84, s18, 0x10001
    s_lshl_b32 s84, s84, 6
    s_add_u32 s12, s12, s84
    s_and_b32 s84, s18, 1
    s_lshl_b32 s84, s84, 4
    s_add_u32 s12, s12, s84
    s_add_u32 s84, s12, 5242880
    v_and_b32 v80, 15, v2
    v_lshlrev_b32 v80, 7, v80
    v_lshrrev_b32 v78, 5, v2
    v_lshl_add_u32 v80, v78, 5, v80
    s_mov_b32 s87, 0
    s_mov_b32 s85, 0xffff
L_h1:
    buffer_load_dwordx4 v[104:107], v80, s[32:35], s84 offen sc1
    s_add_u32 s13, s13, 1
    s_cmp_ge_u32 s13, 16384
    s_cbranch_scc1 L_h1ok
    s_cmp_lg_u32 s87, 0
    s_cbranch_scc1 L_h1d
    s_waitcnt vmcnt(0)
    v_msad_u8 v108, v104, s76, 0
    v_msad_u8 v108, v105, s77, v108
    v_msad_u8 v108, v106, s78, v108
    v_msad_u8 v108, v107, s79, v108
    v_cmp_ne_u32 vcc, 0, v108
    s_nop 1
    s_or_b32 s12, vcc_lo, vcc_hi
    s_and_b32 s12, s12, 0xffff
    s_bcnt1_i32_b32 s12, s12
    s_cmp_le_u32 s12, 6
    s_cselect_b32 s87, 1, 0
    s_branch L_h1
L_h1d:
    s_bitcmp1_b32 s85, 0
    s_cselect_b64 exec, -1, 0
    buffer_load_dwordx4 v[128:131], v5, s[32:35], s80 offen offset:0 sc1
    s_bitcmp1_b32 s85, 1
    s_cselect_b64 exec, -1, 0
    buffer_load_dwordx4 v[132:135], v5, s[32:35], s80 offen offset:1024 sc1
    s_bitcmp1_b32 s85, 2
    s_cselect_b64 exec, -1, 0
    buffer_load_dwordx4 v[136:139], v5, s[32:35], s80 offen offset:2048 sc1
    s_bitcmp1_b32 s85, 3
    s_cselect_b64 exec, -1, 0
    buffer_load_dwordx4 v[140:143], v5, s[32:35], s80 offen offset:3072 sc1
    s_bitcmp1_b32 s85, 4
    s_cselect_b64 exec, -1, 0
    buffer_load_dwordx4 v[144:147], v5, s[32:35], s81 offen offset:0 sc1
    s_bitcmp1_b32 s85, 5
    s_cselect_b64 exec, -1, 0
    buffer_load_dwordx4 v[148:151], v5, s[32:35], s81 offen offset:1024 sc1
    s_bitcmp1_b32 s85, 6
    s_cselect_b64 exec, -1, 0
    buffer_load_dwordx4 v[152:155], v5, s[32:35], s81 offen offset:2048 sc1
    s_bitcmp1_b32 s85, 7
    s_cselect_b64 exec, -1, 0
    buffer_load_dwordx4 v[156:159], v5, s[32:35], s81 offen offset:3072 sc1
    s_bitcmp1_b32 s85, 8
    s_cselect_b64 exec, -1, 0
    buffer_load_dwordx4 v[160:163], v5, s[32:35], s82 offen offset:0 sc1
    s_bitcmp1_b32 s85, 9
    s_cselect_b64 exec, -1, 0
    buffer_load_dwordx4 v[164:167], v5, s[32:35], s82 offen offset:1024 sc1
    s_bitcmp1_b32 s85, 10
    s_cselect_b64 exec, -1, 0
    buffer_load_dwordx4 v[168:171], v5, s[32:35], s82 offen offset:2048 sc1
    s_bitcmp1_b32 s85, 11
    s_cselect_b64 exec, -1, 0
    buffer_load_dwordx4 v[172:175], v5, s[32:35], s82 offen offset:3072 sc1
    s_bitcmp1_b32 s85, 12
    s_cselect_b64 exec, -1, 0
    buffer_load_dwordx4 v[176:179], v5, s[32:35], s83 offen offset:0 sc1
    s_bitcmp1_b32 s85, 13
    s_cselect_b64 exec, -1, 0
    buffer_load_dwordx4 v[180:183], v5, s[32:35], s83 offen offset:1024 sc1
    s_bitcmp1_b32 s85, 14
    s_cselect_b64 exec, -1, 0
    buffer_load_dwordx4 v[184:187], v5, s[32:35], s83 offen offset:2048 sc1
    s_bitcmp1_b32 s85, 15
    s_cselect_b64 exec, -1, 0
    buffer_load_dwordx4 v[188:191], v5, s[32:35], s83 offen offset:3072 sc1
    s_mov_b64 exec, -1
    s_waitcnt vmcnt(16)
    v_msad_u8 v108, v104, s76, 0
    v_msad_u8 v108, v105, s77, v108
    v_msad_u8 v108, v106, s78, v108
    v_msad_u8 v108, v107, s79, v108
    v_cmp_ne_u32 vcc, 0, v108
    s_nop 1
    s_or_b32 s85, vcc_lo, vcc_hi
    s_and_b32 s85, s85, 0xffff
    s_bcnt1_i32_b32 s12, s85
    s_cmp_le_u32 s12, 6
    s_cselect_b32 s87, 1, 0
    s_cmp_lg_u32 s85, 0
    s_waitcnt vmcnt(0)
    s_cbranch_scc1 L_h1
    v_msad_u8 v108, v128, v63, 0
    v_msad_u8 v109, v132, v63, 0
    v_msad_u8 v108, v136, v63, v108
    v_msad_u8 v109, v140, v63, v109
    v_msad_u8 v108, v144, v63, v108
    v_msad_u8 v109, v148, v63, v109
    v_msad_u8 v108, v152, v63, v108
    v_msad_u8 v109, v156, v63, v109
    v_msad_u8 v108, v160, v63, v108
    v_msad_u8 v109, v164, v63, v109
    v_msad_u8 v108, v168, v63, v108
    v_msad_u8 v109, v172, v63, v109
    v_msad_u8 v108, v176, v63, v108
    v_msad_u8 v109, v180, v63, v109
    v_msad_u8 v108, v184, v63, v108
    v_msad_u8 v109, v188, v63, v109
    v_or_b32 v108, v108, v109
    v_cmp_ne_u32 vcc, 0, v108
    s_mov_b32 s85, 0xffff
    s_cbranch_vccnz L_h1
L_h1ok:
    s_waitcnt vmcnt(0)
    v_pk_add_f32 v[128:129], v[128:129], v[160:161]
    v_pk_add_f32 v[130:131], v[130:131], v[162:163]
    v_pk_add_f32 v[132:133], v[132:133], v[164:165]
    v_pk_add_f32 v[134:135], v[134:135], v[166:167]
    v_pk_add_f32 v[136:137], v[136:137], v[168:169]
    v_pk_add_f32 v[138:139], v[138:139], v[170:171]
    v_pk_add_f32 v[140:141], v[140:141], v[172:173]
    v_pk_add_f32 v[142:143], v[142:143], v[174:175]
    v_pk_add_f32 v[144:145], v[144:145], v[176:177]
    v_pk_add_f32 v[146:147], v[146:147], v[178:179]
    v_pk_add_f32 v[148:149], v[148:149], v[180:181]
    v_pk_add_f32 v[150:151], v[150:151], v[182:183]
    v_pk_add_f32 v[152:153], v[152:153], v[184:185]
    v_pk_add_f32 v[154:155], v[154:155], v[186:187]
    v_pk_add_f32 v[156:157], v[156:157], v[188:189]
    v_pk_add_f32 v[158:159], v[158:159], v[190:191]
    v_pk_add_f32 v[128:129], v[128:129], v[144:145]
    v_pk_add_f32 v[130:131], v[130:131], v[146:147]
    v_pk_add_f32 v[132:133], v[132:133], v[148:149]
    v_pk_add_f32 v[134:135], v[134:135], v[150:151]
    v_pk_add_f32 v[136:137], v[136:137], v[152:153]
    v_pk_add_f32 v[138:139], v[138:139], v[154:155]
    v_pk_add_f32 v[140:141], v[140:141], v[156:157]
    v_pk_add_f32 v[142:143], v[142:143], v[158:159]
    v_pk_add_f32 v[128:129], v[128:129], v[136:137]
    v_pk_add_f32 v[130:131], v[130:131], v[138:139]
    v_pk_add_f32 v[132:133], v[132:133], v[140:141]
    v_pk_add_f32 v[134:135], v[134:135], v[142:143]
    v_pk_add_f32 v[128:129], v[128:129], v[132:133]
    v_pk_add_f32 v[130:131], v[130:131], v[134:135]
    v_add_f32_dpp v104, v104, v104 row_ror:1 row_mask:0xf bank_mask:0xf
    v_add_f32_dpp v105, v105, v105 row_ror:1 row_mask:0xf bank_mask:0xf
    v_add_f32_dpp v106, v106, v106 row_ror:1 row_mask:0xf bank_mask:0xf
    v_add_f32_dpp v107, v107, v107 row_ror:1 row_mask:0xf bank_mask:0xf
    v_add_f32_dpp v104, v104, v104 row_ror:2 row_mask:0xf bank_mask:0xf
    v_add_f32_dpp v105, v105, v105 row_ror:2 row_mask:0xf bank_mask:0xf
    v_add_f32_dpp v106, v106, v106 row_ror:2 row_mask:0xf bank_mask:0xf
    v_add_f32_dpp v107, v107, v107 row_ror:2 row_mask:0xf bank_mask:0xf
    v_add_f32_dpp v104, v104, v104 row_ror:4 row_mask:0xf bank_mask:0xf
    v_add_f32_dpp v105, v105, v105 row_ror:4 row_mask:0xf bank_mask:0xf
    v_add_f32_dpp v106, v106, v106 row_ror:4 row_mask:0xf bank_mask:0xf
    v_add_f32_dpp v107, v107, v107 row_ror:4 row_mask:0xf bank_mask:0xf
    v_add_f32_dpp v104, v104, v104 row_ror:8 row_mask:0xf bank_mask:0xf
    v_add_f32_dpp v105, v105, v105 row_ror:8 row_mask:0xf bank_mask:0xf
    v_add_f32_dpp v106, v106, v106 row_ror:8 row_mask:0xf bank_mask:0xf
    v_add_f32_dpp v107, v107, v107 row_ror:8 row_mask:0xf bank_mask:0xf
    v_cvt_pk_bf16_f32 v108, v128, v129
    v_cvt_pk_bf16_f32 v109, v130, v131
    v_cvt_pk_bf16_f32 v112, v104, v105
    v_cvt_pk_bf16_f32 v113, v106, v107
    v_mov_b32 v110, v108
    v_mov_b32 v111, v109
    v_mov_b32 v114, v112
    v_mov_b32 v115, v113
    s_lshl_b32 s12, s19, 13
    s_lshl_b32 s13, s18, 9
    s_add_u32 s12, s12, s13
    s_add_u32 s12, s12, 32768
    s_lshl_b32 s13, s19, 11
    s_lshl_b32 s80, s18, 7
    s_add_u32 s13, s13, s80
    s_add_u32 s13, s13, 163840
    v_permlane32_swap_b32 v108, v110
    v_permlane32_swap_b32 v109, v111
    v_permlane32_swap_b32 v112, v114
    v_permlane32_swap_b32 v113, v115
    s_mov_b32 exec_hi, 0
    buffer_store_dwordx4 v[108:111], v5, s[32:35], s12 offen sc1
    s_mov_b32 exec_lo, 255
    buffer_store_dwordx4 v[112:115], v5, s[32:35], s13 offen sc1
    s_mov_b64 exec, -1
L_nohop:
    v_min_u32 v80, 6, v62
    v_lshl_add_u32 v80, v80, 3, v4
    v_lshlrev_b32 v80, 2, v80
    s_lshl_b32 s12, s86, 2
    s_add_u32 s80, s12, 327680
    s_add_u32 s81, s80, 28672
    s_add_u32 s82, s80, 57344
    s_add_u32 s83, s80, 86016
    v_and_b32 v78, 1, v4
    v_lshlrev_b32 v78, 4, v78
    v_lshrrev_b32 v78, v78, s23
    v_bfe_u32 v79, v78, 8, 8
    v_and_b32 v78, 0xff, v78
    s_mov_b32 s13, 0
    v_add_u32 v81, 14336, v80
L_gu:
    buffer_load_dword v104, v80, s[32:35], s80 offen sc1
    buffer_load_dword v105, v81, s[32:35], s80 offen sc1
    buffer_load_dword v106, v80, s[32:35], s81 offen sc1
    buffer_load_dword v107, v81, s[32:35], s81 offen sc1
    buffer_load_dword v108, v80, s[32:35], s82 offen sc1
    buffer_load_dword v109, v81, s[32:35], s82 offen sc1
    buffer_load_dword v110, v80, s[32:35], s83 offen sc1
    buffer_load_dword v111, v81, s[32:35], s83 offen sc1
    s_add_u32 s13, s13, 1
    s_cmp_lg_u32 s21, 0
    s_cbranch_scc1 L_nofl
    s_waitcnt vmcnt(8)
    v_mov_b32 v112, 162896
    v_mov_b32 v113, 1
    s_mov_b64 exec, 1
    ds_write_b32 v112, v113
    s_mov_b64 exec, -1
L_nofl:
    s_cmp_lg_u32 s13, 1
    s_cbranch_scc1 L_noflush
    s_mov_b32 s7, s90
    s_mul_i32 s12, s21, 16
    s_add_u32 s12, s12, 0
    s_and_b32 s90, s88, 1
    s_lshl_b32 s90, s90, 6
    s_xor_b32 s12, s12, s90
    s_cmp_ge_u32 s12, 32
    s_cselect_b32 s90, 24, 0
    s_add_u32 s12, s12, s90
    s_lshl_b32 s12, s12, 10
    v_add_u32 v76, s12, v5
    s_mul_i32 s12, s21, 16
    s_add_u32 s12, s12, 64
    s_and_b32 s90, s88, 1
    s_lshl_b32 s90, s90, 6
    s_xor_b32 s12, s12, s90
    s_cmp_ge_u32 s12, 32
    s_cselect_b32 s90, 24, 0
    s_add_u32 s12, s12, s90
    s_lshl_b32 s12, s12, 10
    v_add_u32 v77, s12, v5
    s_mul_i32 s12, s21, 4
    s_add_u32 s12, s12, 64
    s_and_b32 s90, s88, 1
    s_lshl_b32 s90, s90, 6
    s_xor_b32 s12, s12, s90
    s_cmp_ge_u32 s12, 32
    s_cselect_b32 s90, 24, 0
    s_add_u32 s12, s12, s90
    s_lshl_b32 s12, s12, 10
    v_add_u32 v60, s12, v5
    s_mov_b32 s90, s7
    v_mov_b32 v113, 162976
    s_mov_b32 s13, 0
L_gtf:
    ds_read_b64 v[114:115], v113
    ds_read_b64 v[82:83], v113 offset:8
    s_add_u32 s13, s13, 1
    s_cmp_ge_u32 s13, 262144
    s_cbranch_scc1 L_gxf
    s_waitcnt lgkmcnt(0)
    v_and_b32 v114, v114, v115
    v_and_b32 v82, v82, v83
    v_and_b32 v114, v114, v82
    v_cmp_eq_u32 vcc, 1, v114
    s_cbranch_vccz L_gtf
L_gxf:
    s_waitcnt lgkmcnt(0)
    ds_write_b128 v76, v[84:87] offset:0
    ds_write_b128 v76, v[88:91] offset:1024
    ds_write_b128 v76, v[92:95] offset:2048
    ds_write_b128 v76, v[96:99] offset:3072
    ds_write_b128 v76, v[100:103] offset:4096
    ds_write_b128 v76, v[116:119] offset:5120
    ds_write_b128 v76, v[120:123] offset:6144
    ds_write_b128 v76, v[124:127] offset:7168
    ds_write_b128 v76, v[64:67] offset:8192
    ds_write_b128 v76, v[68:71] offset:9216
    ds_write_b128 v76, v[72:75] offset:10240
    ds_write_b128 v76, v[236:239] offset:11264
    ds_write_b128 v76, v[240:243] offset:12288
    ds_write_b128 v76, v[244:247] offset:13312
    ds_write_b128 v76, v[248:251] offset:14336
    ds_write_b128 v76, v[252:255] offset:15360
    ds_write_b128 v60, v[220:223] offset:0
    ds_write_b128 v60, v[224:227] offset:1024
    ds_write_b128 v60, v[228:231] offset:2048
    ds_write_b128 v60, v[232:235] offset:3072
    s_cmp_eq_u32 s21, 0
    s_cbranch_scc1 L_nofx
    ds_write_b128 v77, v[128:131] offset:0
    ds_write_b128 v77, v[132:135] offset:1024
    ds_write_b128 v77, v[136:139] offset:2048
    ds_write_b128 v77, v[140:143] offset:3072
    ds_write_b128 v77, v[144:147] offset:4096
    ds_write_b128 v77, v[148:151] offset:5120
    ds_write_b128 v77, v[152:155] offset:6144
    ds_write_b128 v77, v[156:159] offset:7168
    ds_write_b128 v77, v[160:163] offset:8192
    ds_write_b128 v77, v[164:167] offset:9216
    ds_write_b128 v77, v[168:171] offset:10240
    ds_write_b128 v77, v[172:175] offset:11264
    ds_write_b128 v77, v[176:179] offset:12288
    ds_write_b128 v77, v[180:183] offset:13312
    ds_write_b128 v77, v[184:187] offset:14336
    ds_write_b128 v77, v[188:191] offset:15360
L_nofx:
    s_waitcnt lgkmcnt(0)
    s_mov_b32 s13, 1
L_noflush:
    s_waitcnt vmcnt(0)
    v_msad_u8 v112, v104, v78, 0
    v_msad_u8 v112, v105, v79, v112
    v_msad_u8 v112, v106, v78, v112
    v_msad_u8 v112, v107, v79, v112
    v_msad_u8 v112, v108, v78, v112
    v_msad_u8 v112, v109, v79, v112
    v_msad_u8 v112, v110, v78, v112
    v_msad_u8 v112, v111, v79, v112
    v_cmp_ne_u32 vcc, 0, v112
    s_cbranch_vccz L_guok
    s_cmp_lt_u32 s13, 16384
    s_cbranch_scc1 L_gu
L_guok:
    v_pk_add_f32 v[104:105], v[104:105], v[106:107]
    v_pk_add_f32 v[108:109], v[108:109], v[110:111]
    v_pk_add_f32 v[104:105], v[104:105], v[108:109]
    v_cvt_pk_bf16_f32 v104, v104, v105
    v_and_b32 v105, 0xffff0000, v104
    v_lshlrev_b32 v104, 16, v104
    v_mul_f32 v106, 0xbfb8aa3b, v104
    v_exp_f32 v106, v106
    s_nop 0
    v_add_f32 v106, 1.0, v106
    v_rcp_f32 v106, v106
    s_nop 0
    v_mul_f32 v106, v106, v104
    v_cvt_pk_bf16_f32 v106, v106, v106
    v_lshlrev_b32 v106, 16, v106
    v_mul_f32 v106, v106, v105
    v_cvt_pk_bf16_f32 v106, v106, v106
    ds_swizzle_b32 v64, v106 offset:0x18
    ds_swizzle_b32 v66, v106 offset:0x38
    ds_swizzle_b32 v68, v106 offset:0x58
    ds_swizzle_b32 v70, v106 offset:0x78
    ds_swizzle_b32 v72, v106 offset:0x98
    ds_swizzle_b32 v74, v106 offset:0xb8
    ds_swizzle_b32 v76, v106 offset:0xd8
    s_waitcnt lgkmcnt(0)
    v_and_b32 v65, 0xffff0000, v64
    v_and_b32 v64, 0xffff, v64
    v_and_b32 v67, 0xffff0000, v66
    v_and_b32 v66, 0xffff, v66
    v_and_b32 v69, 0xffff0000, v68
    v_and_b32 v68, 0xffff, v68
    v_and_b32 v71, 0xffff0000, v70
    v_and_b32 v70, 0xffff, v70
    v_and_b32 v73, 0xffff0000, v72
    v_and_b32 v72, 0xffff, v72
    v_and_b32 v75, 0xffff0000, v74
    v_and_b32 v74, 0xffff, v74
    v_and_b32 v77, 0xffff0000, v76
    v_and_b32 v76, 0xffff, v76
    v_dot2_f32_bf16 v220, v192, v64, 0
    v_dot2_f32_bf16 v221, v192, v65, 0
    v_dot2_f32_bf16 v222, v193, v64, 0
    v_dot2_f32_bf16 v223, v193, v65, 0
    v_dot2_f32_bf16 v224, v194, v64, 0
    v_dot2_f32_bf16 v225, v194, v65, 0
    v_dot2_f32_bf16 v226, v195, v64, 0
    v_dot2_f32_bf16 v227, v195, v65, 0
    v_dot2_f32_bf16 v220, v196, v66, v220
    v_dot2_f32_bf16 v221, v196, v67, v221
    v_dot2_f32_bf16 v222, v197, v66, v222
    v_dot2_f32_bf16 v223, v197, v67, v223
    v_dot2_f32_bf16 v224, v198, v66, v224
    v_dot2_f32_bf16 v225, v198, v67, v225
    v_dot2_f32_bf16 v226, v199, v66, v226
    v_dot2_f32_bf16 v227, v199, v67, v227
    v_dot2_f32_bf16 v220, v200, v68, v220
    v_dot2_f32_bf16 v221, v200, v69, v221
    v_dot2_f32_bf16 v222, v201, v68, v222
    v_dot2_f32_bf16 v223, v201, v69, v223
    v_dot2_f32_bf16 v224, v202, v68, v224
    v_dot2_f32_bf16 v225, v202, v69, v225
    v_dot2_f32_bf16 v226, v203, v68, v226
    v_dot2_f32_bf16 v227, v203, v69, v227
    v_dot2_f32_bf16 v220, v204, v70, v220
    v_dot2_f32_bf16 v221, v204, v71, v221
    v_dot2_f32_bf16 v222, v205, v70, v222
    v_dot2_f32_bf16 v223, v205, v71, v223
    v_dot2_f32_bf16 v224, v206, v70, v224
    v_dot2_f32_bf16 v225, v206, v71, v225
    v_dot2_f32_bf16 v226, v207, v70, v226
    v_dot2_f32_bf16 v227, v207, v71, v227
    v_dot2_f32_bf16 v220, v208, v72, v220
    v_dot2_f32_bf16 v221, v208, v73, v221
    v_dot2_f32_bf16 v222, v209, v72, v222
    v_dot2_f32_bf16 v223, v209, v73, v223
    v_dot2_f32_bf16 v224, v210, v72, v224
    v_dot2_f32_bf16 v225, v210, v73, v225
    v_dot2_f32_bf16 v226, v211, v72, v226
    v_dot2_f32_bf16 v227, v211, v73, v227
    v_dot2_f32_bf16 v220, v212, v74, v220
    v_dot2_f32_bf16 v221, v212, v75, v221
    v_dot2_f32_bf16 v222, v213, v74, v222
    v_dot2_f32_bf16 v223, v213, v75, v223
    v_dot2_f32_bf16 v224, v214, v74, v224
    v_dot2_f32_bf16 v225, v214, v75, v225
    v_dot2_f32_bf16 v226, v215, v74, v226
    v_dot2_f32_bf16 v227, v215, v75, v227
    v_dot2_f32_bf16 v220, v216, v76, v220
    v_dot2_f32_bf16 v221, v216, v77, v221
    v_dot2_f32_bf16 v222, v217, v76, v222
    v_dot2_f32_bf16 v223, v217, v77, v223
    v_dot2_f32_bf16 v224, v218, v76, v224
    v_dot2_f32_bf16 v225, v218, v77, v225
    v_dot2_f32_bf16 v226, v219, v76, v226
    v_dot2_f32_bf16 v227, v219, v77, v227
    v_permlane32_swap_b32 v220, v224
    v_permlane32_swap_b32 v221, v225
    v_permlane32_swap_b32 v222, v226
    v_permlane32_swap_b32 v223, v227
    v_add_f32 v220, v220, v224
    v_add_f32 v221, v221, v225
    v_add_f32 v222, v222, v226
    v_add_f32 v223, v223, v227
    s_nop 0
    v_permlane16_swap_b32 v220, v222
    v_permlane16_swap_b32 v221, v223
    v_add_f32 v220, v220, v222
    v_add_f32 v221, v221, v223
    s_nop 0
    v_add_f32_dpp v220, v220, v220 row_ror:8 row_mask:0xf bank_mask:0xf
    v_add_f32_dpp v221, v221, v221 row_ror:8 row_mask:0xf bank_mask:0xf
    v_lshrrev_b32 v80, 4, v2
    v_lshlrev_b32 v80, 3, v80
    v_lshl_add_u32 v80, v62, 5, v80
    s_lshl_b32 s12, s21, 8
    s_add_u32 s12, s12, 161792
    v_add_u32 v80, s12, v80
    ds_write_b64 v80, v[220:221]
    v_mov_b32 v80, 162848
    v_mov_b32 v78, 1
    s_mov_b64 exec, 1
    ds_add_rtn_u32 v79, v80, v78 offset:4
    s_mov_b64 exec, -1
    s_waitcnt lgkmcnt(0)
    v_readfirstlane_b32 s12, v79
    s_nop 1
    s_cmp_lg_u32 s12, 3
    s_cbranch_scc1 L_noy
    v_lshlrev_b32 v78, 2, v2
    v_add_u32 v80, 161792, v78
    ds_read2st64_b32 v[220:221], v80 offset0:0 offset1:1
    ds_read2st64_b32 v[222:223], v80 offset0:2 offset1:3
    s_lshl_b32 s12, s11, 8
    s_add_u32 s12, s12, 458752
    s_mov_b32 s13, 0xffffff00
    s_waitcnt lgkmcnt(0)
    v_pk_add_f32 v[220:221], v[220:221], v[222:223]
    v_add_f32 v220, v220, v221
    v_and_or_b32 v220, v220, s13, v63
    buffer_store_dword v220, v78, s[32:35], s12 offen sc1
L_noy:
    s_cmp_lg_u32 s21, 0
    s_cbranch_scc1 L_prepd
    s_waitcnt vmcnt(0)
    v_sub_f32 v50, 1.0, v48
    v_cvt_pk_bf16_f32 v50, v50, v50
    v_lshlrev_b32 v50, 16, v50
    v_lshlrev_b32 v32, 16, v24
    v_and_b32 v33, 0xffff0000, v24
    v_lshlrev_b32 v34, 16, v25
    v_and_b32 v35, 0xffff0000, v25
    v_lshlrev_b32 v36, 16, v26
    v_and_b32 v37, 0xffff0000, v26
    v_lshlrev_b32 v38, 16, v27
    v_and_b32 v39, 0xffff0000, v27
    v_lshlrev_b32 v40, 16, v28
    v_and_b32 v41, 0xffff0000, v28
    v_lshlrev_b32 v42, 16, v29
    v_and_b32 v43, 0xffff0000, v29
    v_lshlrev_b32 v44, 16, v30
    v_and_b32 v45, 0xffff0000, v30
    v_lshlrev_b32 v46, 16, v31
    v_and_b32 v47, 0xffff0000, v31
    v_pk_mul_f32 v[32:33], v[32:33], v[50:51] op_sel_hi:[1,0]
    v_pk_mul_f32 v[34:35], v[34:35], v[50:51] op_sel_hi:[1,0]
    v_pk_mul_f32 v[36:37], v[36:37], v[50:51] op_sel_hi:[1,0]
    v_pk_mul_f32 v[38:39], v[38:39], v[50:51] op_sel_hi:[1,0]
    v_pk_mul_f32 v[40:41], v[40:41], v[50:51] op_sel_hi:[1,0]
    v_pk_mul_f32 v[42:43], v[42:43], v[50:51] op_sel_hi:[1,0]
    v_pk_mul_f32 v[44:45], v[44:45], v[50:51] op_sel_hi:[1,0]
    v_pk_mul_f32 v[46:47], v[46:47], v[50:51] op_sel_hi:[1,0]
    v_cvt_pk_bf16_f32 v33, v32, v33
    v_cvt_pk_bf16_f32 v35, v34, v35
    v_cvt_pk_bf16_f32 v37, v36, v37
    v_cvt_pk_bf16_f32 v39, v38, v39
    v_cvt_pk_bf16_f32 v41, v40, v41
    v_cvt_pk_bf16_f32 v43, v42, v43
    v_cvt_pk_bf16_f32 v45, v44, v45
    v_cvt_pk_bf16_f32 v47, v46, v47
    v_lshlrev_b32 v32, 16, v33
    v_and_b32 v33, 0xffff0000, v33
    v_lshlrev_b32 v34, 16, v35
    v_and_b32 v35, 0xffff0000, v35
    v_lshlrev_b32 v36, 16, v37
    v_and_b32 v37, 0xffff0000, v37
    v_lshlrev_b32 v38, 16, v39
    v_and_b32 v39, 0xffff0000, v39
    v_lshlrev_b32 v40, 16, v41
    v_and_b32 v41, 0xffff0000, v41
    v_lshlrev_b32 v42, 16, v43
    v_and_b32 v43, 0xffff0000, v43
    v_lshlrev_b32 v44, 16, v45
    v_and_b32 v45, 0xffff0000, v45
    v_lshlrev_b32 v46, 16, v47
    v_and_b32 v47, 0xffff0000, v47
L_prepd:
    s_mov_b32 s21, s4
    s_mov_b32 s22, s5
    s_mov_b32 s45, 0
    s_lshr_b32 s12, s21, 4
    s_cmp_eq_u32 s12, s92
    s_cselect_b32 s46, 1, 0
    s_mov_b32 s45, 1
    s_branch L_phaseb
L_keyre_0:
    s_add_u32 s13, s13, 1
    s_cmp_ge_u32 s13, 16384
    s_cbranch_scc1 L_keyok_0
    s_mov_b32 s12, 0
    buffer_load_dwordx4 v[104:107], v5, s[32:35], s12 offen offset:0 sc1
    buffer_load_dwordx4 v[108:111], v5, s[32:35], s12 offen offset:1024 sc1
    s_waitcnt vmcnt(0)
    v_xor_b32 v105, s23, v105
    v_xor_b32 v107, s23, v107
    v_xor_b32 v109, s23, v109
    v_xor_b32 v111, s23, v111
    v_or3_b32 v105, v105, v107, v109
    v_or_b32 v105, v105, v111
    v_cmp_ne_u32 vcc, 0, v105
    s_cbranch_vccnz L_keyre_0
    s_branch L_keyok_0
L_keyre_1:
    s_add_u32 s13, s13, 1
    s_cmp_ge_u32 s13, 16384
    s_cbranch_scc1 L_keyok_1
    s_mov_b32 s12, 0
    buffer_load_dwordx4 v[104:107], v5, s[32:35], s12 offen offset:0 sc1
    buffer_load_dwordx4 v[108:111], v5, s[32:35], s12 offen offset:1024 sc1
    s_waitcnt vmcnt(0)
    v_xor_b32 v105, s23, v105
    v_xor_b32 v107, s23, v107
    v_xor_b32 v109, s23, v109
    v_xor_b32 v111, s23, v111
    v_or3_b32 v105, v105, v107, v109
    v_or_b32 v105, v105, v111
    v_cmp_ne_u32 vcc, 0, v105
    s_cbranch_vccnz L_keyre_1
    s_branch L_keyok_1
L_keyre_2:
    s_add_u32 s13, s13, 1
    s_cmp_ge_u32 s13, 16384
    s_cbranch_scc1 L_keyok_2
    s_mov_b32 s12, 0
    buffer_load_dwordx4 v[104:107], v5, s[32:35], s12 offen offset:0 sc1
    buffer_load_dwordx4 v[108:111], v5, s[32:35], s12 offen offset:1024 sc1
    s_waitcnt vmcnt(0)
    v_xor_b32 v105, s23, v105
    v_xor_b32 v107, s23, v107
    v_xor_b32 v109, s23, v109
    v_xor_b32 v111, s23, v111
    v_or3_b32 v105, v105, v107, v109
    v_or_b32 v105, v105, v111
    v_cmp_ne_u32 vcc, 0, v105
    s_cbranch_vccnz L_keyre_2
    s_branch L_keyok_2
L_keyre_3:
    s_add_u32 s13, s13, 1
    s_cmp_ge_u32 s13, 16384
    s_cbranch_scc1 L_keyok_3
    s_mov_b32 s12, 0
    buffer_load_dwordx4 v[104:107], v5, s[32:35], s12 offen offset:0 sc1
    buffer_load_dwordx4 v[108:111], v5, s[32:35], s12 offen offset:1024 sc1
    s_waitcnt vmcnt(0)
    v_xor_b32 v105, s23, v105
    v_xor_b32 v107, s23, v107
    v_xor_b32 v109, s23, v109
    v_xor_b32 v111, s23, v111
    v_or3_b32 v105, v105, v107, v109
    v_or_b32 v105, v105, v111
    v_cmp_ne_u32 vcc, 0, v105
    s_cbranch_vccnz L_keyre_3
    s_branch L_keyok_3
L_keyre_4:
    s_add_u32 s13, s13, 1
    s_cmp_ge_u32 s13, 16384
    s_cbranch_scc1 L_keyok_4
    s_mov_b32 s12, 0
    buffer_load_dwordx4 v[104:107], v5, s[32:35], s12 offen offset:0 sc1
    buffer_load_dwordx4 v[108:111], v5, s[32:35], s12 offen offset:1024 sc1
    s_waitcnt vmcnt(0)
    v_xor_b32 v105, s23, v105
    v_xor_b32 v107, s23, v107
    v_xor_b32 v109, s23, v109
    v_xor_b32 v111, s23, v111
    v_or3_b32 v105, v105, v107, v109
    v_or_b32 v105, v105, v111
    v_cmp_ne_u32 vcc, 0, v105
    s_cbranch_vccnz L_keyre_4
    s_branch L_keyok_4
L_compute:
    s_setprio 1
    s_lshr_b32 s21, s20, 1
    s_and_b32 s22, s20, 1
    v_lshrrev_b32 v3, 5, v2
    v_and_b32 v4, 31, v2
    s_lshl_b32 s12, s21, 13
    v_lshlrev_b32 v6, 7, v4
    v_add_u32 v6, s12, v6
    v_bfe_u32 v7, v2, 1, 3
    v_add_u32 v8, 0, v3
    v_xor_b32 v8, v8, v7
    v_lshl_add_u32 v20, v8, 4, v6
    v_add_u32 v8, 2, v3
    v_xor_b32 v8, v8, v7
    v_lshl_add_u32 v21, v8, 4, v6
    v_add_u32 v8, 4, v3
    v_xor_b32 v8, v8, v7
    v_lshl_add_u32 v22, v8, 4, v6
    v_add_u32 v8, 6, v3
    v_xor_b32 v8, v8, v7
    v_lshl_add_u32 v23, v8, 4, v6
    v_lshlrev_b32 v6, 10, v3
    v_bfe_u32 v7, v2, 2, 2
    v_lshl_add_u32 v6, v7, 7, v6
    v_bfe_u32 v8, v2, 3, 1
    v_xor_b32 v8, s22, v8
    v_lshl_add_u32 v6, v8, 6, v6
    v_bfe_u32 v8, v2, 4, 1
    v_lshlrev_b32 v8, 5, v8
    v_and_b32 v9, 3, v2
    v_lshl_add_u32 v8, v9, 3, v8
    v_add_u32 v6, v6, v8
    v_add_u32 v36, 16384, v6
    v_lshl_add_u32 v7, v3, 2, v7
    v_lshl_add_u32 v12, v7, 6, v8
    s_lshl_b32 s12, s22, 11
    s_add_u32 s12, s12, 155648
    v_add_u32 v12, s12, v12
    v_lshlrev_b32 v6, 14, v3
    v_lshl_add_u32 v6, v4, 4, v6
    v_lshlrev_b32 v7, 9, v3
    s_lshl_b32 s12, s22, 3
    s_lshl_b32 s13, s21, 2
    s_add_u32 s12, s12, s13
    s_lshl_b32 s13, s12, 14
    s_lshl_b32 s14, s19, 18
    s_add_u32 s13, s13, s14
    s_lshl_b32 s14, s18, 10
    s_add_u32 s13, s13, s14
    s_add_u32 s40, s13, 1048576
    s_add_u32 s41, s40, 32768
    s_lshl_b32 s13, s12, 9
    s_lshl_b32 s14, s19, 13
    s_add_u32 s13, s13, s14
    s_lshl_b32 s14, s18, 5
    s_add_u32 s13, s13, s14
    s_add_u32 s42, s13, 5242880
    s_add_u32 s43, s42, 1024
    s_lshl_b32 s13, s21, 4
    s_lshl_b32 s44, 1, s13
    s_xor_b32 s13, s13, 16
    s_lshl_b32 s45, 1, s13
    s_lshl_b32 s13, s22, 1
    s_add_u32 s13, s13, s21
    s_lshl_b32 s13, s13, 11
    s_lshl_b32 s14, s19, 13
    s_add_u32 s13, s13, s14
    s_lshl_b32 s14, s18, 7
    s_add_u32 s13, s13, s14
    s_add_u32 s42, s13, 5242880
    s_mov_b32 s45, 0x10001
    v_lshlrev_b32 v7, 2, v2
    v_mov_b32 v68, 0
    v_mov_b32 v69, 0
    v_mov_b32 v70, 0
    v_mov_b32 v71, 0
    v_mov_b32 v160, 0
    v_mov_b32 v161, 0
    v_mov_b32 v162, 0
    v_mov_b32 v163, 0
    v_mov_b32 v164, 0
    v_mov_b32 v165, 0
    v_mov_b32 v166, 0
    v_mov_b32 v167, 0
    v_mov_b32 v168, 0
    v_mov_b32 v169, 0
    v_mov_b32 v170, 0
    v_mov_b32 v171, 0
    v_mov_b32 v172, 0
    v_mov_b32 v173, 0
    v_mov_b32 v174, 0
    v_mov_b32 v175, 0
    v_mov_b32 v176, 0
    v_mov_b32 v177, 0
    v_mov_b32 v178, 0
    v_mov_b32 v179, 0
    v_mov_b32 v180, 0
    v_mov_b32 v181, 0
    v_mov_b32 v182, 0
    v_mov_b32 v183, 0
    v_mov_b32 v184, 0
    v_mov_b32 v185, 0
    v_mov_b32 v186, 0
    v_mov_b32 v187, 0
    v_mov_b32 v188, 0
    v_mov_b32 v189, 0
    v_mov_b32 v190, 0
    v_mov_b32 v191, 0
    v_mov_b32 v192, 0
    v_mov_b32 v193, 0
    v_mov_b32 v194, 0
    v_mov_b32 v195, 0
    v_mov_b32 v196, 0
    v_mov_b32 v197, 0
    v_mov_b32 v198, 0
    v_mov_b32 v199, 0
    v_mov_b32 v200, 0
    v_mov_b32 v201, 0
    v_mov_b32 v202, 0
    v_mov_b32 v203, 0
    v_mov_b32 v204, 0
    v_mov_b32 v205, 0
    v_mov_b32 v206, 0
    v_mov_b32 v207, 0
    v_mov_b32 v208, 0
    v_mov_b32 v209, 0
    v_mov_b32 v210, 0
    v_mov_b32 v211, 0
    v_mov_b32 v212, 0
    v_mov_b32 v213, 0
    v_mov_b32 v214, 0
    v_mov_b32 v215, 0
    v_mov_b32 v216, 0
    v_mov_b32 v217, 0
    v_mov_b32 v218, 0
    v_mov_b32 v219, 0
    v_mov_b32 v220, 0
    v_mov_b32 v221, 0
    v_mov_b32 v222, 0
    v_mov_b32 v223, 0
    v_mov_b32 v224, 0
    v_mov_b32 v225, 0
    v_mov_b32 v226, 0
    v_mov_b32 v227, 0
    v_mov_b32 v228, 0
    v_mov_b32 v229, 0
    v_mov_b32 v230, 0
    v_mov_b32 v231, 0
    v_mov_b32 v232, 0
    v_mov_b32 v233, 0
    v_mov_b32 v234, 0
    v_mov_b32 v235, 0
    v_mov_b32 v236, 0
    v_mov_b32 v237, 0
    v_mov_b32 v238, 0
    v_mov_b32 v239, 0
    v_mov_b32 v240, 0
    v_mov_b32 v241, 0
    v_mov_b32 v242, 0
    v_mov_b32 v243, 0
    v_mov_b32 v244, 0
    v_mov_b32 v245, 0
    v_mov_b32 v246, 0
    v_mov_b32 v247, 0
    v_mov_b32 v248, 0
    v_mov_b32 v249, 0
    v_mov_b32 v250, 0
    v_mov_b32 v251, 0
    v_mov_b32 v252, 0
    v_mov_b32 v253, 0
    v_mov_b32 v254, 0
    v_mov_b32 v255, 0
    v_lshlrev_b32 v8, 2, v3
    v_sub_u32 v8, v4, v8
    v_mov_b32 v9, 0x3f80
    v_mov_b32 v10, 0x3f800000
    v_cmp_eq_u32 vcc, 0, v8
    s_nop 1
    v_cndmask_b32 v11, 0, v9, vcc
    v_cmp_eq_u32 vcc, 1, v8
    s_nop 1
    v_cndmask_b32 v48, v11, v10, vcc
    v_cmp_eq_u32 vcc, 2, v8
    s_nop 1
    v_cndmask_b32 v11, 0, v9, vcc
    v_cmp_eq_u32 vcc, 3, v8
    s_nop 1
    v_cndmask_b32 v49, v11, v10, vcc
    v_cmp_eq_u32 vcc, 8, v8
    s_nop 1
    v_cndmask_b32 v11, 0, v9, vcc
    v_cmp_eq_u32 vcc, 9, v8
    s_nop 1
    v_cndmask_b32 v50, v11, v10, vcc
    v_cmp_eq_u32 vcc, 10, v8
    s_nop 1
    v_cndmask_b32 v11, 0, v9, vcc
    v_cmp_eq_u32 vcc, 11, v8
    s_nop 1
    v_cndmask_b32 v51, v11, v10, vcc
    v_cmp_eq_u32 vcc, 16, v8
    s_nop 1
    v_cndmask_b32 v11, 0, v9, vcc
    v_cmp_eq_u32 vcc, 17, v8
    s_nop 1
    v_cndmask_b32 v52, v11, v10, vcc
    v_cmp_eq_u32 vcc, 18, v8
    s_nop 1
    v_cndmask_b32 v11, 0, v9, vcc
    v_cmp_eq_u32 vcc, 19, v8
    s_nop 1
    v_cndmask_b32 v53, v11, v10, vcc
    v_cmp_eq_u32 vcc, 24, v8
    s_nop 1
    v_cndmask_b32 v11, 0, v9, vcc
    v_cmp_eq_u32 vcc, 25, v8
    s_nop 1
    v_cndmask_b32 v54, v11, v10, vcc
    v_cmp_eq_u32 vcc, 26, v8
    s_nop 1
    v_cndmask_b32 v11, 0, v9, vcc
    v_cmp_eq_u32 vcc, 27, v8
    s_nop 1
    v_cndmask_b32 v55, v11, v10, vcc
    v_mov_b32 v9, 0x3f803f80
    v_cmp_gt_u32 vcc, 16, v4
    s_nop 1
    v_cndmask_b32 v56, 0, v9, vcc
    v_cndmask_b32 v60, v9, 0, vcc
    v_cndmask_b32 v57, 0, v9, vcc
    v_cndmask_b32 v61, v9, 0, vcc
    v_cndmask_b32 v58, 0, v9, vcc
    v_cndmask_b32 v62, v9, 0, vcc
    v_cndmask_b32 v59, 0, v9, vcc
    v_cndmask_b32 v63, v9, 0, vcc
    s_waitcnt lgkmcnt(0)
    s_mov_b32 s32, s62
    s_and_b32 s33, s63, 0xffff
    s_mov_b32 s34, 33554432
    s_mov_b32 s35, 0x00020000
    s_mov_b32 s24, s4
    s_and_b32 s25, s5, 0xffff
    s_mov_b32 s26, 4194304
    s_mov_b32 s27, 0x00020000
    s_cmp_lg_u32 s20, 0
    s_cbranch_scc1 L_c_noinit
    v_add_u32 v8, 162816, v5
    s_mov_b64 exec, 0xffff
    ds_write_b128 v8, v[68:71]
    s_mov_b64 exec, -1
    s_cmp_lg_u32 s2, 0
    s_cbranch_scc1 L_c_noinit
    s_mov_b32 s72, s60
    s_and_b32 s73, s61, 0xffff
    s_mov_b32 s74, 256
    s_mov_b32 s75, 0x00020000
    s_memrealtime s[14:15]
    s_waitcnt lgkmcnt(0)
    s_mul_i32 s14, s14, 0x9e3779b1
    s_or_b32 s14, s14, 0x01010101
    v_mov_b32 v8, s14
    s_mov_b64 exec, 1
    buffer_store_dword v8, v68, s[72:75], 0 offen offset:4 sc1
    s_mov_b64 exec, -1
L_c_noinit:
    s_lshl_b32 s14, s22, 1
    s_add_u32 s15, s14, s21
    s_xor_b32 s14, s15, 1
    s_mul_i32 s14, s14, 4352
    s_mul_i32 s15, s15, 4352
    s_add_u32 s14, s14, 98304
    s_add_u32 s15, s15, 98304
    v_add_u32 v8, s14, v5
    v_add_u32 v9, s15, v5
    v_lshlrev_b32 v11, 4, v3
    v_add_u32 v10, s14, v11
    v_add_u32 v11, s15, v11
    s_lshl_b32 s14, s20, 2
    s_add_u32 s15, s14, 162832
    v_mov_b32 v13, s15
    v_xor_b32 v14, 8, v13
    v_subrev_u32 v17, 16, v13
    v_mov_b32 v15, 1
    v_bfe_u32 v16, v2, 4, 1
    v_cmp_eq_u32 vcc, s21, v16
    s_nop 1
    v_cndmask_b32 v10, v10, v11, vcc
    s_lshl_b32 s14, s21, 7
    v_add_u32 v10, s14, v10
    v_lshrrev_b32 v11, 2, v5
    v_sub_u32 v16, v9, v5
    v_add_u32 v11, v16, v11
    s_waitcnt lgkmcnt(0)
    s_barrier
    ds_read_b128 v[100:103], v20
    ds_read_b64_tr_b16 v[108:109], v36 offset:0
    ds_read_b64_tr_b16 v[110:111], v36 offset:512
    ds_read_b128 v[104:107], v20 offset:4096
    ds_read_b64_tr_b16 v[112:113], v36 offset:8192
    ds_read_b64_tr_b16 v[114:115], v36 offset:8704
    ds_read_b64_tr_b16 v[116:117], v36 offset:16384
    ds_read_b64_tr_b16 v[118:119], v36 offset:16896
    s_mov_b32 s48, 0
    s_mov_b32 s49, 0
    s_mov_b32 s64, 16384
    s_mov_b32 s65, 4294868992
    s_mov_b32 s66, 40960
    s_mov_b32 s67, 4294885376
.p2align 3
L_c_loop:
    s_add_u32 s49, s49, 1
    s_cmp_eq_u32 s49, 3
    s_mov_b32 s50, 40960
    s_cselect_b32 s50, 4294885376, s50
    s_cselect_b32 s49, 0, s49
    s_cmp_eq_u32 s48, 10
    s_cselect_b32 s51, 81920, s50
    s_waitcnt lgkmcnt(5)
    v_mfma_f32_32x32x16_bf16 v[160:175], v[108:111], v[100:103], v[160:175]
    ds_read_b128 v[120:123], v21
    ds_read_b64_tr_b16 v[128:129], v36 offset:2048
    s_waitcnt lgkmcnt(6)
    v_mfma_f32_32x32x16_bf16 v[176:191], v[108:111], v[104:107], v[176:191]
    ds_read_b64_tr_b16 v[130:131], v36 offset:2560
    s_waitcnt lgkmcnt(5)
    v_mfma_f32_32x32x16_bf16 v[192:207], v[112:115], v[100:103], v[192:207]
    ds_read_b128 v[124:127], v21 offset:4096
    v_mfma_f32_32x32x16_bf16 v[208:223], v[112:115], v[104:107], v[208:223]
    ds_read_b64_tr_b16 v[132:133], v36 offset:10240
    ds_read_b64_tr_b16 v[134:135], v36 offset:10752
    s_waitcnt lgkmcnt(6)
    v_mfma_f32_32x32x16_bf16 v[224:239], v[100:103], v[116:119], v[224:239]
    ds_read_b64_tr_b16 v[136:137], v36 offset:18432
    v_add_u32 v21, s51, v21
    v_mfma_f32_32x32x16_bf16 v[240:255], v[104:107], v[116:119], v[240:255]
    ds_read_b64_tr_b16 v[138:139], v36 offset:18944
    v_add_u32 v20, s51, v20
    s_waitcnt lgkmcnt(5)
    v_mfma_f32_32x32x16_bf16 v[160:175], v[128:131], v[120:123], v[160:175]
    ds_read_b128 v[100:103], v22
    ds_read_b64_tr_b16 v[108:109], v36 offset:4096
    s_waitcnt lgkmcnt(6)
    v_mfma_f32_32x32x16_bf16 v[176:191], v[128:131], v[124:127], v[176:191]
    ds_read_b64_tr_b16 v[110:111], v36 offset:4608
    s_waitcnt lgkmcnt(5)
    v_mfma_f32_32x32x16_bf16 v[192:207], v[132:135], v[120:123], v[192:207]
    ds_read_b128 v[104:107], v22 offset:4096
    v_mfma_f32_32x32x16_bf16 v[208:223], v[132:135], v[124:127], v[208:223]
    ds_read_b64_tr_b16 v[112:113], v36 offset:12288
    ds_read_b64_tr_b16 v[114:115], v36 offset:12800
    s_waitcnt lgkmcnt(6)
    v_mfma_f32_32x32x16_bf16 v[224:239], v[120:123], v[136:139], v[224:239]
    ds_read_b64_tr_b16 v[116:117], v36 offset:20480
    v_add_u32 v22, s51, v22
    v_mfma_f32_32x32x16_bf16 v[240:255], v[124:127], v[136:139], v[240:255]
    ds_read_b64_tr_b16 v[118:119], v36 offset:20992
    s_waitcnt lgkmcnt(5)
    v_mfma_f32_32x32x16_bf16 v[160:175], v[108:111], v[100:103], v[160:175]
    ds_read_b128 v[120:123], v23
    ds_read_b64_tr_b16 v[128:129], v36 offset:6144
    ds_read_b64_tr_b16 v[130:131], v36 offset:6656
    s_waitcnt lgkmcnt(7)
    v_mfma_f32_32x32x16_bf16 v[176:191], v[108:111], v[104:107], v[176:191]
    ds_read_b128 v[124:127], v23 offset:4096
    ds_read_b64_tr_b16 v[132:133], v36 offset:14336
    ds_read_b64_tr_b16 v[134:135], v36 offset:14848
    s_waitcnt lgkmcnt(8)
    v_mfma_f32_32x32x16_bf16 v[192:207], v[112:115], v[100:103], v[192:207]
    ds_read_b64_tr_b16 v[136:137], v36 offset:22528
    ds_read_b64_tr_b16 v[138:139], v36 offset:23040
    v_mfma_f32_32x32x16_bf16 v[208:223], v[112:115], v[104:107], v[208:223]
    s_waitcnt lgkmcnt(8)
    v_mfma_f32_32x32x16_bf16 v[224:239], v[100:103], v[116:119], v[224:239]
    v_add_u32 v23, s51, v23
    v_mfma_f32_32x32x16_bf16 v[240:255], v[104:107], v[116:119], v[240:255]
    v_add_u32 v36, s50, v36
    s_waitcnt lgkmcnt(0)
    v_mfma_f32_32x32x16_bf16 v[160:175], v[128:131], v[120:123], v[160:175]
    s_barrier
    ds_read_b128 v[100:103], v20
    ds_read_b64_tr_b16 v[108:109], v36 offset:0
    ds_read_b64_tr_b16 v[110:111], v36 offset:512
    v_mfma_f32_32x32x16_bf16 v[176:191], v[128:131], v[124:127], v[176:191]
    ds_read_b128 v[104:107], v20 offset:4096
    ds_read_b64_tr_b16 v[112:113], v36 offset:8192
    ds_read_b64_tr_b16 v[114:115], v36 offset:8704
    v_mfma_f32_32x32x16_bf16 v[192:207], v[132:135], v[120:123], v[192:207]
    ds_read_b64_tr_b16 v[116:117], v36 offset:16384
    ds_read_b64_tr_b16 v[118:119], v36 offset:16896
    v_mfma_f32_32x32x16_bf16 v[208:223], v[132:135], v[124:127], v[208:223]
    v_mfma_f32_32x32x16_bf16 v[224:239], v[120:123], v[136:139], v[224:239]
    s_add_u32 s48, s48, 1
    s_cmp_lt_u32 s48, 11
    v_mfma_f32_32x32x16_bf16 v[240:255], v[124:127], v[136:139], v[240:255]
    s_cbranch_scc1 L_c_loop
    s_waitcnt lgkmcnt(2)
.p2align 3
L_c_loop2:
    s_add_u32 s49, s49, 1
    s_cmp_eq_u32 s49, 3
    s_mov_b32 s50, 40960
    s_cselect_b32 s50, 4294885376, s50
    s_cselect_b32 s49, 0, s49
    s_mov_b32 s51, s64
    s_mov_b32 s64, s65
    s_mov_b32 s65, s66
    s_mov_b32 s66, s67
    s_waitcnt lgkmcnt(3)
    v_mfma_f32_32x32x16_bf16 v[192:207], v[112:115], v[100:103], v[192:207]
    ds_read_b128 v[120:123], v21
    ds_read_b64_tr_b16 v[132:133], v36 offset:10240
    s_waitcnt lgkmcnt(4)
    v_mfma_f32_32x32x16_bf16 v[208:223], v[112:115], v[104:107], v[208:223]
    ds_read_b64_tr_b16 v[134:135], v36 offset:10752
    ds_read_b128 v[124:127], v21 offset:4096
    s_waitcnt lgkmcnt(4)
    v_mfma_f32_32x32x16_bf16 v[224:239], v[100:103], v[116:119], v[224:239]
    ds_read_b64_tr_b16 v[136:137], v36 offset:18432
    v_add_u32 v21, s51, v21
    v_mfma_f32_32x32x16_bf16 v[240:255], v[104:107], v[116:119], v[240:255]
    ds_read_b64_tr_b16 v[138:139], v36 offset:18944
    v_add_u32 v20, s51, v20
    s_waitcnt lgkmcnt(3)
    v_mfma_f32_32x32x16_bf16 v[192:207], v[132:135], v[120:123], v[192:207]
    ds_read_b128 v[100:103], v22
    ds_read_b64_tr_b16 v[112:113], v36 offset:12288
    s_waitcnt lgkmcnt(4)
    v_mfma_f32_32x32x16_bf16 v[208:223], v[132:135], v[124:127], v[208:223]
    ds_read_b64_tr_b16 v[114:115], v36 offset:12800
    ds_read_b128 v[104:107], v22 offset:4096
    s_waitcnt lgkmcnt(4)
    v_mfma_f32_32x32x16_bf16 v[224:239], v[120:123], v[136:139], v[224:239]
    ds_read_b64_tr_b16 v[116:117], v36 offset:20480
    v_add_u32 v22, s51, v22
    v_mfma_f32_32x32x16_bf16 v[240:255], v[124:127], v[136:139], v[240:255]
    ds_read_b64_tr_b16 v[118:119], v36 offset:20992
    s_waitcnt lgkmcnt(3)
    v_mfma_f32_32x32x16_bf16 v[192:207], v[112:115], v[100:103], v[192:207]
    ds_read_b128 v[120:123], v23
    ds_read_b64_tr_b16 v[132:133], v36 offset:14336
    ds_read_b64_tr_b16 v[134:135], v36 offset:14848
    s_waitcnt lgkmcnt(5)
    v_mfma_f32_32x32x16_bf16 v[208:223], v[112:115], v[104:107], v[208:223]
    ds_read_b128 v[124:127], v23 offset:4096
    ds_read_b64_tr_b16 v[136:137], v36 offset:22528
    ds_read_b64_tr_b16 v[138:139], v36 offset:23040
    s_waitcnt lgkmcnt(6)
    v_mfma_f32_32x32x16_bf16 v[224:239], v[100:103], v[116:119], v[224:239]
    v_add_u32 v23, s51, v23
    v_mfma_f32_32x32x16_bf16 v[240:255], v[104:107], v[116:119], v[240:255]
    v_add_u32 v36, s50, v36
    s_waitcnt lgkmcnt(0)
    v_mfma_f32_32x32x16_bf16 v[192:207], v[132:135], v[120:123], v[192:207]
    s_barrier
    ds_read_b128 v[100:103], v20
    ds_read_b64_tr_b16 v[112:113], v36 offset:8192
    ds_read_b64_tr_b16 v[114:115], v36 offset:8704
    v_mfma_f32_32x32x16_bf16 v[208:223], v[132:135], v[124:127], v[208:223]
    ds_read_b128 v[104:107], v20 offset:4096
    ds_read_b64_tr_b16 v[116:117], v36 offset:16384
    ds_read_b64_tr_b16 v[118:119], v36 offset:16896
    v_mfma_f32_32x32x16_bf16 v[224:239], v[120:123], v[136:139], v[224:239]
    s_add_u32 s48, s48, 1
    s_cmp_lt_u32 s48, 15
    v_mfma_f32_32x32x16_bf16 v[240:255], v[124:127], v[136:139], v[240:255]
    s_cbranch_scc1 L_c_loop2
    s_waitcnt lgkmcnt(3)
    v_mfma_f32_32x32x16_bf16 v[192:207], v[112:115], v[100:103], v[192:207]
    ds_read_b128 v[120:123], v21
    ds_read_b64_tr_b16 v[132:133], v36 offset:10240
    s_waitcnt lgkmcnt(4)
    v_mfma_f32_32x32x16_bf16 v[208:223], v[112:115], v[104:107], v[208:223]
    ds_read_b64_tr_b16 v[134:135], v36 offset:10752
    ds_read_b128 v[124:127], v21 offset:4096
    s_waitcnt lgkmcnt(4)
    v_mfma_f32_32x32x16_bf16 v[224:239], v[100:103], v[116:119], v[224:239]
    ds_read_b64_tr_b16 v[136:137], v36 offset:18432
    v_mfma_f32_32x32x16_bf16 v[240:255], v[104:107], v[116:119], v[240:255]
    ds_read_b64_tr_b16 v[138:139], v36 offset:18944
    s_waitcnt lgkmcnt(3)
    v_mfma_f32_32x32x16_bf16 v[192:207], v[132:135], v[120:123], v[192:207]
    ds_read_b128 v[100:103], v22
    ds_read_b64_tr_b16 v[112:113], v36 offset:12288
    s_waitcnt lgkmcnt(4)
    v_mfma_f32_32x32x16_bf16 v[208:223], v[132:135], v[124:127], v[208:223]
    ds_read_b64_tr_b16 v[114:115], v36 offset:12800
    ds_read_b128 v[104:107], v22 offset:4096
    s_waitcnt lgkmcnt(4)
    v_mfma_f32_32x32x16_bf16 v[224:239], v[120:123], v[136:139], v[224:239]
    ds_read_b64_tr_b16 v[116:117], v36 offset:20480
    v_mfma_f32_32x32x16_bf16 v[240:255], v[124:127], v[136:139], v[240:255]
    ds_read_b64_tr_b16 v[118:119], v36 offset:20992
    s_waitcnt lgkmcnt(3)
    v_mfma_f32_32x32x16_bf16 v[192:207], v[112:115], v[100:103], v[192:207]
    ds_read_b128 v[120:123], v23
    ds_read_b64_tr_b16 v[132:133], v36 offset:14336
    ds_read_b64_tr_b16 v[134:135], v36 offset:14848
    s_waitcnt lgkmcnt(5)
    v_mfma_f32_32x32x16_bf16 v[208:223], v[112:115], v[104:107], v[208:223]
    ds_read_b128 v[124:127], v23 offset:4096
    ds_read_b64_tr_b16 v[136:137], v36 offset:22528
    ds_read_b64_tr_b16 v[138:139], v36 offset:23040
    s_waitcnt lgkmcnt(6)
    v_mfma_f32_32x32x16_bf16 v[224:239], v[100:103], v[116:119], v[224:239]
    v_mfma_f32_32x32x16_bf16 v[240:255], v[104:107], v[116:119], v[240:255]
    s_waitcnt lgkmcnt(0)
    v_mfma_f32_32x32x16_bf16 v[192:207], v[132:135], v[120:123], v[192:207]
    s_mov_b64 exec, 1
    ds_write_b32 v17, v15
    s_mov_b64 exec, -1
    ds_read_b64_tr_b16 v[40:41], v12 offset:0
    ds_read_b64_tr_b16 v[42:43], v12 offset:512
    ds_read_b64_tr_b16 v[44:45], v12 offset:1024
    ds_read_b64_tr_b16 v[46:47], v12 offset:1536
    v_mov_b32 v16, 162864
    ds_read_b96 v[24:26], v16
    v_mfma_f32_32x32x16_bf16 v[208:223], v[132:135], v[124:127], v[208:223]
    v_mfma_f32_32x32x16_bf16 v[224:239], v[120:123], v[136:139], v[224:239]
    v_mfma_f32_32x32x16_bf16 v[240:255], v[124:127], v[136:139], v[240:255]
    s_mov_b32 s48, 0x3fb8aa3b
    s_mov_b32 s52, 0xbfb8aa3b
    v_cvt_pk_bf16_f32 v64, v192, v193
    v_cvt_pk_bf16_f32 v65, v194, v195
    v_cvt_pk_bf16_f32 v66, v196, v197
    v_cvt_pk_bf16_f32 v67, v198, v199
    v_cvt_pk_bf16_f32 v68, v200, v201
    v_cvt_pk_bf16_f32 v69, v202, v203
    v_cvt_pk_bf16_f32 v70, v204, v205
    v_cvt_pk_bf16_f32 v71, v206, v207
    s_waitcnt lgkmcnt(0)
    v_mfma_f32_32x32x16_bf16 v[192:207], v[40:43], v[64:67], 0
    v_mfma_f32_32x32x16_bf16 v[192:207], v[44:47], v[68:71], v[192:207]
    v_cvt_pk_bf16_f32 v72, v208, v209
    v_cvt_pk_bf16_f32 v73, v210, v211
    v_cvt_pk_bf16_f32 v74, v212, v213
    v_cvt_pk_bf16_f32 v75, v214, v215
    v_cvt_pk_bf16_f32 v76, v216, v217
    v_cvt_pk_bf16_f32 v77, v218, v219
    v_cvt_pk_bf16_f32 v78, v220, v221
    v_cvt_pk_bf16_f32 v79, v222, v223
    v_mfma_f32_32x32x16_bf16 v[208:223], v[40:43], v[72:75], 0
    s_nop 0
    v_mfma_f32_32x32x16_bf16 v[208:223], v[44:47], v[76:79], v[208:223]
    v_readfirstlane_b32 s72, v24
    v_readfirstlane_b32 s73, v25
    v_readfirstlane_b32 s74, v26
    v_and_b32 v27, 3, v2
    v_lshlrev_b32 v27, 3, v27
    v_bfe_u32 v27, v26, v27, 8
    v_mov_b32 v28, 0xffffff00
    s_and_b32 s76, s74, 0xff
    s_bfe_u32 s77, s74, 0x80008
    s_bfe_u32 s78, s74, 0x80010
    s_lshr_b32 s79, s74, 24
    v_cvt_pk_bf16_f32 v80, v224, v225
    v_cvt_pk_bf16_f32 v81, v226, v227
    v_cvt_pk_bf16_f32 v82, v228, v229
    v_cvt_pk_bf16_f32 v83, v230, v231
    v_cvt_pk_bf16_f32 v84, v232, v233
    v_cvt_pk_bf16_f32 v85, v234, v235
    v_cvt_pk_bf16_f32 v86, v236, v237
    v_cvt_pk_bf16_f32 v87, v238, v239
    v_cvt_pk_bf16_f32 v88, v240, v241
    v_cvt_pk_bf16_f32 v89, v242, v243
    v_cvt_pk_bf16_f32 v90, v244, v245
    v_cvt_pk_bf16_f32 v91, v246, v247
    v_cvt_pk_bf16_f32 v92, v248, v249
    v_cvt_pk_bf16_f32 v93, v250, v251
    v_cvt_pk_bf16_f32 v94, v252, v253
    v_cvt_pk_bf16_f32 v95, v254, v255
    v_cvt_pk_bf16_f32 v64, v192, v193
    v_cvt_pk_bf16_f32 v65, v194, v195
    v_cvt_pk_bf16_f32 v66, v196, v197
    v_cvt_pk_bf16_f32 v67, v198, v199
    v_cvt_pk_bf16_f32 v68, v200, v201
    v_cvt_pk_bf16_f32 v69, v202, v203
    v_cvt_pk_bf16_f32 v70, v204, v205
    v_cvt_pk_bf16_f32 v71, v206, v207
    v_lshlrev_b32 v192, 16, v64
    v_and_b32 v193, 0xffff0000, v64
    v_lshlrev_b32 v194, 16, v65
    v_and_b32 v195, 0xffff0000, v65
    v_lshlrev_b32 v196, 16, v66
    v_and_b32 v197, 0xffff0000, v66
    v_lshlrev_b32 v198, 16, v67
    v_and_b32 v199, 0xffff0000, v67
    v_lshlrev_b32 v200, 16, v68
    v_and_b32 v201, 0xffff0000, v68
    v_lshlrev_b32 v202, 16, v69
    v_and_b32 v203, 0xffff0000, v69
    v_lshlrev_b32 v204, 16, v70
    v_and_b32 v205, 0xffff0000, v70
    v_lshlrev_b32 v206, 16, v71
    v_and_b32 v207, 0xffff0000, v71
    v_max3_f32 v144, v192, v193, v194
    v_max3_f32 v145, v195, v196, v197
    v_max3_f32 v146, v198, v199, v200
    v_max3_f32 v147, v201, v202, v203
    v_max3_f32 v148, v204, v205, v206
    v_max3_f32 v144, v144, v145, v207
    v_max3_f32 v146, v146, v147, v148
    v_max_f32 v144, v144, v146
    v_min3_f32 v150, v192, v193, v194
    v_min3_f32 v151, v195, v196, v197
    v_min3_f32 v152, v198, v199, v200
    v_min3_f32 v153, v201, v202, v203
    v_min3_f32 v154, v204, v205, v206
    v_min3_f32 v150, v150, v151, v207
    v_min3_f32 v152, v152, v153, v154
    v_min_f32 v150, v150, v152
    v_mov_b32 v145, v144
    v_mov_b32 v151, v150
    s_nop 0
    v_permlane32_swap_b32 v144, v145
    v_permlane32_swap_b32 v150, v151
    v_max_f32 v144, v144, v145
    v_min_f32 v150, v150, v151
    v_mul_f32 v144, s52, v144
    v_mul_f32 v150, s48, v150
    v_pk_fma_f32 v[224:225], v[192:193], s[48:49], v[144:145] op_sel_hi:[1,0,0]
    v_pk_fma_f32 v[112:113], v[192:193], s[52:53], v[150:151] op_sel_hi:[1,0,0]
    v_pk_fma_f32 v[226:227], v[194:195], s[48:49], v[144:145] op_sel_hi:[1,0,0]
    v_pk_fma_f32 v[114:115], v[194:195], s[52:53], v[150:151] op_sel_hi:[1,0,0]
    v_pk_fma_f32 v[228:229], v[196:197], s[48:49], v[144:145] op_sel_hi:[1,0,0]
    v_pk_fma_f32 v[116:117], v[196:197], s[52:53], v[150:151] op_sel_hi:[1,0,0]
    v_pk_fma_f32 v[230:231], v[198:199], s[48:49], v[144:145] op_sel_hi:[1,0,0]
    v_pk_fma_f32 v[118:119], v[198:199], s[52:53], v[150:151] op_sel_hi:[1,0,0]
    v_pk_fma_f32 v[232:233], v[200:201], s[48:49], v[144:145] op_sel_hi:[1,0,0]
    v_pk_fma_f32 v[120:121], v[200:201], s[52:53], v[150:151] op_sel_hi:[1,0,0]
    v_pk_fma_f32 v[234:235], v[202:203], s[48:49], v[144:145] op_sel_hi:[1,0,0]
    v_pk_fma_f32 v[122:123], v[202:203], s[52:53], v[150:151] op_sel_hi:[1,0,0]
    v_pk_fma_f32 v[236:237], v[204:205], s[48:49], v[144:145] op_sel_hi:[1,0,0]
    v_pk_fma_f32 v[124:125], v[204:205], s[52:53], v[150:151] op_sel_hi:[1,0,0]
    v_pk_fma_f32 v[238:239], v[206:207], s[48:49], v[144:145] op_sel_hi:[1,0,0]
    v_pk_fma_f32 v[126:127], v[206:207], s[52:53], v[150:151] op_sel_hi:[1,0,0]
    v_exp_f32 v224, v224
    v_exp_f32 v112, v112
    v_exp_f32 v225, v225
    v_exp_f32 v113, v113
    v_exp_f32 v226, v226
    v_exp_f32 v114, v114
    v_exp_f32 v227, v227
    v_exp_f32 v115, v115
    v_exp_f32 v228, v228
    v_exp_f32 v116, v116
    v_exp_f32 v229, v229
    v_exp_f32 v117, v117
    v_exp_f32 v230, v230
    v_exp_f32 v118, v118
    v_exp_f32 v231, v231
    v_exp_f32 v119, v119
    v_exp_f32 v232, v232
    v_exp_f32 v120, v120
    v_exp_f32 v233, v233
    v_exp_f32 v121, v121
    v_exp_f32 v234, v234
    v_exp_f32 v122, v122
    v_exp_f32 v235, v235
    v_exp_f32 v123, v123
    v_exp_f32 v236, v236
    v_exp_f32 v124, v124
    v_exp_f32 v237, v237
    v_exp_f32 v125, v125
    v_exp_f32 v238, v238
    v_exp_f32 v126, v126
    v_exp_f32 v239, v239
    v_exp_f32 v127, v127
    v_pk_add_f32 v[144:145], v[224:225], v[226:227]
    v_pk_add_f32 v[146:147], v[228:229], v[230:231]
    v_pk_add_f32 v[148:149], v[232:233], v[234:235]
    v_pk_add_f32 v[150:151], v[112:113], v[114:115]
    v_pk_add_f32 v[152:153], v[116:117], v[118:119]
    v_pk_add_f32 v[154:155], v[120:121], v[122:123]
    v_pk_add_f32 v[144:145], v[144:145], v[236:237]
    v_pk_add_f32 v[146:147], v[146:147], v[238:239]
    v_pk_add_f32 v[150:151], v[150:151], v[124:125]
    v_pk_add_f32 v[152:153], v[152:153], v[126:127]
    v_pk_add_f32 v[144:145], v[144:145], v[148:149]
    v_pk_add_f32 v[150:151], v[150:151], v[154:155]
    v_pk_add_f32 v[144:145], v[144:145], v[146:147]
    v_pk_add_f32 v[150:151], v[150:151], v[152:153]
    v_add_f32 v144, v144, v145
    v_add_f32 v150, v150, v151
    v_mov_b32 v145, v144
    v_mov_b32 v151, v150
    s_nop 0
    v_permlane32_swap_b32 v144, v145
    v_permlane32_swap_b32 v150, v151
    v_add_f32 v144, v144, v145
    v_add_f32 v150, v150, v151
    v_rcp_f32 v144, v144
    v_rcp_f32 v150, v150
    v_pk_mul_f32 v[224:225], v[224:225], v[144:145] op_sel_hi:[1,0]
    v_pk_mul_f32 v[112:113], v[112:113], v[150:151] op_sel_hi:[1,0]
    v_pk_mul_f32 v[226:227], v[226:227], v[144:145] op_sel_hi:[1,0]
    v_pk_mul_f32 v[114:115], v[114:115], v[150:151] op_sel_hi:[1,0]
    v_pk_mul_f32 v[228:229], v[228:229], v[144:145] op_sel_hi:[1,0]
    v_pk_mul_f32 v[116:117], v[116:117], v[150:151] op_sel_hi:[1,0]
    v_pk_mul_f32 v[230:231], v[230:231], v[144:145] op_sel_hi:[1,0]
    v_pk_mul_f32 v[118:119], v[118:119], v[150:151] op_sel_hi:[1,0]
    v_pk_mul_f32 v[232:233], v[232:233], v[144:145] op_sel_hi:[1,0]
    v_pk_mul_f32 v[120:121], v[120:121], v[150:151] op_sel_hi:[1,0]
    v_pk_mul_f32 v[234:235], v[234:235], v[144:145] op_sel_hi:[1,0]
    v_pk_mul_f32 v[122:123], v[122:123], v[150:151] op_sel_hi:[1,0]
    v_pk_mul_f32 v[236:237], v[236:237], v[144:145] op_sel_hi:[1,0]
    v_pk_mul_f32 v[124:125], v[124:125], v[150:151] op_sel_hi:[1,0]
    v_pk_mul_f32 v[238:239], v[238:239], v[144:145] op_sel_hi:[1,0]
    v_pk_mul_f32 v[126:127], v[126:127], v[150:151] op_sel_hi:[1,0]
    v_cvt_pk_bf16_f32 v64, v224, v225
    v_cvt_pk_bf16_f32 v96, v112, v113
    v_cvt_pk_bf16_f32 v65, v226, v227
    v_cvt_pk_bf16_f32 v97, v114, v115
    v_cvt_pk_bf16_f32 v66, v228, v229
    v_cvt_pk_bf16_f32 v98, v116, v117
    v_cvt_pk_bf16_f32 v67, v230, v231
    v_cvt_pk_bf16_f32 v99, v118, v119
    v_cvt_pk_bf16_f32 v68, v232, v233
    v_cvt_pk_bf16_f32 v100, v120, v121
    v_cvt_pk_bf16_f32 v69, v234, v235
    v_cvt_pk_bf16_f32 v101, v122, v123
    v_cvt_pk_bf16_f32 v70, v236, v237
    v_cvt_pk_bf16_f32 v102, v124, v125
    v_cvt_pk_bf16_f32 v71, v238, v239
    v_cvt_pk_bf16_f32 v103, v126, v127
    v_mfma_f32_32x32x16_bf16 v[192:207], v[64:67], v[48:51], 0
    v_cvt_pk_bf16_f32 v72, v208, v209
    v_cvt_pk_bf16_f32 v73, v210, v211
    v_cvt_pk_bf16_f32 v74, v212, v213
    v_cvt_pk_bf16_f32 v75, v214, v215
    v_cvt_pk_bf16_f32 v76, v216, v217
    v_cvt_pk_bf16_f32 v77, v218, v219
    v_cvt_pk_bf16_f32 v78, v220, v221
    v_mfma_f32_32x32x16_bf16 v[192:207], v[68:71], v[52:55], v[192:207]
    v_cvt_pk_bf16_f32 v79, v222, v223
    v_lshlrev_b32 v208, 16, v72
    v_and_b32 v209, 0xffff0000, v72
    v_lshlrev_b32 v210, 16, v73
    v_and_b32 v211, 0xffff0000, v73
    v_lshlrev_b32 v212, 16, v74
    v_and_b32 v213, 0xffff0000, v74
    v_mfma_f32_32x32x16_bf16 v[224:239], v[96:99], v[48:51], 0
    v_lshlrev_b32 v214, 16, v75
    v_and_b32 v215, 0xffff0000, v75
    v_lshlrev_b32 v216, 16, v76
    v_and_b32 v217, 0xffff0000, v76
    v_lshlrev_b32 v218, 16, v77
    v_and_b32 v219, 0xffff0000, v77
    v_lshlrev_b32 v220, 16, v78
    v_mfma_f32_32x32x16_bf16 v[224:239], v[100:103], v[52:55], v[224:239]
    v_and_b32 v221, 0xffff0000, v78
    v_lshlrev_b32 v222, 16, v79
    v_and_b32 v223, 0xffff0000, v79
    v_max3_f32 v144, v208, v209, v210
    v_max3_f32 v145, v211, v212, v213
    v_max3_f32 v146, v214, v215, v216
    v_max3_f32 v147, v217, v218, v219
    v_max3_f32 v148, v220, v221, v222
    v_max3_f32 v144, v144, v145, v223
    v_max3_f32 v146, v146, v147, v148
    v_max_f32 v144, v144, v146
    v_min3_f32 v150, v208, v209, v210
    v_min3_f32 v151, v211, v212, v213
    v_min3_f32 v152, v214, v215, v216
    v_min3_f32 v153, v217, v218, v219
    v_min3_f32 v154, v220, v221, v222
    v_min3_f32 v150, v150, v151, v223
    v_min3_f32 v152, v152, v153, v154
    v_min_f32 v150, v150, v152
    v_mov_b32 v145, v144
    v_mov_b32 v151, v150
    s_nop 0
    v_permlane32_swap_b32 v144, v145
    v_permlane32_swap_b32 v150, v151
    v_max_f32 v144, v144, v145
    v_min_f32 v150, v150, v151
    v_mul_f32 v144, s52, v144
    v_mul_f32 v150, s48, v150
    v_pk_fma_f32 v[240:241], v[208:209], s[48:49], v[144:145] op_sel_hi:[1,0,0]
    v_pk_fma_f32 v[128:129], v[208:209], s[52:53], v[150:151] op_sel_hi:[1,0,0]
    v_pk_fma_f32 v[242:243], v[210:211], s[48:49], v[144:145] op_sel_hi:[1,0,0]
    v_pk_fma_f32 v[130:131], v[210:211], s[52:53], v[150:151] op_sel_hi:[1,0,0]
    v_pk_fma_f32 v[244:245], v[212:213], s[48:49], v[144:145] op_sel_hi:[1,0,0]
    v_pk_fma_f32 v[132:133], v[212:213], s[52:53], v[150:151] op_sel_hi:[1,0,0]
    v_pk_fma_f32 v[246:247], v[214:215], s[48:49], v[144:145] op_sel_hi:[1,0,0]
    v_pk_fma_f32 v[134:135], v[214:215], s[52:53], v[150:151] op_sel_hi:[1,0,0]
    v_pk_fma_f32 v[248:249], v[216:217], s[48:49], v[144:145] op_sel_hi:[1,0,0]
    v_pk_fma_f32 v[136:137], v[216:217], s[52:53], v[150:151] op_sel_hi:[1,0,0]
    v_pk_fma_f32 v[250:251], v[218:219], s[48:49], v[144:145] op_sel_hi:[1,0,0]
    v_pk_fma_f32 v[138:139], v[218:219], s[52:53], v[150:151] op_sel_hi:[1,0,0]
    v_pk_fma_f32 v[252:253], v[220:221], s[48:49], v[144:145] op_sel_hi:[1,0,0]
    v_pk_fma_f32 v[140:141], v[220:221], s[52:53], v[150:151] op_sel_hi:[1,0,0]
    v_pk_fma_f32 v[254:255], v[222:223], s[48:49], v[144:145] op_sel_hi:[1,0,0]
    v_pk_fma_f32 v[142:143], v[222:223], s[52:53], v[150:151] op_sel_hi:[1,0,0]
    v_cvt_pk_bf16_f32 v64, v192, v193
    v_cvt_pk_bf16_f32 v65, v194, v195
    v_cvt_pk_bf16_f32 v66, v196, v197
    v_cvt_pk_bf16_f32 v67, v198, v199
    v_cvt_pk_bf16_f32 v68, v200, v201
    v_cvt_pk_bf16_f32 v69, v202, v203
    v_cvt_pk_bf16_f32 v70, v204, v205
    v_cvt_pk_bf16_f32 v71, v206, v207
    v_cvt_pk_bf16_f32 v96, v224, v225
    v_cvt_pk_bf16_f32 v97, v226, v227
    v_cvt_pk_bf16_f32 v98, v228, v229
    v_cvt_pk_bf16_f32 v99, v230, v231
    v_cvt_pk_bf16_f32 v100, v232, v233
    v_cvt_pk_bf16_f32 v101, v234, v235
    v_cvt_pk_bf16_f32 v102, v236, v237
    v_cvt_pk_bf16_f32 v103, v238, v239
    v_mfma_f32_32x32x16_bf16 v[112:127], v[64:67], v[80:83], 0
    v_exp_f32 v240, v240
    v_exp_f32 v128, v128
    v_exp_f32 v241, v241
    v_exp_f32 v129, v129
    v_mfma_f32_32x32x16_bf16 v[112:127], v[68:71], v[84:87], v[112:127]
    v_exp_f32 v242, v242
    v_exp_f32 v130, v130
    v_exp_f32 v243, v243
    v_exp_f32 v131, v131
    v_mfma_f32_32x32x16_bf16 v[192:207], v[96:99], v[80:83], 0
    v_exp_f32 v244, v244
    v_exp_f32 v132, v132
    v_exp_f32 v245, v245
    v_exp_f32 v133, v133
    v_mfma_f32_32x32x16_bf16 v[192:207], v[100:103], v[84:87], v[192:207]
    v_exp_f32 v246, v246
    v_exp_f32 v134, v134
    v_exp_f32 v247, v247
    v_exp_f32 v135, v135
    v_mfma_f32_32x32x16_bf16 v[224:239], v[64:67], v[56:59], 0
    v_exp_f32 v248, v248
    v_exp_f32 v136, v136
    v_exp_f32 v249, v249
    v_exp_f32 v137, v137
    v_mfma_f32_32x32x16_bf16 v[224:239], v[68:71], v[56:59], v[224:239]
    v_exp_f32 v250, v250
    v_exp_f32 v138, v138
    v_exp_f32 v251, v251
    v_exp_f32 v139, v139
    v_mfma_f32_32x32x16_bf16 v[224:239], v[96:99], v[60:63], v[224:239]
    v_exp_f32 v252, v252
    v_exp_f32 v140, v140
    v_exp_f32 v253, v253
    v_exp_f32 v141, v141
    v_mfma_f32_32x32x16_bf16 v[224:239], v[100:103], v[60:63], v[224:239]
    v_exp_f32 v254, v254
    v_exp_f32 v142, v142
    v_exp_f32 v255, v255
    v_exp_f32 v143, v143
    v_pk_add_f32 v[144:145], v[240:241], v[242:243]
    v_pk_add_f32 v[146:147], v[244:245], v[246:247]
    v_pk_add_f32 v[148:149], v[248:249], v[250:251]
    v_pk_add_f32 v[150:151], v[128:129], v[130:131]
    v_pk_add_f32 v[152:153], v[132:133], v[134:135]
    v_pk_add_f32 v[154:155], v[136:137], v[138:139]
    v_pk_add_f32 v[144:145], v[144:145], v[252:253]
    v_pk_add_f32 v[146:147], v[146:147], v[254:255]
    v_pk_add_f32 v[150:151], v[150:151], v[140:141]
    v_pk_add_f32 v[152:153], v[152:153], v[142:143]
    v_pk_add_f32 v[144:145], v[144:145], v[148:149]
    v_pk_add_f32 v[150:151], v[150:151], v[154:155]
    v_pk_add_f32 v[144:145], v[144:145], v[146:147]
    v_pk_add_f32 v[150:151], v[150:151], v[152:153]
    v_add_f32 v144, v144, v145
    v_add_f32 v150, v150, v151
    v_mov_b32 v145, v144
    v_mov_b32 v151, v150
    s_nop 0
    v_permlane32_swap_b32 v144, v145
    v_permlane32_swap_b32 v150, v151
    v_add_f32 v144, v144, v145
    v_add_f32 v150, v150, v151
    v_rcp_f32 v144, v144
    v_rcp_f32 v150, v150
    v_pk_mul_f32 v[240:241], v[240:241], v[144:145] op_sel_hi:[1,0]
    v_pk_mul_f32 v[128:129], v[128:129], v[150:151] op_sel_hi:[1,0]
    v_pk_mul_f32 v[242:243], v[242:243], v[144:145] op_sel_hi:[1,0]
    v_pk_mul_f32 v[130:131], v[130:131], v[150:151] op_sel_hi:[1,0]
    v_pk_mul_f32 v[244:245], v[244:245], v[144:145] op_sel_hi:[1,0]
    v_pk_mul_f32 v[132:133], v[132:133], v[150:151] op_sel_hi:[1,0]
    v_pk_mul_f32 v[246:247], v[246:247], v[144:145] op_sel_hi:[1,0]
    v_pk_mul_f32 v[134:135], v[134:135], v[150:151] op_sel_hi:[1,0]
    v_pk_mul_f32 v[248:249], v[248:249], v[144:145] op_sel_hi:[1,0]
    v_pk_mul_f32 v[136:137], v[136:137], v[150:151] op_sel_hi:[1,0]
    v_pk_mul_f32 v[250:251], v[250:251], v[144:145] op_sel_hi:[1,0]
    v_pk_mul_f32 v[138:139], v[138:139], v[150:151] op_sel_hi:[1,0]
    v_pk_mul_f32 v[252:253], v[252:253], v[144:145] op_sel_hi:[1,0]
    v_pk_mul_f32 v[140:141], v[140:141], v[150:151] op_sel_hi:[1,0]
    v_pk_mul_f32 v[254:255], v[254:255], v[144:145] op_sel_hi:[1,0]
    v_pk_mul_f32 v[142:143], v[142:143], v[150:151] op_sel_hi:[1,0]
    s_cmp_eq_u32 s21, 0
    s_cbranch_scc0 L_c_rw1
    v_cvt_pk_bf16_f32 v104, v128, v129
    v_cvt_pk_bf16_f32 v105, v130, v131
    v_cvt_pk_bf16_f32 v106, v132, v133
    v_cvt_pk_bf16_f32 v107, v134, v135
    v_cvt_pk_bf16_f32 v108, v136, v137
    v_cvt_pk_bf16_f32 v109, v138, v139
    v_cvt_pk_bf16_f32 v110, v140, v141
    v_cvt_pk_bf16_f32 v111, v142, v143
    v_mfma_f32_32x32x16_bf16 v[208:223], v[104:107], v[48:51], 0
    v_cvt_pk_bf16_f32 v72, v240, v241
    v_cvt_pk_bf16_f32 v73, v242, v243
    v_cvt_pk_bf16_f32 v74, v244, v245
    v_cvt_pk_bf16_f32 v75, v246, v247
    v_mfma_f32_32x32x16_bf16 v[208:223], v[108:111], v[52:55], v[208:223]
    v_cvt_pk_bf16_f32 v76, v248, v249
    v_cvt_pk_bf16_f32 v77, v250, v251
    v_cvt_pk_bf16_f32 v78, v252, v253
    v_cvt_pk_bf16_f32 v79, v254, v255
    v_mfma_f32_32x32x16_bf16 v[240:255], v[72:75], v[48:51], 0
    s_nop 0
    v_mfma_f32_32x32x16_bf16 v[240:255], v[76:79], v[52:55], v[240:255]
    s_nop 4
    v_cvt_pk_bf16_f32 v104, v208, v209
    v_cvt_pk_bf16_f32 v105, v210, v211
    v_cvt_pk_bf16_f32 v106, v212, v213
    v_cvt_pk_bf16_f32 v107, v214, v215
    v_cvt_pk_bf16_f32 v108, v216, v217
    v_cvt_pk_bf16_f32 v109, v218, v219
    v_cvt_pk_bf16_f32 v110, v220, v221
    v_cvt_pk_bf16_f32 v111, v222, v223
    v_mfma_f32_32x32x16_bf16 v[192:207], v[104:107], v[88:91], v[192:207]
    v_cvt_pk_bf16_f32 v72, v240, v241
    v_cvt_pk_bf16_f32 v73, v242, v243
    v_cvt_pk_bf16_f32 v74, v244, v245
    v_cvt_pk_bf16_f32 v75, v246, v247
    v_mfma_f32_32x32x16_bf16 v[192:207], v[108:111], v[92:95], v[192:207]
    v_cvt_pk_bf16_f32 v76, v248, v249
    v_cvt_pk_bf16_f32 v77, v250, v251
    v_cvt_pk_bf16_f32 v78, v252, v253
    v_cvt_pk_bf16_f32 v79, v254, v255
    v_mfma_f32_32x32x16_bf16 v[224:239], v[104:107], v[60:63], v[224:239]
    s_nop 0
    v_mfma_f32_32x32x16_bf16 v[224:239], v[108:111], v[60:63], v[224:239]
    s_nop 4
    ds_write_b128 v8, v[192:195] offset:0
    v_mfma_f32_32x32x16_bf16 v[224:239], v[72:75], v[56:59], v[224:239]
    ds_write_b128 v8, v[196:199] offset:1024
    v_mfma_f32_32x32x16_bf16 v[224:239], v[76:79], v[56:59], v[224:239]
    ds_write_b128 v8, v[200:203] offset:2048
    ds_write_b128 v8, v[204:207] offset:3072
    v_mfma_f32_32x32x16_bf16 v[112:127], v[72:75], v[88:91], v[112:127]
    v_mfma_f32_32x32x16_bf16 v[112:127], v[76:79], v[92:95], v[112:127]
    s_mov_b32 exec_lo, s45
    s_mov_b32 exec_hi, s45
    s_nop 5
    ds_write_b128 v10, v[224:227] offset:4096
    ds_write_b128 v10, v[228:231] offset:4128
    ds_write_b128 v10, v[232:235] offset:4160
    ds_write_b128 v10, v[236:239] offset:4192
    ds_write_b32 v13, v15
    s_mov_b64 exec, -1
    s_mov_b32 s13, 0
L_c_x0:
    ds_read_b32 v16, v14
    ds_read_b128 v[128:131], v9 offset:0
    ds_read_b128 v[132:135], v9 offset:1024
    ds_read_b128 v[136:139], v9 offset:2048
    ds_read_b128 v[140:143], v9 offset:3072
    ds_read_b32 v144, v11 offset:4096
    ds_read_b32 v145, v11 offset:4224
    s_add_u32 s13, s13, 1
    s_cmp_ge_u32 s13, 262144
    s_cbranch_scc1 L_c_y0
    s_waitcnt lgkmcnt(6)
    v_cmp_eq_u32 vcc, 1, v16
    s_cbranch_vccz L_c_x0
L_c_y0:
    s_waitcnt lgkmcnt(2)
    v_pk_add_f32 v[112:113], v[112:113], v[128:129]
    v_pk_add_f32 v[114:115], v[114:115], v[130:131]
    v_pk_add_f32 v[116:117], v[116:117], v[132:133]
    v_pk_add_f32 v[118:119], v[118:119], v[134:135]
    v_pk_add_f32 v[120:121], v[120:121], v[136:137]
    v_pk_add_f32 v[122:123], v[122:123], v[138:139]
    v_pk_add_f32 v[124:125], v[124:125], v[140:141]
    v_pk_add_f32 v[126:127], v[126:127], v[142:143]
    v_and_or_b32 v112, v112, v28, v27
    buffer_store_dwordx4 v[112:115], v6, s[32:35], s40 offen offset:0 sc1
    v_and_or_b32 v116, v116, v28, v27
    buffer_store_dwordx4 v[116:119], v6, s[32:35], s40 offen offset:512 sc1
    v_and_or_b32 v120, v120, v28, v27
    buffer_store_dwordx4 v[120:123], v6, s[32:35], s41 offen offset:0 sc1
    v_and_or_b32 v124, v124, v28, v27
    buffer_store_dwordx4 v[124:127], v6, s[32:35], s41 offen offset:512 sc1
    s_branch L_c_zs
L_c_rw1:
    s_nop 1
    v_cvt_pk_bf16_f32 v72, v240, v241
    v_cvt_pk_bf16_f32 v73, v242, v243
    v_cvt_pk_bf16_f32 v74, v244, v245
    v_cvt_pk_bf16_f32 v75, v246, v247
    v_cvt_pk_bf16_f32 v76, v248, v249
    v_cvt_pk_bf16_f32 v77, v250, v251
    v_cvt_pk_bf16_f32 v78, v252, v253
    v_cvt_pk_bf16_f32 v79, v254, v255
    v_mfma_f32_32x32x16_bf16 v[208:223], v[72:75], v[48:51], 0
    v_cvt_pk_bf16_f32 v104, v128, v129
    v_cvt_pk_bf16_f32 v105, v130, v131
    v_cvt_pk_bf16_f32 v106, v132, v133
    v_cvt_pk_bf16_f32 v107, v134, v135
    v_mfma_f32_32x32x16_bf16 v[208:223], v[76:79], v[52:55], v[208:223]
    v_cvt_pk_bf16_f32 v108, v136, v137
    v_cvt_pk_bf16_f32 v109, v138, v139
    v_cvt_pk_bf16_f32 v110, v140, v141
    v_cvt_pk_bf16_f32 v111, v142, v143
    v_mfma_f32_32x32x16_bf16 v[240:255], v[104:107], v[48:51], 0
    s_nop 0
    v_mfma_f32_32x32x16_bf16 v[240:255], v[108:111], v[52:55], v[240:255]
    s_nop 4
    v_cvt_pk_bf16_f32 v72, v208, v209
    v_cvt_pk_bf16_f32 v73, v210, v211
    v_cvt_pk_bf16_f32 v74, v212, v213
    v_cvt_pk_bf16_f32 v75, v214, v215
    v_cvt_pk_bf16_f32 v76, v216, v217
    v_cvt_pk_bf16_f32 v77, v218, v219
    v_cvt_pk_bf16_f32 v78, v220, v221
    v_cvt_pk_bf16_f32 v79, v222, v223
    v_mfma_f32_32x32x16_bf16 v[112:127], v[72:75], v[88:91], v[112:127]
    v_cvt_pk_bf16_f32 v104, v240, v241
    v_cvt_pk_bf16_f32 v105, v242, v243
    v_cvt_pk_bf16_f32 v106, v244, v245
    v_cvt_pk_bf16_f32 v107, v246, v247
    v_mfma_f32_32x32x16_bf16 v[112:127], v[76:79], v[92:95], v[112:127]
    v_cvt_pk_bf16_f32 v108, v248, v249
    v_cvt_pk_bf16_f32 v109, v250, v251
    v_cvt_pk_bf16_f32 v110, v252, v253
    v_cvt_pk_bf16_f32 v111, v254, v255
    v_mfma_f32_32x32x16_bf16 v[224:239], v[72:75], v[56:59], v[224:239]
    s_nop 0
    v_mfma_f32_32x32x16_bf16 v[224:239], v[76:79], v[56:59], v[224:239]
    s_nop 4
    ds_write_b128 v8, v[112:115] offset:0
    v_mfma_f32_32x32x16_bf16 v[224:239], v[104:107], v[60:63], v[224:239]
    ds_write_b128 v8, v[116:119] offset:1024
    v_mfma_f32_32x32x16_bf16 v[224:239], v[108:111], v[60:63], v[224:239]
    ds_write_b128 v8, v[120:123] offset:2048
    ds_write_b128 v8, v[124:127] offset:3072
    v_mfma_f32_32x32x16_bf16 v[192:207], v[104:107], v[88:91], v[192:207]
    v_mfma_f32_32x32x16_bf16 v[192:207], v[108:111], v[92:95], v[192:207]
    s_mov_b32 exec_lo, s45
    s_mov_b32 exec_hi, s45
    s_nop 5
    ds_write_b128 v10, v[224:227] offset:4096
    ds_write_b128 v10, v[228:231] offset:4128
    ds_write_b128 v10, v[232:235] offset:4160
    ds_write_b128 v10, v[236:239] offset:4192
    ds_write_b32 v13, v15
    s_mov_b64 exec, -1
    s_mov_b32 s13, 0
L_c_x1:
    ds_read_b32 v16, v14
    ds_read_b128 v[128:131], v9 offset:0
    ds_read_b128 v[132:135], v9 offset:1024
    ds_read_b128 v[136:139], v9 offset:2048
    ds_read_b128 v[140:143], v9 offset:3072
    ds_read_b32 v144, v11 offset:4096
    ds_read_b32 v145, v11 offset:4224
    s_add_u32 s13, s13, 1
    s_cmp_ge_u32 s13, 262144
    s_cbranch_scc1 L_c_y1
    s_waitcnt lgkmcnt(6)
    v_cmp_eq_u32 vcc, 1, v16
    s_cbranch_vccz L_c_x1
L_c_y1:
    s_waitcnt lgkmcnt(2)
    v_pk_add_f32 v[192:193], v[192:193], v[128:129]
    v_pk_add_f32 v[194:195], v[194:195], v[130:131]
    v_pk_add_f32 v[196:197], v[196:197], v[132:133]
    v_pk_add_f32 v[198:199], v[198:199], v[134:135]
    v_pk_add_f32 v[200:201], v[200:201], v[136:137]
    v_pk_add_f32 v[202:203], v[202:203], v[138:139]
    v_pk_add_f32 v[204:205], v[204:205], v[140:141]
    v_pk_add_f32 v[206:207], v[206:207], v[142:143]
    v_and_or_b32 v192, v192, v28, v27
    buffer_store_dwordx4 v[192:195], v6, s[32:35], s40 offen offset:0 sc1
    v_and_or_b32 v196, v196, v28, v27
    buffer_store_dwordx4 v[196:199], v6, s[32:35], s40 offen offset:512 sc1
    v_and_or_b32 v200, v200, v28, v27
    buffer_store_dwordx4 v[200:203], v6, s[32:35], s41 offen offset:0 sc1
    v_and_or_b32 v204, v204, v28, v27
    buffer_store_dwordx4 v[204:207], v6, s[32:35], s41 offen offset:512 sc1
L_c_zs:
    s_waitcnt lgkmcnt(0)
    v_add_f32 v144, v144, v145
    v_and_or_b32 v144, v144, v28, v27
    s_mov_b32 exec_hi, 0
    buffer_store_dword v144, v7, s[32:35], s42 offen sc1
    s_mov_b32 exec_lo, 1
    ds_write_b32 v13, v15 offset:96
    s_mov_b64 exec, -1
    v_mov_b32 v16, 162960
    s_mov_b32 s13, 0
L_c_wq:
    ds_read_b128 v[64:67], v16
    s_add_u32 s13, s13, 1
    s_cmp_ge_u32 s13, 262144
    s_cbranch_scc1 L_c_wqok
    s_waitcnt lgkmcnt(0)
    v_and_b32 v64, v64, v65
    v_and_b32 v66, v66, v67
    v_and_b32 v64, v64, v66
    v_cmp_eq_u32 vcc, 1, v64
    s_cbranch_vccz L_c_wq
L_c_wqok:
    s_waitcnt lgkmcnt(0)
    v_add_u32 v36, 0x2000, v36
    ds_read_b64_tr_b16 v[72:73], v36 offset:0
    ds_read_b64_tr_b16 v[74:75], v36 offset:512
    ds_read_b128 v[64:67], v20
    ds_read_b128 v[68:71], v20 offset:4096
    ds_read_b64_tr_b16 v[84:85], v36 offset:2048
    ds_read_b64_tr_b16 v[86:87], v36 offset:2560
    ds_read_b128 v[76:79], v21
    ds_read_b128 v[80:83], v21 offset:4096
    ds_read_b64_tr_b16 v[96:97], v36 offset:4096
    ds_read_b64_tr_b16 v[98:99], v36 offset:4608
    ds_read_b128 v[88:91], v22
    ds_read_b128 v[92:95], v22 offset:4096
    s_waitcnt lgkmcnt(9)
    v_mfma_f32_32x32x16_bf16 v[160:175], v[72:75], v[64:67], v[160:175]
    s_waitcnt lgkmcnt(8)
    v_mfma_f32_32x32x16_bf16 v[176:191], v[72:75], v[68:71], v[176:191]
    ds_read_b64_tr_b16 v[108:109], v36 offset:6144
    ds_read_b64_tr_b16 v[110:111], v36 offset:6656
    ds_read_b128 v[100:103], v23
    ds_read_b128 v[104:107], v23 offset:4096
    s_waitcnt lgkmcnt(9)
    v_mfma_f32_32x32x16_bf16 v[160:175], v[84:87], v[76:79], v[160:175]
    s_waitcnt lgkmcnt(8)
    v_mfma_f32_32x32x16_bf16 v[176:191], v[84:87], v[80:83], v[176:191]
    v_add_u32 v20, 0x14000, v20
    v_add_u32 v36, 0xc000, v36
    ds_read_b64_tr_b16 v[72:73], v36 offset:0
    ds_read_b64_tr_b16 v[74:75], v36 offset:512
    ds_read_b128 v[64:67], v20
    ds_read_b128 v[68:71], v20 offset:4096
    s_waitcnt lgkmcnt(9)
    v_mfma_f32_32x32x16_bf16 v[160:175], v[96:99], v[88:91], v[160:175]
    s_waitcnt lgkmcnt(8)
    v_mfma_f32_32x32x16_bf16 v[176:191], v[96:99], v[92:95], v[176:191]
    v_add_u32 v21, 0x14000, v21
    ds_read_b64_tr_b16 v[84:85], v36 offset:2048
    ds_read_b64_tr_b16 v[86:87], v36 offset:2560
    ds_read_b128 v[76:79], v21
    ds_read_b128 v[80:83], v21 offset:4096
    s_waitcnt lgkmcnt(9)
    v_mfma_f32_32x32x16_bf16 v[160:175], v[108:111], v[100:103], v[160:175]
    s_waitcnt lgkmcnt(8)
    v_mfma_f32_32x32x16_bf16 v[176:191], v[108:111], v[104:107], v[176:191]
    v_add_u32 v22, 0x14000, v22
    ds_read_b64_tr_b16 v[96:97], v36 offset:4096
    ds_read_b64_tr_b16 v[98:99], v36 offset:4608
    ds_read_b128 v[88:91], v22
    ds_read_b128 v[92:95], v22 offset:4096
    s_waitcnt lgkmcnt(9)
    v_mfma_f32_32x32x16_bf16 v[160:175], v[72:75], v[64:67], v[160:175]
    s_waitcnt lgkmcnt(8)
    v_mfma_f32_32x32x16_bf16 v[176:191], v[72:75], v[68:71], v[176:191]
    v_add_u32 v23, 0x14000, v23
    ds_read_b64_tr_b16 v[108:109], v36 offset:6144
    ds_read_b64_tr_b16 v[110:111], v36 offset:6656
    ds_read_b128 v[100:103], v23
    ds_read_b128 v[104:107], v23 offset:4096
    s_waitcnt lgkmcnt(9)
    v_mfma_f32_32x32x16_bf16 v[160:175], v[84:87], v[76:79], v[160:175]
    s_waitcnt lgkmcnt(8)
    v_mfma_f32_32x32x16_bf16 v[176:191], v[84:87], v[80:83], v[176:191]
    v_add_u32 v20, 0xffff6000, v20
    v_add_u32 v36, 0xffffe000, v36
    ds_read_b64_tr_b16 v[72:73], v36 offset:0
    ds_read_b64_tr_b16 v[74:75], v36 offset:512
    ds_read_b128 v[64:67], v20
    ds_read_b128 v[68:71], v20 offset:4096
    s_waitcnt lgkmcnt(9)
    v_mfma_f32_32x32x16_bf16 v[160:175], v[96:99], v[88:91], v[160:175]
    s_waitcnt lgkmcnt(8)
    v_mfma_f32_32x32x16_bf16 v[176:191], v[96:99], v[92:95], v[176:191]
    v_add_u32 v21, 0xffff6000, v21
    ds_read_b64_tr_b16 v[84:85], v36 offset:2048
    ds_read_b64_tr_b16 v[86:87], v36 offset:2560
    ds_read_b128 v[76:79], v21
    ds_read_b128 v[80:83], v21 offset:4096
    s_waitcnt lgkmcnt(9)
    v_mfma_f32_32x32x16_bf16 v[160:175], v[108:111], v[100:103], v[160:175]
    s_waitcnt lgkmcnt(8)
    v_mfma_f32_32x32x16_bf16 v[176:191], v[108:111], v[104:107], v[176:191]
    v_add_u32 v22, 0xffff6000, v22
    ds_read_b64_tr_b16 v[96:97], v36 offset:4096
    ds_read_b64_tr_b16 v[98:99], v36 offset:4608
    ds_read_b128 v[88:91], v22
    ds_read_b128 v[92:95], v22 offset:4096
    s_waitcnt lgkmcnt(9)
    v_mfma_f32_32x32x16_bf16 v[160:175], v[72:75], v[64:67], v[160:175]
    s_waitcnt lgkmcnt(8)
    v_mfma_f32_32x32x16_bf16 v[176:191], v[72:75], v[68:71], v[176:191]
    v_add_u32 v23, 0xffff6000, v23
    ds_read_b64_tr_b16 v[108:109], v36 offset:6144
    ds_read_b64_tr_b16 v[110:111], v36 offset:6656
    ds_read_b128 v[100:103], v23
    ds_read_b128 v[104:107], v23 offset:4096
    s_waitcnt lgkmcnt(9)
    v_mfma_f32_32x32x16_bf16 v[160:175], v[84:87], v[76:79], v[160:175]
    s_waitcnt lgkmcnt(8)
    v_mfma_f32_32x32x16_bf16 v[176:191], v[84:87], v[80:83], v[176:191]
    v_add_u32 v20, 0x18000, v20
    v_add_u32 v36, 0xffffe000, v36
    ds_read_b64_tr_b16 v[72:73], v36 offset:0
    ds_read_b64_tr_b16 v[74:75], v36 offset:512
    ds_read_b128 v[64:67], v20
    ds_read_b128 v[68:71], v20 offset:4096
    s_waitcnt lgkmcnt(9)
    v_mfma_f32_32x32x16_bf16 v[160:175], v[96:99], v[88:91], v[160:175]
    s_waitcnt lgkmcnt(8)
    v_mfma_f32_32x32x16_bf16 v[176:191], v[96:99], v[92:95], v[176:191]
    v_add_u32 v21, 0x18000, v21
    ds_read_b64_tr_b16 v[84:85], v36 offset:2048
    ds_read_b64_tr_b16 v[86:87], v36 offset:2560
    ds_read_b128 v[76:79], v21
    ds_read_b128 v[80:83], v21 offset:4096
    s_waitcnt lgkmcnt(9)
    v_mfma_f32_32x32x16_bf16 v[160:175], v[108:111], v[100:103], v[160:175]
    s_waitcnt lgkmcnt(8)
    v_mfma_f32_32x32x16_bf16 v[176:191], v[108:111], v[104:107], v[176:191]
    v_add_u32 v22, 0x18000, v22
    ds_read_b64_tr_b16 v[96:97], v36 offset:4096
    ds_read_b64_tr_b16 v[98:99], v36 offset:4608
    ds_read_b128 v[88:91], v22
    ds_read_b128 v[92:95], v22 offset:4096
    s_waitcnt lgkmcnt(9)
    v_mfma_f32_32x32x16_bf16 v[160:175], v[72:75], v[64:67], v[160:175]
    s_waitcnt lgkmcnt(8)
    v_mfma_f32_32x32x16_bf16 v[176:191], v[72:75], v[68:71], v[176:191]
    v_add_u32 v23, 0x18000, v23
    ds_read_b64_tr_b16 v[108:109], v36 offset:6144
    ds_read_b64_tr_b16 v[110:111], v36 offset:6656
    ds_read_b128 v[100:103], v23
    ds_read_b128 v[104:107], v23 offset:4096
    s_waitcnt lgkmcnt(9)
    v_mfma_f32_32x32x16_bf16 v[160:175], v[84:87], v[76:79], v[160:175]
    s_waitcnt lgkmcnt(8)
    v_mfma_f32_32x32x16_bf16 v[176:191], v[84:87], v[80:83], v[176:191]
    v_add_u32 v20, 0xffffc000, v20
    v_add_u32 v36, 0xffff6000, v36
    ds_read_b64_tr_b16 v[72:73], v36 offset:0
    ds_read_b64_tr_b16 v[74:75], v36 offset:512
    ds_read_b128 v[64:67], v20
    ds_read_b128 v[68:71], v20 offset:4096
    s_waitcnt lgkmcnt(9)
    v_mfma_f32_32x32x16_bf16 v[160:175], v[96:99], v[88:91], v[160:175]
    s_waitcnt lgkmcnt(8)
    v_mfma_f32_32x32x16_bf16 v[176:191], v[96:99], v[92:95], v[176:191]
    v_add_u32 v21, 0xffffc000, v21
    ds_read_b64_tr_b16 v[84:85], v36 offset:2048
    ds_read_b64_tr_b16 v[86:87], v36 offset:2560
    ds_read_b128 v[76:79], v21
    ds_read_b128 v[80:83], v21 offset:4096
    s_waitcnt lgkmcnt(9)
    v_mfma_f32_32x32x16_bf16 v[160:175], v[108:111], v[100:103], v[160:175]
    s_waitcnt lgkmcnt(8)
    v_mfma_f32_32x32x16_bf16 v[176:191], v[108:111], v[104:107], v[176:191]
    v_add_u32 v22, 0xffffc000, v22
    ds_read_b64_tr_b16 v[96:97], v36 offset:4096
    ds_read_b64_tr_b16 v[98:99], v36 offset:4608
    ds_read_b128 v[88:91], v22
    ds_read_b128 v[92:95], v22 offset:4096
    s_waitcnt lgkmcnt(9)
    v_mfma_f32_32x32x16_bf16 v[160:175], v[72:75], v[64:67], v[160:175]
    s_waitcnt lgkmcnt(8)
    v_mfma_f32_32x32x16_bf16 v[176:191], v[72:75], v[68:71], v[176:191]
    v_add_u32 v23, 0xffffc000, v23
    ds_read_b64_tr_b16 v[108:109], v36 offset:6144
    ds_read_b64_tr_b16 v[110:111], v36 offset:6656
    ds_read_b128 v[100:103], v23
    ds_read_b128 v[104:107], v23 offset:4096
    s_waitcnt lgkmcnt(9)
    v_mfma_f32_32x32x16_bf16 v[160:175], v[84:87], v[76:79], v[160:175]
    s_waitcnt lgkmcnt(8)
    v_mfma_f32_32x32x16_bf16 v[176:191], v[84:87], v[80:83], v[176:191]
    s_waitcnt lgkmcnt(5)
    v_mfma_f32_32x32x16_bf16 v[160:175], v[96:99], v[88:91], v[160:175]
    s_waitcnt lgkmcnt(4)
    v_mfma_f32_32x32x16_bf16 v[176:191], v[96:99], v[92:95], v[176:191]
    s_waitcnt lgkmcnt(1)
    v_mfma_f32_32x32x16_bf16 v[160:175], v[108:111], v[100:103], v[160:175]
    s_waitcnt lgkmcnt(0)
    v_mfma_f32_32x32x16_bf16 v[176:191], v[108:111], v[104:107], v[176:191]
    s_mov_b64 exec, 1
    ds_write_b32 v13, v15 offset:144
    s_mov_b64 exec, -1
    s_nop 6
    v_cvt_pk_bf16_f32 v64, v160, v161
    v_cvt_pk_bf16_f32 v65, v162, v163
    v_cvt_pk_bf16_f32 v66, v164, v165
    v_cvt_pk_bf16_f32 v67, v166, v167
    v_cvt_pk_bf16_f32 v68, v168, v169
    v_cvt_pk_bf16_f32 v69, v170, v171
    v_cvt_pk_bf16_f32 v70, v172, v173
    v_cvt_pk_bf16_f32 v71, v174, v175
    v_mfma_f32_32x32x16_bf16 v[160:175], v[40:43], v[64:67], 0
    s_nop 0
    v_mfma_f32_32x32x16_bf16 v[160:175], v[44:47], v[68:71], v[160:175]
    v_cvt_pk_bf16_f32 v72, v176, v177
    v_cvt_pk_bf16_f32 v73, v178, v179
    v_cvt_pk_bf16_f32 v74, v180, v181
    v_cvt_pk_bf16_f32 v75, v182, v183
    v_cvt_pk_bf16_f32 v76, v184, v185
    v_cvt_pk_bf16_f32 v77, v186, v187
    v_cvt_pk_bf16_f32 v78, v188, v189
    v_cvt_pk_bf16_f32 v79, v190, v191
    v_mfma_f32_32x32x16_bf16 v[176:191], v[40:43], v[72:75], 0
    s_nop 0
    v_mfma_f32_32x32x16_bf16 v[176:191], v[44:47], v[76:79], v[176:191]
    s_nop 0
    v_cvt_pk_bf16_f32 v64, v160, v161
    v_cvt_pk_bf16_f32 v65, v162, v163
    v_cvt_pk_bf16_f32 v66, v164, v165
    v_cvt_pk_bf16_f32 v67, v166, v167
    v_cvt_pk_bf16_f32 v68, v168, v169
    v_cvt_pk_bf16_f32 v69, v170, v171
    v_cvt_pk_bf16_f32 v70, v172, v173
    v_cvt_pk_bf16_f32 v71, v174, v175
    v_lshlrev_b32 v160, 16, v64
    v_and_b32 v161, 0xffff0000, v64
    v_lshlrev_b32 v162, 16, v65
    v_and_b32 v163, 0xffff0000, v65
    v_lshlrev_b32 v164, 16, v66
    v_and_b32 v165, 0xffff0000, v66
    v_lshlrev_b32 v166, 16, v67
    v_and_b32 v167, 0xffff0000, v67
    v_lshlrev_b32 v168, 16, v68
    v_and_b32 v169, 0xffff0000, v68
    v_lshlrev_b32 v170, 16, v69
    v_and_b32 v171, 0xffff0000, v69
    v_lshlrev_b32 v172, 16, v70
    v_and_b32 v173, 0xffff0000, v70
    v_lshlrev_b32 v174, 16, v71
    v_and_b32 v175, 0xffff0000, v71
    v_cvt_pk_bf16_f32 v72, v176, v177
    v_cvt_pk_bf16_f32 v73, v178, v179
    v_cvt_pk_bf16_f32 v74, v180, v181
    v_cvt_pk_bf16_f32 v75, v182, v183
    v_cvt_pk_bf16_f32 v76, v184, v185
    v_cvt_pk_bf16_f32 v77, v186, v187
    v_cvt_pk_bf16_f32 v78, v188, v189
    v_cvt_pk_bf16_f32 v79, v190, v191
    v_lshlrev_b32 v176, 16, v72
    v_and_b32 v177, 0xffff0000, v72
    v_lshlrev_b32 v178, 16, v73
    v_and_b32 v179, 0xffff0000, v73
    v_lshlrev_b32 v180, 16, v74
    v_and_b32 v181, 0xffff0000, v74
    v_lshlrev_b32 v182, 16, v75
    v_and_b32 v183, 0xffff0000, v75
    v_lshlrev_b32 v184, 16, v76
    v_and_b32 v185, 0xffff0000, v76
    v_lshlrev_b32 v186, 16, v77
    v_and_b32 v187, 0xffff0000, v77
    v_lshlrev_b32 v188, 16, v78
    v_and_b32 v189, 0xffff0000, v78
    v_lshlrev_b32 v190, 16, v79
    v_and_b32 v191, 0xffff0000, v79
    v_max3_f32 v24, v160, v161, v162
    v_max3_f32 v25, v163, v164, v165
    v_max3_f32 v26, v166, v167, v168
    v_max3_f32 v27, v169, v170, v171
    v_max3_f32 v28, v172, v173, v174
    v_max3_f32 v24, v24, v25, v175
    v_max3_f32 v26, v26, v27, v28
    v_max_f32 v24, v24, v26
    v_min3_f32 v30, v160, v161, v162
    v_min3_f32 v31, v163, v164, v165
    v_min3_f32 v32, v166, v167, v168
    v_min3_f32 v33, v169, v170, v171
    v_min3_f32 v34, v172, v173, v174
    v_min3_f32 v30, v30, v31, v175
    v_min3_f32 v32, v32, v33, v34
    v_min_f32 v30, v30, v32
    v_mov_b32 v25, v24
    v_mov_b32 v31, v30
    s_nop 0
    v_permlane32_swap_b32 v24, v25
    v_permlane32_swap_b32 v30, v31
    v_max_f32 v24, v24, v25
    v_min_f32 v30, v30, v31
    v_mul_f32 v24, s52, v24
    v_mul_f32 v30, s48, v30
    v_pk_fma_f32 v[192:193], v[160:161], s[48:49], v[24:25] op_sel_hi:[1,0,0]
    v_pk_fma_f32 v[224:225], v[160:161], s[52:53], v[30:31] op_sel_hi:[1,0,0]
    v_pk_fma_f32 v[194:195], v[162:163], s[48:49], v[24:25] op_sel_hi:[1,0,0]
    v_pk_fma_f32 v[226:227], v[162:163], s[52:53], v[30:31] op_sel_hi:[1,0,0]
    v_pk_fma_f32 v[196:197], v[164:165], s[48:49], v[24:25] op_sel_hi:[1,0,0]
    v_pk_fma_f32 v[228:229], v[164:165], s[52:53], v[30:31] op_sel_hi:[1,0,0]
    v_pk_fma_f32 v[198:199], v[166:167], s[48:49], v[24:25] op_sel_hi:[1,0,0]
    v_pk_fma_f32 v[230:231], v[166:167], s[52:53], v[30:31] op_sel_hi:[1,0,0]
    v_pk_fma_f32 v[200:201], v[168:169], s[48:49], v[24:25] op_sel_hi:[1,0,0]
    v_pk_fma_f32 v[232:233], v[168:169], s[52:53], v[30:31] op_sel_hi:[1,0,0]
    v_pk_fma_f32 v[202:203], v[170:171], s[48:49], v[24:25] op_sel_hi:[1,0,0]
    v_pk_fma_f32 v[234:235], v[170:171], s[52:53], v[30:31] op_sel_hi:[1,0,0]
    v_pk_fma_f32 v[204:205], v[172:173], s[48:49], v[24:25] op_sel_hi:[1,0,0]
    v_pk_fma_f32 v[236:237], v[172:173], s[52:53], v[30:31] op_sel_hi:[1,0,0]
    v_pk_fma_f32 v[206:207], v[174:175], s[48:49], v[24:25] op_sel_hi:[1,0,0]
    v_pk_fma_f32 v[238:239], v[174:175], s[52:53], v[30:31] op_sel_hi:[1,0,0]
    v_exp_f32 v192, v192
    v_exp_f32 v224, v224
    v_exp_f32 v193, v193
    v_exp_f32 v225, v225
    v_exp_f32 v194, v194
    v_exp_f32 v226, v226
    v_exp_f32 v195, v195
    v_exp_f32 v227, v227
    v_exp_f32 v196, v196
    v_exp_f32 v228, v228
    v_exp_f32 v197, v197
    v_exp_f32 v229, v229
    v_exp_f32 v198, v198
    v_exp_f32 v230, v230
    v_exp_f32 v199, v199
    v_exp_f32 v231, v231
    v_exp_f32 v200, v200
    v_exp_f32 v232, v232
    v_exp_f32 v201, v201
    v_exp_f32 v233, v233
    v_exp_f32 v202, v202
    v_exp_f32 v234, v234
    v_exp_f32 v203, v203
    v_exp_f32 v235, v235
    v_exp_f32 v204, v204
    v_exp_f32 v236, v236
    v_exp_f32 v205, v205
    v_exp_f32 v237, v237
    v_exp_f32 v206, v206
    v_exp_f32 v238, v238
    v_exp_f32 v207, v207
    v_exp_f32 v239, v239
    v_pk_add_f32 v[24:25], v[192:193], v[194:195]
    v_pk_add_f32 v[26:27], v[196:197], v[198:199]
    v_pk_add_f32 v[28:29], v[200:201], v[202:203]
    v_pk_add_f32 v[30:31], v[224:225], v[226:227]
    v_pk_add_f32 v[32:33], v[228:229], v[230:231]
    v_pk_add_f32 v[34:35], v[232:233], v[234:235]
    v_pk_add_f32 v[24:25], v[24:25], v[204:205]
    v_pk_add_f32 v[26:27], v[26:27], v[206:207]
    v_pk_add_f32 v[30:31], v[30:31], v[236:237]
    v_pk_add_f32 v[32:33], v[32:33], v[238:239]
    v_pk_add_f32 v[24:25], v[24:25], v[28:29]
    v_pk_add_f32 v[30:31], v[30:31], v[34:35]
    v_pk_add_f32 v[24:25], v[24:25], v[26:27]
    v_pk_add_f32 v[30:31], v[30:31], v[32:33]
    v_add_f32 v24, v24, v25
    v_add_f32 v30, v30, v31
    v_mov_b32 v25, v24
    v_mov_b32 v31, v30
    s_nop 0
    v_permlane32_swap_b32 v24, v25
    v_permlane32_swap_b32 v30, v31
    v_add_f32 v24, v24, v25
    v_add_f32 v30, v30, v31
    v_rcp_f32 v24, v24
    v_rcp_f32 v30, v30
    v_pk_mul_f32 v[192:193], v[192:193], v[24:25] op_sel_hi:[1,0]
    v_pk_mul_f32 v[224:225], v[224:225], v[30:31] op_sel_hi:[1,0]
    v_pk_mul_f32 v[194:195], v[194:195], v[24:25] op_sel_hi:[1,0]
    v_pk_mul_f32 v[226:227], v[226:227], v[30:31] op_sel_hi:[1,0]
    v_pk_mul_f32 v[196:197], v[196:197], v[24:25] op_sel_hi:[1,0]
    v_pk_mul_f32 v[228:229], v[228:229], v[30:31] op_sel_hi:[1,0]
    v_pk_mul_f32 v[198:199], v[198:199], v[24:25] op_sel_hi:[1,0]
    v_pk_mul_f32 v[230:231], v[230:231], v[30:31] op_sel_hi:[1,0]
    v_pk_mul_f32 v[200:201], v[200:201], v[24:25] op_sel_hi:[1,0]
    v_pk_mul_f32 v[232:233], v[232:233], v[30:31] op_sel_hi:[1,0]
    v_pk_mul_f32 v[202:203], v[202:203], v[24:25] op_sel_hi:[1,0]
    v_pk_mul_f32 v[234:235], v[234:235], v[30:31] op_sel_hi:[1,0]
    v_pk_mul_f32 v[204:205], v[204:205], v[24:25] op_sel_hi:[1,0]
    v_pk_mul_f32 v[236:237], v[236:237], v[30:31] op_sel_hi:[1,0]
    v_pk_mul_f32 v[206:207], v[206:207], v[24:25] op_sel_hi:[1,0]
    v_pk_mul_f32 v[238:239], v[238:239], v[30:31] op_sel_hi:[1,0]
    v_cvt_pk_bf16_f32 v80, v192, v193
    v_cvt_pk_bf16_f32 v88, v224, v225
    v_cvt_pk_bf16_f32 v81, v194, v195
    v_cvt_pk_bf16_f32 v89, v226, v227
    v_cvt_pk_bf16_f32 v82, v196, v197
    v_cvt_pk_bf16_f32 v90, v228, v229
    v_cvt_pk_bf16_f32 v83, v198, v199
    v_cvt_pk_bf16_f32 v91, v230, v231
    v_cvt_pk_bf16_f32 v84, v200, v201
    v_cvt_pk_bf16_f32 v92, v232, v233
    v_cvt_pk_bf16_f32 v85, v202, v203
    v_cvt_pk_bf16_f32 v93, v234, v235
    v_cvt_pk_bf16_f32 v86, v204, v205
    v_cvt_pk_bf16_f32 v94, v236, v237
    v_cvt_pk_bf16_f32 v87, v206, v207
    v_cvt_pk_bf16_f32 v95, v238, v239
    v_max3_f32 v24, v176, v177, v178
    v_max3_f32 v25, v179, v180, v181
    v_max3_f32 v26, v182, v183, v184
    v_max3_f32 v27, v185, v186, v187
    v_max3_f32 v28, v188, v189, v190
    v_max3_f32 v24, v24, v25, v191
    v_max3_f32 v26, v26, v27, v28
    v_max_f32 v24, v24, v26
    v_min3_f32 v30, v176, v177, v178
    v_min3_f32 v31, v179, v180, v181
    v_min3_f32 v32, v182, v183, v184
    v_min3_f32 v33, v185, v186, v187
    v_min3_f32 v34, v188, v189, v190
    v_min3_f32 v30, v30, v31, v191
    v_min3_f32 v32, v32, v33, v34
    v_min_f32 v30, v30, v32
    v_mov_b32 v25, v24
    v_mov_b32 v31, v30
    s_nop 0
    v_permlane32_swap_b32 v24, v25
    v_permlane32_swap_b32 v30, v31
    v_max_f32 v24, v24, v25
    v_min_f32 v30, v30, v31
    v_mul_f32 v24, s52, v24
    v_mul_f32 v30, s48, v30
    v_pk_fma_f32 v[208:209], v[176:177], s[48:49], v[24:25] op_sel_hi:[1,0,0]
    v_pk_fma_f32 v[240:241], v[176:177], s[52:53], v[30:31] op_sel_hi:[1,0,0]
    v_pk_fma_f32 v[210:211], v[178:179], s[48:49], v[24:25] op_sel_hi:[1,0,0]
    v_pk_fma_f32 v[242:243], v[178:179], s[52:53], v[30:31] op_sel_hi:[1,0,0]
    v_pk_fma_f32 v[212:213], v[180:181], s[48:49], v[24:25] op_sel_hi:[1,0,0]
    v_pk_fma_f32 v[244:245], v[180:181], s[52:53], v[30:31] op_sel_hi:[1,0,0]
    v_pk_fma_f32 v[214:215], v[182:183], s[48:49], v[24:25] op_sel_hi:[1,0,0]
    v_pk_fma_f32 v[246:247], v[182:183], s[52:53], v[30:31] op_sel_hi:[1,0,0]
    v_pk_fma_f32 v[216:217], v[184:185], s[48:49], v[24:25] op_sel_hi:[1,0,0]
    v_pk_fma_f32 v[248:249], v[184:185], s[52:53], v[30:31] op_sel_hi:[1,0,0]
    v_pk_fma_f32 v[218:219], v[186:187], s[48:49], v[24:25] op_sel_hi:[1,0,0]
    v_pk_fma_f32 v[250:251], v[186:187], s[52:53], v[30:31] op_sel_hi:[1,0,0]
    v_pk_fma_f32 v[220:221], v[188:189], s[48:49], v[24:25] op_sel_hi:[1,0,0]
    v_pk_fma_f32 v[252:253], v[188:189], s[52:53], v[30:31] op_sel_hi:[1,0,0]
    v_pk_fma_f32 v[222:223], v[190:191], s[48:49], v[24:25] op_sel_hi:[1,0,0]
    v_pk_fma_f32 v[254:255], v[190:191], s[52:53], v[30:31] op_sel_hi:[1,0,0]
    v_exp_f32 v208, v208
    v_exp_f32 v240, v240
    v_exp_f32 v209, v209
    v_exp_f32 v241, v241
    v_exp_f32 v210, v210
    v_exp_f32 v242, v242
    v_exp_f32 v211, v211
    v_exp_f32 v243, v243
    v_exp_f32 v212, v212
    v_exp_f32 v244, v244
    v_exp_f32 v213, v213
    v_exp_f32 v245, v245
    v_exp_f32 v214, v214
    v_exp_f32 v246, v246
    v_exp_f32 v215, v215
    v_exp_f32 v247, v247
    v_exp_f32 v216, v216
    v_exp_f32 v248, v248
    v_exp_f32 v217, v217
    v_exp_f32 v249, v249
    v_exp_f32 v218, v218
    v_exp_f32 v250, v250
    v_exp_f32 v219, v219
    v_exp_f32 v251, v251
    v_exp_f32 v220, v220
    v_exp_f32 v252, v252
    v_exp_f32 v221, v221
    v_exp_f32 v253, v253
    v_exp_f32 v222, v222
    v_exp_f32 v254, v254
    v_exp_f32 v223, v223
    v_exp_f32 v255, v255
    v_pk_add_f32 v[24:25], v[208:209], v[210:211]
    v_pk_add_f32 v[26:27], v[212:213], v[214:215]
    v_pk_add_f32 v[28:29], v[216:217], v[218:219]
    v_pk_add_f32 v[30:31], v[240:241], v[242:243]
    v_pk_add_f32 v[32:33], v[244:245], v[246:247]
    v_pk_add_f32 v[34:35], v[248:249], v[250:251]
    v_pk_add_f32 v[24:25], v[24:25], v[220:221]
    v_pk_add_f32 v[26:27], v[26:27], v[222:223]
    v_pk_add_f32 v[30:31], v[30:31], v[252:253]
    v_pk_add_f32 v[32:33], v[32:33], v[254:255]
    v_pk_add_f32 v[24:25], v[24:25], v[28:29]
    v_pk_add_f32 v[30:31], v[30:31], v[34:35]
    v_pk_add_f32 v[24:25], v[24:25], v[26:27]
    v_pk_add_f32 v[30:31], v[30:31], v[32:33]
    v_add_f32 v24, v24, v25
    v_add_f32 v30, v30, v31
    v_mov_b32 v25, v24
    v_mov_b32 v31, v30
    s_nop 0
    v_permlane32_swap_b32 v24, v25
    v_permlane32_swap_b32 v30, v31
    v_add_f32 v24, v24, v25
    v_add_f32 v30, v30, v31
    v_rcp_f32 v24, v24
    v_rcp_f32 v30, v30
    v_pk_mul_f32 v[208:209], v[208:209], v[24:25] op_sel_hi:[1,0]
    v_pk_mul_f32 v[240:241], v[240:241], v[30:31] op_sel_hi:[1,0]
    v_pk_mul_f32 v[210:211], v[210:211], v[24:25] op_sel_hi:[1,0]
    v_pk_mul_f32 v[242:243], v[242:243], v[30:31] op_sel_hi:[1,0]
    v_pk_mul_f32 v[212:213], v[212:213], v[24:25] op_sel_hi:[1,0]
    v_pk_mul_f32 v[244:245], v[244:245], v[30:31] op_sel_hi:[1,0]
    v_pk_mul_f32 v[214:215], v[214:215], v[24:25] op_sel_hi:[1,0]
    v_pk_mul_f32 v[246:247], v[246:247], v[30:31] op_sel_hi:[1,0]
    v_pk_mul_f32 v[216:217], v[216:217], v[24:25] op_sel_hi:[1,0]
    v_pk_mul_f32 v[248:249], v[248:249], v[30:31] op_sel_hi:[1,0]
    v_pk_mul_f32 v[218:219], v[218:219], v[24:25] op_sel_hi:[1,0]
    v_pk_mul_f32 v[250:251], v[250:251], v[30:31] op_sel_hi:[1,0]
    v_pk_mul_f32 v[220:221], v[220:221], v[24:25] op_sel_hi:[1,0]
    v_pk_mul_f32 v[252:253], v[252:253], v[30:31] op_sel_hi:[1,0]
    v_pk_mul_f32 v[222:223], v[222:223], v[24:25] op_sel_hi:[1,0]
    v_pk_mul_f32 v[254:255], v[254:255], v[30:31] op_sel_hi:[1,0]
    v_cvt_pk_bf16_f32 v96, v208, v209
    v_cvt_pk_bf16_f32 v104, v240, v241
    v_cvt_pk_bf16_f32 v97, v210, v211
    v_cvt_pk_bf16_f32 v105, v242, v243
    v_cvt_pk_bf16_f32 v98, v212, v213
    v_cvt_pk_bf16_f32 v106, v244, v245
    v_cvt_pk_bf16_f32 v99, v214, v215
    v_cvt_pk_bf16_f32 v107, v246, v247
    v_cvt_pk_bf16_f32 v100, v216, v217
    v_cvt_pk_bf16_f32 v108, v248, v249
    v_cvt_pk_bf16_f32 v101, v218, v219
    v_cvt_pk_bf16_f32 v109, v250, v251
    v_cvt_pk_bf16_f32 v102, v220, v221
    v_cvt_pk_bf16_f32 v110, v252, v253
    v_cvt_pk_bf16_f32 v103, v222, v223
    v_cvt_pk_bf16_f32 v111, v254, v255
    s_lshl_b32 s12, s19, 1
    s_add_u32 s23, s12, s22
    s_lshl_b32 s12, s23, 12
    s_add_u32 s43, s12, 32768
    s_lshl_b32 s14, s23, 10
    s_add_u32 s46, s14, 163840
    v_lshlrev_b32 v52, 7, v3
    v_lshrrev_b32 v53, 2, v4
    v_lshlrev_b32 v53, 7, v53
    s_lshl_b32 s40, s18, 1
    s_add_u32 s40, s40, s21
    s_lshl_b32 s41, s40, 6
    s_add_u32 s41, s41, s23
    s_lshl_b32 s41, s41, 11
    s_add_u32 s41, s41, 8388608
    s_add_u32 s42, s41, 65536
    s_lshl_b32 s12, s18, 10
    s_lshl_b32 s40, s21, 5
    s_add_u32 s40, s40, s12
    s_add_u32 s40, s40, s23
    s_lshl_b32 s40, s40, 2
    s_add_u32 s40, s40, 524288
    s_sub_u32 s21, s72, 1
    s_mov_b32 s22, s73
    s_mov_b32 s23, s74
    s_lshl_b32 s40, s18, 1
    s_lshr_b32 s12, s20, 1
    s_add_u32 s40, s40, s12
    s_lshl_b32 s40, s40, 5
    s_lshl_b32 s12, s19, 1
    s_add_u32 s40, s40, s12
    s_and_b32 s12, s20, 1
    s_add_u32 s40, s40, s12
    s_lshl_b32 s40, s40, 7
    s_add_u32 s40, s40, 6291456
    s_and_b32 s88, s16, 1
    s_lshl_b32 s88, s88, 3
    s_lshr_b32 s89, s16, 1
    s_lshl_b32 s89, s89, 1
    s_add_u32 s88, s88, s89
    s_lshr_b32 s89, s17, 4
    s_add_u32 s88, s88, s89
    s_and_b32 s89, s17, 15
    s_mov_b32 s68, s58
    s_and_b32 s69, s59, 0xffff
    s_mov_b32 s70, 4194304
    s_mov_b32 s71, 0x00020000
    s_and_b32 s90, s20, 3
    s_lshr_b32 s91, s20, 2
    s_lshl_b32 s12, s88, 3
    s_lshl_b32 s13, s90, 1
    s_add_u32 s12, s12, s13
    s_add_u32 s92, s12, s91
    s_lshl_b32 s12, s92, 4
    v_and_b32 v3, 15, v2
    v_add_u32 v6, s12, v3
    v_lshlrev_b32 v8, 2, v6
    v_bfe_u32 v9, v2, 4, 1
    v_lshrrev_b32 v10, 5, v2
    v_lshlrev_b32 v7, 11, v6
    v_lshl_add_u32 v7, v9, 6, v7
    v_lshl_add_u32 v7, v10, 4, v7
    s_lshl_b32 s12, s89, 7
    v_add_u32 v7, s12, v7
    s_mov_b32 s12, 4096
    buffer_load_dwordx4 v[24:27], v7, s[24:27], 0 offen
    buffer_load_dwordx4 v[28:31], v7, s[24:27], 0 offen offset:32
    buffer_load_dword v48, v8, s[32:35], s12 offen sc1
    v_lshlrev_b32 v22, 8, v3
    v_lshl_add_u32 v22, v9, 7, v22
    v_lshl_add_u32 v22, v10, 5, v22
    v_lshlrev_b32 v10, 9, v10
    v_bfe_u32 v11, v2, 2, 2
    v_lshl_add_u32 v10, v11, 7, v10
    v_bfe_u32 v11, v2, 3, 1
    v_lshl_add_u32 v10, v11, 6, v10
    v_lshl_add_u32 v10, v9, 5, v10
    v_and_b32 v11, 3, v2
    v_lshl_add_u32 v10, v11, 3, v10
    v_xor_b32 v11, 64, v10
    s_lshl_b32 s12, s91, 8
    v_xor_b32 v17, s12, v5
    v_lshlrev_b32 v8, 2, v3
    s_lshl_b32 s12, s20, 12
    s_mov_b32 s15, 32768
    s_cmp_lt_u32 s20, 6
    s_cselect_b32 s13, s15, 131072
    s_add_u32 s12, s12, s13
    v_add_u32 v20, s12, v5
    s_xor_b32 s14, s20, 4
    s_lshl_b32 s12, s14, 12
    s_cmp_lt_u32 s14, 6
    s_cselect_b32 s13, s15, 131072
    s_add_u32 s12, s12, s13
    v_add_u32 v21, s12, v5
    s_lshl_b32 s12, s88, 2
    s_add_u32 s12, s12, s90
    s_lshl_b32 s13, s12, 16
    s_lshl_b32 s14, s91, 15
    s_add_u32 s13, s13, s14
    s_add_u32 s95, s13, 8388608
    s_lshl_b32 s12, s88, 12
    s_lshl_b32 s13, s89, 8
    s_mul_i32 s13, s13, 1
    s_add_u32 s12, s12, s13
    s_lshr_b32 s13, s90, 1
    s_lshl_b32 s13, s13, 7
    s_add_u32 s12, s12, s13
    s_lshl_b32 s13, s91, 6
    s_add_u32 s12, s12, s13
    s_add_u32 s15, s12, 524288
    s_lshl_b32 s97, s91, 4
    v_lshlrev_b32 v8, 7, v3
    s_lshl_b32 s12, s88, 1
    s_lshr_b32 s13, s90, 1
    s_add_u32 s12, s12, s13
    s_lshl_b32 s12, s12, 12
    s_lshl_b32 s13, s91, 11
    s_add_u32 s12, s12, s13
    s_and_b32 s13, s89, 0
    s_lshl_b32 s13, s13, 17
    s_add_u32 s12, s12, s13
    s_add_u32 s15, s12, 6291456
    s_mov_b32 s93, s89
    s_waitcnt vmcnt(0)
    v_sub_f32 v50, 1.0, v48
    v_cvt_pk_bf16_f32 v50, v50, v50
    v_lshlrev_b32 v50, 16, v50
    v_lshlrev_b32 v32, 16, v24
    v_and_b32 v33, 0xffff0000, v24
    v_lshlrev_b32 v34, 16, v25
    v_and_b32 v35, 0xffff0000, v25
    v_lshlrev_b32 v36, 16, v26
    v_and_b32 v37, 0xffff0000, v26
    v_lshlrev_b32 v38, 16, v27
    v_and_b32 v39, 0xffff0000, v27
    v_lshlrev_b32 v40, 16, v28
    v_and_b32 v41, 0xffff0000, v28
    v_lshlrev_b32 v42, 16, v29
    v_and_b32 v43, 0xffff0000, v29
    v_lshlrev_b32 v44, 16, v30
    v_and_b32 v45, 0xffff0000, v30
    v_lshlrev_b32 v46, 16, v31
    v_and_b32 v47, 0xffff0000, v31
    v_pk_mul_f32 v[32:33], v[32:33], v[50:51] op_sel_hi:[1,0]
    v_pk_mul_f32 v[34:35], v[34:35], v[50:51] op_sel_hi:[1,0]
    v_pk_mul_f32 v[36:37], v[36:37], v[50:51] op_sel_hi:[1,0]
    v_pk_mul_f32 v[38:39], v[38:39], v[50:51] op_sel_hi:[1,0]
    v_pk_mul_f32 v[40:41], v[40:41], v[50:51] op_sel_hi:[1,0]
    v_pk_mul_f32 v[42:43], v[42:43], v[50:51] op_sel_hi:[1,0]
    v_pk_mul_f32 v[44:45], v[44:45], v[50:51] op_sel_hi:[1,0]
    v_pk_mul_f32 v[46:47], v[46:47], v[50:51] op_sel_hi:[1,0]
    v_cvt_pk_bf16_f32 v33, v32, v33
    v_cvt_pk_bf16_f32 v35, v34, v35
    v_cvt_pk_bf16_f32 v37, v36, v37
    v_cvt_pk_bf16_f32 v39, v38, v39
    v_cvt_pk_bf16_f32 v41, v40, v41
    v_cvt_pk_bf16_f32 v43, v42, v43
    v_cvt_pk_bf16_f32 v45, v44, v45
    v_cvt_pk_bf16_f32 v47, v46, v47
    v_lshlrev_b32 v32, 16, v33
    v_and_b32 v33, 0xffff0000, v33
    v_lshlrev_b32 v34, 16, v35
    v_and_b32 v35, 0xffff0000, v35
    v_lshlrev_b32 v36, 16, v37
    v_and_b32 v37, 0xffff0000, v37
    v_lshlrev_b32 v38, 16, v39
    v_and_b32 v39, 0xffff0000, v39
    v_lshlrev_b32 v40, 16, v41
    v_and_b32 v41, 0xffff0000, v41
    v_lshlrev_b32 v42, 16, v43
    v_and_b32 v43, 0xffff0000, v43
    v_lshlrev_b32 v44, 16, v45
    v_and_b32 v45, 0xffff0000, v45
    v_lshlrev_b32 v46, 16, v47
    v_and_b32 v47, 0xffff0000, v47
    s_mov_b32 s13, 0
    v_mov_b32 v54, 162896
L_c_kz:
    ds_read_b32 v55, v54
    s_add_u32 s13, s13, 1
    s_cmp_ge_u32 s13, 262144
    s_cbranch_scc1 L_c_kzok
    s_waitcnt lgkmcnt(0)
    v_cmp_eq_u32 vcc, 1, v55
    s_cbranch_vccz L_c_kz
L_c_kzok:
    s_mov_b32 s13, 0
L_c_kv:
    buffer_load_dwordx4 v[112:115], v5, s[32:35], s43 offen offset:0 sc1
    buffer_load_dwordx4 v[116:119], v5, s[32:35], s43 offen offset:1024 sc1
    buffer_load_dwordx4 v[120:123], v5, s[32:35], s43 offen offset:2048 sc1
    buffer_load_dwordx4 v[124:127], v5, s[32:35], s43 offen offset:3072 sc1
    buffer_load_dwordx4 v[128:131], v52, s[32:35], s46 offen offset:0 sc1
    buffer_load_dwordx4 v[132:135], v52, s[32:35], s46 offen offset:256 sc1
    buffer_load_dwordx4 v[136:139], v52, s[32:35], s46 offen offset:512 sc1
    buffer_load_dwordx4 v[140:143], v52, s[32:35], s46 offen offset:768 sc1
    s_add_u32 s13, s13, 1
    s_waitcnt vmcnt(0)
    v_max3_u32 v55, v112, v113, v114
    v_max3_u32 v55, v55, v115, v116
    v_max3_u32 v55, v55, v117, v118
    v_max3_u32 v55, v55, v119, v120
    v_max3_u32 v55, v55, v121, v122
    v_max3_u32 v55, v55, v123, v124
    v_max3_u32 v55, v55, v125, v126
    v_max3_u32 v55, v55, v127, v128
    v_max3_u32 v55, v55, v129, v130
    v_max3_u32 v55, v55, v131, v132
    v_max3_u32 v55, v55, v133, v134
    v_max3_u32 v55, v55, v135, v136
    v_max3_u32 v55, v55, v137, v138
    v_max3_u32 v55, v55, v139, v140
    v_max3_u32 v55, v55, v141, v142
    v_max_u32 v55, v55, v143
    v_cmp_eq_u32 vcc, -1, v55
    s_cbranch_vccz L_c_kvok
    s_cmp_lt_u32 s13, 16384
    s_cbranch_scc1 L_c_kv
L_c_kvok:
    v_mfma_f32_32x32x16_bf16 v[192:207], v[128:131], v[80:83], 0
    v_mfma_f32_32x32x16_bf16 v[192:207], v[132:135], v[84:87], v[192:207]
    v_mfma_f32_32x32x16_bf16 v[192:207], v[136:139], v[88:91], v[192:207]
    v_mfma_f32_32x32x16_bf16 v[192:207], v[140:143], v[92:95], v[192:207]
    v_mfma_f32_32x32x16_bf16 v[160:175], v[112:115], v[80:83], 0
    s_mov_b32 s45, 0
    s_lshr_b32 s12, s21, 4
    s_cmp_eq_u32 s12, s92
    s_cselect_b32 s46, 1, 0
    s_mov_b32 s45, 1
    v_mfma_f32_32x32x16_bf16 v[160:175], v[116:119], v[84:87], v[160:175]
    v_mov_b32 v56, s23
    v_mov_b32 v57, s23
    v_mov_b32 v58, s23
    v_mov_b32 v59, s23
    v_mfma_f32_32x32x16_bf16 v[160:175], v[120:123], v[88:91], v[160:175]
    v_lshrrev_b32 v60, 3, v2
    v_lshlrev_b32 v60, 17, v60
    v_and_b32 v61, 0x70, v5
    v_add_u32 v60, v60, v61
    v_mfma_f32_32x32x16_bf16 v[160:175], v[124:127], v[92:95], v[160:175]
    v_cvt_pk_bf16_f32 v54, 0, v192
    v_add_f32 v54, 0x358637bd, v54
    v_cvt_pk_bf16_f32 v54, 0, v54
    v_rcp_f32 v54, v54
    v_mfma_f32_32x32x16_bf16 v[208:223], v[128:131], v[96:99], 0
    s_nop 6
    v_cvt_pk_bf16_f32 v160, 0, v160
    v_cvt_pk_bf16_f32 v161, 0, v161
    v_cvt_pk_bf16_f32 v162, 0, v162
    v_cvt_pk_bf16_f32 v163, 0, v163
    v_cvt_pk_bf16_f32 v164, 0, v164
    v_mfma_f32_32x32x16_bf16 v[208:223], v[132:135], v[100:103], v[208:223]
    v_cvt_pk_bf16_f32 v165, 0, v165
    v_cvt_pk_bf16_f32 v166, 0, v166
    v_cvt_pk_bf16_f32 v167, 0, v167
    v_cvt_pk_bf16_f32 v168, 0, v168
    v_cvt_pk_bf16_f32 v169, 0, v169
    v_mfma_f32_32x32x16_bf16 v[208:223], v[136:139], v[104:107], v[208:223]
    v_cvt_pk_bf16_f32 v170, 0, v170
    v_cvt_pk_bf16_f32 v171, 0, v171
    v_cvt_pk_bf16_f32 v172, 0, v172
    v_cvt_pk_bf16_f32 v173, 0, v173
    v_cvt_pk_bf16_f32 v174, 0, v174
    v_mfma_f32_32x32x16_bf16 v[208:223], v[140:143], v[108:111], v[208:223]
    v_cvt_pk_bf16_f32 v175, 0, v175
    v_mul_f32 v160, v160, v54
    v_mul_f32 v161, v161, v54
    v_mul_f32 v162, v162, v54
    v_mul_f32 v163, v163, v54
    v_mfma_f32_32x32x16_bf16 v[176:191], v[112:115], v[96:99], 0
    v_mul_f32 v164, v164, v54
    v_mul_f32 v165, v165, v54
    v_mul_f32 v166, v166, v54
    v_mul_f32 v167, v167, v54
    v_mul_f32 v168, v168, v54
    v_mfma_f32_32x32x16_bf16 v[176:191], v[116:119], v[100:103], v[176:191]
    v_mul_f32 v169, v169, v54
    v_mul_f32 v170, v170, v54
    v_mul_f32 v171, v171, v54
    v_mul_f32 v172, v172, v54
    v_mul_f32 v173, v173, v54
    v_mfma_f32_32x32x16_bf16 v[176:191], v[120:123], v[104:107], v[176:191]
    v_mul_f32 v174, v174, v54
    v_mul_f32 v175, v175, v54
    v_cvt_pk_bf16_f32 v64, v160, v161
    v_cvt_pk_bf16_f32 v65, v162, v163
    v_cvt_pk_bf16_f32 v66, v164, v165
    v_mfma_f32_32x32x16_bf16 v[176:191], v[124:127], v[108:111], v[176:191]
    v_cvt_pk_bf16_f32 v67, v166, v167
    buffer_store_dwordx4 v[64:67], v5, s[32:35], s41 offen sc1
    v_cvt_pk_bf16_f32 v68, v168, v169
    v_cvt_pk_bf16_f32 v69, v170, v171
    v_cvt_pk_bf16_f32 v70, v172, v173
    v_cvt_pk_bf16_f32 v71, v174, v175
    buffer_store_dwordx4 v[68:71], v5, s[32:35], s41 offen offset:1024 sc1
    v_cvt_pk_bf16_f32 v62, 0, v208
    v_add_f32 v62, 0x358637bd, v62
    v_cvt_pk_bf16_f32 v62, 0, v62
    v_rcp_f32 v62, v62
    s_nop 0
    v_cvt_pk_bf16_f32 v176, 0, v176
    v_cvt_pk_bf16_f32 v177, 0, v177
    v_cvt_pk_bf16_f32 v178, 0, v178
    v_cvt_pk_bf16_f32 v179, 0, v179
    v_cvt_pk_bf16_f32 v180, 0, v180
    v_cvt_pk_bf16_f32 v181, 0, v181
    v_cvt_pk_bf16_f32 v182, 0, v182
    v_cvt_pk_bf16_f32 v183, 0, v183
    v_pk_mul_f32 v[176:177], v[176:177], v[62:63] op_sel_hi:[1,0]
    v_pk_mul_f32 v[178:179], v[178:179], v[62:63] op_sel_hi:[1,0]
    v_pk_mul_f32 v[180:181], v[180:181], v[62:63] op_sel_hi:[1,0]
    v_pk_mul_f32 v[182:183], v[182:183], v[62:63] op_sel_hi:[1,0]
    v_cvt_pk_bf16_f32 v72, v176, v177
    v_cvt_pk_bf16_f32 v73, v178, v179
    v_cvt_pk_bf16_f32 v74, v180, v181
    v_cvt_pk_bf16_f32 v75, v182, v183
    buffer_store_dwordx4 v[72:75], v5, s[32:35], s42 offen sc1
    v_cvt_pk_bf16_f32 v184, 0, v184
    v_cvt_pk_bf16_f32 v185, 0, v185
    v_cvt_pk_bf16_f32 v186, 0, v186
    v_cvt_pk_bf16_f32 v187, 0, v187
    v_cvt_pk_bf16_f32 v188, 0, v188
    v_cvt_pk_bf16_f32 v189, 0, v189
    v_cvt_pk_bf16_f32 v190, 0, v190
    v_cvt_pk_bf16_f32 v191, 0, v191
    v_pk_mul_f32 v[184:185], v[184:185], v[62:63] op_sel_hi:[1,0]
    v_pk_mul_f32 v[186:187], v[186:187], v[62:63] op_sel_hi:[1,0]
    v_pk_mul_f32 v[188:189], v[188:189], v[62:63] op_sel_hi:[1,0]
    v_pk_mul_f32 v[190:191], v[190:191], v[62:63] op_sel_hi:[1,0]
    v_cvt_pk_bf16_f32 v76, v184, v185
    v_cvt_pk_bf16_f32 v77, v186, v187
    v_cvt_pk_bf16_f32 v78, v188, v189
    v_cvt_pk_bf16_f32 v79, v190, v191
    buffer_store_dwordx4 v[76:79], v5, s[32:35], s42 offen offset:1024 sc1
    s_waitcnt vmcnt(0)
    s_mov_b32 exec_lo, 0xff
    s_mov_b32 exec_hi, 0
    buffer_store_dwordx4 v[56:59], v60, s[32:35], s40 offen sc1
    s_mov_b64 exec, -1
L_phaseb:
    s_setprio 0
    s_nop 4
L_own_r0:
    s_nop 0
    s_barrier
    s_mov_b32 s14, 0xffff0000
    s_mov_b32 s47, 0
    s_mov_b32 s96, 0
    s_cmp_lg_u32 s96, 0
    s_cbranch_scc1 L_pk0
L_pl0:
    buffer_load_dword v52, v8, s[32:35], s15 offen sc1
    s_add_u32 s47, s47, 1
    s_cmp_ge_u32 s47, 16384
    s_cselect_b32 s12, -1, 0
    s_waitcnt vmcnt(0)
    v_cmp_eq_u32 vcc, s23, v52
    s_nop 1
    s_or_b32 s12, s12, vcc_lo
    s_lshr_b32 s12, s12, s93
    s_or_b32 s96, s96, s12
    s_andn2_b32 s96, s96, s14
    s_cbranch_scc0 L_pl0
L_pk0:
    s_ff1_i32_b32 s12, s96
    s_bitset0_b32 s96, s12
    s_bitset1_b32 s14, s12
    s_add_u32 s12, s12, s93
    s_and_b32 s80, s12, 15
    s_lshl_b32 s94, s80, 11
    s_add_u32 s94, s94, s95
    buffer_load_dwordx4 v[96:99], v17, s[32:35], s94 offen
    buffer_load_dwordx4 v[100:103], v17, s[32:35], s94 offen offset:1024
    s_add_u32 s12, s80, s97
    s_lshl_b32 s13, s12, 12
    s_cmp_ge_u32 s12, 8
    s_cselect_b32 s12, 24576, 0
    s_add_u32 s13, s13, s12
    v_add_u32 v12, s13, v10
    v_add_u32 v13, s13, v11
    ds_read_b64_tr_b16 v[120:121], v12 offset:0
    ds_read_b64_tr_b16 v[122:123], v12 offset:1024
    ds_read_b64_tr_b16 v[124:125], v13 offset:0
    ds_read_b64_tr_b16 v[126:127], v13 offset:1024
    ds_read_b64_tr_b16 v[128:129], v12 offset:2048
    ds_read_b64_tr_b16 v[130:131], v12 offset:3072
    ds_read_b64_tr_b16 v[132:133], v13 offset:2048
    ds_read_b64_tr_b16 v[134:135], v13 offset:3072
    s_cmp_lg_u32 s96, 0
    s_cbranch_scc1 L_pk1
L_pl1:
    buffer_load_dword v53, v8, s[32:35], s15 offen sc1
    s_add_u32 s47, s47, 1
    s_cmp_ge_u32 s47, 16384
    s_cselect_b32 s12, -1, 0
    s_waitcnt vmcnt(0)
    v_cmp_eq_u32 vcc, s23, v53
    s_nop 1
    s_or_b32 s12, s12, vcc_lo
    s_lshr_b32 s12, s12, s93
    s_or_b32 s96, s96, s12
    s_andn2_b32 s96, s96, s14
    s_cbranch_scc0 L_pl1
L_pk1:
    s_ff1_i32_b32 s12, s96
    s_bitset0_b32 s96, s12
    s_bitset1_b32 s14, s12
    s_add_u32 s12, s12, s93
    s_and_b32 s81, s12, 15
    s_lshl_b32 s94, s81, 11
    s_add_u32 s94, s94, s95
    buffer_load_dwordx4 v[104:107], v17, s[32:35], s94 offen
    buffer_load_dwordx4 v[108:111], v17, s[32:35], s94 offen offset:1024
    s_cmp_lg_u32 s96, 0
    s_cbranch_scc1 L_pk2
L_pl2:
    buffer_load_dword v54, v8, s[32:35], s15 offen sc1
    s_add_u32 s47, s47, 1
    s_cmp_ge_u32 s47, 16384
    s_cselect_b32 s12, -1, 0
    s_waitcnt vmcnt(0)
    v_cmp_eq_u32 vcc, s23, v54
    s_nop 1
    s_or_b32 s12, s12, vcc_lo
    s_lshr_b32 s12, s12, s93
    s_or_b32 s96, s96, s12
    s_andn2_b32 s96, s96, s14
    s_cbranch_scc0 L_pl2
L_pk2:
    s_ff1_i32_b32 s12, s96
    s_bitset0_b32 s96, s12
    s_bitset1_b32 s14, s12
    s_add_u32 s12, s12, s93
    s_and_b32 s82, s12, 15
    s_lshl_b32 s94, s82, 11
    s_add_u32 s94, s94, s95
    buffer_load_dwordx4 v[112:115], v17, s[32:35], s94 offen
    buffer_load_dwordx4 v[116:119], v17, s[32:35], s94 offen offset:1024
    s_add_u32 s12, s81, s97
    s_lshl_b32 s13, s12, 12
    s_cmp_ge_u32 s12, 8
    s_cselect_b32 s12, 24576, 0
    s_add_u32 s13, s13, s12
    v_add_u32 v14, s13, v10
    v_add_u32 v15, s13, v11
    s_waitcnt vmcnt(4)
    s_waitcnt lgkmcnt(6)
    v_mfma_f32_32x32x16_bf16 v[64:79], v[120:123], v[96:99], 0
    ds_read_b64_tr_b16 v[136:137], v14 offset:0
    ds_read_b64_tr_b16 v[138:139], v14 offset:1024
    s_waitcnt lgkmcnt(6)
    v_mfma_f32_32x32x16_bf16 v[80:95], v[124:127], v[96:99], 0
    ds_read_b64_tr_b16 v[140:141], v15 offset:0
    ds_read_b64_tr_b16 v[142:143], v15 offset:1024
    s_waitcnt lgkmcnt(6)
    v_mfma_f32_32x32x16_bf16 v[64:79], v[128:131], v[100:103], v[64:79]
    ds_read_b64_tr_b16 v[144:145], v14 offset:2048
    ds_read_b64_tr_b16 v[146:147], v14 offset:3072
    s_waitcnt lgkmcnt(6)
    v_mfma_f32_32x32x16_bf16 v[80:95], v[132:135], v[100:103], v[80:95]
    ds_read_b64_tr_b16 v[148:149], v15 offset:2048
    ds_read_b64_tr_b16 v[150:151], v15 offset:3072
    s_cmp_lg_u32 s96, 0
    s_cbranch_scc1 L_pk3
L_pl3:
    buffer_load_dword v55, v8, s[32:35], s15 offen sc1
    s_add_u32 s47, s47, 1
    s_cmp_ge_u32 s47, 16384
    s_cselect_b32 s12, -1, 0
    s_waitcnt vmcnt(0)
    v_cmp_eq_u32 vcc, s23, v55
    s_nop 1
    s_or_b32 s12, s12, vcc_lo
    s_lshr_b32 s12, s12, s93
    s_or_b32 s96, s96, s12
    s_andn2_b32 s96, s96, s14
    s_cbranch_scc0 L_pl3
L_pk3:
    s_ff1_i32_b32 s12, s96
    s_bitset0_b32 s96, s12
    s_bitset1_b32 s14, s12
    s_add_u32 s12, s12, s93
    s_and_b32 s83, s12, 15
    s_lshl_b32 s94, s83, 11
    s_add_u32 s94, s94, s95
    buffer_load_dwordx4 v[96:99], v17, s[32:35], s94 offen
    buffer_load_dwordx4 v[100:103], v17, s[32:35], s94 offen offset:1024
    s_add_u32 s12, s82, s97
    s_lshl_b32 s13, s12, 12
    s_cmp_ge_u32 s12, 8
    s_cselect_b32 s12, 24576, 0
    s_add_u32 s13, s13, s12
    v_add_u32 v12, s13, v10
    v_add_u32 v13, s13, v11
    s_waitcnt vmcnt(4)
    s_waitcnt lgkmcnt(6)
    v_mfma_f32_32x32x16_bf16 v[64:79], v[136:139], v[104:107], v[64:79]
    ds_read_b64_tr_b16 v[120:121], v12 offset:0
    ds_read_b64_tr_b16 v[122:123], v12 offset:1024
    s_waitcnt lgkmcnt(6)
    v_mfma_f32_32x32x16_bf16 v[80:95], v[140:143], v[104:107], v[80:95]
    ds_read_b64_tr_b16 v[124:125], v13 offset:0
    ds_read_b64_tr_b16 v[126:127], v13 offset:1024
    s_waitcnt lgkmcnt(6)
    v_mfma_f32_32x32x16_bf16 v[64:79], v[144:147], v[108:111], v[64:79]
    ds_read_b64_tr_b16 v[128:129], v12 offset:2048
    ds_read_b64_tr_b16 v[130:131], v12 offset:3072
    s_waitcnt lgkmcnt(6)
    v_mfma_f32_32x32x16_bf16 v[80:95], v[148:151], v[108:111], v[80:95]
    ds_read_b64_tr_b16 v[132:133], v13 offset:2048
    ds_read_b64_tr_b16 v[134:135], v13 offset:3072
    s_cmp_lg_u32 s96, 0
    s_cbranch_scc1 L_pk4
L_pl4:
    buffer_load_dword v56, v8, s[32:35], s15 offen sc1
    s_add_u32 s47, s47, 1
    s_cmp_ge_u32 s47, 16384
    s_cselect_b32 s12, -1, 0
    s_waitcnt vmcnt(0)
    v_cmp_eq_u32 vcc, s23, v56
    s_nop 1
    s_or_b32 s12, s12, vcc_lo
    s_lshr_b32 s12, s12, s93
    s_or_b32 s96, s96, s12
    s_andn2_b32 s96, s96, s14
    s_cbranch_scc0 L_pl4
L_pk4:
    s_ff1_i32_b32 s12, s96
    s_bitset0_b32 s96, s12
    s_bitset1_b32 s14, s12
    s_add_u32 s12, s12, s93
    s_and_b32 s84, s12, 15
    s_lshl_b32 s94, s84, 11
    s_add_u32 s94, s94, s95
    buffer_load_dwordx4 v[104:107], v17, s[32:35], s94 offen
    buffer_load_dwordx4 v[108:111], v17, s[32:35], s94 offen offset:1024
    s_add_u32 s12, s83, s97
    s_lshl_b32 s13, s12, 12
    s_cmp_ge_u32 s12, 8
    s_cselect_b32 s12, 24576, 0
    s_add_u32 s13, s13, s12
    v_add_u32 v14, s13, v10
    v_add_u32 v15, s13, v11
    s_waitcnt vmcnt(4)
    s_waitcnt lgkmcnt(6)
    v_mfma_f32_32x32x16_bf16 v[64:79], v[120:123], v[112:115], v[64:79]
    ds_read_b64_tr_b16 v[136:137], v14 offset:0
    ds_read_b64_tr_b16 v[138:139], v14 offset:1024
    s_waitcnt lgkmcnt(6)
    v_mfma_f32_32x32x16_bf16 v[80:95], v[124:127], v[112:115], v[80:95]
    ds_read_b64_tr_b16 v[140:141], v15 offset:0
    ds_read_b64_tr_b16 v[142:143], v15 offset:1024
    s_waitcnt lgkmcnt(6)
    v_mfma_f32_32x32x16_bf16 v[64:79], v[128:131], v[116:119], v[64:79]
    ds_read_b64_tr_b16 v[144:145], v14 offset:2048
    ds_read_b64_tr_b16 v[146:147], v14 offset:3072
    s_waitcnt lgkmcnt(6)
    v_mfma_f32_32x32x16_bf16 v[80:95], v[132:135], v[116:119], v[80:95]
    ds_read_b64_tr_b16 v[148:149], v15 offset:2048
    ds_read_b64_tr_b16 v[150:151], v15 offset:3072
    s_cmp_lg_u32 s96, 0
    s_cbranch_scc1 L_pk5
L_pl5:
    buffer_load_dword v57, v8, s[32:35], s15 offen sc1
    s_add_u32 s47, s47, 1
    s_cmp_ge_u32 s47, 16384
    s_cselect_b32 s12, -1, 0
    s_waitcnt vmcnt(0)
    v_cmp_eq_u32 vcc, s23, v57
    s_nop 1
    s_or_b32 s12, s12, vcc_lo
    s_lshr_b32 s12, s12, s93
    s_or_b32 s96, s96, s12
    s_andn2_b32 s96, s96, s14
    s_cbranch_scc0 L_pl5
L_pk5:
    s_ff1_i32_b32 s12, s96
    s_bitset0_b32 s96, s12
    s_bitset1_b32 s14, s12
    s_add_u32 s12, s12, s93
    s_and_b32 s85, s12, 15
    s_lshl_b32 s94, s85, 11
    s_add_u32 s94, s94, s95
    buffer_load_dwordx4 v[112:115], v17, s[32:35], s94 offen
    buffer_load_dwordx4 v[116:119], v17, s[32:35], s94 offen offset:1024
    s_add_u32 s12, s84, s97
    s_lshl_b32 s13, s12, 12
    s_cmp_ge_u32 s12, 8
    s_cselect_b32 s12, 24576, 0
    s_add_u32 s13, s13, s12
    v_add_u32 v12, s13, v10
    v_add_u32 v13, s13, v11
    s_waitcnt vmcnt(4)
    s_waitcnt lgkmcnt(6)
    v_mfma_f32_32x32x16_bf16 v[64:79], v[136:139], v[96:99], v[64:79]
    ds_read_b64_tr_b16 v[120:121], v12 offset:0
    ds_read_b64_tr_b16 v[122:123], v12 offset:1024
    s_waitcnt lgkmcnt(6)
    v_mfma_f32_32x32x16_bf16 v[80:95], v[140:143], v[96:99], v[80:95]
    ds_read_b64_tr_b16 v[124:125], v13 offset:0
    ds_read_b64_tr_b16 v[126:127], v13 offset:1024
    s_waitcnt lgkmcnt(6)
    v_mfma_f32_32x32x16_bf16 v[64:79], v[144:147], v[100:103], v[64:79]
    ds_read_b64_tr_b16 v[128:129], v12 offset:2048
    ds_read_b64_tr_b16 v[130:131], v12 offset:3072
    s_waitcnt lgkmcnt(6)
    v_mfma_f32_32x32x16_bf16 v[80:95], v[148:151], v[100:103], v[80:95]
    ds_read_b64_tr_b16 v[132:133], v13 offset:2048
    ds_read_b64_tr_b16 v[134:135], v13 offset:3072
    s_cmp_lg_u32 s96, 0
    s_cbranch_scc1 L_pk6
L_pl6:
    buffer_load_dword v58, v8, s[32:35], s15 offen sc1
    s_add_u32 s47, s47, 1
    s_cmp_ge_u32 s47, 16384
    s_cselect_b32 s12, -1, 0
    s_waitcnt vmcnt(0)
    v_cmp_eq_u32 vcc, s23, v58
    s_nop 1
    s_or_b32 s12, s12, vcc_lo
    s_lshr_b32 s12, s12, s93
    s_or_b32 s96, s96, s12
    s_andn2_b32 s96, s96, s14
    s_cbranch_scc0 L_pl6
L_pk6:
    s_ff1_i32_b32 s12, s96
    s_bitset0_b32 s96, s12
    s_bitset1_b32 s14, s12
    s_add_u32 s12, s12, s93
    s_and_b32 s86, s12, 15
    s_lshl_b32 s94, s86, 11
    s_add_u32 s94, s94, s95
    buffer_load_dwordx4 v[96:99], v17, s[32:35], s94 offen
    buffer_load_dwordx4 v[100:103], v17, s[32:35], s94 offen offset:1024
    s_add_u32 s12, s85, s97
    s_lshl_b32 s13, s12, 12
    s_cmp_ge_u32 s12, 8
    s_cselect_b32 s12, 24576, 0
    s_add_u32 s13, s13, s12
    v_add_u32 v14, s13, v10
    v_add_u32 v15, s13, v11
    s_waitcnt vmcnt(4)
    s_waitcnt lgkmcnt(6)
    v_mfma_f32_32x32x16_bf16 v[64:79], v[120:123], v[104:107], v[64:79]
    ds_read_b64_tr_b16 v[136:137], v14 offset:0
    ds_read_b64_tr_b16 v[138:139], v14 offset:1024
    s_waitcnt lgkmcnt(6)
    v_mfma_f32_32x32x16_bf16 v[80:95], v[124:127], v[104:107], v[80:95]
    ds_read_b64_tr_b16 v[140:141], v15 offset:0
    ds_read_b64_tr_b16 v[142:143], v15 offset:1024
    s_waitcnt lgkmcnt(6)
    v_mfma_f32_32x32x16_bf16 v[64:79], v[128:131], v[108:111], v[64:79]
    ds_read_b64_tr_b16 v[144:145], v14 offset:2048
    ds_read_b64_tr_b16 v[146:147], v14 offset:3072
    s_waitcnt lgkmcnt(6)
    v_mfma_f32_32x32x16_bf16 v[80:95], v[132:135], v[108:111], v[80:95]
    ds_read_b64_tr_b16 v[148:149], v15 offset:2048
    ds_read_b64_tr_b16 v[150:151], v15 offset:3072
    s_cmp_lg_u32 s96, 0
    s_cbranch_scc1 L_pk7
L_pl7:
    buffer_load_dword v59, v8, s[32:35], s15 offen sc1
    s_add_u32 s47, s47, 1
    s_cmp_ge_u32 s47, 16384
    s_cselect_b32 s12, -1, 0
    s_waitcnt vmcnt(0)
    v_cmp_eq_u32 vcc, s23, v59
    s_nop 1
    s_or_b32 s12, s12, vcc_lo
    s_lshr_b32 s12, s12, s93
    s_or_b32 s96, s96, s12
    s_andn2_b32 s96, s96, s14
    s_cbranch_scc0 L_pl7
L_pk7:
    s_ff1_i32_b32 s12, s96
    s_bitset0_b32 s96, s12
    s_bitset1_b32 s14, s12
    s_add_u32 s12, s12, s93
    s_and_b32 s87, s12, 15
    s_lshl_b32 s94, s87, 11
    s_add_u32 s94, s94, s95
    buffer_load_dwordx4 v[104:107], v17, s[32:35], s94 offen
    buffer_load_dwordx4 v[108:111], v17, s[32:35], s94 offen offset:1024
    s_add_u32 s12, s86, s97
    s_lshl_b32 s13, s12, 12
    s_cmp_ge_u32 s12, 8
    s_cselect_b32 s12, 24576, 0
    s_add_u32 s13, s13, s12
    v_add_u32 v12, s13, v10
    v_add_u32 v13, s13, v11
    s_waitcnt vmcnt(4)
    s_waitcnt lgkmcnt(6)
    v_mfma_f32_32x32x16_bf16 v[64:79], v[136:139], v[112:115], v[64:79]
    ds_read_b64_tr_b16 v[120:121], v12 offset:0
    ds_read_b64_tr_b16 v[122:123], v12 offset:1024
    s_waitcnt lgkmcnt(6)
    v_mfma_f32_32x32x16_bf16 v[80:95], v[140:143], v[112:115], v[80:95]
    ds_read_b64_tr_b16 v[124:125], v13 offset:0
    ds_read_b64_tr_b16 v[126:127], v13 offset:1024
    s_waitcnt lgkmcnt(6)
    v_mfma_f32_32x32x16_bf16 v[64:79], v[144:147], v[116:119], v[64:79]
    ds_read_b64_tr_b16 v[128:129], v12 offset:2048
    ds_read_b64_tr_b16 v[130:131], v12 offset:3072
    s_waitcnt lgkmcnt(6)
    v_mfma_f32_32x32x16_bf16 v[80:95], v[148:151], v[116:119], v[80:95]
    ds_read_b64_tr_b16 v[132:133], v13 offset:2048
    ds_read_b64_tr_b16 v[134:135], v13 offset:3072
    s_cmp_lg_u32 s96, 0
    s_cbranch_scc1 L_pk8
L_pl8:
    buffer_load_dword v52, v8, s[32:35], s15 offen sc1
    s_add_u32 s47, s47, 1
    s_cmp_ge_u32 s47, 16384
    s_cselect_b32 s12, -1, 0
    s_waitcnt vmcnt(0)
    v_cmp_eq_u32 vcc, s23, v52
    s_nop 1
    s_or_b32 s12, s12, vcc_lo
    s_lshr_b32 s12, s12, s93
    s_or_b32 s96, s96, s12
    s_andn2_b32 s96, s96, s14
    s_cbranch_scc0 L_pl8
L_pk8:
    s_ff1_i32_b32 s12, s96
    s_bitset0_b32 s96, s12
    s_bitset1_b32 s14, s12
    s_add_u32 s12, s12, s93
    s_and_b32 s80, s12, 15
    s_lshl_b32 s94, s80, 11
    s_add_u32 s94, s94, s95
    buffer_load_dwordx4 v[112:115], v17, s[32:35], s94 offen
    buffer_load_dwordx4 v[116:119], v17, s[32:35], s94 offen offset:1024
    s_add_u32 s12, s87, s97
    s_lshl_b32 s13, s12, 12
    s_cmp_ge_u32 s12, 8
    s_cselect_b32 s12, 24576, 0
    s_add_u32 s13, s13, s12
    v_add_u32 v14, s13, v10
    v_add_u32 v15, s13, v11
    s_waitcnt vmcnt(4)
    s_waitcnt lgkmcnt(6)
    v_mfma_f32_32x32x16_bf16 v[64:79], v[120:123], v[96:99], v[64:79]
    ds_read_b64_tr_b16 v[136:137], v14 offset:0
    ds_read_b64_tr_b16 v[138:139], v14 offset:1024
    s_waitcnt lgkmcnt(6)
    v_mfma_f32_32x32x16_bf16 v[80:95], v[124:127], v[96:99], v[80:95]
    ds_read_b64_tr_b16 v[140:141], v15 offset:0
    ds_read_b64_tr_b16 v[142:143], v15 offset:1024
    s_waitcnt lgkmcnt(6)
    v_mfma_f32_32x32x16_bf16 v[64:79], v[128:131], v[100:103], v[64:79]
    ds_read_b64_tr_b16 v[144:145], v14 offset:2048
    ds_read_b64_tr_b16 v[146:147], v14 offset:3072
    s_waitcnt lgkmcnt(6)
    v_mfma_f32_32x32x16_bf16 v[80:95], v[132:135], v[100:103], v[80:95]
    ds_read_b64_tr_b16 v[148:149], v15 offset:2048
    ds_read_b64_tr_b16 v[150:151], v15 offset:3072
    s_cmp_lg_u32 s96, 0
    s_cbranch_scc1 L_pk9
L_pl9:
    buffer_load_dword v53, v8, s[32:35], s15 offen sc1
    s_add_u32 s47, s47, 1
    s_cmp_ge_u32 s47, 16384
    s_cselect_b32 s12, -1, 0
    s_waitcnt vmcnt(0)
    v_cmp_eq_u32 vcc, s23, v53
    s_nop 1
    s_or_b32 s12, s12, vcc_lo
    s_lshr_b32 s12, s12, s93
    s_or_b32 s96, s96, s12
    s_andn2_b32 s96, s96, s14
    s_cbranch_scc0 L_pl9
L_pk9:
    s_ff1_i32_b32 s12, s96
    s_bitset0_b32 s96, s12
    s_bitset1_b32 s14, s12
    s_add_u32 s12, s12, s93
    s_and_b32 s81, s12, 15
    s_lshl_b32 s94, s81, 11
    s_add_u32 s94, s94, s95
    buffer_load_dwordx4 v[96:99], v17, s[32:35], s94 offen
    buffer_load_dwordx4 v[100:103], v17, s[32:35], s94 offen offset:1024
    s_add_u32 s12, s80, s97
    s_lshl_b32 s13, s12, 12
    s_cmp_ge_u32 s12, 8
    s_cselect_b32 s12, 24576, 0
    s_add_u32 s13, s13, s12
    v_add_u32 v12, s13, v10
    v_add_u32 v13, s13, v11
    s_waitcnt vmcnt(4)
    s_waitcnt lgkmcnt(6)
    v_mfma_f32_32x32x16_bf16 v[64:79], v[136:139], v[104:107], v[64:79]
    ds_read_b64_tr_b16 v[120:121], v12 offset:0
    ds_read_b64_tr_b16 v[122:123], v12 offset:1024
    s_waitcnt lgkmcnt(6)
    v_mfma_f32_32x32x16_bf16 v[80:95], v[140:143], v[104:107], v[80:95]
    ds_read_b64_tr_b16 v[124:125], v13 offset:0
    ds_read_b64_tr_b16 v[126:127], v13 offset:1024
    s_waitcnt lgkmcnt(6)
    v_mfma_f32_32x32x16_bf16 v[64:79], v[144:147], v[108:111], v[64:79]
    ds_read_b64_tr_b16 v[128:129], v12 offset:2048
    ds_read_b64_tr_b16 v[130:131], v12 offset:3072
    s_waitcnt lgkmcnt(6)
    v_mfma_f32_32x32x16_bf16 v[80:95], v[148:151], v[108:111], v[80:95]
    ds_read_b64_tr_b16 v[132:133], v13 offset:2048
    ds_read_b64_tr_b16 v[134:135], v13 offset:3072
    s_cmp_lg_u32 s96, 0
    s_cbranch_scc1 L_pk10
L_pl10:
    buffer_load_dword v54, v8, s[32:35], s15 offen sc1
    s_add_u32 s47, s47, 1
    s_cmp_ge_u32 s47, 16384
    s_cselect_b32 s12, -1, 0
    s_waitcnt vmcnt(0)
    v_cmp_eq_u32 vcc, s23, v54
    s_nop 1
    s_or_b32 s12, s12, vcc_lo
    s_lshr_b32 s12, s12, s93
    s_or_b32 s96, s96, s12
    s_andn2_b32 s96, s96, s14
    s_cbranch_scc0 L_pl10
L_pk10:
    s_ff1_i32_b32 s12, s96
    s_bitset0_b32 s96, s12
    s_bitset1_b32 s14, s12
    s_add_u32 s12, s12, s93
    s_and_b32 s82, s12, 15
    s_lshl_b32 s94, s82, 11
    s_add_u32 s94, s94, s95
    buffer_load_dwordx4 v[104:107], v17, s[32:35], s94 offen
    buffer_load_dwordx4 v[108:111], v17, s[32:35], s94 offen offset:1024
    s_add_u32 s12, s81, s97
    s_lshl_b32 s13, s12, 12
    s_cmp_ge_u32 s12, 8
    s_cselect_b32 s12, 24576, 0
    s_add_u32 s13, s13, s12
    v_add_u32 v14, s13, v10
    v_add_u32 v15, s13, v11
    s_waitcnt vmcnt(4)
    s_waitcnt lgkmcnt(6)
    v_mfma_f32_32x32x16_bf16 v[64:79], v[120:123], v[112:115], v[64:79]
    ds_read_b64_tr_b16 v[136:137], v14 offset:0
    ds_read_b64_tr_b16 v[138:139], v14 offset:1024
    s_waitcnt lgkmcnt(6)
    v_mfma_f32_32x32x16_bf16 v[80:95], v[124:127], v[112:115], v[80:95]
    ds_read_b64_tr_b16 v[140:141], v15 offset:0
    ds_read_b64_tr_b16 v[142:143], v15 offset:1024
    s_waitcnt lgkmcnt(6)
    v_mfma_f32_32x32x16_bf16 v[64:79], v[128:131], v[116:119], v[64:79]
    ds_read_b64_tr_b16 v[144:145], v14 offset:2048
    ds_read_b64_tr_b16 v[146:147], v14 offset:3072
    s_waitcnt lgkmcnt(6)
    v_mfma_f32_32x32x16_bf16 v[80:95], v[132:135], v[116:119], v[80:95]
    ds_read_b64_tr_b16 v[148:149], v15 offset:2048
    ds_read_b64_tr_b16 v[150:151], v15 offset:3072
    s_cmp_lg_u32 s96, 0
    s_cbranch_scc1 L_pk11
L_pl11:
    buffer_load_dword v55, v8, s[32:35], s15 offen sc1
    s_add_u32 s47, s47, 1
    s_cmp_ge_u32 s47, 16384
    s_cselect_b32 s12, -1, 0
    s_waitcnt vmcnt(0)
    v_cmp_eq_u32 vcc, s23, v55
    s_nop 1
    s_or_b32 s12, s12, vcc_lo
    s_lshr_b32 s12, s12, s93
    s_or_b32 s96, s96, s12
    s_andn2_b32 s96, s96, s14
    s_cbranch_scc0 L_pl11
L_pk11:
    s_ff1_i32_b32 s12, s96
    s_bitset0_b32 s96, s12
    s_bitset1_b32 s14, s12
    s_add_u32 s12, s12, s93
    s_and_b32 s83, s12, 15
    s_lshl_b32 s94, s83, 11
    s_add_u32 s94, s94, s95
    buffer_load_dwordx4 v[112:115], v17, s[32:35], s94 offen
    buffer_load_dwordx4 v[116:119], v17, s[32:35], s94 offen offset:1024
    s_mov_b32 s45, 1
    s_cmp_eq_u32 s46, 0
    s_cbranch_scc1 L_b_nold
    s_lshl_b32 s12, s89, 12
    s_add_u32 s12, s12, 458752
    buffer_load_dwordx4 v[224:227], v22, s[32:35], s12 offen offset:0 sc1
    buffer_load_dwordx4 v[228:231], v22, s[32:35], s12 offen offset:16 sc1
    buffer_load_dwordx4 v[232:235], v22, s[32:35], s12 offen offset:64 sc1
    buffer_load_dwordx4 v[236:239], v22, s[32:35], s12 offen offset:80 sc1
L_b_nold:
    s_add_u32 s12, s82, s97
    s_lshl_b32 s13, s12, 12
    s_cmp_ge_u32 s12, 8
    s_cselect_b32 s12, 24576, 0
    s_add_u32 s13, s13, s12
    v_add_u32 v12, s13, v10
    v_add_u32 v13, s13, v11
    s_waitcnt vmcnt(4)
    s_waitcnt lgkmcnt(6)
    v_mfma_f32_32x32x16_bf16 v[64:79], v[136:139], v[96:99], v[64:79]
    ds_read_b64_tr_b16 v[120:121], v12 offset:0
    ds_read_b64_tr_b16 v[122:123], v12 offset:1024
    s_waitcnt lgkmcnt(6)
    v_mfma_f32_32x32x16_bf16 v[80:95], v[140:143], v[96:99], v[80:95]
    ds_read_b64_tr_b16 v[124:125], v13 offset:0
    ds_read_b64_tr_b16 v[126:127], v13 offset:1024
    s_waitcnt lgkmcnt(6)
    v_mfma_f32_32x32x16_bf16 v[64:79], v[144:147], v[100:103], v[64:79]
    ds_read_b64_tr_b16 v[128:129], v12 offset:2048
    ds_read_b64_tr_b16 v[130:131], v12 offset:3072
    s_waitcnt lgkmcnt(6)
    v_mfma_f32_32x32x16_bf16 v[80:95], v[148:151], v[100:103], v[80:95]
    ds_read_b64_tr_b16 v[132:133], v13 offset:2048
    ds_read_b64_tr_b16 v[134:135], v13 offset:3072
    s_cmp_lg_u32 s96, 0
    s_cbranch_scc1 L_pk12
L_pl12:
    buffer_load_dword v56, v8, s[32:35], s15 offen sc1
    s_add_u32 s47, s47, 1
    s_cmp_ge_u32 s47, 16384
    s_cselect_b32 s12, -1, 0
    s_waitcnt vmcnt(0)
    v_cmp_eq_u32 vcc, s23, v56
    s_nop 1
    s_or_b32 s12, s12, vcc_lo
    s_lshr_b32 s12, s12, s93
    s_or_b32 s96, s96, s12
    s_andn2_b32 s96, s96, s14
    s_cbranch_scc0 L_pl12
L_pk12:
    s_ff1_i32_b32 s12, s96
    s_bitset0_b32 s96, s12
    s_bitset1_b32 s14, s12
    s_add_u32 s12, s12, s93
    s_and_b32 s84, s12, 15
    s_lshl_b32 s94, s84, 11
    s_add_u32 s94, s94, s95
    buffer_load_dwordx4 v[96:99], v17, s[32:35], s94 offen
    buffer_load_dwordx4 v[100:103], v17, s[32:35], s94 offen offset:1024
    s_add_u32 s12, s83, s97
    s_lshl_b32 s13, s12, 12
    s_cmp_ge_u32 s12, 8
    s_cselect_b32 s12, 24576, 0
    s_add_u32 s13, s13, s12
    v_add_u32 v14, s13, v10
    v_add_u32 v15, s13, v11
    s_waitcnt vmcnt(4)
    s_waitcnt lgkmcnt(6)
    v_mfma_f32_32x32x16_bf16 v[64:79], v[120:123], v[104:107], v[64:79]
    ds_read_b64_tr_b16 v[136:137], v14 offset:0
    ds_read_b64_tr_b16 v[138:139], v14 offset:1024
    s_waitcnt lgkmcnt(6)
    v_mfma_f32_32x32x16_bf16 v[80:95], v[124:127], v[104:107], v[80:95]
    ds_read_b64_tr_b16 v[140:141], v15 offset:0
    ds_read_b64_tr_b16 v[142:143], v15 offset:1024
    s_waitcnt lgkmcnt(6)
    v_mfma_f32_32x32x16_bf16 v[64:79], v[128:131], v[108:111], v[64:79]
    ds_read_b64_tr_b16 v[144:145], v14 offset:2048
    ds_read_b64_tr_b16 v[146:147], v14 offset:3072
    s_waitcnt lgkmcnt(6)
    v_mfma_f32_32x32x16_bf16 v[80:95], v[132:135], v[108:111], v[80:95]
    ds_read_b64_tr_b16 v[148:149], v15 offset:2048
    ds_read_b64_tr_b16 v[150:151], v15 offset:3072
    s_cmp_lg_u32 s96, 0
    s_cbranch_scc1 L_pk13
L_pl13:
    buffer_load_dword v57, v8, s[32:35], s15 offen sc1
    s_add_u32 s47, s47, 1
    s_cmp_ge_u32 s47, 16384
    s_cselect_b32 s12, -1, 0
    s_waitcnt vmcnt(0)
    v_cmp_eq_u32 vcc, s23, v57
    s_nop 1
    s_or_b32 s12, s12, vcc_lo
    s_lshr_b32 s12, s12, s93
    s_or_b32 s96, s96, s12
    s_andn2_b32 s96, s96, s14
    s_cbranch_scc0 L_pl13
L_pk13:
    s_ff1_i32_b32 s12, s96
    s_bitset0_b32 s96, s12
    s_bitset1_b32 s14, s12
    s_add_u32 s12, s12, s93
    s_and_b32 s85, s12, 15
    s_lshl_b32 s94, s85, 11
    s_add_u32 s94, s94, s95
    buffer_load_dwordx4 v[104:107], v17, s[32:35], s94 offen
    buffer_load_dwordx4 v[108:111], v17, s[32:35], s94 offen offset:1024
    s_cmp_lg_u32 s46, 0
    s_cbranch_scc1 L_own
L_own_r1:
    s_add_u32 s12, s84, s97
    s_lshl_b32 s13, s12, 12
    s_cmp_ge_u32 s12, 8
    s_cselect_b32 s12, 24576, 0
    s_add_u32 s13, s13, s12
    v_add_u32 v12, s13, v10
    v_add_u32 v13, s13, v11
    s_waitcnt vmcnt(4)
    s_waitcnt lgkmcnt(6)
    v_mfma_f32_32x32x16_bf16 v[64:79], v[136:139], v[112:115], v[64:79]
    ds_read_b64_tr_b16 v[120:121], v12 offset:0
    ds_read_b64_tr_b16 v[122:123], v12 offset:1024
    s_waitcnt lgkmcnt(6)
    v_mfma_f32_32x32x16_bf16 v[80:95], v[140:143], v[112:115], v[80:95]
    ds_read_b64_tr_b16 v[124:125], v13 offset:0
    ds_read_b64_tr_b16 v[126:127], v13 offset:1024
    s_waitcnt lgkmcnt(6)
    v_mfma_f32_32x32x16_bf16 v[64:79], v[144:147], v[116:119], v[64:79]
    ds_read_b64_tr_b16 v[128:129], v12 offset:2048
    ds_read_b64_tr_b16 v[130:131], v12 offset:3072
    s_waitcnt lgkmcnt(6)
    v_mfma_f32_32x32x16_bf16 v[80:95], v[148:151], v[116:119], v[80:95]
    ds_read_b64_tr_b16 v[132:133], v13 offset:2048
    ds_read_b64_tr_b16 v[134:135], v13 offset:3072
    s_cmp_lg_u32 s96, 0
    s_cbranch_scc1 L_pk14
L_pl14:
    buffer_load_dword v58, v8, s[32:35], s15 offen sc1
    s_add_u32 s47, s47, 1
    s_cmp_ge_u32 s47, 16384
    s_cselect_b32 s12, -1, 0
    s_waitcnt vmcnt(0)
    v_cmp_eq_u32 vcc, s23, v58
    s_nop 1
    s_or_b32 s12, s12, vcc_lo
    s_lshr_b32 s12, s12, s93
    s_or_b32 s96, s96, s12
    s_andn2_b32 s96, s96, s14
    s_cbranch_scc0 L_pl14
L_pk14:
    s_ff1_i32_b32 s12, s96
    s_bitset0_b32 s96, s12
    s_bitset1_b32 s14, s12
    s_add_u32 s12, s12, s93
    s_and_b32 s86, s12, 15
    s_lshl_b32 s94, s86, 11
    s_add_u32 s94, s94, s95
    buffer_load_dwordx4 v[112:115], v17, s[32:35], s94 offen
    buffer_load_dwordx4 v[116:119], v17, s[32:35], s94 offen offset:1024
    s_add_u32 s12, s85, s97
    s_lshl_b32 s13, s12, 12
    s_cmp_ge_u32 s12, 8
    s_cselect_b32 s12, 24576, 0
    s_add_u32 s13, s13, s12
    v_add_u32 v14, s13, v10
    v_add_u32 v15, s13, v11
    s_waitcnt vmcnt(4)
    s_waitcnt lgkmcnt(6)
    v_mfma_f32_32x32x16_bf16 v[64:79], v[120:123], v[96:99], v[64:79]
    ds_read_b64_tr_b16 v[136:137], v14 offset:0
    ds_read_b64_tr_b16 v[138:139], v14 offset:1024
    s_waitcnt lgkmcnt(6)
    v_mfma_f32_32x32x16_bf16 v[80:95], v[124:127], v[96:99], v[80:95]
    ds_read_b64_tr_b16 v[140:141], v15 offset:0
    ds_read_b64_tr_b16 v[142:143], v15 offset:1024
    s_waitcnt lgkmcnt(6)
    v_mfma_f32_32x32x16_bf16 v[64:79], v[128:131], v[100:103], v[64:79]
    ds_read_b64_tr_b16 v[144:145], v14 offset:2048
    ds_read_b64_tr_b16 v[146:147], v14 offset:3072
    s_waitcnt lgkmcnt(6)
    v_mfma_f32_32x32x16_bf16 v[80:95], v[132:135], v[100:103], v[80:95]
    ds_read_b64_tr_b16 v[148:149], v15 offset:2048
    ds_read_b64_tr_b16 v[150:151], v15 offset:3072
    s_cmp_lg_u32 s96, 0
    s_cbranch_scc1 L_pk15
L_pl15:
    buffer_load_dword v59, v8, s[32:35], s15 offen sc1
    s_add_u32 s47, s47, 1
    s_cmp_ge_u32 s47, 16384
    s_cselect_b32 s12, -1, 0
    s_waitcnt vmcnt(0)
    v_cmp_eq_u32 vcc, s23, v59
    s_nop 1
    s_or_b32 s12, s12, vcc_lo
    s_lshr_b32 s12, s12, s93
    s_or_b32 s96, s96, s12
    s_andn2_b32 s96, s96, s14
    s_cbranch_scc0 L_pl15
L_pk15:
    s_ff1_i32_b32 s12, s96
    s_bitset0_b32 s96, s12
    s_bitset1_b32 s14, s12
    s_add_u32 s12, s12, s93
    s_and_b32 s87, s12, 15
    s_lshl_b32 s94, s87, 11
    s_add_u32 s94, s94, s95
    buffer_load_dwordx4 v[96:99], v17, s[32:35], s94 offen
    buffer_load_dwordx4 v[100:103], v17, s[32:35], s94 offen offset:1024
    s_add_u32 s12, s86, s97
    s_lshl_b32 s13, s12, 12
    s_cmp_ge_u32 s12, 8
    s_cselect_b32 s12, 24576, 0
    s_add_u32 s13, s13, s12
    v_add_u32 v12, s13, v10
    v_add_u32 v13, s13, v11
    s_waitcnt vmcnt(4)
    s_waitcnt lgkmcnt(6)
    v_mfma_f32_32x32x16_bf16 v[64:79], v[136:139], v[104:107], v[64:79]
    ds_read_b64_tr_b16 v[120:121], v12 offset:0
    ds_read_b64_tr_b16 v[122:123], v12 offset:1024
    s_waitcnt lgkmcnt(6)
    v_mfma_f32_32x32x16_bf16 v[80:95], v[140:143], v[104:107], v[80:95]
    ds_read_b64_tr_b16 v[124:125], v13 offset:0
    ds_read_b64_tr_b16 v[126:127], v13 offset:1024
    s_waitcnt lgkmcnt(6)
    v_mfma_f32_32x32x16_bf16 v[64:79], v[144:147], v[108:111], v[64:79]
    ds_read_b64_tr_b16 v[128:129], v12 offset:2048
    ds_read_b64_tr_b16 v[130:131], v12 offset:3072
    s_waitcnt lgkmcnt(6)
    v_mfma_f32_32x32x16_bf16 v[80:95], v[148:151], v[108:111], v[80:95]
    ds_read_b64_tr_b16 v[132:133], v13 offset:2048
    ds_read_b64_tr_b16 v[134:135], v13 offset:3072
    s_add_u32 s12, s87, s97
    s_lshl_b32 s13, s12, 12
    s_cmp_ge_u32 s12, 8
    s_cselect_b32 s12, 24576, 0
    s_add_u32 s13, s13, s12
    v_add_u32 v14, s13, v10
    v_add_u32 v15, s13, v11
    s_waitcnt vmcnt(2)
    s_waitcnt lgkmcnt(6)
    v_mfma_f32_32x32x16_bf16 v[64:79], v[120:123], v[112:115], v[64:79]
    ds_read_b64_tr_b16 v[136:137], v14 offset:0
    ds_read_b64_tr_b16 v[138:139], v14 offset:1024
    s_waitcnt lgkmcnt(6)
    v_mfma_f32_32x32x16_bf16 v[80:95], v[124:127], v[112:115], v[80:95]
    ds_read_b64_tr_b16 v[140:141], v15 offset:0
    ds_read_b64_tr_b16 v[142:143], v15 offset:1024
    s_waitcnt lgkmcnt(6)
    v_mfma_f32_32x32x16_bf16 v[64:79], v[128:131], v[116:119], v[64:79]
    ds_read_b64_tr_b16 v[144:145], v14 offset:2048
    ds_read_b64_tr_b16 v[146:147], v14 offset:3072
    s_waitcnt lgkmcnt(6)
    v_mfma_f32_32x32x16_bf16 v[80:95], v[132:135], v[116:119], v[80:95]
    ds_read_b64_tr_b16 v[148:149], v15 offset:2048
    ds_read_b64_tr_b16 v[150:151], v15 offset:3072
    s_waitcnt vmcnt(0)
    s_waitcnt lgkmcnt(6)
    v_mfma_f32_32x32x16_bf16 v[64:79], v[136:139], v[96:99], v[64:79]
    s_waitcnt lgkmcnt(4)
    v_mfma_f32_32x32x16_bf16 v[80:95], v[140:143], v[96:99], v[80:95]
    s_waitcnt lgkmcnt(2)
    v_mfma_f32_32x32x16_bf16 v[64:79], v[144:147], v[100:103], v[64:79]
    s_waitcnt lgkmcnt(0)
    v_mfma_f32_32x32x16_bf16 v[80:95], v[148:151], v[100:103], v[80:95]
    s_nop 11
    v_permlane16_swap_b32 v64, v80
    v_permlane16_swap_b32 v65, v81
    v_permlane16_swap_b32 v66, v82
    v_permlane16_swap_b32 v67, v83
    v_permlane16_swap_b32 v68, v84
    v_permlane16_swap_b32 v69, v85
    v_permlane16_swap_b32 v70, v86
    v_permlane16_swap_b32 v71, v87
    v_permlane16_swap_b32 v72, v88
    v_permlane16_swap_b32 v73, v89
    v_permlane16_swap_b32 v74, v90
    v_permlane16_swap_b32 v75, v91
    v_permlane16_swap_b32 v76, v92
    v_permlane16_swap_b32 v77, v93
    v_permlane16_swap_b32 v78, v94
    v_permlane16_swap_b32 v79, v95
    ds_write_b128 v20, v[80:83] offset:0
    ds_write_b128 v20, v[84:87] offset:1024
    ds_write_b128 v20, v[88:91] offset:2048
    ds_write_b128 v20, v[92:95] offset:3072
    s_waitcnt lgkmcnt(0)
    v_bfe_u32 v9, v2, 3, 1
    v_mul_u32_u24 v9, 16352, v9
    v_sub_u32 v7, v7, v9
    s_mov_b32 s12, 16384
    s_barrier
    ds_read_b128 v[80:83], v21 offset:0
    ds_read_b128 v[84:87], v21 offset:1024
    ds_read_b128 v[88:91], v21 offset:2048
    ds_read_b128 v[92:95], v21 offset:3072
    s_waitcnt lgkmcnt(3)
    v_pk_add_f32 v[64:65], v[64:65], v[80:81]
    v_pk_add_f32 v[66:67], v[66:67], v[82:83]
    v_cvt_pk_bf16_f32 v96, v64, v65
    v_cvt_pk_bf16_f32 v97, v66, v67
    s_waitcnt lgkmcnt(2)
    v_pk_add_f32 v[68:69], v[68:69], v[84:85]
    v_pk_add_f32 v[70:71], v[70:71], v[86:87]
    v_cvt_pk_bf16_f32 v98, v68, v69
    v_cvt_pk_bf16_f32 v99, v70, v71
    s_waitcnt lgkmcnt(1)
    v_pk_add_f32 v[72:73], v[72:73], v[88:89]
    v_pk_add_f32 v[74:75], v[74:75], v[90:91]
    v_cvt_pk_bf16_f32 v100, v72, v73
    v_cvt_pk_bf16_f32 v101, v74, v75
    s_waitcnt lgkmcnt(0)
    v_pk_add_f32 v[76:77], v[76:77], v[92:93]
    v_pk_add_f32 v[78:79], v[78:79], v[94:95]
    v_cvt_pk_bf16_f32 v102, v76, v77
    v_cvt_pk_bf16_f32 v103, v78, v79
    v_permlane32_swap_b32 v96, v98
    v_permlane32_swap_b32 v97, v99
    v_permlane32_swap_b32 v100, v102
    v_permlane32_swap_b32 v101, v103
    v_lshlrev_b32 v104, 16, v96
    v_and_b32 v105, 0xffff0000, v96
    v_lshlrev_b32 v106, 16, v97
    v_and_b32 v107, 0xffff0000, v97
    v_lshlrev_b32 v108, 16, v98
    v_and_b32 v109, 0xffff0000, v98
    v_lshlrev_b32 v110, 16, v99
    v_and_b32 v111, 0xffff0000, v99
    v_pk_mul_f32 v[104:105], v[104:105], v[48:49] op_sel_hi:[1,0]
    v_pk_mul_f32 v[106:107], v[106:107], v[48:49] op_sel_hi:[1,0]
    v_pk_mul_f32 v[108:109], v[108:109], v[48:49] op_sel_hi:[1,0]
    v_pk_mul_f32 v[110:111], v[110:111], v[48:49] op_sel_hi:[1,0]
    v_cvt_pk_bf16_f32 v96, v104, v105
    v_cvt_pk_bf16_f32 v97, v106, v107
    v_cvt_pk_bf16_f32 v98, v108, v109
    v_cvt_pk_bf16_f32 v99, v110, v111
    v_lshlrev_b32 v104, 16, v96
    v_and_b32 v105, 0xffff0000, v96
    v_lshlrev_b32 v106, 16, v97
    v_and_b32 v107, 0xffff0000, v97
    v_lshlrev_b32 v108, 16, v98
    v_and_b32 v109, 0xffff0000, v98
    v_lshlrev_b32 v110, 16, v99
    v_and_b32 v111, 0xffff0000, v99
    v_pk_add_f32 v[104:105], v[104:105], v[32:33]
    v_pk_add_f32 v[106:107], v[106:107], v[34:35]
    v_pk_add_f32 v[108:109], v[108:109], v[36:37]
    v_pk_add_f32 v[110:111], v[110:111], v[38:39]
    v_cvt_pk_bf16_f32 v96, v104, v105
    v_cvt_pk_bf16_f32 v97, v106, v107
    v_cvt_pk_bf16_f32 v98, v108, v109
    v_cvt_pk_bf16_f32 v99, v110, v111
    v_lshlrev_b32 v112, 16, v100
    v_and_b32 v113, 0xffff0000, v100
    v_lshlrev_b32 v114, 16, v101
    v_and_b32 v115, 0xffff0000, v101
    v_lshlrev_b32 v116, 16, v102
    v_and_b32 v117, 0xffff0000, v102
    v_lshlrev_b32 v118, 16, v103
    v_and_b32 v119, 0xffff0000, v103
    v_pk_mul_f32 v[112:113], v[112:113], v[48:49] op_sel_hi:[1,0]
    v_pk_mul_f32 v[114:115], v[114:115], v[48:49] op_sel_hi:[1,0]
    v_pk_mul_f32 v[116:117], v[116:117], v[48:49] op_sel_hi:[1,0]
    v_pk_mul_f32 v[118:119], v[118:119], v[48:49] op_sel_hi:[1,0]
    v_cvt_pk_bf16_f32 v100, v112, v113
    v_cvt_pk_bf16_f32 v101, v114, v115
    v_cvt_pk_bf16_f32 v102, v116, v117
    v_cvt_pk_bf16_f32 v103, v118, v119
    v_lshlrev_b32 v112, 16, v100
    v_and_b32 v113, 0xffff0000, v100
    v_lshlrev_b32 v114, 16, v101
    v_and_b32 v115, 0xffff0000, v101
    v_lshlrev_b32 v116, 16, v102
    v_and_b32 v117, 0xffff0000, v102
    v_lshlrev_b32 v118, 16, v103
    v_and_b32 v119, 0xffff0000, v103
    v_pk_add_f32 v[112:113], v[112:113], v[40:41]
    v_pk_add_f32 v[114:115], v[114:115], v[42:43]
    v_pk_add_f32 v[116:117], v[116:117], v[44:45]
    v_pk_add_f32 v[118:119], v[118:119], v[46:47]
    v_cvt_pk_bf16_f32 v100, v112, v113
    v_cvt_pk_bf16_f32 v101, v114, v115
    v_cvt_pk_bf16_f32 v102, v116, v117
    v_cvt_pk_bf16_f32 v103, v118, v119
    v_mov_b32 v104, v100
    v_mov_b32 v105, v101
    v_mov_b32 v106, v102
    v_mov_b32 v107, v103
    v_mov_b32_dpp v100, v96 row_ror:8 row_mask:0xf bank_mask:0x3
    v_mov_b32_dpp v101, v97 row_ror:8 row_mask:0xf bank_mask:0x3
    v_mov_b32_dpp v102, v98 row_ror:8 row_mask:0xf bank_mask:0x3
    v_mov_b32_dpp v103, v99 row_ror:8 row_mask:0xf bank_mask:0x3
    v_mov_b32_dpp v96, v104 row_ror:8 row_mask:0xf bank_mask:0xc
    v_mov_b32_dpp v97, v105 row_ror:8 row_mask:0xf bank_mask:0xc
    v_mov_b32_dpp v98, v106 row_ror:8 row_mask:0xf bank_mask:0xc
    v_mov_b32_dpp v99, v107 row_ror:8 row_mask:0xf bank_mask:0xc
    buffer_store_dwordx4 v[96:99], v7, s[68:71], 0 offen sc1
    buffer_store_dwordx4 v[100:103], v7, s[68:71], s12 offen sc1
    s_endpgm
L_own:
    s_mov_b32 s13, 0
L_b_y:
    s_waitcnt vmcnt(0)
    v_msad_u8 v240, v224, s76, 0
    v_msad_u8 v240, v225, s77, v240
    v_msad_u8 v240, v226, s78, v240
    v_msad_u8 v240, v227, s79, v240
    v_msad_u8 v240, v228, s76, v240
    v_msad_u8 v240, v229, s77, v240
    v_msad_u8 v240, v230, s78, v240
    v_msad_u8 v240, v231, s79, v240
    v_msad_u8 v240, v232, s76, v240
    v_msad_u8 v240, v233, s77, v240
    v_msad_u8 v240, v234, s78, v240
    v_msad_u8 v240, v235, s79, v240
    v_msad_u8 v240, v236, s76, v240
    v_msad_u8 v240, v237, s77, v240
    v_msad_u8 v240, v238, s78, v240
    v_msad_u8 v240, v239, s79, v240
    v_cmp_ne_u32 vcc, 0, v240
    s_nop 1
    s_or_b32 s46, vcc_lo, vcc_hi
    s_cbranch_scc0 L_b_yok
    s_cmp_eq_u32 s45, 0
    s_cbranch_scc1 L_b_yok
    s_lshl_b32 s12, s89, 12
    s_add_u32 s12, s12, 458752
    buffer_load_dwordx4 v[224:227], v22, s[32:35], s12 offen offset:0 sc1
    buffer_load_dwordx4 v[228:231], v22, s[32:35], s12 offen offset:16 sc1
    buffer_load_dwordx4 v[232:235], v22, s[32:35], s12 offen offset:64 sc1
    buffer_load_dwordx4 v[236:239], v22, s[32:35], s12 offen offset:80 sc1
    s_add_u32 s13, s13, 1
    s_cmp_lt_u32 s13, 16384
    s_cbranch_scc1 L_b_y
    s_waitcnt vmcnt(0)
    s_mov_b32 s46, 0
L_b_yok:
    v_add_f32_dpp v224, v224, v224 row_ror:1 row_mask:0xf bank_mask:0xf
    v_add_f32_dpp v225, v225, v225 row_ror:1 row_mask:0xf bank_mask:0xf
    v_add_f32_dpp v226, v226, v226 row_ror:1 row_mask:0xf bank_mask:0xf
    v_add_f32_dpp v227, v227, v227 row_ror:1 row_mask:0xf bank_mask:0xf
    v_add_f32_dpp v228, v228, v228 row_ror:1 row_mask:0xf bank_mask:0xf
    v_add_f32_dpp v229, v229, v229 row_ror:1 row_mask:0xf bank_mask:0xf
    v_add_f32_dpp v230, v230, v230 row_ror:1 row_mask:0xf bank_mask:0xf
    v_add_f32_dpp v231, v231, v231 row_ror:1 row_mask:0xf bank_mask:0xf
    v_add_f32_dpp v232, v232, v232 row_ror:1 row_mask:0xf bank_mask:0xf
    v_add_f32_dpp v233, v233, v233 row_ror:1 row_mask:0xf bank_mask:0xf
    v_add_f32_dpp v234, v234, v234 row_ror:1 row_mask:0xf bank_mask:0xf
    v_add_f32_dpp v235, v235, v235 row_ror:1 row_mask:0xf bank_mask:0xf
    v_add_f32_dpp v236, v236, v236 row_ror:1 row_mask:0xf bank_mask:0xf
    v_add_f32_dpp v237, v237, v237 row_ror:1 row_mask:0xf bank_mask:0xf
    v_add_f32_dpp v238, v238, v238 row_ror:1 row_mask:0xf bank_mask:0xf
    v_add_f32_dpp v239, v239, v239 row_ror:1 row_mask:0xf bank_mask:0xf
    v_add_f32_dpp v224, v224, v224 row_ror:2 row_mask:0xf bank_mask:0xf
    v_add_f32_dpp v225, v225, v225 row_ror:2 row_mask:0xf bank_mask:0xf
    v_add_f32_dpp v226, v226, v226 row_ror:2 row_mask:0xf bank_mask:0xf
    v_add_f32_dpp v227, v227, v227 row_ror:2 row_mask:0xf bank_mask:0xf
    v_add_f32_dpp v228, v228, v228 row_ror:2 row_mask:0xf bank_mask:0xf
    v_add_f32_dpp v229, v229, v229 row_ror:2 row_mask:0xf bank_mask:0xf
    v_add_f32_dpp v230, v230, v230 row_ror:2 row_mask:0xf bank_mask:0xf
    v_add_f32_dpp v231, v231, v231 row_ror:2 row_mask:0xf bank_mask:0xf
    v_add_f32_dpp v232, v232, v232 row_ror:2 row_mask:0xf bank_mask:0xf
    v_add_f32_dpp v233, v233, v233 row_ror:2 row_mask:0xf bank_mask:0xf
    v_add_f32_dpp v234, v234, v234 row_ror:2 row_mask:0xf bank_mask:0xf
    v_add_f32_dpp v235, v235, v235 row_ror:2 row_mask:0xf bank_mask:0xf
    v_add_f32_dpp v236, v236, v236 row_ror:2 row_mask:0xf bank_mask:0xf
    v_add_f32_dpp v237, v237, v237 row_ror:2 row_mask:0xf bank_mask:0xf
    v_add_f32_dpp v238, v238, v238 row_ror:2 row_mask:0xf bank_mask:0xf
    v_add_f32_dpp v239, v239, v239 row_ror:2 row_mask:0xf bank_mask:0xf
    v_add_f32_dpp v224, v224, v224 row_ror:4 row_mask:0xf bank_mask:0xf
    v_add_f32_dpp v225, v225, v225 row_ror:4 row_mask:0xf bank_mask:0xf
    v_add_f32_dpp v226, v226, v226 row_ror:4 row_mask:0xf bank_mask:0xf
    v_add_f32_dpp v227, v227, v227 row_ror:4 row_mask:0xf bank_mask:0xf
    v_add_f32_dpp v228, v228, v228 row_ror:4 row_mask:0xf bank_mask:0xf
    v_add_f32_dpp v229, v229, v229 row_ror:4 row_mask:0xf bank_mask:0xf
    v_add_f32_dpp v230, v230, v230 row_ror:4 row_mask:0xf bank_mask:0xf
    v_add_f32_dpp v231, v231, v231 row_ror:4 row_mask:0xf bank_mask:0xf
    v_add_f32_dpp v232, v232, v232 row_ror:4 row_mask:0xf bank_mask:0xf
    v_add_f32_dpp v233, v233, v233 row_ror:4 row_mask:0xf bank_mask:0xf
    v_add_f32_dpp v234, v234, v234 row_ror:4 row_mask:0xf bank_mask:0xf
    v_add_f32_dpp v235, v235, v235 row_ror:4 row_mask:0xf bank_mask:0xf
    v_add_f32_dpp v236, v236, v236 row_ror:4 row_mask:0xf bank_mask:0xf
    v_add_f32_dpp v237, v237, v237 row_ror:4 row_mask:0xf bank_mask:0xf
    v_add_f32_dpp v238, v238, v238 row_ror:4 row_mask:0xf bank_mask:0xf
    v_add_f32_dpp v239, v239, v239 row_ror:4 row_mask:0xf bank_mask:0xf
    v_add_f32_dpp v224, v224, v224 row_ror:8 row_mask:0xf bank_mask:0xf
    v_add_f32_dpp v225, v225, v225 row_ror:8 row_mask:0xf bank_mask:0xf
    v_add_f32_dpp v226, v226, v226 row_ror:8 row_mask:0xf bank_mask:0xf
    v_add_f32_dpp v227, v227, v227 row_ror:8 row_mask:0xf bank_mask:0xf
    v_add_f32_dpp v228, v228, v228 row_ror:8 row_mask:0xf bank_mask:0xf
    v_add_f32_dpp v229, v229, v229 row_ror:8 row_mask:0xf bank_mask:0xf
    v_add_f32_dpp v230, v230, v230 row_ror:8 row_mask:0xf bank_mask:0xf
    v_add_f32_dpp v231, v231, v231 row_ror:8 row_mask:0xf bank_mask:0xf
    v_add_f32_dpp v232, v232, v232 row_ror:8 row_mask:0xf bank_mask:0xf
    v_add_f32_dpp v233, v233, v233 row_ror:8 row_mask:0xf bank_mask:0xf
    v_add_f32_dpp v234, v234, v234 row_ror:8 row_mask:0xf bank_mask:0xf
    v_add_f32_dpp v235, v235, v235 row_ror:8 row_mask:0xf bank_mask:0xf
    v_add_f32_dpp v236, v236, v236 row_ror:8 row_mask:0xf bank_mask:0xf
    v_add_f32_dpp v237, v237, v237 row_ror:8 row_mask:0xf bank_mask:0xf
    v_add_f32_dpp v238, v238, v238 row_ror:8 row_mask:0xf bank_mask:0xf
    v_add_f32_dpp v239, v239, v239 row_ror:8 row_mask:0xf bank_mask:0xf
    v_cvt_pk_bf16_f32 v240, v224, v225
    v_cvt_pk_bf16_f32 v241, v226, v227
    v_cvt_pk_bf16_f32 v242, v228, v229
    v_cvt_pk_bf16_f32 v243, v230, v231
    v_cvt_pk_bf16_f32 v244, v232, v233
    v_cvt_pk_bf16_f32 v245, v234, v235
    v_cvt_pk_bf16_f32 v246, v236, v237
    v_cvt_pk_bf16_f32 v247, v238, v239
    v_lshlrev_b32 v224, 16, v240
    v_and_b32 v225, 0xffff0000, v240
    v_lshlrev_b32 v226, 16, v241
    v_and_b32 v227, 0xffff0000, v241
    v_lshlrev_b32 v228, 16, v242
    v_and_b32 v229, 0xffff0000, v242
    v_lshlrev_b32 v230, 16, v243
    v_and_b32 v231, 0xffff0000, v243
    v_lshlrev_b32 v232, 16, v244
    v_and_b32 v233, 0xffff0000, v244
    v_lshlrev_b32 v234, 16, v245
    v_and_b32 v235, 0xffff0000, v245
    v_lshlrev_b32 v236, 16, v246
    v_and_b32 v237, 0xffff0000, v246
    v_lshlrev_b32 v238, 16, v247
    v_and_b32 v239, 0xffff0000, v247
    v_pk_mul_f32 v[224:225], v[224:225], s[22:23] op_sel_hi:[1,0]
    v_pk_mul_f32 v[226:227], v[226:227], s[22:23] op_sel_hi:[1,0]
    v_pk_mul_f32 v[228:229], v[228:229], s[22:23] op_sel_hi:[1,0]
    v_pk_mul_f32 v[230:231], v[230:231], s[22:23] op_sel_hi:[1,0]
    v_pk_mul_f32 v[232:233], v[232:233], s[22:23] op_sel_hi:[1,0]
    v_pk_mul_f32 v[234:235], v[234:235], s[22:23] op_sel_hi:[1,0]
    v_pk_mul_f32 v[236:237], v[236:237], s[22:23] op_sel_hi:[1,0]
    v_pk_mul_f32 v[238:239], v[238:239], s[22:23] op_sel_hi:[1,0]
    v_cvt_pk_bf16_f32 v240, v224, v225
    v_cvt_pk_bf16_f32 v241, v226, v227
    v_cvt_pk_bf16_f32 v242, v228, v229
    v_cvt_pk_bf16_f32 v243, v230, v231
    v_cvt_pk_bf16_f32 v244, v232, v233
    v_cvt_pk_bf16_f32 v245, v234, v235
    v_cvt_pk_bf16_f32 v246, v236, v237
    v_cvt_pk_bf16_f32 v247, v238, v239
    v_lshlrev_b32 v224, 16, v240
    v_and_b32 v225, 0xffff0000, v240
    v_lshlrev_b32 v226, 16, v241
    v_and_b32 v227, 0xffff0000, v241
    v_lshlrev_b32 v228, 16, v242
    v_and_b32 v229, 0xffff0000, v242
    v_lshlrev_b32 v230, 16, v243
    v_and_b32 v231, 0xffff0000, v243
    v_lshlrev_b32 v232, 16, v244
    v_and_b32 v233, 0xffff0000, v244
    v_lshlrev_b32 v234, 16, v245
    v_and_b32 v235, 0xffff0000, v245
    v_lshlrev_b32 v236, 16, v246
    v_and_b32 v237, 0xffff0000, v246
    v_lshlrev_b32 v238, 16, v247
    v_and_b32 v239, 0xffff0000, v247
    v_lshlrev_b32 v32, 16, v24
    v_and_b32 v33, 0xffff0000, v24
    v_lshlrev_b32 v34, 16, v25
    v_and_b32 v35, 0xffff0000, v25
    v_lshlrev_b32 v36, 16, v26
    v_and_b32 v37, 0xffff0000, v26
    v_lshlrev_b32 v38, 16, v27
    v_and_b32 v39, 0xffff0000, v27
    v_lshlrev_b32 v40, 16, v28
    v_and_b32 v41, 0xffff0000, v28
    v_lshlrev_b32 v42, 16, v29
    v_and_b32 v43, 0xffff0000, v29
    v_lshlrev_b32 v44, 16, v30
    v_and_b32 v45, 0xffff0000, v30
    v_lshlrev_b32 v46, 16, v31
    v_and_b32 v47, 0xffff0000, v31
    v_pk_add_f32 v[224:225], v[224:225], v[32:33]
    v_pk_add_f32 v[226:227], v[226:227], v[34:35]
    v_pk_add_f32 v[228:229], v[228:229], v[36:37]
    v_pk_add_f32 v[230:231], v[230:231], v[38:39]
    v_pk_add_f32 v[232:233], v[232:233], v[40:41]
    v_pk_add_f32 v[234:235], v[234:235], v[42:43]
    v_pk_add_f32 v[236:237], v[236:237], v[44:45]
    v_pk_add_f32 v[238:239], v[238:239], v[46:47]
    v_cvt_pk_bf16_f32 v240, v224, v225
    v_cvt_pk_bf16_f32 v241, v226, v227
    v_cvt_pk_bf16_f32 v242, v228, v229
    v_cvt_pk_bf16_f32 v243, v230, v231
    v_cvt_pk_bf16_f32 v244, v232, v233
    v_cvt_pk_bf16_f32 v245, v234, v235
    v_cvt_pk_bf16_f32 v246, v236, v237
    v_cvt_pk_bf16_f32 v247, v238, v239
    s_cmp_eq_u32 s46, 0
    s_cselect_b32 s12, s21, -1
    v_cmp_eq_u32 vcc, s12, v6
    s_nop 1
    v_cndmask_b32 v24, v24, v240, vcc
    v_cndmask_b32 v25, v25, v241, vcc
    v_cndmask_b32 v26, v26, v242, vcc
    v_cndmask_b32 v27, v27, v243, vcc
    v_cndmask_b32 v28, v28, v244, vcc
    v_cndmask_b32 v29, v29, v245, vcc
    v_cndmask_b32 v30, v30, v246, vcc
    v_cndmask_b32 v31, v31, v247, vcc
    v_lshlrev_b32 v32, 16, v24
    v_and_b32 v33, 0xffff0000, v24
    v_lshlrev_b32 v34, 16, v25
    v_and_b32 v35, 0xffff0000, v25
    v_lshlrev_b32 v36, 16, v26
    v_and_b32 v37, 0xffff0000, v26
    v_lshlrev_b32 v38, 16, v27
    v_and_b32 v39, 0xffff0000, v27
    v_lshlrev_b32 v40, 16, v28
    v_and_b32 v41, 0xffff0000, v28
    v_lshlrev_b32 v42, 16, v29
    v_and_b32 v43, 0xffff0000, v29
    v_lshlrev_b32 v44, 16, v30
    v_and_b32 v45, 0xffff0000, v30
    v_lshlrev_b32 v46, 16, v31
    v_and_b32 v47, 0xffff0000, v31
    v_pk_mul_f32 v[32:33], v[32:33], v[50:51] op_sel_hi:[1,0]
    v_pk_mul_f32 v[34:35], v[34:35], v[50:51] op_sel_hi:[1,0]
    v_pk_mul_f32 v[36:37], v[36:37], v[50:51] op_sel_hi:[1,0]
    v_pk_mul_f32 v[38:39], v[38:39], v[50:51] op_sel_hi:[1,0]
    v_pk_mul_f32 v[40:41], v[40:41], v[50:51] op_sel_hi:[1,0]
    v_pk_mul_f32 v[42:43], v[42:43], v[50:51] op_sel_hi:[1,0]
    v_pk_mul_f32 v[44:45], v[44:45], v[50:51] op_sel_hi:[1,0]
    v_pk_mul_f32 v[46:47], v[46:47], v[50:51] op_sel_hi:[1,0]
    v_cvt_pk_bf16_f32 v33, v32, v33
    v_cvt_pk_bf16_f32 v35, v34, v35
    v_cvt_pk_bf16_f32 v37, v36, v37
    v_cvt_pk_bf16_f32 v39, v38, v39
    v_cvt_pk_bf16_f32 v41, v40, v41
    v_cvt_pk_bf16_f32 v43, v42, v43
    v_cvt_pk_bf16_f32 v45, v44, v45
    v_cvt_pk_bf16_f32 v47, v46, v47
    v_lshlrev_b32 v32, 16, v33
    v_and_b32 v33, 0xffff0000, v33
    v_lshlrev_b32 v34, 16, v35
    v_and_b32 v35, 0xffff0000, v35
    v_lshlrev_b32 v36, 16, v37
    v_and_b32 v37, 0xffff0000, v37
    v_lshlrev_b32 v38, 16, v39
    v_and_b32 v39, 0xffff0000, v39
    v_lshlrev_b32 v40, 16, v41
    v_and_b32 v41, 0xffff0000, v41
    v_lshlrev_b32 v42, 16, v43
    v_and_b32 v43, 0xffff0000, v43
    v_lshlrev_b32 v44, 16, v45
    v_and_b32 v45, 0xffff0000, v45
    v_lshlrev_b32 v46, 16, v47
    v_and_b32 v47, 0xffff0000, v47
    s_branch L_own_r1
L_end:
    s_endpgm
.section .rodata,"a"
.p2align 6
.amdhsa_kernel gated_mix__linear_kernel_hedgehog__moe_arch_mod__prompt_kernel
  .amdhsa_next_free_vgpr 256
  .amdhsa_next_free_sgpr 102
  .amdhsa_accum_offset 256
  .amdhsa_group_segment_fixed_size 0
  .amdhsa_kernarg_size 104
  .amdhsa_user_sgpr_count 2
  .amdhsa_user_sgpr_kernarg_segment_ptr 1
  .amdhsa_system_sgpr_workgroup_id_x 1
.end_amdhsa_kernel
```

```asm
; @launch grid=(256,1,1) block=(512,1,1) lds=163840
.amdgcn_target "amdgcn-amd-amdhsa--gfx950"
.text
.globl gated_mix__linear_kernel_hedgehog__moe_arch_mod__prompt_kernel
.p2align 12
.p2align 8
.type gated_mix__linear_kernel_hedgehog__moe_arch_mod__prompt_kernel,@function
gated_mix__linear_kernel_hedgehog__moe_arch_mod__prompt_kernel:
    s_cmp_ge_u32 s2, 256
    s_cbranch_scc1 L_end
    s_load_dwordx4 s[4:7], s[0:1], 0
    s_load_dwordx4 s[8:11], s[0:1], 16
    s_load_dwordx16 s[48:63], s[0:1], 40
    v_lshrrev_b32 v1, 6, v0
    v_and_b32 v2, 63, v0
    v_readfirstlane_b32 s20, v1
    s_and_b32 s16, s2, 7
    s_lshr_b32 s17, s2, 3
    s_and_b32 s18, s16, 1
    s_lshl_b32 s18, s18, 3
    s_and_b32 s19, s17, 7
    s_add_u32 s18, s18, s19
    s_lshr_b32 s19, s16, 1
    s_lshl_b32 s19, s19, 2
    s_lshr_b32 s12, s17, 3
    s_add_u32 s19, s19, s12
    v_lshlrev_b32 v5, 4, v2
    s_cmp_lt_u32 s20, 4
    s_cbranch_scc1 L_compute
    s_sub_u32 s21, s20, 4
    s_mov_b32 s68, 0x76543210
    s_mov_b32 s69, 0xfedcba98
    s_lshl_b32 s12, s16, 1
    s_mul_i32 s12, s12, 0x11111111
    s_xor_b32 s68, s68, s12
    s_xor_b32 s69, s69, s12
    v_lshrrev_b32 v4, 3, v2
    v_lshlrev_b32 v9, 11, v4
    v_and_b32 v6, 7, v2
    v_lshrrev_b32 v7, 4, v2
    v_xor_b32 v8, v6, v7
    v_lshl_add_u32 v10, v8, 4, v9
    v_xor_b32 v8, 4, v8
    v_lshl_add_u32 v11, v8, 4, v9
    v_mul_u32_u24 v12, 6144, v4
    v_and_b32 v7, 1, v7
    v_lshlrev_b32 v7, 2, v7
    v_xor_b32 v8, v6, v7
    v_lshl_add_u32 v12, v8, 4, v12
    s_lshl_b32 s12, s18, 18
    s_lshl_b32 s13, s21, 16
    s_add_u32 s12, s12, s13
    s_add_u32 s13, s12, 0
    v_add_u32 v20, s13, v10
    s_add_u32 s13, s12, 15360
    v_add_u32 v21, s13, v11
    s_add_u32 s13, s12, 30720
    v_add_u32 v22, s13, v10
    s_add_u32 s13, s12, 46080
    v_add_u32 v23, s13, v11
    s_lshl_b32 s12, s19, 7
    s_mul_i32 s14, s21, 6
    s_mul_i32 s14, s21, 98304
    s_add_u32 s14, s14, s12
    s_add_u32 s13, s14, 2048
    v_add_u32 v24, s13, v12
    s_add_u32 s13, s14, 50176
    v_add_u32 v25, s13, v12
    s_add_u32 s13, s14, 4096
    v_add_u32 v26, s13, v12
    s_add_u32 s13, s14, 52224
    v_add_u32 v27, s13, v12
    s_add_u32 s13, s14, 0
    v_add_u32 v28, s13, v12
    s_add_u32 s13, s14, 48128
    v_add_u32 v29, s13, v12
    s_lshl_b32 s94, s21, 12
    s_mul_i32 s95, s21, 6144
    s_add_u32 s95, s95, 16384
    s_lshl_b32 s95, s21, 11
    s_waitcnt lgkmcnt(0)
    s_mov_b32 s24, s4
    s_and_b32 s25, s5, 0xffff
    s_mov_b32 s26, 4194304
    s_mov_b32 s27, 0x00020000
    s_mov_b32 s28, s6
    s_and_b32 s29, s7, 0xffff
    s_mov_b32 s30, 6291456
    s_mov_b32 s31, 0x00020000
    s_bfe_u32 s91, s68, 0x40000
    s_lshl_b32 s92, s91, 7
    s_mul_i32 s93, s91, 393216
    s_add_u32 m0, s94, 0
    s_nop 0
    buffer_load_dwordx4 v20, s[24:27], s92 offen offset:0 lds
    buffer_load_dwordx4 v21, s[24:27], s92 offen offset:1024 lds
    buffer_load_dwordx4 v22, s[24:27], s92 offen offset:2048 lds
    buffer_load_dwordx4 v23, s[24:27], s92 offen offset:3072 lds
    s_add_u32 m0, s95, 24576
    s_nop 0
    buffer_load_dwordx4 v24, s[28:31], s93 offen offset:0 lds
    buffer_load_dwordx4 v25, s[28:31], s93 offen offset:1024 lds
    s_add_u32 m0, s95, 32768
    s_nop 0
    buffer_load_dwordx4 v26, s[28:31], s93 offen offset:0 lds
    buffer_load_dwordx4 v27, s[28:31], s93 offen offset:1024 lds
    s_add_u32 m0, s95, 16384
    s_nop 0
    buffer_load_dwordx4 v28, s[28:31], s93 offen offset:0 lds
    buffer_load_dwordx4 v29, s[28:31], s93 offen offset:1024 lds
    s_bfe_u32 s91, s68, 0x40004
    s_lshl_b32 s92, s91, 7
    s_mul_i32 s93, s91, 393216
    s_add_u32 m0, s94, 40960
    s_nop 0
    buffer_load_dwordx4 v20, s[24:27], s92 offen offset:0 lds
    buffer_load_dwordx4 v21, s[24:27], s92 offen offset:1024 lds
    buffer_load_dwordx4 v22, s[24:27], s92 offen offset:2048 lds
    buffer_load_dwordx4 v23, s[24:27], s92 offen offset:3072 lds
    s_add_u32 m0, s95, 65536
    s_nop 0
    buffer_load_dwordx4 v24, s[28:31], s93 offen offset:0 lds
    buffer_load_dwordx4 v25, s[28:31], s93 offen offset:1024 lds
    s_mov_b32 s32, s62
    s_and_b32 s33, s63, 0xffff
    s_mov_b32 s34, 33554432
    s_mov_b32 s35, 0x00020000
    s_mov_b32 s36, s10
    s_and_b32 s37, s11, 0xffff
    s_mov_b32 s38, 2097152
    s_mov_b32 s39, 0x00020000
    s_mov_b32 s40, s50
    s_and_b32 s41, s51, 0xffff
    s_mov_b32 s42, 7340032
    s_mov_b32 s43, 0x00020000
    s_mov_b32 s44, s52
    s_and_b32 s45, s53, 0xffff
    s_mov_b32 s46, 7340032
    s_mov_b32 s47, 0x00020000
    s_mov_b32 s64, s54
    s_and_b32 s65, s55, 0xffff
    s_mov_b32 s66, 7340032
    s_mov_b32 s67, 0x00020000
    s_mov_b32 s72, s60
    s_and_b32 s73, s61, 0xffff
    s_mov_b32 s74, 256
    s_mov_b32 s75, 0x00020000
    s_mov_b32 s76, s8
    s_and_b32 s77, s9, 0xffff
    s_mov_b32 s78, 65536
    s_mov_b32 s79, 0x00020000
    s_mov_b32 s80, s48
    s_and_b32 s81, s49, 0xffff
    s_mov_b32 s82, 2048
    s_mov_b32 s83, 0x00020000
    s_mov_b32 s84, s56
    s_and_b32 s85, s57, 0xffff
    s_mov_b32 s86, 2048
    s_mov_b32 s87, 0x00020000
    s_cmp_gt_u32 s19, 3
    s_subb_u32 s10, s19, 0
    s_cmp_gt_u32 s19, 11
    s_subb_u32 s10, s10, 0
    s_lshl_b32 s10, s10, 4
    s_add_u32 s10, s10, s18
    s_and_b32 s12, s19, 7
    s_cmp_eq_u32 s12, 3
    s_cselect_b32 s10, 224, s10
    s_xor_b32 s11, s18, 2
    s_lshl_b32 s11, s11, 4
    s_add_u32 s11, s11, s19
    s_lshl_b32 s11, s19, 4
    s_add_u32 s11, s11, s18
    s_cmp_lt_u32 s10, 224
    s_cselect_b32 s42, s42, 0
    s_cselect_b32 s46, s46, 0
    s_and_b32 s88, s16, 1
    s_lshl_b32 s88, s88, 3
    s_lshr_b32 s89, s16, 1
    s_lshl_b32 s89, s89, 1
    s_add_u32 s88, s88, s89
    s_lshr_b32 s89, s17, 4
    s_add_u32 s88, s88, s89
    s_and_b32 s89, s17, 15
    v_mov_b32 v13, 0
    v_mul_u32_u24 v30, 57344, v4
    v_lshl_add_u32 v30, v6, 4, v30
    v_lshl_add_u32 v31, v6, 4, v9
    v_lshl_add_u32 v33, v8, 4, v9
    s_lshl_b32 s12, s89, 7
    v_add_u32 v33, s12, v33
    v_lshlrev_b32 v34, 4, v4
    s_and_b32 s12, s10, 3
    s_lshl_b32 s12, s12, 8
    s_lshl_b32 s13, s21, 6
    s_add_u32 s70, s12, s13
    s_mul_i32 s71, s70, 7168
    s_lshr_b32 s12, s10, 2
    s_lshl_b32 s12, s12, 7
    s_add_u32 s71, s71, s12
    s_and_b32 s12, s11, 15
    s_mul_i32 s12, s12, 224
    s_mul_i32 s13, s21, 56
    s_add_u32 s96, s12, s13
    s_lshl_b32 s97, s96, 11
    s_lshr_b32 s12, s11, 4
    s_lshl_b32 s12, s12, 7
    s_add_u32 s97, s97, s12
    s_lshl_b32 s22, s18, 7
    s_lshl_b32 s12, s19, 3
    s_add_u32 s22, s22, s12
    s_lshl_b32 s12, s21, 1
    s_add_u32 s22, s22, s12
    s_xor_b32 s9, s71, 512
    s_and_b32 s12, s18, 7
    s_lshl_b32 s12, s12, 2
    s_add_u32 s12, s12, s21
    s_mul_i32 s12, s12, 6
    v_add_u32 v32, s12, v2
    v_lshrrev_b32 v11, 6, v32
    v_and_b32 v32, 63, v32
    v_mul_u32_u24 v32, 6144, v32
    v_lshl_add_u32 v32, v11, 11, v32
    s_lshl_b32 s12, s19, 7
    v_add_u32 v32, s12, v32
    s_lshl_b32 s12, s2, 6
    s_lshl_b32 s13, s21, 4
    s_add_u32 s12, s12, s13
    v_add_u32 v10, s12, v2
    v_lshlrev_b32 v10, 7, v10
    s_lshl_b32 s12, s17, 6
    s_add_u32 s12, s12, s13
    s_sub_u32 s12, s12, 16
    v_add_u32 v11, s12, v2
    v_and_b32 v12, 1, v11
    v_lshrrev_b32 v11, 1, v11
    v_lshlrev_b32 v11, 11, v11
    v_lshl_add_u32 v11, v12, 10, v11
    v_add_u32 v11, 384, v11
    v_cmp_gt_u32 vcc, 16, v2
    s_nop 1
    v_cndmask_b32 v10, v11, v10, vcc
    s_mul_i32 s12, s2, 13108
    s_lshr_b32 s12, s12, 16
    s_mul_i32 s12, s12, 5
    s_sub_u32 s3, s2, s12
    s_cmp_ge_u32 s10, 224
    s_cselect_b32 s3, 0, s3
    s_cmp_eq_u32 s3, 1
    s_cbranch_scc1 L_var1
    s_cmp_eq_u32 s3, 2
    s_cbranch_scc1 L_var2
    s_cmp_eq_u32 s3, 3
    s_cbranch_scc1 L_var3
    s_cmp_eq_u32 s3, 4
    s_cbranch_scc1 L_var4
    s_branch L_var0
.fill 818, 4, 0xbf800000
L_var0:
    s_nop 0
    s_waitcnt vmcnt(6)
    s_barrier
    s_add_u32 m0, s95, 73728
    s_nop 0
    buffer_load_dwordx4 v26, s[28:31], s93 offen offset:0 lds
    buffer_load_dwordx4 v27, s[28:31], s93 offen offset:1024 lds
    s_add_u32 m0, s95, 57344
    s_nop 0
    buffer_load_dwordx4 v28, s[28:31], s93 offen offset:0 lds
    buffer_load_dwordx4 v29, s[28:31], s93 offen offset:1024 lds
    s_bfe_u32 s91, s68, 0x40008
    s_lshl_b32 s92, s91, 7
    s_mul_i32 s93, s91, 393216
    s_add_u32 m0, s94, 81920
    s_nop 0
    buffer_load_dwordx4 v20, s[24:27], s92 offen offset:0 lds
    buffer_load_dwordx4 v21, s[24:27], s92 offen offset:1024 lds
    buffer_load_dwordx4 v22, s[24:27], s92 offen offset:2048 lds
    buffer_load_dwordx4 v23, s[24:27], s92 offen offset:3072 lds
    s_add_u32 m0, s95, 106496
    s_nop 0
    buffer_load_dwordx4 v24, s[28:31], s93 offen offset:0 lds
    buffer_load_dwordx4 v25, s[28:31], s93 offen offset:1024 lds
    s_add_u32 m0, s95, 114688
    s_nop 0
    buffer_load_dwordx4 v26, s[28:31], s93 offen offset:0 lds
    buffer_load_dwordx4 v27, s[28:31], s93 offen offset:1024 lds
    s_add_u32 m0, s95, 98304
    s_nop 0
    buffer_load_dwordx4 v28, s[28:31], s93 offen offset:0 lds
    buffer_load_dwordx4 v29, s[28:31], s93 offen offset:1024 lds
    s_lshl_b32 s12, s19, 2
    s_add_u32 s12, s12, s21
    s_lshl_b32 s12, s12, 10
    s_lshl_b32 s13, s21, 10
    s_add_u32 m0, s13, 155648
    s_nop 0
    buffer_load_dwordx4 v5, s[76:79], s12 offen lds
    s_lshl_b32 s12, s22, 11
    buffer_load_dwordx4 v[40:43], v5, s[24:27], s12 offen offset:0
    buffer_load_dwordx4 v[44:47], v5, s[24:27], s12 offen offset:1024
    buffer_load_dwordx4 v[48:51], v5, s[24:27], s12 offen offset:2048
    buffer_load_dwordx4 v[52:55], v5, s[24:27], s12 offen offset:3072
    buffer_load_dwordx4 v[56:59], v5, s[80:83], 0 offen offset:0
    buffer_load_dwordx4 v[60:63], v5, s[80:83], 0 offen offset:1024
    buffer_load_dwordx4 v[64:67], v5, s[84:87], 0 offen offset:0
    buffer_load_dwordx4 v[68:71], v5, s[84:87], 0 offen offset:1024
    s_cmp_ge_u32 s10, 224
    s_cbranch_scc1 L_p30_0
    s_add_u32 s12, s71, 0
    buffer_load_dwordx4 v[128:131], v30, s[40:43], s12 offen nt
    s_add_u32 s12, s71, 7168
    buffer_load_dwordx4 v[132:135], v30, s[40:43], s12 offen nt
    s_add_u32 s12, s71, 14336
    buffer_load_dwordx4 v[136:139], v30, s[40:43], s12 offen nt
    s_add_u32 s12, s71, 21504
    buffer_load_dwordx4 v[140:143], v30, s[40:43], s12 offen nt
    s_add_u32 s12, s71, 28672
    buffer_load_dwordx4 v[144:147], v30, s[40:43], s12 offen nt
    s_add_u32 s12, s71, 35840
    buffer_load_dwordx4 v[148:151], v30, s[40:43], s12 offen nt
    s_add_u32 s12, s71, 43008
    buffer_load_dwordx4 v[152:155], v30, s[40:43], s12 offen nt
    s_add_u32 s12, s71, 50176
    buffer_load_dwordx4 v[156:159], v30, s[40:43], s12 offen nt
    s_branch L_p3e0_0
L_p30_0:
    s_mov_b64 exec, 63
    s_bfe_u32 s12, s68, 0x4000c
    s_mul_i32 s12, s12, 393216
    buffer_load_dword v128, v32, s[28:31], s12 offen
    s_bfe_u32 s12, s68, 0x40010
    s_mul_i32 s12, s12, 393216
    buffer_load_dword v132, v32, s[28:31], s12 offen
    s_bfe_u32 s12, s68, 0x40014
    s_mul_i32 s12, s12, 393216
    buffer_load_dword v136, v32, s[28:31], s12 offen
    s_bfe_u32 s12, s68, 0x40018
    s_mul_i32 s12, s12, 393216
    buffer_load_dword v140, v32, s[28:31], s12 offen
    s_bfe_u32 s12, s68, 0x4001c
    s_mul_i32 s12, s12, 393216
    buffer_load_dword v144, v32, s[28:31], s12 offen
    s_bfe_u32 s12, s69, 0x40000
    s_mul_i32 s12, s12, 393216
    buffer_load_dword v148, v32, s[28:31], s12 offen
    s_bfe_u32 s12, s69, 0x40004
    s_mul_i32 s12, s12, 393216
    buffer_load_dword v152, v32, s[28:31], s12 offen
    s_bfe_u32 s12, s69, 0x40008
    s_mul_i32 s12, s12, 393216
    buffer_load_dword v156, v32, s[28:31], s12 offen
    s_mov_b64 exec, -1
L_p3e0_0:
L_bw1_0:
    s_waitcnt vmcnt(27)
    s_barrier
    s_bfe_u32 s91, s68, 0x4000c
    s_lshl_b32 s92, s91, 7
    s_mul_i32 s93, s91, 393216
    s_add_u32 m0, s94, 0
    s_nop 0
    buffer_load_dwordx4 v20, s[24:27], s92 offen offset:0 lds
    s_waitcnt vmcnt(9)
    s_mov_b32 s8, 0xffff0000
    v_lshlrev_b32 v72, 16, v56
    v_and_b32 v56, s8, v56
    v_lshlrev_b32 v73, 16, v64
    v_and_b32 v64, s8, v64
    v_lshlrev_b32 v112, 16, v40
    buffer_load_dwordx4 v21, s[24:27], s92 offen offset:1024 lds
    v_and_b32 v40, s8, v40
    v_lshlrev_b32 v116, 16, v48
    v_and_b32 v48, s8, v48
    v_mul_f32 v113, v112, v73
    v_mul_f32 v114, v40, v64
    v_mul_f32 v90, v112, v72
    v_mul_f32 v117, v116, v73
    buffer_load_dwordx4 v22, s[24:27], s92 offen offset:2048 lds
    v_mul_f32 v118, v48, v64
    v_mul_f32 v92, v116, v72
    v_cvt_pk_bf16_f32 v113, 0, v113
    v_cvt_pk_bf16_f32 v114, 0, v114
    v_fmac_f32 v90, v40, v56
    v_cvt_pk_bf16_f32 v117, 0, v117
    v_cvt_pk_bf16_f32 v118, 0, v118
    buffer_load_dwordx4 v23, s[24:27], s92 offen offset:3072 lds
    v_fmac_f32 v92, v48, v56
    v_add_f32 v91, v113, v114
    v_add_f32 v93, v117, v118
    v_lshlrev_b32 v72, 16, v57
    v_and_b32 v57, s8, v57
    v_lshlrev_b32 v73, 16, v65
    v_and_b32 v65, s8, v65
    s_add_u32 m0, s95, 24576
    s_nop 0
    buffer_load_dwordx4 v24, s[28:31], s93 offen offset:0 lds
    v_lshlrev_b32 v112, 16, v41
    v_and_b32 v41, s8, v41
    v_lshlrev_b32 v116, 16, v49
    v_and_b32 v49, s8, v49
    v_mul_f32 v113, v112, v73
    v_mul_f32 v114, v41, v65
    v_fmac_f32 v90, v112, v72
    s_cmp_lg_u32 s21, 0
    s_cbranch_scc1 L_noclr_0
    v_mov_b32 v104, -1
    v_mov_b32 v105, -1
    v_mov_b32 v106, -1
    v_mov_b32 v107, -1
    s_lshl_b32 s12, s19, 13
    s_lshl_b32 s13, s18, 9
    s_add_u32 s12, s12, s13
    s_add_u32 s12, s12, 32768
    s_lshl_b32 s13, s19, 11
    s_lshl_b32 s90, s18, 7
    s_add_u32 s13, s13, s90
    s_add_u32 s13, s13, 163840
    s_mov_b32 exec_hi, 0
    buffer_store_dwordx4 v[104:107], v5, s[32:35], s12 offen sc1
    s_mov_b32 exec_lo, 255
    buffer_store_dwordx4 v[104:107], v5, s[32:35], s13 offen sc1
    s_mov_b64 exec, -1
L_noclr_0:
    v_mul_f32 v117, v116, v73
    v_mul_f32 v118, v49, v65
    v_fmac_f32 v92, v116, v72
    v_cvt_pk_bf16_f32 v113, 0, v113
    v_cvt_pk_bf16_f32 v114, 0, v114
    v_fmac_f32 v90, v41, v57
    v_cvt_pk_bf16_f32 v117, 0, v117
    v_cvt_pk_bf16_f32 v118, 0, v118
    v_fmac_f32 v92, v49, v57
    v_add_f32 v91, v91, v113
    v_add_f32 v93, v93, v117
    v_add_f32 v91, v91, v114
    v_add_f32 v93, v93, v118
    v_lshlrev_b32 v72, 16, v58
    v_and_b32 v58, s8, v58
    v_lshlrev_b32 v73, 16, v66
    v_and_b32 v66, s8, v66
    v_lshlrev_b32 v112, 16, v42
    v_and_b32 v42, s8, v42
    v_lshlrev_b32 v116, 16, v50
    v_and_b32 v50, s8, v50
    v_mul_f32 v113, v112, v73
    v_mul_f32 v114, v42, v66
    v_fmac_f32 v90, v112, v72
    v_mul_f32 v117, v116, v73
L_bw2_0:
    s_barrier
    s_add_u32 m0, s95, 24576
    s_nop 0
    buffer_load_dwordx4 v25, s[28:31], s93 offen offset:1024 lds
    v_mul_f32 v118, v50, v66
    v_fmac_f32 v92, v116, v72
    v_cvt_pk_bf16_f32 v113, 0, v113
    v_cvt_pk_bf16_f32 v114, 0, v114
    v_fmac_f32 v90, v42, v58
    v_cvt_pk_bf16_f32 v117, 0, v117
    v_cvt_pk_bf16_f32 v118, 0, v118
    s_add_u32 m0, s95, 32768
    s_nop 0
    buffer_load_dwordx4 v26, s[28:31], s93 offen offset:0 lds
    v_fmac_f32 v92, v50, v58
    v_add_f32 v91, v91, v113
    v_add_f32 v93, v93, v117
    v_add_f32 v91, v91, v114
    v_add_f32 v93, v93, v118
    v_lshlrev_b32 v72, 16, v59
    v_and_b32 v59, s8, v59
    buffer_load_dwordx4 v27, s[28:31], s93 offen offset:1024 lds
    v_lshlrev_b32 v73, 16, v67
    v_and_b32 v67, s8, v67
    v_lshlrev_b32 v112, 16, v43
    v_and_b32 v43, s8, v43
    v_lshlrev_b32 v116, 16, v51
    v_and_b32 v51, s8, v51
    v_mul_f32 v113, v112, v73
    s_add_u32 m0, s95, 16384
    s_nop 0
    buffer_load_dwordx4 v28, s[28:31], s93 offen offset:0 lds
    v_mul_f32 v114, v43, v67
    v_fmac_f32 v90, v112, v72
    v_mul_f32 v117, v116, v73
    v_mul_f32 v118, v51, v67
    v_fmac_f32 v92, v116, v72
    v_cvt_pk_bf16_f32 v113, 0, v113
    v_cvt_pk_bf16_f32 v114, 0, v114
    buffer_load_dwordx4 v29, s[28:31], s93 offen offset:1024 lds
    v_fmac_f32 v90, v43, v59
    v_cvt_pk_bf16_f32 v117, 0, v117
    v_cvt_pk_bf16_f32 v118, 0, v118
    v_fmac_f32 v92, v51, v59
    v_add_f32 v91, v91, v113
    v_add_f32 v93, v93, v117
    v_add_f32 v91, v91, v114
    s_bfe_u32 s91, s68, 0x40010
    s_lshl_b32 s92, s91, 7
    s_mul_i32 s93, s91, 393216
    s_add_u32 m0, s94, 40960
    s_nop 0
    buffer_load_dwordx4 v20, s[24:27], s92 offen offset:0 lds
    v_add_f32 v93, v93, v118
    v_lshlrev_b32 v72, 16, v60
    v_and_b32 v60, s8, v60
    v_lshlrev_b32 v73, 16, v68
    v_and_b32 v68, s8, v68
    v_lshlrev_b32 v112, 16, v44
    v_and_b32 v44, s8, v44
    buffer_load_dwordx4 v21, s[24:27], s92 offen offset:1024 lds
    v_lshlrev_b32 v116, 16, v52
    v_and_b32 v52, s8, v52
    v_mul_f32 v113, v112, v73
    v_mul_f32 v114, v44, v68
    v_fmac_f32 v90, v112, v72
    v_mul_f32 v117, v116, v73
    v_mul_f32 v118, v52, v68
    buffer_load_dwordx4 v22, s[24:27], s92 offen offset:2048 lds
    v_fmac_f32 v92, v116, v72
    v_cvt_pk_bf16_f32 v113, 0, v113
    v_cvt_pk_bf16_f32 v114, 0, v114
    v_fmac_f32 v90, v44, v60
    v_cvt_pk_bf16_f32 v117, 0, v117
    v_cvt_pk_bf16_f32 v118, 0, v118
    v_fmac_f32 v92, v52, v60
    buffer_load_dwordx4 v23, s[24:27], s92 offen offset:3072 lds
    v_add_f32 v91, v91, v113
    v_add_f32 v93, v93, v117
    v_add_f32 v91, v91, v114
    v_add_f32 v93, v93, v118
    v_lshlrev_b32 v72, 16, v61
    v_and_b32 v61, s8, v61
    v_lshlrev_b32 v73, 16, v69
    s_add_u32 m0, s95, 65536
    s_nop 0
    buffer_load_dwordx4 v24, s[28:31], s93 offen offset:0 lds
    v_and_b32 v69, s8, v69
    v_lshlrev_b32 v112, 16, v45
    v_and_b32 v45, s8, v45
    v_lshlrev_b32 v116, 16, v53
    v_and_b32 v53, s8, v53
    v_mul_f32 v113, v112, v73
    v_mul_f32 v114, v45, v69
    buffer_load_dwordx4 v25, s[28:31], s93 offen offset:1024 lds
    v_fmac_f32 v90, v112, v72
    v_mul_f32 v117, v116, v73
    v_mul_f32 v118, v53, v69
    v_fmac_f32 v92, v116, v72
    v_cvt_pk_bf16_f32 v113, 0, v113
    v_cvt_pk_bf16_f32 v114, 0, v114
    v_fmac_f32 v90, v45, v61
    s_add_u32 m0, s95, 73728
    s_nop 0
    buffer_load_dwordx4 v26, s[28:31], s93 offen offset:0 lds
    v_cvt_pk_bf16_f32 v117, 0, v117
    v_cvt_pk_bf16_f32 v118, 0, v118
    v_fmac_f32 v92, v53, v61
    v_add_f32 v91, v91, v113
    v_add_f32 v93, v93, v117
    v_add_f32 v91, v91, v114
    v_add_f32 v93, v93, v118
    buffer_load_dword v15, v13, s[72:75], 0 offen offset:4 sc1
    v_lshlrev_b32 v72, 16, v62
    v_and_b32 v62, s8, v62
    v_lshlrev_b32 v73, 16, v70
    v_and_b32 v70, s8, v70
    v_lshlrev_b32 v112, 16, v46
    v_and_b32 v46, s8, v46
    v_lshlrev_b32 v116, 16, v54
    v_and_b32 v54, s8, v54
    v_mul_f32 v113, v112, v73
    v_mul_f32 v114, v46, v70
    v_fmac_f32 v90, v112, v72
    v_mul_f32 v117, v116, v73
    v_mul_f32 v118, v54, v70
    v_fmac_f32 v92, v116, v72
    v_cvt_pk_bf16_f32 v113, 0, v113
    v_cvt_pk_bf16_f32 v114, 0, v114
    v_fmac_f32 v90, v46, v62
    v_cvt_pk_bf16_f32 v117, 0, v117
    v_cvt_pk_bf16_f32 v118, 0, v118
    v_fmac_f32 v92, v54, v62
    v_add_f32 v91, v91, v113
    v_add_f32 v93, v93, v117
    v_add_f32 v91, v91, v114
    v_add_f32 v93, v93, v118
    v_lshlrev_b32 v72, 16, v63
L_bw3_0:
    s_waitcnt vmcnt(8)
    s_barrier
    s_add_u32 m0, s95, 73728
    s_nop 0
    buffer_load_dwordx4 v27, s[28:31], s93 offen offset:1024 lds
    v_and_b32 v63, s8, v63
    v_lshlrev_b32 v73, 16, v71
    v_and_b32 v71, s8, v71
    v_lshlrev_b32 v112, 16, v47
    v_and_b32 v47, s8, v47
    v_lshlrev_b32 v116, 16, v55
    v_and_b32 v55, s8, v55
    s_add_u32 m0, s95, 57344
    s_nop 0
    buffer_load_dwordx4 v28, s[28:31], s93 offen offset:0 lds
    v_mul_f32 v113, v112, v73
    v_mul_f32 v114, v47, v71
    v_fmac_f32 v90, v112, v72
    v_mul_f32 v117, v116, v73
    v_mul_f32 v118, v55, v71
    v_fmac_f32 v92, v116, v72
    v_cvt_pk_bf16_f32 v113, 0, v113
    buffer_load_dwordx4 v29, s[28:31], s93 offen offset:1024 lds
    v_cvt_pk_bf16_f32 v114, 0, v114
    v_fmac_f32 v90, v47, v63
    v_cvt_pk_bf16_f32 v117, 0, v117
    v_cvt_pk_bf16_f32 v118, 0, v118
    v_fmac_f32 v92, v55, v63
    v_add_f32 v91, v91, v113
    v_add_f32 v93, v93, v117
    s_bfe_u32 s91, s68, 0x40014
    s_lshl_b32 s92, s91, 7
    s_mul_i32 s93, s91, 393216
    s_add_u32 m0, s94, 81920
    s_nop 0
    buffer_load_dwordx4 v20, s[24:27], s92 offen offset:0 lds
    v_add_f32 v91, v91, v114
    v_add_f32 v93, v93, v118
    v_add_f32_dpp v90, v90, v90 row_shr:1 row_mask:0xf bank_mask:0xf
    v_add_f32_dpp v91, v91, v91 row_shr:1 row_mask:0xf bank_mask:0xf
    v_add_f32_dpp v92, v92, v92 row_shr:1 row_mask:0xf bank_mask:0xf
    v_add_f32_dpp v93, v93, v93 row_shr:1 row_mask:0xf bank_mask:0xf
    v_add_f32_dpp v90, v90, v90 row_shr:2 row_mask:0xf bank_mask:0xf
    buffer_load_dwordx4 v21, s[24:27], s92 offen offset:1024 lds
    v_add_f32_dpp v91, v91, v91 row_shr:2 row_mask:0xf bank_mask:0xf
    v_add_f32_dpp v92, v92, v92 row_shr:2 row_mask:0xf bank_mask:0xf
    v_add_f32_dpp v93, v93, v93 row_shr:2 row_mask:0xf bank_mask:0xf
    v_add_f32_dpp v90, v90, v90 row_shr:4 row_mask:0xf bank_mask:0xf
    v_add_f32_dpp v91, v91, v91 row_shr:4 row_mask:0xf bank_mask:0xf
    v_add_f32_dpp v92, v92, v92 row_shr:4 row_mask:0xf bank_mask:0xf
    v_add_f32_dpp v93, v93, v93 row_shr:4 row_mask:0xf bank_mask:0xf
    buffer_load_dwordx4 v22, s[24:27], s92 offen offset:2048 lds
    v_add_f32_dpp v90, v90, v90 row_shr:8 row_mask:0xf bank_mask:0xf
    v_add_f32_dpp v91, v91, v91 row_shr:8 row_mask:0xf bank_mask:0xf
    v_add_f32_dpp v92, v92, v92 row_shr:8 row_mask:0xf bank_mask:0xf
    v_add_f32_dpp v93, v93, v93 row_shr:8 row_mask:0xf bank_mask:0xf
    v_add_f32_dpp v90, v90, v90 row_bcast:15 row_mask:0xa bank_mask:0xf
    v_add_f32_dpp v91, v91, v91 row_bcast:15 row_mask:0xa bank_mask:0xf
    v_add_f32_dpp v92, v92, v92 row_bcast:15 row_mask:0xa bank_mask:0xf
    buffer_load_dwordx4 v23, s[24:27], s92 offen offset:3072 lds
    v_add_f32_dpp v93, v93, v93 row_bcast:15 row_mask:0xa bank_mask:0xf
    v_add_f32_dpp v90, v90, v90 row_bcast:31 row_mask:0xc bank_mask:0xf
    v_add_f32_dpp v91, v91, v91 row_bcast:31 row_mask:0xc bank_mask:0xf
    v_add_f32_dpp v92, v92, v92 row_bcast:31 row_mask:0xc bank_mask:0xf
    v_add_f32_dpp v93, v93, v93 row_bcast:31 row_mask:0xc bank_mask:0xf
    v_mov_b32 v97, 0x8000
    v_mov_b32 v98, 0xffff
    s_add_u32 m0, s95, 106496
    s_nop 0
    buffer_load_dwordx4 v24, s[28:31], s93 offen offset:0 lds
    v_cvt_pk_bf16_f32 v94, v90, v91
    v_cvt_pk_bf16_f32 v104, v92, v93
    v_and_b32 v95, 0xffff, v94
    v_and_b32 v96, 0x8000, v94
    v_and_b32 v94, 0xffff0000, v94
    v_cmp_ne_u32 vcc, 0, v96
    v_mul_f32 v94, 0xbfb8aa3b, v94
    buffer_load_dwordx4 v25, s[28:31], s93 offen offset:1024 lds
    v_exp_f32 v94, v94
    v_cndmask_b32 v96, v97, v98, vcc
    v_xor_b32 v95, v95, v96
    v_add_f32 v94, 1.0, v94
    v_lshlrev_b32 v95, 11, v95
    v_rcp_f32 v94, v94
    s_sub_u32 s12, 2047, s22
    v_or_b32 v100, s12, v95
    s_add_u32 m0, s95, 114688
    s_nop 0
    buffer_load_dwordx4 v26, s[28:31], s93 offen offset:0 lds
    v_cvt_pk_bf16_f32 v94, v94, v94
    v_lshlrev_b32 v102, 16, v94
    v_and_b32 v105, 0xffff, v104
    v_and_b32 v106, 0x8000, v104
    v_and_b32 v104, 0xffff0000, v104
    v_cmp_ne_u32 vcc, 0, v106
    v_mul_f32 v104, 0xbfb8aa3b, v104
    buffer_load_dwordx4 v27, s[28:31], s93 offen offset:1024 lds
    v_exp_f32 v104, v104
    v_cndmask_b32 v106, v97, v98, vcc
    v_xor_b32 v105, v105, v106
    v_add_f32 v104, 1.0, v104
    v_lshlrev_b32 v105, 11, v105
    v_rcp_f32 v104, v104
    s_sub_u32 s12, 2046, s22
    v_or_b32 v101, s12, v105
    s_add_u32 m0, s95, 98304
    s_nop 0
    buffer_load_dwordx4 v28, s[28:31], s93 offen offset:0 lds
    v_cvt_pk_bf16_f32 v104, v104, v104
    v_lshlrev_b32 v103, 16, v104
    v_max_u32 v100, v100, v101
    s_lshl_b32 s12, s22, 2
    s_add_u32 s12, s12, 4096
    s_lshl_b32 s13, s21, 2
    s_add_u32 s13, s13, 162880
    v_mov_b32 v14, s13
    s_mov_b32 exec_lo, 0
    s_mov_b32 exec_hi, 0x80000000
    buffer_store_dwordx2 v[102:103], v13, s[32:35], s12 offen sc1
    ds_write_b32 v14, v100
    s_mov_b64 exec, -1
    s_waitcnt lgkmcnt(0)
L_bw4_0:
    s_waitcnt vmcnt(10)
    s_barrier
    s_add_u32 m0, s95, 98304
    s_nop 0
    buffer_load_dwordx4 v29, s[28:31], s93 offen offset:1024 lds
    s_bfe_u32 s91, s68, 0x40018
    s_lshl_b32 s92, s91, 7
    s_mul_i32 s93, s91, 393216
    s_add_u32 m0, s94, 0
    s_nop 0
    buffer_load_dwordx4 v20, s[24:27], s92 offen offset:0 lds
    buffer_load_dwordx4 v21, s[24:27], s92 offen offset:1024 lds
    buffer_load_dwordx4 v22, s[24:27], s92 offen offset:2048 lds
    buffer_load_dwordx4 v23, s[24:27], s92 offen offset:3072 lds
    s_add_u32 m0, s95, 24576
    s_nop 0
    buffer_load_dwordx4 v24, s[28:31], s93 offen offset:0 lds
    buffer_load_dwordx4 v25, s[28:31], s93 offen offset:1024 lds
    s_add_u32 m0, s95, 32768
    s_nop 0
    buffer_load_dwordx4 v26, s[28:31], s93 offen offset:0 lds
    buffer_load_dwordx4 v27, s[28:31], s93 offen offset:1024 lds
    s_add_u32 m0, s95, 16384
    s_nop 0
    buffer_load_dwordx4 v28, s[28:31], s93 offen offset:0 lds
    buffer_load_dwordx4 v29, s[28:31], s93 offen offset:1024 lds
    s_waitcnt vmcnt(11)
L_bw5_0:
    s_waitcnt vmcnt(10)
    s_barrier
    s_bfe_u32 s91, s68, 0x4001c
    s_lshl_b32 s92, s91, 7
    s_mul_i32 s93, s91, 393216
    s_add_u32 m0, s94, 40960
    s_nop 0
    buffer_load_dwordx4 v20, s[24:27], s92 offen offset:0 lds
    buffer_load_dwordx4 v21, s[24:27], s92 offen offset:1024 lds
    buffer_load_dwordx4 v22, s[24:27], s92 offen offset:2048 lds
    buffer_load_dwordx4 v23, s[24:27], s92 offen offset:3072 lds
    s_add_u32 m0, s95, 65536
    s_nop 0
    buffer_load_dwordx4 v24, s[28:31], s93 offen offset:0 lds
    buffer_load_dwordx4 v25, s[28:31], s93 offen offset:1024 lds
    s_add_u32 m0, s95, 73728
    s_nop 0
    buffer_load_dwordx4 v26, s[28:31], s93 offen offset:0 lds
    buffer_load_dwordx4 v27, s[28:31], s93 offen offset:1024 lds
    s_add_u32 m0, s95, 57344
    s_nop 0
    buffer_load_dwordx4 v28, s[28:31], s93 offen offset:0 lds
    buffer_load_dwordx4 v29, s[28:31], s93 offen offset:1024 lds
    s_cmp_ge_u32 s10, 224
    s_cbranch_scc1 L_p31_0
    s_add_u32 s12, s9, 0
    buffer_load_dwordx4 v[160:163], v30, s[44:47], s12 offen nt
    s_add_u32 s12, s9, 7168
    buffer_load_dwordx4 v[164:167], v30, s[44:47], s12 offen nt
    s_add_u32 s12, s9, 14336
    buffer_load_dwordx4 v[168:171], v30, s[44:47], s12 offen nt
    s_add_u32 s12, s9, 21504
    buffer_load_dwordx4 v[172:175], v30, s[44:47], s12 offen nt
    s_add_u32 s12, s9, 28672
    buffer_load_dwordx4 v[176:179], v30, s[44:47], s12 offen nt
    s_add_u32 s12, s9, 35840
    buffer_load_dwordx4 v[180:183], v30, s[44:47], s12 offen nt
    s_add_u32 s12, s9, 43008
    buffer_load_dwordx4 v[184:187], v30, s[44:47], s12 offen nt
    s_add_u32 s12, s9, 50176
    buffer_load_dwordx4 v[188:191], v30, s[44:47], s12 offen nt
    s_branch L_p3e1_0
L_p31_0:
    s_mov_b64 exec, 63
    s_bfe_u32 s12, s69, 0x4000c
    s_mul_i32 s12, s12, 393216
    buffer_load_dword v160, v32, s[28:31], s12 offen
    s_bfe_u32 s12, s69, 0x40010
    s_mul_i32 s12, s12, 393216
    buffer_load_dword v164, v32, s[28:31], s12 offen
    s_bfe_u32 s12, s69, 0x40014
    s_mul_i32 s12, s12, 393216
    buffer_load_dword v168, v32, s[28:31], s12 offen
    s_bfe_u32 s12, s69, 0x40018
    s_mul_i32 s12, s12, 393216
    buffer_load_dword v172, v32, s[28:31], s12 offen
    s_bfe_u32 s12, s69, 0x4001c
    s_mul_i32 s12, s12, 393216
    buffer_load_dword v176, v32, s[28:31], s12 offen
    s_mov_b64 exec, 1
    s_bfe_u32 s12, s69, 0x4001c
    s_mul_i32 s12, s12, 393216
    buffer_load_dword v180, v32, s[28:31], s12 offen
    s_bfe_u32 s12, s69, 0x4001c
    s_mul_i32 s12, s12, 393216
    buffer_load_dword v184, v32, s[28:31], s12 offen
    s_bfe_u32 s12, s69, 0x4001c
    s_mul_i32 s12, s12, 393216
    buffer_load_dword v188, v32, s[28:31], s12 offen
    s_mov_b64 exec, -1
L_p3e1_0:
    s_mov_b32 exec_lo, 0xffff0000
    s_mov_b32 exec_hi, 0
    buffer_load_dword v19, v10, s[36:39], 0 offen
    s_mov_b64 exec, -1
    s_mov_b32 s13, 0
L_tagchk_0:
    v_readfirstlane_b32 s23, v15
    s_nop 1
    s_cmp_lg_u32 s23, 0
    s_cbranch_scc1 L_tagok_0
    s_add_u32 s13, s13, 1
    s_cmp_ge_u32 s13, 16384
    s_cbranch_scc1 L_tagok_0
    buffer_load_dword v15, v13, s[72:75], 0 offen offset:4 sc1
    s_waitcnt vmcnt(0)
    s_branch L_tagchk_0
L_tagok_0:
    s_and_b32 s76, s23, 0xff
    s_bfe_u32 s77, s23, 0x80008
    s_bfe_u32 s78, s23, 0x80010
    s_lshr_b32 s79, s23, 24
    v_and_b32 v35, 3, v2
    v_lshlrev_b32 v35, 3, v35
    v_bfe_u32 v35, s23, v35, 8
    s_cmp_lg_u32 s21, 0
    s_cbranch_scc1 L_nopub_0
    v_mov_b32 v14, 162880
    ds_read_b128 v[104:107], v14
    s_lshl_b32 s12, s2, 3
    s_add_u32 s12, s12, 0
    s_waitcnt lgkmcnt(0)
    v_max3_u32 v104, v104, v105, v106
    v_max_u32 v104, v104, v107
    v_mov_b32 v105, s23
    s_mov_b64 exec, 1
    buffer_store_dwordx2 v[104:105], v13, s[32:35], s12 offen sc1
    s_mov_b64 exec, -1
L_nopub_0:
L_bw6_0:
    s_waitcnt vmcnt(19)
    s_barrier
    s_bfe_u32 s91, s69, 0x40000
    s_lshl_b32 s92, s91, 7
    s_mul_i32 s93, s91, 393216
    s_add_u32 m0, s94, 81920
    s_nop 0
    buffer_load_dwordx4 v20, s[24:27], s92 offen offset:0 lds
    buffer_load_dwordx4 v21, s[24:27], s92 offen offset:1024 lds
    buffer_load_dwordx4 v22, s[24:27], s92 offen offset:2048 lds
    buffer_load_dwordx4 v23, s[24:27], s92 offen offset:3072 lds
    s_add_u32 m0, s95, 106496
    s_nop 0
    buffer_load_dwordx4 v24, s[28:31], s93 offen offset:0 lds
L_bw7_0:
    s_waitcnt vmcnt(14)
    s_barrier
    s_add_u32 m0, s95, 106496
    s_nop 0
    buffer_load_dwordx4 v25, s[28:31], s93 offen offset:1024 lds
    s_add_u32 m0, s95, 114688
    s_nop 0
    buffer_load_dwordx4 v26, s[28:31], s93 offen offset:0 lds
    buffer_load_dwordx4 v27, s[28:31], s93 offen offset:1024 lds
    s_add_u32 m0, s95, 98304
    s_nop 0
    buffer_load_dwordx4 v28, s[28:31], s93 offen offset:0 lds
    buffer_load_dwordx4 v29, s[28:31], s93 offen offset:1024 lds
    s_bfe_u32 s91, s69, 0x40004
    s_lshl_b32 s92, s91, 7
    s_mul_i32 s93, s91, 393216
    s_add_u32 m0, s94, 0
    s_nop 0
    buffer_load_dwordx4 v20, s[24:27], s92 offen offset:0 lds
    buffer_load_dwordx4 v21, s[24:27], s92 offen offset:1024 lds
    buffer_load_dwordx4 v22, s[24:27], s92 offen offset:2048 lds
    buffer_load_dwordx4 v23, s[24:27], s92 offen offset:3072 lds
    s_add_u32 m0, s95, 24576
    s_nop 0
    buffer_load_dwordx4 v24, s[28:31], s93 offen offset:0 lds
    buffer_load_dwordx4 v25, s[28:31], s93 offen offset:1024 lds
    s_add_u32 m0, s95, 32768
    s_nop 0
    buffer_load_dwordx4 v26, s[28:31], s93 offen offset:0 lds
L_bw8_0:
    s_waitcnt vmcnt(7)
    s_barrier
    s_add_u32 m0, s95, 32768
    s_nop 0
    buffer_load_dwordx4 v27, s[28:31], s93 offen offset:1024 lds
    s_add_u32 m0, s95, 16384
    s_nop 0
    buffer_load_dwordx4 v28, s[28:31], s93 offen offset:0 lds
    buffer_load_dwordx4 v29, s[28:31], s93 offen offset:1024 lds
    s_bfe_u32 s91, s69, 0x40008
    s_lshl_b32 s92, s91, 7
    s_mul_i32 s93, s91, 393216
    s_add_u32 m0, s94, 40960
    s_nop 0
    buffer_load_dwordx4 v20, s[24:27], s92 offen offset:0 lds
    buffer_load_dwordx4 v21, s[24:27], s92 offen offset:1024 lds
    buffer_load_dwordx4 v22, s[24:27], s92 offen offset:2048 lds
    buffer_load_dwordx4 v23, s[24:27], s92 offen offset:3072 lds
    s_add_u32 m0, s95, 65536
    s_nop 0
    buffer_load_dwordx4 v24, s[28:31], s93 offen offset:0 lds
    buffer_load_dwordx4 v25, s[28:31], s93 offen offset:1024 lds
    s_add_u32 m0, s95, 73728
    s_nop 0
    buffer_load_dwordx4 v26, s[28:31], s93 offen offset:0 lds
    buffer_load_dwordx4 v27, s[28:31], s93 offen offset:1024 lds
    s_add_u32 m0, s95, 57344
    s_nop 0
    buffer_load_dwordx4 v28, s[28:31], s93 offen offset:0 lds
L_bw9_0:
    s_waitcnt vmcnt(9)
    s_barrier
    s_add_u32 m0, s95, 57344
    s_nop 0
    buffer_load_dwordx4 v29, s[28:31], s93 offen offset:1024 lds
    s_bfe_u32 s91, s69, 0x4000c
    s_lshl_b32 s92, s91, 7
    s_mul_i32 s93, s91, 393216
    s_add_u32 m0, s94, 122880
    s_nop 0
    buffer_load_dwordx4 v20, s[24:27], s92 offen offset:0 lds
    buffer_load_dwordx4 v21, s[24:27], s92 offen offset:1024 lds
    buffer_load_dwordx4 v22, s[24:27], s92 offen offset:2048 lds
    buffer_load_dwordx4 v23, s[24:27], s92 offen offset:3072 lds
    s_add_u32 m0, s95, 106496
    s_nop 0
    buffer_load_dwordx4 v24, s[28:31], s93 offen offset:0 lds
    buffer_load_dwordx4 v25, s[28:31], s93 offen offset:1024 lds
    s_add_u32 m0, s95, 114688
    s_nop 0
    buffer_load_dwordx4 v26, s[28:31], s93 offen offset:0 lds
    buffer_load_dwordx4 v27, s[28:31], s93 offen offset:1024 lds
    s_mov_b32 s12, 0
    buffer_load_dwordx4 v[104:107], v5, s[32:35], s12 offen offset:0 sc1
    buffer_load_dwordx4 v[108:111], v5, s[32:35], s12 offen offset:1024 sc1
L_bw10_0:
    s_waitcnt vmcnt(10)
    s_barrier
    s_bfe_u32 s91, s69, 0x40010
    s_lshl_b32 s92, s91, 7
    s_mul_i32 s93, s91, 393216
    s_add_u32 m0, s94, 139264
    s_nop 0
    buffer_load_dwordx4 v20, s[24:27], s92 offen offset:0 lds
    buffer_load_dwordx4 v21, s[24:27], s92 offen offset:1024 lds
    buffer_load_dwordx4 v22, s[24:27], s92 offen offset:2048 lds
    buffer_load_dwordx4 v23, s[24:27], s92 offen offset:3072 lds
    s_add_u32 m0, s95, 24576
    s_nop 0
    buffer_load_dwordx4 v24, s[28:31], s93 offen offset:0 lds
    buffer_load_dwordx4 v25, s[28:31], s93 offen offset:1024 lds
    s_add_u32 m0, s95, 32768
    s_nop 0
    buffer_load_dwordx4 v26, s[28:31], s93 offen offset:0 lds
    buffer_load_dwordx4 v27, s[28:31], s93 offen offset:1024 lds
    s_add_u32 s12, s97, 0
    buffer_load_dwordx4 v[192:195], v31, s[64:67], s12 offen nt
    s_add_u32 s12, s97, 16384
    buffer_load_dwordx4 v[196:199], v31, s[64:67], s12 offen nt
    s_add_u32 s12, s97, 32768
    buffer_load_dwordx4 v[200:203], v31, s[64:67], s12 offen nt
    s_add_u32 s12, s97, 49152
    buffer_load_dwordx4 v[204:207], v31, s[64:67], s12 offen nt
    s_add_u32 s12, s97, 65536
    buffer_load_dwordx4 v[208:211], v31, s[64:67], s12 offen nt
    s_add_u32 s12, s97, 81920
    buffer_load_dwordx4 v[212:215], v31, s[64:67], s12 offen nt
    s_add_u32 s12, s97, 98304
    buffer_load_dwordx4 v[216:219], v31, s[64:67], s12 offen nt
L_bw11_0:
    s_waitcnt vmcnt(17)
    s_barrier
    s_bfe_u32 s91, s69, 0x40014
    s_lshl_b32 s92, s91, 7
    s_mul_i32 s93, s91, 393216
    s_add_u32 m0, s94, 40960
    s_nop 0
    buffer_load_dwordx4 v20, s[24:27], s92 offen offset:0 lds
    s_waitcnt vmcnt(16)
    s_mov_b32 s13, 0
    v_xor_b32 v105, s23, v105
    v_xor_b32 v107, s23, v107
    v_xor_b32 v109, s23, v109
    v_xor_b32 v111, s23, v111
    v_or3_b32 v105, v105, v107, v109
    v_or_b32 v105, v105, v111
    v_cmp_ne_u32 vcc, 0, v105
    s_cbranch_vccnz L_keyre_0
L_keyok_0:
    buffer_load_dwordx4 v21, s[24:27], s92 offen offset:1024 lds
    v_max3_u32 v104, v104, v106, v108
    v_max_u32 v104, v104, v110
    s_nop 1
    v_max_u32_dpp v104, v104, v104 row_shr:1 row_mask:0xf bank_mask:0xf
    s_nop 1
    v_max_u32_dpp v104, v104, v104 row_shr:2 row_mask:0xf bank_mask:0xf
    s_nop 1
    v_max_u32_dpp v104, v104, v104 row_shr:4 row_mask:0xf bank_mask:0xf
    s_nop 1
    v_max_u32_dpp v104, v104, v104 row_shr:8 row_mask:0xf bank_mask:0xf
    s_nop 1
    v_max_u32_dpp v104, v104, v104 row_bcast:15 row_mask:0xa bank_mask:0xf
    buffer_load_dwordx4 v22, s[24:27], s92 offen offset:2048 lds
    s_nop 0
    v_max_u32_dpp v104, v104, v104 row_bcast:31 row_mask:0xc bank_mask:0xf
    s_nop 0
    v_readlane_b32 s14, v104, 63
    s_nop 1
    s_and_b32 s15, s14, 2047
    s_sub_u32 s15, 2047, s15
    s_lshl_b32 s12, s15, 11
    s_lshl_b32 s13, s70, 1
    s_add_u32 s12, s12, s13
    buffer_load_dwordx4 v[36:39], v34, s[24:27], s12 offen
    s_lshr_b32 s12, s14, 11
    s_and_b32 s13, s12, 0x8000
    s_cmp_lg_u32 s13, 0
    s_mov_b32 s13, 0xffff
    s_cselect_b32 s13, 0x8000, s13
    s_xor_b32 s12, s12, s13
    s_lshl_b32 s12, s12, 16
    v_mov_b32 v105, s12
    buffer_load_dwordx4 v23, s[24:27], s92 offen offset:3072 lds
    v_mul_f32 v105, 0xbfb8aa3b, v105
    v_exp_f32 v105, v105
    s_nop 0
    v_add_f32 v105, 1.0, v105
    v_rcp_f32 v105, v105
    s_nop 0
    v_cvt_pk_bf16_f32 v105, v105, v105
    v_lshlrev_b32 v105, 16, v105
    s_add_u32 s12, s15, 1
    v_mov_b32 v104, s12
    s_add_u32 m0, s95, 65536
    s_nop 0
    buffer_load_dwordx4 v24, s[28:31], s93 offen offset:0 lds
    v_mov_b32 v106, s23
    v_readfirstlane_b32 s14, v105
    v_mov_b32 v14, 162864
    s_mov_b64 exec, 1
    ds_write_b96 v14, v[104:106]
    s_mov_b64 exec, -1
    s_waitcnt lgkmcnt(0)
L_bw12_0:
    s_waitcnt vmcnt(13)
    s_barrier
    s_add_u32 m0, s95, 65536
    s_nop 0
    buffer_load_dwordx4 v25, s[28:31], s93 offen offset:1024 lds
    s_waitcnt vmcnt(3)
    s_mov_b32 s8, 0xffff0000
    v_lshlrev_b32 v40, 16, v36
    v_and_b32 v41, s8, v36
    v_lshlrev_b32 v42, 16, v37
    v_and_b32 v43, s8, v37
    v_lshlrev_b32 v44, 16, v38
    s_add_u32 m0, s95, 73728
    s_nop 0
    buffer_load_dwordx4 v26, s[28:31], s93 offen offset:0 lds
    v_and_b32 v45, s8, v38
    v_lshlrev_b32 v46, 16, v39
    v_and_b32 v47, s8, v39
    v_lshlrev_b32 v48, 16, v128
    v_lshlrev_b32 v49, 16, v129
    v_and_b32 v128, s8, v128
    v_and_b32 v129, s8, v129
    v_mul_f32 v220, v48, v40
    v_mul_f32 v222, v49, v40
    v_mul_f32 v221, v128, v40
    v_mul_f32 v223, v129, v40
    v_lshlrev_b32 v50, 16, v130
    v_lshlrev_b32 v51, 16, v131
    v_and_b32 v130, s8, v130
    buffer_load_dwordx4 v27, s[28:31], s93 offen offset:1024 lds
    v_and_b32 v131, s8, v131
    v_mul_f32 v224, v50, v40
    v_mul_f32 v226, v51, v40
    v_mul_f32 v225, v130, v40
    v_mul_f32 v227, v131, v40
    v_lshlrev_b32 v48, 16, v160
    v_lshlrev_b32 v49, 16, v161
    v_and_b32 v160, s8, v160
    v_and_b32 v161, s8, v161
    v_mul_f32 v228, v48, v40
    v_mul_f32 v230, v49, v40
    v_mul_f32 v229, v160, v40
    v_mul_f32 v231, v161, v40
    v_lshlrev_b32 v50, 16, v162
    s_bfe_u32 s91, s69, 0x40018
    s_lshl_b32 s92, s91, 7
    s_mul_i32 s93, s91, 393216
    s_add_u32 m0, s94, 81920
    s_nop 0
    buffer_load_dwordx4 v20, s[24:27], s92 offen offset:0 lds
    v_lshlrev_b32 v51, 16, v163
    v_and_b32 v162, s8, v162
    v_and_b32 v163, s8, v163
    v_mul_f32 v232, v50, v40
    v_mul_f32 v234, v51, v40
    v_mul_f32 v233, v162, v40
    v_mul_f32 v235, v163, v40
    buffer_load_dwordx4 v21, s[24:27], s92 offen offset:1024 lds
    v_lshlrev_b32 v48, 16, v132
    v_lshlrev_b32 v49, 16, v133
    v_and_b32 v132, s8, v132
    v_and_b32 v133, s8, v133
    v_fmac_f32 v220, v48, v41
    v_fmac_f32 v222, v49, v41
    v_fmac_f32 v221, v132, v41
    buffer_load_dwordx4 v22, s[24:27], s92 offen offset:2048 lds
    v_fmac_f32 v223, v133, v41
    v_lshlrev_b32 v50, 16, v134
    v_lshlrev_b32 v51, 16, v135
    v_and_b32 v134, s8, v134
    v_and_b32 v135, s8, v135
    v_fmac_f32 v224, v50, v41
    v_fmac_f32 v226, v51, v41
    buffer_load_dwordx4 v23, s[24:27], s92 offen offset:3072 lds
    v_fmac_f32 v225, v134, v41
    v_fmac_f32 v227, v135, v41
    v_lshlrev_b32 v48, 16, v164
    v_lshlrev_b32 v49, 16, v165
    v_and_b32 v164, s8, v164
    v_and_b32 v165, s8, v165
    v_fmac_f32 v228, v48, v41
    s_add_u32 m0, s95, 106496
    s_nop 0
    buffer_load_dwordx4 v24, s[28:31], s93 offen offset:0 lds
    v_fmac_f32 v230, v49, v41
    v_fmac_f32 v229, v164, v41
    v_fmac_f32 v231, v165, v41
    v_lshlrev_b32 v50, 16, v166
    v_lshlrev_b32 v51, 16, v167
    v_and_b32 v166, s8, v166
    v_and_b32 v167, s8, v167
    buffer_load_dwordx4 v25, s[28:31], s93 offen offset:1024 lds
    v_fmac_f32 v232, v50, v41
    v_fmac_f32 v234, v51, v41
    v_fmac_f32 v233, v166, v41
    v_fmac_f32 v235, v167, v41
    v_lshlrev_b32 v48, 16, v136
    v_lshlrev_b32 v49, 16, v137
    v_and_b32 v136, s8, v136
    s_add_u32 m0, s95, 114688
    s_nop 0
    buffer_load_dwordx4 v26, s[28:31], s93 offen offset:0 lds
    v_and_b32 v137, s8, v137
    v_fmac_f32 v220, v48, v42
    v_fmac_f32 v222, v49, v42
    v_fmac_f32 v221, v136, v42
    v_fmac_f32 v223, v137, v42
    v_lshlrev_b32 v50, 16, v138
    v_lshlrev_b32 v51, 16, v139
    v_and_b32 v138, s8, v138
    v_and_b32 v139, s8, v139
    v_fmac_f32 v224, v50, v42
    v_fmac_f32 v226, v51, v42
    v_fmac_f32 v225, v138, v42
    v_fmac_f32 v227, v139, v42
    v_lshlrev_b32 v48, 16, v168
    v_lshlrev_b32 v49, 16, v169
    v_and_b32 v168, s8, v168
    v_and_b32 v169, s8, v169
    v_fmac_f32 v228, v48, v42
    v_fmac_f32 v230, v49, v42
    v_fmac_f32 v229, v168, v42
    v_fmac_f32 v231, v169, v42
    v_lshlrev_b32 v50, 16, v170
    v_lshlrev_b32 v51, 16, v171
    v_and_b32 v170, s8, v170
    v_and_b32 v171, s8, v171
    v_fmac_f32 v232, v50, v42
    v_fmac_f32 v234, v51, v42
    v_fmac_f32 v233, v170, v42
    v_fmac_f32 v235, v171, v42
    v_lshlrev_b32 v48, 16, v140
    v_lshlrev_b32 v49, 16, v141
    v_and_b32 v140, s8, v140
    v_and_b32 v141, s8, v141
    v_fmac_f32 v220, v48, v43
    v_fmac_f32 v222, v49, v43
    v_fmac_f32 v221, v140, v43
    v_fmac_f32 v223, v141, v43
    v_lshlrev_b32 v50, 16, v142
    v_lshlrev_b32 v51, 16, v143
L_bw13_0:
    s_waitcnt vmcnt(7)
    s_barrier
    s_add_u32 m0, s95, 114688
    s_nop 0
    buffer_load_dwordx4 v27, s[28:31], s93 offen offset:1024 lds
    v_and_b32 v142, s8, v142
    v_and_b32 v143, s8, v143
    v_fmac_f32 v224, v50, v43
    v_fmac_f32 v226, v51, v43
    v_fmac_f32 v225, v142, v43
    v_fmac_f32 v227, v143, v43
    v_lshlrev_b32 v48, 16, v172
    v_lshlrev_b32 v49, 16, v173
    v_and_b32 v172, s8, v172
    v_and_b32 v173, s8, v173
    v_fmac_f32 v228, v48, v43
    v_fmac_f32 v230, v49, v43
    v_fmac_f32 v229, v172, v43
    v_fmac_f32 v231, v173, v43
    s_bfe_u32 s91, s69, 0x4001c
    s_lshl_b32 s92, s91, 7
    s_mul_i32 s93, s91, 393216
    s_add_u32 m0, s94, 0
    s_nop 0
    buffer_load_dwordx4 v20, s[24:27], s92 offen offset:0 lds
    v_lshlrev_b32 v50, 16, v174
    v_lshlrev_b32 v51, 16, v175
    v_and_b32 v174, s8, v174
    v_and_b32 v175, s8, v175
    v_fmac_f32 v232, v50, v43
    v_fmac_f32 v234, v51, v43
    v_fmac_f32 v233, v174, v43
    buffer_load_dwordx4 v21, s[24:27], s92 offen offset:1024 lds
    v_fmac_f32 v235, v175, v43
    v_lshlrev_b32 v48, 16, v144
    v_lshlrev_b32 v49, 16, v145
    v_and_b32 v144, s8, v144
    v_and_b32 v145, s8, v145
    v_fmac_f32 v220, v48, v44
    v_fmac_f32 v222, v49, v44
    buffer_load_dwordx4 v22, s[24:27], s92 offen offset:2048 lds
    v_fmac_f32 v221, v144, v44
    v_fmac_f32 v223, v145, v44
    v_lshlrev_b32 v50, 16, v146
    v_lshlrev_b32 v51, 16, v147
    v_and_b32 v146, s8, v146
    v_and_b32 v147, s8, v147
    v_fmac_f32 v224, v50, v44
    buffer_load_dwordx4 v23, s[24:27], s92 offen offset:3072 lds
    v_fmac_f32 v226, v51, v44
    v_fmac_f32 v225, v146, v44
    v_fmac_f32 v227, v147, v44
    v_lshlrev_b32 v48, 16, v176
    v_lshlrev_b32 v49, 16, v177
    v_and_b32 v176, s8, v176
    v_and_b32 v177, s8, v177
    s_add_u32 m0, s95, 24576
    s_nop 0
    buffer_load_dwordx4 v24, s[28:31], s93 offen offset:0 lds
    v_fmac_f32 v228, v48, v44
    v_fmac_f32 v230, v49, v44
    v_fmac_f32 v229, v176, v44
    v_fmac_f32 v231, v177, v44
    v_lshlrev_b32 v50, 16, v178
    v_lshlrev_b32 v51, 16, v179
    v_and_b32 v178, s8, v178
    buffer_load_dwordx4 v25, s[28:31], s93 offen offset:1024 lds
    v_and_b32 v179, s8, v179
    v_fmac_f32 v232, v50, v44
    v_fmac_f32 v234, v51, v44
    v_fmac_f32 v233, v178, v44
    v_fmac_f32 v235, v179, v44
    v_lshlrev_b32 v48, 16, v148
    v_lshlrev_b32 v49, 16, v149
    s_add_u32 m0, s95, 32768
    s_nop 0
    buffer_load_dwordx4 v26, s[28:31], s93 offen offset:0 lds
    v_and_b32 v148, s8, v148
    v_and_b32 v149, s8, v149
    v_fmac_f32 v220, v48, v45
    v_fmac_f32 v222, v49, v45
    v_fmac_f32 v221, v148, v45
    v_fmac_f32 v223, v149, v45
    v_lshlrev_b32 v50, 16, v150
    v_lshlrev_b32 v51, 16, v151
    v_and_b32 v150, s8, v150
    v_and_b32 v151, s8, v151
    v_fmac_f32 v224, v50, v45
    v_fmac_f32 v226, v51, v45
    v_fmac_f32 v225, v150, v45
    v_fmac_f32 v227, v151, v45
    buffer_load_dwordx4 v27, s[28:31], s93 offen offset:1024 lds
    v_lshlrev_b32 v48, 16, v180
    v_lshlrev_b32 v49, 16, v181
    v_and_b32 v180, s8, v180
    v_and_b32 v181, s8, v181
    v_fmac_f32 v228, v48, v45
    v_fmac_f32 v230, v49, v45
    v_fmac_f32 v229, v180, v45
    v_fmac_f32 v231, v181, v45
    v_lshlrev_b32 v50, 16, v182
    v_lshlrev_b32 v51, 16, v183
    v_and_b32 v182, s8, v182
    v_and_b32 v183, s8, v183
    v_fmac_f32 v232, v50, v45
    v_fmac_f32 v234, v51, v45
    v_fmac_f32 v233, v182, v45
    v_fmac_f32 v235, v183, v45
    v_lshlrev_b32 v48, 16, v152
    v_lshlrev_b32 v49, 16, v153
    v_and_b32 v152, s8, v152
    v_and_b32 v153, s8, v153
    v_fmac_f32 v220, v48, v46
    v_fmac_f32 v222, v49, v46
    v_fmac_f32 v221, v152, v46
    v_fmac_f32 v223, v153, v46
    v_lshlrev_b32 v50, 16, v154
    v_lshlrev_b32 v51, 16, v155
    v_and_b32 v154, s8, v154
    v_and_b32 v155, s8, v155
    v_fmac_f32 v224, v50, v46
    v_fmac_f32 v226, v51, v46
    v_fmac_f32 v225, v154, v46
    v_fmac_f32 v227, v155, v46
    v_lshlrev_b32 v48, 16, v184
    v_lshlrev_b32 v49, 16, v185
    v_and_b32 v184, s8, v184
    v_and_b32 v185, s8, v185
    v_fmac_f32 v228, v48, v46
    v_fmac_f32 v230, v49, v46
    v_fmac_f32 v229, v184, v46
L_bw14_0:
    s_waitcnt vmcnt(8)
    s_barrier
    s_bfe_u32 s12, s69, 0x4000c
    s_mul_i32 s12, s12, 393216
    s_add_u32 m0, s95, 16384
    s_nop 0
    buffer_load_dwordx4 v28, s[28:31], s12 offen offset:0 lds
    buffer_load_dwordx4 v29, s[28:31], s12 offen offset:1024 lds
    s_bfe_u32 s12, s69, 0x40010
    s_mul_i32 s12, s12, 393216
    s_add_u32 m0, s95, 57344
    s_nop 0
    buffer_load_dwordx4 v28, s[28:31], s12 offen offset:0 lds
    buffer_load_dwordx4 v29, s[28:31], s12 offen offset:1024 lds
    s_mul_i32 s12, s21, 16
    s_add_u32 s12, s12, 0
    s_and_b32 s90, s88, 1
    s_lshl_b32 s90, s90, 6
    s_xor_b32 s12, s12, s90
    s_lshl_b32 s12, s12, 14
    s_add_u32 s90, s12, 0
    buffer_load_dwordx4 v[84:87], v33, s[36:39], s90 offen
    s_add_u32 s90, s12, 16384
    buffer_load_dwordx4 v[88:91], v33, s[36:39], s90 offen
    s_add_u32 s90, s12, 32768
    buffer_load_dwordx4 v[92:95], v33, s[36:39], s90 offen
    s_add_u32 s90, s12, 49152
    buffer_load_dwordx4 v[96:99], v33, s[36:39], s90 offen
    s_add_u32 s90, s12, 65536
    buffer_load_dwordx4 v[100:103], v33, s[36:39], s90 offen
    s_add_u32 s90, s12, 81920
    buffer_load_dwordx4 v[116:119], v33, s[36:39], s90 offen
    s_add_u32 s90, s12, 98304
    buffer_load_dwordx4 v[120:123], v33, s[36:39], s90 offen
    s_add_u32 s90, s12, 114688
    buffer_load_dwordx4 v[124:127], v33, s[36:39], s90 offen
    s_add_u32 s90, s12, 131072
    buffer_load_dwordx4 v[64:67], v33, s[36:39], s90 offen
    v_fmac_f32 v231, v185, v46
    v_lshlrev_b32 v50, 16, v186
    v_lshlrev_b32 v51, 16, v187
    v_and_b32 v186, s8, v186
    v_and_b32 v187, s8, v187
    v_fmac_f32 v232, v50, v46
    v_fmac_f32 v234, v51, v46
    v_fmac_f32 v233, v186, v46
    v_fmac_f32 v235, v187, v46
    v_lshlrev_b32 v48, 16, v156
    v_lshlrev_b32 v49, 16, v157
    v_and_b32 v156, s8, v156
    v_and_b32 v157, s8, v157
    v_fmac_f32 v220, v48, v47
    v_fmac_f32 v222, v49, v47
    v_fmac_f32 v221, v156, v47
    v_fmac_f32 v223, v157, v47
    v_lshlrev_b32 v50, 16, v158
    v_lshlrev_b32 v51, 16, v159
    v_and_b32 v158, s8, v158
    v_and_b32 v159, s8, v159
    v_fmac_f32 v224, v50, v47
    v_fmac_f32 v226, v51, v47
    v_fmac_f32 v225, v158, v47
    v_fmac_f32 v227, v159, v47
L_bw15_0:
    s_waitcnt vmcnt(13)
    s_barrier
    v_lshlrev_b32 v48, 16, v188
    v_lshlrev_b32 v49, 16, v189
    v_and_b32 v188, s8, v188
    v_and_b32 v189, s8, v189
    v_fmac_f32 v228, v48, v47
    v_fmac_f32 v230, v49, v47
    v_fmac_f32 v229, v188, v47
    v_fmac_f32 v231, v189, v47
    v_lshlrev_b32 v50, 16, v190
    v_lshlrev_b32 v51, 16, v191
    v_and_b32 v190, s8, v190
    v_and_b32 v191, s8, v191
    v_fmac_f32 v232, v50, v47
    v_fmac_f32 v234, v51, v47
    v_fmac_f32 v233, v190, v47
    v_fmac_f32 v235, v191, v47
    v_permlane32_swap_b32 v220, v228
    v_permlane32_swap_b32 v221, v229
    v_permlane32_swap_b32 v222, v230
    v_permlane32_swap_b32 v223, v231
    v_permlane32_swap_b32 v224, v232
    v_permlane32_swap_b32 v225, v233
    v_permlane32_swap_b32 v226, v234
    v_permlane32_swap_b32 v227, v235
    v_add_f32 v220, v220, v228
    v_add_f32 v221, v221, v229
    v_add_f32 v222, v222, v230
    v_add_f32 v223, v223, v231
    v_add_f32 v224, v224, v232
    v_add_f32 v225, v225, v233
    v_add_f32 v226, v226, v234
    v_add_f32 v227, v227, v235
    v_permlane16_swap_b32 v220, v224
    v_permlane16_swap_b32 v221, v225
    v_permlane16_swap_b32 v222, v226
    v_permlane16_swap_b32 v223, v227
    v_add_f32 v220, v220, v224
    v_add_f32 v221, v221, v225
    v_add_f32 v222, v222, v226
    v_add_f32 v223, v223, v227
    v_add_f32_dpp v220, v220, v220 row_ror:8 row_mask:0xf bank_mask:0xf
    v_add_f32_dpp v221, v221, v221 row_ror:8 row_mask:0xf bank_mask:0xf
    v_add_f32_dpp v222, v222, v222 row_ror:8 row_mask:0xf bank_mask:0xf
    v_add_f32_dpp v223, v223, v223 row_ror:8 row_mask:0xf bank_mask:0xf
    s_branch L_varend
.fill 421, 4, 0xbf800000
L_var1:
    s_nop 0
    s_waitcnt vmcnt(6)
    s_barrier
    s_add_u32 m0, s95, 73728
    s_nop 0
    buffer_load_dwordx4 v26, s[28:31], s93 offen offset:0 lds
    buffer_load_dwordx4 v27, s[28:31], s93 offen offset:1024 lds
    s_add_u32 m0, s95, 57344
    s_nop 0
    buffer_load_dwordx4 v28, s[28:31], s93 offen offset:0 lds
    buffer_load_dwordx4 v29, s[28:31], s93 offen offset:1024 lds
    s_bfe_u32 s91, s68, 0x40008
    s_lshl_b32 s92, s91, 7
    s_mul_i32 s93, s91, 393216
    s_add_u32 m0, s94, 81920
    s_nop 0
    buffer_load_dwordx4 v20, s[24:27], s92 offen offset:0 lds
    buffer_load_dwordx4 v21, s[24:27], s92 offen offset:1024 lds
    buffer_load_dwordx4 v22, s[24:27], s92 offen offset:2048 lds
    buffer_load_dwordx4 v23, s[24:27], s92 offen offset:3072 lds
    s_add_u32 m0, s95, 106496
    s_nop 0
    buffer_load_dwordx4 v24, s[28:31], s93 offen offset:0 lds
    buffer_load_dwordx4 v25, s[28:31], s93 offen offset:1024 lds
    s_add_u32 m0, s95, 114688
    s_nop 0
    buffer_load_dwordx4 v26, s[28:31], s93 offen offset:0 lds
    buffer_load_dwordx4 v27, s[28:31], s93 offen offset:1024 lds
    s_add_u32 m0, s95, 98304
    s_nop 0
    buffer_load_dwordx4 v28, s[28:31], s93 offen offset:0 lds
    buffer_load_dwordx4 v29, s[28:31], s93 offen offset:1024 lds
    s_lshl_b32 s12, s19, 2
    s_add_u32 s12, s12, s21
    s_lshl_b32 s12, s12, 10
    s_lshl_b32 s13, s21, 10
    s_add_u32 m0, s13, 155648
    s_nop 0
    buffer_load_dwordx4 v5, s[76:79], s12 offen lds
    s_lshl_b32 s12, s22, 11
    buffer_load_dwordx4 v[40:43], v5, s[24:27], s12 offen offset:0
    buffer_load_dwordx4 v[44:47], v5, s[24:27], s12 offen offset:1024
    buffer_load_dwordx4 v[48:51], v5, s[24:27], s12 offen offset:2048
    buffer_load_dwordx4 v[52:55], v5, s[24:27], s12 offen offset:3072
    buffer_load_dwordx4 v[56:59], v5, s[80:83], 0 offen offset:0
    buffer_load_dwordx4 v[60:63], v5, s[80:83], 0 offen offset:1024
    buffer_load_dwordx4 v[64:67], v5, s[84:87], 0 offen offset:0
    buffer_load_dwordx4 v[68:71], v5, s[84:87], 0 offen offset:1024
L_bw1_1:
    s_waitcnt vmcnt(19)
    s_barrier
    s_bfe_u32 s91, s68, 0x4000c
    s_lshl_b32 s92, s91, 7
    s_mul_i32 s93, s91, 393216
    s_add_u32 m0, s94, 0
    s_nop 0
    buffer_load_dwordx4 v20, s[24:27], s92 offen offset:0 lds
    s_waitcnt vmcnt(1)
    s_mov_b32 s8, 0xffff0000
    v_lshlrev_b32 v72, 16, v56
    v_and_b32 v56, s8, v56
    v_lshlrev_b32 v73, 16, v64
    v_and_b32 v64, s8, v64
    v_lshlrev_b32 v112, 16, v40
    buffer_load_dwordx4 v21, s[24:27], s92 offen offset:1024 lds
    v_and_b32 v40, s8, v40
    v_lshlrev_b32 v116, 16, v48
    v_and_b32 v48, s8, v48
    v_mul_f32 v113, v112, v73
    v_mul_f32 v114, v40, v64
    v_mul_f32 v90, v112, v72
    v_mul_f32 v117, v116, v73
    buffer_load_dwordx4 v22, s[24:27], s92 offen offset:2048 lds
    v_mul_f32 v118, v48, v64
    v_mul_f32 v92, v116, v72
    v_cvt_pk_bf16_f32 v113, 0, v113
    v_cvt_pk_bf16_f32 v114, 0, v114
    v_fmac_f32 v90, v40, v56
    v_cvt_pk_bf16_f32 v117, 0, v117
    v_cvt_pk_bf16_f32 v118, 0, v118
    buffer_load_dwordx4 v23, s[24:27], s92 offen offset:3072 lds
    v_fmac_f32 v92, v48, v56
    v_add_f32 v91, v113, v114
    v_add_f32 v93, v117, v118
    v_lshlrev_b32 v72, 16, v57
    v_and_b32 v57, s8, v57
    v_lshlrev_b32 v73, 16, v65
    v_and_b32 v65, s8, v65
    s_add_u32 m0, s95, 24576
    s_nop 0
    buffer_load_dwordx4 v24, s[28:31], s93 offen offset:0 lds
    v_lshlrev_b32 v112, 16, v41
    v_and_b32 v41, s8, v41
    v_lshlrev_b32 v116, 16, v49
    v_and_b32 v49, s8, v49
    v_mul_f32 v113, v112, v73
    v_mul_f32 v114, v41, v65
    v_fmac_f32 v90, v112, v72
    buffer_load_dwordx4 v25, s[28:31], s93 offen offset:1024 lds
    v_mul_f32 v117, v116, v73
    v_mul_f32 v118, v49, v65
    v_fmac_f32 v92, v116, v72
    v_cvt_pk_bf16_f32 v113, 0, v113
    v_cvt_pk_bf16_f32 v114, 0, v114
    v_fmac_f32 v90, v41, v57
    v_cvt_pk_bf16_f32 v117, 0, v117
    s_add_u32 m0, s95, 32768
    s_nop 0
    buffer_load_dwordx4 v26, s[28:31], s93 offen offset:0 lds
    v_cvt_pk_bf16_f32 v118, 0, v118
    v_fmac_f32 v92, v49, v57
    v_add_f32 v91, v91, v113
    v_add_f32 v93, v93, v117
    v_add_f32 v91, v91, v114
    v_add_f32 v93, v93, v118
    v_lshlrev_b32 v72, 16, v58
    buffer_load_dwordx4 v27, s[28:31], s93 offen offset:1024 lds
    v_and_b32 v58, s8, v58
    v_lshlrev_b32 v73, 16, v66
    v_and_b32 v66, s8, v66
    v_lshlrev_b32 v112, 16, v42
    v_and_b32 v42, s8, v42
    v_lshlrev_b32 v116, 16, v50
    v_and_b32 v50, s8, v50
    s_add_u32 m0, s95, 16384
    s_nop 0
    buffer_load_dwordx4 v28, s[28:31], s93 offen offset:0 lds
    v_mul_f32 v113, v112, v73
    v_mul_f32 v114, v42, v66
    v_fmac_f32 v90, v112, v72
    v_mul_f32 v117, v116, v73
    v_mul_f32 v118, v50, v66
    v_fmac_f32 v92, v116, v72
    v_cvt_pk_bf16_f32 v113, 0, v113
    buffer_load_dwordx4 v29, s[28:31], s93 offen offset:1024 lds
    v_cvt_pk_bf16_f32 v114, 0, v114
    v_fmac_f32 v90, v42, v58
    v_cvt_pk_bf16_f32 v117, 0, v117
    v_cvt_pk_bf16_f32 v118, 0, v118
    v_fmac_f32 v92, v50, v58
    v_add_f32 v91, v91, v113
    v_add_f32 v93, v93, v117
    s_cmp_lg_u32 s21, 0
    s_cbranch_scc1 L_noclr_1
    v_mov_b32 v104, -1
    v_mov_b32 v105, -1
    v_mov_b32 v106, -1
    v_mov_b32 v107, -1
    s_lshl_b32 s12, s19, 13
    s_lshl_b32 s13, s18, 9
    s_add_u32 s12, s12, s13
    s_add_u32 s12, s12, 32768
    s_lshl_b32 s13, s19, 11
    s_lshl_b32 s90, s18, 7
    s_add_u32 s13, s13, s90
    s_add_u32 s13, s13, 163840
    s_mov_b32 exec_hi, 0
    buffer_store_dwordx4 v[104:107], v5, s[32:35], s12 offen sc1
    s_mov_b32 exec_lo, 255
    buffer_store_dwordx4 v[104:107], v5, s[32:35], s13 offen sc1
    s_mov_b64 exec, -1
L_noclr_1:
    s_cmp_ge_u32 s10, 224
    s_cbranch_scc1 L_p30_1
    s_add_u32 s12, s71, 0
    buffer_load_dwordx4 v[128:131], v30, s[40:43], s12 offen nt
    s_add_u32 s12, s71, 7168
    buffer_load_dwordx4 v[132:135], v30, s[40:43], s12 offen nt
    s_add_u32 s12, s71, 14336
    buffer_load_dwordx4 v[136:139], v30, s[40:43], s12 offen nt
    s_add_u32 s12, s71, 21504
    buffer_load_dwordx4 v[140:143], v30, s[40:43], s12 offen nt
    s_add_u32 s12, s71, 28672
    buffer_load_dwordx4 v[144:147], v30, s[40:43], s12 offen nt
    s_add_u32 s12, s71, 35840
    buffer_load_dwordx4 v[148:151], v30, s[40:43], s12 offen nt
    s_add_u32 s12, s71, 43008
    buffer_load_dwordx4 v[152:155], v30, s[40:43], s12 offen nt
    s_add_u32 s12, s71, 50176
    buffer_load_dwordx4 v[156:159], v30, s[40:43], s12 offen nt
    s_branch L_p3e0_1
L_p30_1:
    s_mov_b64 exec, 63
    s_bfe_u32 s12, s68, 0x4000c
    s_mul_i32 s12, s12, 393216
    buffer_load_dword v128, v32, s[28:31], s12 offen
    s_bfe_u32 s12, s68, 0x40010
    s_mul_i32 s12, s12, 393216
    buffer_load_dword v132, v32, s[28:31], s12 offen
    s_bfe_u32 s12, s68, 0x40014
    s_mul_i32 s12, s12, 393216
    buffer_load_dword v136, v32, s[28:31], s12 offen
    s_bfe_u32 s12, s68, 0x40018
    s_mul_i32 s12, s12, 393216
    buffer_load_dword v140, v32, s[28:31], s12 offen
    s_bfe_u32 s12, s68, 0x4001c
    s_mul_i32 s12, s12, 393216
    buffer_load_dword v144, v32, s[28:31], s12 offen
    s_bfe_u32 s12, s69, 0x40000
    s_mul_i32 s12, s12, 393216
    buffer_load_dword v148, v32, s[28:31], s12 offen
    s_bfe_u32 s12, s69, 0x40004
    s_mul_i32 s12, s12, 393216
    buffer_load_dword v152, v32, s[28:31], s12 offen
    s_bfe_u32 s12, s69, 0x40008
    s_mul_i32 s12, s12, 393216
    buffer_load_dword v156, v32, s[28:31], s12 offen
    s_mov_b64 exec, -1
L_p3e0_1:
    v_add_f32 v91, v91, v114
    v_add_f32 v93, v93, v118
    v_lshlrev_b32 v72, 16, v59
    v_and_b32 v59, s8, v59
    v_lshlrev_b32 v73, 16, v67
    v_and_b32 v67, s8, v67
    v_lshlrev_b32 v112, 16, v43
    v_and_b32 v43, s8, v43
    v_lshlrev_b32 v116, 16, v51
    v_and_b32 v51, s8, v51
    v_mul_f32 v113, v112, v73
    v_mul_f32 v114, v43, v67
    v_fmac_f32 v90, v112, v72
    v_mul_f32 v117, v116, v73
    v_mul_f32 v118, v51, v67
    v_fmac_f32 v92, v116, v72
    v_cvt_pk_bf16_f32 v113, 0, v113
    v_cvt_pk_bf16_f32 v114, 0, v114
    v_fmac_f32 v90, v43, v59
    v_cvt_pk_bf16_f32 v117, 0, v117
    v_cvt_pk_bf16_f32 v118, 0, v118
    v_fmac_f32 v92, v51, v59
    v_add_f32 v91, v91, v113
    v_add_f32 v93, v93, v117
    v_add_f32 v91, v91, v114
L_bw2_1:
    s_barrier
    s_bfe_u32 s91, s68, 0x40010
    s_lshl_b32 s92, s91, 7
    s_mul_i32 s93, s91, 393216
    s_add_u32 m0, s94, 40960
    s_nop 0
    buffer_load_dwordx4 v20, s[24:27], s92 offen offset:0 lds
    v_add_f32 v93, v93, v118
    v_lshlrev_b32 v72, 16, v60
    v_and_b32 v60, s8, v60
    v_lshlrev_b32 v73, 16, v68
    v_and_b32 v68, s8, v68
    v_lshlrev_b32 v112, 16, v44
    v_and_b32 v44, s8, v44
    buffer_load_dwordx4 v21, s[24:27], s92 offen offset:1024 lds
    v_lshlrev_b32 v116, 16, v52
    v_and_b32 v52, s8, v52
    v_mul_f32 v113, v112, v73
    v_mul_f32 v114, v44, v68
    v_fmac_f32 v90, v112, v72
    v_mul_f32 v117, v116, v73
    v_mul_f32 v118, v52, v68
    buffer_load_dwordx4 v22, s[24:27], s92 offen offset:2048 lds
    v_fmac_f32 v92, v116, v72
    v_cvt_pk_bf16_f32 v113, 0, v113
    v_cvt_pk_bf16_f32 v114, 0, v114
    v_fmac_f32 v90, v44, v60
    v_cvt_pk_bf16_f32 v117, 0, v117
    v_cvt_pk_bf16_f32 v118, 0, v118
    v_fmac_f32 v92, v52, v60
    buffer_load_dwordx4 v23, s[24:27], s92 offen offset:3072 lds
    v_add_f32 v91, v91, v113
    v_add_f32 v93, v93, v117
    v_add_f32 v91, v91, v114
    v_add_f32 v93, v93, v118
    v_lshlrev_b32 v72, 16, v61
    v_and_b32 v61, s8, v61
    v_lshlrev_b32 v73, 16, v69
    s_add_u32 m0, s95, 65536
    s_nop 0
    buffer_load_dwordx4 v24, s[28:31], s93 offen offset:0 lds
    v_and_b32 v69, s8, v69
    v_lshlrev_b32 v112, 16, v45
    v_and_b32 v45, s8, v45
    v_lshlrev_b32 v116, 16, v53
    v_and_b32 v53, s8, v53
    v_mul_f32 v113, v112, v73
    v_mul_f32 v114, v45, v69
    buffer_load_dword v15, v13, s[72:75], 0 offen offset:4 sc1
    v_fmac_f32 v90, v112, v72
    v_mul_f32 v117, v116, v73
    v_mul_f32 v118, v53, v69
    v_fmac_f32 v92, v116, v72
    v_cvt_pk_bf16_f32 v113, 0, v113
    v_cvt_pk_bf16_f32 v114, 0, v114
    v_fmac_f32 v90, v45, v61
    v_cvt_pk_bf16_f32 v117, 0, v117
    v_cvt_pk_bf16_f32 v118, 0, v118
    v_fmac_f32 v92, v53, v61
    v_add_f32 v91, v91, v113
    v_add_f32 v93, v93, v117
    v_add_f32 v91, v91, v114
    v_add_f32 v93, v93, v118
    v_lshlrev_b32 v72, 16, v62
    v_and_b32 v62, s8, v62
    v_lshlrev_b32 v73, 16, v70
    v_and_b32 v70, s8, v70
    v_lshlrev_b32 v112, 16, v46
    v_and_b32 v46, s8, v46
    v_lshlrev_b32 v116, 16, v54
    v_and_b32 v54, s8, v54
    v_mul_f32 v113, v112, v73
    v_mul_f32 v114, v46, v70
    v_fmac_f32 v90, v112, v72
L_bw3_1:
    s_waitcnt vmcnt(14)
    s_barrier
    s_add_u32 m0, s95, 65536
    s_nop 0
    buffer_load_dwordx4 v25, s[28:31], s93 offen offset:1024 lds
    v_mul_f32 v117, v116, v73
    v_mul_f32 v118, v54, v70
    v_fmac_f32 v92, v116, v72
    v_cvt_pk_bf16_f32 v113, 0, v113
    v_cvt_pk_bf16_f32 v114, 0, v114
    v_fmac_f32 v90, v46, v62
    v_cvt_pk_bf16_f32 v117, 0, v117
    s_add_u32 m0, s95, 73728
    s_nop 0
    buffer_load_dwordx4 v26, s[28:31], s93 offen offset:0 lds
    v_cvt_pk_bf16_f32 v118, 0, v118
    v_fmac_f32 v92, v54, v62
    v_add_f32 v91, v91, v113
    v_add_f32 v93, v93, v117
    v_add_f32 v91, v91, v114
    v_add_f32 v93, v93, v118
    v_lshlrev_b32 v72, 16, v63
    buffer_load_dwordx4 v27, s[28:31], s93 offen offset:1024 lds
    v_and_b32 v63, s8, v63
    v_lshlrev_b32 v73, 16, v71
    v_and_b32 v71, s8, v71
    v_lshlrev_b32 v112, 16, v47
    v_and_b32 v47, s8, v47
    v_lshlrev_b32 v116, 16, v55
    v_and_b32 v55, s8, v55
    s_add_u32 m0, s95, 57344
    s_nop 0
    buffer_load_dwordx4 v28, s[28:31], s93 offen offset:0 lds
    v_mul_f32 v113, v112, v73
    v_mul_f32 v114, v47, v71
    v_fmac_f32 v90, v112, v72
    v_mul_f32 v117, v116, v73
    v_mul_f32 v118, v55, v71
    v_fmac_f32 v92, v116, v72
    v_cvt_pk_bf16_f32 v113, 0, v113
    buffer_load_dwordx4 v29, s[28:31], s93 offen offset:1024 lds
    v_cvt_pk_bf16_f32 v114, 0, v114
    v_fmac_f32 v90, v47, v63
    v_cvt_pk_bf16_f32 v117, 0, v117
    v_cvt_pk_bf16_f32 v118, 0, v118
    v_fmac_f32 v92, v55, v63
    v_add_f32 v91, v91, v113
    v_add_f32 v93, v93, v117
    s_bfe_u32 s91, s68, 0x40014
    s_lshl_b32 s92, s91, 7
    s_mul_i32 s93, s91, 393216
    s_add_u32 m0, s94, 81920
    s_nop 0
    buffer_load_dwordx4 v20, s[24:27], s92 offen offset:0 lds
    v_add_f32 v91, v91, v114
    v_add_f32 v93, v93, v118
    v_add_f32_dpp v90, v90, v90 row_shr:1 row_mask:0xf bank_mask:0xf
    v_add_f32_dpp v91, v91, v91 row_shr:1 row_mask:0xf bank_mask:0xf
    v_add_f32_dpp v92, v92, v92 row_shr:1 row_mask:0xf bank_mask:0xf
    v_add_f32_dpp v93, v93, v93 row_shr:1 row_mask:0xf bank_mask:0xf
    v_add_f32_dpp v90, v90, v90 row_shr:2 row_mask:0xf bank_mask:0xf
    buffer_load_dwordx4 v21, s[24:27], s92 offen offset:1024 lds
    v_add_f32_dpp v91, v91, v91 row_shr:2 row_mask:0xf bank_mask:0xf
    v_add_f32_dpp v92, v92, v92 row_shr:2 row_mask:0xf bank_mask:0xf
    v_add_f32_dpp v93, v93, v93 row_shr:2 row_mask:0xf bank_mask:0xf
    v_add_f32_dpp v90, v90, v90 row_shr:4 row_mask:0xf bank_mask:0xf
    v_add_f32_dpp v91, v91, v91 row_shr:4 row_mask:0xf bank_mask:0xf
    v_add_f32_dpp v92, v92, v92 row_shr:4 row_mask:0xf bank_mask:0xf
    v_add_f32_dpp v93, v93, v93 row_shr:4 row_mask:0xf bank_mask:0xf
    buffer_load_dwordx4 v22, s[24:27], s92 offen offset:2048 lds
    v_add_f32_dpp v90, v90, v90 row_shr:8 row_mask:0xf bank_mask:0xf
    v_add_f32_dpp v91, v91, v91 row_shr:8 row_mask:0xf bank_mask:0xf
    v_add_f32_dpp v92, v92, v92 row_shr:8 row_mask:0xf bank_mask:0xf
    v_add_f32_dpp v93, v93, v93 row_shr:8 row_mask:0xf bank_mask:0xf
    v_add_f32_dpp v90, v90, v90 row_bcast:15 row_mask:0xa bank_mask:0xf
    v_add_f32_dpp v91, v91, v91 row_bcast:15 row_mask:0xa bank_mask:0xf
    v_add_f32_dpp v92, v92, v92 row_bcast:15 row_mask:0xa bank_mask:0xf
    buffer_load_dwordx4 v23, s[24:27], s92 offen offset:3072 lds
    v_add_f32_dpp v93, v93, v93 row_bcast:15 row_mask:0xa bank_mask:0xf
    v_add_f32_dpp v90, v90, v90 row_bcast:31 row_mask:0xc bank_mask:0xf
    v_add_f32_dpp v91, v91, v91 row_bcast:31 row_mask:0xc bank_mask:0xf
    v_add_f32_dpp v92, v92, v92 row_bcast:31 row_mask:0xc bank_mask:0xf
    v_add_f32_dpp v93, v93, v93 row_bcast:31 row_mask:0xc bank_mask:0xf
    v_mov_b32 v97, 0x8000
    v_mov_b32 v98, 0xffff
    s_add_u32 m0, s95, 106496
    s_nop 0
    buffer_load_dwordx4 v24, s[28:31], s93 offen offset:0 lds
    v_cvt_pk_bf16_f32 v94, v90, v91
    v_cvt_pk_bf16_f32 v104, v92, v93
    v_and_b32 v95, 0xffff, v94
    v_and_b32 v96, 0x8000, v94
    v_and_b32 v94, 0xffff0000, v94
    v_cmp_ne_u32 vcc, 0, v96
    v_mul_f32 v94, 0xbfb8aa3b, v94
    buffer_load_dwordx4 v25, s[28:31], s93 offen offset:1024 lds
    v_exp_f32 v94, v94
    v_cndmask_b32 v96, v97, v98, vcc
    v_xor_b32 v95, v95, v96
    v_add_f32 v94, 1.0, v94
    v_lshlrev_b32 v95, 11, v95
    v_rcp_f32 v94, v94
    s_sub_u32 s12, 2047, s22
    v_or_b32 v100, s12, v95
    s_add_u32 m0, s95, 114688
    s_nop 0
    buffer_load_dwordx4 v26, s[28:31], s93 offen offset:0 lds
    v_cvt_pk_bf16_f32 v94, v94, v94
    v_lshlrev_b32 v102, 16, v94
    v_and_b32 v105, 0xffff, v104
    v_and_b32 v106, 0x8000, v104
    v_and_b32 v104, 0xffff0000, v104
    v_cmp_ne_u32 vcc, 0, v106
    v_mul_f32 v104, 0xbfb8aa3b, v104
    v_exp_f32 v104, v104
    v_cndmask_b32 v106, v97, v98, vcc
    v_xor_b32 v105, v105, v106
    v_add_f32 v104, 1.0, v104
    v_lshlrev_b32 v105, 11, v105
    v_rcp_f32 v104, v104
    s_sub_u32 s12, 2046, s22
    v_or_b32 v101, s12, v105
    v_cvt_pk_bf16_f32 v104, v104, v104
    v_lshlrev_b32 v103, 16, v104
    v_max_u32 v100, v100, v101
    s_lshl_b32 s12, s22, 2
    s_add_u32 s12, s12, 4096
    s_lshl_b32 s13, s21, 2
    s_add_u32 s13, s13, 162880
    v_mov_b32 v14, s13
    s_mov_b32 exec_lo, 0
    s_mov_b32 exec_hi, 0x80000000
    buffer_store_dwordx2 v[102:103], v13, s[32:35], s12 offen sc1
    ds_write_b32 v14, v100
    s_mov_b64 exec, -1
    s_waitcnt lgkmcnt(0)
L_bw4_1:
    s_waitcnt vmcnt(8)
    s_barrier
    s_add_u32 m0, s95, 114688
    s_nop 0
    buffer_load_dwordx4 v27, s[28:31], s93 offen offset:1024 lds
    s_add_u32 m0, s95, 98304
    s_nop 0
    buffer_load_dwordx4 v28, s[28:31], s93 offen offset:0 lds
    buffer_load_dwordx4 v29, s[28:31], s93 offen offset:1024 lds
    s_bfe_u32 s91, s68, 0x40018
    s_lshl_b32 s92, s91, 7
    s_mul_i32 s93, s91, 393216
    s_add_u32 m0, s94, 0
    s_nop 0
    buffer_load_dwordx4 v20, s[24:27], s92 offen offset:0 lds
    buffer_load_dwordx4 v21, s[24:27], s92 offen offset:1024 lds
    buffer_load_dwordx4 v22, s[24:27], s92 offen offset:2048 lds
    buffer_load_dwordx4 v23, s[24:27], s92 offen offset:3072 lds
    s_add_u32 m0, s95, 24576
    s_nop 0
    buffer_load_dwordx4 v24, s[28:31], s93 offen offset:0 lds
    buffer_load_dwordx4 v25, s[28:31], s93 offen offset:1024 lds
    s_add_u32 m0, s95, 32768
    s_nop 0
    buffer_load_dwordx4 v26, s[28:31], s93 offen offset:0 lds
    buffer_load_dwordx4 v27, s[28:31], s93 offen offset:1024 lds
    s_add_u32 m0, s95, 16384
    s_nop 0
    buffer_load_dwordx4 v28, s[28:31], s93 offen offset:0 lds
    s_waitcnt vmcnt(12)
L_bw5_1:
    s_waitcnt vmcnt(9)
    s_barrier
    s_add_u32 m0, s95, 16384
    s_nop 0
    buffer_load_dwordx4 v29, s[28:31], s93 offen offset:1024 lds
    s_bfe_u32 s91, s68, 0x4001c
    s_lshl_b32 s92, s91, 7
    s_mul_i32 s93, s91, 393216
    s_add_u32 m0, s94, 40960
    s_nop 0
    buffer_load_dwordx4 v20, s[24:27], s92 offen offset:0 lds
    buffer_load_dwordx4 v21, s[24:27], s92 offen offset:1024 lds
    buffer_load_dwordx4 v22, s[24:27], s92 offen offset:2048 lds
    buffer_load_dwordx4 v23, s[24:27], s92 offen offset:3072 lds
    s_add_u32 m0, s95, 65536
    s_nop 0
    buffer_load_dwordx4 v24, s[28:31], s93 offen offset:0 lds
    buffer_load_dwordx4 v25, s[28:31], s93 offen offset:1024 lds
    s_add_u32 m0, s95, 73728
    s_nop 0
    buffer_load_dwordx4 v26, s[28:31], s93 offen offset:0 lds
    buffer_load_dwordx4 v27, s[28:31], s93 offen offset:1024 lds
    s_add_u32 m0, s95, 57344
    s_nop 0
    buffer_load_dwordx4 v28, s[28:31], s93 offen offset:0 lds
    buffer_load_dwordx4 v29, s[28:31], s93 offen offset:1024 lds
    s_mov_b32 s13, 0
L_tagchk_1:
    v_readfirstlane_b32 s23, v15
    s_nop 1
    s_cmp_lg_u32 s23, 0
    s_cbranch_scc1 L_tagok_1
    s_add_u32 s13, s13, 1
    s_cmp_ge_u32 s13, 16384
    s_cbranch_scc1 L_tagok_1
    buffer_load_dword v15, v13, s[72:75], 0 offen offset:4 sc1
    s_waitcnt vmcnt(0)
    s_branch L_tagchk_1
L_tagok_1:
    s_and_b32 s76, s23, 0xff
    s_bfe_u32 s77, s23, 0x80008
    s_bfe_u32 s78, s23, 0x80010
    s_lshr_b32 s79, s23, 24
    v_and_b32 v35, 3, v2
    v_lshlrev_b32 v35, 3, v35
    v_bfe_u32 v35, s23, v35, 8
    s_cmp_lg_u32 s21, 0
    s_cbranch_scc1 L_nopub_1
    v_mov_b32 v14, 162880
    ds_read_b128 v[104:107], v14
    s_lshl_b32 s12, s2, 3
    s_add_u32 s12, s12, 0
    s_waitcnt lgkmcnt(0)
    v_max3_u32 v104, v104, v105, v106
    v_max_u32 v104, v104, v107
    v_mov_b32 v105, s23
    s_mov_b64 exec, 1
    buffer_store_dwordx2 v[104:105], v13, s[32:35], s12 offen sc1
    s_mov_b64 exec, -1
L_nopub_1:
L_bw6_1:
    s_waitcnt vmcnt(10)
    s_barrier
    s_bfe_u32 s91, s69, 0x40000
    s_lshl_b32 s92, s91, 7
    s_mul_i32 s93, s91, 393216
    s_add_u32 m0, s94, 81920
    s_nop 0
    buffer_load_dwordx4 v20, s[24:27], s92 offen offset:0 lds
    buffer_load_dwordx4 v21, s[24:27], s92 offen offset:1024 lds
    buffer_load_dwordx4 v22, s[24:27], s92 offen offset:2048 lds
    buffer_load_dwordx4 v23, s[24:27], s92 offen offset:3072 lds
    s_add_u32 m0, s95, 106496
    s_nop 0
    buffer_load_dwordx4 v24, s[28:31], s93 offen offset:0 lds
    buffer_load_dwordx4 v25, s[28:31], s93 offen offset:1024 lds
    s_add_u32 m0, s95, 114688
    s_nop 0
    buffer_load_dwordx4 v26, s[28:31], s93 offen offset:0 lds
    buffer_load_dwordx4 v27, s[28:31], s93 offen offset:1024 lds
    s_add_u32 m0, s95, 98304
    s_nop 0
    buffer_load_dwordx4 v28, s[28:31], s93 offen offset:0 lds
    buffer_load_dwordx4 v29, s[28:31], s93 offen offset:1024 lds
    s_cmp_ge_u32 s10, 224
    s_cbranch_scc1 L_p31_1
    s_add_u32 s12, s9, 0
    buffer_load_dwordx4 v[160:163], v30, s[44:47], s12 offen nt
    s_add_u32 s12, s9, 7168
    buffer_load_dwordx4 v[164:167], v30, s[44:47], s12 offen nt
    s_add_u32 s12, s9, 14336
    buffer_load_dwordx4 v[168:171], v30, s[44:47], s12 offen nt
    s_add_u32 s12, s9, 21504
    buffer_load_dwordx4 v[172:175], v30, s[44:47], s12 offen nt
    s_add_u32 s12, s9, 28672
    buffer_load_dwordx4 v[176:179], v30, s[44:47], s12 offen nt
    s_add_u32 s12, s9, 35840
    buffer_load_dwordx4 v[180:183], v30, s[44:47], s12 offen nt
    s_add_u32 s12, s9, 43008
    buffer_load_dwordx4 v[184:187], v30, s[44:47], s12 offen nt
    s_add_u32 s12, s9, 50176
    buffer_load_dwordx4 v[188:191], v30, s[44:47], s12 offen nt
    s_branch L_p3e1_1
L_p31_1:
    s_mov_b64 exec, 63
    s_bfe_u32 s12, s69, 0x4000c
    s_mul_i32 s12, s12, 393216
    buffer_load_dword v160, v32, s[28:31], s12 offen
    s_bfe_u32 s12, s69, 0x40010
    s_mul_i32 s12, s12, 393216
    buffer_load_dword v164, v32, s[28:31], s12 offen
    s_bfe_u32 s12, s69, 0x40014
    s_mul_i32 s12, s12, 393216
    buffer_load_dword v168, v32, s[28:31], s12 offen
    s_bfe_u32 s12, s69, 0x40018
    s_mul_i32 s12, s12, 393216
    buffer_load_dword v172, v32, s[28:31], s12 offen
    s_bfe_u32 s12, s69, 0x4001c
    s_mul_i32 s12, s12, 393216
    buffer_load_dword v176, v32, s[28:31], s12 offen
    s_mov_b64 exec, 1
    s_bfe_u32 s12, s69, 0x4001c
    s_mul_i32 s12, s12, 393216
    buffer_load_dword v180, v32, s[28:31], s12 offen
    s_bfe_u32 s12, s69, 0x4001c
    s_mul_i32 s12, s12, 393216
    buffer_load_dword v184, v32, s[28:31], s12 offen
    s_bfe_u32 s12, s69, 0x4001c
    s_mul_i32 s12, s12, 393216
    buffer_load_dword v188, v32, s[28:31], s12 offen
    s_mov_b64 exec, -1
L_p3e1_1:
    s_mov_b32 exec_lo, 0xffff0000
    s_mov_b32 exec_hi, 0
    buffer_load_dword v19, v10, s[36:39], 0 offen
    s_mov_b64 exec, -1
L_bw7_1:
    s_waitcnt vmcnt(19)
    s_barrier
    s_bfe_u32 s91, s69, 0x40004
    s_lshl_b32 s92, s91, 7
    s_mul_i32 s93, s91, 393216
    s_add_u32 m0, s94, 0
    s_nop 0
    buffer_load_dwordx4 v20, s[24:27], s92 offen offset:0 lds
    buffer_load_dwordx4 v21, s[24:27], s92 offen offset:1024 lds
    buffer_load_dwordx4 v22, s[24:27], s92 offen offset:2048 lds
    buffer_load_dwordx4 v23, s[24:27], s92 offen offset:3072 lds
    s_add_u32 m0, s95, 24576
    s_nop 0
    buffer_load_dwordx4 v24, s[28:31], s93 offen offset:0 lds
L_bw8_1:
    s_waitcnt vmcnt(14)
    s_barrier
    s_add_u32 m0, s95, 24576
    s_nop 0
    buffer_load_dwordx4 v25, s[28:31], s93 offen offset:1024 lds
    s_add_u32 m0, s95, 32768
    s_nop 0
    buffer_load_dwordx4 v26, s[28:31], s93 offen offset:0 lds
    buffer_load_dwordx4 v27, s[28:31], s93 offen offset:1024 lds
    s_add_u32 m0, s95, 16384
    s_nop 0
    buffer_load_dwordx4 v28, s[28:31], s93 offen offset:0 lds
    buffer_load_dwordx4 v29, s[28:31], s93 offen offset:1024 lds
    s_bfe_u32 s91, s69, 0x40008
    s_lshl_b32 s92, s91, 7
    s_mul_i32 s93, s91, 393216
    s_add_u32 m0, s94, 40960
    s_nop 0
    buffer_load_dwordx4 v20, s[24:27], s92 offen offset:0 lds
    buffer_load_dwordx4 v21, s[24:27], s92 offen offset:1024 lds
    buffer_load_dwordx4 v22, s[24:27], s92 offen offset:2048 lds
    buffer_load_dwordx4 v23, s[24:27], s92 offen offset:3072 lds
    s_add_u32 m0, s95, 65536
    s_nop 0
    buffer_load_dwordx4 v24, s[28:31], s93 offen offset:0 lds
    buffer_load_dwordx4 v25, s[28:31], s93 offen offset:1024 lds
    s_add_u32 m0, s95, 73728
    s_nop 0
    buffer_load_dwordx4 v26, s[28:31], s93 offen offset:0 lds
L_bw9_1:
    s_waitcnt vmcnt(7)
    s_barrier
    s_add_u32 m0, s95, 73728
    s_nop 0
    buffer_load_dwordx4 v27, s[28:31], s93 offen offset:1024 lds
    s_add_u32 m0, s95, 57344
    s_nop 0
    buffer_load_dwordx4 v28, s[28:31], s93 offen offset:0 lds
    buffer_load_dwordx4 v29, s[28:31], s93 offen offset:1024 lds
    s_bfe_u32 s91, s69, 0x4000c
    s_lshl_b32 s92, s91, 7
    s_mul_i32 s93, s91, 393216
    s_add_u32 m0, s94, 122880
    s_nop 0
    buffer_load_dwordx4 v20, s[24:27], s92 offen offset:0 lds
    buffer_load_dwordx4 v21, s[24:27], s92 offen offset:1024 lds
    buffer_load_dwordx4 v22, s[24:27], s92 offen offset:2048 lds
    buffer_load_dwordx4 v23, s[24:27], s92 offen offset:3072 lds
    s_add_u32 m0, s95, 106496
    s_nop 0
    buffer_load_dwordx4 v24, s[28:31], s93 offen offset:0 lds
    buffer_load_dwordx4 v25, s[28:31], s93 offen offset:1024 lds
    s_add_u32 m0, s95, 114688
    s_nop 0
    buffer_load_dwordx4 v26, s[28:31], s93 offen offset:0 lds
    buffer_load_dwordx4 v27, s[28:31], s93 offen offset:1024 lds
    s_mov_b32 s12, 0
    buffer_load_dwordx4 v[104:107], v5, s[32:35], s12 offen offset:0 sc1
    buffer_load_dwordx4 v[108:111], v5, s[32:35], s12 offen offset:1024 sc1
L_bw10_1:
    s_waitcnt vmcnt(10)
    s_barrier
    s_bfe_u32 s91, s69, 0x40010
    s_lshl_b32 s92, s91, 7
    s_mul_i32 s93, s91, 393216
    s_add_u32 m0, s94, 139264
    s_nop 0
    buffer_load_dwordx4 v20, s[24:27], s92 offen offset:0 lds
    buffer_load_dwordx4 v21, s[24:27], s92 offen offset:1024 lds
    buffer_load_dwordx4 v22, s[24:27], s92 offen offset:2048 lds
    buffer_load_dwordx4 v23, s[24:27], s92 offen offset:3072 lds
    s_add_u32 m0, s95, 24576
    s_nop 0
    buffer_load_dwordx4 v24, s[28:31], s93 offen offset:0 lds
    buffer_load_dwordx4 v25, s[28:31], s93 offen offset:1024 lds
    s_add_u32 m0, s95, 32768
    s_nop 0
    buffer_load_dwordx4 v26, s[28:31], s93 offen offset:0 lds
    buffer_load_dwordx4 v27, s[28:31], s93 offen offset:1024 lds
L_bw11_1:
    s_waitcnt vmcnt(10)
    s_barrier
    s_bfe_u32 s91, s69, 0x40014
    s_lshl_b32 s92, s91, 7
    s_mul_i32 s93, s91, 393216
    s_add_u32 m0, s94, 40960
    s_nop 0
    buffer_load_dwordx4 v20, s[24:27], s92 offen offset:0 lds
    s_waitcnt vmcnt(9)
    s_mov_b32 s13, 0
    v_xor_b32 v105, s23, v105
    v_xor_b32 v107, s23, v107
    v_xor_b32 v109, s23, v109
    v_xor_b32 v111, s23, v111
    v_or3_b32 v105, v105, v107, v109
    v_or_b32 v105, v105, v111
    v_cmp_ne_u32 vcc, 0, v105
    s_cbranch_vccnz L_keyre_1
L_keyok_1:
    buffer_load_dwordx4 v21, s[24:27], s92 offen offset:1024 lds
    v_max3_u32 v104, v104, v106, v108
    v_max_u32 v104, v104, v110
    s_nop 1
    v_max_u32_dpp v104, v104, v104 row_shr:1 row_mask:0xf bank_mask:0xf
    s_nop 1
    v_max_u32_dpp v104, v104, v104 row_shr:2 row_mask:0xf bank_mask:0xf
    s_nop 1
    v_max_u32_dpp v104, v104, v104 row_shr:4 row_mask:0xf bank_mask:0xf
    s_nop 1
    v_max_u32_dpp v104, v104, v104 row_shr:8 row_mask:0xf bank_mask:0xf
    s_nop 1
    v_max_u32_dpp v104, v104, v104 row_bcast:15 row_mask:0xa bank_mask:0xf
    buffer_load_dwordx4 v22, s[24:27], s92 offen offset:2048 lds
    s_nop 0
    v_max_u32_dpp v104, v104, v104 row_bcast:31 row_mask:0xc bank_mask:0xf
    s_nop 0
    v_readlane_b32 s14, v104, 63
    s_nop 1
    s_and_b32 s15, s14, 2047
    s_sub_u32 s15, 2047, s15
    s_lshl_b32 s12, s15, 11
    s_lshl_b32 s13, s70, 1
    s_add_u32 s12, s12, s13
    buffer_load_dwordx4 v[36:39], v34, s[24:27], s12 offen
    s_lshr_b32 s12, s14, 11
    s_and_b32 s13, s12, 0x8000
    s_cmp_lg_u32 s13, 0
    s_mov_b32 s13, 0xffff
    s_cselect_b32 s13, 0x8000, s13
    s_xor_b32 s12, s12, s13
    s_lshl_b32 s12, s12, 16
    v_mov_b32 v105, s12
    buffer_load_dwordx4 v23, s[24:27], s92 offen offset:3072 lds
    v_mul_f32 v105, 0xbfb8aa3b, v105
    v_exp_f32 v105, v105
    s_nop 0
    v_add_f32 v105, 1.0, v105
    v_rcp_f32 v105, v105
    s_nop 0
    v_cvt_pk_bf16_f32 v105, v105, v105
    v_lshlrev_b32 v105, 16, v105
    s_add_u32 s12, s15, 1
    v_mov_b32 v104, s12
    s_add_u32 m0, s95, 65536
    s_nop 0
    buffer_load_dwordx4 v24, s[28:31], s93 offen offset:0 lds
    v_mov_b32 v106, s23
    v_readfirstlane_b32 s14, v105
    v_mov_b32 v14, 162864
    s_mov_b64 exec, 1
    ds_write_b96 v14, v[104:106]
    s_mov_b64 exec, -1
    s_waitcnt lgkmcnt(0)
    buffer_load_dwordx4 v25, s[28:31], s93 offen offset:1024 lds
    s_add_u32 m0, s95, 73728
    s_nop 0
    buffer_load_dwordx4 v26, s[28:31], s93 offen offset:0 lds
    buffer_load_dwordx4 v27, s[28:31], s93 offen offset:1024 lds
    s_add_u32 s12, s97, 0
    buffer_load_dwordx4 v[192:195], v31, s[64:67], s12 offen nt
    s_add_u32 s12, s97, 16384
    buffer_load_dwordx4 v[196:199], v31, s[64:67], s12 offen nt
    s_add_u32 s12, s97, 32768
    buffer_load_dwordx4 v[200:203], v31, s[64:67], s12 offen nt
    s_add_u32 s12, s97, 49152
    buffer_load_dwordx4 v[204:207], v31, s[64:67], s12 offen nt
    s_add_u32 s12, s97, 65536
    buffer_load_dwordx4 v[208:211], v31, s[64:67], s12 offen nt
    s_add_u32 s12, s97, 81920
    buffer_load_dwordx4 v[212:215], v31, s[64:67], s12 offen nt
    s_add_u32 s12, s97, 98304
    buffer_load_dwordx4 v[216:219], v31, s[64:67], s12 offen nt
L_bw12_1:
    s_waitcnt vmcnt(16)
    s_barrier
    s_bfe_u32 s91, s69, 0x40018
    s_lshl_b32 s92, s91, 7
    s_mul_i32 s93, s91, 393216
    s_add_u32 m0, s94, 81920
    s_nop 0
    buffer_load_dwordx4 v20, s[24:27], s92 offen offset:0 lds
    s_waitcnt vmcnt(13)
    s_mov_b32 s8, 0xffff0000
    v_lshlrev_b32 v40, 16, v36
    v_and_b32 v41, s8, v36
    v_lshlrev_b32 v42, 16, v37
    v_and_b32 v43, s8, v37
    v_lshlrev_b32 v44, 16, v38
    buffer_load_dwordx4 v21, s[24:27], s92 offen offset:1024 lds
    v_and_b32 v45, s8, v38
    v_lshlrev_b32 v46, 16, v39
    v_and_b32 v47, s8, v39
    v_lshlrev_b32 v48, 16, v128
    v_lshlrev_b32 v49, 16, v129
    v_and_b32 v128, s8, v128
    v_and_b32 v129, s8, v129
    buffer_load_dwordx4 v22, s[24:27], s92 offen offset:2048 lds
    v_mul_f32 v220, v48, v40
    v_mul_f32 v222, v49, v40
    v_mul_f32 v221, v128, v40
    v_mul_f32 v223, v129, v40
    v_lshlrev_b32 v50, 16, v130
    v_lshlrev_b32 v51, 16, v131
    v_and_b32 v130, s8, v130
    buffer_load_dwordx4 v23, s[24:27], s92 offen offset:3072 lds
    v_and_b32 v131, s8, v131
    v_mul_f32 v224, v50, v40
    v_mul_f32 v226, v51, v40
    v_mul_f32 v225, v130, v40
    v_mul_f32 v227, v131, v40
    v_lshlrev_b32 v48, 16, v160
    v_lshlrev_b32 v49, 16, v161
    s_add_u32 m0, s95, 106496
    s_nop 0
    buffer_load_dwordx4 v24, s[28:31], s93 offen offset:0 lds
    v_and_b32 v160, s8, v160
    v_and_b32 v161, s8, v161
    v_mul_f32 v228, v48, v40
    v_mul_f32 v230, v49, v40
    v_mul_f32 v229, v160, v40
    v_mul_f32 v231, v161, v40
    v_lshlrev_b32 v50, 16, v162
    v_lshlrev_b32 v51, 16, v163
    v_and_b32 v162, s8, v162
    v_and_b32 v163, s8, v163
    v_mul_f32 v232, v50, v40
    v_mul_f32 v234, v51, v40
    v_mul_f32 v233, v162, v40
    v_mul_f32 v235, v163, v40
    v_lshlrev_b32 v48, 16, v132
    v_lshlrev_b32 v49, 16, v133
    v_and_b32 v132, s8, v132
    v_and_b32 v133, s8, v133
    v_fmac_f32 v220, v48, v41
    v_fmac_f32 v222, v49, v41
    v_fmac_f32 v221, v132, v41
    v_fmac_f32 v223, v133, v41
    v_lshlrev_b32 v50, 16, v134
    v_lshlrev_b32 v51, 16, v135
    v_and_b32 v134, s8, v134
    v_and_b32 v135, s8, v135
    v_fmac_f32 v224, v50, v41
    v_fmac_f32 v226, v51, v41
    v_fmac_f32 v225, v134, v41
    v_fmac_f32 v227, v135, v41
    v_lshlrev_b32 v48, 16, v164
    v_lshlrev_b32 v49, 16, v165
L_bw13_1:
    s_waitcnt vmcnt(12)
    s_barrier
    s_add_u32 m0, s95, 106496
    s_nop 0
    buffer_load_dwordx4 v25, s[28:31], s93 offen offset:1024 lds
    v_and_b32 v164, s8, v164
    v_and_b32 v165, s8, v165
    v_fmac_f32 v228, v48, v41
    v_fmac_f32 v230, v49, v41
    v_fmac_f32 v229, v164, v41
    v_fmac_f32 v231, v165, v41
    v_lshlrev_b32 v50, 16, v166
    s_add_u32 m0, s95, 114688
    s_nop 0
    buffer_load_dwordx4 v26, s[28:31], s93 offen offset:0 lds
    v_lshlrev_b32 v51, 16, v167
    v_and_b32 v166, s8, v166
    v_and_b32 v167, s8, v167
    v_fmac_f32 v232, v50, v41
    v_fmac_f32 v234, v51, v41
    v_fmac_f32 v233, v166, v41
    v_fmac_f32 v235, v167, v41
    v_lshlrev_b32 v48, 16, v136
    v_lshlrev_b32 v49, 16, v137
    v_and_b32 v136, s8, v136
    v_and_b32 v137, s8, v137
    v_fmac_f32 v220, v48, v42
    v_fmac_f32 v222, v49, v42
    v_fmac_f32 v221, v136, v42
    buffer_load_dwordx4 v27, s[28:31], s93 offen offset:1024 lds
    v_fmac_f32 v223, v137, v42
    v_lshlrev_b32 v50, 16, v138
    v_lshlrev_b32 v51, 16, v139
    v_and_b32 v138, s8, v138
    v_and_b32 v139, s8, v139
    v_fmac_f32 v224, v50, v42
    v_fmac_f32 v226, v51, v42
    v_fmac_f32 v225, v138, v42
    v_fmac_f32 v227, v139, v42
    v_lshlrev_b32 v48, 16, v168
    v_lshlrev_b32 v49, 16, v169
    v_and_b32 v168, s8, v168
    v_and_b32 v169, s8, v169
    v_fmac_f32 v228, v48, v42
    s_bfe_u32 s91, s69, 0x4001c
    s_lshl_b32 s92, s91, 7
    s_mul_i32 s93, s91, 393216
    s_add_u32 m0, s94, 0
    s_nop 0
    buffer_load_dwordx4 v20, s[24:27], s92 offen offset:0 lds
    v_fmac_f32 v230, v49, v42
    v_fmac_f32 v229, v168, v42
    v_fmac_f32 v231, v169, v42
    v_lshlrev_b32 v50, 16, v170
    v_lshlrev_b32 v51, 16, v171
    v_and_b32 v170, s8, v170
    v_and_b32 v171, s8, v171
    buffer_load_dwordx4 v21, s[24:27], s92 offen offset:1024 lds
    v_fmac_f32 v232, v50, v42
    v_fmac_f32 v234, v51, v42
    v_fmac_f32 v233, v170, v42
    v_fmac_f32 v235, v171, v42
    v_lshlrev_b32 v48, 16, v140
    v_lshlrev_b32 v49, 16, v141
    v_and_b32 v140, s8, v140
    buffer_load_dwordx4 v22, s[24:27], s92 offen offset:2048 lds
    v_and_b32 v141, s8, v141
    v_fmac_f32 v220, v48, v43
    v_fmac_f32 v222, v49, v43
    v_fmac_f32 v221, v140, v43
    v_fmac_f32 v223, v141, v43
    v_lshlrev_b32 v50, 16, v142
    v_lshlrev_b32 v51, 16, v143
    buffer_load_dwordx4 v23, s[24:27], s92 offen offset:3072 lds
    v_and_b32 v142, s8, v142
    v_and_b32 v143, s8, v143
    v_fmac_f32 v224, v50, v43
    v_fmac_f32 v226, v51, v43
    v_fmac_f32 v225, v142, v43
    v_fmac_f32 v227, v143, v43
    v_lshlrev_b32 v48, 16, v172
    s_add_u32 m0, s95, 24576
    s_nop 0
    buffer_load_dwordx4 v24, s[28:31], s93 offen offset:0 lds
    v_lshlrev_b32 v49, 16, v173
    v_and_b32 v172, s8, v172
    v_and_b32 v173, s8, v173
    v_fmac_f32 v228, v48, v43
    v_fmac_f32 v230, v49, v43
    v_fmac_f32 v229, v172, v43
    v_fmac_f32 v231, v173, v43
    buffer_load_dwordx4 v25, s[28:31], s93 offen offset:1024 lds
    v_lshlrev_b32 v50, 16, v174
    v_lshlrev_b32 v51, 16, v175
    v_and_b32 v174, s8, v174
    v_and_b32 v175, s8, v175
    v_fmac_f32 v232, v50, v43
    v_fmac_f32 v234, v51, v43
    v_fmac_f32 v233, v174, v43
    s_add_u32 m0, s95, 32768
    s_nop 0
    buffer_load_dwordx4 v26, s[28:31], s93 offen offset:0 lds
    v_fmac_f32 v235, v175, v43
    v_lshlrev_b32 v48, 16, v144
    v_lshlrev_b32 v49, 16, v145
    v_and_b32 v144, s8, v144
    v_and_b32 v145, s8, v145
    v_fmac_f32 v220, v48, v44
    v_fmac_f32 v222, v49, v44
    v_fmac_f32 v221, v144, v44
    v_fmac_f32 v223, v145, v44
    v_lshlrev_b32 v50, 16, v146
    v_lshlrev_b32 v51, 16, v147
    v_and_b32 v146, s8, v146
    v_and_b32 v147, s8, v147
    v_fmac_f32 v224, v50, v44
    v_fmac_f32 v226, v51, v44
    v_fmac_f32 v225, v146, v44
    v_fmac_f32 v227, v147, v44
    v_lshlrev_b32 v48, 16, v176
    v_lshlrev_b32 v49, 16, v177
    v_and_b32 v176, s8, v176
    v_and_b32 v177, s8, v177
    v_fmac_f32 v228, v48, v44
    v_fmac_f32 v230, v49, v44
    v_fmac_f32 v229, v176, v44
    v_fmac_f32 v231, v177, v44
    v_lshlrev_b32 v50, 16, v178
    v_lshlrev_b32 v51, 16, v179
    v_and_b32 v178, s8, v178
    v_and_b32 v179, s8, v179
    v_fmac_f32 v232, v50, v44
    v_fmac_f32 v234, v51, v44
    v_fmac_f32 v233, v178, v44
    v_fmac_f32 v235, v179, v44
    v_lshlrev_b32 v48, 16, v148
    v_lshlrev_b32 v49, 16, v149
    v_and_b32 v148, s8, v148
    v_and_b32 v149, s8, v149
    v_fmac_f32 v220, v48, v45
    v_fmac_f32 v222, v49, v45
L_bw14_1:
    s_waitcnt vmcnt(7)
    s_barrier
    s_add_u32 m0, s95, 32768
    s_nop 0
    buffer_load_dwordx4 v27, s[28:31], s93 offen offset:1024 lds
    v_fmac_f32 v221, v148, v45
    v_fmac_f32 v223, v149, v45
    v_lshlrev_b32 v50, 16, v150
    v_lshlrev_b32 v51, 16, v151
    v_and_b32 v150, s8, v150
    v_and_b32 v151, s8, v151
    v_fmac_f32 v224, v50, v45
    v_fmac_f32 v226, v51, v45
    v_fmac_f32 v225, v150, v45
    v_fmac_f32 v227, v151, v45
    v_lshlrev_b32 v48, 16, v180
    v_lshlrev_b32 v49, 16, v181
    v_and_b32 v180, s8, v180
    v_and_b32 v181, s8, v181
    s_bfe_u32 s12, s69, 0x4000c
    s_mul_i32 s12, s12, 393216
    s_add_u32 m0, s95, 16384
    s_nop 0
    buffer_load_dwordx4 v28, s[28:31], s12 offen offset:0 lds
    buffer_load_dwordx4 v29, s[28:31], s12 offen offset:1024 lds
    s_bfe_u32 s12, s69, 0x40010
    s_mul_i32 s12, s12, 393216
    s_add_u32 m0, s95, 57344
    s_nop 0
    buffer_load_dwordx4 v28, s[28:31], s12 offen offset:0 lds
    buffer_load_dwordx4 v29, s[28:31], s12 offen offset:1024 lds
    s_mul_i32 s12, s21, 16
    s_add_u32 s12, s12, 0
    s_and_b32 s90, s88, 1
    s_lshl_b32 s90, s90, 6
    s_xor_b32 s12, s12, s90
    s_lshl_b32 s12, s12, 14
    s_add_u32 s90, s12, 0
    buffer_load_dwordx4 v[84:87], v33, s[36:39], s90 offen
    s_add_u32 s90, s12, 16384
    buffer_load_dwordx4 v[88:91], v33, s[36:39], s90 offen
    s_add_u32 s90, s12, 32768
    buffer_load_dwordx4 v[92:95], v33, s[36:39], s90 offen
    s_add_u32 s90, s12, 49152
    buffer_load_dwordx4 v[96:99], v33, s[36:39], s90 offen
    s_add_u32 s90, s12, 65536
    buffer_load_dwordx4 v[100:103], v33, s[36:39], s90 offen
    s_add_u32 s90, s12, 81920
    buffer_load_dwordx4 v[116:119], v33, s[36:39], s90 offen
    s_add_u32 s90, s12, 98304
    buffer_load_dwordx4 v[120:123], v33, s[36:39], s90 offen
    s_add_u32 s90, s12, 114688
    buffer_load_dwordx4 v[124:127], v33, s[36:39], s90 offen
    s_add_u32 s90, s12, 131072
    buffer_load_dwordx4 v[64:67], v33, s[36:39], s90 offen
    v_fmac_f32 v228, v48, v45
    v_fmac_f32 v230, v49, v45
    v_fmac_f32 v229, v180, v45
    v_fmac_f32 v231, v181, v45
    v_lshlrev_b32 v50, 16, v182
    v_lshlrev_b32 v51, 16, v183
    v_and_b32 v182, s8, v182
    v_and_b32 v183, s8, v183
    v_fmac_f32 v232, v50, v45
    v_fmac_f32 v234, v51, v45
    v_fmac_f32 v233, v182, v45
    v_fmac_f32 v235, v183, v45
    v_lshlrev_b32 v48, 16, v152
    v_lshlrev_b32 v49, 16, v153
    v_and_b32 v152, s8, v152
    v_and_b32 v153, s8, v153
    v_fmac_f32 v220, v48, v46
    v_fmac_f32 v222, v49, v46
    v_fmac_f32 v221, v152, v46
    v_fmac_f32 v223, v153, v46
    v_lshlrev_b32 v50, 16, v154
    v_lshlrev_b32 v51, 16, v155
    v_and_b32 v154, s8, v154
    v_and_b32 v155, s8, v155
    v_fmac_f32 v224, v50, v46
L_bw15_1:
    s_waitcnt vmcnt(13)
    s_barrier
    v_fmac_f32 v226, v51, v46
    v_fmac_f32 v225, v154, v46
    v_fmac_f32 v227, v155, v46
    v_lshlrev_b32 v48, 16, v184
    v_lshlrev_b32 v49, 16, v185
    v_and_b32 v184, s8, v184
    v_and_b32 v185, s8, v185
    v_fmac_f32 v228, v48, v46
    v_fmac_f32 v230, v49, v46
    v_fmac_f32 v229, v184, v46
    v_fmac_f32 v231, v185, v46
    v_lshlrev_b32 v50, 16, v186
    v_lshlrev_b32 v51, 16, v187
    v_and_b32 v186, s8, v186
    v_and_b32 v187, s8, v187
    v_fmac_f32 v232, v50, v46
    v_fmac_f32 v234, v51, v46
    v_fmac_f32 v233, v186, v46
    v_fmac_f32 v235, v187, v46
    v_lshlrev_b32 v48, 16, v156
    v_lshlrev_b32 v49, 16, v157
    v_and_b32 v156, s8, v156
    v_and_b32 v157, s8, v157
    v_fmac_f32 v220, v48, v47
    v_fmac_f32 v222, v49, v47
    v_fmac_f32 v221, v156, v47
    v_fmac_f32 v223, v157, v47
    v_lshlrev_b32 v50, 16, v158
    v_lshlrev_b32 v51, 16, v159
    v_and_b32 v158, s8, v158
    v_and_b32 v159, s8, v159
    v_fmac_f32 v224, v50, v47
    v_fmac_f32 v226, v51, v47
    v_fmac_f32 v225, v158, v47
    v_fmac_f32 v227, v159, v47
    v_lshlrev_b32 v48, 16, v188
    v_lshlrev_b32 v49, 16, v189
    v_and_b32 v188, s8, v188
    v_and_b32 v189, s8, v189
    v_fmac_f32 v228, v48, v47
    v_fmac_f32 v230, v49, v47
    v_fmac_f32 v229, v188, v47
    v_fmac_f32 v231, v189, v47
    v_lshlrev_b32 v50, 16, v190
    v_lshlrev_b32 v51, 16, v191
    v_and_b32 v190, s8, v190
    v_and_b32 v191, s8, v191
    v_fmac_f32 v232, v50, v47
    v_fmac_f32 v234, v51, v47
    v_fmac_f32 v233, v190, v47
    v_fmac_f32 v235, v191, v47
    v_permlane32_swap_b32 v220, v228
    v_permlane32_swap_b32 v221, v229
    v_permlane32_swap_b32 v222, v230
    v_permlane32_swap_b32 v223, v231
    v_permlane32_swap_b32 v224, v232
    v_permlane32_swap_b32 v225, v233
    v_permlane32_swap_b32 v226, v234
    v_permlane32_swap_b32 v227, v235
    v_add_f32 v220, v220, v228
    v_add_f32 v221, v221, v229
    v_add_f32 v222, v222, v230
    v_add_f32 v223, v223, v231
    v_add_f32 v224, v224, v232
    v_add_f32 v225, v225, v233
    v_add_f32 v226, v226, v234
    v_add_f32 v227, v227, v235
    v_permlane16_swap_b32 v220, v224
    v_permlane16_swap_b32 v221, v225
    v_permlane16_swap_b32 v222, v226
    v_permlane16_swap_b32 v223, v227
    v_add_f32 v220, v220, v224
    v_add_f32 v221, v221, v225
    v_add_f32 v222, v222, v226
    v_add_f32 v223, v223, v227
    v_add_f32_dpp v220, v220, v220 row_ror:8 row_mask:0xf bank_mask:0xf
    v_add_f32_dpp v221, v221, v221 row_ror:8 row_mask:0xf bank_mask:0xf
    v_add_f32_dpp v222, v222, v222 row_ror:8 row_mask:0xf bank_mask:0xf
    v_add_f32_dpp v223, v223, v223 row_ror:8 row_mask:0xf bank_mask:0xf
    s_branch L_varend
.fill 429, 4, 0xbf800000
L_var2:
    s_nop 0
    s_waitcnt vmcnt(6)
    s_barrier
    s_add_u32 m0, s95, 73728
    s_nop 0
    buffer_load_dwordx4 v26, s[28:31], s93 offen offset:0 lds
    buffer_load_dwordx4 v27, s[28:31], s93 offen offset:1024 lds
    s_add_u32 m0, s95, 57344
    s_nop 0
    buffer_load_dwordx4 v28, s[28:31], s93 offen offset:0 lds
    buffer_load_dwordx4 v29, s[28:31], s93 offen offset:1024 lds
    s_bfe_u32 s91, s68, 0x40008
    s_lshl_b32 s92, s91, 7
    s_mul_i32 s93, s91, 393216
    s_add_u32 m0, s94, 81920
    s_nop 0
    buffer_load_dwordx4 v20, s[24:27], s92 offen offset:0 lds
    buffer_load_dwordx4 v21, s[24:27], s92 offen offset:1024 lds
    buffer_load_dwordx4 v22, s[24:27], s92 offen offset:2048 lds
    buffer_load_dwordx4 v23, s[24:27], s92 offen offset:3072 lds
    s_add_u32 m0, s95, 106496
    s_nop 0
    buffer_load_dwordx4 v24, s[28:31], s93 offen offset:0 lds
    buffer_load_dwordx4 v25, s[28:31], s93 offen offset:1024 lds
    s_add_u32 m0, s95, 114688
    s_nop 0
    buffer_load_dwordx4 v26, s[28:31], s93 offen offset:0 lds
    buffer_load_dwordx4 v27, s[28:31], s93 offen offset:1024 lds
    s_add_u32 m0, s95, 98304
    s_nop 0
    buffer_load_dwordx4 v28, s[28:31], s93 offen offset:0 lds
    buffer_load_dwordx4 v29, s[28:31], s93 offen offset:1024 lds
    s_lshl_b32 s12, s19, 2
    s_add_u32 s12, s12, s21
    s_lshl_b32 s12, s12, 10
    s_lshl_b32 s13, s21, 10
    s_add_u32 m0, s13, 155648
    s_nop 0
    buffer_load_dwordx4 v5, s[76:79], s12 offen lds
    s_lshl_b32 s12, s22, 11
    buffer_load_dwordx4 v[40:43], v5, s[24:27], s12 offen offset:0
    buffer_load_dwordx4 v[44:47], v5, s[24:27], s12 offen offset:1024
    buffer_load_dwordx4 v[48:51], v5, s[24:27], s12 offen offset:2048
    buffer_load_dwordx4 v[52:55], v5, s[24:27], s12 offen offset:3072
    buffer_load_dwordx4 v[56:59], v5, s[80:83], 0 offen offset:0
    buffer_load_dwordx4 v[60:63], v5, s[80:83], 0 offen offset:1024
    buffer_load_dwordx4 v[64:67], v5, s[84:87], 0 offen offset:0
    buffer_load_dwordx4 v[68:71], v5, s[84:87], 0 offen offset:1024
L_bw1_2:
    s_waitcnt vmcnt(19)
    s_barrier
    s_bfe_u32 s91, s68, 0x4000c
    s_lshl_b32 s92, s91, 7
    s_mul_i32 s93, s91, 393216
    s_add_u32 m0, s94, 0
    s_nop 0
    buffer_load_dwordx4 v20, s[24:27], s92 offen offset:0 lds
    s_waitcnt vmcnt(1)
    s_mov_b32 s8, 0xffff0000
    v_lshlrev_b32 v72, 16, v56
    v_and_b32 v56, s8, v56
    v_lshlrev_b32 v73, 16, v64
    v_and_b32 v64, s8, v64
    v_lshlrev_b32 v112, 16, v40
    buffer_load_dwordx4 v21, s[24:27], s92 offen offset:1024 lds
    v_and_b32 v40, s8, v40
    v_lshlrev_b32 v116, 16, v48
    v_and_b32 v48, s8, v48
    v_mul_f32 v113, v112, v73
    v_mul_f32 v114, v40, v64
    v_mul_f32 v90, v112, v72
    v_mul_f32 v117, v116, v73
    buffer_load_dwordx4 v22, s[24:27], s92 offen offset:2048 lds
    v_mul_f32 v118, v48, v64
    v_mul_f32 v92, v116, v72
    v_cvt_pk_bf16_f32 v113, 0, v113
    v_cvt_pk_bf16_f32 v114, 0, v114
    v_fmac_f32 v90, v40, v56
    v_cvt_pk_bf16_f32 v117, 0, v117
    v_cvt_pk_bf16_f32 v118, 0, v118
    buffer_load_dwordx4 v23, s[24:27], s92 offen offset:3072 lds
    v_fmac_f32 v92, v48, v56
    v_add_f32 v91, v113, v114
    v_add_f32 v93, v117, v118
    v_lshlrev_b32 v72, 16, v57
    v_and_b32 v57, s8, v57
    v_lshlrev_b32 v73, 16, v65
    v_and_b32 v65, s8, v65
    s_add_u32 m0, s95, 24576
    s_nop 0
    buffer_load_dwordx4 v24, s[28:31], s93 offen offset:0 lds
    v_lshlrev_b32 v112, 16, v41
    v_and_b32 v41, s8, v41
    v_lshlrev_b32 v116, 16, v49
    v_and_b32 v49, s8, v49
    v_mul_f32 v113, v112, v73
    v_mul_f32 v114, v41, v65
    v_fmac_f32 v90, v112, v72
    buffer_load_dwordx4 v25, s[28:31], s93 offen offset:1024 lds
    v_mul_f32 v117, v116, v73
    v_mul_f32 v118, v49, v65
    v_fmac_f32 v92, v116, v72
    v_cvt_pk_bf16_f32 v113, 0, v113
    v_cvt_pk_bf16_f32 v114, 0, v114
    v_fmac_f32 v90, v41, v57
    v_cvt_pk_bf16_f32 v117, 0, v117
    s_add_u32 m0, s95, 32768
    s_nop 0
    buffer_load_dwordx4 v26, s[28:31], s93 offen offset:0 lds
    v_cvt_pk_bf16_f32 v118, 0, v118
    v_fmac_f32 v92, v49, v57
    v_add_f32 v91, v91, v113
    v_add_f32 v93, v93, v117
    v_add_f32 v91, v91, v114
    v_add_f32 v93, v93, v118
    v_lshlrev_b32 v72, 16, v58
    buffer_load_dwordx4 v27, s[28:31], s93 offen offset:1024 lds
    v_and_b32 v58, s8, v58
    v_lshlrev_b32 v73, 16, v66
    v_and_b32 v66, s8, v66
    v_lshlrev_b32 v112, 16, v42
    v_and_b32 v42, s8, v42
    v_lshlrev_b32 v116, 16, v50
    v_and_b32 v50, s8, v50
    s_add_u32 m0, s95, 16384
    s_nop 0
    buffer_load_dwordx4 v28, s[28:31], s93 offen offset:0 lds
    v_mul_f32 v113, v112, v73
    v_mul_f32 v114, v42, v66
    v_fmac_f32 v90, v112, v72
    v_mul_f32 v117, v116, v73
    v_mul_f32 v118, v50, v66
    v_fmac_f32 v92, v116, v72
    v_cvt_pk_bf16_f32 v113, 0, v113
    buffer_load_dwordx4 v29, s[28:31], s93 offen offset:1024 lds
    v_cvt_pk_bf16_f32 v114, 0, v114
    v_fmac_f32 v90, v42, v58
    v_cvt_pk_bf16_f32 v117, 0, v117
    v_cvt_pk_bf16_f32 v118, 0, v118
    v_fmac_f32 v92, v50, v58
    v_add_f32 v91, v91, v113
    v_add_f32 v93, v93, v117
    s_cmp_lg_u32 s21, 0
    s_cbranch_scc1 L_noclr_2
    v_mov_b32 v104, -1
    v_mov_b32 v105, -1
    v_mov_b32 v106, -1
    v_mov_b32 v107, -1
    s_lshl_b32 s12, s19, 13
    s_lshl_b32 s13, s18, 9
    s_add_u32 s12, s12, s13
    s_add_u32 s12, s12, 32768
    s_lshl_b32 s13, s19, 11
    s_lshl_b32 s90, s18, 7
    s_add_u32 s13, s13, s90
    s_add_u32 s13, s13, 163840
    s_mov_b32 exec_hi, 0
    buffer_store_dwordx4 v[104:107], v5, s[32:35], s12 offen sc1
    s_mov_b32 exec_lo, 255
    buffer_store_dwordx4 v[104:107], v5, s[32:35], s13 offen sc1
    s_mov_b64 exec, -1
L_noclr_2:
    v_add_f32 v91, v91, v114
    v_add_f32 v93, v93, v118
    v_lshlrev_b32 v72, 16, v59
    v_and_b32 v59, s8, v59
    v_lshlrev_b32 v73, 16, v67
    v_and_b32 v67, s8, v67
    v_lshlrev_b32 v112, 16, v43
    v_and_b32 v43, s8, v43
    v_lshlrev_b32 v116, 16, v51
    v_and_b32 v51, s8, v51
    v_mul_f32 v113, v112, v73
    v_mul_f32 v114, v43, v67
    v_fmac_f32 v90, v112, v72
    v_mul_f32 v117, v116, v73
    v_mul_f32 v118, v51, v67
    v_fmac_f32 v92, v116, v72
    v_cvt_pk_bf16_f32 v113, 0, v113
    v_cvt_pk_bf16_f32 v114, 0, v114
    v_fmac_f32 v90, v43, v59
    v_cvt_pk_bf16_f32 v117, 0, v117
    v_cvt_pk_bf16_f32 v118, 0, v118
    v_fmac_f32 v92, v51, v59
    v_add_f32 v91, v91, v113
    v_add_f32 v93, v93, v117
    v_add_f32 v91, v91, v114
L_bw2_2:
    s_barrier
    s_bfe_u32 s91, s68, 0x40010
    s_lshl_b32 s92, s91, 7
    s_mul_i32 s93, s91, 393216
    s_add_u32 m0, s94, 40960
    s_nop 0
    buffer_load_dwordx4 v20, s[24:27], s92 offen offset:0 lds
    v_add_f32 v93, v93, v118
    v_lshlrev_b32 v72, 16, v60
    v_and_b32 v60, s8, v60
    v_lshlrev_b32 v73, 16, v68
    v_and_b32 v68, s8, v68
    v_lshlrev_b32 v112, 16, v44
    v_and_b32 v44, s8, v44
    buffer_load_dwordx4 v21, s[24:27], s92 offen offset:1024 lds
    v_lshlrev_b32 v116, 16, v52
    v_and_b32 v52, s8, v52
    v_mul_f32 v113, v112, v73
    v_mul_f32 v114, v44, v68
    v_fmac_f32 v90, v112, v72
    v_mul_f32 v117, v116, v73
    v_mul_f32 v118, v52, v68
    buffer_load_dwordx4 v22, s[24:27], s92 offen offset:2048 lds
    v_fmac_f32 v92, v116, v72
    v_cvt_pk_bf16_f32 v113, 0, v113
    v_cvt_pk_bf16_f32 v114, 0, v114
    v_fmac_f32 v90, v44, v60
    v_cvt_pk_bf16_f32 v117, 0, v117
    v_cvt_pk_bf16_f32 v118, 0, v118
    v_fmac_f32 v92, v52, v60
    buffer_load_dwordx4 v23, s[24:27], s92 offen offset:3072 lds
    v_add_f32 v91, v91, v113
    v_add_f32 v93, v93, v117
    v_add_f32 v91, v91, v114
    v_add_f32 v93, v93, v118
    v_lshlrev_b32 v72, 16, v61
    v_and_b32 v61, s8, v61
    v_lshlrev_b32 v73, 16, v69
    s_add_u32 m0, s95, 65536
    s_nop 0
    buffer_load_dwordx4 v24, s[28:31], s93 offen offset:0 lds
    v_and_b32 v69, s8, v69
    v_lshlrev_b32 v112, 16, v45
    v_and_b32 v45, s8, v45
    v_lshlrev_b32 v116, 16, v53
    v_and_b32 v53, s8, v53
    v_mul_f32 v113, v112, v73
    v_mul_f32 v114, v45, v69
    buffer_load_dwordx4 v25, s[28:31], s93 offen offset:1024 lds
    v_fmac_f32 v90, v112, v72
    v_mul_f32 v117, v116, v73
    v_mul_f32 v118, v53, v69
    v_fmac_f32 v92, v116, v72
    v_cvt_pk_bf16_f32 v113, 0, v113
    v_cvt_pk_bf16_f32 v114, 0, v114
    v_fmac_f32 v90, v45, v61
    s_add_u32 m0, s95, 73728
    s_nop 0
    buffer_load_dwordx4 v26, s[28:31], s93 offen offset:0 lds
    v_cvt_pk_bf16_f32 v117, 0, v117
    v_cvt_pk_bf16_f32 v118, 0, v118
    v_fmac_f32 v92, v53, v61
    v_add_f32 v91, v91, v113
    v_add_f32 v93, v93, v117
    v_add_f32 v91, v91, v114
    v_add_f32 v93, v93, v118
    buffer_load_dwordx4 v27, s[28:31], s93 offen offset:1024 lds
    v_lshlrev_b32 v72, 16, v62
    v_and_b32 v62, s8, v62
    v_lshlrev_b32 v73, 16, v70
    v_and_b32 v70, s8, v70
    v_lshlrev_b32 v112, 16, v46
    v_and_b32 v46, s8, v46
    v_lshlrev_b32 v116, 16, v54
    s_add_u32 m0, s95, 57344
    s_nop 0
    buffer_load_dwordx4 v28, s[28:31], s93 offen offset:0 lds
    v_and_b32 v54, s8, v54
    v_mul_f32 v113, v112, v73
    v_mul_f32 v114, v46, v70
    v_fmac_f32 v90, v112, v72
    v_mul_f32 v117, v116, v73
    v_mul_f32 v118, v54, v70
    v_fmac_f32 v92, v116, v72
    buffer_load_dwordx4 v29, s[28:31], s93 offen offset:1024 lds
    v_cvt_pk_bf16_f32 v113, 0, v113
    v_cvt_pk_bf16_f32 v114, 0, v114
    v_fmac_f32 v90, v46, v62
    v_cvt_pk_bf16_f32 v117, 0, v117
    v_cvt_pk_bf16_f32 v118, 0, v118
    v_fmac_f32 v92, v54, v62
    v_add_f32 v91, v91, v113
    s_cmp_ge_u32 s10, 224
    s_cbranch_scc1 L_p30_2
    s_add_u32 s12, s71, 0
    buffer_load_dwordx4 v[128:131], v30, s[40:43], s12 offen nt
    s_add_u32 s12, s71, 7168
    buffer_load_dwordx4 v[132:135], v30, s[40:43], s12 offen nt
    s_add_u32 s12, s71, 14336
    buffer_load_dwordx4 v[136:139], v30, s[40:43], s12 offen nt
    s_add_u32 s12, s71, 21504
    buffer_load_dwordx4 v[140:143], v30, s[40:43], s12 offen nt
    s_add_u32 s12, s71, 28672
    buffer_load_dwordx4 v[144:147], v30, s[40:43], s12 offen nt
    s_add_u32 s12, s71, 35840
    buffer_load_dwordx4 v[148:151], v30, s[40:43], s12 offen nt
    s_add_u32 s12, s71, 43008
    buffer_load_dwordx4 v[152:155], v30, s[40:43], s12 offen nt
    s_add_u32 s12, s71, 50176
    buffer_load_dwordx4 v[156:159], v30, s[40:43], s12 offen nt
    s_branch L_p3e0_2
L_p30_2:
    s_mov_b64 exec, 63
    s_bfe_u32 s12, s68, 0x4000c
    s_mul_i32 s12, s12, 393216
    buffer_load_dword v128, v32, s[28:31], s12 offen
    s_bfe_u32 s12, s68, 0x40010
    s_mul_i32 s12, s12, 393216
    buffer_load_dword v132, v32, s[28:31], s12 offen
    s_bfe_u32 s12, s68, 0x40014
    s_mul_i32 s12, s12, 393216
    buffer_load_dword v136, v32, s[28:31], s12 offen
    s_bfe_u32 s12, s68, 0x40018
    s_mul_i32 s12, s12, 393216
    buffer_load_dword v140, v32, s[28:31], s12 offen
    s_bfe_u32 s12, s68, 0x4001c
    s_mul_i32 s12, s12, 393216
    buffer_load_dword v144, v32, s[28:31], s12 offen
    s_bfe_u32 s12, s69, 0x40000
    s_mul_i32 s12, s12, 393216
    buffer_load_dword v148, v32, s[28:31], s12 offen
    s_bfe_u32 s12, s69, 0x40004
    s_mul_i32 s12, s12, 393216
    buffer_load_dword v152, v32, s[28:31], s12 offen
    s_bfe_u32 s12, s69, 0x40008
    s_mul_i32 s12, s12, 393216
    buffer_load_dword v156, v32, s[28:31], s12 offen
    s_mov_b64 exec, -1
L_p3e0_2:
    buffer_load_dword v15, v13, s[72:75], 0 offen offset:4 sc1
    v_add_f32 v93, v93, v117
    v_add_f32 v91, v91, v114
    v_add_f32 v93, v93, v118
    v_lshlrev_b32 v72, 16, v63
    v_and_b32 v63, s8, v63
    v_lshlrev_b32 v73, 16, v71
    v_and_b32 v71, s8, v71
    v_lshlrev_b32 v112, 16, v47
    v_and_b32 v47, s8, v47
    v_lshlrev_b32 v116, 16, v55
    v_and_b32 v55, s8, v55
    v_mul_f32 v113, v112, v73
    v_mul_f32 v114, v47, v71
    v_fmac_f32 v90, v112, v72
    v_mul_f32 v117, v116, v73
    v_mul_f32 v118, v55, v71
    v_fmac_f32 v92, v116, v72
    v_cvt_pk_bf16_f32 v113, 0, v113
    v_cvt_pk_bf16_f32 v114, 0, v114
    v_fmac_f32 v90, v47, v63
    v_cvt_pk_bf16_f32 v117, 0, v117
    v_cvt_pk_bf16_f32 v118, 0, v118
    v_fmac_f32 v92, v55, v63
    v_add_f32 v91, v91, v113
    v_add_f32 v93, v93, v117
L_bw3_2:
    s_waitcnt vmcnt(19)
    s_barrier
    s_bfe_u32 s91, s68, 0x40014
    s_lshl_b32 s92, s91, 7
    s_mul_i32 s93, s91, 393216
    s_add_u32 m0, s94, 81920
    s_nop 0
    buffer_load_dwordx4 v20, s[24:27], s92 offen offset:0 lds
    v_add_f32 v91, v91, v114
    v_add_f32 v93, v93, v118
    v_add_f32_dpp v90, v90, v90 row_shr:1 row_mask:0xf bank_mask:0xf
    v_add_f32_dpp v91, v91, v91 row_shr:1 row_mask:0xf bank_mask:0xf
    v_add_f32_dpp v92, v92, v92 row_shr:1 row_mask:0xf bank_mask:0xf
    v_add_f32_dpp v93, v93, v93 row_shr:1 row_mask:0xf bank_mask:0xf
    v_add_f32_dpp v90, v90, v90 row_shr:2 row_mask:0xf bank_mask:0xf
    buffer_load_dwordx4 v21, s[24:27], s92 offen offset:1024 lds
    v_add_f32_dpp v91, v91, v91 row_shr:2 row_mask:0xf bank_mask:0xf
    v_add_f32_dpp v92, v92, v92 row_shr:2 row_mask:0xf bank_mask:0xf
    v_add_f32_dpp v93, v93, v93 row_shr:2 row_mask:0xf bank_mask:0xf
    v_add_f32_dpp v90, v90, v90 row_shr:4 row_mask:0xf bank_mask:0xf
    v_add_f32_dpp v91, v91, v91 row_shr:4 row_mask:0xf bank_mask:0xf
    v_add_f32_dpp v92, v92, v92 row_shr:4 row_mask:0xf bank_mask:0xf
    v_add_f32_dpp v93, v93, v93 row_shr:4 row_mask:0xf bank_mask:0xf
    buffer_load_dwordx4 v22, s[24:27], s92 offen offset:2048 lds
    v_add_f32_dpp v90, v90, v90 row_shr:8 row_mask:0xf bank_mask:0xf
    v_add_f32_dpp v91, v91, v91 row_shr:8 row_mask:0xf bank_mask:0xf
    v_add_f32_dpp v92, v92, v92 row_shr:8 row_mask:0xf bank_mask:0xf
    v_add_f32_dpp v93, v93, v93 row_shr:8 row_mask:0xf bank_mask:0xf
    v_add_f32_dpp v90, v90, v90 row_bcast:15 row_mask:0xa bank_mask:0xf
    v_add_f32_dpp v91, v91, v91 row_bcast:15 row_mask:0xa bank_mask:0xf
    v_add_f32_dpp v92, v92, v92 row_bcast:15 row_mask:0xa bank_mask:0xf
    buffer_load_dwordx4 v23, s[24:27], s92 offen offset:3072 lds
    v_add_f32_dpp v93, v93, v93 row_bcast:15 row_mask:0xa bank_mask:0xf
    v_add_f32_dpp v90, v90, v90 row_bcast:31 row_mask:0xc bank_mask:0xf
    v_add_f32_dpp v91, v91, v91 row_bcast:31 row_mask:0xc bank_mask:0xf
    v_add_f32_dpp v92, v92, v92 row_bcast:31 row_mask:0xc bank_mask:0xf
    v_add_f32_dpp v93, v93, v93 row_bcast:31 row_mask:0xc bank_mask:0xf
    v_mov_b32 v97, 0x8000
    v_mov_b32 v98, 0xffff
    s_add_u32 m0, s95, 106496
    s_nop 0
    buffer_load_dwordx4 v24, s[28:31], s93 offen offset:0 lds
    v_cvt_pk_bf16_f32 v94, v90, v91
    v_cvt_pk_bf16_f32 v104, v92, v93
    v_and_b32 v95, 0xffff, v94
    v_and_b32 v96, 0x8000, v94
    v_and_b32 v94, 0xffff0000, v94
    v_cmp_ne_u32 vcc, 0, v96
    v_mul_f32 v94, 0xbfb8aa3b, v94
    v_exp_f32 v94, v94
    v_cndmask_b32 v96, v97, v98, vcc
    v_xor_b32 v95, v95, v96
    v_add_f32 v94, 1.0, v94
    v_lshlrev_b32 v95, 11, v95
    v_rcp_f32 v94, v94
    s_sub_u32 s12, 2047, s22
    v_or_b32 v100, s12, v95
    v_cvt_pk_bf16_f32 v94, v94, v94
    v_lshlrev_b32 v102, 16, v94
    v_and_b32 v105, 0xffff, v104
    v_and_b32 v106, 0x8000, v104
    v_and_b32 v104, 0xffff0000, v104
    v_cmp_ne_u32 vcc, 0, v106
    v_mul_f32 v104, 0xbfb8aa3b, v104
    v_exp_f32 v104, v104
    v_cndmask_b32 v106, v97, v98, vcc
    v_xor_b32 v105, v105, v106
    v_add_f32 v104, 1.0, v104
    v_lshlrev_b32 v105, 11, v105
    v_rcp_f32 v104, v104
    s_sub_u32 s12, 2046, s22
    v_or_b32 v101, s12, v105
    v_cvt_pk_bf16_f32 v104, v104, v104
    v_lshlrev_b32 v103, 16, v104
    v_max_u32 v100, v100, v101
    s_lshl_b32 s12, s22, 2
    s_add_u32 s12, s12, 4096
    s_lshl_b32 s13, s21, 2
    s_add_u32 s13, s13, 162880
    v_mov_b32 v14, s13
    s_mov_b32 exec_lo, 0
    s_mov_b32 exec_hi, 0x80000000
    buffer_store_dwordx2 v[102:103], v13, s[32:35], s12 offen sc1
    ds_write_b32 v14, v100
    s_mov_b64 exec, -1
    s_waitcnt lgkmcnt(0)
L_bw4_2:
    s_waitcnt vmcnt(15)
    s_barrier
    s_add_u32 m0, s95, 106496
    s_nop 0
    buffer_load_dwordx4 v25, s[28:31], s93 offen offset:1024 lds
    s_add_u32 m0, s95, 114688
    s_nop 0
    buffer_load_dwordx4 v26, s[28:31], s93 offen offset:0 lds
    buffer_load_dwordx4 v27, s[28:31], s93 offen offset:1024 lds
    s_add_u32 m0, s95, 98304
    s_nop 0
    buffer_load_dwordx4 v28, s[28:31], s93 offen offset:0 lds
    buffer_load_dwordx4 v29, s[28:31], s93 offen offset:1024 lds
    s_bfe_u32 s91, s68, 0x40018
    s_lshl_b32 s92, s91, 7
    s_mul_i32 s93, s91, 393216
    s_add_u32 m0, s94, 0
    s_nop 0
    buffer_load_dwordx4 v20, s[24:27], s92 offen offset:0 lds
    buffer_load_dwordx4 v21, s[24:27], s92 offen offset:1024 lds
    buffer_load_dwordx4 v22, s[24:27], s92 offen offset:2048 lds
    buffer_load_dwordx4 v23, s[24:27], s92 offen offset:3072 lds
    s_add_u32 m0, s95, 24576
    s_nop 0
    buffer_load_dwordx4 v24, s[28:31], s93 offen offset:0 lds
    buffer_load_dwordx4 v25, s[28:31], s93 offen offset:1024 lds
    s_add_u32 m0, s95, 32768
    s_nop 0
    buffer_load_dwordx4 v26, s[28:31], s93 offen offset:0 lds
    s_waitcnt vmcnt(12)
L_bw5_2:
    s_waitcnt vmcnt(7)
    s_barrier
    s_add_u32 m0, s95, 32768
    s_nop 0
    buffer_load_dwordx4 v27, s[28:31], s93 offen offset:1024 lds
    s_add_u32 m0, s95, 16384
    s_nop 0
    buffer_load_dwordx4 v28, s[28:31], s93 offen offset:0 lds
    buffer_load_dwordx4 v29, s[28:31], s93 offen offset:1024 lds
    s_bfe_u32 s91, s68, 0x4001c
    s_lshl_b32 s92, s91, 7
    s_mul_i32 s93, s91, 393216
    s_add_u32 m0, s94, 40960
    s_nop 0
    buffer_load_dwordx4 v20, s[24:27], s92 offen offset:0 lds
    buffer_load_dwordx4 v21, s[24:27], s92 offen offset:1024 lds
    buffer_load_dwordx4 v22, s[24:27], s92 offen offset:2048 lds
    buffer_load_dwordx4 v23, s[24:27], s92 offen offset:3072 lds
    s_add_u32 m0, s95, 65536
    s_nop 0
    buffer_load_dwordx4 v24, s[28:31], s93 offen offset:0 lds
    buffer_load_dwordx4 v25, s[28:31], s93 offen offset:1024 lds
    s_add_u32 m0, s95, 73728
    s_nop 0
    buffer_load_dwordx4 v26, s[28:31], s93 offen offset:0 lds
    buffer_load_dwordx4 v27, s[28:31], s93 offen offset:1024 lds
    s_add_u32 m0, s95, 57344
    s_nop 0
    buffer_load_dwordx4 v28, s[28:31], s93 offen offset:0 lds
    s_mov_b32 s13, 0
L_tagchk_2:
    v_readfirstlane_b32 s23, v15
    s_nop 1
    s_cmp_lg_u32 s23, 0
    s_cbranch_scc1 L_tagok_2
    s_add_u32 s13, s13, 1
    s_cmp_ge_u32 s13, 16384
    s_cbranch_scc1 L_tagok_2
    buffer_load_dword v15, v13, s[72:75], 0 offen offset:4 sc1
    s_waitcnt vmcnt(0)
    s_branch L_tagchk_2
L_tagok_2:
    s_and_b32 s76, s23, 0xff
    s_bfe_u32 s77, s23, 0x80008
    s_bfe_u32 s78, s23, 0x80010
    s_lshr_b32 s79, s23, 24
    v_and_b32 v35, 3, v2
    v_lshlrev_b32 v35, 3, v35
    v_bfe_u32 v35, s23, v35, 8
    s_cmp_lg_u32 s21, 0
    s_cbranch_scc1 L_nopub_2
    v_mov_b32 v14, 162880
    ds_read_b128 v[104:107], v14
    s_lshl_b32 s12, s2, 3
    s_add_u32 s12, s12, 0
    s_waitcnt lgkmcnt(0)
    v_max3_u32 v104, v104, v105, v106
    v_max_u32 v104, v104, v107
    v_mov_b32 v105, s23
    s_mov_b64 exec, 1
    buffer_store_dwordx2 v[104:105], v13, s[32:35], s12 offen sc1
    s_mov_b64 exec, -1
L_nopub_2:
L_bw6_2:
    s_waitcnt vmcnt(9)
    s_barrier
    s_add_u32 m0, s95, 57344
    s_nop 0
    buffer_load_dwordx4 v29, s[28:31], s93 offen offset:1024 lds
    s_bfe_u32 s91, s69, 0x40000
    s_lshl_b32 s92, s91, 7
    s_mul_i32 s93, s91, 393216
    s_add_u32 m0, s94, 81920
    s_nop 0
    buffer_load_dwordx4 v20, s[24:27], s92 offen offset:0 lds
    buffer_load_dwordx4 v21, s[24:27], s92 offen offset:1024 lds
    buffer_load_dwordx4 v22, s[24:27], s92 offen offset:2048 lds
    buffer_load_dwordx4 v23, s[24:27], s92 offen offset:3072 lds
    s_add_u32 m0, s95, 106496
    s_nop 0
    buffer_load_dwordx4 v24, s[28:31], s93 offen offset:0 lds
    buffer_load_dwordx4 v25, s[28:31], s93 offen offset:1024 lds
    s_add_u32 m0, s95, 114688
    s_nop 0
    buffer_load_dwordx4 v26, s[28:31], s93 offen offset:0 lds
    buffer_load_dwordx4 v27, s[28:31], s93 offen offset:1024 lds
    s_add_u32 m0, s95, 98304
    s_nop 0
    buffer_load_dwordx4 v28, s[28:31], s93 offen offset:0 lds
    buffer_load_dwordx4 v29, s[28:31], s93 offen offset:1024 lds
L_bw7_2:
    s_waitcnt vmcnt(10)
    s_barrier
    s_bfe_u32 s91, s69, 0x40004
    s_lshl_b32 s92, s91, 7
    s_mul_i32 s93, s91, 393216
    s_add_u32 m0, s94, 0
    s_nop 0
    buffer_load_dwordx4 v20, s[24:27], s92 offen offset:0 lds
    buffer_load_dwordx4 v21, s[24:27], s92 offen offset:1024 lds
    buffer_load_dwordx4 v22, s[24:27], s92 offen offset:2048 lds
    buffer_load_dwordx4 v23, s[24:27], s92 offen offset:3072 lds
    s_add_u32 m0, s95, 24576
    s_nop 0
    buffer_load_dwordx4 v24, s[28:31], s93 offen offset:0 lds
    buffer_load_dwordx4 v25, s[28:31], s93 offen offset:1024 lds
    s_add_u32 m0, s95, 32768
    s_nop 0
    buffer_load_dwordx4 v26, s[28:31], s93 offen offset:0 lds
    buffer_load_dwordx4 v27, s[28:31], s93 offen offset:1024 lds
    s_add_u32 m0, s95, 16384
    s_nop 0
    buffer_load_dwordx4 v28, s[28:31], s93 offen offset:0 lds
    buffer_load_dwordx4 v29, s[28:31], s93 offen offset:1024 lds
    s_cmp_ge_u32 s10, 224
    s_cbranch_scc1 L_p31_2
    s_add_u32 s12, s9, 0
    buffer_load_dwordx4 v[160:163], v30, s[44:47], s12 offen nt
    s_add_u32 s12, s9, 7168
    buffer_load_dwordx4 v[164:167], v30, s[44:47], s12 offen nt
    s_add_u32 s12, s9, 14336
    buffer_load_dwordx4 v[168:171], v30, s[44:47], s12 offen nt
    s_add_u32 s12, s9, 21504
    buffer_load_dwordx4 v[172:175], v30, s[44:47], s12 offen nt
    s_add_u32 s12, s9, 28672
    buffer_load_dwordx4 v[176:179], v30, s[44:47], s12 offen nt
    s_add_u32 s12, s9, 35840
    buffer_load_dwordx4 v[180:183], v30, s[44:47], s12 offen nt
    s_add_u32 s12, s9, 43008
    buffer_load_dwordx4 v[184:187], v30, s[44:47], s12 offen nt
    s_add_u32 s12, s9, 50176
    buffer_load_dwordx4 v[188:191], v30, s[44:47], s12 offen nt
    s_branch L_p3e1_2
L_p31_2:
    s_mov_b64 exec, 63
    s_bfe_u32 s12, s69, 0x4000c
    s_mul_i32 s12, s12, 393216
    buffer_load_dword v160, v32, s[28:31], s12 offen
    s_bfe_u32 s12, s69, 0x40010
    s_mul_i32 s12, s12, 393216
    buffer_load_dword v164, v32, s[28:31], s12 offen
    s_bfe_u32 s12, s69, 0x40014
    s_mul_i32 s12, s12, 393216
    buffer_load_dword v168, v32, s[28:31], s12 offen
    s_bfe_u32 s12, s69, 0x40018
    s_mul_i32 s12, s12, 393216
    buffer_load_dword v172, v32, s[28:31], s12 offen
    s_bfe_u32 s12, s69, 0x4001c
    s_mul_i32 s12, s12, 393216
    buffer_load_dword v176, v32, s[28:31], s12 offen
    s_mov_b64 exec, 1
    s_bfe_u32 s12, s69, 0x4001c
    s_mul_i32 s12, s12, 393216
    buffer_load_dword v180, v32, s[28:31], s12 offen
    s_bfe_u32 s12, s69, 0x4001c
    s_mul_i32 s12, s12, 393216
    buffer_load_dword v184, v32, s[28:31], s12 offen
    s_bfe_u32 s12, s69, 0x4001c
    s_mul_i32 s12, s12, 393216
    buffer_load_dword v188, v32, s[28:31], s12 offen
    s_mov_b64 exec, -1
L_p3e1_2:
    s_mov_b32 exec_lo, 0xffff0000
    s_mov_b32 exec_hi, 0
    buffer_load_dword v19, v10, s[36:39], 0 offen
    s_mov_b64 exec, -1
L_bw8_2:
    s_waitcnt vmcnt(19)
    s_barrier
    s_bfe_u32 s91, s69, 0x40008
    s_lshl_b32 s92, s91, 7
    s_mul_i32 s93, s91, 393216
    s_add_u32 m0, s94, 40960
    s_nop 0
    buffer_load_dwordx4 v20, s[24:27], s92 offen offset:0 lds
    buffer_load_dwordx4 v21, s[24:27], s92 offen offset:1024 lds
    buffer_load_dwordx4 v22, s[24:27], s92 offen offset:2048 lds
    buffer_load_dwordx4 v23, s[24:27], s92 offen offset:3072 lds
    s_add_u32 m0, s95, 65536
    s_nop 0
    buffer_load_dwordx4 v24, s[28:31], s93 offen offset:0 lds
L_bw9_2:
    s_waitcnt vmcnt(14)
    s_barrier
    s_add_u32 m0, s95, 65536
    s_nop 0
    buffer_load_dwordx4 v25, s[28:31], s93 offen offset:1024 lds
    s_add_u32 m0, s95, 73728
    s_nop 0
    buffer_load_dwordx4 v26, s[28:31], s93 offen offset:0 lds
    buffer_load_dwordx4 v27, s[28:31], s93 offen offset:1024 lds
    s_add_u32 m0, s95, 57344
    s_nop 0
    buffer_load_dwordx4 v28, s[28:31], s93 offen offset:0 lds
    buffer_load_dwordx4 v29, s[28:31], s93 offen offset:1024 lds
    s_bfe_u32 s91, s69, 0x4000c
    s_lshl_b32 s92, s91, 7
    s_mul_i32 s93, s91, 393216
    s_add_u32 m0, s94, 122880
    s_nop 0
    buffer_load_dwordx4 v20, s[24:27], s92 offen offset:0 lds
    buffer_load_dwordx4 v21, s[24:27], s92 offen offset:1024 lds
    buffer_load_dwordx4 v22, s[24:27], s92 offen offset:2048 lds
    buffer_load_dwordx4 v23, s[24:27], s92 offen offset:3072 lds
    s_add_u32 m0, s95, 106496
    s_nop 0
    buffer_load_dwordx4 v24, s[28:31], s93 offen offset:0 lds
    buffer_load_dwordx4 v25, s[28:31], s93 offen offset:1024 lds
    s_add_u32 m0, s95, 114688
    s_nop 0
    buffer_load_dwordx4 v26, s[28:31], s93 offen offset:0 lds
    s_mov_b32 s12, 0
    buffer_load_dwordx4 v[104:107], v5, s[32:35], s12 offen offset:0 sc1
    buffer_load_dwordx4 v[108:111], v5, s[32:35], s12 offen offset:1024 sc1
L_bw10_2:
    s_waitcnt vmcnt(9)
    s_barrier
    s_add_u32 m0, s95, 114688
    s_nop 0
    buffer_load_dwordx4 v27, s[28:31], s93 offen offset:1024 lds
    s_bfe_u32 s91, s69, 0x40010
    s_lshl_b32 s92, s91, 7
    s_mul_i32 s93, s91, 393216
    s_add_u32 m0, s94, 139264
    s_nop 0
    buffer_load_dwordx4 v20, s[24:27], s92 offen offset:0 lds
    buffer_load_dwordx4 v21, s[24:27], s92 offen offset:1024 lds
    buffer_load_dwordx4 v22, s[24:27], s92 offen offset:2048 lds
    buffer_load_dwordx4 v23, s[24:27], s92 offen offset:3072 lds
    s_add_u32 m0, s95, 24576
    s_nop 0
    buffer_load_dwordx4 v24, s[28:31], s93 offen offset:0 lds
    buffer_load_dwordx4 v25, s[28:31], s93 offen offset:1024 lds
    s_add_u32 m0, s95, 32768
    s_nop 0
    buffer_load_dwordx4 v26, s[28:31], s93 offen offset:0 lds
    buffer_load_dwordx4 v27, s[28:31], s93 offen offset:1024 lds
L_bw11_2:
    s_waitcnt vmcnt(8)
    s_barrier
    s_bfe_u32 s91, s69, 0x40014
    s_lshl_b32 s92, s91, 7
    s_mul_i32 s93, s91, 393216
    s_add_u32 m0, s94, 40960
    s_nop 0
    buffer_load_dwordx4 v20, s[24:27], s92 offen offset:0 lds
    s_mov_b32 s13, 0
    v_xor_b32 v105, s23, v105
    v_xor_b32 v107, s23, v107
    v_xor_b32 v109, s23, v109
    v_xor_b32 v111, s23, v111
    v_or3_b32 v105, v105, v107, v109
    v_or_b32 v105, v105, v111
    v_cmp_ne_u32 vcc, 0, v105
    s_cbranch_vccnz L_keyre_2
L_keyok_2:
    buffer_load_dwordx4 v21, s[24:27], s92 offen offset:1024 lds
    v_max3_u32 v104, v104, v106, v108
    v_max_u32 v104, v104, v110
    s_nop 1
    v_max_u32_dpp v104, v104, v104 row_shr:1 row_mask:0xf bank_mask:0xf
    s_nop 1
    v_max_u32_dpp v104, v104, v104 row_shr:2 row_mask:0xf bank_mask:0xf
    s_nop 1
    v_max_u32_dpp v104, v104, v104 row_shr:4 row_mask:0xf bank_mask:0xf
    s_nop 1
    v_max_u32_dpp v104, v104, v104 row_shr:8 row_mask:0xf bank_mask:0xf
    s_nop 1
    v_max_u32_dpp v104, v104, v104 row_bcast:15 row_mask:0xa bank_mask:0xf
    buffer_load_dwordx4 v22, s[24:27], s92 offen offset:2048 lds
    s_nop 0
    v_max_u32_dpp v104, v104, v104 row_bcast:31 row_mask:0xc bank_mask:0xf
    s_nop 0
    v_readlane_b32 s14, v104, 63
    s_nop 1
    s_and_b32 s15, s14, 2047
    s_sub_u32 s15, 2047, s15
    s_lshl_b32 s12, s15, 11
    s_lshl_b32 s13, s70, 1
    s_add_u32 s12, s12, s13
    buffer_load_dwordx4 v[36:39], v34, s[24:27], s12 offen
    s_lshr_b32 s12, s14, 11
    s_and_b32 s13, s12, 0x8000
    s_cmp_lg_u32 s13, 0
    s_mov_b32 s13, 0xffff
    s_cselect_b32 s13, 0x8000, s13
    s_xor_b32 s12, s12, s13
    s_lshl_b32 s12, s12, 16
    v_mov_b32 v105, s12
    buffer_load_dwordx4 v23, s[24:27], s92 offen offset:3072 lds
    v_mul_f32 v105, 0xbfb8aa3b, v105
    v_exp_f32 v105, v105
    s_nop 0
    v_add_f32 v105, 1.0, v105
    v_rcp_f32 v105, v105
    s_nop 0
    v_cvt_pk_bf16_f32 v105, v105, v105
    v_lshlrev_b32 v105, 16, v105
    s_add_u32 s12, s15, 1
    v_mov_b32 v104, s12
    s_add_u32 m0, s95, 65536
    s_nop 0
    buffer_load_dwordx4 v24, s[28:31], s93 offen offset:0 lds
    v_mov_b32 v106, s23
    v_readfirstlane_b32 s14, v105
    v_mov_b32 v14, 162864
    s_mov_b64 exec, 1
    ds_write_b96 v14, v[104:106]
    s_mov_b64 exec, -1
    s_waitcnt lgkmcnt(0)
    buffer_load_dwordx4 v25, s[28:31], s93 offen offset:1024 lds
    s_add_u32 m0, s95, 73728
    s_nop 0
    buffer_load_dwordx4 v26, s[28:31], s93 offen offset:0 lds
    buffer_load_dwordx4 v27, s[28:31], s93 offen offset:1024 lds
L_bw12_2:
    s_waitcnt vmcnt(9)
    s_barrier
    s_bfe_u32 s91, s69, 0x40018
    s_lshl_b32 s92, s91, 7
    s_mul_i32 s93, s91, 393216
    s_add_u32 m0, s94, 81920
    s_nop 0
    buffer_load_dwordx4 v20, s[24:27], s92 offen offset:0 lds
    s_waitcnt vmcnt(6)
    s_mov_b32 s8, 0xffff0000
    v_lshlrev_b32 v40, 16, v36
    v_and_b32 v41, s8, v36
    v_lshlrev_b32 v42, 16, v37
    v_and_b32 v43, s8, v37
    v_lshlrev_b32 v44, 16, v38
    buffer_load_dwordx4 v21, s[24:27], s92 offen offset:1024 lds
    v_and_b32 v45, s8, v38
    v_lshlrev_b32 v46, 16, v39
    v_and_b32 v47, s8, v39
    v_lshlrev_b32 v48, 16, v128
    v_lshlrev_b32 v49, 16, v129
    v_and_b32 v128, s8, v128
    v_and_b32 v129, s8, v129
    buffer_load_dwordx4 v22, s[24:27], s92 offen offset:2048 lds
    v_mul_f32 v220, v48, v40
    v_mul_f32 v222, v49, v40
    v_mul_f32 v221, v128, v40
    v_mul_f32 v223, v129, v40
    v_lshlrev_b32 v50, 16, v130
    v_lshlrev_b32 v51, 16, v131
    v_and_b32 v130, s8, v130
    buffer_load_dwordx4 v23, s[24:27], s92 offen offset:3072 lds
    v_and_b32 v131, s8, v131
    v_mul_f32 v224, v50, v40
    v_mul_f32 v226, v51, v40
    v_mul_f32 v225, v130, v40
    v_mul_f32 v227, v131, v40
    v_lshlrev_b32 v48, 16, v160
    v_lshlrev_b32 v49, 16, v161
    s_add_u32 m0, s95, 106496
    s_nop 0
    buffer_load_dwordx4 v24, s[28:31], s93 offen offset:0 lds
    v_and_b32 v160, s8, v160
    v_and_b32 v161, s8, v161
    v_mul_f32 v228, v48, v40
    v_mul_f32 v230, v49, v40
    v_mul_f32 v229, v160, v40
    v_mul_f32 v231, v161, v40
    v_lshlrev_b32 v50, 16, v162
    buffer_load_dwordx4 v25, s[28:31], s93 offen offset:1024 lds
    v_lshlrev_b32 v51, 16, v163
    v_and_b32 v162, s8, v162
    v_and_b32 v163, s8, v163
    v_mul_f32 v232, v50, v40
    v_mul_f32 v234, v51, v40
    v_mul_f32 v233, v162, v40
    v_mul_f32 v235, v163, v40
    s_add_u32 m0, s95, 114688
    s_nop 0
    buffer_load_dwordx4 v26, s[28:31], s93 offen offset:0 lds
    v_lshlrev_b32 v48, 16, v132
    v_lshlrev_b32 v49, 16, v133
    v_and_b32 v132, s8, v132
    v_and_b32 v133, s8, v133
    v_fmac_f32 v220, v48, v41
    v_fmac_f32 v222, v49, v41
    v_fmac_f32 v221, v132, v41
    v_fmac_f32 v223, v133, v41
    v_lshlrev_b32 v50, 16, v134
    v_lshlrev_b32 v51, 16, v135
    v_and_b32 v134, s8, v134
    v_and_b32 v135, s8, v135
    v_fmac_f32 v224, v50, v41
    v_fmac_f32 v226, v51, v41
    buffer_load_dwordx4 v27, s[28:31], s93 offen offset:1024 lds
    v_fmac_f32 v225, v134, v41
    v_fmac_f32 v227, v135, v41
    v_lshlrev_b32 v48, 16, v164
    v_lshlrev_b32 v49, 16, v165
    v_and_b32 v164, s8, v164
    v_and_b32 v165, s8, v165
    v_fmac_f32 v228, v48, v41
    v_fmac_f32 v230, v49, v41
    v_fmac_f32 v229, v164, v41
    v_fmac_f32 v231, v165, v41
    v_lshlrev_b32 v50, 16, v166
    v_lshlrev_b32 v51, 16, v167
    v_and_b32 v166, s8, v166
    v_and_b32 v167, s8, v167
    s_add_u32 s12, s97, 0
    buffer_load_dwordx4 v[192:195], v31, s[64:67], s12 offen nt
    s_add_u32 s12, s97, 16384
    buffer_load_dwordx4 v[196:199], v31, s[64:67], s12 offen nt
    s_add_u32 s12, s97, 32768
    buffer_load_dwordx4 v[200:203], v31, s[64:67], s12 offen nt
    s_add_u32 s12, s97, 49152
    buffer_load_dwordx4 v[204:207], v31, s[64:67], s12 offen nt
    s_add_u32 s12, s97, 65536
    buffer_load_dwordx4 v[208:211], v31, s[64:67], s12 offen nt
    s_add_u32 s12, s97, 81920
    buffer_load_dwordx4 v[212:215], v31, s[64:67], s12 offen nt
    s_add_u32 s12, s97, 98304
    buffer_load_dwordx4 v[216:219], v31, s[64:67], s12 offen nt
    v_fmac_f32 v232, v50, v41
    v_fmac_f32 v234, v51, v41
    v_fmac_f32 v233, v166, v41
    v_fmac_f32 v235, v167, v41
    v_lshlrev_b32 v48, 16, v136
    v_lshlrev_b32 v49, 16, v137
    v_and_b32 v136, s8, v136
    v_and_b32 v137, s8, v137
    v_fmac_f32 v220, v48, v42
    v_fmac_f32 v222, v49, v42
    v_fmac_f32 v221, v136, v42
    v_fmac_f32 v223, v137, v42
    v_lshlrev_b32 v50, 16, v138
    v_lshlrev_b32 v51, 16, v139
    v_and_b32 v138, s8, v138
    v_and_b32 v139, s8, v139
    v_fmac_f32 v224, v50, v42
    v_fmac_f32 v226, v51, v42
    v_fmac_f32 v225, v138, v42
    v_fmac_f32 v227, v139, v42
    v_lshlrev_b32 v48, 16, v168
    v_lshlrev_b32 v49, 16, v169
    v_and_b32 v168, s8, v168
    v_and_b32 v169, s8, v169
    v_fmac_f32 v228, v48, v42
L_bw13_2:
    s_waitcnt vmcnt(15)
    s_barrier
    s_bfe_u32 s91, s69, 0x4001c
    s_lshl_b32 s92, s91, 7
    s_mul_i32 s93, s91, 393216
    s_add_u32 m0, s94, 0
    s_nop 0
    buffer_load_dwordx4 v20, s[24:27], s92 offen offset:0 lds
    v_fmac_f32 v230, v49, v42
    v_fmac_f32 v229, v168, v42
    v_fmac_f32 v231, v169, v42
    v_lshlrev_b32 v50, 16, v170
    v_lshlrev_b32 v51, 16, v171
    v_and_b32 v170, s8, v170
    v_and_b32 v171, s8, v171
    buffer_load_dwordx4 v21, s[24:27], s92 offen offset:1024 lds
    v_fmac_f32 v232, v50, v42
    v_fmac_f32 v234, v51, v42
    v_fmac_f32 v233, v170, v42
    v_fmac_f32 v235, v171, v42
    v_lshlrev_b32 v48, 16, v140
    v_lshlrev_b32 v49, 16, v141
    v_and_b32 v140, s8, v140
    buffer_load_dwordx4 v22, s[24:27], s92 offen offset:2048 lds
    v_and_b32 v141, s8, v141
    v_fmac_f32 v220, v48, v43
    v_fmac_f32 v222, v49, v43
    v_fmac_f32 v221, v140, v43
    v_fmac_f32 v223, v141, v43
    v_lshlrev_b32 v50, 16, v142
    v_lshlrev_b32 v51, 16, v143
    buffer_load_dwordx4 v23, s[24:27], s92 offen offset:3072 lds
    v_and_b32 v142, s8, v142
    v_and_b32 v143, s8, v143
    v_fmac_f32 v224, v50, v43
    v_fmac_f32 v226, v51, v43
    v_fmac_f32 v225, v142, v43
    v_fmac_f32 v227, v143, v43
    v_lshlrev_b32 v48, 16, v172
    s_add_u32 m0, s95, 24576
    s_nop 0
    buffer_load_dwordx4 v24, s[28:31], s93 offen offset:0 lds
    v_lshlrev_b32 v49, 16, v173
    v_and_b32 v172, s8, v172
    v_and_b32 v173, s8, v173
    v_fmac_f32 v228, v48, v43
    v_fmac_f32 v230, v49, v43
    v_fmac_f32 v229, v172, v43
    v_fmac_f32 v231, v173, v43
    v_lshlrev_b32 v50, 16, v174
    v_lshlrev_b32 v51, 16, v175
    v_and_b32 v174, s8, v174
    v_and_b32 v175, s8, v175
    v_fmac_f32 v232, v50, v43
    v_fmac_f32 v234, v51, v43
    v_fmac_f32 v233, v174, v43
    v_fmac_f32 v235, v175, v43
    v_lshlrev_b32 v48, 16, v144
    v_lshlrev_b32 v49, 16, v145
    v_and_b32 v144, s8, v144
    v_and_b32 v145, s8, v145
    v_fmac_f32 v220, v48, v44
    v_fmac_f32 v222, v49, v44
    v_fmac_f32 v221, v144, v44
    v_fmac_f32 v223, v145, v44
    v_lshlrev_b32 v50, 16, v146
    v_lshlrev_b32 v51, 16, v147
    v_and_b32 v146, s8, v146
    v_and_b32 v147, s8, v147
    v_fmac_f32 v224, v50, v44
    v_fmac_f32 v226, v51, v44
    v_fmac_f32 v225, v146, v44
    v_fmac_f32 v227, v147, v44
    v_lshlrev_b32 v48, 16, v176
L_bw14_2:
    s_waitcnt vmcnt(12)
    s_barrier
    s_add_u32 m0, s95, 24576
    s_nop 0
    buffer_load_dwordx4 v25, s[28:31], s93 offen offset:1024 lds
    v_lshlrev_b32 v49, 16, v177
    v_and_b32 v176, s8, v176
    v_and_b32 v177, s8, v177
    v_fmac_f32 v228, v48, v44
    v_fmac_f32 v230, v49, v44
    v_fmac_f32 v229, v176, v44
    v_fmac_f32 v231, v177, v44
    s_add_u32 m0, s95, 32768
    s_nop 0
    buffer_load_dwordx4 v26, s[28:31], s93 offen offset:0 lds
    v_lshlrev_b32 v50, 16, v178
    v_lshlrev_b32 v51, 16, v179
    v_and_b32 v178, s8, v178
    v_and_b32 v179, s8, v179
    v_fmac_f32 v232, v50, v44
    v_fmac_f32 v234, v51, v44
    v_fmac_f32 v233, v178, v44
    v_fmac_f32 v235, v179, v44
    v_lshlrev_b32 v48, 16, v148
    v_lshlrev_b32 v49, 16, v149
    v_and_b32 v148, s8, v148
    v_and_b32 v149, s8, v149
    v_fmac_f32 v220, v48, v45
    v_fmac_f32 v222, v49, v45
    buffer_load_dwordx4 v27, s[28:31], s93 offen offset:1024 lds
    v_fmac_f32 v221, v148, v45
    v_fmac_f32 v223, v149, v45
    v_lshlrev_b32 v50, 16, v150
    v_lshlrev_b32 v51, 16, v151
    v_and_b32 v150, s8, v150
    v_and_b32 v151, s8, v151
    v_fmac_f32 v224, v50, v45
    v_fmac_f32 v226, v51, v45
    v_fmac_f32 v225, v150, v45
    v_fmac_f32 v227, v151, v45
    v_lshlrev_b32 v48, 16, v180
    v_lshlrev_b32 v49, 16, v181
    v_and_b32 v180, s8, v180
    v_and_b32 v181, s8, v181
    s_bfe_u32 s12, s69, 0x4000c
    s_mul_i32 s12, s12, 393216
    s_add_u32 m0, s95, 16384
    s_nop 0
    buffer_load_dwordx4 v28, s[28:31], s12 offen offset:0 lds
    buffer_load_dwordx4 v29, s[28:31], s12 offen offset:1024 lds
    s_bfe_u32 s12, s69, 0x40010
    s_mul_i32 s12, s12, 393216
    s_add_u32 m0, s95, 57344
    s_nop 0
    buffer_load_dwordx4 v28, s[28:31], s12 offen offset:0 lds
    buffer_load_dwordx4 v29, s[28:31], s12 offen offset:1024 lds
    s_mul_i32 s12, s21, 16
    s_add_u32 s12, s12, 0
    s_and_b32 s90, s88, 1
    s_lshl_b32 s90, s90, 6
    s_xor_b32 s12, s12, s90
    s_lshl_b32 s12, s12, 14
    s_add_u32 s90, s12, 0
    buffer_load_dwordx4 v[84:87], v33, s[36:39], s90 offen
    s_add_u32 s90, s12, 16384
    buffer_load_dwordx4 v[88:91], v33, s[36:39], s90 offen
    s_add_u32 s90, s12, 32768
    buffer_load_dwordx4 v[92:95], v33, s[36:39], s90 offen
    s_add_u32 s90, s12, 49152
    buffer_load_dwordx4 v[96:99], v33, s[36:39], s90 offen
    s_add_u32 s90, s12, 65536
    buffer_load_dwordx4 v[100:103], v33, s[36:39], s90 offen
    s_add_u32 s90, s12, 81920
    buffer_load_dwordx4 v[116:119], v33, s[36:39], s90 offen
    s_add_u32 s90, s12, 98304
    buffer_load_dwordx4 v[120:123], v33, s[36:39], s90 offen
    s_add_u32 s90, s12, 114688
    buffer_load_dwordx4 v[124:127], v33, s[36:39], s90 offen
    s_add_u32 s90, s12, 131072
    buffer_load_dwordx4 v[64:67], v33, s[36:39], s90 offen
    v_fmac_f32 v228, v48, v45
    v_fmac_f32 v230, v49, v45
    v_fmac_f32 v229, v180, v45
    v_fmac_f32 v231, v181, v45
    v_lshlrev_b32 v50, 16, v182
    v_lshlrev_b32 v51, 16, v183
    v_and_b32 v182, s8, v182
    v_and_b32 v183, s8, v183
    v_fmac_f32 v232, v50, v45
    v_fmac_f32 v234, v51, v45
    v_fmac_f32 v233, v182, v45
    v_fmac_f32 v235, v183, v45
    v_lshlrev_b32 v48, 16, v152
    v_lshlrev_b32 v49, 16, v153
    v_and_b32 v152, s8, v152
    v_and_b32 v153, s8, v153
    v_fmac_f32 v220, v48, v46
    v_fmac_f32 v222, v49, v46
    v_fmac_f32 v221, v152, v46
    v_fmac_f32 v223, v153, v46
    v_lshlrev_b32 v50, 16, v154
    v_lshlrev_b32 v51, 16, v155
    v_and_b32 v154, s8, v154
    v_and_b32 v155, s8, v155
    v_fmac_f32 v224, v50, v46
L_bw15_2:
    s_waitcnt vmcnt(13)
    s_barrier
    v_fmac_f32 v226, v51, v46
    v_fmac_f32 v225, v154, v46
    v_fmac_f32 v227, v155, v46
    v_lshlrev_b32 v48, 16, v184
    v_lshlrev_b32 v49, 16, v185
    v_and_b32 v184, s8, v184
    v_and_b32 v185, s8, v185
    v_fmac_f32 v228, v48, v46
    v_fmac_f32 v230, v49, v46
    v_fmac_f32 v229, v184, v46
    v_fmac_f32 v231, v185, v46
    v_lshlrev_b32 v50, 16, v186
    v_lshlrev_b32 v51, 16, v187
    v_and_b32 v186, s8, v186
    v_and_b32 v187, s8, v187
    v_fmac_f32 v232, v50, v46
    v_fmac_f32 v234, v51, v46
    v_fmac_f32 v233, v186, v46
    v_fmac_f32 v235, v187, v46
    v_lshlrev_b32 v48, 16, v156
    v_lshlrev_b32 v49, 16, v157
    v_and_b32 v156, s8, v156
    v_and_b32 v157, s8, v157
    v_fmac_f32 v220, v48, v47
    v_fmac_f32 v222, v49, v47
    v_fmac_f32 v221, v156, v47
    v_fmac_f32 v223, v157, v47
    v_lshlrev_b32 v50, 16, v158
    v_lshlrev_b32 v51, 16, v159
    v_and_b32 v158, s8, v158
    v_and_b32 v159, s8, v159
    v_fmac_f32 v224, v50, v47
    v_fmac_f32 v226, v51, v47
    v_fmac_f32 v225, v158, v47
    v_fmac_f32 v227, v159, v47
    v_lshlrev_b32 v48, 16, v188
    v_lshlrev_b32 v49, 16, v189
    v_and_b32 v188, s8, v188
    v_and_b32 v189, s8, v189
    v_fmac_f32 v228, v48, v47
    v_fmac_f32 v230, v49, v47
    v_fmac_f32 v229, v188, v47
    v_fmac_f32 v231, v189, v47
    v_lshlrev_b32 v50, 16, v190
    v_lshlrev_b32 v51, 16, v191
    v_and_b32 v190, s8, v190
    v_and_b32 v191, s8, v191
    v_fmac_f32 v232, v50, v47
    v_fmac_f32 v234, v51, v47
    v_fmac_f32 v233, v190, v47
    v_fmac_f32 v235, v191, v47
    v_permlane32_swap_b32 v220, v228
    v_permlane32_swap_b32 v221, v229
    v_permlane32_swap_b32 v222, v230
    v_permlane32_swap_b32 v223, v231
    v_permlane32_swap_b32 v224, v232
    v_permlane32_swap_b32 v225, v233
    v_permlane32_swap_b32 v226, v234
    v_permlane32_swap_b32 v227, v235
    v_add_f32 v220, v220, v228
    v_add_f32 v221, v221, v229
    v_add_f32 v222, v222, v230
    v_add_f32 v223, v223, v231
    v_add_f32 v224, v224, v232
    v_add_f32 v225, v225, v233
    v_add_f32 v226, v226, v234
    v_add_f32 v227, v227, v235
    v_permlane16_swap_b32 v220, v224
    v_permlane16_swap_b32 v221, v225
    v_permlane16_swap_b32 v222, v226
    v_permlane16_swap_b32 v223, v227
    v_add_f32 v220, v220, v224
    v_add_f32 v221, v221, v225
    v_add_f32 v222, v222, v226
    v_add_f32 v223, v223, v227
    v_add_f32_dpp v220, v220, v220 row_ror:8 row_mask:0xf bank_mask:0xf
    v_add_f32_dpp v221, v221, v221 row_ror:8 row_mask:0xf bank_mask:0xf
    v_add_f32_dpp v222, v222, v222 row_ror:8 row_mask:0xf bank_mask:0xf
    v_add_f32_dpp v223, v223, v223 row_ror:8 row_mask:0xf bank_mask:0xf
    s_branch L_varend
.fill 433, 4, 0xbf800000
L_var3:
    s_nop 0
    s_waitcnt vmcnt(6)
    s_barrier
    s_add_u32 m0, s95, 73728
    s_nop 0
    buffer_load_dwordx4 v26, s[28:31], s93 offen offset:0 lds
    buffer_load_dwordx4 v27, s[28:31], s93 offen offset:1024 lds
    s_add_u32 m0, s95, 57344
    s_nop 0
    buffer_load_dwordx4 v28, s[28:31], s93 offen offset:0 lds
    buffer_load_dwordx4 v29, s[28:31], s93 offen offset:1024 lds
    s_bfe_u32 s91, s68, 0x40008
    s_lshl_b32 s92, s91, 7
    s_mul_i32 s93, s91, 393216
    s_add_u32 m0, s94, 81920
    s_nop 0
    buffer_load_dwordx4 v20, s[24:27], s92 offen offset:0 lds
    buffer_load_dwordx4 v21, s[24:27], s92 offen offset:1024 lds
    buffer_load_dwordx4 v22, s[24:27], s92 offen offset:2048 lds
    buffer_load_dwordx4 v23, s[24:27], s92 offen offset:3072 lds
    s_add_u32 m0, s95, 106496
    s_nop 0
    buffer_load_dwordx4 v24, s[28:31], s93 offen offset:0 lds
    buffer_load_dwordx4 v25, s[28:31], s93 offen offset:1024 lds
    s_add_u32 m0, s95, 114688
    s_nop 0
    buffer_load_dwordx4 v26, s[28:31], s93 offen offset:0 lds
    buffer_load_dwordx4 v27, s[28:31], s93 offen offset:1024 lds
    s_add_u32 m0, s95, 98304
    s_nop 0
    buffer_load_dwordx4 v28, s[28:31], s93 offen offset:0 lds
    buffer_load_dwordx4 v29, s[28:31], s93 offen offset:1024 lds
    s_lshl_b32 s12, s19, 2
    s_add_u32 s12, s12, s21
    s_lshl_b32 s12, s12, 10
    s_lshl_b32 s13, s21, 10
    s_add_u32 m0, s13, 155648
    s_nop 0
    buffer_load_dwordx4 v5, s[76:79], s12 offen lds
    s_lshl_b32 s12, s22, 11
    buffer_load_dwordx4 v[40:43], v5, s[24:27], s12 offen offset:0
    buffer_load_dwordx4 v[44:47], v5, s[24:27], s12 offen offset:1024
    buffer_load_dwordx4 v[48:51], v5, s[24:27], s12 offen offset:2048
    buffer_load_dwordx4 v[52:55], v5, s[24:27], s12 offen offset:3072
    buffer_load_dwordx4 v[56:59], v5, s[80:83], 0 offen offset:0
    buffer_load_dwordx4 v[60:63], v5, s[80:83], 0 offen offset:1024
    buffer_load_dwordx4 v[64:67], v5, s[84:87], 0 offen offset:0
    buffer_load_dwordx4 v[68:71], v5, s[84:87], 0 offen offset:1024
L_bw1_3:
    s_waitcnt vmcnt(19)
    s_barrier
    s_bfe_u32 s91, s68, 0x4000c
    s_lshl_b32 s92, s91, 7
    s_mul_i32 s93, s91, 393216
    s_add_u32 m0, s94, 0
    s_nop 0
    buffer_load_dwordx4 v20, s[24:27], s92 offen offset:0 lds
    s_waitcnt vmcnt(1)
    s_mov_b32 s8, 0xffff0000
    v_lshlrev_b32 v72, 16, v56
    v_and_b32 v56, s8, v56
    v_lshlrev_b32 v73, 16, v64
    v_and_b32 v64, s8, v64
    v_lshlrev_b32 v112, 16, v40
    buffer_load_dwordx4 v21, s[24:27], s92 offen offset:1024 lds
    v_and_b32 v40, s8, v40
    v_lshlrev_b32 v116, 16, v48
    v_and_b32 v48, s8, v48
    v_mul_f32 v113, v112, v73
    v_mul_f32 v114, v40, v64
    v_mul_f32 v90, v112, v72
    v_mul_f32 v117, v116, v73
    buffer_load_dwordx4 v22, s[24:27], s92 offen offset:2048 lds
    v_mul_f32 v118, v48, v64
    v_mul_f32 v92, v116, v72
    v_cvt_pk_bf16_f32 v113, 0, v113
    v_cvt_pk_bf16_f32 v114, 0, v114
    v_fmac_f32 v90, v40, v56
    v_cvt_pk_bf16_f32 v117, 0, v117
    v_cvt_pk_bf16_f32 v118, 0, v118
    buffer_load_dwordx4 v23, s[24:27], s92 offen offset:3072 lds
    v_fmac_f32 v92, v48, v56
    v_add_f32 v91, v113, v114
    v_add_f32 v93, v117, v118
    v_lshlrev_b32 v72, 16, v57
    v_and_b32 v57, s8, v57
    v_lshlrev_b32 v73, 16, v65
    v_and_b32 v65, s8, v65
    s_add_u32 m0, s95, 24576
    s_nop 0
    buffer_load_dwordx4 v24, s[28:31], s93 offen offset:0 lds
    v_lshlrev_b32 v112, 16, v41
    v_and_b32 v41, s8, v41
    v_lshlrev_b32 v116, 16, v49
    v_and_b32 v49, s8, v49
    v_mul_f32 v113, v112, v73
    v_mul_f32 v114, v41, v65
    v_fmac_f32 v90, v112, v72
    buffer_load_dwordx4 v25, s[28:31], s93 offen offset:1024 lds
    v_mul_f32 v117, v116, v73
    v_mul_f32 v118, v49, v65
    v_fmac_f32 v92, v116, v72
    v_cvt_pk_bf16_f32 v113, 0, v113
    v_cvt_pk_bf16_f32 v114, 0, v114
    v_fmac_f32 v90, v41, v57
    v_cvt_pk_bf16_f32 v117, 0, v117
    s_add_u32 m0, s95, 32768
    s_nop 0
    buffer_load_dwordx4 v26, s[28:31], s93 offen offset:0 lds
    v_cvt_pk_bf16_f32 v118, 0, v118
    v_fmac_f32 v92, v49, v57
    v_add_f32 v91, v91, v113
    v_add_f32 v93, v93, v117
    v_add_f32 v91, v91, v114
    v_add_f32 v93, v93, v118
    v_lshlrev_b32 v72, 16, v58
    buffer_load_dwordx4 v27, s[28:31], s93 offen offset:1024 lds
    v_and_b32 v58, s8, v58
    v_lshlrev_b32 v73, 16, v66
    v_and_b32 v66, s8, v66
    v_lshlrev_b32 v112, 16, v42
    v_and_b32 v42, s8, v42
    v_lshlrev_b32 v116, 16, v50
    v_and_b32 v50, s8, v50
    s_add_u32 m0, s95, 16384
    s_nop 0
    buffer_load_dwordx4 v28, s[28:31], s93 offen offset:0 lds
    v_mul_f32 v113, v112, v73
    v_mul_f32 v114, v42, v66
    v_fmac_f32 v90, v112, v72
    v_mul_f32 v117, v116, v73
    v_mul_f32 v118, v50, v66
    v_fmac_f32 v92, v116, v72
    v_cvt_pk_bf16_f32 v113, 0, v113
    buffer_load_dwordx4 v29, s[28:31], s93 offen offset:1024 lds
    v_cvt_pk_bf16_f32 v114, 0, v114
    v_fmac_f32 v90, v42, v58
    v_cvt_pk_bf16_f32 v117, 0, v117
    v_cvt_pk_bf16_f32 v118, 0, v118
    v_fmac_f32 v92, v50, v58
    v_add_f32 v91, v91, v113
    v_add_f32 v93, v93, v117
    s_cmp_lg_u32 s21, 0
    s_cbranch_scc1 L_noclr_3
    v_mov_b32 v104, -1
    v_mov_b32 v105, -1
    v_mov_b32 v106, -1
    v_mov_b32 v107, -1
    s_lshl_b32 s12, s19, 13
    s_lshl_b32 s13, s18, 9
    s_add_u32 s12, s12, s13
    s_add_u32 s12, s12, 32768
    s_lshl_b32 s13, s19, 11
    s_lshl_b32 s90, s18, 7
    s_add_u32 s13, s13, s90
    s_add_u32 s13, s13, 163840
    s_mov_b32 exec_hi, 0
    buffer_store_dwordx4 v[104:107], v5, s[32:35], s12 offen sc1
    s_mov_b32 exec_lo, 255
    buffer_store_dwordx4 v[104:107], v5, s[32:35], s13 offen sc1
    s_mov_b64 exec, -1
L_noclr_3:
    v_add_f32 v91, v91, v114
    v_add_f32 v93, v93, v118
    v_lshlrev_b32 v72, 16, v59
    v_and_b32 v59, s8, v59
    v_lshlrev_b32 v73, 16, v67
    v_and_b32 v67, s8, v67
    v_lshlrev_b32 v112, 16, v43
    v_and_b32 v43, s8, v43
    v_lshlrev_b32 v116, 16, v51
    v_and_b32 v51, s8, v51
    v_mul_f32 v113, v112, v73
    v_mul_f32 v114, v43, v67
    v_fmac_f32 v90, v112, v72
    v_mul_f32 v117, v116, v73
    v_mul_f32 v118, v51, v67
    v_fmac_f32 v92, v116, v72
    v_cvt_pk_bf16_f32 v113, 0, v113
    v_cvt_pk_bf16_f32 v114, 0, v114
    v_fmac_f32 v90, v43, v59
    v_cvt_pk_bf16_f32 v117, 0, v117
    v_cvt_pk_bf16_f32 v118, 0, v118
    v_fmac_f32 v92, v51, v59
    v_add_f32 v91, v91, v113
    v_add_f32 v93, v93, v117
    v_add_f32 v91, v91, v114
L_bw2_3:
    s_barrier
    s_bfe_u32 s91, s68, 0x40010
    s_lshl_b32 s92, s91, 7
    s_mul_i32 s93, s91, 393216
    s_add_u32 m0, s94, 40960
    s_nop 0
    buffer_load_dwordx4 v20, s[24:27], s92 offen offset:0 lds
    v_add_f32 v93, v93, v118
    v_lshlrev_b32 v72, 16, v60
    v_and_b32 v60, s8, v60
    v_lshlrev_b32 v73, 16, v68
    v_and_b32 v68, s8, v68
    v_lshlrev_b32 v112, 16, v44
    v_and_b32 v44, s8, v44
    buffer_load_dwordx4 v21, s[24:27], s92 offen offset:1024 lds
    v_lshlrev_b32 v116, 16, v52
    v_and_b32 v52, s8, v52
    v_mul_f32 v113, v112, v73
    v_mul_f32 v114, v44, v68
    v_fmac_f32 v90, v112, v72
    v_mul_f32 v117, v116, v73
    v_mul_f32 v118, v52, v68
    buffer_load_dwordx4 v22, s[24:27], s92 offen offset:2048 lds
    v_fmac_f32 v92, v116, v72
    v_cvt_pk_bf16_f32 v113, 0, v113
    v_cvt_pk_bf16_f32 v114, 0, v114
    v_fmac_f32 v90, v44, v60
    v_cvt_pk_bf16_f32 v117, 0, v117
    v_cvt_pk_bf16_f32 v118, 0, v118
    v_fmac_f32 v92, v52, v60
    buffer_load_dwordx4 v23, s[24:27], s92 offen offset:3072 lds
    v_add_f32 v91, v91, v113
    v_add_f32 v93, v93, v117
    v_add_f32 v91, v91, v114
    v_add_f32 v93, v93, v118
    v_lshlrev_b32 v72, 16, v61
    v_and_b32 v61, s8, v61
    v_lshlrev_b32 v73, 16, v69
    s_add_u32 m0, s95, 65536
    s_nop 0
    buffer_load_dwordx4 v24, s[28:31], s93 offen offset:0 lds
    v_and_b32 v69, s8, v69
    v_lshlrev_b32 v112, 16, v45
    v_and_b32 v45, s8, v45
    v_lshlrev_b32 v116, 16, v53
    v_and_b32 v53, s8, v53
    v_mul_f32 v113, v112, v73
    v_mul_f32 v114, v45, v69
    buffer_load_dwordx4 v25, s[28:31], s93 offen offset:1024 lds
    v_fmac_f32 v90, v112, v72
    v_mul_f32 v117, v116, v73
    v_mul_f32 v118, v53, v69
    v_fmac_f32 v92, v116, v72
    v_cvt_pk_bf16_f32 v113, 0, v113
    v_cvt_pk_bf16_f32 v114, 0, v114
    v_fmac_f32 v90, v45, v61
    s_add_u32 m0, s95, 73728
    s_nop 0
    buffer_load_dwordx4 v26, s[28:31], s93 offen offset:0 lds
    v_cvt_pk_bf16_f32 v117, 0, v117
    v_cvt_pk_bf16_f32 v118, 0, v118
    v_fmac_f32 v92, v53, v61
    v_add_f32 v91, v91, v113
    v_add_f32 v93, v93, v117
    v_add_f32 v91, v91, v114
    v_add_f32 v93, v93, v118
    buffer_load_dwordx4 v27, s[28:31], s93 offen offset:1024 lds
    v_lshlrev_b32 v72, 16, v62
    v_and_b32 v62, s8, v62
    v_lshlrev_b32 v73, 16, v70
    v_and_b32 v70, s8, v70
    v_lshlrev_b32 v112, 16, v46
    v_and_b32 v46, s8, v46
    v_lshlrev_b32 v116, 16, v54
    s_add_u32 m0, s95, 57344
    s_nop 0
    buffer_load_dwordx4 v28, s[28:31], s93 offen offset:0 lds
    v_and_b32 v54, s8, v54
    v_mul_f32 v113, v112, v73
    v_mul_f32 v114, v46, v70
    v_fmac_f32 v90, v112, v72
    v_mul_f32 v117, v116, v73
    v_mul_f32 v118, v54, v70
    v_fmac_f32 v92, v116, v72
    buffer_load_dwordx4 v29, s[28:31], s93 offen offset:1024 lds
    v_cvt_pk_bf16_f32 v113, 0, v113
    v_cvt_pk_bf16_f32 v114, 0, v114
    v_fmac_f32 v90, v46, v62
    v_cvt_pk_bf16_f32 v117, 0, v117
    v_cvt_pk_bf16_f32 v118, 0, v118
    v_fmac_f32 v92, v54, v62
    v_add_f32 v91, v91, v113
    buffer_load_dword v15, v13, s[72:75], 0 offen offset:4 sc1
    v_add_f32 v93, v93, v117
    v_add_f32 v91, v91, v114
    v_add_f32 v93, v93, v118
    v_lshlrev_b32 v72, 16, v63
    v_and_b32 v63, s8, v63
    v_lshlrev_b32 v73, 16, v71
    v_and_b32 v71, s8, v71
    v_lshlrev_b32 v112, 16, v47
    v_and_b32 v47, s8, v47
    v_lshlrev_b32 v116, 16, v55
    v_and_b32 v55, s8, v55
    v_mul_f32 v113, v112, v73
    v_mul_f32 v114, v47, v71
    v_fmac_f32 v90, v112, v72
    v_mul_f32 v117, v116, v73
    v_mul_f32 v118, v55, v71
    v_fmac_f32 v92, v116, v72
    v_cvt_pk_bf16_f32 v113, 0, v113
    v_cvt_pk_bf16_f32 v114, 0, v114
    v_fmac_f32 v90, v47, v63
    v_cvt_pk_bf16_f32 v117, 0, v117
    v_cvt_pk_bf16_f32 v118, 0, v118
    v_fmac_f32 v92, v55, v63
    v_add_f32 v91, v91, v113
    v_add_f32 v93, v93, v117
L_bw3_3:
    s_waitcnt vmcnt(11)
    s_barrier
    s_bfe_u32 s91, s68, 0x40014
    s_lshl_b32 s92, s91, 7
    s_mul_i32 s93, s91, 393216
    s_add_u32 m0, s94, 81920
    s_nop 0
    buffer_load_dwordx4 v20, s[24:27], s92 offen offset:0 lds
    v_add_f32 v91, v91, v114
    v_add_f32 v93, v93, v118
    v_add_f32_dpp v90, v90, v90 row_shr:1 row_mask:0xf bank_mask:0xf
    v_add_f32_dpp v91, v91, v91 row_shr:1 row_mask:0xf bank_mask:0xf
    v_add_f32_dpp v92, v92, v92 row_shr:1 row_mask:0xf bank_mask:0xf
    v_add_f32_dpp v93, v93, v93 row_shr:1 row_mask:0xf bank_mask:0xf
    v_add_f32_dpp v90, v90, v90 row_shr:2 row_mask:0xf bank_mask:0xf
    buffer_load_dwordx4 v21, s[24:27], s92 offen offset:1024 lds
    v_add_f32_dpp v91, v91, v91 row_shr:2 row_mask:0xf bank_mask:0xf
    v_add_f32_dpp v92, v92, v92 row_shr:2 row_mask:0xf bank_mask:0xf
    v_add_f32_dpp v93, v93, v93 row_shr:2 row_mask:0xf bank_mask:0xf
    v_add_f32_dpp v90, v90, v90 row_shr:4 row_mask:0xf bank_mask:0xf
    v_add_f32_dpp v91, v91, v91 row_shr:4 row_mask:0xf bank_mask:0xf
    v_add_f32_dpp v92, v92, v92 row_shr:4 row_mask:0xf bank_mask:0xf
    v_add_f32_dpp v93, v93, v93 row_shr:4 row_mask:0xf bank_mask:0xf
    buffer_load_dwordx4 v22, s[24:27], s92 offen offset:2048 lds
    v_add_f32_dpp v90, v90, v90 row_shr:8 row_mask:0xf bank_mask:0xf
    v_add_f32_dpp v91, v91, v91 row_shr:8 row_mask:0xf bank_mask:0xf
    v_add_f32_dpp v92, v92, v92 row_shr:8 row_mask:0xf bank_mask:0xf
    v_add_f32_dpp v93, v93, v93 row_shr:8 row_mask:0xf bank_mask:0xf
    v_add_f32_dpp v90, v90, v90 row_bcast:15 row_mask:0xa bank_mask:0xf
    v_add_f32_dpp v91, v91, v91 row_bcast:15 row_mask:0xa bank_mask:0xf
    v_add_f32_dpp v92, v92, v92 row_bcast:15 row_mask:0xa bank_mask:0xf
    buffer_load_dwordx4 v23, s[24:27], s92 offen offset:3072 lds
    v_add_f32_dpp v93, v93, v93 row_bcast:15 row_mask:0xa bank_mask:0xf
    v_add_f32_dpp v90, v90, v90 row_bcast:31 row_mask:0xc bank_mask:0xf
    v_add_f32_dpp v91, v91, v91 row_bcast:31 row_mask:0xc bank_mask:0xf
    v_add_f32_dpp v92, v92, v92 row_bcast:31 row_mask:0xc bank_mask:0xf
    v_add_f32_dpp v93, v93, v93 row_bcast:31 row_mask:0xc bank_mask:0xf
    v_mov_b32 v97, 0x8000
    v_mov_b32 v98, 0xffff
    s_add_u32 m0, s95, 106496
    s_nop 0
    buffer_load_dwordx4 v24, s[28:31], s93 offen offset:0 lds
    v_cvt_pk_bf16_f32 v94, v90, v91
    v_cvt_pk_bf16_f32 v104, v92, v93
    v_and_b32 v95, 0xffff, v94
    v_and_b32 v96, 0x8000, v94
    v_and_b32 v94, 0xffff0000, v94
    v_cmp_ne_u32 vcc, 0, v96
    v_mul_f32 v94, 0xbfb8aa3b, v94
    buffer_load_dwordx4 v25, s[28:31], s93 offen offset:1024 lds
    v_exp_f32 v94, v94
    v_cndmask_b32 v96, v97, v98, vcc
    v_xor_b32 v95, v95, v96
    v_add_f32 v94, 1.0, v94
    v_lshlrev_b32 v95, 11, v95
    v_rcp_f32 v94, v94
    s_sub_u32 s12, 2047, s22
    v_or_b32 v100, s12, v95
    s_add_u32 m0, s95, 114688
    s_nop 0
    buffer_load_dwordx4 v26, s[28:31], s93 offen offset:0 lds
    v_cvt_pk_bf16_f32 v94, v94, v94
    v_lshlrev_b32 v102, 16, v94
    v_and_b32 v105, 0xffff, v104
    v_and_b32 v106, 0x8000, v104
    v_and_b32 v104, 0xffff0000, v104
    v_cmp_ne_u32 vcc, 0, v106
    v_mul_f32 v104, 0xbfb8aa3b, v104
    buffer_load_dwordx4 v27, s[28:31], s93 offen offset:1024 lds
    v_exp_f32 v104, v104
    v_cndmask_b32 v106, v97, v98, vcc
    v_xor_b32 v105, v105, v106
    v_add_f32 v104, 1.0, v104
    v_lshlrev_b32 v105, 11, v105
    v_rcp_f32 v104, v104
    s_sub_u32 s12, 2046, s22
    v_or_b32 v101, s12, v105
    s_add_u32 m0, s95, 98304
    s_nop 0
    buffer_load_dwordx4 v28, s[28:31], s93 offen offset:0 lds
    v_cvt_pk_bf16_f32 v104, v104, v104
    v_lshlrev_b32 v103, 16, v104
    v_max_u32 v100, v100, v101
    s_lshl_b32 s12, s22, 2
    s_add_u32 s12, s12, 4096
    s_lshl_b32 s13, s21, 2
    s_add_u32 s13, s13, 162880
    v_mov_b32 v14, s13
    s_mov_b32 exec_lo, 0
    s_mov_b32 exec_hi, 0x80000000
    buffer_store_dwordx2 v[102:103], v13, s[32:35], s12 offen sc1
    ds_write_b32 v14, v100
    s_mov_b64 exec, -1
    s_waitcnt lgkmcnt(0)
    buffer_load_dwordx4 v29, s[28:31], s93 offen offset:1024 lds
    s_cmp_ge_u32 s10, 224
    s_cbranch_scc1 L_p30_3
    s_add_u32 s12, s71, 0
    buffer_load_dwordx4 v[128:131], v30, s[40:43], s12 offen nt
    s_add_u32 s12, s71, 7168
    buffer_load_dwordx4 v[132:135], v30, s[40:43], s12 offen nt
    s_add_u32 s12, s71, 14336
    buffer_load_dwordx4 v[136:139], v30, s[40:43], s12 offen nt
    s_add_u32 s12, s71, 21504
    buffer_load_dwordx4 v[140:143], v30, s[40:43], s12 offen nt
    s_add_u32 s12, s71, 28672
    buffer_load_dwordx4 v[144:147], v30, s[40:43], s12 offen nt
    s_add_u32 s12, s71, 35840
    buffer_load_dwordx4 v[148:151], v30, s[40:43], s12 offen nt
    s_add_u32 s12, s71, 43008
    buffer_load_dwordx4 v[152:155], v30, s[40:43], s12 offen nt
    s_add_u32 s12, s71, 50176
    buffer_load_dwordx4 v[156:159], v30, s[40:43], s12 offen nt
    s_branch L_p3e0_3
L_p30_3:
    s_mov_b64 exec, 63
    s_bfe_u32 s12, s68, 0x4000c
    s_mul_i32 s12, s12, 393216
    buffer_load_dword v128, v32, s[28:31], s12 offen
    s_bfe_u32 s12, s68, 0x40010
    s_mul_i32 s12, s12, 393216
    buffer_load_dword v132, v32, s[28:31], s12 offen
    s_bfe_u32 s12, s68, 0x40014
    s_mul_i32 s12, s12, 393216
    buffer_load_dword v136, v32, s[28:31], s12 offen
    s_bfe_u32 s12, s68, 0x40018
    s_mul_i32 s12, s12, 393216
    buffer_load_dword v140, v32, s[28:31], s12 offen
    s_bfe_u32 s12, s68, 0x4001c
    s_mul_i32 s12, s12, 393216
    buffer_load_dword v144, v32, s[28:31], s12 offen
    s_bfe_u32 s12, s69, 0x40000
    s_mul_i32 s12, s12, 393216
    buffer_load_dword v148, v32, s[28:31], s12 offen
    s_bfe_u32 s12, s69, 0x40004
    s_mul_i32 s12, s12, 393216
    buffer_load_dword v152, v32, s[28:31], s12 offen
    s_bfe_u32 s12, s69, 0x40008
    s_mul_i32 s12, s12, 393216
    buffer_load_dword v156, v32, s[28:31], s12 offen
    s_mov_b64 exec, -1
L_p3e0_3:
L_bw4_3:
    s_waitcnt vmcnt(20)
    s_barrier
    s_bfe_u32 s91, s68, 0x40018
    s_lshl_b32 s92, s91, 7
    s_mul_i32 s93, s91, 393216
    s_add_u32 m0, s94, 0
    s_nop 0
    buffer_load_dwordx4 v20, s[24:27], s92 offen offset:0 lds
    buffer_load_dwordx4 v21, s[24:27], s92 offen offset:1024 lds
    buffer_load_dwordx4 v22, s[24:27], s92 offen offset:2048 lds
    buffer_load_dwordx4 v23, s[24:27], s92 offen offset:3072 lds
    s_add_u32 m0, s95, 24576
    s_nop 0
    buffer_load_dwordx4 v24, s[28:31], s93 offen offset:0 lds
    s_waitcnt vmcnt(14)
L_bw5_3:
    s_waitcnt vmcnt(13)
    s_barrier
    s_add_u32 m0, s95, 24576
    s_nop 0
    buffer_load_dwordx4 v25, s[28:31], s93 offen offset:1024 lds
    s_add_u32 m0, s95, 32768
    s_nop 0
    buffer_load_dwordx4 v26, s[28:31], s93 offen offset:0 lds
    buffer_load_dwordx4 v27, s[28:31], s93 offen offset:1024 lds
    s_add_u32 m0, s95, 16384
    s_nop 0
    buffer_load_dwordx4 v28, s[28:31], s93 offen offset:0 lds
    buffer_load_dwordx4 v29, s[28:31], s93 offen offset:1024 lds
    s_bfe_u32 s91, s68, 0x4001c
    s_lshl_b32 s92, s91, 7
    s_mul_i32 s93, s91, 393216
    s_add_u32 m0, s94, 40960
    s_nop 0
    buffer_load_dwordx4 v20, s[24:27], s92 offen offset:0 lds
    buffer_load_dwordx4 v21, s[24:27], s92 offen offset:1024 lds
    buffer_load_dwordx4 v22, s[24:27], s92 offen offset:2048 lds
    buffer_load_dwordx4 v23, s[24:27], s92 offen offset:3072 lds
    s_add_u32 m0, s95, 65536
    s_nop 0
    buffer_load_dwordx4 v24, s[28:31], s93 offen offset:0 lds
    buffer_load_dwordx4 v25, s[28:31], s93 offen offset:1024 lds
    s_add_u32 m0, s95, 73728
    s_nop 0
    buffer_load_dwordx4 v26, s[28:31], s93 offen offset:0 lds
    s_mov_b32 s13, 0
L_tagchk_3:
    v_readfirstlane_b32 s23, v15
    s_nop 1
    s_cmp_lg_u32 s23, 0
    s_cbranch_scc1 L_tagok_3
    s_add_u32 s13, s13, 1
    s_cmp_ge_u32 s13, 16384
    s_cbranch_scc1 L_tagok_3
    buffer_load_dword v15, v13, s[72:75], 0 offen offset:4 sc1
    s_waitcnt vmcnt(0)
    s_branch L_tagchk_3
L_tagok_3:
    s_and_b32 s76, s23, 0xff
    s_bfe_u32 s77, s23, 0x80008
    s_bfe_u32 s78, s23, 0x80010
    s_lshr_b32 s79, s23, 24
    v_and_b32 v35, 3, v2
    v_lshlrev_b32 v35, 3, v35
    v_bfe_u32 v35, s23, v35, 8
    s_cmp_lg_u32 s21, 0
    s_cbranch_scc1 L_nopub_3
    v_mov_b32 v14, 162880
    ds_read_b128 v[104:107], v14
    s_lshl_b32 s12, s2, 3
    s_add_u32 s12, s12, 0
    s_waitcnt lgkmcnt(0)
    v_max3_u32 v104, v104, v105, v106
    v_max_u32 v104, v104, v107
    v_mov_b32 v105, s23
    s_mov_b64 exec, 1
    buffer_store_dwordx2 v[104:105], v13, s[32:35], s12 offen sc1
    s_mov_b64 exec, -1
L_nopub_3:
L_bw6_3:
    s_waitcnt vmcnt(7)
    s_barrier
    s_add_u32 m0, s95, 73728
    s_nop 0
    buffer_load_dwordx4 v27, s[28:31], s93 offen offset:1024 lds
    s_add_u32 m0, s95, 57344
    s_nop 0
    buffer_load_dwordx4 v28, s[28:31], s93 offen offset:0 lds
    buffer_load_dwordx4 v29, s[28:31], s93 offen offset:1024 lds
    s_bfe_u32 s91, s69, 0x40000
    s_lshl_b32 s92, s91, 7
    s_mul_i32 s93, s91, 393216
    s_add_u32 m0, s94, 81920
    s_nop 0
    buffer_load_dwordx4 v20, s[24:27], s92 offen offset:0 lds
    buffer_load_dwordx4 v21, s[24:27], s92 offen offset:1024 lds
    buffer_load_dwordx4 v22, s[24:27], s92 offen offset:2048 lds
    buffer_load_dwordx4 v23, s[24:27], s92 offen offset:3072 lds
    s_add_u32 m0, s95, 106496
    s_nop 0
    buffer_load_dwordx4 v24, s[28:31], s93 offen offset:0 lds
    buffer_load_dwordx4 v25, s[28:31], s93 offen offset:1024 lds
    s_add_u32 m0, s95, 114688
    s_nop 0
    buffer_load_dwordx4 v26, s[28:31], s93 offen offset:0 lds
    buffer_load_dwordx4 v27, s[28:31], s93 offen offset:1024 lds
    s_add_u32 m0, s95, 98304
    s_nop 0
    buffer_load_dwordx4 v28, s[28:31], s93 offen offset:0 lds
L_bw7_3:
    s_waitcnt vmcnt(9)
    s_barrier
    s_add_u32 m0, s95, 98304
    s_nop 0
    buffer_load_dwordx4 v29, s[28:31], s93 offen offset:1024 lds
    s_bfe_u32 s91, s69, 0x40004
    s_lshl_b32 s92, s91, 7
    s_mul_i32 s93, s91, 393216
    s_add_u32 m0, s94, 0
    s_nop 0
    buffer_load_dwordx4 v20, s[24:27], s92 offen offset:0 lds
    buffer_load_dwordx4 v21, s[24:27], s92 offen offset:1024 lds
    buffer_load_dwordx4 v22, s[24:27], s92 offen offset:2048 lds
    buffer_load_dwordx4 v23, s[24:27], s92 offen offset:3072 lds
    s_add_u32 m0, s95, 24576
    s_nop 0
    buffer_load_dwordx4 v24, s[28:31], s93 offen offset:0 lds
    buffer_load_dwordx4 v25, s[28:31], s93 offen offset:1024 lds
    s_add_u32 m0, s95, 32768
    s_nop 0
    buffer_load_dwordx4 v26, s[28:31], s93 offen offset:0 lds
    buffer_load_dwordx4 v27, s[28:31], s93 offen offset:1024 lds
    s_add_u32 m0, s95, 16384
    s_nop 0
    buffer_load_dwordx4 v28, s[28:31], s93 offen offset:0 lds
    buffer_load_dwordx4 v29, s[28:31], s93 offen offset:1024 lds
L_bw8_3:
    s_waitcnt vmcnt(10)
    s_barrier
    s_bfe_u32 s91, s69, 0x40008
    s_lshl_b32 s92, s91, 7
    s_mul_i32 s93, s91, 393216
    s_add_u32 m0, s94, 40960
    s_nop 0
    buffer_load_dwordx4 v20, s[24:27], s92 offen offset:0 lds
    buffer_load_dwordx4 v21, s[24:27], s92 offen offset:1024 lds
    buffer_load_dwordx4 v22, s[24:27], s92 offen offset:2048 lds
    buffer_load_dwordx4 v23, s[24:27], s92 offen offset:3072 lds
    s_add_u32 m0, s95, 65536
    s_nop 0
    buffer_load_dwordx4 v24, s[28:31], s93 offen offset:0 lds
    buffer_load_dwordx4 v25, s[28:31], s93 offen offset:1024 lds
    s_add_u32 m0, s95, 73728
    s_nop 0
    buffer_load_dwordx4 v26, s[28:31], s93 offen offset:0 lds
    buffer_load_dwordx4 v27, s[28:31], s93 offen offset:1024 lds
    s_add_u32 m0, s95, 57344
    s_nop 0
    buffer_load_dwordx4 v28, s[28:31], s93 offen offset:0 lds
    buffer_load_dwordx4 v29, s[28:31], s93 offen offset:1024 lds
    s_cmp_ge_u32 s10, 224
    s_cbranch_scc1 L_p31_3
    s_add_u32 s12, s9, 0
    buffer_load_dwordx4 v[160:163], v30, s[44:47], s12 offen nt
    s_add_u32 s12, s9, 7168
    buffer_load_dwordx4 v[164:167], v30, s[44:47], s12 offen nt
    s_add_u32 s12, s9, 14336
    buffer_load_dwordx4 v[168:171], v30, s[44:47], s12 offen nt
    s_add_u32 s12, s9, 21504
    buffer_load_dwordx4 v[172:175], v30, s[44:47], s12 offen nt
    s_add_u32 s12, s9, 28672
    buffer_load_dwordx4 v[176:179], v30, s[44:47], s12 offen nt
    s_add_u32 s12, s9, 35840
    buffer_load_dwordx4 v[180:183], v30, s[44:47], s12 offen nt
    s_add_u32 s12, s9, 43008
    buffer_load_dwordx4 v[184:187], v30, s[44:47], s12 offen nt
    s_add_u32 s12, s9, 50176
    buffer_load_dwordx4 v[188:191], v30, s[44:47], s12 offen nt
    s_branch L_p3e1_3
L_p31_3:
    s_mov_b64 exec, 63
    s_bfe_u32 s12, s69, 0x4000c
    s_mul_i32 s12, s12, 393216
    buffer_load_dword v160, v32, s[28:31], s12 offen
    s_bfe_u32 s12, s69, 0x40010
    s_mul_i32 s12, s12, 393216
    buffer_load_dword v164, v32, s[28:31], s12 offen
    s_bfe_u32 s12, s69, 0x40014
    s_mul_i32 s12, s12, 393216
    buffer_load_dword v168, v32, s[28:31], s12 offen
    s_bfe_u32 s12, s69, 0x40018
    s_mul_i32 s12, s12, 393216
    buffer_load_dword v172, v32, s[28:31], s12 offen
    s_bfe_u32 s12, s69, 0x4001c
    s_mul_i32 s12, s12, 393216
    buffer_load_dword v176, v32, s[28:31], s12 offen
    s_mov_b64 exec, 1
    s_bfe_u32 s12, s69, 0x4001c
    s_mul_i32 s12, s12, 393216
    buffer_load_dword v180, v32, s[28:31], s12 offen
    s_bfe_u32 s12, s69, 0x4001c
    s_mul_i32 s12, s12, 393216
    buffer_load_dword v184, v32, s[28:31], s12 offen
    s_bfe_u32 s12, s69, 0x4001c
    s_mul_i32 s12, s12, 393216
    buffer_load_dword v188, v32, s[28:31], s12 offen
    s_mov_b64 exec, -1
L_p3e1_3:
    s_mov_b32 exec_lo, 0xffff0000
    s_mov_b32 exec_hi, 0
    buffer_load_dword v19, v10, s[36:39], 0 offen
    s_mov_b64 exec, -1
L_bw9_3:
    s_waitcnt vmcnt(19)
    s_barrier
    s_bfe_u32 s91, s69, 0x4000c
    s_lshl_b32 s92, s91, 7
    s_mul_i32 s93, s91, 393216
    s_add_u32 m0, s94, 122880
    s_nop 0
    buffer_load_dwordx4 v20, s[24:27], s92 offen offset:0 lds
    buffer_load_dwordx4 v21, s[24:27], s92 offen offset:1024 lds
    buffer_load_dwordx4 v22, s[24:27], s92 offen offset:2048 lds
    buffer_load_dwordx4 v23, s[24:27], s92 offen offset:3072 lds
    s_add_u32 m0, s95, 106496
    s_nop 0
    buffer_load_dwordx4 v24, s[28:31], s93 offen offset:0 lds
    s_mov_b32 s12, 0
    buffer_load_dwordx4 v[104:107], v5, s[32:35], s12 offen offset:0 sc1
    buffer_load_dwordx4 v[108:111], v5, s[32:35], s12 offen offset:1024 sc1
L_bw10_3:
    s_waitcnt vmcnt(16)
    s_barrier
    s_add_u32 m0, s95, 106496
    s_nop 0
    buffer_load_dwordx4 v25, s[28:31], s93 offen offset:1024 lds
    s_add_u32 m0, s95, 114688
    s_nop 0
    buffer_load_dwordx4 v26, s[28:31], s93 offen offset:0 lds
    buffer_load_dwordx4 v27, s[28:31], s93 offen offset:1024 lds
    s_bfe_u32 s91, s69, 0x40010
    s_lshl_b32 s92, s91, 7
    s_mul_i32 s93, s91, 393216
    s_add_u32 m0, s94, 139264
    s_nop 0
    buffer_load_dwordx4 v20, s[24:27], s92 offen offset:0 lds
    buffer_load_dwordx4 v21, s[24:27], s92 offen offset:1024 lds
    buffer_load_dwordx4 v22, s[24:27], s92 offen offset:2048 lds
    buffer_load_dwordx4 v23, s[24:27], s92 offen offset:3072 lds
    s_add_u32 m0, s95, 24576
    s_nop 0
    buffer_load_dwordx4 v24, s[28:31], s93 offen offset:0 lds
    buffer_load_dwordx4 v25, s[28:31], s93 offen offset:1024 lds
    s_add_u32 m0, s95, 32768
    s_nop 0
    buffer_load_dwordx4 v26, s[28:31], s93 offen offset:0 lds
L_bw11_3:
    s_waitcnt vmcnt(7)
    s_barrier
    s_add_u32 m0, s95, 32768
    s_nop 0
    buffer_load_dwordx4 v27, s[28:31], s93 offen offset:1024 lds
    s_mov_b32 s13, 0
    v_xor_b32 v105, s23, v105
    v_xor_b32 v107, s23, v107
    v_xor_b32 v109, s23, v109
    v_xor_b32 v111, s23, v111
    v_or3_b32 v105, v105, v107, v109
    v_or_b32 v105, v105, v111
    v_cmp_ne_u32 vcc, 0, v105
    s_cbranch_vccnz L_keyre_3
L_keyok_3:
    v_max3_u32 v104, v104, v106, v108
    v_max_u32 v104, v104, v110
    s_nop 1
    v_max_u32_dpp v104, v104, v104 row_shr:1 row_mask:0xf bank_mask:0xf
    s_nop 1
    v_max_u32_dpp v104, v104, v104 row_shr:2 row_mask:0xf bank_mask:0xf
    s_nop 1
    v_max_u32_dpp v104, v104, v104 row_shr:4 row_mask:0xf bank_mask:0xf
    s_bfe_u32 s91, s69, 0x40014
    s_lshl_b32 s92, s91, 7
    s_mul_i32 s93, s91, 393216
    s_add_u32 m0, s94, 40960
    s_nop 0
    buffer_load_dwordx4 v20, s[24:27], s92 offen offset:0 lds
    v_max_u32_dpp v104, v104, v104 row_shr:8 row_mask:0xf bank_mask:0xf
    s_nop 1
    v_max_u32_dpp v104, v104, v104 row_bcast:15 row_mask:0xa bank_mask:0xf
    s_nop 1
    v_max_u32_dpp v104, v104, v104 row_bcast:31 row_mask:0xc bank_mask:0xf
    s_nop 0
    v_readlane_b32 s14, v104, 63
    s_nop 1
    s_and_b32 s15, s14, 2047
    s_sub_u32 s15, 2047, s15
    s_lshl_b32 s12, s15, 11
    s_lshl_b32 s13, s70, 1
    s_add_u32 s12, s12, s13
    buffer_load_dwordx4 v[36:39], v34, s[24:27], s12 offen
    buffer_load_dwordx4 v21, s[24:27], s92 offen offset:1024 lds
    s_lshr_b32 s12, s14, 11
    s_and_b32 s13, s12, 0x8000
    s_cmp_lg_u32 s13, 0
    s_mov_b32 s13, 0xffff
    s_cselect_b32 s13, 0x8000, s13
    s_xor_b32 s12, s12, s13
    s_lshl_b32 s12, s12, 16
    v_mov_b32 v105, s12
    buffer_load_dwordx4 v22, s[24:27], s92 offen offset:2048 lds
    v_mul_f32 v105, 0xbfb8aa3b, v105
    v_exp_f32 v105, v105
    s_nop 0
    v_add_f32 v105, 1.0, v105
    v_rcp_f32 v105, v105
    s_nop 0
    v_cvt_pk_bf16_f32 v105, v105, v105
    v_lshlrev_b32 v105, 16, v105
    s_add_u32 s12, s15, 1
    v_mov_b32 v104, s12
    buffer_load_dwordx4 v23, s[24:27], s92 offen offset:3072 lds
    v_mov_b32 v106, s23
    v_readfirstlane_b32 s14, v105
    v_mov_b32 v14, 162864
    s_mov_b64 exec, 1
    ds_write_b96 v14, v[104:106]
    s_mov_b64 exec, -1
    s_waitcnt lgkmcnt(0)
    s_add_u32 m0, s95, 65536
    s_nop 0
    buffer_load_dwordx4 v24, s[28:31], s93 offen offset:0 lds
    buffer_load_dwordx4 v25, s[28:31], s93 offen offset:1024 lds
    s_add_u32 m0, s95, 73728
    s_nop 0
    buffer_load_dwordx4 v26, s[28:31], s93 offen offset:0 lds
    buffer_load_dwordx4 v27, s[28:31], s93 offen offset:1024 lds
L_bw12_3:
    s_waitcnt vmcnt(9)
    s_barrier
    s_bfe_u32 s91, s69, 0x40018
    s_lshl_b32 s92, s91, 7
    s_mul_i32 s93, s91, 393216
    s_add_u32 m0, s94, 81920
    s_nop 0
    buffer_load_dwordx4 v20, s[24:27], s92 offen offset:0 lds
    s_waitcnt vmcnt(8)
    s_mov_b32 s8, 0xffff0000
    v_lshlrev_b32 v40, 16, v36
    v_and_b32 v41, s8, v36
    v_lshlrev_b32 v42, 16, v37
    v_and_b32 v43, s8, v37
    v_lshlrev_b32 v44, 16, v38
    buffer_load_dwordx4 v21, s[24:27], s92 offen offset:1024 lds
    v_and_b32 v45, s8, v38
    v_lshlrev_b32 v46, 16, v39
    v_and_b32 v47, s8, v39
    v_lshlrev_b32 v48, 16, v128
    v_lshlrev_b32 v49, 16, v129
    v_and_b32 v128, s8, v128
    v_and_b32 v129, s8, v129
    buffer_load_dwordx4 v22, s[24:27], s92 offen offset:2048 lds
    v_mul_f32 v220, v48, v40
    v_mul_f32 v222, v49, v40
    v_mul_f32 v221, v128, v40
    v_mul_f32 v223, v129, v40
    v_lshlrev_b32 v50, 16, v130
    v_lshlrev_b32 v51, 16, v131
    v_and_b32 v130, s8, v130
    buffer_load_dwordx4 v23, s[24:27], s92 offen offset:3072 lds
    v_and_b32 v131, s8, v131
    v_mul_f32 v224, v50, v40
    v_mul_f32 v226, v51, v40
    v_mul_f32 v225, v130, v40
    v_mul_f32 v227, v131, v40
    v_lshlrev_b32 v48, 16, v160
    v_lshlrev_b32 v49, 16, v161
    s_add_u32 m0, s95, 106496
    s_nop 0
    buffer_load_dwordx4 v24, s[28:31], s93 offen offset:0 lds
    v_and_b32 v160, s8, v160
    v_and_b32 v161, s8, v161
    v_mul_f32 v228, v48, v40
    v_mul_f32 v230, v49, v40
    v_mul_f32 v229, v160, v40
    v_mul_f32 v231, v161, v40
    v_lshlrev_b32 v50, 16, v162
    buffer_load_dwordx4 v25, s[28:31], s93 offen offset:1024 lds
    v_lshlrev_b32 v51, 16, v163
    v_and_b32 v162, s8, v162
    v_and_b32 v163, s8, v163
    v_mul_f32 v232, v50, v40
    v_mul_f32 v234, v51, v40
    v_mul_f32 v233, v162, v40
    v_mul_f32 v235, v163, v40
    s_add_u32 m0, s95, 114688
    s_nop 0
    buffer_load_dwordx4 v26, s[28:31], s93 offen offset:0 lds
    v_lshlrev_b32 v48, 16, v132
    v_lshlrev_b32 v49, 16, v133
    v_and_b32 v132, s8, v132
    v_and_b32 v133, s8, v133
    v_fmac_f32 v220, v48, v41
    v_fmac_f32 v222, v49, v41
    v_fmac_f32 v221, v132, v41
    v_fmac_f32 v223, v133, v41
    v_lshlrev_b32 v50, 16, v134
    v_lshlrev_b32 v51, 16, v135
    v_and_b32 v134, s8, v134
    v_and_b32 v135, s8, v135
    v_fmac_f32 v224, v50, v41
    v_fmac_f32 v226, v51, v41
    buffer_load_dwordx4 v27, s[28:31], s93 offen offset:1024 lds
    v_fmac_f32 v225, v134, v41
    v_fmac_f32 v227, v135, v41
    v_lshlrev_b32 v48, 16, v164
    v_lshlrev_b32 v49, 16, v165
    v_and_b32 v164, s8, v164
    v_and_b32 v165, s8, v165
    v_fmac_f32 v228, v48, v41
    v_fmac_f32 v230, v49, v41
    v_fmac_f32 v229, v164, v41
    v_fmac_f32 v231, v165, v41
    v_lshlrev_b32 v50, 16, v166
    v_lshlrev_b32 v51, 16, v167
    v_and_b32 v166, s8, v166
    v_and_b32 v167, s8, v167
    v_fmac_f32 v232, v50, v41
    v_fmac_f32 v234, v51, v41
    v_fmac_f32 v233, v166, v41
    v_fmac_f32 v235, v167, v41
    v_lshlrev_b32 v48, 16, v136
    v_lshlrev_b32 v49, 16, v137
    v_and_b32 v136, s8, v136
    v_and_b32 v137, s8, v137
    v_fmac_f32 v220, v48, v42
    v_fmac_f32 v222, v49, v42
    v_fmac_f32 v221, v136, v42
    v_fmac_f32 v223, v137, v42
    v_lshlrev_b32 v50, 16, v138
    v_lshlrev_b32 v51, 16, v139
    v_and_b32 v138, s8, v138
    v_and_b32 v139, s8, v139
    v_fmac_f32 v224, v50, v42
    v_fmac_f32 v226, v51, v42
    v_fmac_f32 v225, v138, v42
    v_fmac_f32 v227, v139, v42
    v_lshlrev_b32 v48, 16, v168
    v_lshlrev_b32 v49, 16, v169
    v_and_b32 v168, s8, v168
    v_and_b32 v169, s8, v169
    v_fmac_f32 v228, v48, v42
L_bw13_3:
    s_waitcnt vmcnt(8)
    s_barrier
    s_bfe_u32 s91, s69, 0x4001c
    s_lshl_b32 s92, s91, 7
    s_mul_i32 s93, s91, 393216
    s_add_u32 m0, s94, 0
    s_nop 0
    buffer_load_dwordx4 v20, s[24:27], s92 offen offset:0 lds
    v_fmac_f32 v230, v49, v42
    v_fmac_f32 v229, v168, v42
    v_fmac_f32 v231, v169, v42
    v_lshlrev_b32 v50, 16, v170
    v_lshlrev_b32 v51, 16, v171
    v_and_b32 v170, s8, v170
    v_and_b32 v171, s8, v171
    buffer_load_dwordx4 v21, s[24:27], s92 offen offset:1024 lds
    v_fmac_f32 v232, v50, v42
    v_fmac_f32 v234, v51, v42
    v_fmac_f32 v233, v170, v42
    v_fmac_f32 v235, v171, v42
    v_lshlrev_b32 v48, 16, v140
    v_lshlrev_b32 v49, 16, v141
    v_and_b32 v140, s8, v140
    buffer_load_dwordx4 v22, s[24:27], s92 offen offset:2048 lds
    v_and_b32 v141, s8, v141
    v_fmac_f32 v220, v48, v43
    v_fmac_f32 v222, v49, v43
    v_fmac_f32 v221, v140, v43
    v_fmac_f32 v223, v141, v43
    v_lshlrev_b32 v50, 16, v142
    v_lshlrev_b32 v51, 16, v143
    buffer_load_dwordx4 v23, s[24:27], s92 offen offset:3072 lds
    v_and_b32 v142, s8, v142
    v_and_b32 v143, s8, v143
    v_fmac_f32 v224, v50, v43
    v_fmac_f32 v226, v51, v43
    v_fmac_f32 v225, v142, v43
    v_fmac_f32 v227, v143, v43
    v_lshlrev_b32 v48, 16, v172
    s_add_u32 m0, s95, 24576
    s_nop 0
    buffer_load_dwordx4 v24, s[28:31], s93 offen offset:0 lds
    v_lshlrev_b32 v49, 16, v173
    v_and_b32 v172, s8, v172
    v_and_b32 v173, s8, v173
    v_fmac_f32 v228, v48, v43
    v_fmac_f32 v230, v49, v43
    v_fmac_f32 v229, v172, v43
    v_fmac_f32 v231, v173, v43
    buffer_load_dwordx4 v25, s[28:31], s93 offen offset:1024 lds
    v_lshlrev_b32 v50, 16, v174
    v_lshlrev_b32 v51, 16, v175
    v_and_b32 v174, s8, v174
    v_and_b32 v175, s8, v175
    v_fmac_f32 v232, v50, v43
    v_fmac_f32 v234, v51, v43
    v_fmac_f32 v233, v174, v43
    s_add_u32 m0, s95, 32768
    s_nop 0
    buffer_load_dwordx4 v26, s[28:31], s93 offen offset:0 lds
    v_fmac_f32 v235, v175, v43
    v_lshlrev_b32 v48, 16, v144
    v_lshlrev_b32 v49, 16, v145
    v_and_b32 v144, s8, v144
    v_and_b32 v145, s8, v145
    v_fmac_f32 v220, v48, v44
    v_fmac_f32 v222, v49, v44
    v_fmac_f32 v221, v144, v44
    v_fmac_f32 v223, v145, v44
    v_lshlrev_b32 v50, 16, v146
    v_lshlrev_b32 v51, 16, v147
    v_and_b32 v146, s8, v146
    v_and_b32 v147, s8, v147
    v_fmac_f32 v224, v50, v44
    buffer_load_dwordx4 v27, s[28:31], s93 offen offset:1024 lds
    v_fmac_f32 v226, v51, v44
    v_fmac_f32 v225, v146, v44
    v_fmac_f32 v227, v147, v44
    v_lshlrev_b32 v48, 16, v176
    v_lshlrev_b32 v49, 16, v177
    v_and_b32 v176, s8, v176
    v_and_b32 v177, s8, v177
    v_fmac_f32 v228, v48, v44
    v_fmac_f32 v230, v49, v44
    v_fmac_f32 v229, v176, v44
    v_fmac_f32 v231, v177, v44
    v_lshlrev_b32 v50, 16, v178
    v_lshlrev_b32 v51, 16, v179
    v_and_b32 v178, s8, v178
    s_add_u32 s12, s97, 0
    buffer_load_dwordx4 v[192:195], v31, s[64:67], s12 offen nt
    s_add_u32 s12, s97, 16384
    buffer_load_dwordx4 v[196:199], v31, s[64:67], s12 offen nt
    s_add_u32 s12, s97, 32768
    buffer_load_dwordx4 v[200:203], v31, s[64:67], s12 offen nt
    s_add_u32 s12, s97, 49152
    buffer_load_dwordx4 v[204:207], v31, s[64:67], s12 offen nt
    s_add_u32 s12, s97, 65536
    buffer_load_dwordx4 v[208:211], v31, s[64:67], s12 offen nt
    s_add_u32 s12, s97, 81920
    buffer_load_dwordx4 v[212:215], v31, s[64:67], s12 offen nt
    s_add_u32 s12, s97, 98304
    buffer_load_dwordx4 v[216:219], v31, s[64:67], s12 offen nt
    v_and_b32 v179, s8, v179
    v_fmac_f32 v232, v50, v44
    v_fmac_f32 v234, v51, v44
    v_fmac_f32 v233, v178, v44
    v_fmac_f32 v235, v179, v44
    v_lshlrev_b32 v48, 16, v148
    v_lshlrev_b32 v49, 16, v149
    v_and_b32 v148, s8, v148
    v_and_b32 v149, s8, v149
    v_fmac_f32 v220, v48, v45
    v_fmac_f32 v222, v49, v45
    v_fmac_f32 v221, v148, v45
    v_fmac_f32 v223, v149, v45
    v_lshlrev_b32 v50, 16, v150
    v_lshlrev_b32 v51, 16, v151
    v_and_b32 v150, s8, v150
    v_and_b32 v151, s8, v151
    v_fmac_f32 v224, v50, v45
    v_fmac_f32 v226, v51, v45
    v_fmac_f32 v225, v150, v45
    v_fmac_f32 v227, v151, v45
    v_lshlrev_b32 v48, 16, v180
    v_lshlrev_b32 v49, 16, v181
    v_and_b32 v180, s8, v180
    v_and_b32 v181, s8, v181
L_bw14_3:
    s_waitcnt vmcnt(15)
    s_barrier
    s_bfe_u32 s12, s69, 0x4000c
    s_mul_i32 s12, s12, 393216
    s_add_u32 m0, s95, 16384
    s_nop 0
    buffer_load_dwordx4 v28, s[28:31], s12 offen offset:0 lds
    buffer_load_dwordx4 v29, s[28:31], s12 offen offset:1024 lds
    s_bfe_u32 s12, s69, 0x40010
    s_mul_i32 s12, s12, 393216
    s_add_u32 m0, s95, 57344
    s_nop 0
    buffer_load_dwordx4 v28, s[28:31], s12 offen offset:0 lds
    buffer_load_dwordx4 v29, s[28:31], s12 offen offset:1024 lds
    s_mul_i32 s12, s21, 16
    s_add_u32 s12, s12, 0
    s_and_b32 s90, s88, 1
    s_lshl_b32 s90, s90, 6
    s_xor_b32 s12, s12, s90
    s_lshl_b32 s12, s12, 14
    s_add_u32 s90, s12, 0
    buffer_load_dwordx4 v[84:87], v33, s[36:39], s90 offen
    s_add_u32 s90, s12, 16384
    buffer_load_dwordx4 v[88:91], v33, s[36:39], s90 offen
    s_add_u32 s90, s12, 32768
    buffer_load_dwordx4 v[92:95], v33, s[36:39], s90 offen
    s_add_u32 s90, s12, 49152
    buffer_load_dwordx4 v[96:99], v33, s[36:39], s90 offen
    s_add_u32 s90, s12, 65536
    buffer_load_dwordx4 v[100:103], v33, s[36:39], s90 offen
    s_add_u32 s90, s12, 81920
    buffer_load_dwordx4 v[116:119], v33, s[36:39], s90 offen
    s_add_u32 s90, s12, 98304
    buffer_load_dwordx4 v[120:123], v33, s[36:39], s90 offen
    s_add_u32 s90, s12, 114688
    buffer_load_dwordx4 v[124:127], v33, s[36:39], s90 offen
    s_add_u32 s90, s12, 131072
    buffer_load_dwordx4 v[64:67], v33, s[36:39], s90 offen
    v_fmac_f32 v228, v48, v45
    v_fmac_f32 v230, v49, v45
    v_fmac_f32 v229, v180, v45
    v_fmac_f32 v231, v181, v45
    v_lshlrev_b32 v50, 16, v182
    v_lshlrev_b32 v51, 16, v183
    v_and_b32 v182, s8, v182
    v_and_b32 v183, s8, v183
    v_fmac_f32 v232, v50, v45
    v_fmac_f32 v234, v51, v45
    v_fmac_f32 v233, v182, v45
    v_fmac_f32 v235, v183, v45
    v_lshlrev_b32 v48, 16, v152
    v_lshlrev_b32 v49, 16, v153
    v_and_b32 v152, s8, v152
    v_and_b32 v153, s8, v153
    v_fmac_f32 v220, v48, v46
    v_fmac_f32 v222, v49, v46
    v_fmac_f32 v221, v152, v46
    v_fmac_f32 v223, v153, v46
    v_lshlrev_b32 v50, 16, v154
    v_lshlrev_b32 v51, 16, v155
    v_and_b32 v154, s8, v154
    v_and_b32 v155, s8, v155
    v_fmac_f32 v224, v50, v46
L_bw15_3:
    s_waitcnt vmcnt(20)
    s_barrier
    v_fmac_f32 v226, v51, v46
    v_fmac_f32 v225, v154, v46
    v_fmac_f32 v227, v155, v46
    v_lshlrev_b32 v48, 16, v184
    v_lshlrev_b32 v49, 16, v185
    v_and_b32 v184, s8, v184
    v_and_b32 v185, s8, v185
    v_fmac_f32 v228, v48, v46
    v_fmac_f32 v230, v49, v46
    v_fmac_f32 v229, v184, v46
    v_fmac_f32 v231, v185, v46
    v_lshlrev_b32 v50, 16, v186
    v_lshlrev_b32 v51, 16, v187
    v_and_b32 v186, s8, v186
    v_and_b32 v187, s8, v187
    v_fmac_f32 v232, v50, v46
    v_fmac_f32 v234, v51, v46
    v_fmac_f32 v233, v186, v46
    v_fmac_f32 v235, v187, v46
    v_lshlrev_b32 v48, 16, v156
    v_lshlrev_b32 v49, 16, v157
    v_and_b32 v156, s8, v156
    v_and_b32 v157, s8, v157
    v_fmac_f32 v220, v48, v47
    v_fmac_f32 v222, v49, v47
    v_fmac_f32 v221, v156, v47
    v_fmac_f32 v223, v157, v47
    v_lshlrev_b32 v50, 16, v158
    v_lshlrev_b32 v51, 16, v159
    v_and_b32 v158, s8, v158
    v_and_b32 v159, s8, v159
    v_fmac_f32 v224, v50, v47
    v_fmac_f32 v226, v51, v47
    v_fmac_f32 v225, v158, v47
    v_fmac_f32 v227, v159, v47
    v_lshlrev_b32 v48, 16, v188
    v_lshlrev_b32 v49, 16, v189
    v_and_b32 v188, s8, v188
    v_and_b32 v189, s8, v189
    v_fmac_f32 v228, v48, v47
    v_fmac_f32 v230, v49, v47
    v_fmac_f32 v229, v188, v47
    v_fmac_f32 v231, v189, v47
    v_lshlrev_b32 v50, 16, v190
    v_lshlrev_b32 v51, 16, v191
    v_and_b32 v190, s8, v190
    v_and_b32 v191, s8, v191
    v_fmac_f32 v232, v50, v47
    v_fmac_f32 v234, v51, v47
    v_fmac_f32 v233, v190, v47
    v_fmac_f32 v235, v191, v47
    v_permlane32_swap_b32 v220, v228
    v_permlane32_swap_b32 v221, v229
    v_permlane32_swap_b32 v222, v230
    v_permlane32_swap_b32 v223, v231
    v_permlane32_swap_b32 v224, v232
    v_permlane32_swap_b32 v225, v233
    v_permlane32_swap_b32 v226, v234
    v_permlane32_swap_b32 v227, v235
    v_add_f32 v220, v220, v228
    v_add_f32 v221, v221, v229
    v_add_f32 v222, v222, v230
    v_add_f32 v223, v223, v231
    v_add_f32 v224, v224, v232
    v_add_f32 v225, v225, v233
    v_add_f32 v226, v226, v234
    v_add_f32 v227, v227, v235
    v_permlane16_swap_b32 v220, v224
    v_permlane16_swap_b32 v221, v225
    v_permlane16_swap_b32 v222, v226
    v_permlane16_swap_b32 v223, v227
    v_add_f32 v220, v220, v224
    v_add_f32 v221, v221, v225
    v_add_f32 v222, v222, v226
    v_add_f32 v223, v223, v227
    v_add_f32_dpp v220, v220, v220 row_ror:8 row_mask:0xf bank_mask:0xf
    v_add_f32_dpp v221, v221, v221 row_ror:8 row_mask:0xf bank_mask:0xf
    v_add_f32_dpp v222, v222, v222 row_ror:8 row_mask:0xf bank_mask:0xf
    v_add_f32_dpp v223, v223, v223 row_ror:8 row_mask:0xf bank_mask:0xf
    s_branch L_varend
.fill 411, 4, 0xbf800000
L_var4:
    s_nop 0
    s_waitcnt vmcnt(6)
    s_barrier
    s_add_u32 m0, s95, 73728
    s_nop 0
    buffer_load_dwordx4 v26, s[28:31], s93 offen offset:0 lds
    buffer_load_dwordx4 v27, s[28:31], s93 offen offset:1024 lds
    s_add_u32 m0, s95, 57344
    s_nop 0
    buffer_load_dwordx4 v28, s[28:31], s93 offen offset:0 lds
    buffer_load_dwordx4 v29, s[28:31], s93 offen offset:1024 lds
    s_bfe_u32 s91, s68, 0x40008
    s_lshl_b32 s92, s91, 7
    s_mul_i32 s93, s91, 393216
    s_add_u32 m0, s94, 81920
    s_nop 0
    buffer_load_dwordx4 v20, s[24:27], s92 offen offset:0 lds
    buffer_load_dwordx4 v21, s[24:27], s92 offen offset:1024 lds
    buffer_load_dwordx4 v22, s[24:27], s92 offen offset:2048 lds
    buffer_load_dwordx4 v23, s[24:27], s92 offen offset:3072 lds
    s_add_u32 m0, s95, 106496
    s_nop 0
    buffer_load_dwordx4 v24, s[28:31], s93 offen offset:0 lds
    buffer_load_dwordx4 v25, s[28:31], s93 offen offset:1024 lds
    s_add_u32 m0, s95, 114688
    s_nop 0
    buffer_load_dwordx4 v26, s[28:31], s93 offen offset:0 lds
    buffer_load_dwordx4 v27, s[28:31], s93 offen offset:1024 lds
    s_add_u32 m0, s95, 98304
    s_nop 0
    buffer_load_dwordx4 v28, s[28:31], s93 offen offset:0 lds
    buffer_load_dwordx4 v29, s[28:31], s93 offen offset:1024 lds
    s_lshl_b32 s12, s19, 2
    s_add_u32 s12, s12, s21
    s_lshl_b32 s12, s12, 10
    s_lshl_b32 s13, s21, 10
    s_add_u32 m0, s13, 155648
    s_nop 0
    buffer_load_dwordx4 v5, s[76:79], s12 offen lds
    s_lshl_b32 s12, s22, 11
    buffer_load_dwordx4 v[40:43], v5, s[24:27], s12 offen offset:0
    buffer_load_dwordx4 v[44:47], v5, s[24:27], s12 offen offset:1024
    buffer_load_dwordx4 v[48:51], v5, s[24:27], s12 offen offset:2048
    buffer_load_dwordx4 v[52:55], v5, s[24:27], s12 offen offset:3072
    buffer_load_dwordx4 v[56:59], v5, s[80:83], 0 offen offset:0
    buffer_load_dwordx4 v[60:63], v5, s[80:83], 0 offen offset:1024
    buffer_load_dwordx4 v[64:67], v5, s[84:87], 0 offen offset:0
    buffer_load_dwordx4 v[68:71], v5, s[84:87], 0 offen offset:1024
L_bw1_4:
    s_waitcnt vmcnt(19)
    s_barrier
    s_bfe_u32 s91, s68, 0x4000c
    s_lshl_b32 s92, s91, 7
    s_mul_i32 s93, s91, 393216
    s_add_u32 m0, s94, 0
    s_nop 0
    buffer_load_dwordx4 v20, s[24:27], s92 offen offset:0 lds
    s_waitcnt vmcnt(1)
    s_mov_b32 s8, 0xffff0000
    v_lshlrev_b32 v72, 16, v56
    v_and_b32 v56, s8, v56
    v_lshlrev_b32 v73, 16, v64
    v_and_b32 v64, s8, v64
    v_lshlrev_b32 v112, 16, v40
    buffer_load_dwordx4 v21, s[24:27], s92 offen offset:1024 lds
    v_and_b32 v40, s8, v40
    v_lshlrev_b32 v116, 16, v48
    v_and_b32 v48, s8, v48
    v_mul_f32 v113, v112, v73
    v_mul_f32 v114, v40, v64
    v_mul_f32 v90, v112, v72
    v_mul_f32 v117, v116, v73
    buffer_load_dwordx4 v22, s[24:27], s92 offen offset:2048 lds
    v_mul_f32 v118, v48, v64
    v_mul_f32 v92, v116, v72
    v_cvt_pk_bf16_f32 v113, 0, v113
    v_cvt_pk_bf16_f32 v114, 0, v114
    v_fmac_f32 v90, v40, v56
    v_cvt_pk_bf16_f32 v117, 0, v117
    v_cvt_pk_bf16_f32 v118, 0, v118
    buffer_load_dwordx4 v23, s[24:27], s92 offen offset:3072 lds
    v_fmac_f32 v92, v48, v56
    v_add_f32 v91, v113, v114
    v_add_f32 v93, v117, v118
    v_lshlrev_b32 v72, 16, v57
    v_and_b32 v57, s8, v57
    v_lshlrev_b32 v73, 16, v65
    v_and_b32 v65, s8, v65
    s_add_u32 m0, s95, 24576
    s_nop 0
    buffer_load_dwordx4 v24, s[28:31], s93 offen offset:0 lds
    v_lshlrev_b32 v112, 16, v41
    v_and_b32 v41, s8, v41
    v_lshlrev_b32 v116, 16, v49
    v_and_b32 v49, s8, v49
    v_mul_f32 v113, v112, v73
    v_mul_f32 v114, v41, v65
    v_fmac_f32 v90, v112, v72
    buffer_load_dwordx4 v25, s[28:31], s93 offen offset:1024 lds
    v_mul_f32 v117, v116, v73
    v_mul_f32 v118, v49, v65
    v_fmac_f32 v92, v116, v72
    v_cvt_pk_bf16_f32 v113, 0, v113
    v_cvt_pk_bf16_f32 v114, 0, v114
    v_fmac_f32 v90, v41, v57
    v_cvt_pk_bf16_f32 v117, 0, v117
    s_add_u32 m0, s95, 32768
    s_nop 0
    buffer_load_dwordx4 v26, s[28:31], s93 offen offset:0 lds
    v_cvt_pk_bf16_f32 v118, 0, v118
    v_fmac_f32 v92, v49, v57
    v_add_f32 v91, v91, v113
    v_add_f32 v93, v93, v117
    v_add_f32 v91, v91, v114
    v_add_f32 v93, v93, v118
    v_lshlrev_b32 v72, 16, v58
    buffer_load_dwordx4 v27, s[28:31], s93 offen offset:1024 lds
    v_and_b32 v58, s8, v58
    v_lshlrev_b32 v73, 16, v66
    v_and_b32 v66, s8, v66
    v_lshlrev_b32 v112, 16, v42
    v_and_b32 v42, s8, v42
    v_lshlrev_b32 v116, 16, v50
    v_and_b32 v50, s8, v50
    s_add_u32 m0, s95, 16384
    s_nop 0
    buffer_load_dwordx4 v28, s[28:31], s93 offen offset:0 lds
    v_mul_f32 v113, v112, v73
    v_mul_f32 v114, v42, v66
    v_fmac_f32 v90, v112, v72
    v_mul_f32 v117, v116, v73
    v_mul_f32 v118, v50, v66
    v_fmac_f32 v92, v116, v72
    v_cvt_pk_bf16_f32 v113, 0, v113
    buffer_load_dwordx4 v29, s[28:31], s93 offen offset:1024 lds
    v_cvt_pk_bf16_f32 v114, 0, v114
    v_fmac_f32 v90, v42, v58
    v_cvt_pk_bf16_f32 v117, 0, v117
    v_cvt_pk_bf16_f32 v118, 0, v118
    v_fmac_f32 v92, v50, v58
    v_add_f32 v91, v91, v113
    v_add_f32 v93, v93, v117
    s_cmp_lg_u32 s21, 0
    s_cbranch_scc1 L_noclr_4
    v_mov_b32 v104, -1
    v_mov_b32 v105, -1
    v_mov_b32 v106, -1
    v_mov_b32 v107, -1
    s_lshl_b32 s12, s19, 13
    s_lshl_b32 s13, s18, 9
    s_add_u32 s12, s12, s13
    s_add_u32 s12, s12, 32768
    s_lshl_b32 s13, s19, 11
    s_lshl_b32 s90, s18, 7
    s_add_u32 s13, s13, s90
    s_add_u32 s13, s13, 163840
    s_mov_b32 exec_hi, 0
    buffer_store_dwordx4 v[104:107], v5, s[32:35], s12 offen sc1
    s_mov_b32 exec_lo, 255
    buffer_store_dwordx4 v[104:107], v5, s[32:35], s13 offen sc1
    s_mov_b64 exec, -1
L_noclr_4:
    v_add_f32 v91, v91, v114
    v_add_f32 v93, v93, v118
    v_lshlrev_b32 v72, 16, v59
    v_and_b32 v59, s8, v59
    v_lshlrev_b32 v73, 16, v67
    v_and_b32 v67, s8, v67
    v_lshlrev_b32 v112, 16, v43
    v_and_b32 v43, s8, v43
    v_lshlrev_b32 v116, 16, v51
    v_and_b32 v51, s8, v51
    v_mul_f32 v113, v112, v73
    v_mul_f32 v114, v43, v67
    v_fmac_f32 v90, v112, v72
    v_mul_f32 v117, v116, v73
    v_mul_f32 v118, v51, v67
    v_fmac_f32 v92, v116, v72
    v_cvt_pk_bf16_f32 v113, 0, v113
    v_cvt_pk_bf16_f32 v114, 0, v114
    v_fmac_f32 v90, v43, v59
    v_cvt_pk_bf16_f32 v117, 0, v117
    v_cvt_pk_bf16_f32 v118, 0, v118
    v_fmac_f32 v92, v51, v59
    v_add_f32 v91, v91, v113
    v_add_f32 v93, v93, v117
    v_add_f32 v91, v91, v114
L_bw2_4:
    s_barrier
    s_bfe_u32 s91, s68, 0x40010
    s_lshl_b32 s92, s91, 7
    s_mul_i32 s93, s91, 393216
    s_add_u32 m0, s94, 40960
    s_nop 0
    buffer_load_dwordx4 v20, s[24:27], s92 offen offset:0 lds
    v_add_f32 v93, v93, v118
    v_lshlrev_b32 v72, 16, v60
    v_and_b32 v60, s8, v60
    v_lshlrev_b32 v73, 16, v68
    v_and_b32 v68, s8, v68
    v_lshlrev_b32 v112, 16, v44
    v_and_b32 v44, s8, v44
    buffer_load_dwordx4 v21, s[24:27], s92 offen offset:1024 lds
    v_lshlrev_b32 v116, 16, v52
    v_and_b32 v52, s8, v52
    v_mul_f32 v113, v112, v73
    v_mul_f32 v114, v44, v68
    v_fmac_f32 v90, v112, v72
    v_mul_f32 v117, v116, v73
    v_mul_f32 v118, v52, v68
    buffer_load_dwordx4 v22, s[24:27], s92 offen offset:2048 lds
    v_fmac_f32 v92, v116, v72
    v_cvt_pk_bf16_f32 v113, 0, v113
    v_cvt_pk_bf16_f32 v114, 0, v114
    v_fmac_f32 v90, v44, v60
    v_cvt_pk_bf16_f32 v117, 0, v117
    v_cvt_pk_bf16_f32 v118, 0, v118
    v_fmac_f32 v92, v52, v60
    buffer_load_dwordx4 v23, s[24:27], s92 offen offset:3072 lds
    v_add_f32 v91, v91, v113
    v_add_f32 v93, v93, v117
    v_add_f32 v91, v91, v114
    v_add_f32 v93, v93, v118
    v_lshlrev_b32 v72, 16, v61
    v_and_b32 v61, s8, v61
    v_lshlrev_b32 v73, 16, v69
    s_add_u32 m0, s95, 65536
    s_nop 0
    buffer_load_dwordx4 v24, s[28:31], s93 offen offset:0 lds
    v_and_b32 v69, s8, v69
    v_lshlrev_b32 v112, 16, v45
    v_and_b32 v45, s8, v45
    v_lshlrev_b32 v116, 16, v53
    v_and_b32 v53, s8, v53
    v_mul_f32 v113, v112, v73
    v_mul_f32 v114, v45, v69
    buffer_load_dwordx4 v25, s[28:31], s93 offen offset:1024 lds
    v_fmac_f32 v90, v112, v72
    v_mul_f32 v117, v116, v73
    v_mul_f32 v118, v53, v69
    v_fmac_f32 v92, v116, v72
    v_cvt_pk_bf16_f32 v113, 0, v113
    v_cvt_pk_bf16_f32 v114, 0, v114
    v_fmac_f32 v90, v45, v61
    s_add_u32 m0, s95, 73728
    s_nop 0
    buffer_load_dwordx4 v26, s[28:31], s93 offen offset:0 lds
    v_cvt_pk_bf16_f32 v117, 0, v117
    v_cvt_pk_bf16_f32 v118, 0, v118
    v_fmac_f32 v92, v53, v61
    v_add_f32 v91, v91, v113
    v_add_f32 v93, v93, v117
    v_add_f32 v91, v91, v114
    v_add_f32 v93, v93, v118
    buffer_load_dwordx4 v27, s[28:31], s93 offen offset:1024 lds
    v_lshlrev_b32 v72, 16, v62
    v_and_b32 v62, s8, v62
    v_lshlrev_b32 v73, 16, v70
    v_and_b32 v70, s8, v70
    v_lshlrev_b32 v112, 16, v46
    v_and_b32 v46, s8, v46
    v_lshlrev_b32 v116, 16, v54
    s_add_u32 m0, s95, 57344
    s_nop 0
    buffer_load_dwordx4 v28, s[28:31], s93 offen offset:0 lds
    v_and_b32 v54, s8, v54
    v_mul_f32 v113, v112, v73
    v_mul_f32 v114, v46, v70
    v_fmac_f32 v90, v112, v72
    v_mul_f32 v117, v116, v73
    v_mul_f32 v118, v54, v70
    v_fmac_f32 v92, v116, v72
    buffer_load_dwordx4 v29, s[28:31], s93 offen offset:1024 lds
    v_cvt_pk_bf16_f32 v113, 0, v113
    v_cvt_pk_bf16_f32 v114, 0, v114
    v_fmac_f32 v90, v46, v62
    v_cvt_pk_bf16_f32 v117, 0, v117
    v_cvt_pk_bf16_f32 v118, 0, v118
    v_fmac_f32 v92, v54, v62
    v_add_f32 v91, v91, v113
    buffer_load_dword v15, v13, s[72:75], 0 offen offset:4 sc1
    v_add_f32 v93, v93, v117
    v_add_f32 v91, v91, v114
    v_add_f32 v93, v93, v118
    v_lshlrev_b32 v72, 16, v63
    v_and_b32 v63, s8, v63
    v_lshlrev_b32 v73, 16, v71
    v_and_b32 v71, s8, v71
    v_lshlrev_b32 v112, 16, v47
    v_and_b32 v47, s8, v47
    v_lshlrev_b32 v116, 16, v55
    v_and_b32 v55, s8, v55
    v_mul_f32 v113, v112, v73
    v_mul_f32 v114, v47, v71
    v_fmac_f32 v90, v112, v72
    v_mul_f32 v117, v116, v73
    v_mul_f32 v118, v55, v71
    v_fmac_f32 v92, v116, v72
    v_cvt_pk_bf16_f32 v113, 0, v113
    v_cvt_pk_bf16_f32 v114, 0, v114
    v_fmac_f32 v90, v47, v63
    v_cvt_pk_bf16_f32 v117, 0, v117
    v_cvt_pk_bf16_f32 v118, 0, v118
    v_fmac_f32 v92, v55, v63
    v_add_f32 v91, v91, v113
    v_add_f32 v93, v93, v117
L_bw3_4:
    s_waitcnt vmcnt(11)
    s_barrier
    s_bfe_u32 s91, s68, 0x40014
    s_lshl_b32 s92, s91, 7
    s_mul_i32 s93, s91, 393216
    s_add_u32 m0, s94, 81920
    s_nop 0
    buffer_load_dwordx4 v20, s[24:27], s92 offen offset:0 lds
    v_add_f32 v91, v91, v114
    v_add_f32 v93, v93, v118
    v_add_f32_dpp v90, v90, v90 row_shr:1 row_mask:0xf bank_mask:0xf
    v_add_f32_dpp v91, v91, v91 row_shr:1 row_mask:0xf bank_mask:0xf
    v_add_f32_dpp v92, v92, v92 row_shr:1 row_mask:0xf bank_mask:0xf
    v_add_f32_dpp v93, v93, v93 row_shr:1 row_mask:0xf bank_mask:0xf
    v_add_f32_dpp v90, v90, v90 row_shr:2 row_mask:0xf bank_mask:0xf
    buffer_load_dwordx4 v21, s[24:27], s92 offen offset:1024 lds
    v_add_f32_dpp v91, v91, v91 row_shr:2 row_mask:0xf bank_mask:0xf
    v_add_f32_dpp v92, v92, v92 row_shr:2 row_mask:0xf bank_mask:0xf
    v_add_f32_dpp v93, v93, v93 row_shr:2 row_mask:0xf bank_mask:0xf
    v_add_f32_dpp v90, v90, v90 row_shr:4 row_mask:0xf bank_mask:0xf
    v_add_f32_dpp v91, v91, v91 row_shr:4 row_mask:0xf bank_mask:0xf
    v_add_f32_dpp v92, v92, v92 row_shr:4 row_mask:0xf bank_mask:0xf
    v_add_f32_dpp v93, v93, v93 row_shr:4 row_mask:0xf bank_mask:0xf
    buffer_load_dwordx4 v22, s[24:27], s92 offen offset:2048 lds
    v_add_f32_dpp v90, v90, v90 row_shr:8 row_mask:0xf bank_mask:0xf
    v_add_f32_dpp v91, v91, v91 row_shr:8 row_mask:0xf bank_mask:0xf
    v_add_f32_dpp v92, v92, v92 row_shr:8 row_mask:0xf bank_mask:0xf
    v_add_f32_dpp v93, v93, v93 row_shr:8 row_mask:0xf bank_mask:0xf
    v_add_f32_dpp v90, v90, v90 row_bcast:15 row_mask:0xa bank_mask:0xf
    v_add_f32_dpp v91, v91, v91 row_bcast:15 row_mask:0xa bank_mask:0xf
    v_add_f32_dpp v92, v92, v92 row_bcast:15 row_mask:0xa bank_mask:0xf
    buffer_load_dwordx4 v23, s[24:27], s92 offen offset:3072 lds
    v_add_f32_dpp v93, v93, v93 row_bcast:15 row_mask:0xa bank_mask:0xf
    v_add_f32_dpp v90, v90, v90 row_bcast:31 row_mask:0xc bank_mask:0xf
    v_add_f32_dpp v91, v91, v91 row_bcast:31 row_mask:0xc bank_mask:0xf
    v_add_f32_dpp v92, v92, v92 row_bcast:31 row_mask:0xc bank_mask:0xf
    v_add_f32_dpp v93, v93, v93 row_bcast:31 row_mask:0xc bank_mask:0xf
    v_mov_b32 v97, 0x8000
    v_mov_b32 v98, 0xffff
    s_add_u32 m0, s95, 106496
    s_nop 0
    buffer_load_dwordx4 v24, s[28:31], s93 offen offset:0 lds
    v_cvt_pk_bf16_f32 v94, v90, v91
    v_cvt_pk_bf16_f32 v104, v92, v93
    v_and_b32 v95, 0xffff, v94
    v_and_b32 v96, 0x8000, v94
    v_and_b32 v94, 0xffff0000, v94
    v_cmp_ne_u32 vcc, 0, v96
    v_mul_f32 v94, 0xbfb8aa3b, v94
    buffer_load_dwordx4 v25, s[28:31], s93 offen offset:1024 lds
    v_exp_f32 v94, v94
    v_cndmask_b32 v96, v97, v98, vcc
    v_xor_b32 v95, v95, v96
    v_add_f32 v94, 1.0, v94
    v_lshlrev_b32 v95, 11, v95
    v_rcp_f32 v94, v94
    s_sub_u32 s12, 2047, s22
    v_or_b32 v100, s12, v95
    s_add_u32 m0, s95, 114688
    s_nop 0
    buffer_load_dwordx4 v26, s[28:31], s93 offen offset:0 lds
    v_cvt_pk_bf16_f32 v94, v94, v94
    v_lshlrev_b32 v102, 16, v94
    v_and_b32 v105, 0xffff, v104
    v_and_b32 v106, 0x8000, v104
    v_and_b32 v104, 0xffff0000, v104
    v_cmp_ne_u32 vcc, 0, v106
    v_mul_f32 v104, 0xbfb8aa3b, v104
    buffer_load_dwordx4 v27, s[28:31], s93 offen offset:1024 lds
    v_exp_f32 v104, v104
    v_cndmask_b32 v106, v97, v98, vcc
    v_xor_b32 v105, v105, v106
    v_add_f32 v104, 1.0, v104
    v_lshlrev_b32 v105, 11, v105
    v_rcp_f32 v104, v104
    s_sub_u32 s12, 2046, s22
    v_or_b32 v101, s12, v105
    s_add_u32 m0, s95, 98304
    s_nop 0
    buffer_load_dwordx4 v28, s[28:31], s93 offen offset:0 lds
    v_cvt_pk_bf16_f32 v104, v104, v104
    v_lshlrev_b32 v103, 16, v104
    v_max_u32 v100, v100, v101
    s_lshl_b32 s12, s22, 2
    s_add_u32 s12, s12, 4096
    s_lshl_b32 s13, s21, 2
    s_add_u32 s13, s13, 162880
    v_mov_b32 v14, s13
    s_mov_b32 exec_lo, 0
    s_mov_b32 exec_hi, 0x80000000
    buffer_store_dwordx2 v[102:103], v13, s[32:35], s12 offen sc1
    ds_write_b32 v14, v100
    s_mov_b64 exec, -1
    s_waitcnt lgkmcnt(0)
    buffer_load_dwordx4 v29, s[28:31], s93 offen offset:1024 lds
L_bw4_4:
    s_waitcnt vmcnt(12)
    s_barrier
    s_bfe_u32 s91, s68, 0x40018
    s_lshl_b32 s92, s91, 7
    s_mul_i32 s93, s91, 393216
    s_add_u32 m0, s94, 0
    s_nop 0
    buffer_load_dwordx4 v20, s[24:27], s92 offen offset:0 lds
    buffer_load_dwordx4 v21, s[24:27], s92 offen offset:1024 lds
    buffer_load_dwordx4 v22, s[24:27], s92 offen offset:2048 lds
    buffer_load_dwordx4 v23, s[24:27], s92 offen offset:3072 lds
    s_add_u32 m0, s95, 24576
    s_nop 0
    buffer_load_dwordx4 v24, s[28:31], s93 offen offset:0 lds
    buffer_load_dwordx4 v25, s[28:31], s93 offen offset:1024 lds
    s_add_u32 m0, s95, 32768
    s_nop 0
    buffer_load_dwordx4 v26, s[28:31], s93 offen offset:0 lds
    buffer_load_dwordx4 v27, s[28:31], s93 offen offset:1024 lds
    s_add_u32 m0, s95, 16384
    s_nop 0
    buffer_load_dwordx4 v28, s[28:31], s93 offen offset:0 lds
    buffer_load_dwordx4 v29, s[28:31], s93 offen offset:1024 lds
    s_cmp_ge_u32 s10, 224
    s_cbranch_scc1 L_p30_4
    s_add_u32 s12, s71, 0
    buffer_load_dwordx4 v[128:131], v30, s[40:43], s12 offen nt
    s_add_u32 s12, s71, 7168
    buffer_load_dwordx4 v[132:135], v30, s[40:43], s12 offen nt
    s_add_u32 s12, s71, 14336
    buffer_load_dwordx4 v[136:139], v30, s[40:43], s12 offen nt
    s_add_u32 s12, s71, 21504
    buffer_load_dwordx4 v[140:143], v30, s[40:43], s12 offen nt
    s_add_u32 s12, s71, 28672
    buffer_load_dwordx4 v[144:147], v30, s[40:43], s12 offen nt
    s_add_u32 s12, s71, 35840
    buffer_load_dwordx4 v[148:151], v30, s[40:43], s12 offen nt
    s_add_u32 s12, s71, 43008
    buffer_load_dwordx4 v[152:155], v30, s[40:43], s12 offen nt
    s_add_u32 s12, s71, 50176
    buffer_load_dwordx4 v[156:159], v30, s[40:43], s12 offen nt
    s_branch L_p3e0_4
L_p30_4:
    s_mov_b64 exec, 63
    s_bfe_u32 s12, s68, 0x4000c
    s_mul_i32 s12, s12, 393216
    buffer_load_dword v128, v32, s[28:31], s12 offen
    s_bfe_u32 s12, s68, 0x40010
    s_mul_i32 s12, s12, 393216
    buffer_load_dword v132, v32, s[28:31], s12 offen
    s_bfe_u32 s12, s68, 0x40014
    s_mul_i32 s12, s12, 393216
    buffer_load_dword v136, v32, s[28:31], s12 offen
    s_bfe_u32 s12, s68, 0x40018
    s_mul_i32 s12, s12, 393216
    buffer_load_dword v140, v32, s[28:31], s12 offen
    s_bfe_u32 s12, s68, 0x4001c
    s_mul_i32 s12, s12, 393216
    buffer_load_dword v144, v32, s[28:31], s12 offen
    s_bfe_u32 s12, s69, 0x40000
    s_mul_i32 s12, s12, 393216
    buffer_load_dword v148, v32, s[28:31], s12 offen
    s_bfe_u32 s12, s69, 0x40004
    s_mul_i32 s12, s12, 393216
    buffer_load_dword v152, v32, s[28:31], s12 offen
    s_bfe_u32 s12, s69, 0x40008
    s_mul_i32 s12, s12, 393216
    buffer_load_dword v156, v32, s[28:31], s12 offen
    s_mov_b64 exec, -1
L_p3e0_4:
    s_waitcnt vmcnt(19)
L_bw5_4:
    s_waitcnt vmcnt(18)
    s_barrier
    s_bfe_u32 s91, s68, 0x4001c
    s_lshl_b32 s92, s91, 7
    s_mul_i32 s93, s91, 393216
    s_add_u32 m0, s94, 40960
    s_nop 0
    buffer_load_dwordx4 v20, s[24:27], s92 offen offset:0 lds
    buffer_load_dwordx4 v21, s[24:27], s92 offen offset:1024 lds
    buffer_load_dwordx4 v22, s[24:27], s92 offen offset:2048 lds
    buffer_load_dwordx4 v23, s[24:27], s92 offen offset:3072 lds
    s_add_u32 m0, s95, 65536
    s_nop 0
    buffer_load_dwordx4 v24, s[28:31], s93 offen offset:0 lds
    s_mov_b32 s13, 0
L_tagchk_4:
    v_readfirstlane_b32 s23, v15
    s_nop 1
    s_cmp_lg_u32 s23, 0
    s_cbranch_scc1 L_tagok_4
    s_add_u32 s13, s13, 1
    s_cmp_ge_u32 s13, 16384
    s_cbranch_scc1 L_tagok_4
    buffer_load_dword v15, v13, s[72:75], 0 offen offset:4 sc1
    s_waitcnt vmcnt(0)
    s_branch L_tagchk_4
L_tagok_4:
    s_and_b32 s76, s23, 0xff
    s_bfe_u32 s77, s23, 0x80008
    s_bfe_u32 s78, s23, 0x80010
    s_lshr_b32 s79, s23, 24
    v_and_b32 v35, 3, v2
    v_lshlrev_b32 v35, 3, v35
    v_bfe_u32 v35, s23, v35, 8
    s_cmp_lg_u32 s21, 0
    s_cbranch_scc1 L_nopub_4
    v_mov_b32 v14, 162880
    ds_read_b128 v[104:107], v14
    s_lshl_b32 s12, s2, 3
    s_add_u32 s12, s12, 0
    s_waitcnt lgkmcnt(0)
    v_max3_u32 v104, v104, v105, v106
    v_max_u32 v104, v104, v107
    v_mov_b32 v105, s23
    s_mov_b64 exec, 1
    buffer_store_dwordx2 v[104:105], v13, s[32:35], s12 offen sc1
    s_mov_b64 exec, -1
L_nopub_4:
L_bw6_4:
    s_waitcnt vmcnt(13)
    s_barrier
    s_add_u32 m0, s95, 65536
    s_nop 0
    buffer_load_dwordx4 v25, s[28:31], s93 offen offset:1024 lds
    s_add_u32 m0, s95, 73728
    s_nop 0
    buffer_load_dwordx4 v26, s[28:31], s93 offen offset:0 lds
    buffer_load_dwordx4 v27, s[28:31], s93 offen offset:1024 lds
    s_add_u32 m0, s95, 57344
    s_nop 0
    buffer_load_dwordx4 v28, s[28:31], s93 offen offset:0 lds
    buffer_load_dwordx4 v29, s[28:31], s93 offen offset:1024 lds
    s_bfe_u32 s91, s69, 0x40000
    s_lshl_b32 s92, s91, 7
    s_mul_i32 s93, s91, 393216
    s_add_u32 m0, s94, 81920
    s_nop 0
    buffer_load_dwordx4 v20, s[24:27], s92 offen offset:0 lds
    buffer_load_dwordx4 v21, s[24:27], s92 offen offset:1024 lds
    buffer_load_dwordx4 v22, s[24:27], s92 offen offset:2048 lds
    buffer_load_dwordx4 v23, s[24:27], s92 offen offset:3072 lds
    s_add_u32 m0, s95, 106496
    s_nop 0
    buffer_load_dwordx4 v24, s[28:31], s93 offen offset:0 lds
    buffer_load_dwordx4 v25, s[28:31], s93 offen offset:1024 lds
    s_add_u32 m0, s95, 114688
    s_nop 0
    buffer_load_dwordx4 v26, s[28:31], s93 offen offset:0 lds
L_bw7_4:
    s_waitcnt vmcnt(7)
    s_barrier
    s_add_u32 m0, s95, 114688
    s_nop 0
    buffer_load_dwordx4 v27, s[28:31], s93 offen offset:1024 lds
    s_add_u32 m0, s95, 98304
    s_nop 0
    buffer_load_dwordx4 v28, s[28:31], s93 offen offset:0 lds
    buffer_load_dwordx4 v29, s[28:31], s93 offen offset:1024 lds
    s_bfe_u32 s91, s69, 0x40004
    s_lshl_b32 s92, s91, 7
    s_mul_i32 s93, s91, 393216
    s_add_u32 m0, s94, 0
    s_nop 0
    buffer_load_dwordx4 v20, s[24:27], s92 offen offset:0 lds
    buffer_load_dwordx4 v21, s[24:27], s92 offen offset:1024 lds
    buffer_load_dwordx4 v22, s[24:27], s92 offen offset:2048 lds
    buffer_load_dwordx4 v23, s[24:27], s92 offen offset:3072 lds
    s_add_u32 m0, s95, 24576
    s_nop 0
    buffer_load_dwordx4 v24, s[28:31], s93 offen offset:0 lds
    buffer_load_dwordx4 v25, s[28:31], s93 offen offset:1024 lds
    s_add_u32 m0, s95, 32768
    s_nop 0
    buffer_load_dwordx4 v26, s[28:31], s93 offen offset:0 lds
    buffer_load_dwordx4 v27, s[28:31], s93 offen offset:1024 lds
    s_add_u32 m0, s95, 16384
    s_nop 0
    buffer_load_dwordx4 v28, s[28:31], s93 offen offset:0 lds
L_bw8_4:
    s_waitcnt vmcnt(9)
    s_barrier
    s_add_u32 m0, s95, 16384
    s_nop 0
    buffer_load_dwordx4 v29, s[28:31], s93 offen offset:1024 lds
    s_bfe_u32 s91, s69, 0x40008
    s_lshl_b32 s92, s91, 7
    s_mul_i32 s93, s91, 393216
    s_add_u32 m0, s94, 40960
    s_nop 0
    buffer_load_dwordx4 v20, s[24:27], s92 offen offset:0 lds
    buffer_load_dwordx4 v21, s[24:27], s92 offen offset:1024 lds
    buffer_load_dwordx4 v22, s[24:27], s92 offen offset:2048 lds
    buffer_load_dwordx4 v23, s[24:27], s92 offen offset:3072 lds
    s_add_u32 m0, s95, 65536
    s_nop 0
    buffer_load_dwordx4 v24, s[28:31], s93 offen offset:0 lds
    buffer_load_dwordx4 v25, s[28:31], s93 offen offset:1024 lds
    s_add_u32 m0, s95, 73728
    s_nop 0
    buffer_load_dwordx4 v26, s[28:31], s93 offen offset:0 lds
    buffer_load_dwordx4 v27, s[28:31], s93 offen offset:1024 lds
    s_add_u32 m0, s95, 57344
    s_nop 0
    buffer_load_dwordx4 v28, s[28:31], s93 offen offset:0 lds
    buffer_load_dwordx4 v29, s[28:31], s93 offen offset:1024 lds
L_bw9_4:
    s_waitcnt vmcnt(10)
    s_barrier
    s_bfe_u32 s91, s69, 0x4000c
    s_lshl_b32 s92, s91, 7
    s_mul_i32 s93, s91, 393216
    s_add_u32 m0, s94, 122880
    s_nop 0
    buffer_load_dwordx4 v20, s[24:27], s92 offen offset:0 lds
    buffer_load_dwordx4 v21, s[24:27], s92 offen offset:1024 lds
    buffer_load_dwordx4 v22, s[24:27], s92 offen offset:2048 lds
    buffer_load_dwordx4 v23, s[24:27], s92 offen offset:3072 lds
    s_add_u32 m0, s95, 106496
    s_nop 0
    buffer_load_dwordx4 v24, s[28:31], s93 offen offset:0 lds
    buffer_load_dwordx4 v25, s[28:31], s93 offen offset:1024 lds
    s_add_u32 m0, s95, 114688
    s_nop 0
    buffer_load_dwordx4 v26, s[28:31], s93 offen offset:0 lds
    buffer_load_dwordx4 v27, s[28:31], s93 offen offset:1024 lds
    s_cmp_ge_u32 s10, 224
    s_cbranch_scc1 L_p31_4
    s_add_u32 s12, s9, 0
    buffer_load_dwordx4 v[160:163], v30, s[44:47], s12 offen nt
    s_add_u32 s12, s9, 7168
    buffer_load_dwordx4 v[164:167], v30, s[44:47], s12 offen nt
    s_add_u32 s12, s9, 14336
    buffer_load_dwordx4 v[168:171], v30, s[44:47], s12 offen nt
    s_add_u32 s12, s9, 21504
    buffer_load_dwordx4 v[172:175], v30, s[44:47], s12 offen nt
    s_add_u32 s12, s9, 28672
    buffer_load_dwordx4 v[176:179], v30, s[44:47], s12 offen nt
    s_add_u32 s12, s9, 35840
    buffer_load_dwordx4 v[180:183], v30, s[44:47], s12 offen nt
    s_add_u32 s12, s9, 43008
    buffer_load_dwordx4 v[184:187], v30, s[44:47], s12 offen nt
    s_add_u32 s12, s9, 50176
    buffer_load_dwordx4 v[188:191], v30, s[44:47], s12 offen nt
    s_branch L_p3e1_4
L_p31_4:
    s_mov_b64 exec, 63
    s_bfe_u32 s12, s69, 0x4000c
    s_mul_i32 s12, s12, 393216
    buffer_load_dword v160, v32, s[28:31], s12 offen
    s_bfe_u32 s12, s69, 0x40010
    s_mul_i32 s12, s12, 393216
    buffer_load_dword v164, v32, s[28:31], s12 offen
    s_bfe_u32 s12, s69, 0x40014
    s_mul_i32 s12, s12, 393216
    buffer_load_dword v168, v32, s[28:31], s12 offen
    s_bfe_u32 s12, s69, 0x40018
    s_mul_i32 s12, s12, 393216
    buffer_load_dword v172, v32, s[28:31], s12 offen
    s_bfe_u32 s12, s69, 0x4001c
    s_mul_i32 s12, s12, 393216
    buffer_load_dword v176, v32, s[28:31], s12 offen
    s_mov_b64 exec, 1
    s_bfe_u32 s12, s69, 0x4001c
    s_mul_i32 s12, s12, 393216
    buffer_load_dword v180, v32, s[28:31], s12 offen
    s_bfe_u32 s12, s69, 0x4001c
    s_mul_i32 s12, s12, 393216
    buffer_load_dword v184, v32, s[28:31], s12 offen
    s_bfe_u32 s12, s69, 0x4001c
    s_mul_i32 s12, s12, 393216
    buffer_load_dword v188, v32, s[28:31], s12 offen
    s_mov_b64 exec, -1
L_p3e1_4:
    s_mov_b32 exec_lo, 0xffff0000
    s_mov_b32 exec_hi, 0
    buffer_load_dword v19, v10, s[36:39], 0 offen
    s_mov_b64 exec, -1
    s_mov_b32 s12, 0
    buffer_load_dwordx4 v[104:107], v5, s[32:35], s12 offen offset:0 sc1
    buffer_load_dwordx4 v[108:111], v5, s[32:35], s12 offen offset:1024 sc1
L_bw10_4:
    s_waitcnt vmcnt(19)
    s_barrier
    s_bfe_u32 s91, s69, 0x40010
    s_lshl_b32 s92, s91, 7
    s_mul_i32 s93, s91, 393216
    s_add_u32 m0, s94, 139264
    s_nop 0
    buffer_load_dwordx4 v20, s[24:27], s92 offen offset:0 lds
    buffer_load_dwordx4 v21, s[24:27], s92 offen offset:1024 lds
    buffer_load_dwordx4 v22, s[24:27], s92 offen offset:2048 lds
    buffer_load_dwordx4 v23, s[24:27], s92 offen offset:3072 lds
    s_add_u32 m0, s95, 24576
    s_nop 0
    buffer_load_dwordx4 v24, s[28:31], s93 offen offset:0 lds
L_bw11_4:
    s_waitcnt vmcnt(16)
    s_barrier
    s_add_u32 m0, s95, 24576
    s_nop 0
    buffer_load_dwordx4 v25, s[28:31], s93 offen offset:1024 lds
    s_waitcnt vmcnt(6)
    s_mov_b32 s13, 0
    v_xor_b32 v105, s23, v105
    v_xor_b32 v107, s23, v107
    v_xor_b32 v109, s23, v109
    v_xor_b32 v111, s23, v111
    v_or3_b32 v105, v105, v107, v109
    v_or_b32 v105, v105, v111
    v_cmp_ne_u32 vcc, 0, v105
    s_cbranch_vccnz L_keyre_4
L_keyok_4:
    s_add_u32 m0, s95, 32768
    s_nop 0
    buffer_load_dwordx4 v26, s[28:31], s93 offen offset:0 lds
    v_max3_u32 v104, v104, v106, v108
    v_max_u32 v104, v104, v110
    s_nop 1
    v_max_u32_dpp v104, v104, v104 row_shr:1 row_mask:0xf bank_mask:0xf
    s_nop 1
    v_max_u32_dpp v104, v104, v104 row_shr:2 row_mask:0xf bank_mask:0xf
    s_nop 1
    v_max_u32_dpp v104, v104, v104 row_shr:4 row_mask:0xf bank_mask:0xf
    s_nop 1
    v_max_u32_dpp v104, v104, v104 row_shr:8 row_mask:0xf bank_mask:0xf
    s_nop 1
    v_max_u32_dpp v104, v104, v104 row_bcast:15 row_mask:0xa bank_mask:0xf
    s_nop 1
    v_max_u32_dpp v104, v104, v104 row_bcast:31 row_mask:0xc bank_mask:0xf
    s_nop 0
    v_readlane_b32 s14, v104, 63
    s_nop 1
    s_and_b32 s15, s14, 2047
    s_sub_u32 s15, 2047, s15
    s_lshl_b32 s12, s15, 11
    s_lshl_b32 s13, s70, 1
    s_add_u32 s12, s12, s13
    buffer_load_dwordx4 v[36:39], v34, s[24:27], s12 offen
    s_lshr_b32 s12, s14, 11
    s_and_b32 s13, s12, 0x8000
    s_cmp_lg_u32 s13, 0
    s_mov_b32 s13, 0xffff
    s_cselect_b32 s13, 0x8000, s13
    s_xor_b32 s12, s12, s13
    s_lshl_b32 s12, s12, 16
    v_mov_b32 v105, s12
    buffer_load_dwordx4 v27, s[28:31], s93 offen offset:1024 lds
    v_mul_f32 v105, 0xbfb8aa3b, v105
    v_exp_f32 v105, v105
    s_nop 0
    v_add_f32 v105, 1.0, v105
    v_rcp_f32 v105, v105
    s_nop 0
    v_cvt_pk_bf16_f32 v105, v105, v105
    v_lshlrev_b32 v105, 16, v105
    s_add_u32 s12, s15, 1
    v_mov_b32 v104, s12
    v_mov_b32 v106, s23
    v_readfirstlane_b32 s14, v105
    v_mov_b32 v14, 162864
    s_mov_b64 exec, 1
    ds_write_b96 v14, v[104:106]
    s_mov_b64 exec, -1
    s_waitcnt lgkmcnt(0)
    s_bfe_u32 s91, s69, 0x40014
    s_lshl_b32 s92, s91, 7
    s_mul_i32 s93, s91, 393216
    s_add_u32 m0, s94, 40960
    s_nop 0
    buffer_load_dwordx4 v20, s[24:27], s92 offen offset:0 lds
    buffer_load_dwordx4 v21, s[24:27], s92 offen offset:1024 lds
    buffer_load_dwordx4 v22, s[24:27], s92 offen offset:2048 lds
    buffer_load_dwordx4 v23, s[24:27], s92 offen offset:3072 lds
    s_add_u32 m0, s95, 65536
    s_nop 0
    buffer_load_dwordx4 v24, s[28:31], s93 offen offset:0 lds
    buffer_load_dwordx4 v25, s[28:31], s93 offen offset:1024 lds
    s_add_u32 m0, s95, 73728
    s_nop 0
    buffer_load_dwordx4 v26, s[28:31], s93 offen offset:0 lds
L_bw12_4:
    s_waitcnt vmcnt(7)
    s_barrier
    s_add_u32 m0, s95, 73728
    s_nop 0
    buffer_load_dwordx4 v27, s[28:31], s93 offen offset:1024 lds
    s_mov_b32 s8, 0xffff0000
    v_lshlrev_b32 v40, 16, v36
    v_and_b32 v41, s8, v36
    v_lshlrev_b32 v42, 16, v37
    v_and_b32 v43, s8, v37
    v_lshlrev_b32 v44, 16, v38
    v_and_b32 v45, s8, v38
    v_lshlrev_b32 v46, 16, v39
    v_and_b32 v47, s8, v39
    v_lshlrev_b32 v48, 16, v128
    v_lshlrev_b32 v49, 16, v129
    v_and_b32 v128, s8, v128
    v_and_b32 v129, s8, v129
    s_bfe_u32 s91, s69, 0x40018
    s_lshl_b32 s92, s91, 7
    s_mul_i32 s93, s91, 393216
    s_add_u32 m0, s94, 81920
    s_nop 0
    buffer_load_dwordx4 v20, s[24:27], s92 offen offset:0 lds
    v_mul_f32 v220, v48, v40
    v_mul_f32 v222, v49, v40
    v_mul_f32 v221, v128, v40
    v_mul_f32 v223, v129, v40
    v_lshlrev_b32 v50, 16, v130
    v_lshlrev_b32 v51, 16, v131
    v_and_b32 v130, s8, v130
    buffer_load_dwordx4 v21, s[24:27], s92 offen offset:1024 lds
    v_and_b32 v131, s8, v131
    v_mul_f32 v224, v50, v40
    v_mul_f32 v226, v51, v40
    v_mul_f32 v225, v130, v40
    v_mul_f32 v227, v131, v40
    v_lshlrev_b32 v48, 16, v160
    v_lshlrev_b32 v49, 16, v161
    buffer_load_dwordx4 v22, s[24:27], s92 offen offset:2048 lds
    v_and_b32 v160, s8, v160
    v_and_b32 v161, s8, v161
    v_mul_f32 v228, v48, v40
    v_mul_f32 v230, v49, v40
    v_mul_f32 v229, v160, v40
    v_mul_f32 v231, v161, v40
    v_lshlrev_b32 v50, 16, v162
    buffer_load_dwordx4 v23, s[24:27], s92 offen offset:3072 lds
    v_lshlrev_b32 v51, 16, v163
    v_and_b32 v162, s8, v162
    v_and_b32 v163, s8, v163
    v_mul_f32 v232, v50, v40
    v_mul_f32 v234, v51, v40
    v_mul_f32 v233, v162, v40
    v_mul_f32 v235, v163, v40
    s_add_u32 m0, s95, 106496
    s_nop 0
    buffer_load_dwordx4 v24, s[28:31], s93 offen offset:0 lds
    v_lshlrev_b32 v48, 16, v132
    v_lshlrev_b32 v49, 16, v133
    v_and_b32 v132, s8, v132
    v_and_b32 v133, s8, v133
    v_fmac_f32 v220, v48, v41
    v_fmac_f32 v222, v49, v41
    v_fmac_f32 v221, v132, v41
    buffer_load_dwordx4 v25, s[28:31], s93 offen offset:1024 lds
    v_fmac_f32 v223, v133, v41
    v_lshlrev_b32 v50, 16, v134
    v_lshlrev_b32 v51, 16, v135
    v_and_b32 v134, s8, v134
    v_and_b32 v135, s8, v135
    v_fmac_f32 v224, v50, v41
    v_fmac_f32 v226, v51, v41
    s_add_u32 m0, s95, 114688
    s_nop 0
    buffer_load_dwordx4 v26, s[28:31], s93 offen offset:0 lds
    v_fmac_f32 v225, v134, v41
    v_fmac_f32 v227, v135, v41
    v_lshlrev_b32 v48, 16, v164
    v_lshlrev_b32 v49, 16, v165
    v_and_b32 v164, s8, v164
    v_and_b32 v165, s8, v165
    v_fmac_f32 v228, v48, v41
    v_fmac_f32 v230, v49, v41
    v_fmac_f32 v229, v164, v41
    v_fmac_f32 v231, v165, v41
    v_lshlrev_b32 v50, 16, v166
    v_lshlrev_b32 v51, 16, v167
    v_and_b32 v166, s8, v166
    v_and_b32 v167, s8, v167
    buffer_load_dwordx4 v27, s[28:31], s93 offen offset:1024 lds
    v_fmac_f32 v232, v50, v41
    v_fmac_f32 v234, v51, v41
    v_fmac_f32 v233, v166, v41
    v_fmac_f32 v235, v167, v41
    v_lshlrev_b32 v48, 16, v136
    v_lshlrev_b32 v49, 16, v137
    v_and_b32 v136, s8, v136
    v_and_b32 v137, s8, v137
    v_fmac_f32 v220, v48, v42
    v_fmac_f32 v222, v49, v42
    v_fmac_f32 v221, v136, v42
    v_fmac_f32 v223, v137, v42
    v_lshlrev_b32 v50, 16, v138
    v_lshlrev_b32 v51, 16, v139
    v_and_b32 v138, s8, v138
    v_and_b32 v139, s8, v139
    v_fmac_f32 v224, v50, v42
    v_fmac_f32 v226, v51, v42
    v_fmac_f32 v225, v138, v42
    v_fmac_f32 v227, v139, v42
    v_lshlrev_b32 v48, 16, v168
    v_lshlrev_b32 v49, 16, v169
    v_and_b32 v168, s8, v168
    v_and_b32 v169, s8, v169
    v_fmac_f32 v228, v48, v42
    v_fmac_f32 v230, v49, v42
    v_fmac_f32 v229, v168, v42
    v_fmac_f32 v231, v169, v42
    v_lshlrev_b32 v50, 16, v170
    v_lshlrev_b32 v51, 16, v171
    v_and_b32 v170, s8, v170
    v_and_b32 v171, s8, v171
    v_fmac_f32 v232, v50, v42
    v_fmac_f32 v234, v51, v42
    v_fmac_f32 v233, v170, v42
    v_fmac_f32 v235, v171, v42
    v_lshlrev_b32 v48, 16, v140
    v_lshlrev_b32 v49, 16, v141
    v_and_b32 v140, s8, v140
L_bw13_4:
    s_waitcnt vmcnt(8)
    s_barrier
    s_bfe_u32 s91, s69, 0x4001c
    s_lshl_b32 s92, s91, 7
    s_mul_i32 s93, s91, 393216
    s_add_u32 m0, s94, 0
    s_nop 0
    buffer_load_dwordx4 v20, s[24:27], s92 offen offset:0 lds
    v_and_b32 v141, s8, v141
    v_fmac_f32 v220, v48, v43
    v_fmac_f32 v222, v49, v43
    v_fmac_f32 v221, v140, v43
    v_fmac_f32 v223, v141, v43
    v_lshlrev_b32 v50, 16, v142
    v_lshlrev_b32 v51, 16, v143
    buffer_load_dwordx4 v21, s[24:27], s92 offen offset:1024 lds
    v_and_b32 v142, s8, v142
    v_and_b32 v143, s8, v143
    v_fmac_f32 v224, v50, v43
    v_fmac_f32 v226, v51, v43
    v_fmac_f32 v225, v142, v43
    v_fmac_f32 v227, v143, v43
    v_lshlrev_b32 v48, 16, v172
    buffer_load_dwordx4 v22, s[24:27], s92 offen offset:2048 lds
    v_lshlrev_b32 v49, 16, v173
    v_and_b32 v172, s8, v172
    v_and_b32 v173, s8, v173
    v_fmac_f32 v228, v48, v43
    v_fmac_f32 v230, v49, v43
    v_fmac_f32 v229, v172, v43
    v_fmac_f32 v231, v173, v43
    buffer_load_dwordx4 v23, s[24:27], s92 offen offset:3072 lds
    v_lshlrev_b32 v50, 16, v174
    v_lshlrev_b32 v51, 16, v175
    v_and_b32 v174, s8, v174
    v_and_b32 v175, s8, v175
    v_fmac_f32 v232, v50, v43
    v_fmac_f32 v234, v51, v43
    v_fmac_f32 v233, v174, v43
    s_add_u32 m0, s95, 24576
    s_nop 0
    buffer_load_dwordx4 v24, s[28:31], s93 offen offset:0 lds
    v_fmac_f32 v235, v175, v43
    v_lshlrev_b32 v48, 16, v144
    v_lshlrev_b32 v49, 16, v145
    v_and_b32 v144, s8, v144
    v_and_b32 v145, s8, v145
    v_fmac_f32 v220, v48, v44
    v_fmac_f32 v222, v49, v44
    buffer_load_dwordx4 v25, s[28:31], s93 offen offset:1024 lds
    v_fmac_f32 v221, v144, v44
    v_fmac_f32 v223, v145, v44
    v_lshlrev_b32 v50, 16, v146
    v_lshlrev_b32 v51, 16, v147
    v_and_b32 v146, s8, v146
    v_and_b32 v147, s8, v147
    v_fmac_f32 v224, v50, v44
    s_add_u32 m0, s95, 32768
    s_nop 0
    buffer_load_dwordx4 v26, s[28:31], s93 offen offset:0 lds
    v_fmac_f32 v226, v51, v44
    v_fmac_f32 v225, v146, v44
    v_fmac_f32 v227, v147, v44
    v_lshlrev_b32 v48, 16, v176
    v_lshlrev_b32 v49, 16, v177
    v_and_b32 v176, s8, v176
    v_and_b32 v177, s8, v177
    v_fmac_f32 v228, v48, v44
    v_fmac_f32 v230, v49, v44
    v_fmac_f32 v229, v176, v44
    v_fmac_f32 v231, v177, v44
    v_lshlrev_b32 v50, 16, v178
    v_lshlrev_b32 v51, 16, v179
    v_and_b32 v178, s8, v178
    buffer_load_dwordx4 v27, s[28:31], s93 offen offset:1024 lds
    v_and_b32 v179, s8, v179
    v_fmac_f32 v232, v50, v44
    v_fmac_f32 v234, v51, v44
    v_fmac_f32 v233, v178, v44
    v_fmac_f32 v235, v179, v44
    v_lshlrev_b32 v48, 16, v148
    v_lshlrev_b32 v49, 16, v149
    v_and_b32 v148, s8, v148
    v_and_b32 v149, s8, v149
    v_fmac_f32 v220, v48, v45
    v_fmac_f32 v222, v49, v45
    v_fmac_f32 v221, v148, v45
    v_fmac_f32 v223, v149, v45
    v_lshlrev_b32 v50, 16, v150
    v_lshlrev_b32 v51, 16, v151
    v_and_b32 v150, s8, v150
    v_and_b32 v151, s8, v151
    v_fmac_f32 v224, v50, v45
    v_fmac_f32 v226, v51, v45
    v_fmac_f32 v225, v150, v45
    v_fmac_f32 v227, v151, v45
    v_lshlrev_b32 v48, 16, v180
    v_lshlrev_b32 v49, 16, v181
    v_and_b32 v180, s8, v180
    v_and_b32 v181, s8, v181
    v_fmac_f32 v228, v48, v45
    v_fmac_f32 v230, v49, v45
    v_fmac_f32 v229, v180, v45
    v_fmac_f32 v231, v181, v45
    v_lshlrev_b32 v50, 16, v182
    v_lshlrev_b32 v51, 16, v183
    v_and_b32 v182, s8, v182
    v_and_b32 v183, s8, v183
    v_fmac_f32 v232, v50, v45
    v_fmac_f32 v234, v51, v45
    v_fmac_f32 v233, v182, v45
    v_fmac_f32 v235, v183, v45
    v_lshlrev_b32 v48, 16, v152
    v_lshlrev_b32 v49, 16, v153
L_bw14_4:
    s_waitcnt vmcnt(8)
    s_barrier
    s_add_u32 s12, s97, 0
    buffer_load_dwordx4 v[192:195], v31, s[64:67], s12 offen nt
    s_add_u32 s12, s97, 16384
    buffer_load_dwordx4 v[196:199], v31, s[64:67], s12 offen nt
    s_add_u32 s12, s97, 32768
    buffer_load_dwordx4 v[200:203], v31, s[64:67], s12 offen nt
    s_add_u32 s12, s97, 49152
    buffer_load_dwordx4 v[204:207], v31, s[64:67], s12 offen nt
    s_add_u32 s12, s97, 65536
    buffer_load_dwordx4 v[208:211], v31, s[64:67], s12 offen nt
    s_add_u32 s12, s97, 81920
    buffer_load_dwordx4 v[212:215], v31, s[64:67], s12 offen nt
    s_add_u32 s12, s97, 98304
    buffer_load_dwordx4 v[216:219], v31, s[64:67], s12 offen nt
    s_bfe_u32 s12, s69, 0x4000c
    s_mul_i32 s12, s12, 393216
    s_add_u32 m0, s95, 16384
    s_nop 0
    buffer_load_dwordx4 v28, s[28:31], s12 offen offset:0 lds
    buffer_load_dwordx4 v29, s[28:31], s12 offen offset:1024 lds
    s_bfe_u32 s12, s69, 0x40010
    s_mul_i32 s12, s12, 393216
    s_add_u32 m0, s95, 57344
    s_nop 0
    buffer_load_dwordx4 v28, s[28:31], s12 offen offset:0 lds
    buffer_load_dwordx4 v29, s[28:31], s12 offen offset:1024 lds
    s_mul_i32 s12, s21, 16
    s_add_u32 s12, s12, 0
    s_and_b32 s90, s88, 1
    s_lshl_b32 s90, s90, 6
    s_xor_b32 s12, s12, s90
    s_lshl_b32 s12, s12, 14
    s_add_u32 s90, s12, 0
    buffer_load_dwordx4 v[84:87], v33, s[36:39], s90 offen
    s_add_u32 s90, s12, 16384
    buffer_load_dwordx4 v[88:91], v33, s[36:39], s90 offen
    s_add_u32 s90, s12, 32768
    buffer_load_dwordx4 v[92:95], v33, s[36:39], s90 offen
    s_add_u32 s90, s12, 49152
    buffer_load_dwordx4 v[96:99], v33, s[36:39], s90 offen
    s_add_u32 s90, s12, 65536
    buffer_load_dwordx4 v[100:103], v33, s[36:39], s90 offen
    s_add_u32 s90, s12, 81920
    buffer_load_dwordx4 v[116:119], v33, s[36:39], s90 offen
    s_add_u32 s90, s12, 98304
    buffer_load_dwordx4 v[120:123], v33, s[36:39], s90 offen
    s_add_u32 s90, s12, 114688
    buffer_load_dwordx4 v[124:127], v33, s[36:39], s90 offen
    s_add_u32 s90, s12, 131072
    buffer_load_dwordx4 v[64:67], v33, s[36:39], s90 offen
    v_and_b32 v152, s8, v152
    v_and_b32 v153, s8, v153
    v_fmac_f32 v220, v48, v46
    v_fmac_f32 v222, v49, v46
    v_fmac_f32 v221, v152, v46
    v_fmac_f32 v223, v153, v46
    v_lshlrev_b32 v50, 16, v154
    v_lshlrev_b32 v51, 16, v155
    v_and_b32 v154, s8, v154
    v_and_b32 v155, s8, v155
    v_fmac_f32 v224, v50, v46
    v_fmac_f32 v226, v51, v46
    v_fmac_f32 v225, v154, v46
    v_fmac_f32 v227, v155, v46
    v_lshlrev_b32 v48, 16, v184
    v_lshlrev_b32 v49, 16, v185
    v_and_b32 v184, s8, v184
    v_and_b32 v185, s8, v185
    v_fmac_f32 v228, v48, v46
    v_fmac_f32 v230, v49, v46
    v_fmac_f32 v229, v184, v46
    v_fmac_f32 v231, v185, v46
    v_lshlrev_b32 v50, 16, v186
    v_lshlrev_b32 v51, 16, v187
    v_and_b32 v186, s8, v186
L_bw15_4:
    s_waitcnt vmcnt(20)
    s_barrier
    v_and_b32 v187, s8, v187
    v_fmac_f32 v232, v50, v46
    v_fmac_f32 v234, v51, v46
    v_fmac_f32 v233, v186, v46
    v_fmac_f32 v235, v187, v46
    v_lshlrev_b32 v48, 16, v156
    v_lshlrev_b32 v49, 16, v157
    v_and_b32 v156, s8, v156
    v_and_b32 v157, s8, v157
    v_fmac_f32 v220, v48, v47
    v_fmac_f32 v222, v49, v47
    v_fmac_f32 v221, v156, v47
    v_fmac_f32 v223, v157, v47
    v_lshlrev_b32 v50, 16, v158
    v_lshlrev_b32 v51, 16, v159
    v_and_b32 v158, s8, v158
    v_and_b32 v159, s8, v159
    v_fmac_f32 v224, v50, v47
    v_fmac_f32 v226, v51, v47
    v_fmac_f32 v225, v158, v47
    v_fmac_f32 v227, v159, v47
    v_lshlrev_b32 v48, 16, v188
    v_lshlrev_b32 v49, 16, v189
    v_and_b32 v188, s8, v188
    v_and_b32 v189, s8, v189
    v_fmac_f32 v228, v48, v47
    v_fmac_f32 v230, v49, v47
    v_fmac_f32 v229, v188, v47
    v_fmac_f32 v231, v189, v47
    v_lshlrev_b32 v50, 16, v190
    v_lshlrev_b32 v51, 16, v191
    v_and_b32 v190, s8, v190
    v_and_b32 v191, s8, v191
    v_fmac_f32 v232, v50, v47
    v_fmac_f32 v234, v51, v47
    v_fmac_f32 v233, v190, v47
    v_fmac_f32 v235, v191, v47
    v_permlane32_swap_b32 v220, v228
    v_permlane32_swap_b32 v221, v229
    v_permlane32_swap_b32 v222, v230
    v_permlane32_swap_b32 v223, v231
    v_permlane32_swap_b32 v224, v232
    v_permlane32_swap_b32 v225, v233
    v_permlane32_swap_b32 v226, v234
    v_permlane32_swap_b32 v227, v235
    v_add_f32 v220, v220, v228
    v_add_f32 v221, v221, v229
    v_add_f32 v222, v222, v230
    v_add_f32 v223, v223, v231
    v_add_f32 v224, v224, v232
    v_add_f32 v225, v225, v233
    v_add_f32 v226, v226, v234
    v_add_f32 v227, v227, v235
    v_permlane16_swap_b32 v220, v224
    v_permlane16_swap_b32 v221, v225
    v_permlane16_swap_b32 v222, v226
    v_permlane16_swap_b32 v223, v227
    v_add_f32 v220, v220, v224
    v_add_f32 v221, v221, v225
    v_add_f32 v222, v222, v226
    v_add_f32 v223, v223, v227
    v_add_f32_dpp v220, v220, v220 row_ror:8 row_mask:0xf bank_mask:0xf
    v_add_f32_dpp v221, v221, v221 row_ror:8 row_mask:0xf bank_mask:0xf
    v_add_f32_dpp v222, v222, v222 row_ror:8 row_mask:0xf bank_mask:0xf
    v_add_f32_dpp v223, v223, v223 row_ror:8 row_mask:0xf bank_mask:0xf
    s_branch L_varend
.fill 264, 4, 0xbf800000
L_varend:
    s_nop 0
    v_lshrrev_b32 v14, 5, v2
    v_lshlrev_b32 v14, 8, v14
    v_lshl_add_u32 v14, v6, 5, v14
    v_and_b32 v16, 16, v2
    v_add_u32 v14, v14, v16
    s_lshl_b32 s12, s21, 9
    s_add_u32 s12, s12, 159744
    v_add_u32 v14, s12, v14
    ds_write_b128 v14, v[220:223]
    v_mov_b32 v14, 162848
    v_mov_b32 v16, 1
    s_mov_b64 exec, 1
    ds_add_rtn_u32 v17, v14, v16
    s_mov_b64 exec, -1
    s_waitcnt lgkmcnt(0)
    v_readfirstlane_b32 s12, v17
    s_nop 1
    s_cmp_lg_u32 s12, 3
    s_cbranch_scc1 L_nogu
    s_cmp_ge_u32 s10, 224
    s_cbranch_scc1 L_nogu
    v_lshlrev_b32 v14, 2, v2
    v_add_u32 v14, 159744, v14
    ds_read2st64_b32 v[220:221], v14 offset0:0 offset1:1
    ds_read2st64_b32 v[222:223], v14 offset0:2 offset1:3
    ds_read2st64_b32 v[224:225], v14 offset0:4 offset1:5
    ds_read2st64_b32 v[226:227], v14 offset0:6 offset1:7
    s_and_b32 s12, s10, 3
    s_mul_i32 s12, s12, 28672
    s_lshr_b32 s13, s10, 2
    s_lshl_b32 s13, s13, 8
    s_add_u32 s12, s12, 327680
    s_xor_b32 s90, s13, 1024
    s_add_u32 s90, s90, s12
    s_add_u32 s90, s90, 14336
    s_add_u32 s12, s12, s13
    v_lshlrev_b32 v14, 2, v2
    v_and_b32 v16, 1, v2
    v_lshlrev_b32 v16, 4, v16
    v_lshrrev_b32 v16, v16, s23
    v_bfe_u32 v17, v16, 8, 8
    v_and_b32 v16, 0xff, v16
    s_mov_b32 s13, 0xffffff00
    s_waitcnt lgkmcnt(0)
    v_pk_add_f32 v[220:221], v[220:221], v[222:223]
    v_pk_add_f32 v[224:225], v[224:225], v[226:227]
    v_pk_add_f32 v[220:221], v[220:221], v[224:225]
    v_and_or_b32 v220, v220, s13, v16
    v_and_or_b32 v221, v221, s13, v17
    buffer_store_dword v220, v14, s[32:35], s12 offen sc1
    buffer_store_dword v221, v14, s[32:35], s90 offen sc1
L_nogu:
    s_bfe_u32 s12, s69, 0x40014
    s_mul_i32 s12, s12, 393216
    s_add_u32 m0, s95, 65536
    s_nop 0
    buffer_load_dwordx4 v28, s[28:31], s12 offen offset:0 lds
    buffer_load_dwordx4 v29, s[28:31], s12 offen offset:1024 lds
    s_bfe_u32 s12, s69, 0x40018
    s_mul_i32 s12, s12, 393216
    s_add_u32 m0, s95, 73728
    s_nop 0
    buffer_load_dwordx4 v28, s[28:31], s12 offen offset:0 lds
    buffer_load_dwordx4 v29, s[28:31], s12 offen offset:1024 lds
    s_mul_i32 s12, s21, 16
    s_add_u32 s12, s12, 0
    s_and_b32 s90, s88, 1
    s_lshl_b32 s90, s90, 6
    s_xor_b32 s12, s12, s90
    s_lshl_b32 s12, s12, 14
    s_add_u32 s90, s12, 147456
    buffer_load_dwordx4 v[68:71], v33, s[36:39], s90 offen
    s_add_u32 s90, s12, 163840
    buffer_load_dwordx4 v[72:75], v33, s[36:39], s90 offen
    s_add_u32 s90, s12, 180224
    buffer_load_dwordx4 v[236:239], v33, s[36:39], s90 offen
    s_add_u32 s90, s12, 196608
    buffer_load_dwordx4 v[240:243], v33, s[36:39], s90 offen
    s_add_u32 s90, s12, 212992
    buffer_load_dwordx4 v[244:247], v33, s[36:39], s90 offen
    s_add_u32 s90, s12, 229376
    buffer_load_dwordx4 v[248:251], v33, s[36:39], s90 offen
    s_add_u32 s90, s12, 245760
    buffer_load_dwordx4 v[252:255], v33, s[36:39], s90 offen
    s_mul_i32 s12, s21, 4
    s_add_u32 s12, s12, 64
    s_and_b32 s90, s88, 1
    s_lshl_b32 s90, s90, 6
    s_xor_b32 s12, s12, s90
    s_lshl_b32 s12, s12, 14
    s_add_u32 s90, s12, 0
    buffer_load_dwordx4 v[220:223], v33, s[36:39], s90 offen
    s_add_u32 s90, s12, 16384
    buffer_load_dwordx4 v[224:227], v33, s[36:39], s90 offen
    s_add_u32 s90, s12, 32768
    buffer_load_dwordx4 v[228:231], v33, s[36:39], s90 offen
    s_add_u32 s90, s12, 49152
    buffer_load_dwordx4 v[232:235], v33, s[36:39], s90 offen
    v_mov_b32 v14, 162816
    s_mov_b32 s13, 0
L_dspin_g:
    ds_read_b128 v[104:107], v14
    s_add_u32 s13, s13, 1
    s_cmp_ge_u32 s13, 262144
    s_cbranch_scc1 L_dok_g
    s_waitcnt lgkmcnt(0)
    v_and_b32 v104, v104, v105
    v_and_b32 v106, v106, v107
    v_and_b32 v104, v104, v106
    v_cmp_eq_u32 vcc, 1, v104
    s_cbranch_vccz L_dspin_g
L_dok_g:
    s_waitcnt lgkmcnt(0)
    s_bfe_u32 s12, s69, 0x4001c
    s_mul_i32 s12, s12, 393216
    s_add_u32 m0, s95, 24576
    s_nop 0
    buffer_load_dwordx4 v28, s[28:31], s12 offen offset:0 lds
    buffer_load_dwordx4 v29, s[28:31], s12 offen offset:1024 lds
    s_cmp_eq_u32 s21, 0
    s_cbranch_scc1 L_nowrx
    s_mul_i32 s12, s21, 16
    s_add_u32 s12, s12, 64
    s_and_b32 s90, s88, 1
    s_lshl_b32 s90, s90, 6
    s_xor_b32 s12, s12, s90
    s_lshl_b32 s12, s12, 14
    s_add_u32 s90, s12, 0
    buffer_load_dwordx4 v[128:131], v33, s[36:39], s90 offen
    s_add_u32 s90, s12, 16384
    buffer_load_dwordx4 v[132:135], v33, s[36:39], s90 offen
    s_add_u32 s90, s12, 32768
    buffer_load_dwordx4 v[136:139], v33, s[36:39], s90 offen
    s_add_u32 s90, s12, 49152
    buffer_load_dwordx4 v[140:143], v33, s[36:39], s90 offen
    s_add_u32 s90, s12, 65536
    buffer_load_dwordx4 v[144:147], v33, s[36:39], s90 offen
    s_add_u32 s90, s12, 81920
    buffer_load_dwordx4 v[148:151], v33, s[36:39], s90 offen
    s_add_u32 s90, s12, 98304
    buffer_load_dwordx4 v[152:155], v33, s[36:39], s90 offen
    s_add_u32 s90, s12, 114688
    buffer_load_dwordx4 v[156:159], v33, s[36:39], s90 offen
    s_add_u32 s90, s12, 131072
    buffer_load_dwordx4 v[160:163], v33, s[36:39], s90 offen
    s_add_u32 s90, s12, 147456
    buffer_load_dwordx4 v[164:167], v33, s[36:39], s90 offen
    s_add_u32 s90, s12, 163840
    buffer_load_dwordx4 v[168:171], v33, s[36:39], s90 offen
    s_add_u32 s90, s12, 180224
    buffer_load_dwordx4 v[172:175], v33, s[36:39], s90 offen
    s_add_u32 s90, s12, 196608
    buffer_load_dwordx4 v[176:179], v33, s[36:39], s90 offen
    s_add_u32 s90, s12, 212992
    buffer_load_dwordx4 v[180:183], v33, s[36:39], s90 offen
    s_add_u32 s90, s12, 229376
    buffer_load_dwordx4 v[184:187], v33, s[36:39], s90 offen
    s_add_u32 s90, s12, 245760
    buffer_load_dwordx4 v[188:191], v33, s[36:39], s90 offen
L_nowrx:
    v_mov_b32 v62, v6
    v_mov_b32 v63, v35
    s_mov_b32 s86, s96
    s_mov_b32 s4, s15
    s_mov_b32 s5, s14
    v_mov_b32 v61, v33
    s_mov_b32 s68, s58
    s_and_b32 s69, s59, 0xffff
    s_mov_b32 s70, 4194304
    s_mov_b32 s71, 0x00020000
    s_and_b32 s90, s20, 3
    s_lshr_b32 s91, s20, 2
    s_lshl_b32 s12, s88, 3
    s_lshl_b32 s13, s90, 1
    s_add_u32 s12, s12, s13
    s_add_u32 s92, s12, s91
    s_lshl_b32 s12, s92, 4
    v_and_b32 v3, 15, v2
    v_add_u32 v6, s12, v3
    v_lshlrev_b32 v8, 2, v6
    v_bfe_u32 v9, v2, 4, 1
    v_lshrrev_b32 v10, 5, v2
    v_lshlrev_b32 v7, 11, v6
    v_lshl_add_u32 v7, v9, 6, v7
    v_lshl_add_u32 v7, v10, 4, v7
    s_lshl_b32 s12, s89, 7
    v_add_u32 v7, s12, v7
    s_mov_b32 s12, 4096
    buffer_load_dwordx4 v[24:27], v7, s[24:27], 0 offen
    buffer_load_dwordx4 v[28:31], v7, s[24:27], 0 offen offset:32
    buffer_load_dword v48, v8, s[32:35], s12 offen sc1
    v_lshlrev_b32 v22, 8, v3
    v_lshl_add_u32 v22, v9, 7, v22
    v_lshl_add_u32 v22, v10, 5, v22
    v_lshlrev_b32 v10, 9, v10
    v_bfe_u32 v11, v2, 2, 2
    v_lshl_add_u32 v10, v11, 7, v10
    v_bfe_u32 v11, v2, 3, 1
    v_lshl_add_u32 v10, v11, 6, v10
    v_lshl_add_u32 v10, v9, 5, v10
    v_and_b32 v11, 3, v2
    v_lshl_add_u32 v10, v11, 3, v10
    v_xor_b32 v11, 64, v10
    s_lshl_b32 s12, s91, 8
    v_xor_b32 v17, s12, v5
    v_lshlrev_b32 v8, 2, v3
    s_lshl_b32 s12, s20, 12
    s_mov_b32 s15, 32768
    s_cmp_lt_u32 s20, 6
    s_cselect_b32 s13, s15, 131072
    s_add_u32 s12, s12, s13
    v_add_u32 v20, s12, v5
    s_xor_b32 s14, s20, 4
    s_lshl_b32 s12, s14, 12
    s_cmp_lt_u32 s14, 6
    s_cselect_b32 s13, s15, 131072
    s_add_u32 s12, s12, s13
    v_add_u32 v21, s12, v5
    s_lshl_b32 s12, s88, 2
    s_add_u32 s12, s12, s90
    s_lshl_b32 s13, s12, 16
    s_lshl_b32 s14, s91, 15
    s_add_u32 s13, s13, s14
    s_add_u32 s95, s13, 8388608
    s_lshl_b32 s12, s88, 12
    s_lshl_b32 s13, s89, 8
    s_mul_i32 s13, s13, 1
    s_add_u32 s12, s12, s13
    s_lshr_b32 s13, s90, 1
    s_lshl_b32 s13, s13, 7
    s_add_u32 s12, s12, s13
    s_lshl_b32 s13, s91, 6
    s_add_u32 s12, s12, s13
    s_add_u32 s15, s12, 524288
    s_lshl_b32 s97, s91, 4
    v_lshlrev_b32 v8, 7, v3
    s_lshl_b32 s12, s88, 1
    s_lshr_b32 s13, s90, 1
    s_add_u32 s12, s12, s13
    s_lshl_b32 s12, s12, 12
    s_lshl_b32 s13, s91, 11
    s_add_u32 s12, s12, s13
    s_and_b32 s13, s89, 0
    s_lshl_b32 s13, s13, 17
    s_add_u32 s12, s12, s13
    s_add_u32 s15, s12, 6291456
    s_mov_b32 s93, s89
    s_lshl_b32 s12, s21, 2
    s_add_u32 s12, s12, 162960
    v_mov_b32 v78, s12
    v_mov_b32 v79, 1
    s_cmp_eq_u32 s21, 0
    s_cbranch_scc1 L_wqw0
    s_waitcnt vmcnt(19)
    s_branch L_wqw1
L_wqw0:
    s_waitcnt vmcnt(3)
L_wqw1:
    s_mov_b64 exec, 1
    ds_write_b32 v78, v79
    s_mov_b64 exec, -1
    s_cmp_lg_u32 s21, 0
    s_cbranch_scc0 L_hop
    s_waitcnt vmcnt(0)
    v_sub_f32 v50, 1.0, v48
    v_cvt_pk_bf16_f32 v50, v50, v50
    v_lshlrev_b32 v50, 16, v50
    v_lshlrev_b32 v32, 16, v24
    v_and_b32 v33, 0xffff0000, v24
    v_lshlrev_b32 v34, 16, v25
    v_and_b32 v35, 0xffff0000, v25
    v_lshlrev_b32 v36, 16, v26
    v_and_b32 v37, 0xffff0000, v26
    v_lshlrev_b32 v38, 16, v27
    v_and_b32 v39, 0xffff0000, v27
    v_lshlrev_b32 v40, 16, v28
    v_and_b32 v41, 0xffff0000, v28
    v_lshlrev_b32 v42, 16, v29
    v_and_b32 v43, 0xffff0000, v29
    v_lshlrev_b32 v44, 16, v30
    v_and_b32 v45, 0xffff0000, v30
    v_lshlrev_b32 v46, 16, v31
    v_and_b32 v47, 0xffff0000, v31
    v_pk_mul_f32 v[32:33], v[32:33], v[50:51] op_sel_hi:[1,0]
    v_pk_mul_f32 v[34:35], v[34:35], v[50:51] op_sel_hi:[1,0]
    v_pk_mul_f32 v[36:37], v[36:37], v[50:51] op_sel_hi:[1,0]
    v_pk_mul_f32 v[38:39], v[38:39], v[50:51] op_sel_hi:[1,0]
    v_pk_mul_f32 v[40:41], v[40:41], v[50:51] op_sel_hi:[1,0]
    v_pk_mul_f32 v[42:43], v[42:43], v[50:51] op_sel_hi:[1,0]
    v_pk_mul_f32 v[44:45], v[44:45], v[50:51] op_sel_hi:[1,0]
    v_pk_mul_f32 v[46:47], v[46:47], v[50:51] op_sel_hi:[1,0]
    v_cvt_pk_bf16_f32 v33, v32, v33
    v_cvt_pk_bf16_f32 v35, v34, v35
    v_cvt_pk_bf16_f32 v37, v36, v37
    v_cvt_pk_bf16_f32 v39, v38, v39
    v_cvt_pk_bf16_f32 v41, v40, v41
    v_cvt_pk_bf16_f32 v43, v42, v43
    v_cvt_pk_bf16_f32 v45, v44, v45
    v_cvt_pk_bf16_f32 v47, v46, v47
    v_lshlrev_b32 v32, 16, v33
    v_and_b32 v33, 0xffff0000, v33
    v_lshlrev_b32 v34, 16, v35
    v_and_b32 v35, 0xffff0000, v35
    v_lshlrev_b32 v36, 16, v37
    v_and_b32 v37, 0xffff0000, v37
    v_lshlrev_b32 v38, 16, v39
    v_and_b32 v39, 0xffff0000, v39
    v_lshlrev_b32 v40, 16, v41
    v_and_b32 v41, 0xffff0000, v41
    v_lshlrev_b32 v42, 16, v43
    v_and_b32 v43, 0xffff0000, v43
    v_lshlrev_b32 v44, 16, v45
    v_and_b32 v45, 0xffff0000, v45
    v_lshlrev_b32 v46, 16, v47
    v_and_b32 v47, 0xffff0000, v47
    v_mov_b32 v78, 162928
    s_mov_b32 s13, 0
L_gtu:
    ds_read_b128 v[104:107], v78
    s_add_u32 s13, s13, 1
    s_cmp_ge_u32 s13, 262144
    s_cbranch_scc1 L_gxu
    s_waitcnt lgkmcnt(0)
    v_and_b32 v104, v104, v105
    v_and_b32 v106, v106, v107
    v_and_b32 v104, v104, v106
    v_cmp_eq_u32 vcc, 1, v104
    s_cbranch_vccz L_gtu
L_gxu:
    s_waitcnt lgkmcnt(0)
    s_branch L_nohop
L_hop:
    v_mov_b32 v78, 162992
    s_mov_b32 s13, 0
L_gth:
    ds_read_b128 v[104:107], v78
    s_add_u32 s13, s13, 1
    s_cmp_ge_u32 s13, 262144
    s_cbranch_scc1 L_gxh
    s_waitcnt lgkmcnt(0)
    v_and_b32 v104, v104, v105
    v_and_b32 v106, v106, v107
    v_and_b32 v104, v104, v106
    v_cmp_eq_u32 vcc, 1, v104
    s_cbranch_vccz L_gth
L_gxh:
    s_waitcnt lgkmcnt(0)
    s_lshl_b32 s12, s19, 18
    s_lshl_b32 s13, s18, 14
    s_add_u32 s12, s12, s13
    s_add_u32 s80, s12, 1048576
    s_add_u32 s81, s80, 4096
    s_add_u32 s82, s80, 8192
    s_add_u32 s83, s80, 12288
    s_mov_b32 s13, 0
    s_lshl_b32 s12, s19, 13
    s_lshr_b32 s84, s18, 2
    s_lshl_b32 s84, s84, 11
    s_add_u32 s12, s12, s84
    s_bfe_u32 s84, s18, 0x10001
    s_lshl_b32 s84, s84, 6
    s_add_u32 s12, s12, s84
    s_and_b32 s84, s18, 1
    s_lshl_b32 s84, s84, 4
    s_add_u32 s12, s12, s84
    s_add_u32 s84, s12, 5242880
    v_and_b32 v80, 15, v2
    v_lshlrev_b32 v80, 7, v80
    v_lshrrev_b32 v78, 5, v2
    v_lshl_add_u32 v80, v78, 5, v80
    s_mov_b32 s87, 1
    s_mov_b32 s85, 0xffff
L_h1:
    buffer_load_dwordx4 v[104:107], v80, s[32:35], s84 offen sc1
    s_add_u32 s13, s13, 1
    s_cmp_ge_u32 s13, 16384
    s_cbranch_scc1 L_h1ok
    s_cmp_lg_u32 s87, 0
    s_cbranch_scc1 L_h1d
    s_waitcnt vmcnt(0)
    v_msad_u8 v108, v104, s76, 0
    v_msad_u8 v108, v105, s77, v108
    v_msad_u8 v108, v106, s78, v108
    v_msad_u8 v108, v107, s79, v108
    v_cmp_ne_u32 vcc, 0, v108
    s_nop 1
    s_or_b32 s12, vcc_lo, vcc_hi
    s_and_b32 s12, s12, 0xffff
    s_bcnt1_i32_b32 s12, s12
    s_cmp_le_u32 s12, 6
    s_cselect_b32 s87, 1, 0
    s_branch L_h1
L_h1d:
    s_bitcmp1_b32 s85, 0
    s_cselect_b64 exec, -1, 0
    buffer_load_dwordx4 v[128:131], v5, s[32:35], s80 offen offset:0 sc1
    s_bitcmp1_b32 s85, 1
    s_cselect_b64 exec, -1, 0
    buffer_load_dwordx4 v[132:135], v5, s[32:35], s80 offen offset:1024 sc1
    s_bitcmp1_b32 s85, 2
    s_cselect_b64 exec, -1, 0
    buffer_load_dwordx4 v[136:139], v5, s[32:35], s80 offen offset:2048 sc1
    s_bitcmp1_b32 s85, 3
    s_cselect_b64 exec, -1, 0
    buffer_load_dwordx4 v[140:143], v5, s[32:35], s80 offen offset:3072 sc1
    s_bitcmp1_b32 s85, 4
    s_cselect_b64 exec, -1, 0
    buffer_load_dwordx4 v[144:147], v5, s[32:35], s81 offen offset:0 sc1
    s_bitcmp1_b32 s85, 5
    s_cselect_b64 exec, -1, 0
    buffer_load_dwordx4 v[148:151], v5, s[32:35], s81 offen offset:1024 sc1
    s_bitcmp1_b32 s85, 6
    s_cselect_b64 exec, -1, 0
    buffer_load_dwordx4 v[152:155], v5, s[32:35], s81 offen offset:2048 sc1
    s_bitcmp1_b32 s85, 7
    s_cselect_b64 exec, -1, 0
    buffer_load_dwordx4 v[156:159], v5, s[32:35], s81 offen offset:3072 sc1
    s_bitcmp1_b32 s85, 8
    s_cselect_b64 exec, -1, 0
    buffer_load_dwordx4 v[160:163], v5, s[32:35], s82 offen offset:0 sc1
    s_bitcmp1_b32 s85, 9
    s_cselect_b64 exec, -1, 0
    buffer_load_dwordx4 v[164:167], v5, s[32:35], s82 offen offset:1024 sc1
    s_bitcmp1_b32 s85, 10
    s_cselect_b64 exec, -1, 0
    buffer_load_dwordx4 v[168:171], v5, s[32:35], s82 offen offset:2048 sc1
    s_bitcmp1_b32 s85, 11
    s_cselect_b64 exec, -1, 0
    buffer_load_dwordx4 v[172:175], v5, s[32:35], s82 offen offset:3072 sc1
    s_bitcmp1_b32 s85, 12
    s_cselect_b64 exec, -1, 0
    buffer_load_dwordx4 v[176:179], v5, s[32:35], s83 offen offset:0 sc1
    s_bitcmp1_b32 s85, 13
    s_cselect_b64 exec, -1, 0
    buffer_load_dwordx4 v[180:183], v5, s[32:35], s83 offen offset:1024 sc1
    s_bitcmp1_b32 s85, 14
    s_cselect_b64 exec, -1, 0
    buffer_load_dwordx4 v[184:187], v5, s[32:35], s83 offen offset:2048 sc1
    s_bitcmp1_b32 s85, 15
    s_cselect_b64 exec, -1, 0
    buffer_load_dwordx4 v[188:191], v5, s[32:35], s83 offen offset:3072 sc1
    s_mov_b64 exec, -1
    s_waitcnt vmcnt(16)
    v_msad_u8 v108, v104, s76, 0
    v_msad_u8 v108, v105, s77, v108
    v_msad_u8 v108, v106, s78, v108
    v_msad_u8 v108, v107, s79, v108
    v_cmp_ne_u32 vcc, 0, v108
    s_nop 1
    s_or_b32 s85, vcc_lo, vcc_hi
    s_and_b32 s85, s85, 0xffff
    s_bcnt1_i32_b32 s12, s85
    s_cmp_le_u32 s12, 6
    s_cselect_b32 s87, 1, 0
    s_cmp_lg_u32 s85, 0
    s_waitcnt vmcnt(0)
    s_cbranch_scc1 L_h1
    v_msad_u8 v108, v128, v63, 0
    v_msad_u8 v109, v132, v63, 0
    v_msad_u8 v108, v136, v63, v108
    v_msad_u8 v109, v140, v63, v109
    v_msad_u8 v108, v144, v63, v108
    v_msad_u8 v109, v148, v63, v109
    v_msad_u8 v108, v152, v63, v108
    v_msad_u8 v109, v156, v63, v109
    v_msad_u8 v108, v160, v63, v108
    v_msad_u8 v109, v164, v63, v109
    v_msad_u8 v108, v168, v63, v108
    v_msad_u8 v109, v172, v63, v109
    v_msad_u8 v108, v176, v63, v108
    v_msad_u8 v109, v180, v63, v109
    v_msad_u8 v108, v184, v63, v108
    v_msad_u8 v109, v188, v63, v109
    v_or_b32 v108, v108, v109
    v_cmp_ne_u32 vcc, 0, v108
    s_mov_b32 s85, 0xffff
    s_cbranch_vccnz L_h1
L_h1ok:
    s_waitcnt vmcnt(0)
    v_pk_add_f32 v[128:129], v[128:129], v[160:161]
    v_pk_add_f32 v[130:131], v[130:131], v[162:163]
    v_pk_add_f32 v[132:133], v[132:133], v[164:165]
    v_pk_add_f32 v[134:135], v[134:135], v[166:167]
    v_pk_add_f32 v[136:137], v[136:137], v[168:169]
    v_pk_add_f32 v[138:139], v[138:139], v[170:171]
    v_pk_add_f32 v[140:141], v[140:141], v[172:173]
    v_pk_add_f32 v[142:143], v[142:143], v[174:175]
    v_pk_add_f32 v[144:145], v[144:145], v[176:177]
    v_pk_add_f32 v[146:147], v[146:147], v[178:179]
    v_pk_add_f32 v[148:149], v[148:149], v[180:181]
    v_pk_add_f32 v[150:151], v[150:151], v[182:183]
    v_pk_add_f32 v[152:153], v[152:153], v[184:185]
    v_pk_add_f32 v[154:155], v[154:155], v[186:187]
    v_pk_add_f32 v[156:157], v[156:157], v[188:189]
    v_pk_add_f32 v[158:159], v[158:159], v[190:191]
    v_pk_add_f32 v[128:129], v[128:129], v[144:145]
    v_pk_add_f32 v[130:131], v[130:131], v[146:147]
    v_pk_add_f32 v[132:133], v[132:133], v[148:149]
    v_pk_add_f32 v[134:135], v[134:135], v[150:151]
    v_pk_add_f32 v[136:137], v[136:137], v[152:153]
    v_pk_add_f32 v[138:139], v[138:139], v[154:155]
    v_pk_add_f32 v[140:141], v[140:141], v[156:157]
    v_pk_add_f32 v[142:143], v[142:143], v[158:159]
    v_pk_add_f32 v[128:129], v[128:129], v[136:137]
    v_pk_add_f32 v[130:131], v[130:131], v[138:139]
    v_pk_add_f32 v[132:133], v[132:133], v[140:141]
    v_pk_add_f32 v[134:135], v[134:135], v[142:143]
    v_pk_add_f32 v[128:129], v[128:129], v[132:133]
    v_pk_add_f32 v[130:131], v[130:131], v[134:135]
    v_add_f32_dpp v104, v104, v104 row_ror:1 row_mask:0xf bank_mask:0xf
    v_add_f32_dpp v105, v105, v105 row_ror:1 row_mask:0xf bank_mask:0xf
    v_add_f32_dpp v106, v106, v106 row_ror:1 row_mask:0xf bank_mask:0xf
    v_add_f32_dpp v107, v107, v107 row_ror:1 row_mask:0xf bank_mask:0xf
    v_add_f32_dpp v104, v104, v104 row_ror:2 row_mask:0xf bank_mask:0xf
    v_add_f32_dpp v105, v105, v105 row_ror:2 row_mask:0xf bank_mask:0xf
    v_add_f32_dpp v106, v106, v106 row_ror:2 row_mask:0xf bank_mask:0xf
    v_add_f32_dpp v107, v107, v107 row_ror:2 row_mask:0xf bank_mask:0xf
    v_add_f32_dpp v104, v104, v104 row_ror:4 row_mask:0xf bank_mask:0xf
    v_add_f32_dpp v105, v105, v105 row_ror:4 row_mask:0xf bank_mask:0xf
    v_add_f32_dpp v106, v106, v106 row_ror:4 row_mask:0xf bank_mask:0xf
    v_add_f32_dpp v107, v107, v107 row_ror:4 row_mask:0xf bank_mask:0xf
    v_add_f32_dpp v104, v104, v104 row_ror:8 row_mask:0xf bank_mask:0xf
    v_add_f32_dpp v105, v105, v105 row_ror:8 row_mask:0xf bank_mask:0xf
    v_add_f32_dpp v106, v106, v106 row_ror:8 row_mask:0xf bank_mask:0xf
    v_add_f32_dpp v107, v107, v107 row_ror:8 row_mask:0xf bank_mask:0xf
    v_cvt_pk_bf16_f32 v108, v128, v129
    v_cvt_pk_bf16_f32 v109, v130, v131
    v_cvt_pk_bf16_f32 v112, v104, v105
    v_cvt_pk_bf16_f32 v113, v106, v107
    v_mov_b32 v110, v108
    v_mov_b32 v111, v109
    v_mov_b32 v114, v112
    v_mov_b32 v115, v113
    s_lshl_b32 s12, s19, 13
    s_lshl_b32 s13, s18, 9
    s_add_u32 s12, s12, s13
    s_add_u32 s12, s12, 32768
    s_lshl_b32 s13, s19, 11
    s_lshl_b32 s80, s18, 7
    s_add_u32 s13, s13, s80
    s_add_u32 s13, s13, 163840
    v_permlane32_swap_b32 v108, v110
    v_permlane32_swap_b32 v109, v111
    v_permlane32_swap_b32 v112, v114
    v_permlane32_swap_b32 v113, v115
    s_mov_b32 exec_hi, 0
    buffer_store_dwordx4 v[108:111], v5, s[32:35], s12 offen sc1
    s_mov_b32 exec_lo, 255
    buffer_store_dwordx4 v[112:115], v5, s[32:35], s13 offen sc1
    s_mov_b64 exec, -1
L_nohop:
    v_min_u32 v80, 6, v62
    v_lshl_add_u32 v80, v80, 3, v4
    v_lshlrev_b32 v80, 2, v80
    s_lshl_b32 s12, s86, 2
    s_add_u32 s80, s12, 327680
    s_add_u32 s81, s80, 28672
    s_add_u32 s82, s80, 57344
    s_add_u32 s83, s80, 86016
    v_and_b32 v78, 1, v4
    v_lshlrev_b32 v78, 4, v78
    v_lshrrev_b32 v78, v78, s23
    v_bfe_u32 v79, v78, 8, 8
    v_and_b32 v78, 0xff, v78
    s_mov_b32 s13, 0
    v_add_u32 v81, 14336, v80
L_gu:
    buffer_load_dword v104, v80, s[32:35], s80 offen sc1
    buffer_load_dword v105, v81, s[32:35], s80 offen sc1
    buffer_load_dword v106, v80, s[32:35], s81 offen sc1
    buffer_load_dword v107, v81, s[32:35], s81 offen sc1
    buffer_load_dword v108, v80, s[32:35], s82 offen sc1
    buffer_load_dword v109, v81, s[32:35], s82 offen sc1
    buffer_load_dword v110, v80, s[32:35], s83 offen sc1
    buffer_load_dword v111, v81, s[32:35], s83 offen sc1
    s_add_u32 s13, s13, 1
L_guw:
    s_cmp_lg_u32 s21, 0
    s_cbranch_scc1 L_nofl
    s_waitcnt vmcnt(8)
    v_mov_b32 v112, 162896
    v_mov_b32 v113, 1
    s_mov_b64 exec, 1
    ds_write_b32 v112, v113
    s_mov_b64 exec, -1
L_nofl:
    s_cmp_lg_u32 s13, 1
    s_cbranch_scc1 L_noflush
    s_mov_b32 s7, s90
    s_mul_i32 s12, s21, 16
    s_add_u32 s12, s12, 0
    s_and_b32 s90, s88, 1
    s_lshl_b32 s90, s90, 6
    s_xor_b32 s12, s12, s90
    s_cmp_ge_u32 s12, 32
    s_cselect_b32 s90, 24, 0
    s_add_u32 s12, s12, s90
    s_lshl_b32 s12, s12, 10
    v_add_u32 v76, s12, v5
    s_mul_i32 s12, s21, 16
    s_add_u32 s12, s12, 64
    s_and_b32 s90, s88, 1
    s_lshl_b32 s90, s90, 6
    s_xor_b32 s12, s12, s90
    s_cmp_ge_u32 s12, 32
    s_cselect_b32 s90, 24, 0
    s_add_u32 s12, s12, s90
    s_lshl_b32 s12, s12, 10
    v_add_u32 v77, s12, v5
    s_mul_i32 s12, s21, 4
    s_add_u32 s12, s12, 64
    s_and_b32 s90, s88, 1
    s_lshl_b32 s90, s90, 6
    s_xor_b32 s12, s12, s90
    s_cmp_ge_u32 s12, 32
    s_cselect_b32 s90, 24, 0
    s_add_u32 s12, s12, s90
    s_lshl_b32 s12, s12, 10
    v_add_u32 v60, s12, v5
    s_mov_b32 s90, s7
    v_mov_b32 v113, 162976
    s_mov_b32 s13, 0
L_gtf:
    ds_read_b64 v[114:115], v113
    ds_read_b64 v[82:83], v113 offset:8
    s_add_u32 s13, s13, 1
    s_cmp_ge_u32 s13, 262144
    s_cbranch_scc1 L_gxf
    s_waitcnt lgkmcnt(0)
    v_and_b32 v114, v114, v115
    v_and_b32 v82, v82, v83
    v_and_b32 v114, v114, v82
    v_cmp_eq_u32 vcc, 1, v114
    s_cbranch_vccz L_gtf
L_gxf:
    s_waitcnt lgkmcnt(0)
    ds_write_b128 v76, v[84:87] offset:0
    ds_write_b128 v76, v[88:91] offset:1024
    ds_write_b128 v76, v[92:95] offset:2048
    ds_write_b128 v76, v[96:99] offset:3072
    ds_write_b128 v76, v[100:103] offset:4096
    ds_write_b128 v76, v[116:119] offset:5120
    ds_write_b128 v76, v[120:123] offset:6144
    ds_write_b128 v76, v[124:127] offset:7168
    ds_write_b128 v76, v[64:67] offset:8192
    ds_write_b128 v76, v[68:71] offset:9216
    ds_write_b128 v76, v[72:75] offset:10240
    ds_write_b128 v76, v[236:239] offset:11264
    ds_write_b128 v76, v[240:243] offset:12288
    ds_write_b128 v76, v[244:247] offset:13312
    ds_write_b128 v76, v[248:251] offset:14336
    ds_write_b128 v76, v[252:255] offset:15360
    ds_write_b128 v60, v[220:223] offset:0
    ds_write_b128 v60, v[224:227] offset:1024
    ds_write_b128 v60, v[228:231] offset:2048
    ds_write_b128 v60, v[232:235] offset:3072
    s_cmp_eq_u32 s21, 0
    s_cbranch_scc1 L_nofx
    ds_write_b128 v77, v[128:131] offset:0
    ds_write_b128 v77, v[132:135] offset:1024
    ds_write_b128 v77, v[136:139] offset:2048
    ds_write_b128 v77, v[140:143] offset:3072
    ds_write_b128 v77, v[144:147] offset:4096
    ds_write_b128 v77, v[148:151] offset:5120
    ds_write_b128 v77, v[152:155] offset:6144
    ds_write_b128 v77, v[156:159] offset:7168
    ds_write_b128 v77, v[160:163] offset:8192
    ds_write_b128 v77, v[164:167] offset:9216
    ds_write_b128 v77, v[168:171] offset:10240
    ds_write_b128 v77, v[172:175] offset:11264
    ds_write_b128 v77, v[176:179] offset:12288
    ds_write_b128 v77, v[180:183] offset:13312
    ds_write_b128 v77, v[184:187] offset:14336
    ds_write_b128 v77, v[188:191] offset:15360
L_nofx:
    s_waitcnt lgkmcnt(0)
    s_mov_b32 s13, 1
L_noflush:
    s_waitcnt vmcnt(0)
    v_msad_u8 v112, v104, v78, 0
    v_msad_u8 v112, v105, v79, v112
    v_msad_u8 v112, v106, v78, v112
    v_msad_u8 v112, v107, v79, v112
    v_msad_u8 v112, v108, v78, v112
    v_msad_u8 v112, v109, v79, v112
    v_msad_u8 v112, v110, v78, v112
    v_msad_u8 v112, v111, v79, v112
    v_cmp_ne_u32 vcc, 0, v112
    s_cbranch_vccz L_guok
    s_cmp_lt_u32 s13, 16384
    s_cbranch_scc1 L_gu
L_guok:
    v_pk_add_f32 v[104:105], v[104:105], v[106:107]
    v_pk_add_f32 v[108:109], v[108:109], v[110:111]
    v_pk_add_f32 v[104:105], v[104:105], v[108:109]
    v_cvt_pk_bf16_f32 v104, v104, v105
    v_and_b32 v105, 0xffff0000, v104
    v_lshlrev_b32 v104, 16, v104
    v_mul_f32 v106, 0xbfb8aa3b, v104
    v_exp_f32 v106, v106
    s_nop 0
    v_add_f32 v106, 1.0, v106
    v_rcp_f32 v106, v106
    s_nop 0
    v_mul_f32 v106, v106, v104
    v_cvt_pk_bf16_f32 v106, v106, v106
    v_lshlrev_b32 v106, 16, v106
    v_mul_f32 v106, v106, v105
    v_cvt_pk_bf16_f32 v106, v106, v106
    ds_swizzle_b32 v64, v106 offset:0x18
    ds_swizzle_b32 v66, v106 offset:0x38
    ds_swizzle_b32 v68, v106 offset:0x58
    ds_swizzle_b32 v70, v106 offset:0x78
    ds_swizzle_b32 v72, v106 offset:0x98
    ds_swizzle_b32 v74, v106 offset:0xb8
    ds_swizzle_b32 v76, v106 offset:0xd8
    s_waitcnt lgkmcnt(0)
    v_and_b32 v65, 0xffff0000, v64
    v_and_b32 v64, 0xffff, v64
    v_and_b32 v67, 0xffff0000, v66
    v_and_b32 v66, 0xffff, v66
    v_and_b32 v69, 0xffff0000, v68
    v_and_b32 v68, 0xffff, v68
    v_and_b32 v71, 0xffff0000, v70
    v_and_b32 v70, 0xffff, v70
    v_and_b32 v73, 0xffff0000, v72
    v_and_b32 v72, 0xffff, v72
    v_and_b32 v75, 0xffff0000, v74
    v_and_b32 v74, 0xffff, v74
    v_and_b32 v77, 0xffff0000, v76
    v_and_b32 v76, 0xffff, v76
    v_dot2_f32_bf16 v220, v192, v64, 0
    v_dot2_f32_bf16 v221, v192, v65, 0
    v_dot2_f32_bf16 v222, v193, v64, 0
    v_dot2_f32_bf16 v223, v193, v65, 0
    v_dot2_f32_bf16 v224, v194, v64, 0
    v_dot2_f32_bf16 v225, v194, v65, 0
    v_dot2_f32_bf16 v226, v195, v64, 0
    v_dot2_f32_bf16 v227, v195, v65, 0
    v_dot2_f32_bf16 v220, v196, v66, v220
    v_dot2_f32_bf16 v221, v196, v67, v221
    v_dot2_f32_bf16 v222, v197, v66, v222
    v_dot2_f32_bf16 v223, v197, v67, v223
    v_dot2_f32_bf16 v224, v198, v66, v224
    v_dot2_f32_bf16 v225, v198, v67, v225
    v_dot2_f32_bf16 v226, v199, v66, v226
    v_dot2_f32_bf16 v227, v199, v67, v227
    v_dot2_f32_bf16 v220, v200, v68, v220
    v_dot2_f32_bf16 v221, v200, v69, v221
    v_dot2_f32_bf16 v222, v201, v68, v222
    v_dot2_f32_bf16 v223, v201, v69, v223
    v_dot2_f32_bf16 v224, v202, v68, v224
    v_dot2_f32_bf16 v225, v202, v69, v225
    v_dot2_f32_bf16 v226, v203, v68, v226
    v_dot2_f32_bf16 v227, v203, v69, v227
    v_dot2_f32_bf16 v220, v204, v70, v220
    v_dot2_f32_bf16 v221, v204, v71, v221
    v_dot2_f32_bf16 v222, v205, v70, v222
    v_dot2_f32_bf16 v223, v205, v71, v223
    v_dot2_f32_bf16 v224, v206, v70, v224
    v_dot2_f32_bf16 v225, v206, v71, v225
    v_dot2_f32_bf16 v226, v207, v70, v226
    v_dot2_f32_bf16 v227, v207, v71, v227
    v_dot2_f32_bf16 v220, v208, v72, v220
    v_dot2_f32_bf16 v221, v208, v73, v221
    v_dot2_f32_bf16 v222, v209, v72, v222
    v_dot2_f32_bf16 v223, v209, v73, v223
    v_dot2_f32_bf16 v224, v210, v72, v224
    v_dot2_f32_bf16 v225, v210, v73, v225
    v_dot2_f32_bf16 v226, v211, v72, v226
    v_dot2_f32_bf16 v227, v211, v73, v227
    v_dot2_f32_bf16 v220, v212, v74, v220
    v_dot2_f32_bf16 v221, v212, v75, v221
    v_dot2_f32_bf16 v222, v213, v74, v222
    v_dot2_f32_bf16 v223, v213, v75, v223
    v_dot2_f32_bf16 v224, v214, v74, v224
    v_dot2_f32_bf16 v225, v214, v75, v225
    v_dot2_f32_bf16 v226, v215, v74, v226
    v_dot2_f32_bf16 v227, v215, v75, v227
    v_dot2_f32_bf16 v220, v216, v76, v220
    v_dot2_f32_bf16 v221, v216, v77, v221
    v_dot2_f32_bf16 v222, v217, v76, v222
    v_dot2_f32_bf16 v223, v217, v77, v223
    v_dot2_f32_bf16 v224, v218, v76, v224
    v_dot2_f32_bf16 v225, v218, v77, v225
    v_dot2_f32_bf16 v226, v219, v76, v226
    v_dot2_f32_bf16 v227, v219, v77, v227
    v_permlane32_swap_b32 v220, v224
    v_permlane32_swap_b32 v221, v225
    v_permlane32_swap_b32 v222, v226
    v_permlane32_swap_b32 v223, v227
    v_add_f32 v220, v220, v224
    v_add_f32 v221, v221, v225
    v_add_f32 v222, v222, v226
    v_add_f32 v223, v223, v227
    s_nop 0
    v_permlane16_swap_b32 v220, v222
    v_permlane16_swap_b32 v221, v223
    v_add_f32 v220, v220, v222
    v_add_f32 v221, v221, v223
    s_nop 0
    v_add_f32_dpp v220, v220, v220 row_ror:8 row_mask:0xf bank_mask:0xf
    v_add_f32_dpp v221, v221, v221 row_ror:8 row_mask:0xf bank_mask:0xf
    v_lshrrev_b32 v80, 4, v2
    v_lshlrev_b32 v80, 3, v80
    v_lshl_add_u32 v80, v62, 5, v80
    s_lshl_b32 s12, s21, 8
    s_add_u32 s12, s12, 161792
    v_add_u32 v80, s12, v80
    ds_write_b64 v80, v[220:221]
    v_mov_b32 v80, 162848
    v_mov_b32 v78, 1
    s_mov_b64 exec, 1
    ds_add_rtn_u32 v79, v80, v78 offset:4
    s_mov_b64 exec, -1
    s_waitcnt lgkmcnt(0)
    v_readfirstlane_b32 s12, v79
    s_nop 1
    s_cmp_lg_u32 s12, 3
    s_cbranch_scc1 L_noy
    v_lshlrev_b32 v78, 2, v2
    v_add_u32 v80, 161792, v78
    ds_read2st64_b32 v[220:221], v80 offset0:0 offset1:1
    ds_read2st64_b32 v[222:223], v80 offset0:2 offset1:3
    s_lshl_b32 s12, s11, 8
    s_add_u32 s12, s12, 458752
    s_mov_b32 s13, 0xffffff00
    s_waitcnt lgkmcnt(0)
    v_pk_add_f32 v[220:221], v[220:221], v[222:223]
    v_add_f32 v220, v220, v221
    v_and_or_b32 v220, v220, s13, v63
    buffer_store_dword v220, v78, s[32:35], s12 offen sc1
L_noy:
    s_cmp_lg_u32 s21, 0
    s_cbranch_scc1 L_prepd
    s_waitcnt vmcnt(0)
    v_sub_f32 v50, 1.0, v48
    v_cvt_pk_bf16_f32 v50, v50, v50
    v_lshlrev_b32 v50, 16, v50
    v_lshlrev_b32 v32, 16, v24
    v_and_b32 v33, 0xffff0000, v24
    v_lshlrev_b32 v34, 16, v25
    v_and_b32 v35, 0xffff0000, v25
    v_lshlrev_b32 v36, 16, v26
    v_and_b32 v37, 0xffff0000, v26
    v_lshlrev_b32 v38, 16, v27
    v_and_b32 v39, 0xffff0000, v27
    v_lshlrev_b32 v40, 16, v28
    v_and_b32 v41, 0xffff0000, v28
    v_lshlrev_b32 v42, 16, v29
    v_and_b32 v43, 0xffff0000, v29
    v_lshlrev_b32 v44, 16, v30
    v_and_b32 v45, 0xffff0000, v30
    v_lshlrev_b32 v46, 16, v31
    v_and_b32 v47, 0xffff0000, v31
    v_pk_mul_f32 v[32:33], v[32:33], v[50:51] op_sel_hi:[1,0]
    v_pk_mul_f32 v[34:35], v[34:35], v[50:51] op_sel_hi:[1,0]
    v_pk_mul_f32 v[36:37], v[36:37], v[50:51] op_sel_hi:[1,0]
    v_pk_mul_f32 v[38:39], v[38:39], v[50:51] op_sel_hi:[1,0]
    v_pk_mul_f32 v[40:41], v[40:41], v[50:51] op_sel_hi:[1,0]
    v_pk_mul_f32 v[42:43], v[42:43], v[50:51] op_sel_hi:[1,0]
    v_pk_mul_f32 v[44:45], v[44:45], v[50:51] op_sel_hi:[1,0]
    v_pk_mul_f32 v[46:47], v[46:47], v[50:51] op_sel_hi:[1,0]
    v_cvt_pk_bf16_f32 v33, v32, v33
    v_cvt_pk_bf16_f32 v35, v34, v35
    v_cvt_pk_bf16_f32 v37, v36, v37
    v_cvt_pk_bf16_f32 v39, v38, v39
    v_cvt_pk_bf16_f32 v41, v40, v41
    v_cvt_pk_bf16_f32 v43, v42, v43
    v_cvt_pk_bf16_f32 v45, v44, v45
    v_cvt_pk_bf16_f32 v47, v46, v47
    v_lshlrev_b32 v32, 16, v33
    v_and_b32 v33, 0xffff0000, v33
    v_lshlrev_b32 v34, 16, v35
    v_and_b32 v35, 0xffff0000, v35
    v_lshlrev_b32 v36, 16, v37
    v_and_b32 v37, 0xffff0000, v37
    v_lshlrev_b32 v38, 16, v39
    v_and_b32 v39, 0xffff0000, v39
    v_lshlrev_b32 v40, 16, v41
    v_and_b32 v41, 0xffff0000, v41
    v_lshlrev_b32 v42, 16, v43
    v_and_b32 v43, 0xffff0000, v43
    v_lshlrev_b32 v44, 16, v45
    v_and_b32 v45, 0xffff0000, v45
    v_lshlrev_b32 v46, 16, v47
    v_and_b32 v47, 0xffff0000, v47
L_prepd:
    s_mov_b32 s21, s4
    s_mov_b32 s22, s5
    s_mov_b32 s45, 0
    s_lshr_b32 s12, s21, 4
    s_cmp_eq_u32 s12, s92
    s_cselect_b32 s46, 1, 0
    s_mov_b32 s45, 1
    s_branch L_phaseb
L_keyre_0:
    s_add_u32 s13, s13, 1
    s_cmp_ge_u32 s13, 16384
    s_cbranch_scc1 L_keyok_0
    s_mov_b32 s12, 0
    buffer_load_dwordx4 v[104:107], v5, s[32:35], s12 offen offset:0 sc1
    buffer_load_dwordx4 v[108:111], v5, s[32:35], s12 offen offset:1024 sc1
    s_waitcnt vmcnt(0)
    v_xor_b32 v105, s23, v105
    v_xor_b32 v107, s23, v107
    v_xor_b32 v109, s23, v109
    v_xor_b32 v111, s23, v111
    v_or3_b32 v105, v105, v107, v109
    v_or_b32 v105, v105, v111
    v_cmp_ne_u32 vcc, 0, v105
    s_cbranch_vccnz L_keyre_0
    s_branch L_keyok_0
L_keyre_1:
    s_add_u32 s13, s13, 1
    s_cmp_ge_u32 s13, 16384
    s_cbranch_scc1 L_keyok_1
    s_mov_b32 s12, 0
    buffer_load_dwordx4 v[104:107], v5, s[32:35], s12 offen offset:0 sc1
    buffer_load_dwordx4 v[108:111], v5, s[32:35], s12 offen offset:1024 sc1
    s_waitcnt vmcnt(0)
    v_xor_b32 v105, s23, v105
    v_xor_b32 v107, s23, v107
    v_xor_b32 v109, s23, v109
    v_xor_b32 v111, s23, v111
    v_or3_b32 v105, v105, v107, v109
    v_or_b32 v105, v105, v111
    v_cmp_ne_u32 vcc, 0, v105
    s_cbranch_vccnz L_keyre_1
    s_branch L_keyok_1
L_keyre_2:
    s_add_u32 s13, s13, 1
    s_cmp_ge_u32 s13, 16384
    s_cbranch_scc1 L_keyok_2
    s_mov_b32 s12, 0
    buffer_load_dwordx4 v[104:107], v5, s[32:35], s12 offen offset:0 sc1
    buffer_load_dwordx4 v[108:111], v5, s[32:35], s12 offen offset:1024 sc1
    s_waitcnt vmcnt(0)
    v_xor_b32 v105, s23, v105
    v_xor_b32 v107, s23, v107
    v_xor_b32 v109, s23, v109
    v_xor_b32 v111, s23, v111
    v_or3_b32 v105, v105, v107, v109
    v_or_b32 v105, v105, v111
    v_cmp_ne_u32 vcc, 0, v105
    s_cbranch_vccnz L_keyre_2
    s_branch L_keyok_2
L_keyre_3:
    s_add_u32 s13, s13, 1
    s_cmp_ge_u32 s13, 16384
    s_cbranch_scc1 L_keyok_3
    s_mov_b32 s12, 0
    buffer_load_dwordx4 v[104:107], v5, s[32:35], s12 offen offset:0 sc1
    buffer_load_dwordx4 v[108:111], v5, s[32:35], s12 offen offset:1024 sc1
    s_waitcnt vmcnt(0)
    v_xor_b32 v105, s23, v105
    v_xor_b32 v107, s23, v107
    v_xor_b32 v109, s23, v109
    v_xor_b32 v111, s23, v111
    v_or3_b32 v105, v105, v107, v109
    v_or_b32 v105, v105, v111
    v_cmp_ne_u32 vcc, 0, v105
    s_cbranch_vccnz L_keyre_3
    s_branch L_keyok_3
L_keyre_4:
    s_add_u32 s13, s13, 1
    s_cmp_ge_u32 s13, 16384
    s_cbranch_scc1 L_keyok_4
    s_mov_b32 s12, 0
    buffer_load_dwordx4 v[104:107], v5, s[32:35], s12 offen offset:0 sc1
    buffer_load_dwordx4 v[108:111], v5, s[32:35], s12 offen offset:1024 sc1
    s_waitcnt vmcnt(0)
    v_xor_b32 v105, s23, v105
    v_xor_b32 v107, s23, v107
    v_xor_b32 v109, s23, v109
    v_xor_b32 v111, s23, v111
    v_or3_b32 v105, v105, v107, v109
    v_or_b32 v105, v105, v111
    v_cmp_ne_u32 vcc, 0, v105
    s_cbranch_vccnz L_keyre_4
    s_branch L_keyok_4
.fill 792, 4, 0xbf800000
L_compute:
    s_setprio 1
    s_lshr_b32 s21, s20, 1
    s_and_b32 s22, s20, 1
    v_lshrrev_b32 v3, 5, v2
    v_and_b32 v4, 31, v2
    s_lshl_b32 s12, s21, 13
    v_lshlrev_b32 v6, 7, v4
    v_add_u32 v6, s12, v6
    v_bfe_u32 v7, v2, 1, 3
    v_add_u32 v8, 0, v3
    v_xor_b32 v8, v8, v7
    v_lshl_add_u32 v20, v8, 4, v6
    v_add_u32 v8, 2, v3
    v_xor_b32 v8, v8, v7
    v_lshl_add_u32 v21, v8, 4, v6
    v_add_u32 v8, 4, v3
    v_xor_b32 v8, v8, v7
    v_lshl_add_u32 v22, v8, 4, v6
    v_add_u32 v8, 6, v3
    v_xor_b32 v8, v8, v7
    v_lshl_add_u32 v23, v8, 4, v6
    v_lshlrev_b32 v6, 10, v3
    v_bfe_u32 v7, v2, 2, 2
    v_lshl_add_u32 v6, v7, 7, v6
    v_bfe_u32 v8, v2, 3, 1
    v_xor_b32 v8, s22, v8
    v_lshl_add_u32 v6, v8, 6, v6
    v_bfe_u32 v8, v2, 4, 1
    v_lshlrev_b32 v8, 5, v8
    v_and_b32 v9, 3, v2
    v_lshl_add_u32 v8, v9, 3, v8
    v_add_u32 v6, v6, v8
    v_add_u32 v36, 16384, v6
    v_lshl_add_u32 v7, v3, 2, v7
    v_lshl_add_u32 v12, v7, 6, v8
    s_lshl_b32 s12, s22, 11
    s_add_u32 s12, s12, 155648
    v_add_u32 v12, s12, v12
    v_lshlrev_b32 v6, 14, v3
    v_lshl_add_u32 v6, v4, 4, v6
    v_lshlrev_b32 v7, 9, v3
    s_lshl_b32 s12, s22, 3
    s_lshl_b32 s13, s21, 2
    s_add_u32 s12, s12, s13
    s_lshl_b32 s13, s12, 14
    s_lshl_b32 s14, s19, 18
    s_add_u32 s13, s13, s14
    s_lshl_b32 s14, s18, 10
    s_add_u32 s13, s13, s14
    s_add_u32 s40, s13, 1048576
    s_add_u32 s41, s40, 32768
    s_lshl_b32 s13, s12, 9
    s_lshl_b32 s14, s19, 13
    s_add_u32 s13, s13, s14
    s_lshl_b32 s14, s18, 5
    s_add_u32 s13, s13, s14
    s_add_u32 s42, s13, 5242880
    s_add_u32 s43, s42, 1024
    s_lshl_b32 s13, s21, 4
    s_lshl_b32 s44, 1, s13
    s_xor_b32 s13, s13, 16
    s_lshl_b32 s45, 1, s13
    s_lshl_b32 s13, s22, 1
    s_add_u32 s13, s13, s21
    s_lshl_b32 s13, s13, 11
    s_lshl_b32 s14, s19, 13
    s_add_u32 s13, s13, s14
    s_lshl_b32 s14, s18, 7
    s_add_u32 s13, s13, s14
    s_add_u32 s42, s13, 5242880
    s_mov_b32 s45, 0x10001
    v_lshlrev_b32 v7, 2, v2
    v_mov_b32 v68, 0
    v_mov_b32 v69, 0
    v_mov_b32 v70, 0
    v_mov_b32 v71, 0
    v_mov_b32 v160, 0
    v_mov_b32 v161, 0
    v_mov_b32 v162, 0
    v_mov_b32 v163, 0
    v_mov_b32 v164, 0
    v_mov_b32 v165, 0
    v_mov_b32 v166, 0
    v_mov_b32 v167, 0
    v_mov_b32 v168, 0
    v_mov_b32 v169, 0
    v_mov_b32 v170, 0
    v_mov_b32 v171, 0
    v_mov_b32 v172, 0
    v_mov_b32 v173, 0
    v_mov_b32 v174, 0
    v_mov_b32 v175, 0
    v_mov_b32 v176, 0
    v_mov_b32 v177, 0
    v_mov_b32 v178, 0
    v_mov_b32 v179, 0
    v_mov_b32 v180, 0
    v_mov_b32 v181, 0
    v_mov_b32 v182, 0
    v_mov_b32 v183, 0
    v_mov_b32 v184, 0
    v_mov_b32 v185, 0
    v_mov_b32 v186, 0
    v_mov_b32 v187, 0
    v_mov_b32 v188, 0
    v_mov_b32 v189, 0
    v_mov_b32 v190, 0
    v_mov_b32 v191, 0
    v_mov_b32 v192, 0
    v_mov_b32 v193, 0
    v_mov_b32 v194, 0
    v_mov_b32 v195, 0
    v_mov_b32 v196, 0
    v_mov_b32 v197, 0
    v_mov_b32 v198, 0
    v_mov_b32 v199, 0
    v_mov_b32 v200, 0
    v_mov_b32 v201, 0
    v_mov_b32 v202, 0
    v_mov_b32 v203, 0
    v_mov_b32 v204, 0
    v_mov_b32 v205, 0
    v_mov_b32 v206, 0
    v_mov_b32 v207, 0
    v_mov_b32 v208, 0
    v_mov_b32 v209, 0
    v_mov_b32 v210, 0
    v_mov_b32 v211, 0
    v_mov_b32 v212, 0
    v_mov_b32 v213, 0
    v_mov_b32 v214, 0
    v_mov_b32 v215, 0
    v_mov_b32 v216, 0
    v_mov_b32 v217, 0
    v_mov_b32 v218, 0
    v_mov_b32 v219, 0
    v_mov_b32 v220, 0
    v_mov_b32 v221, 0
    v_mov_b32 v222, 0
    v_mov_b32 v223, 0
    v_mov_b32 v224, 0
    v_mov_b32 v225, 0
    v_mov_b32 v226, 0
    v_mov_b32 v227, 0
    v_mov_b32 v228, 0
    v_mov_b32 v229, 0
    v_mov_b32 v230, 0
    v_mov_b32 v231, 0
    v_mov_b32 v232, 0
    v_mov_b32 v233, 0
    v_mov_b32 v234, 0
    v_mov_b32 v235, 0
    v_mov_b32 v236, 0
    v_mov_b32 v237, 0
    v_mov_b32 v238, 0
    v_mov_b32 v239, 0
    v_mov_b32 v240, 0
    v_mov_b32 v241, 0
    v_mov_b32 v242, 0
    v_mov_b32 v243, 0
    v_mov_b32 v244, 0
    v_mov_b32 v245, 0
    v_mov_b32 v246, 0
    v_mov_b32 v247, 0
    v_mov_b32 v248, 0
    v_mov_b32 v249, 0
    v_mov_b32 v250, 0
    v_mov_b32 v251, 0
    v_mov_b32 v252, 0
    v_mov_b32 v253, 0
    v_mov_b32 v254, 0
    v_mov_b32 v255, 0
    v_lshlrev_b32 v8, 2, v3
    v_sub_u32 v8, v4, v8
    v_mov_b32 v9, 0x3f80
    v_mov_b32 v10, 0x3f800000
    v_cmp_eq_u32 vcc, 0, v8
    s_nop 1
    v_cndmask_b32 v11, 0, v9, vcc
    v_cmp_eq_u32 vcc, 1, v8
    s_nop 1
    v_cndmask_b32 v48, v11, v10, vcc
    v_cmp_eq_u32 vcc, 2, v8
    s_nop 1
    v_cndmask_b32 v11, 0, v9, vcc
    v_cmp_eq_u32 vcc, 3, v8
    s_nop 1
    v_cndmask_b32 v49, v11, v10, vcc
    v_cmp_eq_u32 vcc, 8, v8
    s_nop 1
    v_cndmask_b32 v11, 0, v9, vcc
    v_cmp_eq_u32 vcc, 9, v8
    s_nop 1
    v_cndmask_b32 v50, v11, v10, vcc
    v_cmp_eq_u32 vcc, 10, v8
    s_nop 1
    v_cndmask_b32 v11, 0, v9, vcc
    v_cmp_eq_u32 vcc, 11, v8
    s_nop 1
    v_cndmask_b32 v51, v11, v10, vcc
    v_cmp_eq_u32 vcc, 16, v8
    s_nop 1
    v_cndmask_b32 v11, 0, v9, vcc
    v_cmp_eq_u32 vcc, 17, v8
    s_nop 1
    v_cndmask_b32 v52, v11, v10, vcc
    v_cmp_eq_u32 vcc, 18, v8
    s_nop 1
    v_cndmask_b32 v11, 0, v9, vcc
    v_cmp_eq_u32 vcc, 19, v8
    s_nop 1
    v_cndmask_b32 v53, v11, v10, vcc
    v_cmp_eq_u32 vcc, 24, v8
    s_nop 1
    v_cndmask_b32 v11, 0, v9, vcc
    v_cmp_eq_u32 vcc, 25, v8
    s_nop 1
    v_cndmask_b32 v54, v11, v10, vcc
    v_cmp_eq_u32 vcc, 26, v8
    s_nop 1
    v_cndmask_b32 v11, 0, v9, vcc
    v_cmp_eq_u32 vcc, 27, v8
    s_nop 1
    v_cndmask_b32 v55, v11, v10, vcc
    v_mov_b32 v9, 0x3f803f80
    v_cmp_gt_u32 vcc, 16, v4
    s_nop 1
    v_cndmask_b32 v56, 0, v9, vcc
    v_cndmask_b32 v60, v9, 0, vcc
    v_cndmask_b32 v57, 0, v9, vcc
    v_cndmask_b32 v61, v9, 0, vcc
    v_cndmask_b32 v58, 0, v9, vcc
    v_cndmask_b32 v62, v9, 0, vcc
    v_cndmask_b32 v59, 0, v9, vcc
    v_cndmask_b32 v63, v9, 0, vcc
    s_waitcnt lgkmcnt(0)
    s_mov_b32 s32, s62
    s_and_b32 s33, s63, 0xffff
    s_mov_b32 s34, 33554432
    s_mov_b32 s35, 0x00020000
    s_mov_b32 s24, s4
    s_and_b32 s25, s5, 0xffff
    s_mov_b32 s26, 4194304
    s_mov_b32 s27, 0x00020000
    s_cmp_lg_u32 s20, 0
    s_cbranch_scc1 L_c_noinit
    v_add_u32 v8, 162816, v5
    s_mov_b64 exec, 0xffff
    ds_write_b128 v8, v[68:71]
    s_mov_b64 exec, -1
    s_cmp_lg_u32 s2, 0
    s_cbranch_scc1 L_c_noinit
    s_mov_b32 s72, s60
    s_and_b32 s73, s61, 0xffff
    s_mov_b32 s74, 256
    s_mov_b32 s75, 0x00020000
    s_memrealtime s[14:15]
    s_waitcnt lgkmcnt(0)
    s_mul_i32 s14, s14, 0x9e3779b1
    s_or_b32 s14, s14, 0x01010101
    v_mov_b32 v8, s14
    s_mov_b64 exec, 1
    buffer_store_dword v8, v68, s[72:75], 0 offen offset:4 sc1
    s_mov_b64 exec, -1
L_c_noinit:
    s_lshl_b32 s14, s22, 1
    s_add_u32 s15, s14, s21
    s_xor_b32 s14, s15, 1
    s_mul_i32 s14, s14, 4352
    s_mul_i32 s15, s15, 4352
    s_add_u32 s14, s14, 98304
    s_add_u32 s15, s15, 98304
    v_add_u32 v8, s14, v5
    v_add_u32 v9, s15, v5
    v_lshlrev_b32 v11, 4, v3
    v_add_u32 v10, s14, v11
    v_add_u32 v11, s15, v11
    s_lshl_b32 s14, s20, 2
    s_add_u32 s15, s14, 162832
    v_mov_b32 v13, s15
    v_xor_b32 v14, 8, v13
    v_subrev_u32 v17, 16, v13
    v_mov_b32 v15, 1
    v_bfe_u32 v16, v2, 4, 1
    v_cmp_eq_u32 vcc, s21, v16
    s_nop 1
    v_cndmask_b32 v10, v10, v11, vcc
    s_lshl_b32 s14, s21, 7
    v_add_u32 v10, s14, v10
    v_lshrrev_b32 v11, 2, v5
    v_sub_u32 v16, v9, v5
    v_add_u32 v11, v16, v11
    s_waitcnt lgkmcnt(0)
    s_barrier
    ds_read_b128 v[100:103], v20
    ds_read_b64_tr_b16 v[108:109], v36 offset:0
    ds_read_b64_tr_b16 v[110:111], v36 offset:512
    ds_read_b128 v[104:107], v20 offset:4096
    ds_read_b64_tr_b16 v[112:113], v36 offset:8192
    ds_read_b64_tr_b16 v[114:115], v36 offset:8704
    ds_read_b64_tr_b16 v[116:117], v36 offset:16384
    ds_read_b64_tr_b16 v[118:119], v36 offset:16896
    s_mov_b32 s48, 0
    s_mov_b32 s49, 0
    s_mov_b32 s64, 16384
    s_mov_b32 s65, 4294868992
    s_mov_b32 s66, 40960
    s_mov_b32 s67, 4294885376
.p2align 3
L_c_loop:
    s_add_u32 s49, s49, 1
    s_cmp_eq_u32 s49, 3
    s_mov_b32 s50, 40960
    s_cselect_b32 s50, 4294885376, s50
    s_cselect_b32 s49, 0, s49
    s_cmp_eq_u32 s48, 10
    s_cselect_b32 s51, 81920, s50
    s_waitcnt lgkmcnt(5)
    v_mfma_f32_32x32x16_bf16 v[160:175], v[108:111], v[100:103], v[160:175]
    ds_read_b128 v[120:123], v21
    ds_read_b64_tr_b16 v[128:129], v36 offset:2048
    s_waitcnt lgkmcnt(6)
    v_mfma_f32_32x32x16_bf16 v[176:191], v[108:111], v[104:107], v[176:191]
    ds_read_b64_tr_b16 v[130:131], v36 offset:2560
    s_waitcnt lgkmcnt(5)
    v_mfma_f32_32x32x16_bf16 v[192:207], v[112:115], v[100:103], v[192:207]
    ds_read_b128 v[124:127], v21 offset:4096
    v_mfma_f32_32x32x16_bf16 v[208:223], v[112:115], v[104:107], v[208:223]
    ds_read_b64_tr_b16 v[132:133], v36 offset:10240
    ds_read_b64_tr_b16 v[134:135], v36 offset:10752
    s_waitcnt lgkmcnt(6)
    v_mfma_f32_32x32x16_bf16 v[224:239], v[100:103], v[116:119], v[224:239]
    ds_read_b64_tr_b16 v[136:137], v36 offset:18432
    v_add_u32 v21, s51, v21
    v_mfma_f32_32x32x16_bf16 v[240:255], v[104:107], v[116:119], v[240:255]
    ds_read_b64_tr_b16 v[138:139], v36 offset:18944
    v_add_u32 v20, s51, v20
    s_waitcnt lgkmcnt(5)
    v_mfma_f32_32x32x16_bf16 v[160:175], v[128:131], v[120:123], v[160:175]
    ds_read_b128 v[100:103], v22
    ds_read_b64_tr_b16 v[108:109], v36 offset:4096
    s_waitcnt lgkmcnt(6)
    v_mfma_f32_32x32x16_bf16 v[176:191], v[128:131], v[124:127], v[176:191]
    ds_read_b64_tr_b16 v[110:111], v36 offset:4608
    s_waitcnt lgkmcnt(5)
    v_mfma_f32_32x32x16_bf16 v[192:207], v[132:135], v[120:123], v[192:207]
    ds_read_b128 v[104:107], v22 offset:4096
    v_mfma_f32_32x32x16_bf16 v[208:223], v[132:135], v[124:127], v[208:223]
    ds_read_b64_tr_b16 v[112:113], v36 offset:12288
    ds_read_b64_tr_b16 v[114:115], v36 offset:12800
    s_waitcnt lgkmcnt(6)
    v_mfma_f32_32x32x16_bf16 v[224:239], v[120:123], v[136:139], v[224:239]
    ds_read_b64_tr_b16 v[116:117], v36 offset:20480
    v_add_u32 v22, s51, v22
    v_mfma_f32_32x32x16_bf16 v[240:255], v[124:127], v[136:139], v[240:255]
    ds_read_b64_tr_b16 v[118:119], v36 offset:20992
    s_waitcnt lgkmcnt(5)
    v_mfma_f32_32x32x16_bf16 v[160:175], v[108:111], v[100:103], v[160:175]
    ds_read_b128 v[120:123], v23
    ds_read_b64_tr_b16 v[128:129], v36 offset:6144
    ds_read_b64_tr_b16 v[130:131], v36 offset:6656
    s_waitcnt lgkmcnt(7)
    v_mfma_f32_32x32x16_bf16 v[176:191], v[108:111], v[104:107], v[176:191]
    ds_read_b128 v[124:127], v23 offset:4096
    ds_read_b64_tr_b16 v[132:133], v36 offset:14336
    ds_read_b64_tr_b16 v[134:135], v36 offset:14848
    s_waitcnt lgkmcnt(8)
    v_mfma_f32_32x32x16_bf16 v[192:207], v[112:115], v[100:103], v[192:207]
    ds_read_b64_tr_b16 v[136:137], v36 offset:22528
    ds_read_b64_tr_b16 v[138:139], v36 offset:23040
    v_mfma_f32_32x32x16_bf16 v[208:223], v[112:115], v[104:107], v[208:223]
    s_waitcnt lgkmcnt(8)
    v_mfma_f32_32x32x16_bf16 v[224:239], v[100:103], v[116:119], v[224:239]
    v_add_u32 v23, s51, v23
    v_mfma_f32_32x32x16_bf16 v[240:255], v[104:107], v[116:119], v[240:255]
    v_add_u32 v36, s50, v36
    s_waitcnt lgkmcnt(0)
    v_mfma_f32_32x32x16_bf16 v[160:175], v[128:131], v[120:123], v[160:175]
    s_barrier
    ds_read_b128 v[100:103], v20
    ds_read_b64_tr_b16 v[108:109], v36 offset:0
    ds_read_b64_tr_b16 v[110:111], v36 offset:512
    v_mfma_f32_32x32x16_bf16 v[176:191], v[128:131], v[124:127], v[176:191]
    ds_read_b128 v[104:107], v20 offset:4096
    ds_read_b64_tr_b16 v[112:113], v36 offset:8192
    ds_read_b64_tr_b16 v[114:115], v36 offset:8704
    v_mfma_f32_32x32x16_bf16 v[192:207], v[132:135], v[120:123], v[192:207]
    ds_read_b64_tr_b16 v[116:117], v36 offset:16384
    ds_read_b64_tr_b16 v[118:119], v36 offset:16896
    v_mfma_f32_32x32x16_bf16 v[208:223], v[132:135], v[124:127], v[208:223]
    v_mfma_f32_32x32x16_bf16 v[224:239], v[120:123], v[136:139], v[224:239]
    s_add_u32 s48, s48, 1
    s_cmp_lt_u32 s48, 11
    v_mfma_f32_32x32x16_bf16 v[240:255], v[124:127], v[136:139], v[240:255]
    s_cbranch_scc1 L_c_loop
    s_waitcnt lgkmcnt(2)
.p2align 3
L_c_loop2:
    s_add_u32 s49, s49, 1
    s_cmp_eq_u32 s49, 3
    s_mov_b32 s50, 40960
    s_cselect_b32 s50, 4294885376, s50
    s_cselect_b32 s49, 0, s49
    s_mov_b32 s51, s64
    s_mov_b32 s64, s65
    s_mov_b32 s65, s66
    s_mov_b32 s66, s67
    s_waitcnt lgkmcnt(3)
    v_mfma_f32_32x32x16_bf16 v[192:207], v[112:115], v[100:103], v[192:207]
    ds_read_b128 v[120:123], v21
    ds_read_b64_tr_b16 v[132:133], v36 offset:10240
    s_waitcnt lgkmcnt(4)
    v_mfma_f32_32x32x16_bf16 v[208:223], v[112:115], v[104:107], v[208:223]
    ds_read_b64_tr_b16 v[134:135], v36 offset:10752
    ds_read_b128 v[124:127], v21 offset:4096
    s_waitcnt lgkmcnt(4)
    v_mfma_f32_32x32x16_bf16 v[224:239], v[100:103], v[116:119], v[224:239]
    ds_read_b64_tr_b16 v[136:137], v36 offset:18432
    v_add_u32 v21, s51, v21
    v_mfma_f32_32x32x16_bf16 v[240:255], v[104:107], v[116:119], v[240:255]
    ds_read_b64_tr_b16 v[138:139], v36 offset:18944
    v_add_u32 v20, s51, v20
    s_waitcnt lgkmcnt(3)
    v_mfma_f32_32x32x16_bf16 v[192:207], v[132:135], v[120:123], v[192:207]
    ds_read_b128 v[100:103], v22
    ds_read_b64_tr_b16 v[112:113], v36 offset:12288
    s_waitcnt lgkmcnt(4)
    v_mfma_f32_32x32x16_bf16 v[208:223], v[132:135], v[124:127], v[208:223]
    ds_read_b64_tr_b16 v[114:115], v36 offset:12800
    ds_read_b128 v[104:107], v22 offset:4096
    s_waitcnt lgkmcnt(4)
    v_mfma_f32_32x32x16_bf16 v[224:239], v[120:123], v[136:139], v[224:239]
    ds_read_b64_tr_b16 v[116:117], v36 offset:20480
    v_add_u32 v22, s51, v22
    v_mfma_f32_32x32x16_bf16 v[240:255], v[124:127], v[136:139], v[240:255]
    ds_read_b64_tr_b16 v[118:119], v36 offset:20992
    s_waitcnt lgkmcnt(3)
    v_mfma_f32_32x32x16_bf16 v[192:207], v[112:115], v[100:103], v[192:207]
    ds_read_b128 v[120:123], v23
    ds_read_b64_tr_b16 v[132:133], v36 offset:14336
    ds_read_b64_tr_b16 v[134:135], v36 offset:14848
    s_waitcnt lgkmcnt(5)
    v_mfma_f32_32x32x16_bf16 v[208:223], v[112:115], v[104:107], v[208:223]
    ds_read_b128 v[124:127], v23 offset:4096
    ds_read_b64_tr_b16 v[136:137], v36 offset:22528
    ds_read_b64_tr_b16 v[138:139], v36 offset:23040
    s_waitcnt lgkmcnt(6)
    v_mfma_f32_32x32x16_bf16 v[224:239], v[100:103], v[116:119], v[224:239]
    v_add_u32 v23, s51, v23
    v_mfma_f32_32x32x16_bf16 v[240:255], v[104:107], v[116:119], v[240:255]
    v_add_u32 v36, s50, v36
    s_waitcnt lgkmcnt(0)
    v_mfma_f32_32x32x16_bf16 v[192:207], v[132:135], v[120:123], v[192:207]
    s_barrier
    ds_read_b128 v[100:103], v20
    ds_read_b64_tr_b16 v[112:113], v36 offset:8192
    ds_read_b64_tr_b16 v[114:115], v36 offset:8704
    v_mfma_f32_32x32x16_bf16 v[208:223], v[132:135], v[124:127], v[208:223]
    ds_read_b128 v[104:107], v20 offset:4096
    ds_read_b64_tr_b16 v[116:117], v36 offset:16384
    ds_read_b64_tr_b16 v[118:119], v36 offset:16896
    v_mfma_f32_32x32x16_bf16 v[224:239], v[120:123], v[136:139], v[224:239]
    s_add_u32 s48, s48, 1
    s_cmp_lt_u32 s48, 15
    v_mfma_f32_32x32x16_bf16 v[240:255], v[124:127], v[136:139], v[240:255]
    s_cbranch_scc1 L_c_loop2
    s_waitcnt lgkmcnt(3)
    v_mfma_f32_32x32x16_bf16 v[192:207], v[112:115], v[100:103], v[192:207]
    ds_read_b128 v[120:123], v21
    ds_read_b64_tr_b16 v[132:133], v36 offset:10240
    s_waitcnt lgkmcnt(4)
    v_mfma_f32_32x32x16_bf16 v[208:223], v[112:115], v[104:107], v[208:223]
    ds_read_b64_tr_b16 v[134:135], v36 offset:10752
    ds_read_b128 v[124:127], v21 offset:4096
    s_waitcnt lgkmcnt(4)
    v_mfma_f32_32x32x16_bf16 v[224:239], v[100:103], v[116:119], v[224:239]
    ds_read_b64_tr_b16 v[136:137], v36 offset:18432
    v_mfma_f32_32x32x16_bf16 v[240:255], v[104:107], v[116:119], v[240:255]
    ds_read_b64_tr_b16 v[138:139], v36 offset:18944
    s_waitcnt lgkmcnt(3)
    v_mfma_f32_32x32x16_bf16 v[192:207], v[132:135], v[120:123], v[192:207]
    ds_read_b128 v[100:103], v22
    ds_read_b64_tr_b16 v[112:113], v36 offset:12288
    s_waitcnt lgkmcnt(4)
    v_mfma_f32_32x32x16_bf16 v[208:223], v[132:135], v[124:127], v[208:223]
    ds_read_b64_tr_b16 v[114:115], v36 offset:12800
    ds_read_b128 v[104:107], v22 offset:4096
    s_waitcnt lgkmcnt(4)
    v_mfma_f32_32x32x16_bf16 v[224:239], v[120:123], v[136:139], v[224:239]
    ds_read_b64_tr_b16 v[116:117], v36 offset:20480
    v_mfma_f32_32x32x16_bf16 v[240:255], v[124:127], v[136:139], v[240:255]
    ds_read_b64_tr_b16 v[118:119], v36 offset:20992
    s_waitcnt lgkmcnt(3)
    v_mfma_f32_32x32x16_bf16 v[192:207], v[112:115], v[100:103], v[192:207]
    ds_read_b128 v[120:123], v23
    ds_read_b64_tr_b16 v[132:133], v36 offset:14336
    ds_read_b64_tr_b16 v[134:135], v36 offset:14848
    s_waitcnt lgkmcnt(5)
    v_mfma_f32_32x32x16_bf16 v[208:223], v[112:115], v[104:107], v[208:223]
    ds_read_b128 v[124:127], v23 offset:4096
    ds_read_b64_tr_b16 v[136:137], v36 offset:22528
    ds_read_b64_tr_b16 v[138:139], v36 offset:23040
    s_waitcnt lgkmcnt(6)
    v_mfma_f32_32x32x16_bf16 v[224:239], v[100:103], v[116:119], v[224:239]
    v_mfma_f32_32x32x16_bf16 v[240:255], v[104:107], v[116:119], v[240:255]
    s_waitcnt lgkmcnt(0)
    v_mfma_f32_32x32x16_bf16 v[192:207], v[132:135], v[120:123], v[192:207]
    s_mov_b64 exec, 1
    ds_write_b32 v17, v15
    s_mov_b64 exec, -1
    ds_read_b64_tr_b16 v[40:41], v12 offset:0
    ds_read_b64_tr_b16 v[42:43], v12 offset:512
    ds_read_b64_tr_b16 v[44:45], v12 offset:1024
    ds_read_b64_tr_b16 v[46:47], v12 offset:1536
    v_mov_b32 v16, 162864
    ds_read_b96 v[24:26], v16
    v_mfma_f32_32x32x16_bf16 v[208:223], v[132:135], v[124:127], v[208:223]
    v_mfma_f32_32x32x16_bf16 v[224:239], v[120:123], v[136:139], v[224:239]
    v_mfma_f32_32x32x16_bf16 v[240:255], v[124:127], v[136:139], v[240:255]
L_c_ta:
    s_mov_b32 s48, 0x3fb8aa3b
    s_mov_b32 s52, 0xbfb8aa3b
    v_cvt_pk_bf16_f32 v64, v192, v193
    v_cvt_pk_bf16_f32 v65, v194, v195
    v_cvt_pk_bf16_f32 v66, v196, v197
    v_cvt_pk_bf16_f32 v67, v198, v199
    v_cvt_pk_bf16_f32 v68, v200, v201
    v_cvt_pk_bf16_f32 v69, v202, v203
    v_cvt_pk_bf16_f32 v70, v204, v205
    v_cvt_pk_bf16_f32 v71, v206, v207
    s_waitcnt lgkmcnt(0)
    v_mfma_f32_32x32x16_bf16 v[192:207], v[40:43], v[64:67], 0
    v_mfma_f32_32x32x16_bf16 v[192:207], v[44:47], v[68:71], v[192:207]
    v_cvt_pk_bf16_f32 v72, v208, v209
    v_cvt_pk_bf16_f32 v73, v210, v211
    v_cvt_pk_bf16_f32 v74, v212, v213
    v_cvt_pk_bf16_f32 v75, v214, v215
    v_cvt_pk_bf16_f32 v76, v216, v217
    v_cvt_pk_bf16_f32 v77, v218, v219
    v_cvt_pk_bf16_f32 v78, v220, v221
    v_cvt_pk_bf16_f32 v79, v222, v223
    v_mfma_f32_32x32x16_bf16 v[208:223], v[40:43], v[72:75], 0
    s_nop 0
    v_mfma_f32_32x32x16_bf16 v[208:223], v[44:47], v[76:79], v[208:223]
    v_readfirstlane_b32 s72, v24
    v_readfirstlane_b32 s73, v25
    v_readfirstlane_b32 s74, v26
    v_and_b32 v27, 3, v2
    v_lshlrev_b32 v27, 3, v27
    v_bfe_u32 v27, v26, v27, 8
    v_mov_b32 v28, 0xffffff00
    s_and_b32 s76, s74, 0xff
    s_bfe_u32 s77, s74, 0x80008
    s_bfe_u32 s78, s74, 0x80010
    s_lshr_b32 s79, s74, 24
    v_cvt_pk_bf16_f32 v80, v224, v225
    v_cvt_pk_bf16_f32 v81, v226, v227
    v_cvt_pk_bf16_f32 v82, v228, v229
    v_cvt_pk_bf16_f32 v83, v230, v231
    v_cvt_pk_bf16_f32 v84, v232, v233
    v_cvt_pk_bf16_f32 v85, v234, v235
    v_cvt_pk_bf16_f32 v86, v236, v237
    v_cvt_pk_bf16_f32 v87, v238, v239
    v_cvt_pk_bf16_f32 v88, v240, v241
    v_cvt_pk_bf16_f32 v89, v242, v243
    v_cvt_pk_bf16_f32 v90, v244, v245
    v_cvt_pk_bf16_f32 v91, v246, v247
    v_cvt_pk_bf16_f32 v92, v248, v249
    v_cvt_pk_bf16_f32 v93, v250, v251
    v_cvt_pk_bf16_f32 v94, v252, v253
    v_cvt_pk_bf16_f32 v95, v254, v255
    v_cvt_pk_bf16_f32 v64, v192, v193
    v_cvt_pk_bf16_f32 v65, v194, v195
    v_cvt_pk_bf16_f32 v66, v196, v197
    v_cvt_pk_bf16_f32 v67, v198, v199
    v_cvt_pk_bf16_f32 v68, v200, v201
    v_cvt_pk_bf16_f32 v69, v202, v203
    v_cvt_pk_bf16_f32 v70, v204, v205
    v_cvt_pk_bf16_f32 v71, v206, v207
    v_lshlrev_b32 v192, 16, v64
    v_and_b32 v193, 0xffff0000, v64
    v_lshlrev_b32 v194, 16, v65
    v_and_b32 v195, 0xffff0000, v65
    v_lshlrev_b32 v196, 16, v66
    v_and_b32 v197, 0xffff0000, v66
    v_lshlrev_b32 v198, 16, v67
    v_and_b32 v199, 0xffff0000, v67
    v_lshlrev_b32 v200, 16, v68
    v_and_b32 v201, 0xffff0000, v68
    v_lshlrev_b32 v202, 16, v69
    v_and_b32 v203, 0xffff0000, v69
    v_lshlrev_b32 v204, 16, v70
    v_and_b32 v205, 0xffff0000, v70
    v_lshlrev_b32 v206, 16, v71
    v_and_b32 v207, 0xffff0000, v71
    v_max3_f32 v144, v192, v193, v194
    v_max3_f32 v145, v195, v196, v197
    v_max3_f32 v146, v198, v199, v200
    v_max3_f32 v147, v201, v202, v203
    v_max3_f32 v148, v204, v205, v206
    v_max3_f32 v144, v144, v145, v207
    v_max3_f32 v146, v146, v147, v148
    v_max_f32 v144, v144, v146
    v_min3_f32 v150, v192, v193, v194
    v_min3_f32 v151, v195, v196, v197
    v_min3_f32 v152, v198, v199, v200
    v_min3_f32 v153, v201, v202, v203
    v_min3_f32 v154, v204, v205, v206
    v_min3_f32 v150, v150, v151, v207
    v_min3_f32 v152, v152, v153, v154
    v_min_f32 v150, v150, v152
    v_mov_b32 v145, v144
    v_mov_b32 v151, v150
    s_nop 0
    v_permlane32_swap_b32 v144, v145
    v_permlane32_swap_b32 v150, v151
    v_max_f32 v144, v144, v145
    v_min_f32 v150, v150, v151
    v_mul_f32 v144, s52, v144
    v_mul_f32 v150, s48, v150
    v_pk_fma_f32 v[224:225], v[192:193], s[48:49], v[144:145] op_sel_hi:[1,0,0]
    v_pk_fma_f32 v[112:113], v[192:193], s[52:53], v[150:151] op_sel_hi:[1,0,0]
    v_pk_fma_f32 v[226:227], v[194:195], s[48:49], v[144:145] op_sel_hi:[1,0,0]
    v_pk_fma_f32 v[114:115], v[194:195], s[52:53], v[150:151] op_sel_hi:[1,0,0]
    v_pk_fma_f32 v[228:229], v[196:197], s[48:49], v[144:145] op_sel_hi:[1,0,0]
    v_pk_fma_f32 v[116:117], v[196:197], s[52:53], v[150:151] op_sel_hi:[1,0,0]
    v_pk_fma_f32 v[230:231], v[198:199], s[48:49], v[144:145] op_sel_hi:[1,0,0]
    v_pk_fma_f32 v[118:119], v[198:199], s[52:53], v[150:151] op_sel_hi:[1,0,0]
    v_pk_fma_f32 v[232:233], v[200:201], s[48:49], v[144:145] op_sel_hi:[1,0,0]
    v_pk_fma_f32 v[120:121], v[200:201], s[52:53], v[150:151] op_sel_hi:[1,0,0]
    v_pk_fma_f32 v[234:235], v[202:203], s[48:49], v[144:145] op_sel_hi:[1,0,0]
    v_pk_fma_f32 v[122:123], v[202:203], s[52:53], v[150:151] op_sel_hi:[1,0,0]
    v_pk_fma_f32 v[236:237], v[204:205], s[48:49], v[144:145] op_sel_hi:[1,0,0]
    v_pk_fma_f32 v[124:125], v[204:205], s[52:53], v[150:151] op_sel_hi:[1,0,0]
    v_pk_fma_f32 v[238:239], v[206:207], s[48:49], v[144:145] op_sel_hi:[1,0,0]
    v_pk_fma_f32 v[126:127], v[206:207], s[52:53], v[150:151] op_sel_hi:[1,0,0]
    v_exp_f32 v224, v224
    v_exp_f32 v112, v112
    v_exp_f32 v225, v225
    v_exp_f32 v113, v113
    v_exp_f32 v226, v226
    v_exp_f32 v114, v114
    v_exp_f32 v227, v227
    v_exp_f32 v115, v115
    v_exp_f32 v228, v228
    v_exp_f32 v116, v116
    v_exp_f32 v229, v229
    v_exp_f32 v117, v117
    v_exp_f32 v230, v230
    v_exp_f32 v118, v118
    v_exp_f32 v231, v231
    v_exp_f32 v119, v119
    v_exp_f32 v232, v232
    v_exp_f32 v120, v120
    v_exp_f32 v233, v233
    v_exp_f32 v121, v121
    v_exp_f32 v234, v234
    v_exp_f32 v122, v122
    v_exp_f32 v235, v235
    v_exp_f32 v123, v123
    v_exp_f32 v236, v236
    v_exp_f32 v124, v124
    v_exp_f32 v237, v237
    v_exp_f32 v125, v125
    v_exp_f32 v238, v238
    v_exp_f32 v126, v126
    v_exp_f32 v239, v239
    v_exp_f32 v127, v127
    v_pk_add_f32 v[144:145], v[224:225], v[226:227]
    v_pk_add_f32 v[146:147], v[228:229], v[230:231]
    v_pk_add_f32 v[148:149], v[232:233], v[234:235]
    v_pk_add_f32 v[150:151], v[112:113], v[114:115]
    v_pk_add_f32 v[152:153], v[116:117], v[118:119]
    v_pk_add_f32 v[154:155], v[120:121], v[122:123]
    v_pk_add_f32 v[144:145], v[144:145], v[236:237]
    v_pk_add_f32 v[146:147], v[146:147], v[238:239]
    v_pk_add_f32 v[150:151], v[150:151], v[124:125]
    v_pk_add_f32 v[152:153], v[152:153], v[126:127]
    v_pk_add_f32 v[144:145], v[144:145], v[148:149]
    v_pk_add_f32 v[150:151], v[150:151], v[154:155]
    v_pk_add_f32 v[144:145], v[144:145], v[146:147]
    v_pk_add_f32 v[150:151], v[150:151], v[152:153]
    v_add_f32 v144, v144, v145
    v_add_f32 v150, v150, v151
    v_mov_b32 v145, v144
    v_mov_b32 v151, v150
    s_nop 0
    v_permlane32_swap_b32 v144, v145
    v_permlane32_swap_b32 v150, v151
    v_add_f32 v144, v144, v145
    v_add_f32 v150, v150, v151
    v_rcp_f32 v144, v144
    v_rcp_f32 v150, v150
    v_pk_mul_f32 v[224:225], v[224:225], v[144:145] op_sel_hi:[1,0]
    v_pk_mul_f32 v[112:113], v[112:113], v[150:151] op_sel_hi:[1,0]
    v_pk_mul_f32 v[226:227], v[226:227], v[144:145] op_sel_hi:[1,0]
    v_pk_mul_f32 v[114:115], v[114:115], v[150:151] op_sel_hi:[1,0]
    v_pk_mul_f32 v[228:229], v[228:229], v[144:145] op_sel_hi:[1,0]
    v_pk_mul_f32 v[116:117], v[116:117], v[150:151] op_sel_hi:[1,0]
    v_pk_mul_f32 v[230:231], v[230:231], v[144:145] op_sel_hi:[1,0]
    v_pk_mul_f32 v[118:119], v[118:119], v[150:151] op_sel_hi:[1,0]
    v_pk_mul_f32 v[232:233], v[232:233], v[144:145] op_sel_hi:[1,0]
    v_pk_mul_f32 v[120:121], v[120:121], v[150:151] op_sel_hi:[1,0]
    v_pk_mul_f32 v[234:235], v[234:235], v[144:145] op_sel_hi:[1,0]
    v_pk_mul_f32 v[122:123], v[122:123], v[150:151] op_sel_hi:[1,0]
    v_pk_mul_f32 v[236:237], v[236:237], v[144:145] op_sel_hi:[1,0]
    v_pk_mul_f32 v[124:125], v[124:125], v[150:151] op_sel_hi:[1,0]
    v_pk_mul_f32 v[238:239], v[238:239], v[144:145] op_sel_hi:[1,0]
    v_pk_mul_f32 v[126:127], v[126:127], v[150:151] op_sel_hi:[1,0]
    v_cvt_pk_bf16_f32 v64, v224, v225
    v_cvt_pk_bf16_f32 v96, v112, v113
    v_cvt_pk_bf16_f32 v65, v226, v227
    v_cvt_pk_bf16_f32 v97, v114, v115
    v_cvt_pk_bf16_f32 v66, v228, v229
    v_cvt_pk_bf16_f32 v98, v116, v117
    v_cvt_pk_bf16_f32 v67, v230, v231
    v_cvt_pk_bf16_f32 v99, v118, v119
    v_cvt_pk_bf16_f32 v68, v232, v233
    v_cvt_pk_bf16_f32 v100, v120, v121
    v_cvt_pk_bf16_f32 v69, v234, v235
    v_cvt_pk_bf16_f32 v101, v122, v123
    v_cvt_pk_bf16_f32 v70, v236, v237
    v_cvt_pk_bf16_f32 v102, v124, v125
    v_cvt_pk_bf16_f32 v71, v238, v239
    v_cvt_pk_bf16_f32 v103, v126, v127
    v_mfma_f32_32x32x16_bf16 v[192:207], v[64:67], v[48:51], 0
    v_cvt_pk_bf16_f32 v72, v208, v209
    v_cvt_pk_bf16_f32 v73, v210, v211
    v_cvt_pk_bf16_f32 v74, v212, v213
    v_cvt_pk_bf16_f32 v75, v214, v215
    v_cvt_pk_bf16_f32 v76, v216, v217
    v_cvt_pk_bf16_f32 v77, v218, v219
    v_cvt_pk_bf16_f32 v78, v220, v221
    v_mfma_f32_32x32x16_bf16 v[192:207], v[68:71], v[52:55], v[192:207]
    v_cvt_pk_bf16_f32 v79, v222, v223
    v_lshlrev_b32 v208, 16, v72
    v_and_b32 v209, 0xffff0000, v72
    v_lshlrev_b32 v210, 16, v73
    v_and_b32 v211, 0xffff0000, v73
    v_lshlrev_b32 v212, 16, v74
    v_and_b32 v213, 0xffff0000, v74
    v_mfma_f32_32x32x16_bf16 v[224:239], v[96:99], v[48:51], 0
    v_lshlrev_b32 v214, 16, v75
    v_and_b32 v215, 0xffff0000, v75
    v_lshlrev_b32 v216, 16, v76
    v_and_b32 v217, 0xffff0000, v76
    v_lshlrev_b32 v218, 16, v77
    v_and_b32 v219, 0xffff0000, v77
    v_lshlrev_b32 v220, 16, v78
    v_mfma_f32_32x32x16_bf16 v[224:239], v[100:103], v[52:55], v[224:239]
    v_and_b32 v221, 0xffff0000, v78
    v_lshlrev_b32 v222, 16, v79
    v_and_b32 v223, 0xffff0000, v79
    v_max3_f32 v144, v208, v209, v210
    v_max3_f32 v145, v211, v212, v213
    v_max3_f32 v146, v214, v215, v216
    v_max3_f32 v147, v217, v218, v219
    v_max3_f32 v148, v220, v221, v222
    v_max3_f32 v144, v144, v145, v223
    v_max3_f32 v146, v146, v147, v148
    v_max_f32 v144, v144, v146
    v_min3_f32 v150, v208, v209, v210
    v_min3_f32 v151, v211, v212, v213
    v_min3_f32 v152, v214, v215, v216
    v_min3_f32 v153, v217, v218, v219
    v_min3_f32 v154, v220, v221, v222
    v_min3_f32 v150, v150, v151, v223
    v_min3_f32 v152, v152, v153, v154
    v_min_f32 v150, v150, v152
    v_mov_b32 v145, v144
    v_mov_b32 v151, v150
    s_nop 0
    v_permlane32_swap_b32 v144, v145
    v_permlane32_swap_b32 v150, v151
    v_max_f32 v144, v144, v145
    v_min_f32 v150, v150, v151
    v_mul_f32 v144, s52, v144
    v_mul_f32 v150, s48, v150
    v_pk_fma_f32 v[240:241], v[208:209], s[48:49], v[144:145] op_sel_hi:[1,0,0]
    v_pk_fma_f32 v[128:129], v[208:209], s[52:53], v[150:151] op_sel_hi:[1,0,0]
    v_pk_fma_f32 v[242:243], v[210:211], s[48:49], v[144:145] op_sel_hi:[1,0,0]
    v_pk_fma_f32 v[130:131], v[210:211], s[52:53], v[150:151] op_sel_hi:[1,0,0]
    v_pk_fma_f32 v[244:245], v[212:213], s[48:49], v[144:145] op_sel_hi:[1,0,0]
    v_pk_fma_f32 v[132:133], v[212:213], s[52:53], v[150:151] op_sel_hi:[1,0,0]
    v_pk_fma_f32 v[246:247], v[214:215], s[48:49], v[144:145] op_sel_hi:[1,0,0]
    v_pk_fma_f32 v[134:135], v[214:215], s[52:53], v[150:151] op_sel_hi:[1,0,0]
    v_pk_fma_f32 v[248:249], v[216:217], s[48:49], v[144:145] op_sel_hi:[1,0,0]
    v_pk_fma_f32 v[136:137], v[216:217], s[52:53], v[150:151] op_sel_hi:[1,0,0]
    v_pk_fma_f32 v[250:251], v[218:219], s[48:49], v[144:145] op_sel_hi:[1,0,0]
    v_pk_fma_f32 v[138:139], v[218:219], s[52:53], v[150:151] op_sel_hi:[1,0,0]
    v_pk_fma_f32 v[252:253], v[220:221], s[48:49], v[144:145] op_sel_hi:[1,0,0]
    v_pk_fma_f32 v[140:141], v[220:221], s[52:53], v[150:151] op_sel_hi:[1,0,0]
    v_pk_fma_f32 v[254:255], v[222:223], s[48:49], v[144:145] op_sel_hi:[1,0,0]
    v_pk_fma_f32 v[142:143], v[222:223], s[52:53], v[150:151] op_sel_hi:[1,0,0]
    v_cvt_pk_bf16_f32 v64, v192, v193
    v_cvt_pk_bf16_f32 v65, v194, v195
    v_cvt_pk_bf16_f32 v66, v196, v197
    v_cvt_pk_bf16_f32 v67, v198, v199
    v_cvt_pk_bf16_f32 v68, v200, v201
    v_cvt_pk_bf16_f32 v69, v202, v203
    v_cvt_pk_bf16_f32 v70, v204, v205
    v_cvt_pk_bf16_f32 v71, v206, v207
    v_cvt_pk_bf16_f32 v96, v224, v225
    v_cvt_pk_bf16_f32 v97, v226, v227
    v_cvt_pk_bf16_f32 v98, v228, v229
    v_cvt_pk_bf16_f32 v99, v230, v231
    v_cvt_pk_bf16_f32 v100, v232, v233
    v_cvt_pk_bf16_f32 v101, v234, v235
    v_cvt_pk_bf16_f32 v102, v236, v237
    v_cvt_pk_bf16_f32 v103, v238, v239
    v_mfma_f32_32x32x16_bf16 v[112:127], v[64:67], v[80:83], 0
    v_exp_f32 v240, v240
    v_exp_f32 v128, v128
    v_exp_f32 v241, v241
    v_exp_f32 v129, v129
    v_mfma_f32_32x32x16_bf16 v[112:127], v[68:71], v[84:87], v[112:127]
    v_exp_f32 v242, v242
    v_exp_f32 v130, v130
    v_exp_f32 v243, v243
    v_exp_f32 v131, v131
    v_mfma_f32_32x32x16_bf16 v[192:207], v[96:99], v[80:83], 0
    v_exp_f32 v244, v244
    v_exp_f32 v132, v132
    v_exp_f32 v245, v245
    v_exp_f32 v133, v133
    v_mfma_f32_32x32x16_bf16 v[192:207], v[100:103], v[84:87], v[192:207]
    v_exp_f32 v246, v246
    v_exp_f32 v134, v134
    v_exp_f32 v247, v247
    v_exp_f32 v135, v135
    v_mfma_f32_32x32x16_bf16 v[224:239], v[64:67], v[56:59], 0
    v_exp_f32 v248, v248
    v_exp_f32 v136, v136
    v_exp_f32 v249, v249
    v_exp_f32 v137, v137
    v_mfma_f32_32x32x16_bf16 v[224:239], v[68:71], v[56:59], v[224:239]
    v_exp_f32 v250, v250
    v_exp_f32 v138, v138
    v_exp_f32 v251, v251
    v_exp_f32 v139, v139
    v_mfma_f32_32x32x16_bf16 v[224:239], v[96:99], v[60:63], v[224:239]
    v_exp_f32 v252, v252
    v_exp_f32 v140, v140
    v_exp_f32 v253, v253
    v_exp_f32 v141, v141
    v_mfma_f32_32x32x16_bf16 v[224:239], v[100:103], v[60:63], v[224:239]
    v_exp_f32 v254, v254
    v_exp_f32 v142, v142
    v_exp_f32 v255, v255
    v_exp_f32 v143, v143
    v_pk_add_f32 v[144:145], v[240:241], v[242:243]
    v_pk_add_f32 v[146:147], v[244:245], v[246:247]
    v_pk_add_f32 v[148:149], v[248:249], v[250:251]
    v_pk_add_f32 v[150:151], v[128:129], v[130:131]
    v_pk_add_f32 v[152:153], v[132:133], v[134:135]
    v_pk_add_f32 v[154:155], v[136:137], v[138:139]
    v_pk_add_f32 v[144:145], v[144:145], v[252:253]
    v_pk_add_f32 v[146:147], v[146:147], v[254:255]
    v_pk_add_f32 v[150:151], v[150:151], v[140:141]
    v_pk_add_f32 v[152:153], v[152:153], v[142:143]
    v_pk_add_f32 v[144:145], v[144:145], v[148:149]
    v_pk_add_f32 v[150:151], v[150:151], v[154:155]
    v_pk_add_f32 v[144:145], v[144:145], v[146:147]
    v_pk_add_f32 v[150:151], v[150:151], v[152:153]
    v_add_f32 v144, v144, v145
    v_add_f32 v150, v150, v151
    v_mov_b32 v145, v144
    v_mov_b32 v151, v150
    s_nop 0
    v_permlane32_swap_b32 v144, v145
    v_permlane32_swap_b32 v150, v151
    v_add_f32 v144, v144, v145
    v_add_f32 v150, v150, v151
    v_rcp_f32 v144, v144
    v_rcp_f32 v150, v150
    v_pk_mul_f32 v[240:241], v[240:241], v[144:145] op_sel_hi:[1,0]
    v_pk_mul_f32 v[128:129], v[128:129], v[150:151] op_sel_hi:[1,0]
    v_pk_mul_f32 v[242:243], v[242:243], v[144:145] op_sel_hi:[1,0]
    v_pk_mul_f32 v[130:131], v[130:131], v[150:151] op_sel_hi:[1,0]
    v_pk_mul_f32 v[244:245], v[244:245], v[144:145] op_sel_hi:[1,0]
    v_pk_mul_f32 v[132:133], v[132:133], v[150:151] op_sel_hi:[1,0]
    v_pk_mul_f32 v[246:247], v[246:247], v[144:145] op_sel_hi:[1,0]
    v_pk_mul_f32 v[134:135], v[134:135], v[150:151] op_sel_hi:[1,0]
    v_pk_mul_f32 v[248:249], v[248:249], v[144:145] op_sel_hi:[1,0]
    v_pk_mul_f32 v[136:137], v[136:137], v[150:151] op_sel_hi:[1,0]
    v_pk_mul_f32 v[250:251], v[250:251], v[144:145] op_sel_hi:[1,0]
    v_pk_mul_f32 v[138:139], v[138:139], v[150:151] op_sel_hi:[1,0]
    v_pk_mul_f32 v[252:253], v[252:253], v[144:145] op_sel_hi:[1,0]
    v_pk_mul_f32 v[140:141], v[140:141], v[150:151] op_sel_hi:[1,0]
    v_pk_mul_f32 v[254:255], v[254:255], v[144:145] op_sel_hi:[1,0]
    v_pk_mul_f32 v[142:143], v[142:143], v[150:151] op_sel_hi:[1,0]
    s_cmp_eq_u32 s21, 0
    s_cbranch_scc0 L_c_rw1
    v_cvt_pk_bf16_f32 v104, v128, v129
    v_cvt_pk_bf16_f32 v105, v130, v131
    v_cvt_pk_bf16_f32 v106, v132, v133
    v_cvt_pk_bf16_f32 v107, v134, v135
    v_cvt_pk_bf16_f32 v108, v136, v137
    v_cvt_pk_bf16_f32 v109, v138, v139
    v_cvt_pk_bf16_f32 v110, v140, v141
    v_cvt_pk_bf16_f32 v111, v142, v143
    v_mfma_f32_32x32x16_bf16 v[208:223], v[104:107], v[48:51], 0
    v_cvt_pk_bf16_f32 v72, v240, v241
    v_cvt_pk_bf16_f32 v73, v242, v243
    v_cvt_pk_bf16_f32 v74, v244, v245
    v_cvt_pk_bf16_f32 v75, v246, v247
    v_mfma_f32_32x32x16_bf16 v[208:223], v[108:111], v[52:55], v[208:223]
    v_cvt_pk_bf16_f32 v76, v248, v249
    v_cvt_pk_bf16_f32 v77, v250, v251
    v_cvt_pk_bf16_f32 v78, v252, v253
    v_cvt_pk_bf16_f32 v79, v254, v255
    v_mfma_f32_32x32x16_bf16 v[240:255], v[72:75], v[48:51], 0
    s_nop 0
    v_mfma_f32_32x32x16_bf16 v[240:255], v[76:79], v[52:55], v[240:255]
    s_nop 4
    v_cvt_pk_bf16_f32 v104, v208, v209
    v_cvt_pk_bf16_f32 v105, v210, v211
    v_cvt_pk_bf16_f32 v106, v212, v213
    v_cvt_pk_bf16_f32 v107, v214, v215
    v_cvt_pk_bf16_f32 v108, v216, v217
    v_cvt_pk_bf16_f32 v109, v218, v219
    v_cvt_pk_bf16_f32 v110, v220, v221
    v_cvt_pk_bf16_f32 v111, v222, v223
    v_mfma_f32_32x32x16_bf16 v[192:207], v[104:107], v[88:91], v[192:207]
    v_cvt_pk_bf16_f32 v72, v240, v241
    v_cvt_pk_bf16_f32 v73, v242, v243
    v_cvt_pk_bf16_f32 v74, v244, v245
    v_cvt_pk_bf16_f32 v75, v246, v247
    v_mfma_f32_32x32x16_bf16 v[192:207], v[108:111], v[92:95], v[192:207]
    v_cvt_pk_bf16_f32 v76, v248, v249
    v_cvt_pk_bf16_f32 v77, v250, v251
    v_cvt_pk_bf16_f32 v78, v252, v253
    v_cvt_pk_bf16_f32 v79, v254, v255
    v_mfma_f32_32x32x16_bf16 v[224:239], v[104:107], v[60:63], v[224:239]
    s_nop 0
    v_mfma_f32_32x32x16_bf16 v[224:239], v[108:111], v[60:63], v[224:239]
    s_nop 4
    ds_write_b128 v8, v[192:195] offset:0
    v_mfma_f32_32x32x16_bf16 v[224:239], v[72:75], v[56:59], v[224:239]
    ds_write_b128 v8, v[196:199] offset:1024
    v_mfma_f32_32x32x16_bf16 v[224:239], v[76:79], v[56:59], v[224:239]
    ds_write_b128 v8, v[200:203] offset:2048
    ds_write_b128 v8, v[204:207] offset:3072
    v_mfma_f32_32x32x16_bf16 v[112:127], v[72:75], v[88:91], v[112:127]
    v_mfma_f32_32x32x16_bf16 v[112:127], v[76:79], v[92:95], v[112:127]
    s_mov_b32 exec_lo, s45
    s_mov_b32 exec_hi, s45
    s_nop 5
    ds_write_b128 v10, v[224:227] offset:4096
    ds_write_b128 v10, v[228:231] offset:4128
    ds_write_b128 v10, v[232:235] offset:4160
    ds_write_b128 v10, v[236:239] offset:4192
    ds_write_b32 v13, v15
    s_mov_b64 exec, -1
    s_mov_b32 s13, 0
L_c_x0:
    ds_read_b32 v16, v14
    ds_read_b128 v[128:131], v9 offset:0
    ds_read_b128 v[132:135], v9 offset:1024
    ds_read_b128 v[136:139], v9 offset:2048
    ds_read_b128 v[140:143], v9 offset:3072
    ds_read_b32 v144, v11 offset:4096
    ds_read_b32 v145, v11 offset:4224
    s_add_u32 s13, s13, 1
    s_cmp_ge_u32 s13, 262144
    s_cbranch_scc1 L_c_y0
    s_waitcnt lgkmcnt(6)
    v_cmp_eq_u32 vcc, 1, v16
    s_cbranch_vccz L_c_x0
L_c_y0:
    s_waitcnt lgkmcnt(2)
    v_pk_add_f32 v[112:113], v[112:113], v[128:129]
    v_pk_add_f32 v[114:115], v[114:115], v[130:131]
    v_pk_add_f32 v[116:117], v[116:117], v[132:133]
    v_pk_add_f32 v[118:119], v[118:119], v[134:135]
    v_pk_add_f32 v[120:121], v[120:121], v[136:137]
    v_pk_add_f32 v[122:123], v[122:123], v[138:139]
    v_pk_add_f32 v[124:125], v[124:125], v[140:141]
    v_pk_add_f32 v[126:127], v[126:127], v[142:143]
    v_and_or_b32 v112, v112, v28, v27
    buffer_store_dwordx4 v[112:115], v6, s[32:35], s40 offen offset:0 sc1
    v_and_or_b32 v116, v116, v28, v27
    buffer_store_dwordx4 v[116:119], v6, s[32:35], s40 offen offset:512 sc1
    v_and_or_b32 v120, v120, v28, v27
    buffer_store_dwordx4 v[120:123], v6, s[32:35], s41 offen offset:0 sc1
    v_and_or_b32 v124, v124, v28, v27
    buffer_store_dwordx4 v[124:127], v6, s[32:35], s41 offen offset:512 sc1
    s_branch L_c_zs
L_c_rw1:
    s_nop 1
    v_cvt_pk_bf16_f32 v72, v240, v241
    v_cvt_pk_bf16_f32 v73, v242, v243
    v_cvt_pk_bf16_f32 v74, v244, v245
    v_cvt_pk_bf16_f32 v75, v246, v247
    v_cvt_pk_bf16_f32 v76, v248, v249
    v_cvt_pk_bf16_f32 v77, v250, v251
    v_cvt_pk_bf16_f32 v78, v252, v253
    v_cvt_pk_bf16_f32 v79, v254, v255
    v_mfma_f32_32x32x16_bf16 v[208:223], v[72:75], v[48:51], 0
    v_cvt_pk_bf16_f32 v104, v128, v129
    v_cvt_pk_bf16_f32 v105, v130, v131
    v_cvt_pk_bf16_f32 v106, v132, v133
    v_cvt_pk_bf16_f32 v107, v134, v135
    v_mfma_f32_32x32x16_bf16 v[208:223], v[76:79], v[52:55], v[208:223]
    v_cvt_pk_bf16_f32 v108, v136, v137
    v_cvt_pk_bf16_f32 v109, v138, v139
    v_cvt_pk_bf16_f32 v110, v140, v141
    v_cvt_pk_bf16_f32 v111, v142, v143
    v_mfma_f32_32x32x16_bf16 v[240:255], v[104:107], v[48:51], 0
    s_nop 0
    v_mfma_f32_32x32x16_bf16 v[240:255], v[108:111], v[52:55], v[240:255]
    s_nop 4
    v_cvt_pk_bf16_f32 v72, v208, v209
    v_cvt_pk_bf16_f32 v73, v210, v211
    v_cvt_pk_bf16_f32 v74, v212, v213
    v_cvt_pk_bf16_f32 v75, v214, v215
    v_cvt_pk_bf16_f32 v76, v216, v217
    v_cvt_pk_bf16_f32 v77, v218, v219
    v_cvt_pk_bf16_f32 v78, v220, v221
    v_cvt_pk_bf16_f32 v79, v222, v223
    v_mfma_f32_32x32x16_bf16 v[112:127], v[72:75], v[88:91], v[112:127]
    v_cvt_pk_bf16_f32 v104, v240, v241
    v_cvt_pk_bf16_f32 v105, v242, v243
    v_cvt_pk_bf16_f32 v106, v244, v245
    v_cvt_pk_bf16_f32 v107, v246, v247
    v_mfma_f32_32x32x16_bf16 v[112:127], v[76:79], v[92:95], v[112:127]
    v_cvt_pk_bf16_f32 v108, v248, v249
    v_cvt_pk_bf16_f32 v109, v250, v251
    v_cvt_pk_bf16_f32 v110, v252, v253
    v_cvt_pk_bf16_f32 v111, v254, v255
    v_mfma_f32_32x32x16_bf16 v[224:239], v[72:75], v[56:59], v[224:239]
    s_nop 0
    v_mfma_f32_32x32x16_bf16 v[224:239], v[76:79], v[56:59], v[224:239]
    s_nop 4
    ds_write_b128 v8, v[112:115] offset:0
    v_mfma_f32_32x32x16_bf16 v[224:239], v[104:107], v[60:63], v[224:239]
    ds_write_b128 v8, v[116:119] offset:1024
    v_mfma_f32_32x32x16_bf16 v[224:239], v[108:111], v[60:63], v[224:239]
    ds_write_b128 v8, v[120:123] offset:2048
    ds_write_b128 v8, v[124:127] offset:3072
    v_mfma_f32_32x32x16_bf16 v[192:207], v[104:107], v[88:91], v[192:207]
    v_mfma_f32_32x32x16_bf16 v[192:207], v[108:111], v[92:95], v[192:207]
    s_mov_b32 exec_lo, s45
    s_mov_b32 exec_hi, s45
    s_nop 5
    ds_write_b128 v10, v[224:227] offset:4096
    ds_write_b128 v10, v[228:231] offset:4128
    ds_write_b128 v10, v[232:235] offset:4160
    ds_write_b128 v10, v[236:239] offset:4192
    ds_write_b32 v13, v15
    s_mov_b64 exec, -1
    s_mov_b32 s13, 0
L_c_x1:
    ds_read_b32 v16, v14
    ds_read_b128 v[128:131], v9 offset:0
    ds_read_b128 v[132:135], v9 offset:1024
    ds_read_b128 v[136:139], v9 offset:2048
    ds_read_b128 v[140:143], v9 offset:3072
    ds_read_b32 v144, v11 offset:4096
    ds_read_b32 v145, v11 offset:4224
    s_add_u32 s13, s13, 1
    s_cmp_ge_u32 s13, 262144
    s_cbranch_scc1 L_c_y1
    s_waitcnt lgkmcnt(6)
    v_cmp_eq_u32 vcc, 1, v16
    s_cbranch_vccz L_c_x1
L_c_y1:
    s_waitcnt lgkmcnt(2)
    v_pk_add_f32 v[192:193], v[192:193], v[128:129]
    v_pk_add_f32 v[194:195], v[194:195], v[130:131]
    v_pk_add_f32 v[196:197], v[196:197], v[132:133]
    v_pk_add_f32 v[198:199], v[198:199], v[134:135]
    v_pk_add_f32 v[200:201], v[200:201], v[136:137]
    v_pk_add_f32 v[202:203], v[202:203], v[138:139]
    v_pk_add_f32 v[204:205], v[204:205], v[140:141]
    v_pk_add_f32 v[206:207], v[206:207], v[142:143]
    v_and_or_b32 v192, v192, v28, v27
    buffer_store_dwordx4 v[192:195], v6, s[32:35], s40 offen offset:0 sc1
    v_and_or_b32 v196, v196, v28, v27
    buffer_store_dwordx4 v[196:199], v6, s[32:35], s40 offen offset:512 sc1
    v_and_or_b32 v200, v200, v28, v27
    buffer_store_dwordx4 v[200:203], v6, s[32:35], s41 offen offset:0 sc1
    v_and_or_b32 v204, v204, v28, v27
    buffer_store_dwordx4 v[204:207], v6, s[32:35], s41 offen offset:512 sc1
L_c_zs:
    s_waitcnt lgkmcnt(0)
    v_add_f32 v144, v144, v145
    v_and_or_b32 v144, v144, v28, v27
    s_mov_b32 exec_hi, 0
    buffer_store_dword v144, v7, s[32:35], s42 offen sc1
    s_mov_b32 exec_lo, 1
    ds_write_b32 v13, v15 offset:96
    s_mov_b64 exec, -1
    v_mov_b32 v16, 162960
    s_mov_b32 s13, 0
L_c_wq:
    ds_read_b128 v[64:67], v16
    s_add_u32 s13, s13, 1
    s_cmp_ge_u32 s13, 262144
    s_cbranch_scc1 L_c_wqok
    s_waitcnt lgkmcnt(0)
    v_and_b32 v64, v64, v65
    v_and_b32 v66, v66, v67
    v_and_b32 v64, v64, v66
    v_cmp_eq_u32 vcc, 1, v64
    s_cbranch_vccz L_c_wq
L_c_wqok:
    s_waitcnt lgkmcnt(0)
    v_add_u32 v36, 0x2000, v36
    ds_read_b64_tr_b16 v[72:73], v36 offset:0
    ds_read_b64_tr_b16 v[74:75], v36 offset:512
    ds_read_b128 v[64:67], v20
    ds_read_b128 v[68:71], v20 offset:4096
    ds_read_b64_tr_b16 v[84:85], v36 offset:2048
    ds_read_b64_tr_b16 v[86:87], v36 offset:2560
    ds_read_b128 v[76:79], v21
    ds_read_b128 v[80:83], v21 offset:4096
    ds_read_b64_tr_b16 v[96:97], v36 offset:4096
    ds_read_b64_tr_b16 v[98:99], v36 offset:4608
    ds_read_b128 v[88:91], v22
    ds_read_b128 v[92:95], v22 offset:4096
    s_waitcnt lgkmcnt(9)
    v_mfma_f32_32x32x16_bf16 v[160:175], v[72:75], v[64:67], v[160:175]
    s_waitcnt lgkmcnt(8)
    v_mfma_f32_32x32x16_bf16 v[176:191], v[72:75], v[68:71], v[176:191]
    ds_read_b64_tr_b16 v[108:109], v36 offset:6144
    ds_read_b64_tr_b16 v[110:111], v36 offset:6656
    ds_read_b128 v[100:103], v23
    ds_read_b128 v[104:107], v23 offset:4096
    s_waitcnt lgkmcnt(9)
    v_mfma_f32_32x32x16_bf16 v[160:175], v[84:87], v[76:79], v[160:175]
    s_waitcnt lgkmcnt(8)
    v_mfma_f32_32x32x16_bf16 v[176:191], v[84:87], v[80:83], v[176:191]
    v_add_u32 v20, 0x14000, v20
    v_add_u32 v36, 0xc000, v36
    ds_read_b64_tr_b16 v[72:73], v36 offset:0
    ds_read_b64_tr_b16 v[74:75], v36 offset:512
    ds_read_b128 v[64:67], v20
    ds_read_b128 v[68:71], v20 offset:4096
    s_waitcnt lgkmcnt(9)
    v_mfma_f32_32x32x16_bf16 v[160:175], v[96:99], v[88:91], v[160:175]
    s_waitcnt lgkmcnt(8)
    v_mfma_f32_32x32x16_bf16 v[176:191], v[96:99], v[92:95], v[176:191]
    v_add_u32 v21, 0x14000, v21
    ds_read_b64_tr_b16 v[84:85], v36 offset:2048
    ds_read_b64_tr_b16 v[86:87], v36 offset:2560
    ds_read_b128 v[76:79], v21
    ds_read_b128 v[80:83], v21 offset:4096
    s_waitcnt lgkmcnt(9)
    v_mfma_f32_32x32x16_bf16 v[160:175], v[108:111], v[100:103], v[160:175]
    s_waitcnt lgkmcnt(8)
    v_mfma_f32_32x32x16_bf16 v[176:191], v[108:111], v[104:107], v[176:191]
    v_add_u32 v22, 0x14000, v22
    ds_read_b64_tr_b16 v[96:97], v36 offset:4096
    ds_read_b64_tr_b16 v[98:99], v36 offset:4608
    ds_read_b128 v[88:91], v22
    ds_read_b128 v[92:95], v22 offset:4096
    s_waitcnt lgkmcnt(9)
    v_mfma_f32_32x32x16_bf16 v[160:175], v[72:75], v[64:67], v[160:175]
    s_waitcnt lgkmcnt(8)
    v_mfma_f32_32x32x16_bf16 v[176:191], v[72:75], v[68:71], v[176:191]
    v_add_u32 v23, 0x14000, v23
    ds_read_b64_tr_b16 v[108:109], v36 offset:6144
    ds_read_b64_tr_b16 v[110:111], v36 offset:6656
    ds_read_b128 v[100:103], v23
    ds_read_b128 v[104:107], v23 offset:4096
    s_waitcnt lgkmcnt(9)
    v_mfma_f32_32x32x16_bf16 v[160:175], v[84:87], v[76:79], v[160:175]
    s_waitcnt lgkmcnt(8)
    v_mfma_f32_32x32x16_bf16 v[176:191], v[84:87], v[80:83], v[176:191]
    v_add_u32 v20, 0xffff6000, v20
    v_add_u32 v36, 0xffffe000, v36
    ds_read_b64_tr_b16 v[72:73], v36 offset:0
    ds_read_b64_tr_b16 v[74:75], v36 offset:512
    ds_read_b128 v[64:67], v20
    ds_read_b128 v[68:71], v20 offset:4096
    s_waitcnt lgkmcnt(9)
    v_mfma_f32_32x32x16_bf16 v[160:175], v[96:99], v[88:91], v[160:175]
    s_waitcnt lgkmcnt(8)
    v_mfma_f32_32x32x16_bf16 v[176:191], v[96:99], v[92:95], v[176:191]
    v_add_u32 v21, 0xffff6000, v21
    ds_read_b64_tr_b16 v[84:85], v36 offset:2048
    ds_read_b64_tr_b16 v[86:87], v36 offset:2560
    ds_read_b128 v[76:79], v21
    ds_read_b128 v[80:83], v21 offset:4096
    s_waitcnt lgkmcnt(9)
    v_mfma_f32_32x32x16_bf16 v[160:175], v[108:111], v[100:103], v[160:175]
    s_waitcnt lgkmcnt(8)
    v_mfma_f32_32x32x16_bf16 v[176:191], v[108:111], v[104:107], v[176:191]
    v_add_u32 v22, 0xffff6000, v22
    ds_read_b64_tr_b16 v[96:97], v36 offset:4096
    ds_read_b64_tr_b16 v[98:99], v36 offset:4608
    ds_read_b128 v[88:91], v22
    ds_read_b128 v[92:95], v22 offset:4096
    s_mov_b64 exec, 1
    ds_write_b32 v13, v15 offset:160
    s_mov_b64 exec, -1
    s_waitcnt lgkmcnt(9)
    v_mfma_f32_32x32x16_bf16 v[160:175], v[72:75], v[64:67], v[160:175]
    s_waitcnt lgkmcnt(8)
    v_mfma_f32_32x32x16_bf16 v[176:191], v[72:75], v[68:71], v[176:191]
    v_add_u32 v23, 0xffff6000, v23
    ds_read_b64_tr_b16 v[108:109], v36 offset:6144
    ds_read_b64_tr_b16 v[110:111], v36 offset:6656
    ds_read_b128 v[100:103], v23
    ds_read_b128 v[104:107], v23 offset:4096
    s_waitcnt lgkmcnt(9)
    v_mfma_f32_32x32x16_bf16 v[160:175], v[84:87], v[76:79], v[160:175]
    s_waitcnt lgkmcnt(8)
    v_mfma_f32_32x32x16_bf16 v[176:191], v[84:87], v[80:83], v[176:191]
    v_add_u32 v20, 0x18000, v20
    v_add_u32 v36, 0xffffe000, v36
    ds_read_b64_tr_b16 v[72:73], v36 offset:0
    ds_read_b64_tr_b16 v[74:75], v36 offset:512
    ds_read_b128 v[64:67], v20
    ds_read_b128 v[68:71], v20 offset:4096
    s_waitcnt lgkmcnt(9)
    v_mfma_f32_32x32x16_bf16 v[160:175], v[96:99], v[88:91], v[160:175]
    s_waitcnt lgkmcnt(8)
    v_mfma_f32_32x32x16_bf16 v[176:191], v[96:99], v[92:95], v[176:191]
    v_add_u32 v21, 0x18000, v21
    ds_read_b64_tr_b16 v[84:85], v36 offset:2048
    ds_read_b64_tr_b16 v[86:87], v36 offset:2560
    ds_read_b128 v[76:79], v21
    ds_read_b128 v[80:83], v21 offset:4096
    s_waitcnt lgkmcnt(9)
    v_mfma_f32_32x32x16_bf16 v[160:175], v[108:111], v[100:103], v[160:175]
    s_waitcnt lgkmcnt(8)
    v_mfma_f32_32x32x16_bf16 v[176:191], v[108:111], v[104:107], v[176:191]
    v_add_u32 v22, 0x18000, v22
    ds_read_b64_tr_b16 v[96:97], v36 offset:4096
    ds_read_b64_tr_b16 v[98:99], v36 offset:4608
    ds_read_b128 v[88:91], v22
    ds_read_b128 v[92:95], v22 offset:4096
    s_waitcnt lgkmcnt(9)
    v_mfma_f32_32x32x16_bf16 v[160:175], v[72:75], v[64:67], v[160:175]
    s_waitcnt lgkmcnt(8)
    v_mfma_f32_32x32x16_bf16 v[176:191], v[72:75], v[68:71], v[176:191]
    v_add_u32 v23, 0x18000, v23
    ds_read_b64_tr_b16 v[108:109], v36 offset:6144
    ds_read_b64_tr_b16 v[110:111], v36 offset:6656
    ds_read_b128 v[100:103], v23
    ds_read_b128 v[104:107], v23 offset:4096
    s_waitcnt lgkmcnt(9)
    v_mfma_f32_32x32x16_bf16 v[160:175], v[84:87], v[76:79], v[160:175]
    s_waitcnt lgkmcnt(8)
    v_mfma_f32_32x32x16_bf16 v[176:191], v[84:87], v[80:83], v[176:191]
    v_add_u32 v20, 0xffffc000, v20
    v_add_u32 v36, 0xffff6000, v36
    ds_read_b64_tr_b16 v[72:73], v36 offset:0
    ds_read_b64_tr_b16 v[74:75], v36 offset:512
    ds_read_b128 v[64:67], v20
    ds_read_b128 v[68:71], v20 offset:4096
    s_waitcnt lgkmcnt(9)
    v_mfma_f32_32x32x16_bf16 v[160:175], v[96:99], v[88:91], v[160:175]
    s_waitcnt lgkmcnt(8)
    v_mfma_f32_32x32x16_bf16 v[176:191], v[96:99], v[92:95], v[176:191]
    v_add_u32 v21, 0xffffc000, v21
    ds_read_b64_tr_b16 v[84:85], v36 offset:2048
    ds_read_b64_tr_b16 v[86:87], v36 offset:2560
    ds_read_b128 v[76:79], v21
    ds_read_b128 v[80:83], v21 offset:4096
    s_waitcnt lgkmcnt(9)
    v_mfma_f32_32x32x16_bf16 v[160:175], v[108:111], v[100:103], v[160:175]
    s_waitcnt lgkmcnt(8)
    v_mfma_f32_32x32x16_bf16 v[176:191], v[108:111], v[104:107], v[176:191]
    v_add_u32 v22, 0xffffc000, v22
    ds_read_b64_tr_b16 v[96:97], v36 offset:4096
    ds_read_b64_tr_b16 v[98:99], v36 offset:4608
    ds_read_b128 v[88:91], v22
    ds_read_b128 v[92:95], v22 offset:4096
    s_waitcnt lgkmcnt(9)
    v_mfma_f32_32x32x16_bf16 v[160:175], v[72:75], v[64:67], v[160:175]
    s_waitcnt lgkmcnt(8)
    v_mfma_f32_32x32x16_bf16 v[176:191], v[72:75], v[68:71], v[176:191]
    v_add_u32 v23, 0xffffc000, v23
    ds_read_b64_tr_b16 v[108:109], v36 offset:6144
    ds_read_b64_tr_b16 v[110:111], v36 offset:6656
    ds_read_b128 v[100:103], v23
    ds_read_b128 v[104:107], v23 offset:4096
    s_waitcnt lgkmcnt(9)
    v_mfma_f32_32x32x16_bf16 v[160:175], v[84:87], v[76:79], v[160:175]
    s_waitcnt lgkmcnt(8)
    v_mfma_f32_32x32x16_bf16 v[176:191], v[84:87], v[80:83], v[176:191]
    s_waitcnt lgkmcnt(5)
    v_mfma_f32_32x32x16_bf16 v[160:175], v[96:99], v[88:91], v[160:175]
    s_waitcnt lgkmcnt(4)
    v_mfma_f32_32x32x16_bf16 v[176:191], v[96:99], v[92:95], v[176:191]
    s_waitcnt lgkmcnt(1)
    v_mfma_f32_32x32x16_bf16 v[160:175], v[108:111], v[100:103], v[160:175]
    s_waitcnt lgkmcnt(0)
    v_mfma_f32_32x32x16_bf16 v[176:191], v[108:111], v[104:107], v[176:191]
    s_mov_b64 exec, 1
    ds_write_b32 v13, v15 offset:144
    s_mov_b64 exec, -1
    s_nop 6
    v_cvt_pk_bf16_f32 v64, v160, v161
    v_cvt_pk_bf16_f32 v65, v162, v163
    v_cvt_pk_bf16_f32 v66, v164, v165
    v_cvt_pk_bf16_f32 v67, v166, v167
    v_cvt_pk_bf16_f32 v68, v168, v169
    v_cvt_pk_bf16_f32 v69, v170, v171
    v_cvt_pk_bf16_f32 v70, v172, v173
    v_cvt_pk_bf16_f32 v71, v174, v175
    v_mfma_f32_32x32x16_bf16 v[160:175], v[40:43], v[64:67], 0
    s_nop 0
    v_mfma_f32_32x32x16_bf16 v[160:175], v[44:47], v[68:71], v[160:175]
    v_cvt_pk_bf16_f32 v72, v176, v177
    v_cvt_pk_bf16_f32 v73, v178, v179
    v_cvt_pk_bf16_f32 v74, v180, v181
    v_cvt_pk_bf16_f32 v75, v182, v183
    v_cvt_pk_bf16_f32 v76, v184, v185
    v_cvt_pk_bf16_f32 v77, v186, v187
    v_cvt_pk_bf16_f32 v78, v188, v189
    v_cvt_pk_bf16_f32 v79, v190, v191
    v_mfma_f32_32x32x16_bf16 v[176:191], v[40:43], v[72:75], 0
    s_nop 0
    v_mfma_f32_32x32x16_bf16 v[176:191], v[44:47], v[76:79], v[176:191]
    s_nop 0
    v_cvt_pk_bf16_f32 v64, v160, v161
    v_cvt_pk_bf16_f32 v65, v162, v163
    v_cvt_pk_bf16_f32 v66, v164, v165
    v_cvt_pk_bf16_f32 v67, v166, v167
    v_cvt_pk_bf16_f32 v68, v168, v169
    v_cvt_pk_bf16_f32 v69, v170, v171
    v_cvt_pk_bf16_f32 v70, v172, v173
    v_cvt_pk_bf16_f32 v71, v174, v175
    v_lshlrev_b32 v160, 16, v64
    v_and_b32 v161, 0xffff0000, v64
    v_lshlrev_b32 v162, 16, v65
    v_and_b32 v163, 0xffff0000, v65
    v_lshlrev_b32 v164, 16, v66
    v_and_b32 v165, 0xffff0000, v66
    v_lshlrev_b32 v166, 16, v67
    v_and_b32 v167, 0xffff0000, v67
    v_lshlrev_b32 v168, 16, v68
    v_and_b32 v169, 0xffff0000, v68
    v_lshlrev_b32 v170, 16, v69
    v_and_b32 v171, 0xffff0000, v69
    v_lshlrev_b32 v172, 16, v70
    v_and_b32 v173, 0xffff0000, v70
    v_lshlrev_b32 v174, 16, v71
    v_and_b32 v175, 0xffff0000, v71
    v_cvt_pk_bf16_f32 v72, v176, v177
    v_cvt_pk_bf16_f32 v73, v178, v179
    v_cvt_pk_bf16_f32 v74, v180, v181
    v_cvt_pk_bf16_f32 v75, v182, v183
    v_cvt_pk_bf16_f32 v76, v184, v185
    v_cvt_pk_bf16_f32 v77, v186, v187
    v_cvt_pk_bf16_f32 v78, v188, v189
    v_cvt_pk_bf16_f32 v79, v190, v191
    v_lshlrev_b32 v176, 16, v72
    v_and_b32 v177, 0xffff0000, v72
    v_lshlrev_b32 v178, 16, v73
    v_and_b32 v179, 0xffff0000, v73
    v_lshlrev_b32 v180, 16, v74
    v_and_b32 v181, 0xffff0000, v74
    v_lshlrev_b32 v182, 16, v75
    v_and_b32 v183, 0xffff0000, v75
    v_lshlrev_b32 v184, 16, v76
    v_and_b32 v185, 0xffff0000, v76
    v_lshlrev_b32 v186, 16, v77
    v_and_b32 v187, 0xffff0000, v77
    v_lshlrev_b32 v188, 16, v78
    v_and_b32 v189, 0xffff0000, v78
    v_lshlrev_b32 v190, 16, v79
    v_and_b32 v191, 0xffff0000, v79
    v_max3_f32 v24, v160, v161, v162
    v_max3_f32 v25, v163, v164, v165
    v_max3_f32 v26, v166, v167, v168
    v_max3_f32 v27, v169, v170, v171
    v_max3_f32 v28, v172, v173, v174
    v_max3_f32 v24, v24, v25, v175
    v_max3_f32 v26, v26, v27, v28
    v_max_f32 v24, v24, v26
    v_min3_f32 v30, v160, v161, v162
    v_min3_f32 v31, v163, v164, v165
    v_min3_f32 v32, v166, v167, v168
    v_min3_f32 v33, v169, v170, v171
    v_min3_f32 v34, v172, v173, v174
    v_min3_f32 v30, v30, v31, v175
    v_min3_f32 v32, v32, v33, v34
    v_min_f32 v30, v30, v32
    v_mov_b32 v25, v24
    v_mov_b32 v31, v30
    s_nop 0
    v_permlane32_swap_b32 v24, v25
    v_permlane32_swap_b32 v30, v31
    v_max_f32 v24, v24, v25
    v_min_f32 v30, v30, v31
    v_mul_f32 v24, s52, v24
    v_mul_f32 v30, s48, v30
    v_pk_fma_f32 v[192:193], v[160:161], s[48:49], v[24:25] op_sel_hi:[1,0,0]
    v_pk_fma_f32 v[224:225], v[160:161], s[52:53], v[30:31] op_sel_hi:[1,0,0]
    v_pk_fma_f32 v[194:195], v[162:163], s[48:49], v[24:25] op_sel_hi:[1,0,0]
    v_pk_fma_f32 v[226:227], v[162:163], s[52:53], v[30:31] op_sel_hi:[1,0,0]
    v_pk_fma_f32 v[196:197], v[164:165], s[48:49], v[24:25] op_sel_hi:[1,0,0]
    v_pk_fma_f32 v[228:229], v[164:165], s[52:53], v[30:31] op_sel_hi:[1,0,0]
    v_pk_fma_f32 v[198:199], v[166:167], s[48:49], v[24:25] op_sel_hi:[1,0,0]
    v_pk_fma_f32 v[230:231], v[166:167], s[52:53], v[30:31] op_sel_hi:[1,0,0]
    v_pk_fma_f32 v[200:201], v[168:169], s[48:49], v[24:25] op_sel_hi:[1,0,0]
    v_pk_fma_f32 v[232:233], v[168:169], s[52:53], v[30:31] op_sel_hi:[1,0,0]
    v_pk_fma_f32 v[202:203], v[170:171], s[48:49], v[24:25] op_sel_hi:[1,0,0]
    v_pk_fma_f32 v[234:235], v[170:171], s[52:53], v[30:31] op_sel_hi:[1,0,0]
    v_pk_fma_f32 v[204:205], v[172:173], s[48:49], v[24:25] op_sel_hi:[1,0,0]
    v_pk_fma_f32 v[236:237], v[172:173], s[52:53], v[30:31] op_sel_hi:[1,0,0]
    v_pk_fma_f32 v[206:207], v[174:175], s[48:49], v[24:25] op_sel_hi:[1,0,0]
    v_pk_fma_f32 v[238:239], v[174:175], s[52:53], v[30:31] op_sel_hi:[1,0,0]
    v_exp_f32 v192, v192
    v_exp_f32 v224, v224
    v_exp_f32 v193, v193
    v_exp_f32 v225, v225
    v_exp_f32 v194, v194
    v_exp_f32 v226, v226
    v_exp_f32 v195, v195
    v_exp_f32 v227, v227
    v_exp_f32 v196, v196
    v_exp_f32 v228, v228
    v_exp_f32 v197, v197
    v_exp_f32 v229, v229
    v_exp_f32 v198, v198
    v_exp_f32 v230, v230
    v_exp_f32 v199, v199
    v_exp_f32 v231, v231
    v_exp_f32 v200, v200
    v_exp_f32 v232, v232
    v_exp_f32 v201, v201
    v_exp_f32 v233, v233
    v_exp_f32 v202, v202
    v_exp_f32 v234, v234
    v_exp_f32 v203, v203
    v_exp_f32 v235, v235
    v_exp_f32 v204, v204
    v_exp_f32 v236, v236
    v_exp_f32 v205, v205
    v_exp_f32 v237, v237
    v_exp_f32 v206, v206
    v_exp_f32 v238, v238
    v_exp_f32 v207, v207
    v_exp_f32 v239, v239
    v_pk_add_f32 v[24:25], v[192:193], v[194:195]
    v_pk_add_f32 v[26:27], v[196:197], v[198:199]
    v_pk_add_f32 v[28:29], v[200:201], v[202:203]
    v_pk_add_f32 v[30:31], v[224:225], v[226:227]
    v_pk_add_f32 v[32:33], v[228:229], v[230:231]
    v_pk_add_f32 v[34:35], v[232:233], v[234:235]
    v_pk_add_f32 v[24:25], v[24:25], v[204:205]
    v_pk_add_f32 v[26:27], v[26:27], v[206:207]
    v_pk_add_f32 v[30:31], v[30:31], v[236:237]
    v_pk_add_f32 v[32:33], v[32:33], v[238:239]
    v_pk_add_f32 v[24:25], v[24:25], v[28:29]
    v_pk_add_f32 v[30:31], v[30:31], v[34:35]
    v_pk_add_f32 v[24:25], v[24:25], v[26:27]
    v_pk_add_f32 v[30:31], v[30:31], v[32:33]
    v_add_f32 v24, v24, v25
    v_add_f32 v30, v30, v31
    v_mov_b32 v25, v24
    v_mov_b32 v31, v30
    s_nop 0
    v_permlane32_swap_b32 v24, v25
    v_permlane32_swap_b32 v30, v31
    v_add_f32 v24, v24, v25
    v_add_f32 v30, v30, v31
    v_rcp_f32 v24, v24
    v_rcp_f32 v30, v30
    v_pk_mul_f32 v[192:193], v[192:193], v[24:25] op_sel_hi:[1,0]
    v_pk_mul_f32 v[224:225], v[224:225], v[30:31] op_sel_hi:[1,0]
    v_pk_mul_f32 v[194:195], v[194:195], v[24:25] op_sel_hi:[1,0]
    v_pk_mul_f32 v[226:227], v[226:227], v[30:31] op_sel_hi:[1,0]
    v_pk_mul_f32 v[196:197], v[196:197], v[24:25] op_sel_hi:[1,0]
    v_pk_mul_f32 v[228:229], v[228:229], v[30:31] op_sel_hi:[1,0]
    v_pk_mul_f32 v[198:199], v[198:199], v[24:25] op_sel_hi:[1,0]
    v_pk_mul_f32 v[230:231], v[230:231], v[30:31] op_sel_hi:[1,0]
    v_pk_mul_f32 v[200:201], v[200:201], v[24:25] op_sel_hi:[1,0]
    v_pk_mul_f32 v[232:233], v[232:233], v[30:31] op_sel_hi:[1,0]
    v_pk_mul_f32 v[202:203], v[202:203], v[24:25] op_sel_hi:[1,0]
    v_pk_mul_f32 v[234:235], v[234:235], v[30:31] op_sel_hi:[1,0]
    v_pk_mul_f32 v[204:205], v[204:205], v[24:25] op_sel_hi:[1,0]
    v_pk_mul_f32 v[236:237], v[236:237], v[30:31] op_sel_hi:[1,0]
    v_pk_mul_f32 v[206:207], v[206:207], v[24:25] op_sel_hi:[1,0]
    v_pk_mul_f32 v[238:239], v[238:239], v[30:31] op_sel_hi:[1,0]
    v_cvt_pk_bf16_f32 v80, v192, v193
    v_cvt_pk_bf16_f32 v88, v224, v225
    v_cvt_pk_bf16_f32 v81, v194, v195
    v_cvt_pk_bf16_f32 v89, v226, v227
    v_cvt_pk_bf16_f32 v82, v196, v197
    v_cvt_pk_bf16_f32 v90, v228, v229
    v_cvt_pk_bf16_f32 v83, v198, v199
    v_cvt_pk_bf16_f32 v91, v230, v231
    v_cvt_pk_bf16_f32 v84, v200, v201
    v_cvt_pk_bf16_f32 v92, v232, v233
    v_cvt_pk_bf16_f32 v85, v202, v203
    v_cvt_pk_bf16_f32 v93, v234, v235
    v_cvt_pk_bf16_f32 v86, v204, v205
    v_cvt_pk_bf16_f32 v94, v236, v237
    v_cvt_pk_bf16_f32 v87, v206, v207
    v_cvt_pk_bf16_f32 v95, v238, v239
    v_max3_f32 v24, v176, v177, v178
    v_max3_f32 v25, v179, v180, v181
    v_max3_f32 v26, v182, v183, v184
    v_max3_f32 v27, v185, v186, v187
    v_max3_f32 v28, v188, v189, v190
    v_max3_f32 v24, v24, v25, v191
    v_max3_f32 v26, v26, v27, v28
    v_max_f32 v24, v24, v26
    v_min3_f32 v30, v176, v177, v178
    v_min3_f32 v31, v179, v180, v181
    v_min3_f32 v32, v182, v183, v184
    v_min3_f32 v33, v185, v186, v187
    v_min3_f32 v34, v188, v189, v190
    v_min3_f32 v30, v30, v31, v191
    v_min3_f32 v32, v32, v33, v34
    v_min_f32 v30, v30, v32
    v_mov_b32 v25, v24
    v_mov_b32 v31, v30
    s_nop 0
    v_permlane32_swap_b32 v24, v25
    v_permlane32_swap_b32 v30, v31
    v_max_f32 v24, v24, v25
    v_min_f32 v30, v30, v31
    v_mul_f32 v24, s52, v24
    v_mul_f32 v30, s48, v30
    v_pk_fma_f32 v[208:209], v[176:177], s[48:49], v[24:25] op_sel_hi:[1,0,0]
    v_pk_fma_f32 v[240:241], v[176:177], s[52:53], v[30:31] op_sel_hi:[1,0,0]
    v_pk_fma_f32 v[210:211], v[178:179], s[48:49], v[24:25] op_sel_hi:[1,0,0]
    v_pk_fma_f32 v[242:243], v[178:179], s[52:53], v[30:31] op_sel_hi:[1,0,0]
    v_pk_fma_f32 v[212:213], v[180:181], s[48:49], v[24:25] op_sel_hi:[1,0,0]
    v_pk_fma_f32 v[244:245], v[180:181], s[52:53], v[30:31] op_sel_hi:[1,0,0]
    v_pk_fma_f32 v[214:215], v[182:183], s[48:49], v[24:25] op_sel_hi:[1,0,0]
    v_pk_fma_f32 v[246:247], v[182:183], s[52:53], v[30:31] op_sel_hi:[1,0,0]
    v_pk_fma_f32 v[216:217], v[184:185], s[48:49], v[24:25] op_sel_hi:[1,0,0]
    v_pk_fma_f32 v[248:249], v[184:185], s[52:53], v[30:31] op_sel_hi:[1,0,0]
    v_pk_fma_f32 v[218:219], v[186:187], s[48:49], v[24:25] op_sel_hi:[1,0,0]
    v_pk_fma_f32 v[250:251], v[186:187], s[52:53], v[30:31] op_sel_hi:[1,0,0]
    v_pk_fma_f32 v[220:221], v[188:189], s[48:49], v[24:25] op_sel_hi:[1,0,0]
    v_pk_fma_f32 v[252:253], v[188:189], s[52:53], v[30:31] op_sel_hi:[1,0,0]
    v_pk_fma_f32 v[222:223], v[190:191], s[48:49], v[24:25] op_sel_hi:[1,0,0]
    v_pk_fma_f32 v[254:255], v[190:191], s[52:53], v[30:31] op_sel_hi:[1,0,0]
    v_exp_f32 v208, v208
    v_exp_f32 v240, v240
    v_exp_f32 v209, v209
    v_exp_f32 v241, v241
    v_exp_f32 v210, v210
    v_exp_f32 v242, v242
    v_exp_f32 v211, v211
    v_exp_f32 v243, v243
    v_exp_f32 v212, v212
    v_exp_f32 v244, v244
    v_exp_f32 v213, v213
    v_exp_f32 v245, v245
    v_exp_f32 v214, v214
    v_exp_f32 v246, v246
    v_exp_f32 v215, v215
    v_exp_f32 v247, v247
    v_exp_f32 v216, v216
    v_exp_f32 v248, v248
    v_exp_f32 v217, v217
    v_exp_f32 v249, v249
    v_exp_f32 v218, v218
    v_exp_f32 v250, v250
    v_exp_f32 v219, v219
    v_exp_f32 v251, v251
    v_exp_f32 v220, v220
    v_exp_f32 v252, v252
    v_exp_f32 v221, v221
    v_exp_f32 v253, v253
    v_exp_f32 v222, v222
    v_exp_f32 v254, v254
    v_exp_f32 v223, v223
    v_exp_f32 v255, v255
    v_pk_add_f32 v[24:25], v[208:209], v[210:211]
    v_pk_add_f32 v[26:27], v[212:213], v[214:215]
    v_pk_add_f32 v[28:29], v[216:217], v[218:219]
    v_pk_add_f32 v[30:31], v[240:241], v[242:243]
    v_pk_add_f32 v[32:33], v[244:245], v[246:247]
    v_pk_add_f32 v[34:35], v[248:249], v[250:251]
    v_pk_add_f32 v[24:25], v[24:25], v[220:221]
    v_pk_add_f32 v[26:27], v[26:27], v[222:223]
    v_pk_add_f32 v[30:31], v[30:31], v[252:253]
    v_pk_add_f32 v[32:33], v[32:33], v[254:255]
    v_pk_add_f32 v[24:25], v[24:25], v[28:29]
    v_pk_add_f32 v[30:31], v[30:31], v[34:35]
    v_pk_add_f32 v[24:25], v[24:25], v[26:27]
    v_pk_add_f32 v[30:31], v[30:31], v[32:33]
    v_add_f32 v24, v24, v25
    v_add_f32 v30, v30, v31
    v_mov_b32 v25, v24
    v_mov_b32 v31, v30
    s_nop 0
    v_permlane32_swap_b32 v24, v25
    v_permlane32_swap_b32 v30, v31
    v_add_f32 v24, v24, v25
    v_add_f32 v30, v30, v31
    v_rcp_f32 v24, v24
    v_rcp_f32 v30, v30
    v_pk_mul_f32 v[208:209], v[208:209], v[24:25] op_sel_hi:[1,0]
    v_pk_mul_f32 v[240:241], v[240:241], v[30:31] op_sel_hi:[1,0]
    v_pk_mul_f32 v[210:211], v[210:211], v[24:25] op_sel_hi:[1,0]
    v_pk_mul_f32 v[242:243], v[242:243], v[30:31] op_sel_hi:[1,0]
    v_pk_mul_f32 v[212:213], v[212:213], v[24:25] op_sel_hi:[1,0]
    v_pk_mul_f32 v[244:245], v[244:245], v[30:31] op_sel_hi:[1,0]
    v_pk_mul_f32 v[214:215], v[214:215], v[24:25] op_sel_hi:[1,0]
    v_pk_mul_f32 v[246:247], v[246:247], v[30:31] op_sel_hi:[1,0]
    v_pk_mul_f32 v[216:217], v[216:217], v[24:25] op_sel_hi:[1,0]
    v_pk_mul_f32 v[248:249], v[248:249], v[30:31] op_sel_hi:[1,0]
    v_pk_mul_f32 v[218:219], v[218:219], v[24:25] op_sel_hi:[1,0]
    v_pk_mul_f32 v[250:251], v[250:251], v[30:31] op_sel_hi:[1,0]
    v_pk_mul_f32 v[220:221], v[220:221], v[24:25] op_sel_hi:[1,0]
    v_pk_mul_f32 v[252:253], v[252:253], v[30:31] op_sel_hi:[1,0]
    v_pk_mul_f32 v[222:223], v[222:223], v[24:25] op_sel_hi:[1,0]
    v_pk_mul_f32 v[254:255], v[254:255], v[30:31] op_sel_hi:[1,0]
    v_cvt_pk_bf16_f32 v96, v208, v209
    v_cvt_pk_bf16_f32 v104, v240, v241
    v_cvt_pk_bf16_f32 v97, v210, v211
    v_cvt_pk_bf16_f32 v105, v242, v243
    v_cvt_pk_bf16_f32 v98, v212, v213
    v_cvt_pk_bf16_f32 v106, v244, v245
    v_cvt_pk_bf16_f32 v99, v214, v215
    v_cvt_pk_bf16_f32 v107, v246, v247
    v_cvt_pk_bf16_f32 v100, v216, v217
    v_cvt_pk_bf16_f32 v108, v248, v249
    v_cvt_pk_bf16_f32 v101, v218, v219
    v_cvt_pk_bf16_f32 v109, v250, v251
    v_cvt_pk_bf16_f32 v102, v220, v221
    v_cvt_pk_bf16_f32 v110, v252, v253
    v_cvt_pk_bf16_f32 v103, v222, v223
    v_cvt_pk_bf16_f32 v111, v254, v255
    s_lshl_b32 s12, s19, 1
    s_add_u32 s23, s12, s22
    s_lshl_b32 s12, s23, 12
    s_add_u32 s43, s12, 32768
    s_lshl_b32 s14, s23, 10
    s_add_u32 s46, s14, 163840
    v_lshlrev_b32 v52, 7, v3
    v_lshrrev_b32 v53, 2, v4
    v_lshlrev_b32 v53, 7, v53
    s_lshl_b32 s40, s18, 1
    s_add_u32 s40, s40, s21
    s_lshl_b32 s41, s40, 6
    s_add_u32 s41, s41, s23
    s_lshl_b32 s41, s41, 11
    s_add_u32 s41, s41, 8388608
    s_add_u32 s42, s41, 65536
    s_lshl_b32 s12, s18, 10
    s_lshl_b32 s40, s21, 5
    s_add_u32 s40, s40, s12
    s_add_u32 s40, s40, s23
    s_lshl_b32 s40, s40, 2
    s_add_u32 s40, s40, 524288
    s_sub_u32 s21, s72, 1
    s_mov_b32 s22, s73
    s_mov_b32 s23, s74
    s_lshl_b32 s40, s18, 1
    s_lshr_b32 s12, s20, 1
    s_add_u32 s40, s40, s12
    s_lshl_b32 s40, s40, 5
    s_lshl_b32 s12, s19, 1
    s_add_u32 s40, s40, s12
    s_and_b32 s12, s20, 1
    s_add_u32 s40, s40, s12
    s_lshl_b32 s40, s40, 7
    s_add_u32 s40, s40, 6291456
    s_and_b32 s88, s16, 1
    s_lshl_b32 s88, s88, 3
    s_lshr_b32 s89, s16, 1
    s_lshl_b32 s89, s89, 1
    s_add_u32 s88, s88, s89
    s_lshr_b32 s89, s17, 4
    s_add_u32 s88, s88, s89
    s_and_b32 s89, s17, 15
    s_mov_b32 s68, s58
    s_and_b32 s69, s59, 0xffff
    s_mov_b32 s70, 4194304
    s_mov_b32 s71, 0x00020000
    s_and_b32 s90, s20, 3
    s_lshr_b32 s91, s20, 2
    s_lshl_b32 s12, s88, 3
    s_lshl_b32 s13, s90, 1
    s_add_u32 s12, s12, s13
    s_add_u32 s92, s12, s91
    s_lshl_b32 s12, s92, 4
    v_and_b32 v3, 15, v2
    v_add_u32 v6, s12, v3
    v_lshlrev_b32 v8, 2, v6
    v_bfe_u32 v9, v2, 4, 1
    v_lshrrev_b32 v10, 5, v2
    v_lshlrev_b32 v7, 11, v6
    v_lshl_add_u32 v7, v9, 6, v7
    v_lshl_add_u32 v7, v10, 4, v7
    s_lshl_b32 s12, s89, 7
    v_add_u32 v7, s12, v7
    s_mov_b32 s12, 4096
    buffer_load_dwordx4 v[24:27], v7, s[24:27], 0 offen
    buffer_load_dwordx4 v[28:31], v7, s[24:27], 0 offen offset:32
    buffer_load_dword v48, v8, s[32:35], s12 offen sc1
    v_lshlrev_b32 v22, 8, v3
    v_lshl_add_u32 v22, v9, 7, v22
    v_lshl_add_u32 v22, v10, 5, v22
    v_lshlrev_b32 v10, 9, v10
    v_bfe_u32 v11, v2, 2, 2
    v_lshl_add_u32 v10, v11, 7, v10
    v_bfe_u32 v11, v2, 3, 1
    v_lshl_add_u32 v10, v11, 6, v10
    v_lshl_add_u32 v10, v9, 5, v10
    v_and_b32 v11, 3, v2
    v_lshl_add_u32 v10, v11, 3, v10
    v_xor_b32 v11, 64, v10
    s_lshl_b32 s12, s91, 8
    v_xor_b32 v17, s12, v5
    v_lshlrev_b32 v8, 2, v3
    s_lshl_b32 s12, s20, 12
    s_mov_b32 s15, 32768
    s_cmp_lt_u32 s20, 6
    s_cselect_b32 s13, s15, 131072
    s_add_u32 s12, s12, s13
    v_add_u32 v20, s12, v5
    s_xor_b32 s14, s20, 4
    s_lshl_b32 s12, s14, 12
    s_cmp_lt_u32 s14, 6
    s_cselect_b32 s13, s15, 131072
    s_add_u32 s12, s12, s13
    v_add_u32 v21, s12, v5
    s_lshl_b32 s12, s88, 2
    s_add_u32 s12, s12, s90
    s_lshl_b32 s13, s12, 16
    s_lshl_b32 s14, s91, 15
    s_add_u32 s13, s13, s14
    s_add_u32 s95, s13, 8388608
    s_lshl_b32 s12, s88, 12
    s_lshl_b32 s13, s89, 8
    s_mul_i32 s13, s13, 1
    s_add_u32 s12, s12, s13
    s_lshr_b32 s13, s90, 1
    s_lshl_b32 s13, s13, 7
    s_add_u32 s12, s12, s13
    s_lshl_b32 s13, s91, 6
    s_add_u32 s12, s12, s13
    s_add_u32 s15, s12, 524288
    s_lshl_b32 s97, s91, 4
    v_lshlrev_b32 v8, 7, v3
    s_lshl_b32 s12, s88, 1
    s_lshr_b32 s13, s90, 1
    s_add_u32 s12, s12, s13
    s_lshl_b32 s12, s12, 12
    s_lshl_b32 s13, s91, 11
    s_add_u32 s12, s12, s13
    s_and_b32 s13, s89, 0
    s_lshl_b32 s13, s13, 17
    s_add_u32 s12, s12, s13
    s_add_u32 s15, s12, 6291456
    s_mov_b32 s93, s89
    s_waitcnt vmcnt(0)
    v_sub_f32 v50, 1.0, v48
    v_cvt_pk_bf16_f32 v50, v50, v50
    v_lshlrev_b32 v50, 16, v50
    v_lshlrev_b32 v32, 16, v24
    v_and_b32 v33, 0xffff0000, v24
    v_lshlrev_b32 v34, 16, v25
    v_and_b32 v35, 0xffff0000, v25
    v_lshlrev_b32 v36, 16, v26
    v_and_b32 v37, 0xffff0000, v26
    v_lshlrev_b32 v38, 16, v27
    v_and_b32 v39, 0xffff0000, v27
    v_lshlrev_b32 v40, 16, v28
    v_and_b32 v41, 0xffff0000, v28
    v_lshlrev_b32 v42, 16, v29
    v_and_b32 v43, 0xffff0000, v29
    v_lshlrev_b32 v44, 16, v30
    v_and_b32 v45, 0xffff0000, v30
    v_lshlrev_b32 v46, 16, v31
    v_and_b32 v47, 0xffff0000, v31
    v_pk_mul_f32 v[32:33], v[32:33], v[50:51] op_sel_hi:[1,0]
    v_pk_mul_f32 v[34:35], v[34:35], v[50:51] op_sel_hi:[1,0]
    v_pk_mul_f32 v[36:37], v[36:37], v[50:51] op_sel_hi:[1,0]
    v_pk_mul_f32 v[38:39], v[38:39], v[50:51] op_sel_hi:[1,0]
    v_pk_mul_f32 v[40:41], v[40:41], v[50:51] op_sel_hi:[1,0]
    v_pk_mul_f32 v[42:43], v[42:43], v[50:51] op_sel_hi:[1,0]
    v_pk_mul_f32 v[44:45], v[44:45], v[50:51] op_sel_hi:[1,0]
    v_pk_mul_f32 v[46:47], v[46:47], v[50:51] op_sel_hi:[1,0]
    v_cvt_pk_bf16_f32 v33, v32, v33
    v_cvt_pk_bf16_f32 v35, v34, v35
    v_cvt_pk_bf16_f32 v37, v36, v37
    v_cvt_pk_bf16_f32 v39, v38, v39
    v_cvt_pk_bf16_f32 v41, v40, v41
    v_cvt_pk_bf16_f32 v43, v42, v43
    v_cvt_pk_bf16_f32 v45, v44, v45
    v_cvt_pk_bf16_f32 v47, v46, v47
    v_lshlrev_b32 v32, 16, v33
    v_and_b32 v33, 0xffff0000, v33
    v_lshlrev_b32 v34, 16, v35
    v_and_b32 v35, 0xffff0000, v35
    v_lshlrev_b32 v36, 16, v37
    v_and_b32 v37, 0xffff0000, v37
    v_lshlrev_b32 v38, 16, v39
    v_and_b32 v39, 0xffff0000, v39
    v_lshlrev_b32 v40, 16, v41
    v_and_b32 v41, 0xffff0000, v41
    v_lshlrev_b32 v42, 16, v43
    v_and_b32 v43, 0xffff0000, v43
    v_lshlrev_b32 v44, 16, v45
    v_and_b32 v45, 0xffff0000, v45
    v_lshlrev_b32 v46, 16, v47
    v_and_b32 v47, 0xffff0000, v47
    s_mov_b32 s13, 0
    v_mov_b32 v54, 162896
L_c_kz:
    ds_read_b32 v55, v54
    s_add_u32 s13, s13, 1
    s_cmp_ge_u32 s13, 262144
    s_cbranch_scc1 L_c_kzok
    s_waitcnt lgkmcnt(0)
    v_cmp_eq_u32 vcc, 1, v55
    s_cbranch_vccz L_c_kz
L_c_kzok:
    s_mov_b32 s13, 0
L_c_kv:
    buffer_load_dwordx4 v[112:115], v5, s[32:35], s43 offen offset:0 sc1
    buffer_load_dwordx4 v[116:119], v5, s[32:35], s43 offen offset:1024 sc1
    buffer_load_dwordx4 v[120:123], v5, s[32:35], s43 offen offset:2048 sc1
    buffer_load_dwordx4 v[124:127], v5, s[32:35], s43 offen offset:3072 sc1
    buffer_load_dwordx4 v[128:131], v52, s[32:35], s46 offen offset:0 sc1
    buffer_load_dwordx4 v[132:135], v52, s[32:35], s46 offen offset:256 sc1
    buffer_load_dwordx4 v[136:139], v52, s[32:35], s46 offen offset:512 sc1
    buffer_load_dwordx4 v[140:143], v52, s[32:35], s46 offen offset:768 sc1
    s_add_u32 s13, s13, 1
    s_waitcnt vmcnt(0)
    v_max3_u32 v55, v112, v113, v114
    v_max3_u32 v55, v55, v115, v116
    v_max3_u32 v55, v55, v117, v118
    v_max3_u32 v55, v55, v119, v120
    v_max3_u32 v55, v55, v121, v122
    v_max3_u32 v55, v55, v123, v124
    v_max3_u32 v55, v55, v125, v126
    v_max3_u32 v55, v55, v127, v128
    v_max3_u32 v55, v55, v129, v130
    v_max3_u32 v55, v55, v131, v132
    v_max3_u32 v55, v55, v133, v134
    v_max3_u32 v55, v55, v135, v136
    v_max3_u32 v55, v55, v137, v138
    v_max3_u32 v55, v55, v139, v140
    v_max3_u32 v55, v55, v141, v142
    v_max_u32 v55, v55, v143
    v_cmp_eq_u32 vcc, -1, v55
    s_cbranch_vccz L_c_kvok
    s_cmp_lt_u32 s13, 16384
    s_cbranch_scc1 L_c_kv
L_c_kvok:
    v_mfma_f32_32x32x16_bf16 v[192:207], v[128:131], v[80:83], 0
    v_mfma_f32_32x32x16_bf16 v[192:207], v[132:135], v[84:87], v[192:207]
    v_mfma_f32_32x32x16_bf16 v[192:207], v[136:139], v[88:91], v[192:207]
    v_mfma_f32_32x32x16_bf16 v[192:207], v[140:143], v[92:95], v[192:207]
    v_mfma_f32_32x32x16_bf16 v[160:175], v[112:115], v[80:83], 0
    s_mov_b32 s45, 0
    s_lshr_b32 s12, s21, 4
    s_cmp_eq_u32 s12, s92
    s_cselect_b32 s46, 1, 0
    s_mov_b32 s45, 1
    v_mfma_f32_32x32x16_bf16 v[160:175], v[116:119], v[84:87], v[160:175]
    v_mov_b32 v56, s23
    v_mov_b32 v57, s23
    v_mov_b32 v58, s23
    v_mov_b32 v59, s23
    v_mfma_f32_32x32x16_bf16 v[160:175], v[120:123], v[88:91], v[160:175]
    v_lshrrev_b32 v60, 3, v2
    v_lshlrev_b32 v60, 17, v60
    v_and_b32 v61, 0x70, v5
    v_add_u32 v60, v60, v61
    v_mfma_f32_32x32x16_bf16 v[160:175], v[124:127], v[92:95], v[160:175]
    v_cvt_pk_bf16_f32 v54, 0, v192
    v_add_f32 v54, 0x358637bd, v54
    v_cvt_pk_bf16_f32 v54, 0, v54
    v_rcp_f32 v54, v54
    v_mfma_f32_32x32x16_bf16 v[208:223], v[128:131], v[96:99], 0
    s_nop 6
    v_cvt_pk_bf16_f32 v160, 0, v160
    v_cvt_pk_bf16_f32 v161, 0, v161
    v_cvt_pk_bf16_f32 v162, 0, v162
    v_cvt_pk_bf16_f32 v163, 0, v163
    v_cvt_pk_bf16_f32 v164, 0, v164
    v_mfma_f32_32x32x16_bf16 v[208:223], v[132:135], v[100:103], v[208:223]
    v_cvt_pk_bf16_f32 v165, 0, v165
    v_cvt_pk_bf16_f32 v166, 0, v166
    v_cvt_pk_bf16_f32 v167, 0, v167
    v_cvt_pk_bf16_f32 v168, 0, v168
    v_cvt_pk_bf16_f32 v169, 0, v169
    v_mfma_f32_32x32x16_bf16 v[208:223], v[136:139], v[104:107], v[208:223]
    v_cvt_pk_bf16_f32 v170, 0, v170
    v_cvt_pk_bf16_f32 v171, 0, v171
    v_cvt_pk_bf16_f32 v172, 0, v172
    v_cvt_pk_bf16_f32 v173, 0, v173
    v_cvt_pk_bf16_f32 v174, 0, v174
    v_mfma_f32_32x32x16_bf16 v[208:223], v[140:143], v[108:111], v[208:223]
    v_cvt_pk_bf16_f32 v175, 0, v175
    v_mul_f32 v160, v160, v54
    v_mul_f32 v161, v161, v54
    v_mul_f32 v162, v162, v54
    v_mul_f32 v163, v163, v54
    v_mfma_f32_32x32x16_bf16 v[176:191], v[112:115], v[96:99], 0
    v_mul_f32 v164, v164, v54
    v_mul_f32 v165, v165, v54
    v_mul_f32 v166, v166, v54
    v_mul_f32 v167, v167, v54
    v_mul_f32 v168, v168, v54
    v_mfma_f32_32x32x16_bf16 v[176:191], v[116:119], v[100:103], v[176:191]
    v_mul_f32 v169, v169, v54
    v_mul_f32 v170, v170, v54
    v_mul_f32 v171, v171, v54
    v_mul_f32 v172, v172, v54
    v_mul_f32 v173, v173, v54
    v_mfma_f32_32x32x16_bf16 v[176:191], v[120:123], v[104:107], v[176:191]
    v_mul_f32 v174, v174, v54
    v_mul_f32 v175, v175, v54
    v_cvt_pk_bf16_f32 v64, v160, v161
    v_cvt_pk_bf16_f32 v65, v162, v163
    v_cvt_pk_bf16_f32 v66, v164, v165
    v_mfma_f32_32x32x16_bf16 v[176:191], v[124:127], v[108:111], v[176:191]
    v_cvt_pk_bf16_f32 v67, v166, v167
    buffer_store_dwordx4 v[64:67], v5, s[32:35], s41 offen sc1
    v_cvt_pk_bf16_f32 v68, v168, v169
    v_cvt_pk_bf16_f32 v69, v170, v171
    v_cvt_pk_bf16_f32 v70, v172, v173
    v_cvt_pk_bf16_f32 v71, v174, v175
    buffer_store_dwordx4 v[68:71], v5, s[32:35], s41 offen offset:1024 sc1
    v_cvt_pk_bf16_f32 v62, 0, v208
    v_add_f32 v62, 0x358637bd, v62
    v_cvt_pk_bf16_f32 v62, 0, v62
    v_rcp_f32 v62, v62
    s_nop 0
    v_cvt_pk_bf16_f32 v176, 0, v176
    v_cvt_pk_bf16_f32 v177, 0, v177
    v_cvt_pk_bf16_f32 v178, 0, v178
    v_cvt_pk_bf16_f32 v179, 0, v179
    v_cvt_pk_bf16_f32 v180, 0, v180
    v_cvt_pk_bf16_f32 v181, 0, v181
    v_cvt_pk_bf16_f32 v182, 0, v182
    v_cvt_pk_bf16_f32 v183, 0, v183
    v_pk_mul_f32 v[176:177], v[176:177], v[62:63] op_sel_hi:[1,0]
    v_pk_mul_f32 v[178:179], v[178:179], v[62:63] op_sel_hi:[1,0]
    v_pk_mul_f32 v[180:181], v[180:181], v[62:63] op_sel_hi:[1,0]
    v_pk_mul_f32 v[182:183], v[182:183], v[62:63] op_sel_hi:[1,0]
    v_cvt_pk_bf16_f32 v72, v176, v177
    v_cvt_pk_bf16_f32 v73, v178, v179
    v_cvt_pk_bf16_f32 v74, v180, v181
    v_cvt_pk_bf16_f32 v75, v182, v183
    buffer_store_dwordx4 v[72:75], v5, s[32:35], s42 offen sc1
    v_cvt_pk_bf16_f32 v184, 0, v184
    v_cvt_pk_bf16_f32 v185, 0, v185
    v_cvt_pk_bf16_f32 v186, 0, v186
    v_cvt_pk_bf16_f32 v187, 0, v187
    v_cvt_pk_bf16_f32 v188, 0, v188
    v_cvt_pk_bf16_f32 v189, 0, v189
    v_cvt_pk_bf16_f32 v190, 0, v190
    v_cvt_pk_bf16_f32 v191, 0, v191
    v_pk_mul_f32 v[184:185], v[184:185], v[62:63] op_sel_hi:[1,0]
    v_pk_mul_f32 v[186:187], v[186:187], v[62:63] op_sel_hi:[1,0]
    v_pk_mul_f32 v[188:189], v[188:189], v[62:63] op_sel_hi:[1,0]
    v_pk_mul_f32 v[190:191], v[190:191], v[62:63] op_sel_hi:[1,0]
    v_cvt_pk_bf16_f32 v76, v184, v185
    v_cvt_pk_bf16_f32 v77, v186, v187
    v_cvt_pk_bf16_f32 v78, v188, v189
    v_cvt_pk_bf16_f32 v79, v190, v191
    buffer_store_dwordx4 v[76:79], v5, s[32:35], s42 offen offset:1024 sc1
    s_waitcnt vmcnt(0)
    s_mov_b32 exec_lo, 0xff
    s_mov_b32 exec_hi, 0
    buffer_store_dwordx4 v[56:59], v60, s[32:35], s40 offen sc1
    s_mov_b64 exec, -1
L_phaseb:
    s_setprio 0
    s_nop 4
L_own_r0:
    s_nop 0
    s_barrier
    s_mov_b32 s14, 0xffff0000
    s_mov_b32 s47, 0
    s_mov_b32 s96, 0
    s_cmp_lg_u32 s96, 0
    s_cbranch_scc1 L_pk0
L_pl0:
    buffer_load_dword v52, v8, s[32:35], s15 offen sc1
    s_add_u32 s47, s47, 1
    s_cmp_ge_u32 s47, 16384
    s_cselect_b32 s12, -1, 0
    s_waitcnt vmcnt(0)
    v_cmp_eq_u32 vcc, s23, v52
    s_nop 1
    s_or_b32 s12, s12, vcc_lo
    s_lshr_b32 s12, s12, s93
    s_or_b32 s96, s96, s12
    s_andn2_b32 s96, s96, s14
    s_cbranch_scc0 L_pl0
L_pk0:
    s_ff1_i32_b32 s12, s96
    s_bitset0_b32 s96, s12
    s_bitset1_b32 s14, s12
    s_add_u32 s12, s12, s93
    s_and_b32 s80, s12, 15
    s_lshl_b32 s94, s80, 11
    s_add_u32 s94, s94, s95
    buffer_load_dwordx4 v[96:99], v17, s[32:35], s94 offen
    buffer_load_dwordx4 v[100:103], v17, s[32:35], s94 offen offset:1024
    s_add_u32 s12, s80, s97
    s_lshl_b32 s13, s12, 12
    s_cmp_ge_u32 s12, 8
    s_cselect_b32 s12, 24576, 0
    s_add_u32 s13, s13, s12
    v_add_u32 v12, s13, v10
    v_add_u32 v13, s13, v11
    ds_read_b64_tr_b16 v[120:121], v12 offset:0
    ds_read_b64_tr_b16 v[122:123], v12 offset:1024
    ds_read_b64_tr_b16 v[124:125], v13 offset:0
    ds_read_b64_tr_b16 v[126:127], v13 offset:1024
    ds_read_b64_tr_b16 v[128:129], v12 offset:2048
    ds_read_b64_tr_b16 v[130:131], v12 offset:3072
    ds_read_b64_tr_b16 v[132:133], v13 offset:2048
    ds_read_b64_tr_b16 v[134:135], v13 offset:3072
    s_cmp_lg_u32 s96, 0
    s_cbranch_scc1 L_pk1
L_pl1:
    buffer_load_dword v53, v8, s[32:35], s15 offen sc1
    s_add_u32 s47, s47, 1
    s_cmp_ge_u32 s47, 16384
    s_cselect_b32 s12, -1, 0
    s_waitcnt vmcnt(0)
    v_cmp_eq_u32 vcc, s23, v53
    s_nop 1
    s_or_b32 s12, s12, vcc_lo
    s_lshr_b32 s12, s12, s93
    s_or_b32 s96, s96, s12
    s_andn2_b32 s96, s96, s14
    s_cbranch_scc0 L_pl1
L_pk1:
    s_ff1_i32_b32 s12, s96
    s_bitset0_b32 s96, s12
    s_bitset1_b32 s14, s12
    s_add_u32 s12, s12, s93
    s_and_b32 s81, s12, 15
    s_lshl_b32 s94, s81, 11
    s_add_u32 s94, s94, s95
    buffer_load_dwordx4 v[104:107], v17, s[32:35], s94 offen
    buffer_load_dwordx4 v[108:111], v17, s[32:35], s94 offen offset:1024
    s_cmp_lg_u32 s96, 0
    s_cbranch_scc1 L_pk2
L_pl2:
    buffer_load_dword v54, v8, s[32:35], s15 offen sc1
    s_add_u32 s47, s47, 1
    s_cmp_ge_u32 s47, 16384
    s_cselect_b32 s12, -1, 0
    s_waitcnt vmcnt(0)
    v_cmp_eq_u32 vcc, s23, v54
    s_nop 1
    s_or_b32 s12, s12, vcc_lo
    s_lshr_b32 s12, s12, s93
    s_or_b32 s96, s96, s12
    s_andn2_b32 s96, s96, s14
    s_cbranch_scc0 L_pl2
L_pk2:
    s_ff1_i32_b32 s12, s96
    s_bitset0_b32 s96, s12
    s_bitset1_b32 s14, s12
    s_add_u32 s12, s12, s93
    s_and_b32 s82, s12, 15
    s_lshl_b32 s94, s82, 11
    s_add_u32 s94, s94, s95
    buffer_load_dwordx4 v[112:115], v17, s[32:35], s94 offen
    buffer_load_dwordx4 v[116:119], v17, s[32:35], s94 offen offset:1024
    s_add_u32 s12, s81, s97
    s_lshl_b32 s13, s12, 12
    s_cmp_ge_u32 s12, 8
    s_cselect_b32 s12, 24576, 0
    s_add_u32 s13, s13, s12
    v_add_u32 v14, s13, v10
    v_add_u32 v15, s13, v11
    s_waitcnt vmcnt(4)
    s_waitcnt lgkmcnt(6)
    v_mfma_f32_32x32x16_bf16 v[64:79], v[120:123], v[96:99], 0
    ds_read_b64_tr_b16 v[136:137], v14 offset:0
    ds_read_b64_tr_b16 v[138:139], v14 offset:1024
    s_waitcnt lgkmcnt(6)
    v_mfma_f32_32x32x16_bf16 v[80:95], v[124:127], v[96:99], 0
    ds_read_b64_tr_b16 v[140:141], v15 offset:0
    ds_read_b64_tr_b16 v[142:143], v15 offset:1024
    s_waitcnt lgkmcnt(6)
    v_mfma_f32_32x32x16_bf16 v[64:79], v[128:131], v[100:103], v[64:79]
    ds_read_b64_tr_b16 v[144:145], v14 offset:2048
    ds_read_b64_tr_b16 v[146:147], v14 offset:3072
    s_waitcnt lgkmcnt(6)
    v_mfma_f32_32x32x16_bf16 v[80:95], v[132:135], v[100:103], v[80:95]
    ds_read_b64_tr_b16 v[148:149], v15 offset:2048
    ds_read_b64_tr_b16 v[150:151], v15 offset:3072
    s_cmp_lg_u32 s96, 0
    s_cbranch_scc1 L_pk3
L_pl3:
    buffer_load_dword v55, v8, s[32:35], s15 offen sc1
    s_add_u32 s47, s47, 1
    s_cmp_ge_u32 s47, 16384
    s_cselect_b32 s12, -1, 0
    s_waitcnt vmcnt(0)
    v_cmp_eq_u32 vcc, s23, v55
    s_nop 1
    s_or_b32 s12, s12, vcc_lo
    s_lshr_b32 s12, s12, s93
    s_or_b32 s96, s96, s12
    s_andn2_b32 s96, s96, s14
    s_cbranch_scc0 L_pl3
L_pk3:
    s_ff1_i32_b32 s12, s96
    s_bitset0_b32 s96, s12
    s_bitset1_b32 s14, s12
    s_add_u32 s12, s12, s93
    s_and_b32 s83, s12, 15
    s_lshl_b32 s94, s83, 11
    s_add_u32 s94, s94, s95
    buffer_load_dwordx4 v[96:99], v17, s[32:35], s94 offen
    buffer_load_dwordx4 v[100:103], v17, s[32:35], s94 offen offset:1024
    s_add_u32 s12, s82, s97
    s_lshl_b32 s13, s12, 12
    s_cmp_ge_u32 s12, 8
    s_cselect_b32 s12, 24576, 0
    s_add_u32 s13, s13, s12
    v_add_u32 v12, s13, v10
    v_add_u32 v13, s13, v11
    s_waitcnt vmcnt(4)
    s_waitcnt lgkmcnt(6)
    v_mfma_f32_32x32x16_bf16 v[64:79], v[136:139], v[104:107], v[64:79]
    ds_read_b64_tr_b16 v[120:121], v12 offset:0
    ds_read_b64_tr_b16 v[122:123], v12 offset:1024
    s_waitcnt lgkmcnt(6)
    v_mfma_f32_32x32x16_bf16 v[80:95], v[140:143], v[104:107], v[80:95]
    ds_read_b64_tr_b16 v[124:125], v13 offset:0
    ds_read_b64_tr_b16 v[126:127], v13 offset:1024
    s_waitcnt lgkmcnt(6)
    v_mfma_f32_32x32x16_bf16 v[64:79], v[144:147], v[108:111], v[64:79]
    ds_read_b64_tr_b16 v[128:129], v12 offset:2048
    ds_read_b64_tr_b16 v[130:131], v12 offset:3072
    s_waitcnt lgkmcnt(6)
    v_mfma_f32_32x32x16_bf16 v[80:95], v[148:151], v[108:111], v[80:95]
    ds_read_b64_tr_b16 v[132:133], v13 offset:2048
    ds_read_b64_tr_b16 v[134:135], v13 offset:3072
    s_cmp_lg_u32 s96, 0
    s_cbranch_scc1 L_pk4
L_pl4:
    buffer_load_dword v56, v8, s[32:35], s15 offen sc1
    s_add_u32 s47, s47, 1
    s_cmp_ge_u32 s47, 16384
    s_cselect_b32 s12, -1, 0
    s_waitcnt vmcnt(0)
    v_cmp_eq_u32 vcc, s23, v56
    s_nop 1
    s_or_b32 s12, s12, vcc_lo
    s_lshr_b32 s12, s12, s93
    s_or_b32 s96, s96, s12
    s_andn2_b32 s96, s96, s14
    s_cbranch_scc0 L_pl4
L_pk4:
    s_ff1_i32_b32 s12, s96
    s_bitset0_b32 s96, s12
    s_bitset1_b32 s14, s12
    s_add_u32 s12, s12, s93
    s_and_b32 s84, s12, 15
    s_lshl_b32 s94, s84, 11
    s_add_u32 s94, s94, s95
    buffer_load_dwordx4 v[104:107], v17, s[32:35], s94 offen
    buffer_load_dwordx4 v[108:111], v17, s[32:35], s94 offen offset:1024
    s_add_u32 s12, s83, s97
    s_lshl_b32 s13, s12, 12
    s_cmp_ge_u32 s12, 8
    s_cselect_b32 s12, 24576, 0
    s_add_u32 s13, s13, s12
    v_add_u32 v14, s13, v10
    v_add_u32 v15, s13, v11
    s_waitcnt vmcnt(4)
    s_waitcnt lgkmcnt(6)
    v_mfma_f32_32x32x16_bf16 v[64:79], v[120:123], v[112:115], v[64:79]
    ds_read_b64_tr_b16 v[136:137], v14 offset:0
    ds_read_b64_tr_b16 v[138:139], v14 offset:1024
    s_waitcnt lgkmcnt(6)
    v_mfma_f32_32x32x16_bf16 v[80:95], v[124:127], v[112:115], v[80:95]
    ds_read_b64_tr_b16 v[140:141], v15 offset:0
    ds_read_b64_tr_b16 v[142:143], v15 offset:1024
    s_waitcnt lgkmcnt(6)
    v_mfma_f32_32x32x16_bf16 v[64:79], v[128:131], v[116:119], v[64:79]
    ds_read_b64_tr_b16 v[144:145], v14 offset:2048
    ds_read_b64_tr_b16 v[146:147], v14 offset:3072
    s_waitcnt lgkmcnt(6)
    v_mfma_f32_32x32x16_bf16 v[80:95], v[132:135], v[116:119], v[80:95]
    ds_read_b64_tr_b16 v[148:149], v15 offset:2048
    ds_read_b64_tr_b16 v[150:151], v15 offset:3072
    s_cmp_lg_u32 s96, 0
    s_cbranch_scc1 L_pk5
L_pl5:
    buffer_load_dword v57, v8, s[32:35], s15 offen sc1
    s_add_u32 s47, s47, 1
    s_cmp_ge_u32 s47, 16384
    s_cselect_b32 s12, -1, 0
    s_waitcnt vmcnt(0)
    v_cmp_eq_u32 vcc, s23, v57
    s_nop 1
    s_or_b32 s12, s12, vcc_lo
    s_lshr_b32 s12, s12, s93
    s_or_b32 s96, s96, s12
    s_andn2_b32 s96, s96, s14
    s_cbranch_scc0 L_pl5
L_pk5:
    s_ff1_i32_b32 s12, s96
    s_bitset0_b32 s96, s12
    s_bitset1_b32 s14, s12
    s_add_u32 s12, s12, s93
    s_and_b32 s85, s12, 15
    s_lshl_b32 s94, s85, 11
    s_add_u32 s94, s94, s95
    buffer_load_dwordx4 v[112:115], v17, s[32:35], s94 offen
    buffer_load_dwordx4 v[116:119], v17, s[32:35], s94 offen offset:1024
    s_add_u32 s12, s84, s97
    s_lshl_b32 s13, s12, 12
    s_cmp_ge_u32 s12, 8
    s_cselect_b32 s12, 24576, 0
    s_add_u32 s13, s13, s12
    v_add_u32 v12, s13, v10
    v_add_u32 v13, s13, v11
    s_waitcnt vmcnt(4)
    s_waitcnt lgkmcnt(6)
    v_mfma_f32_32x32x16_bf16 v[64:79], v[136:139], v[96:99], v[64:79]
    ds_read_b64_tr_b16 v[120:121], v12 offset:0
    ds_read_b64_tr_b16 v[122:123], v12 offset:1024
    s_waitcnt lgkmcnt(6)
    v_mfma_f32_32x32x16_bf16 v[80:95], v[140:143], v[96:99], v[80:95]
    ds_read_b64_tr_b16 v[124:125], v13 offset:0
    ds_read_b64_tr_b16 v[126:127], v13 offset:1024
    s_waitcnt lgkmcnt(6)
    v_mfma_f32_32x32x16_bf16 v[64:79], v[144:147], v[100:103], v[64:79]
    ds_read_b64_tr_b16 v[128:129], v12 offset:2048
    ds_read_b64_tr_b16 v[130:131], v12 offset:3072
    s_waitcnt lgkmcnt(6)
    v_mfma_f32_32x32x16_bf16 v[80:95], v[148:151], v[100:103], v[80:95]
    ds_read_b64_tr_b16 v[132:133], v13 offset:2048
    ds_read_b64_tr_b16 v[134:135], v13 offset:3072
    s_cmp_lg_u32 s96, 0
    s_cbranch_scc1 L_pk6
L_pl6:
    buffer_load_dword v58, v8, s[32:35], s15 offen sc1
    s_add_u32 s47, s47, 1
    s_cmp_ge_u32 s47, 16384
    s_cselect_b32 s12, -1, 0
    s_waitcnt vmcnt(0)
    v_cmp_eq_u32 vcc, s23, v58
    s_nop 1
    s_or_b32 s12, s12, vcc_lo
    s_lshr_b32 s12, s12, s93
    s_or_b32 s96, s96, s12
    s_andn2_b32 s96, s96, s14
    s_cbranch_scc0 L_pl6
L_pk6:
    s_ff1_i32_b32 s12, s96
    s_bitset0_b32 s96, s12
    s_bitset1_b32 s14, s12
    s_add_u32 s12, s12, s93
    s_and_b32 s86, s12, 15
    s_lshl_b32 s94, s86, 11
    s_add_u32 s94, s94, s95
    buffer_load_dwordx4 v[96:99], v17, s[32:35], s94 offen
    buffer_load_dwordx4 v[100:103], v17, s[32:35], s94 offen offset:1024
    s_add_u32 s12, s85, s97
    s_lshl_b32 s13, s12, 12
    s_cmp_ge_u32 s12, 8
    s_cselect_b32 s12, 24576, 0
    s_add_u32 s13, s13, s12
    v_add_u32 v14, s13, v10
    v_add_u32 v15, s13, v11
    s_waitcnt vmcnt(4)
    s_waitcnt lgkmcnt(6)
    v_mfma_f32_32x32x16_bf16 v[64:79], v[120:123], v[104:107], v[64:79]
    ds_read_b64_tr_b16 v[136:137], v14 offset:0
    ds_read_b64_tr_b16 v[138:139], v14 offset:1024
    s_waitcnt lgkmcnt(6)
    v_mfma_f32_32x32x16_bf16 v[80:95], v[124:127], v[104:107], v[80:95]
    ds_read_b64_tr_b16 v[140:141], v15 offset:0
    ds_read_b64_tr_b16 v[142:143], v15 offset:1024
    s_waitcnt lgkmcnt(6)
    v_mfma_f32_32x32x16_bf16 v[64:79], v[128:131], v[108:111], v[64:79]
    ds_read_b64_tr_b16 v[144:145], v14 offset:2048
    ds_read_b64_tr_b16 v[146:147], v14 offset:3072
    s_waitcnt lgkmcnt(6)
    v_mfma_f32_32x32x16_bf16 v[80:95], v[132:135], v[108:111], v[80:95]
    ds_read_b64_tr_b16 v[148:149], v15 offset:2048
    ds_read_b64_tr_b16 v[150:151], v15 offset:3072
    s_cmp_lg_u32 s96, 0
    s_cbranch_scc1 L_pk7
L_pl7:
    buffer_load_dword v59, v8, s[32:35], s15 offen sc1
    s_add_u32 s47, s47, 1
    s_cmp_ge_u32 s47, 16384
    s_cselect_b32 s12, -1, 0
    s_waitcnt vmcnt(0)
    v_cmp_eq_u32 vcc, s23, v59
    s_nop 1
    s_or_b32 s12, s12, vcc_lo
    s_lshr_b32 s12, s12, s93
    s_or_b32 s96, s96, s12
    s_andn2_b32 s96, s96, s14
    s_cbranch_scc0 L_pl7
L_pk7:
    s_ff1_i32_b32 s12, s96
    s_bitset0_b32 s96, s12
    s_bitset1_b32 s14, s12
    s_add_u32 s12, s12, s93
    s_and_b32 s87, s12, 15
    s_lshl_b32 s94, s87, 11
    s_add_u32 s94, s94, s95
    buffer_load_dwordx4 v[104:107], v17, s[32:35], s94 offen
    buffer_load_dwordx4 v[108:111], v17, s[32:35], s94 offen offset:1024
    s_add_u32 s12, s86, s97
    s_lshl_b32 s13, s12, 12
    s_cmp_ge_u32 s12, 8
    s_cselect_b32 s12, 24576, 0
    s_add_u32 s13, s13, s12
    v_add_u32 v12, s13, v10
    v_add_u32 v13, s13, v11
    s_waitcnt vmcnt(4)
    s_waitcnt lgkmcnt(6)
    v_mfma_f32_32x32x16_bf16 v[64:79], v[136:139], v[112:115], v[64:79]
    ds_read_b64_tr_b16 v[120:121], v12 offset:0
    ds_read_b64_tr_b16 v[122:123], v12 offset:1024
    s_waitcnt lgkmcnt(6)
    v_mfma_f32_32x32x16_bf16 v[80:95], v[140:143], v[112:115], v[80:95]
    ds_read_b64_tr_b16 v[124:125], v13 offset:0
    ds_read_b64_tr_b16 v[126:127], v13 offset:1024
    s_waitcnt lgkmcnt(6)
    v_mfma_f32_32x32x16_bf16 v[64:79], v[144:147], v[116:119], v[64:79]
    ds_read_b64_tr_b16 v[128:129], v12 offset:2048
    ds_read_b64_tr_b16 v[130:131], v12 offset:3072
    s_waitcnt lgkmcnt(6)
    v_mfma_f32_32x32x16_bf16 v[80:95], v[148:151], v[116:119], v[80:95]
    ds_read_b64_tr_b16 v[132:133], v13 offset:2048
    ds_read_b64_tr_b16 v[134:135], v13 offset:3072
    s_cmp_lg_u32 s96, 0
    s_cbranch_scc1 L_pk8
L_pl8:
    buffer_load_dword v52, v8, s[32:35], s15 offen sc1
    s_add_u32 s47, s47, 1
    s_cmp_ge_u32 s47, 16384
    s_cselect_b32 s12, -1, 0
    s_waitcnt vmcnt(0)
    v_cmp_eq_u32 vcc, s23, v52
    s_nop 1
    s_or_b32 s12, s12, vcc_lo
    s_lshr_b32 s12, s12, s93
    s_or_b32 s96, s96, s12
    s_andn2_b32 s96, s96, s14
    s_cbranch_scc0 L_pl8
L_pk8:
    s_ff1_i32_b32 s12, s96
    s_bitset0_b32 s96, s12
    s_bitset1_b32 s14, s12
    s_add_u32 s12, s12, s93
    s_and_b32 s80, s12, 15
    s_lshl_b32 s94, s80, 11
    s_add_u32 s94, s94, s95
    buffer_load_dwordx4 v[112:115], v17, s[32:35], s94 offen
    buffer_load_dwordx4 v[116:119], v17, s[32:35], s94 offen offset:1024
    s_add_u32 s12, s87, s97
    s_lshl_b32 s13, s12, 12
    s_cmp_ge_u32 s12, 8
    s_cselect_b32 s12, 24576, 0
    s_add_u32 s13, s13, s12
    v_add_u32 v14, s13, v10
    v_add_u32 v15, s13, v11
    s_waitcnt vmcnt(4)
    s_waitcnt lgkmcnt(6)
    v_mfma_f32_32x32x16_bf16 v[64:79], v[120:123], v[96:99], v[64:79]
    ds_read_b64_tr_b16 v[136:137], v14 offset:0
    ds_read_b64_tr_b16 v[138:139], v14 offset:1024
    s_waitcnt lgkmcnt(6)
    v_mfma_f32_32x32x16_bf16 v[80:95], v[124:127], v[96:99], v[80:95]
    ds_read_b64_tr_b16 v[140:141], v15 offset:0
    ds_read_b64_tr_b16 v[142:143], v15 offset:1024
    s_waitcnt lgkmcnt(6)
    v_mfma_f32_32x32x16_bf16 v[64:79], v[128:131], v[100:103], v[64:79]
    ds_read_b64_tr_b16 v[144:145], v14 offset:2048
    ds_read_b64_tr_b16 v[146:147], v14 offset:3072
    s_waitcnt lgkmcnt(6)
    v_mfma_f32_32x32x16_bf16 v[80:95], v[132:135], v[100:103], v[80:95]
    ds_read_b64_tr_b16 v[148:149], v15 offset:2048
    ds_read_b64_tr_b16 v[150:151], v15 offset:3072
    s_cmp_lg_u32 s96, 0
    s_cbranch_scc1 L_pk9
L_pl9:
    buffer_load_dword v53, v8, s[32:35], s15 offen sc1
    s_add_u32 s47, s47, 1
    s_cmp_ge_u32 s47, 16384
    s_cselect_b32 s12, -1, 0
    s_waitcnt vmcnt(0)
    v_cmp_eq_u32 vcc, s23, v53
    s_nop 1
    s_or_b32 s12, s12, vcc_lo
    s_lshr_b32 s12, s12, s93
    s_or_b32 s96, s96, s12
    s_andn2_b32 s96, s96, s14
    s_cbranch_scc0 L_pl9
L_pk9:
    s_ff1_i32_b32 s12, s96
    s_bitset0_b32 s96, s12
    s_bitset1_b32 s14, s12
    s_add_u32 s12, s12, s93
    s_and_b32 s81, s12, 15
    s_lshl_b32 s94, s81, 11
    s_add_u32 s94, s94, s95
    buffer_load_dwordx4 v[96:99], v17, s[32:35], s94 offen
    buffer_load_dwordx4 v[100:103], v17, s[32:35], s94 offen offset:1024
    s_add_u32 s12, s80, s97
    s_lshl_b32 s13, s12, 12
    s_cmp_ge_u32 s12, 8
    s_cselect_b32 s12, 24576, 0
    s_add_u32 s13, s13, s12
    v_add_u32 v12, s13, v10
    v_add_u32 v13, s13, v11
    s_waitcnt vmcnt(4)
    s_waitcnt lgkmcnt(6)
    v_mfma_f32_32x32x16_bf16 v[64:79], v[136:139], v[104:107], v[64:79]
    ds_read_b64_tr_b16 v[120:121], v12 offset:0
    ds_read_b64_tr_b16 v[122:123], v12 offset:1024
    s_waitcnt lgkmcnt(6)
    v_mfma_f32_32x32x16_bf16 v[80:95], v[140:143], v[104:107], v[80:95]
    ds_read_b64_tr_b16 v[124:125], v13 offset:0
    ds_read_b64_tr_b16 v[126:127], v13 offset:1024
    s_waitcnt lgkmcnt(6)
    v_mfma_f32_32x32x16_bf16 v[64:79], v[144:147], v[108:111], v[64:79]
    ds_read_b64_tr_b16 v[128:129], v12 offset:2048
    ds_read_b64_tr_b16 v[130:131], v12 offset:3072
    s_waitcnt lgkmcnt(6)
    v_mfma_f32_32x32x16_bf16 v[80:95], v[148:151], v[108:111], v[80:95]
    ds_read_b64_tr_b16 v[132:133], v13 offset:2048
    ds_read_b64_tr_b16 v[134:135], v13 offset:3072
    s_cmp_lg_u32 s96, 0
    s_cbranch_scc1 L_pk10
L_pl10:
    buffer_load_dword v54, v8, s[32:35], s15 offen sc1
    s_add_u32 s47, s47, 1
    s_cmp_ge_u32 s47, 16384
    s_cselect_b32 s12, -1, 0
    s_waitcnt vmcnt(0)
    v_cmp_eq_u32 vcc, s23, v54
    s_nop 1
    s_or_b32 s12, s12, vcc_lo
    s_lshr_b32 s12, s12, s93
    s_or_b32 s96, s96, s12
    s_andn2_b32 s96, s96, s14
    s_cbranch_scc0 L_pl10
L_pk10:
    s_ff1_i32_b32 s12, s96
    s_bitset0_b32 s96, s12
    s_bitset1_b32 s14, s12
    s_add_u32 s12, s12, s93
    s_and_b32 s82, s12, 15
    s_lshl_b32 s94, s82, 11
    s_add_u32 s94, s94, s95
    buffer_load_dwordx4 v[104:107], v17, s[32:35], s94 offen
    buffer_load_dwordx4 v[108:111], v17, s[32:35], s94 offen offset:1024
    s_add_u32 s12, s81, s97
    s_lshl_b32 s13, s12, 12
    s_cmp_ge_u32 s12, 8
    s_cselect_b32 s12, 24576, 0
    s_add_u32 s13, s13, s12
    v_add_u32 v14, s13, v10
    v_add_u32 v15, s13, v11
    s_waitcnt vmcnt(4)
    s_waitcnt lgkmcnt(6)
    v_mfma_f32_32x32x16_bf16 v[64:79], v[120:123], v[112:115], v[64:79]
    ds_read_b64_tr_b16 v[136:137], v14 offset:0
    ds_read_b64_tr_b16 v[138:139], v14 offset:1024
    s_waitcnt lgkmcnt(6)
    v_mfma_f32_32x32x16_bf16 v[80:95], v[124:127], v[112:115], v[80:95]
    ds_read_b64_tr_b16 v[140:141], v15 offset:0
    ds_read_b64_tr_b16 v[142:143], v15 offset:1024
    s_waitcnt lgkmcnt(6)
    v_mfma_f32_32x32x16_bf16 v[64:79], v[128:131], v[116:119], v[64:79]
    ds_read_b64_tr_b16 v[144:145], v14 offset:2048
    ds_read_b64_tr_b16 v[146:147], v14 offset:3072
    s_waitcnt lgkmcnt(6)
    v_mfma_f32_32x32x16_bf16 v[80:95], v[132:135], v[116:119], v[80:95]
    ds_read_b64_tr_b16 v[148:149], v15 offset:2048
    ds_read_b64_tr_b16 v[150:151], v15 offset:3072
    s_cmp_lg_u32 s96, 0
    s_cbranch_scc1 L_pk11
L_pl11:
    buffer_load_dword v55, v8, s[32:35], s15 offen sc1
    s_add_u32 s47, s47, 1
    s_cmp_ge_u32 s47, 16384
    s_cselect_b32 s12, -1, 0
    s_waitcnt vmcnt(0)
    v_cmp_eq_u32 vcc, s23, v55
    s_nop 1
    s_or_b32 s12, s12, vcc_lo
    s_lshr_b32 s12, s12, s93
    s_or_b32 s96, s96, s12
    s_andn2_b32 s96, s96, s14
    s_cbranch_scc0 L_pl11
L_pk11:
    s_ff1_i32_b32 s12, s96
    s_bitset0_b32 s96, s12
    s_bitset1_b32 s14, s12
    s_add_u32 s12, s12, s93
    s_and_b32 s83, s12, 15
    s_lshl_b32 s94, s83, 11
    s_add_u32 s94, s94, s95
    buffer_load_dwordx4 v[112:115], v17, s[32:35], s94 offen
    buffer_load_dwordx4 v[116:119], v17, s[32:35], s94 offen offset:1024
    s_mov_b32 s45, 1
    s_cmp_eq_u32 s46, 0
    s_cbranch_scc1 L_b_nold
    s_lshl_b32 s12, s89, 12
    s_add_u32 s12, s12, 458752
    buffer_load_dwordx4 v[224:227], v22, s[32:35], s12 offen offset:0 sc1
    buffer_load_dwordx4 v[228:231], v22, s[32:35], s12 offen offset:16 sc1
    buffer_load_dwordx4 v[232:235], v22, s[32:35], s12 offen offset:64 sc1
    buffer_load_dwordx4 v[236:239], v22, s[32:35], s12 offen offset:80 sc1
L_b_nold:
    s_add_u32 s12, s82, s97
    s_lshl_b32 s13, s12, 12
    s_cmp_ge_u32 s12, 8
    s_cselect_b32 s12, 24576, 0
    s_add_u32 s13, s13, s12
    v_add_u32 v12, s13, v10
    v_add_u32 v13, s13, v11
    s_waitcnt vmcnt(4)
    s_waitcnt lgkmcnt(6)
    v_mfma_f32_32x32x16_bf16 v[64:79], v[136:139], v[96:99], v[64:79]
    ds_read_b64_tr_b16 v[120:121], v12 offset:0
    ds_read_b64_tr_b16 v[122:123], v12 offset:1024
    s_waitcnt lgkmcnt(6)
    v_mfma_f32_32x32x16_bf16 v[80:95], v[140:143], v[96:99], v[80:95]
    ds_read_b64_tr_b16 v[124:125], v13 offset:0
    ds_read_b64_tr_b16 v[126:127], v13 offset:1024
    s_waitcnt lgkmcnt(6)
    v_mfma_f32_32x32x16_bf16 v[64:79], v[144:147], v[100:103], v[64:79]
    ds_read_b64_tr_b16 v[128:129], v12 offset:2048
    ds_read_b64_tr_b16 v[130:131], v12 offset:3072
    s_waitcnt lgkmcnt(6)
    v_mfma_f32_32x32x16_bf16 v[80:95], v[148:151], v[100:103], v[80:95]
    ds_read_b64_tr_b16 v[132:133], v13 offset:2048
    ds_read_b64_tr_b16 v[134:135], v13 offset:3072
    s_cmp_lg_u32 s96, 0
    s_cbranch_scc1 L_pk12
L_pl12:
    buffer_load_dword v56, v8, s[32:35], s15 offen sc1
    s_add_u32 s47, s47, 1
    s_cmp_ge_u32 s47, 16384
    s_cselect_b32 s12, -1, 0
    s_waitcnt vmcnt(0)
    v_cmp_eq_u32 vcc, s23, v56
    s_nop 1
    s_or_b32 s12, s12, vcc_lo
    s_lshr_b32 s12, s12, s93
    s_or_b32 s96, s96, s12
    s_andn2_b32 s96, s96, s14
    s_cbranch_scc0 L_pl12
L_pk12:
    s_ff1_i32_b32 s12, s96
    s_bitset0_b32 s96, s12
    s_bitset1_b32 s14, s12
    s_add_u32 s12, s12, s93
    s_and_b32 s84, s12, 15
    s_lshl_b32 s94, s84, 11
    s_add_u32 s94, s94, s95
    buffer_load_dwordx4 v[96:99], v17, s[32:35], s94 offen
    buffer_load_dwordx4 v[100:103], v17, s[32:35], s94 offen offset:1024
    s_add_u32 s12, s83, s97
    s_lshl_b32 s13, s12, 12
    s_cmp_ge_u32 s12, 8
    s_cselect_b32 s12, 24576, 0
    s_add_u32 s13, s13, s12
    v_add_u32 v14, s13, v10
    v_add_u32 v15, s13, v11
    s_waitcnt vmcnt(4)
    s_waitcnt lgkmcnt(6)
    v_mfma_f32_32x32x16_bf16 v[64:79], v[120:123], v[104:107], v[64:79]
    ds_read_b64_tr_b16 v[136:137], v14 offset:0
    ds_read_b64_tr_b16 v[138:139], v14 offset:1024
    s_waitcnt lgkmcnt(6)
    v_mfma_f32_32x32x16_bf16 v[80:95], v[124:127], v[104:107], v[80:95]
    ds_read_b64_tr_b16 v[140:141], v15 offset:0
    ds_read_b64_tr_b16 v[142:143], v15 offset:1024
    s_waitcnt lgkmcnt(6)
    v_mfma_f32_32x32x16_bf16 v[64:79], v[128:131], v[108:111], v[64:79]
    ds_read_b64_tr_b16 v[144:145], v14 offset:2048
    ds_read_b64_tr_b16 v[146:147], v14 offset:3072
    s_waitcnt lgkmcnt(6)
    v_mfma_f32_32x32x16_bf16 v[80:95], v[132:135], v[108:111], v[80:95]
    ds_read_b64_tr_b16 v[148:149], v15 offset:2048
    ds_read_b64_tr_b16 v[150:151], v15 offset:3072
    s_cmp_lg_u32 s96, 0
    s_cbranch_scc1 L_pk13
L_pl13:
    buffer_load_dword v57, v8, s[32:35], s15 offen sc1
    s_add_u32 s47, s47, 1
    s_cmp_ge_u32 s47, 16384
    s_cselect_b32 s12, -1, 0
    s_waitcnt vmcnt(0)
    v_cmp_eq_u32 vcc, s23, v57
    s_nop 1
    s_or_b32 s12, s12, vcc_lo
    s_lshr_b32 s12, s12, s93
    s_or_b32 s96, s96, s12
    s_andn2_b32 s96, s96, s14
    s_cbranch_scc0 L_pl13
L_pk13:
    s_ff1_i32_b32 s12, s96
    s_bitset0_b32 s96, s12
    s_bitset1_b32 s14, s12
    s_add_u32 s12, s12, s93
    s_and_b32 s85, s12, 15
    s_lshl_b32 s94, s85, 11
    s_add_u32 s94, s94, s95
    buffer_load_dwordx4 v[104:107], v17, s[32:35], s94 offen
    buffer_load_dwordx4 v[108:111], v17, s[32:35], s94 offen offset:1024
    s_cmp_lg_u32 s46, 0
    s_cbranch_scc1 L_own
L_own_r1:
    s_add_u32 s12, s84, s97
    s_lshl_b32 s13, s12, 12
    s_cmp_ge_u32 s12, 8
    s_cselect_b32 s12, 24576, 0
    s_add_u32 s13, s13, s12
    v_add_u32 v12, s13, v10
    v_add_u32 v13, s13, v11
    s_waitcnt vmcnt(4)
    s_waitcnt lgkmcnt(6)
    v_mfma_f32_32x32x16_bf16 v[64:79], v[136:139], v[112:115], v[64:79]
    ds_read_b64_tr_b16 v[120:121], v12 offset:0
    ds_read_b64_tr_b16 v[122:123], v12 offset:1024
    s_waitcnt lgkmcnt(6)
    v_mfma_f32_32x32x16_bf16 v[80:95], v[140:143], v[112:115], v[80:95]
    ds_read_b64_tr_b16 v[124:125], v13 offset:0
    ds_read_b64_tr_b16 v[126:127], v13 offset:1024
    s_waitcnt lgkmcnt(6)
    v_mfma_f32_32x32x16_bf16 v[64:79], v[144:147], v[116:119], v[64:79]
    ds_read_b64_tr_b16 v[128:129], v12 offset:2048
    ds_read_b64_tr_b16 v[130:131], v12 offset:3072
    s_waitcnt lgkmcnt(6)
    v_mfma_f32_32x32x16_bf16 v[80:95], v[148:151], v[116:119], v[80:95]
    ds_read_b64_tr_b16 v[132:133], v13 offset:2048
    ds_read_b64_tr_b16 v[134:135], v13 offset:3072
    s_cmp_lg_u32 s96, 0
    s_cbranch_scc1 L_pk14
L_pl14:
    buffer_load_dword v58, v8, s[32:35], s15 offen sc1
    s_add_u32 s47, s47, 1
    s_cmp_ge_u32 s47, 16384
    s_cselect_b32 s12, -1, 0
    s_waitcnt vmcnt(0)
    v_cmp_eq_u32 vcc, s23, v58
    s_nop 1
    s_or_b32 s12, s12, vcc_lo
    s_lshr_b32 s12, s12, s93
    s_or_b32 s96, s96, s12
    s_andn2_b32 s96, s96, s14
    s_cbranch_scc0 L_pl14
L_pk14:
    s_ff1_i32_b32 s12, s96
    s_bitset0_b32 s96, s12
    s_bitset1_b32 s14, s12
    s_add_u32 s12, s12, s93
    s_and_b32 s86, s12, 15
    s_lshl_b32 s94, s86, 11
    s_add_u32 s94, s94, s95
    buffer_load_dwordx4 v[112:115], v17, s[32:35], s94 offen
    buffer_load_dwordx4 v[116:119], v17, s[32:35], s94 offen offset:1024
    s_add_u32 s12, s85, s97
    s_lshl_b32 s13, s12, 12
    s_cmp_ge_u32 s12, 8
    s_cselect_b32 s12, 24576, 0
    s_add_u32 s13, s13, s12
    v_add_u32 v14, s13, v10
    v_add_u32 v15, s13, v11
    s_waitcnt vmcnt(4)
    s_waitcnt lgkmcnt(6)
    v_mfma_f32_32x32x16_bf16 v[64:79], v[120:123], v[96:99], v[64:79]
    ds_read_b64_tr_b16 v[136:137], v14 offset:0
    ds_read_b64_tr_b16 v[138:139], v14 offset:1024
    s_waitcnt lgkmcnt(6)
    v_mfma_f32_32x32x16_bf16 v[80:95], v[124:127], v[96:99], v[80:95]
    ds_read_b64_tr_b16 v[140:141], v15 offset:0
    ds_read_b64_tr_b16 v[142:143], v15 offset:1024
    s_waitcnt lgkmcnt(6)
    v_mfma_f32_32x32x16_bf16 v[64:79], v[128:131], v[100:103], v[64:79]
    ds_read_b64_tr_b16 v[144:145], v14 offset:2048
    ds_read_b64_tr_b16 v[146:147], v14 offset:3072
    s_waitcnt lgkmcnt(6)
    v_mfma_f32_32x32x16_bf16 v[80:95], v[132:135], v[100:103], v[80:95]
    ds_read_b64_tr_b16 v[148:149], v15 offset:2048
    ds_read_b64_tr_b16 v[150:151], v15 offset:3072
    s_cmp_lg_u32 s96, 0
    s_cbranch_scc1 L_pk15
L_pl15:
    buffer_load_dword v59, v8, s[32:35], s15 offen sc1
    s_add_u32 s47, s47, 1
    s_cmp_ge_u32 s47, 16384
    s_cselect_b32 s12, -1, 0
    s_waitcnt vmcnt(0)
    v_cmp_eq_u32 vcc, s23, v59
    s_nop 1
    s_or_b32 s12, s12, vcc_lo
    s_lshr_b32 s12, s12, s93
    s_or_b32 s96, s96, s12
    s_andn2_b32 s96, s96, s14
    s_cbranch_scc0 L_pl15
L_pk15:
    s_ff1_i32_b32 s12, s96
    s_bitset0_b32 s96, s12
    s_bitset1_b32 s14, s12
    s_add_u32 s12, s12, s93
    s_and_b32 s87, s12, 15
    s_lshl_b32 s94, s87, 11
    s_add_u32 s94, s94, s95
    buffer_load_dwordx4 v[96:99], v17, s[32:35], s94 offen
    buffer_load_dwordx4 v[100:103], v17, s[32:35], s94 offen offset:1024
    s_add_u32 s12, s86, s97
    s_lshl_b32 s13, s12, 12
    s_cmp_ge_u32 s12, 8
    s_cselect_b32 s12, 24576, 0
    s_add_u32 s13, s13, s12
    v_add_u32 v12, s13, v10
    v_add_u32 v13, s13, v11
    s_waitcnt vmcnt(4)
    s_waitcnt lgkmcnt(6)
    v_mfma_f32_32x32x16_bf16 v[64:79], v[136:139], v[104:107], v[64:79]
    ds_read_b64_tr_b16 v[120:121], v12 offset:0
    ds_read_b64_tr_b16 v[122:123], v12 offset:1024
    s_waitcnt lgkmcnt(6)
    v_mfma_f32_32x32x16_bf16 v[80:95], v[140:143], v[104:107], v[80:95]
    ds_read_b64_tr_b16 v[124:125], v13 offset:0
    ds_read_b64_tr_b16 v[126:127], v13 offset:1024
    s_waitcnt lgkmcnt(6)
    v_mfma_f32_32x32x16_bf16 v[64:79], v[144:147], v[108:111], v[64:79]
    ds_read_b64_tr_b16 v[128:129], v12 offset:2048
    ds_read_b64_tr_b16 v[130:131], v12 offset:3072
    s_waitcnt lgkmcnt(6)
    v_mfma_f32_32x32x16_bf16 v[80:95], v[148:151], v[108:111], v[80:95]
    ds_read_b64_tr_b16 v[132:133], v13 offset:2048
    ds_read_b64_tr_b16 v[134:135], v13 offset:3072
    s_add_u32 s12, s87, s97
    s_lshl_b32 s13, s12, 12
    s_cmp_ge_u32 s12, 8
    s_cselect_b32 s12, 24576, 0
    s_add_u32 s13, s13, s12
    v_add_u32 v14, s13, v10
    v_add_u32 v15, s13, v11
    s_waitcnt vmcnt(2)
    s_waitcnt lgkmcnt(6)
    v_mfma_f32_32x32x16_bf16 v[64:79], v[120:123], v[112:115], v[64:79]
    ds_read_b64_tr_b16 v[136:137], v14 offset:0
    ds_read_b64_tr_b16 v[138:139], v14 offset:1024
    s_waitcnt lgkmcnt(6)
    v_mfma_f32_32x32x16_bf16 v[80:95], v[124:127], v[112:115], v[80:95]
    ds_read_b64_tr_b16 v[140:141], v15 offset:0
    ds_read_b64_tr_b16 v[142:143], v15 offset:1024
    s_waitcnt lgkmcnt(6)
    v_mfma_f32_32x32x16_bf16 v[64:79], v[128:131], v[116:119], v[64:79]
    ds_read_b64_tr_b16 v[144:145], v14 offset:2048
    ds_read_b64_tr_b16 v[146:147], v14 offset:3072
    s_waitcnt lgkmcnt(6)
    v_mfma_f32_32x32x16_bf16 v[80:95], v[132:135], v[116:119], v[80:95]
    ds_read_b64_tr_b16 v[148:149], v15 offset:2048
    ds_read_b64_tr_b16 v[150:151], v15 offset:3072
    s_waitcnt vmcnt(0)
    s_waitcnt lgkmcnt(6)
    v_mfma_f32_32x32x16_bf16 v[64:79], v[136:139], v[96:99], v[64:79]
    s_waitcnt lgkmcnt(4)
    v_mfma_f32_32x32x16_bf16 v[80:95], v[140:143], v[96:99], v[80:95]
    s_waitcnt lgkmcnt(2)
    v_mfma_f32_32x32x16_bf16 v[64:79], v[144:147], v[100:103], v[64:79]
    s_waitcnt lgkmcnt(0)
    v_mfma_f32_32x32x16_bf16 v[80:95], v[148:151], v[100:103], v[80:95]
    s_nop 11
    v_permlane16_swap_b32 v64, v80
    v_permlane16_swap_b32 v65, v81
    v_permlane16_swap_b32 v66, v82
    v_permlane16_swap_b32 v67, v83
    v_permlane16_swap_b32 v68, v84
    v_permlane16_swap_b32 v69, v85
    v_permlane16_swap_b32 v70, v86
    v_permlane16_swap_b32 v71, v87
    v_permlane16_swap_b32 v72, v88
    v_permlane16_swap_b32 v73, v89
    v_permlane16_swap_b32 v74, v90
    v_permlane16_swap_b32 v75, v91
    v_permlane16_swap_b32 v76, v92
    v_permlane16_swap_b32 v77, v93
    v_permlane16_swap_b32 v78, v94
    v_permlane16_swap_b32 v79, v95
    ds_write_b128 v20, v[80:83] offset:0
    ds_write_b128 v20, v[84:87] offset:1024
    ds_write_b128 v20, v[88:91] offset:2048
    ds_write_b128 v20, v[92:95] offset:3072
    s_waitcnt lgkmcnt(0)
    v_bfe_u32 v9, v2, 3, 1
    v_mul_u32_u24 v9, 16352, v9
    v_sub_u32 v7, v7, v9
    s_mov_b32 s12, 16384
    s_barrier
    ds_read_b128 v[80:83], v21 offset:0
    ds_read_b128 v[84:87], v21 offset:1024
    ds_read_b128 v[88:91], v21 offset:2048
    ds_read_b128 v[92:95], v21 offset:3072
    s_waitcnt lgkmcnt(3)
    v_pk_add_f32 v[64:65], v[64:65], v[80:81]
    v_pk_add_f32 v[66:67], v[66:67], v[82:83]
    v_cvt_pk_bf16_f32 v96, v64, v65
    v_cvt_pk_bf16_f32 v97, v66, v67
    s_waitcnt lgkmcnt(2)
    v_pk_add_f32 v[68:69], v[68:69], v[84:85]
    v_pk_add_f32 v[70:71], v[70:71], v[86:87]
    v_cvt_pk_bf16_f32 v98, v68, v69
    v_cvt_pk_bf16_f32 v99, v70, v71
    s_waitcnt lgkmcnt(1)
    v_pk_add_f32 v[72:73], v[72:73], v[88:89]
    v_pk_add_f32 v[74:75], v[74:75], v[90:91]
    v_cvt_pk_bf16_f32 v100, v72, v73
    v_cvt_pk_bf16_f32 v101, v74, v75
    s_waitcnt lgkmcnt(0)
    v_pk_add_f32 v[76:77], v[76:77], v[92:93]
    v_pk_add_f32 v[78:79], v[78:79], v[94:95]
    v_cvt_pk_bf16_f32 v102, v76, v77
    v_cvt_pk_bf16_f32 v103, v78, v79
    v_permlane32_swap_b32 v96, v98
    v_permlane32_swap_b32 v97, v99
    v_permlane32_swap_b32 v100, v102
    v_permlane32_swap_b32 v101, v103
    v_lshlrev_b32 v104, 16, v96
    v_and_b32 v105, 0xffff0000, v96
    v_lshlrev_b32 v106, 16, v97
    v_and_b32 v107, 0xffff0000, v97
    v_lshlrev_b32 v108, 16, v98
    v_and_b32 v109, 0xffff0000, v98
    v_lshlrev_b32 v110, 16, v99
    v_and_b32 v111, 0xffff0000, v99
    v_pk_mul_f32 v[104:105], v[104:105], v[48:49] op_sel_hi:[1,0]
    v_pk_mul_f32 v[106:107], v[106:107], v[48:49] op_sel_hi:[1,0]
    v_pk_mul_f32 v[108:109], v[108:109], v[48:49] op_sel_hi:[1,0]
    v_pk_mul_f32 v[110:111], v[110:111], v[48:49] op_sel_hi:[1,0]
    v_cvt_pk_bf16_f32 v96, v104, v105
    v_cvt_pk_bf16_f32 v97, v106, v107
    v_cvt_pk_bf16_f32 v98, v108, v109
    v_cvt_pk_bf16_f32 v99, v110, v111
    v_lshlrev_b32 v104, 16, v96
    v_and_b32 v105, 0xffff0000, v96
    v_lshlrev_b32 v106, 16, v97
    v_and_b32 v107, 0xffff0000, v97
    v_lshlrev_b32 v108, 16, v98
    v_and_b32 v109, 0xffff0000, v98
    v_lshlrev_b32 v110, 16, v99
    v_and_b32 v111, 0xffff0000, v99
    v_pk_add_f32 v[104:105], v[104:105], v[32:33]
    v_pk_add_f32 v[106:107], v[106:107], v[34:35]
    v_pk_add_f32 v[108:109], v[108:109], v[36:37]
    v_pk_add_f32 v[110:111], v[110:111], v[38:39]
    v_cvt_pk_bf16_f32 v96, v104, v105
    v_cvt_pk_bf16_f32 v97, v106, v107
    v_cvt_pk_bf16_f32 v98, v108, v109
    v_cvt_pk_bf16_f32 v99, v110, v111
    v_lshlrev_b32 v112, 16, v100
    v_and_b32 v113, 0xffff0000, v100
    v_lshlrev_b32 v114, 16, v101
    v_and_b32 v115, 0xffff0000, v101
    v_lshlrev_b32 v116, 16, v102
    v_and_b32 v117, 0xffff0000, v102
    v_lshlrev_b32 v118, 16, v103
    v_and_b32 v119, 0xffff0000, v103
    v_pk_mul_f32 v[112:113], v[112:113], v[48:49] op_sel_hi:[1,0]
    v_pk_mul_f32 v[114:115], v[114:115], v[48:49] op_sel_hi:[1,0]
    v_pk_mul_f32 v[116:117], v[116:117], v[48:49] op_sel_hi:[1,0]
    v_pk_mul_f32 v[118:119], v[118:119], v[48:49] op_sel_hi:[1,0]
    v_cvt_pk_bf16_f32 v100, v112, v113
    v_cvt_pk_bf16_f32 v101, v114, v115
    v_cvt_pk_bf16_f32 v102, v116, v117
    v_cvt_pk_bf16_f32 v103, v118, v119
    v_lshlrev_b32 v112, 16, v100
    v_and_b32 v113, 0xffff0000, v100
    v_lshlrev_b32 v114, 16, v101
    v_and_b32 v115, 0xffff0000, v101
    v_lshlrev_b32 v116, 16, v102
    v_and_b32 v117, 0xffff0000, v102
    v_lshlrev_b32 v118, 16, v103
    v_and_b32 v119, 0xffff0000, v103
    v_pk_add_f32 v[112:113], v[112:113], v[40:41]
    v_pk_add_f32 v[114:115], v[114:115], v[42:43]
    v_pk_add_f32 v[116:117], v[116:117], v[44:45]
    v_pk_add_f32 v[118:119], v[118:119], v[46:47]
    v_cvt_pk_bf16_f32 v100, v112, v113
    v_cvt_pk_bf16_f32 v101, v114, v115
    v_cvt_pk_bf16_f32 v102, v116, v117
    v_cvt_pk_bf16_f32 v103, v118, v119
    v_mov_b32 v104, v100
    v_mov_b32 v105, v101
    v_mov_b32 v106, v102
    v_mov_b32 v107, v103
    v_mov_b32_dpp v100, v96 row_ror:8 row_mask:0xf bank_mask:0x3
    v_mov_b32_dpp v101, v97 row_ror:8 row_mask:0xf bank_mask:0x3
    v_mov_b32_dpp v102, v98 row_ror:8 row_mask:0xf bank_mask:0x3
    v_mov_b32_dpp v103, v99 row_ror:8 row_mask:0xf bank_mask:0x3
    v_mov_b32_dpp v96, v104 row_ror:8 row_mask:0xf bank_mask:0xc
    v_mov_b32_dpp v97, v105 row_ror:8 row_mask:0xf bank_mask:0xc
    v_mov_b32_dpp v98, v106 row_ror:8 row_mask:0xf bank_mask:0xc
    v_mov_b32_dpp v99, v107 row_ror:8 row_mask:0xf bank_mask:0xc
    buffer_store_dwordx4 v[96:99], v7, s[68:71], 0 offen sc1
    buffer_store_dwordx4 v[100:103], v7, s[68:71], s12 offen sc1
    s_endpgm
L_own:
    s_mov_b32 s13, 0
L_b_y:
    s_waitcnt vmcnt(0)
    v_msad_u8 v240, v224, s76, 0
    v_msad_u8 v240, v225, s77, v240
    v_msad_u8 v240, v226, s78, v240
    v_msad_u8 v240, v227, s79, v240
    v_msad_u8 v240, v228, s76, v240
    v_msad_u8 v240, v229, s77, v240
    v_msad_u8 v240, v230, s78, v240
    v_msad_u8 v240, v231, s79, v240
    v_msad_u8 v240, v232, s76, v240
    v_msad_u8 v240, v233, s77, v240
    v_msad_u8 v240, v234, s78, v240
    v_msad_u8 v240, v235, s79, v240
    v_msad_u8 v240, v236, s76, v240
    v_msad_u8 v240, v237, s77, v240
    v_msad_u8 v240, v238, s78, v240
    v_msad_u8 v240, v239, s79, v240
    v_cmp_ne_u32 vcc, 0, v240
    s_nop 1
    s_or_b32 s46, vcc_lo, vcc_hi
    s_cbranch_scc0 L_b_yok
    s_cmp_eq_u32 s45, 0
    s_cbranch_scc1 L_b_yok
    s_lshl_b32 s12, s89, 12
    s_add_u32 s12, s12, 458752
    buffer_load_dwordx4 v[224:227], v22, s[32:35], s12 offen offset:0 sc1
    buffer_load_dwordx4 v[228:231], v22, s[32:35], s12 offen offset:16 sc1
    buffer_load_dwordx4 v[232:235], v22, s[32:35], s12 offen offset:64 sc1
    buffer_load_dwordx4 v[236:239], v22, s[32:35], s12 offen offset:80 sc1
    s_add_u32 s13, s13, 1
    s_cmp_lt_u32 s13, 16384
    s_cbranch_scc1 L_b_y
    s_waitcnt vmcnt(0)
    s_mov_b32 s46, 0
L_b_yok:
    v_add_f32_dpp v224, v224, v224 row_ror:1 row_mask:0xf bank_mask:0xf
    v_add_f32_dpp v225, v225, v225 row_ror:1 row_mask:0xf bank_mask:0xf
    v_add_f32_dpp v226, v226, v226 row_ror:1 row_mask:0xf bank_mask:0xf
    v_add_f32_dpp v227, v227, v227 row_ror:1 row_mask:0xf bank_mask:0xf
    v_add_f32_dpp v228, v228, v228 row_ror:1 row_mask:0xf bank_mask:0xf
    v_add_f32_dpp v229, v229, v229 row_ror:1 row_mask:0xf bank_mask:0xf
    v_add_f32_dpp v230, v230, v230 row_ror:1 row_mask:0xf bank_mask:0xf
    v_add_f32_dpp v231, v231, v231 row_ror:1 row_mask:0xf bank_mask:0xf
    v_add_f32_dpp v232, v232, v232 row_ror:1 row_mask:0xf bank_mask:0xf
    v_add_f32_dpp v233, v233, v233 row_ror:1 row_mask:0xf bank_mask:0xf
    v_add_f32_dpp v234, v234, v234 row_ror:1 row_mask:0xf bank_mask:0xf
    v_add_f32_dpp v235, v235, v235 row_ror:1 row_mask:0xf bank_mask:0xf
    v_add_f32_dpp v236, v236, v236 row_ror:1 row_mask:0xf bank_mask:0xf
    v_add_f32_dpp v237, v237, v237 row_ror:1 row_mask:0xf bank_mask:0xf
    v_add_f32_dpp v238, v238, v238 row_ror:1 row_mask:0xf bank_mask:0xf
    v_add_f32_dpp v239, v239, v239 row_ror:1 row_mask:0xf bank_mask:0xf
    v_add_f32_dpp v224, v224, v224 row_ror:2 row_mask:0xf bank_mask:0xf
    v_add_f32_dpp v225, v225, v225 row_ror:2 row_mask:0xf bank_mask:0xf
    v_add_f32_dpp v226, v226, v226 row_ror:2 row_mask:0xf bank_mask:0xf
    v_add_f32_dpp v227, v227, v227 row_ror:2 row_mask:0xf bank_mask:0xf
    v_add_f32_dpp v228, v228, v228 row_ror:2 row_mask:0xf bank_mask:0xf
    v_add_f32_dpp v229, v229, v229 row_ror:2 row_mask:0xf bank_mask:0xf
    v_add_f32_dpp v230, v230, v230 row_ror:2 row_mask:0xf bank_mask:0xf
    v_add_f32_dpp v231, v231, v231 row_ror:2 row_mask:0xf bank_mask:0xf
    v_add_f32_dpp v232, v232, v232 row_ror:2 row_mask:0xf bank_mask:0xf
    v_add_f32_dpp v233, v233, v233 row_ror:2 row_mask:0xf bank_mask:0xf
    v_add_f32_dpp v234, v234, v234 row_ror:2 row_mask:0xf bank_mask:0xf
    v_add_f32_dpp v235, v235, v235 row_ror:2 row_mask:0xf bank_mask:0xf
    v_add_f32_dpp v236, v236, v236 row_ror:2 row_mask:0xf bank_mask:0xf
    v_add_f32_dpp v237, v237, v237 row_ror:2 row_mask:0xf bank_mask:0xf
    v_add_f32_dpp v238, v238, v238 row_ror:2 row_mask:0xf bank_mask:0xf
    v_add_f32_dpp v239, v239, v239 row_ror:2 row_mask:0xf bank_mask:0xf
    v_add_f32_dpp v224, v224, v224 row_ror:4 row_mask:0xf bank_mask:0xf
    v_add_f32_dpp v225, v225, v225 row_ror:4 row_mask:0xf bank_mask:0xf
    v_add_f32_dpp v226, v226, v226 row_ror:4 row_mask:0xf bank_mask:0xf
    v_add_f32_dpp v227, v227, v227 row_ror:4 row_mask:0xf bank_mask:0xf
    v_add_f32_dpp v228, v228, v228 row_ror:4 row_mask:0xf bank_mask:0xf
    v_add_f32_dpp v229, v229, v229 row_ror:4 row_mask:0xf bank_mask:0xf
    v_add_f32_dpp v230, v230, v230 row_ror:4 row_mask:0xf bank_mask:0xf
    v_add_f32_dpp v231, v231, v231 row_ror:4 row_mask:0xf bank_mask:0xf
    v_add_f32_dpp v232, v232, v232 row_ror:4 row_mask:0xf bank_mask:0xf
    v_add_f32_dpp v233, v233, v233 row_ror:4 row_mask:0xf bank_mask:0xf
    v_add_f32_dpp v234, v234, v234 row_ror:4 row_mask:0xf bank_mask:0xf
    v_add_f32_dpp v235, v235, v235 row_ror:4 row_mask:0xf bank_mask:0xf
    v_add_f32_dpp v236, v236, v236 row_ror:4 row_mask:0xf bank_mask:0xf
    v_add_f32_dpp v237, v237, v237 row_ror:4 row_mask:0xf bank_mask:0xf
    v_add_f32_dpp v238, v238, v238 row_ror:4 row_mask:0xf bank_mask:0xf
    v_add_f32_dpp v239, v239, v239 row_ror:4 row_mask:0xf bank_mask:0xf
    v_add_f32_dpp v224, v224, v224 row_ror:8 row_mask:0xf bank_mask:0xf
    v_add_f32_dpp v225, v225, v225 row_ror:8 row_mask:0xf bank_mask:0xf
    v_add_f32_dpp v226, v226, v226 row_ror:8 row_mask:0xf bank_mask:0xf
    v_add_f32_dpp v227, v227, v227 row_ror:8 row_mask:0xf bank_mask:0xf
    v_add_f32_dpp v228, v228, v228 row_ror:8 row_mask:0xf bank_mask:0xf
    v_add_f32_dpp v229, v229, v229 row_ror:8 row_mask:0xf bank_mask:0xf
    v_add_f32_dpp v230, v230, v230 row_ror:8 row_mask:0xf bank_mask:0xf
    v_add_f32_dpp v231, v231, v231 row_ror:8 row_mask:0xf bank_mask:0xf
    v_add_f32_dpp v232, v232, v232 row_ror:8 row_mask:0xf bank_mask:0xf
    v_add_f32_dpp v233, v233, v233 row_ror:8 row_mask:0xf bank_mask:0xf
    v_add_f32_dpp v234, v234, v234 row_ror:8 row_mask:0xf bank_mask:0xf
    v_add_f32_dpp v235, v235, v235 row_ror:8 row_mask:0xf bank_mask:0xf
    v_add_f32_dpp v236, v236, v236 row_ror:8 row_mask:0xf bank_mask:0xf
    v_add_f32_dpp v237, v237, v237 row_ror:8 row_mask:0xf bank_mask:0xf
    v_add_f32_dpp v238, v238, v238 row_ror:8 row_mask:0xf bank_mask:0xf
    v_add_f32_dpp v239, v239, v239 row_ror:8 row_mask:0xf bank_mask:0xf
    v_cvt_pk_bf16_f32 v240, v224, v225
    v_cvt_pk_bf16_f32 v241, v226, v227
    v_cvt_pk_bf16_f32 v242, v228, v229
    v_cvt_pk_bf16_f32 v243, v230, v231
    v_cvt_pk_bf16_f32 v244, v232, v233
    v_cvt_pk_bf16_f32 v245, v234, v235
    v_cvt_pk_bf16_f32 v246, v236, v237
    v_cvt_pk_bf16_f32 v247, v238, v239
    v_lshlrev_b32 v224, 16, v240
    v_and_b32 v225, 0xffff0000, v240
    v_lshlrev_b32 v226, 16, v241
    v_and_b32 v227, 0xffff0000, v241
    v_lshlrev_b32 v228, 16, v242
    v_and_b32 v229, 0xffff0000, v242
    v_lshlrev_b32 v230, 16, v243
    v_and_b32 v231, 0xffff0000, v243
    v_lshlrev_b32 v232, 16, v244
    v_and_b32 v233, 0xffff0000, v244
    v_lshlrev_b32 v234, 16, v245
    v_and_b32 v235, 0xffff0000, v245
    v_lshlrev_b32 v236, 16, v246
    v_and_b32 v237, 0xffff0000, v246
    v_lshlrev_b32 v238, 16, v247
    v_and_b32 v239, 0xffff0000, v247
    v_pk_mul_f32 v[224:225], v[224:225], s[22:23] op_sel_hi:[1,0]
    v_pk_mul_f32 v[226:227], v[226:227], s[22:23] op_sel_hi:[1,0]
    v_pk_mul_f32 v[228:229], v[228:229], s[22:23] op_sel_hi:[1,0]
    v_pk_mul_f32 v[230:231], v[230:231], s[22:23] op_sel_hi:[1,0]
    v_pk_mul_f32 v[232:233], v[232:233], s[22:23] op_sel_hi:[1,0]
    v_pk_mul_f32 v[234:235], v[234:235], s[22:23] op_sel_hi:[1,0]
    v_pk_mul_f32 v[236:237], v[236:237], s[22:23] op_sel_hi:[1,0]
    v_pk_mul_f32 v[238:239], v[238:239], s[22:23] op_sel_hi:[1,0]
    v_cvt_pk_bf16_f32 v240, v224, v225
    v_cvt_pk_bf16_f32 v241, v226, v227
    v_cvt_pk_bf16_f32 v242, v228, v229
    v_cvt_pk_bf16_f32 v243, v230, v231
    v_cvt_pk_bf16_f32 v244, v232, v233
    v_cvt_pk_bf16_f32 v245, v234, v235
    v_cvt_pk_bf16_f32 v246, v236, v237
    v_cvt_pk_bf16_f32 v247, v238, v239
    v_lshlrev_b32 v224, 16, v240
    v_and_b32 v225, 0xffff0000, v240
    v_lshlrev_b32 v226, 16, v241
    v_and_b32 v227, 0xffff0000, v241
    v_lshlrev_b32 v228, 16, v242
    v_and_b32 v229, 0xffff0000, v242
    v_lshlrev_b32 v230, 16, v243
    v_and_b32 v231, 0xffff0000, v243
    v_lshlrev_b32 v232, 16, v244
    v_and_b32 v233, 0xffff0000, v244
    v_lshlrev_b32 v234, 16, v245
    v_and_b32 v235, 0xffff0000, v245
    v_lshlrev_b32 v236, 16, v246
    v_and_b32 v237, 0xffff0000, v246
    v_lshlrev_b32 v238, 16, v247
    v_and_b32 v239, 0xffff0000, v247
    v_lshlrev_b32 v32, 16, v24
    v_and_b32 v33, 0xffff0000, v24
    v_lshlrev_b32 v34, 16, v25
    v_and_b32 v35, 0xffff0000, v25
    v_lshlrev_b32 v36, 16, v26
    v_and_b32 v37, 0xffff0000, v26
    v_lshlrev_b32 v38, 16, v27
    v_and_b32 v39, 0xffff0000, v27
    v_lshlrev_b32 v40, 16, v28
    v_and_b32 v41, 0xffff0000, v28
    v_lshlrev_b32 v42, 16, v29
    v_and_b32 v43, 0xffff0000, v29
    v_lshlrev_b32 v44, 16, v30
    v_and_b32 v45, 0xffff0000, v30
    v_lshlrev_b32 v46, 16, v31
    v_and_b32 v47, 0xffff0000, v31
    v_pk_add_f32 v[224:225], v[224:225], v[32:33]
    v_pk_add_f32 v[226:227], v[226:227], v[34:35]
    v_pk_add_f32 v[228:229], v[228:229], v[36:37]
    v_pk_add_f32 v[230:231], v[230:231], v[38:39]
    v_pk_add_f32 v[232:233], v[232:233], v[40:41]
    v_pk_add_f32 v[234:235], v[234:235], v[42:43]
    v_pk_add_f32 v[236:237], v[236:237], v[44:45]
    v_pk_add_f32 v[238:239], v[238:239], v[46:47]
    v_cvt_pk_bf16_f32 v240, v224, v225
    v_cvt_pk_bf16_f32 v241, v226, v227
    v_cvt_pk_bf16_f32 v242, v228, v229
    v_cvt_pk_bf16_f32 v243, v230, v231
    v_cvt_pk_bf16_f32 v244, v232, v233
    v_cvt_pk_bf16_f32 v245, v234, v235
    v_cvt_pk_bf16_f32 v246, v236, v237
    v_cvt_pk_bf16_f32 v247, v238, v239
    s_cmp_eq_u32 s46, 0
    s_cselect_b32 s12, s21, -1
    v_cmp_eq_u32 vcc, s12, v6
    s_nop 1
    v_cndmask_b32 v24, v24, v240, vcc
    v_cndmask_b32 v25, v25, v241, vcc
    v_cndmask_b32 v26, v26, v242, vcc
    v_cndmask_b32 v27, v27, v243, vcc
    v_cndmask_b32 v28, v28, v244, vcc
    v_cndmask_b32 v29, v29, v245, vcc
    v_cndmask_b32 v30, v30, v246, vcc
    v_cndmask_b32 v31, v31, v247, vcc
    v_lshlrev_b32 v32, 16, v24
    v_and_b32 v33, 0xffff0000, v24
    v_lshlrev_b32 v34, 16, v25
    v_and_b32 v35, 0xffff0000, v25
    v_lshlrev_b32 v36, 16, v26
    v_and_b32 v37, 0xffff0000, v26
    v_lshlrev_b32 v38, 16, v27
    v_and_b32 v39, 0xffff0000, v27
    v_lshlrev_b32 v40, 16, v28
    v_and_b32 v41, 0xffff0000, v28
    v_lshlrev_b32 v42, 16, v29
    v_and_b32 v43, 0xffff0000, v29
    v_lshlrev_b32 v44, 16, v30
    v_and_b32 v45, 0xffff0000, v30
    v_lshlrev_b32 v46, 16, v31
    v_and_b32 v47, 0xffff0000, v31
    v_pk_mul_f32 v[32:33], v[32:33], v[50:51] op_sel_hi:[1,0]
    v_pk_mul_f32 v[34:35], v[34:35], v[50:51] op_sel_hi:[1,0]
    v_pk_mul_f32 v[36:37], v[36:37], v[50:51] op_sel_hi:[1,0]
    v_pk_mul_f32 v[38:39], v[38:39], v[50:51] op_sel_hi:[1,0]
    v_pk_mul_f32 v[40:41], v[40:41], v[50:51] op_sel_hi:[1,0]
    v_pk_mul_f32 v[42:43], v[42:43], v[50:51] op_sel_hi:[1,0]
    v_pk_mul_f32 v[44:45], v[44:45], v[50:51] op_sel_hi:[1,0]
    v_pk_mul_f32 v[46:47], v[46:47], v[50:51] op_sel_hi:[1,0]
    v_cvt_pk_bf16_f32 v33, v32, v33
    v_cvt_pk_bf16_f32 v35, v34, v35
    v_cvt_pk_bf16_f32 v37, v36, v37
    v_cvt_pk_bf16_f32 v39, v38, v39
    v_cvt_pk_bf16_f32 v41, v40, v41
    v_cvt_pk_bf16_f32 v43, v42, v43
    v_cvt_pk_bf16_f32 v45, v44, v45
    v_cvt_pk_bf16_f32 v47, v46, v47
    v_lshlrev_b32 v32, 16, v33
    v_and_b32 v33, 0xffff0000, v33
    v_lshlrev_b32 v34, 16, v35
    v_and_b32 v35, 0xffff0000, v35
    v_lshlrev_b32 v36, 16, v37
    v_and_b32 v37, 0xffff0000, v37
    v_lshlrev_b32 v38, 16, v39
    v_and_b32 v39, 0xffff0000, v39
    v_lshlrev_b32 v40, 16, v41
    v_and_b32 v41, 0xffff0000, v41
    v_lshlrev_b32 v42, 16, v43
    v_and_b32 v43, 0xffff0000, v43
    v_lshlrev_b32 v44, 16, v45
    v_and_b32 v45, 0xffff0000, v45
    v_lshlrev_b32 v46, 16, v47
    v_and_b32 v47, 0xffff0000, v47
    s_branch L_own_r1
L_end:
    s_endpgm
.section .rodata,"a"
.p2align 6
.amdhsa_kernel gated_mix__linear_kernel_hedgehog__moe_arch_mod__prompt_kernel
  .amdhsa_next_free_vgpr 256
  .amdhsa_next_free_sgpr 102
  .amdhsa_accum_offset 256
  .amdhsa_group_segment_fixed_size 0
  .amdhsa_kernarg_size 104
  .amdhsa_user_sgpr_count 2
  .amdhsa_user_sgpr_kernarg_segment_ptr 1
  .amdhsa_system_sgpr_workgroup_id_x 1
.end_amdhsa_kernel
```

```asm
; @launch grid=(256,1,1) block=(512,1,1) lds=163840
.amdgcn_target "amdgcn-amd-amdhsa--gfx950"
.text
.globl gated_mix__linear_kernel_hedgehog__moe_arch_mod__prompt_kernel
.p2align 12
.p2align 8
.type gated_mix__linear_kernel_hedgehog__moe_arch_mod__prompt_kernel,@function
gated_mix__linear_kernel_hedgehog__moe_arch_mod__prompt_kernel:
    s_cmp_ge_u32 s2, 256
    s_cbranch_scc1 L_end
    s_load_dwordx4 s[4:7], s[0:1], 0
    s_load_dwordx4 s[8:11], s[0:1], 16
    s_load_dwordx16 s[48:63], s[0:1], 40
    v_lshrrev_b32 v1, 6, v0
    v_and_b32 v2, 63, v0
    v_readfirstlane_b32 s20, v1
    s_and_b32 s16, s2, 7
    s_lshr_b32 s17, s2, 3
    s_and_b32 s18, s16, 1
    s_lshl_b32 s18, s18, 3
    s_and_b32 s19, s17, 7
    s_add_u32 s18, s18, s19
    s_lshr_b32 s19, s16, 1
    s_lshl_b32 s19, s19, 2
    s_lshr_b32 s12, s17, 3
    s_add_u32 s19, s19, s12
    v_lshlrev_b32 v5, 4, v2
    s_cmp_lt_u32 s20, 4
    s_cbranch_scc1 L_compute
    s_sub_u32 s21, s20, 4
    s_mov_b32 s68, 0x76543210
    s_mov_b32 s69, 0xfedcba98
    s_lshl_b32 s12, s16, 1
    s_mul_i32 s12, s12, 0x11111111
    s_xor_b32 s68, s68, s12
    s_xor_b32 s69, s69, s12
    v_lshrrev_b32 v4, 3, v2
    v_lshlrev_b32 v9, 11, v4
    v_and_b32 v6, 7, v2
    v_lshrrev_b32 v7, 4, v2
    v_xor_b32 v8, v6, v7
    v_lshl_add_u32 v10, v8, 4, v9
    v_xor_b32 v8, 4, v8
    v_lshl_add_u32 v11, v8, 4, v9
    v_mul_u32_u24 v12, 6144, v4
    v_and_b32 v7, 1, v7
    v_lshlrev_b32 v7, 2, v7
    v_xor_b32 v8, v6, v7
    v_lshl_add_u32 v12, v8, 4, v12
    s_lshl_b32 s12, s18, 18
    s_lshl_b32 s13, s21, 16
    s_add_u32 s12, s12, s13
    s_add_u32 s13, s12, 0
    v_add_u32 v20, s13, v10
    s_add_u32 s13, s12, 15360
    v_add_u32 v21, s13, v11
    s_add_u32 s13, s12, 30720
    v_add_u32 v22, s13, v10
    s_add_u32 s13, s12, 46080
    v_add_u32 v23, s13, v11
    s_lshl_b32 s12, s19, 7
    s_mul_i32 s14, s21, 6
    s_mul_i32 s14, s21, 98304
    s_add_u32 s14, s14, s12
    s_add_u32 s13, s14, 2048
    v_add_u32 v24, s13, v12
    s_add_u32 s13, s14, 50176
    v_add_u32 v25, s13, v12
    s_add_u32 s13, s14, 4096
    v_add_u32 v26, s13, v12
    s_add_u32 s13, s14, 52224
    v_add_u32 v27, s13, v12
    s_add_u32 s13, s14, 0
    v_add_u32 v28, s13, v12
    s_add_u32 s13, s14, 48128
    v_add_u32 v29, s13, v12
    s_lshl_b32 s94, s21, 12
    s_mul_i32 s95, s21, 6144
    s_add_u32 s95, s95, 16384
    s_lshl_b32 s95, s21, 11
    s_waitcnt lgkmcnt(0)
    s_mov_b32 s24, s4
    s_and_b32 s25, s5, 0xffff
    s_mov_b32 s26, 4194304
    s_mov_b32 s27, 0x00020000
    s_mov_b32 s28, s6
    s_and_b32 s29, s7, 0xffff
    s_mov_b32 s30, 6291456
    s_mov_b32 s31, 0x00020000
    s_bfe_u32 s91, s68, 0x40000
    s_lshl_b32 s92, s91, 7
    s_mul_i32 s93, s91, 393216
    s_add_u32 m0, s94, 0
    s_nop 0
    buffer_load_dwordx4 v20, s[24:27], s92 offen offset:0 lds
    buffer_load_dwordx4 v21, s[24:27], s92 offen offset:1024 lds
    buffer_load_dwordx4 v22, s[24:27], s92 offen offset:2048 lds
    buffer_load_dwordx4 v23, s[24:27], s92 offen offset:3072 lds
    s_add_u32 m0, s95, 24576
    s_nop 0
    buffer_load_dwordx4 v24, s[28:31], s93 offen offset:0 lds
    buffer_load_dwordx4 v25, s[28:31], s93 offen offset:1024 lds
    s_add_u32 m0, s95, 32768
    s_nop 0
    buffer_load_dwordx4 v26, s[28:31], s93 offen offset:0 lds
    buffer_load_dwordx4 v27, s[28:31], s93 offen offset:1024 lds
    s_add_u32 m0, s95, 16384
    s_nop 0
    buffer_load_dwordx4 v28, s[28:31], s93 offen offset:0 lds
    buffer_load_dwordx4 v29, s[28:31], s93 offen offset:1024 lds
    s_bfe_u32 s91, s68, 0x40004
    s_lshl_b32 s92, s91, 7
    s_mul_i32 s93, s91, 393216
    s_add_u32 m0, s94, 40960
    s_nop 0
    buffer_load_dwordx4 v20, s[24:27], s92 offen offset:0 lds
    buffer_load_dwordx4 v21, s[24:27], s92 offen offset:1024 lds
    buffer_load_dwordx4 v22, s[24:27], s92 offen offset:2048 lds
    buffer_load_dwordx4 v23, s[24:27], s92 offen offset:3072 lds
    s_add_u32 m0, s95, 65536
    s_nop 0
    buffer_load_dwordx4 v24, s[28:31], s93 offen offset:0 lds
    buffer_load_dwordx4 v25, s[28:31], s93 offen offset:1024 lds
    s_mov_b32 s32, s62
    s_and_b32 s33, s63, 0xffff
    s_mov_b32 s34, 33554432
    s_mov_b32 s35, 0x00020000
    s_mov_b32 s36, s10
    s_and_b32 s37, s11, 0xffff
    s_mov_b32 s38, 2097152
    s_mov_b32 s39, 0x00020000
    s_mov_b32 s40, s50
    s_and_b32 s41, s51, 0xffff
    s_mov_b32 s42, 7340032
    s_mov_b32 s43, 0x00020000
    s_mov_b32 s44, s52
    s_and_b32 s45, s53, 0xffff
    s_mov_b32 s46, 7340032
    s_mov_b32 s47, 0x00020000
    s_mov_b32 s64, s54
    s_and_b32 s65, s55, 0xffff
    s_mov_b32 s66, 7340032
    s_mov_b32 s67, 0x00020000
    s_mov_b32 s72, s60
    s_and_b32 s73, s61, 0xffff
    s_mov_b32 s74, 256
    s_mov_b32 s75, 0x00020000
    s_mov_b32 s76, s8
    s_and_b32 s77, s9, 0xffff
    s_mov_b32 s78, 65536
    s_mov_b32 s79, 0x00020000
    s_mov_b32 s80, s48
    s_and_b32 s81, s49, 0xffff
    s_mov_b32 s82, 2048
    s_mov_b32 s83, 0x00020000
    s_mov_b32 s84, s56
    s_and_b32 s85, s57, 0xffff
    s_mov_b32 s86, 2048
    s_mov_b32 s87, 0x00020000
    s_cmp_gt_u32 s19, 3
    s_subb_u32 s10, s19, 0
    s_cmp_gt_u32 s19, 11
    s_subb_u32 s10, s10, 0
    s_lshl_b32 s10, s10, 4
    s_add_u32 s10, s10, s18
    s_and_b32 s12, s19, 7
    s_cmp_eq_u32 s12, 3
    s_cselect_b32 s10, 224, s10
    s_xor_b32 s11, s18, 2
    s_lshl_b32 s11, s11, 4
    s_add_u32 s11, s11, s19
    s_lshl_b32 s11, s19, 4
    s_add_u32 s11, s11, s18
    s_cmp_lt_u32 s10, 224
    s_cselect_b32 s42, s42, 0
    s_cselect_b32 s46, s46, 0
    s_and_b32 s88, s16, 1
    s_lshl_b32 s88, s88, 3
    s_lshr_b32 s89, s16, 1
    s_lshl_b32 s89, s89, 1
    s_add_u32 s88, s88, s89
    s_lshr_b32 s89, s17, 4
    s_add_u32 s88, s88, s89
    s_and_b32 s89, s17, 15
    v_mov_b32 v13, 0
    v_mul_u32_u24 v30, 57344, v4
    v_lshl_add_u32 v30, v6, 4, v30
    v_lshl_add_u32 v31, v6, 4, v9
    v_lshl_add_u32 v33, v8, 4, v9
    s_lshl_b32 s12, s89, 7
    v_add_u32 v33, s12, v33
    v_lshlrev_b32 v34, 4, v4
    s_and_b32 s12, s10, 3
    s_lshl_b32 s12, s12, 8
    s_lshl_b32 s13, s21, 6
    s_add_u32 s70, s12, s13
    s_mul_i32 s71, s70, 7168
    s_lshr_b32 s12, s10, 2
    s_lshl_b32 s12, s12, 7
    s_add_u32 s71, s71, s12
    s_and_b32 s12, s11, 15
    s_mul_i32 s12, s12, 224
    s_mul_i32 s13, s21, 56
    s_add_u32 s96, s12, s13
    s_lshl_b32 s97, s96, 11
    s_lshr_b32 s12, s11, 4
    s_lshl_b32 s12, s12, 7
    s_add_u32 s97, s97, s12
    s_lshl_b32 s22, s18, 7
    s_lshl_b32 s12, s19, 3
    s_add_u32 s22, s22, s12
    s_lshl_b32 s12, s21, 1
    s_add_u32 s22, s22, s12
    s_xor_b32 s9, s71, 512
    s_and_b32 s12, s18, 7
    s_lshl_b32 s12, s12, 2
    s_add_u32 s12, s12, s21
    s_mul_i32 s12, s12, 6
    v_add_u32 v32, s12, v2
    v_lshrrev_b32 v11, 6, v32
    v_and_b32 v32, 63, v32
    v_mul_u32_u24 v32, 6144, v32
    v_lshl_add_u32 v32, v11, 11, v32
    s_lshl_b32 s12, s19, 7
    v_add_u32 v32, s12, v32
    s_lshl_b32 s12, s2, 6
    s_lshl_b32 s13, s21, 4
    s_add_u32 s12, s12, s13
    v_add_u32 v10, s12, v2
    v_lshlrev_b32 v10, 7, v10
    s_lshl_b32 s12, s17, 6
    s_add_u32 s12, s12, s13
    s_sub_u32 s12, s12, 16
    v_add_u32 v11, s12, v2
    v_and_b32 v12, 1, v11
    v_lshrrev_b32 v11, 1, v11
    v_lshlrev_b32 v11, 11, v11
    v_lshl_add_u32 v11, v12, 10, v11
    v_add_u32 v11, 384, v11
    v_cmp_gt_u32 vcc, 16, v2
    s_nop 1
    v_cndmask_b32 v10, v11, v10, vcc
    s_mul_i32 s12, s2, 13108
    s_lshr_b32 s12, s12, 16
    s_mul_i32 s12, s12, 5
    s_sub_u32 s3, s2, s12
    s_cmp_ge_u32 s10, 224
    s_cselect_b32 s3, 0, s3
    s_cmp_eq_u32 s3, 1
    s_cbranch_scc1 L_var1
    s_cmp_eq_u32 s3, 2
    s_cbranch_scc1 L_var2
    s_cmp_eq_u32 s3, 3
    s_cbranch_scc1 L_var3
    s_cmp_eq_u32 s3, 4
    s_cbranch_scc1 L_var4
    s_branch L_var0
.fill 818, 4, 0xbf800000
L_var0:
    s_nop 0
    s_waitcnt vmcnt(6)
    s_barrier
    s_add_u32 m0, s95, 73728
    s_nop 0
    buffer_load_dwordx4 v26, s[28:31], s93 offen offset:0 lds
    buffer_load_dwordx4 v27, s[28:31], s93 offen offset:1024 lds
    s_add_u32 m0, s95, 57344
    s_nop 0
    buffer_load_dwordx4 v28, s[28:31], s93 offen offset:0 lds
    buffer_load_dwordx4 v29, s[28:31], s93 offen offset:1024 lds
    s_bfe_u32 s91, s68, 0x40008
    s_lshl_b32 s92, s91, 7
    s_mul_i32 s93, s91, 393216
    s_add_u32 m0, s94, 81920
    s_nop 0
    buffer_load_dwordx4 v20, s[24:27], s92 offen offset:0 lds
    buffer_load_dwordx4 v21, s[24:27], s92 offen offset:1024 lds
    buffer_load_dwordx4 v22, s[24:27], s92 offen offset:2048 lds
    buffer_load_dwordx4 v23, s[24:27], s92 offen offset:3072 lds
    s_add_u32 m0, s95, 106496
    s_nop 0
    buffer_load_dwordx4 v24, s[28:31], s93 offen offset:0 lds
    buffer_load_dwordx4 v25, s[28:31], s93 offen offset:1024 lds
    s_add_u32 m0, s95, 114688
    s_nop 0
    buffer_load_dwordx4 v26, s[28:31], s93 offen offset:0 lds
    buffer_load_dwordx4 v27, s[28:31], s93 offen offset:1024 lds
    s_add_u32 m0, s95, 98304
    s_nop 0
    buffer_load_dwordx4 v28, s[28:31], s93 offen offset:0 lds
    buffer_load_dwordx4 v29, s[28:31], s93 offen offset:1024 lds
    s_lshl_b32 s12, s19, 2
    s_add_u32 s12, s12, s21
    s_lshl_b32 s12, s12, 10
    s_lshl_b32 s13, s21, 10
    s_add_u32 m0, s13, 155648
    s_nop 0
    buffer_load_dwordx4 v5, s[76:79], s12 offen lds
    s_lshl_b32 s12, s22, 11
    buffer_load_dwordx4 v[40:43], v5, s[24:27], s12 offen offset:0
    buffer_load_dwordx4 v[44:47], v5, s[24:27], s12 offen offset:1024
    buffer_load_dwordx4 v[48:51], v5, s[24:27], s12 offen offset:2048
    buffer_load_dwordx4 v[52:55], v5, s[24:27], s12 offen offset:3072
    buffer_load_dwordx4 v[56:59], v5, s[80:83], 0 offen offset:0
    buffer_load_dwordx4 v[60:63], v5, s[80:83], 0 offen offset:1024
    buffer_load_dwordx4 v[64:67], v5, s[84:87], 0 offen offset:0
    buffer_load_dwordx4 v[68:71], v5, s[84:87], 0 offen offset:1024
    s_cmp_ge_u32 s10, 224
    s_cbranch_scc1 L_p30_0
    s_add_u32 s12, s71, 0
    buffer_load_dwordx4 v[128:131], v30, s[40:43], s12 offen nt
    s_add_u32 s12, s71, 7168
    buffer_load_dwordx4 v[132:135], v30, s[40:43], s12 offen nt
    s_add_u32 s12, s71, 14336
    buffer_load_dwordx4 v[136:139], v30, s[40:43], s12 offen nt
    s_add_u32 s12, s71, 21504
    buffer_load_dwordx4 v[140:143], v30, s[40:43], s12 offen nt
    s_add_u32 s12, s71, 28672
    buffer_load_dwordx4 v[144:147], v30, s[40:43], s12 offen nt
    s_add_u32 s12, s71, 35840
    buffer_load_dwordx4 v[148:151], v30, s[40:43], s12 offen nt
    s_add_u32 s12, s71, 43008
    buffer_load_dwordx4 v[152:155], v30, s[40:43], s12 offen nt
    s_add_u32 s12, s71, 50176
    buffer_load_dwordx4 v[156:159], v30, s[40:43], s12 offen nt
    s_branch L_p3e0_0
L_p30_0:
    s_mov_b64 exec, 63
    s_bfe_u32 s12, s68, 0x4000c
    s_mul_i32 s12, s12, 393216
    buffer_load_dword v128, v32, s[28:31], s12 offen
    s_bfe_u32 s12, s68, 0x40010
    s_mul_i32 s12, s12, 393216
    buffer_load_dword v132, v32, s[28:31], s12 offen
    s_bfe_u32 s12, s68, 0x40014
    s_mul_i32 s12, s12, 393216
    buffer_load_dword v136, v32, s[28:31], s12 offen
    s_bfe_u32 s12, s68, 0x40018
    s_mul_i32 s12, s12, 393216
    buffer_load_dword v140, v32, s[28:31], s12 offen
    s_bfe_u32 s12, s68, 0x4001c
    s_mul_i32 s12, s12, 393216
    buffer_load_dword v144, v32, s[28:31], s12 offen
    s_bfe_u32 s12, s69, 0x40000
    s_mul_i32 s12, s12, 393216
    buffer_load_dword v148, v32, s[28:31], s12 offen
    s_bfe_u32 s12, s69, 0x40004
    s_mul_i32 s12, s12, 393216
    buffer_load_dword v152, v32, s[28:31], s12 offen
    s_bfe_u32 s12, s69, 0x40008
    s_mul_i32 s12, s12, 393216
    buffer_load_dword v156, v32, s[28:31], s12 offen
    s_mov_b64 exec, -1
L_p3e0_0:
L_bw1_0:
    s_waitcnt vmcnt(27)
    s_barrier
    s_bfe_u32 s91, s68, 0x4000c
    s_lshl_b32 s92, s91, 7
    s_mul_i32 s93, s91, 393216
    s_add_u32 m0, s94, 0
    s_nop 0
    buffer_load_dwordx4 v20, s[24:27], s92 offen offset:0 lds
    s_waitcnt vmcnt(9)
    s_mov_b32 s8, 0xffff0000
    v_lshlrev_b32 v72, 16, v56
    v_and_b32 v56, s8, v56
    v_lshlrev_b32 v73, 16, v64
    v_and_b32 v64, s8, v64
    v_lshlrev_b32 v112, 16, v40
    buffer_load_dwordx4 v21, s[24:27], s92 offen offset:1024 lds
    v_and_b32 v40, s8, v40
    v_lshlrev_b32 v116, 16, v48
    v_and_b32 v48, s8, v48
    v_mul_f32 v113, v112, v73
    v_mul_f32 v114, v40, v64
    v_mul_f32 v90, v112, v72
    v_mul_f32 v117, v116, v73
    buffer_load_dwordx4 v22, s[24:27], s92 offen offset:2048 lds
    v_mul_f32 v118, v48, v64
    v_mul_f32 v92, v116, v72
    v_cvt_pk_bf16_f32 v113, 0, v113
    v_cvt_pk_bf16_f32 v114, 0, v114
    v_fmac_f32 v90, v40, v56
    v_cvt_pk_bf16_f32 v117, 0, v117
    v_cvt_pk_bf16_f32 v118, 0, v118
    buffer_load_dwordx4 v23, s[24:27], s92 offen offset:3072 lds
    v_fmac_f32 v92, v48, v56
    v_add_f32 v91, v113, v114
    v_add_f32 v93, v117, v118
    v_lshlrev_b32 v72, 16, v57
    v_and_b32 v57, s8, v57
    v_lshlrev_b32 v73, 16, v65
    v_and_b32 v65, s8, v65
    s_add_u32 m0, s95, 24576
    s_nop 0
    buffer_load_dwordx4 v24, s[28:31], s93 offen offset:0 lds
    v_lshlrev_b32 v112, 16, v41
    v_and_b32 v41, s8, v41
    v_lshlrev_b32 v116, 16, v49
    v_and_b32 v49, s8, v49
    v_mul_f32 v113, v112, v73
    v_mul_f32 v114, v41, v65
    v_fmac_f32 v90, v112, v72
    s_cmp_lg_u32 s21, 0
    s_cbranch_scc1 L_noclr_0
    v_mov_b32 v104, -1
    v_mov_b32 v105, -1
    v_mov_b32 v106, -1
    v_mov_b32 v107, -1
    s_lshl_b32 s12, s19, 13
    s_lshl_b32 s13, s18, 9
    s_add_u32 s12, s12, s13
    s_add_u32 s12, s12, 32768
    s_lshl_b32 s13, s19, 11
    s_lshl_b32 s90, s18, 7
    s_add_u32 s13, s13, s90
    s_add_u32 s13, s13, 163840
    s_mov_b32 exec_hi, 0
    buffer_store_dwordx4 v[104:107], v5, s[32:35], s12 offen sc1
    s_mov_b32 exec_lo, 255
    buffer_store_dwordx4 v[104:107], v5, s[32:35], s13 offen sc1
    s_mov_b64 exec, -1
L_noclr_0:
    v_mul_f32 v117, v116, v73
    v_mul_f32 v118, v49, v65
    v_fmac_f32 v92, v116, v72
    v_cvt_pk_bf16_f32 v113, 0, v113
    v_cvt_pk_bf16_f32 v114, 0, v114
    v_fmac_f32 v90, v41, v57
    v_cvt_pk_bf16_f32 v117, 0, v117
    v_cvt_pk_bf16_f32 v118, 0, v118
    v_fmac_f32 v92, v49, v57
    v_add_f32 v91, v91, v113
    v_add_f32 v93, v93, v117
    v_add_f32 v91, v91, v114
    v_add_f32 v93, v93, v118
    v_lshlrev_b32 v72, 16, v58
    v_and_b32 v58, s8, v58
    v_lshlrev_b32 v73, 16, v66
    v_and_b32 v66, s8, v66
    v_lshlrev_b32 v112, 16, v42
    v_and_b32 v42, s8, v42
    v_lshlrev_b32 v116, 16, v50
    v_and_b32 v50, s8, v50
    v_mul_f32 v113, v112, v73
    v_mul_f32 v114, v42, v66
    v_fmac_f32 v90, v112, v72
    v_mul_f32 v117, v116, v73
L_bw2_0:
    s_barrier
    s_add_u32 m0, s95, 24576
    s_nop 0
    buffer_load_dwordx4 v25, s[28:31], s93 offen offset:1024 lds
    v_mul_f32 v118, v50, v66
    v_fmac_f32 v92, v116, v72
    v_cvt_pk_bf16_f32 v113, 0, v113
    v_cvt_pk_bf16_f32 v114, 0, v114
    v_fmac_f32 v90, v42, v58
    v_cvt_pk_bf16_f32 v117, 0, v117
    v_cvt_pk_bf16_f32 v118, 0, v118
    s_add_u32 m0, s95, 32768
    s_nop 0
    buffer_load_dwordx4 v26, s[28:31], s93 offen offset:0 lds
    v_fmac_f32 v92, v50, v58
    v_add_f32 v91, v91, v113
    v_add_f32 v93, v93, v117
    v_add_f32 v91, v91, v114
    v_add_f32 v93, v93, v118
    v_lshlrev_b32 v72, 16, v59
    v_and_b32 v59, s8, v59
    buffer_load_dwordx4 v27, s[28:31], s93 offen offset:1024 lds
    v_lshlrev_b32 v73, 16, v67
    v_and_b32 v67, s8, v67
    v_lshlrev_b32 v112, 16, v43
    v_and_b32 v43, s8, v43
    v_lshlrev_b32 v116, 16, v51
    v_and_b32 v51, s8, v51
    v_mul_f32 v113, v112, v73
    s_add_u32 m0, s95, 16384
    s_nop 0
    buffer_load_dwordx4 v28, s[28:31], s93 offen offset:0 lds
    v_mul_f32 v114, v43, v67
    v_fmac_f32 v90, v112, v72
    v_mul_f32 v117, v116, v73
    v_mul_f32 v118, v51, v67
    v_fmac_f32 v92, v116, v72
    v_cvt_pk_bf16_f32 v113, 0, v113
    v_cvt_pk_bf16_f32 v114, 0, v114
    buffer_load_dwordx4 v29, s[28:31], s93 offen offset:1024 lds
    v_fmac_f32 v90, v43, v59
    v_cvt_pk_bf16_f32 v117, 0, v117
    v_cvt_pk_bf16_f32 v118, 0, v118
    v_fmac_f32 v92, v51, v59
    v_add_f32 v91, v91, v113
    v_add_f32 v93, v93, v117
    v_add_f32 v91, v91, v114
    s_bfe_u32 s91, s68, 0x40010
    s_lshl_b32 s92, s91, 7
    s_mul_i32 s93, s91, 393216
    s_add_u32 m0, s94, 40960
    s_nop 0
    buffer_load_dwordx4 v20, s[24:27], s92 offen offset:0 lds
    v_add_f32 v93, v93, v118
    v_lshlrev_b32 v72, 16, v60
    v_and_b32 v60, s8, v60
    v_lshlrev_b32 v73, 16, v68
    v_and_b32 v68, s8, v68
    v_lshlrev_b32 v112, 16, v44
    v_and_b32 v44, s8, v44
    buffer_load_dwordx4 v21, s[24:27], s92 offen offset:1024 lds
    v_lshlrev_b32 v116, 16, v52
    v_and_b32 v52, s8, v52
    v_mul_f32 v113, v112, v73
    v_mul_f32 v114, v44, v68
    v_fmac_f32 v90, v112, v72
    v_mul_f32 v117, v116, v73
    v_mul_f32 v118, v52, v68
    buffer_load_dwordx4 v22, s[24:27], s92 offen offset:2048 lds
    v_fmac_f32 v92, v116, v72
    v_cvt_pk_bf16_f32 v113, 0, v113
    v_cvt_pk_bf16_f32 v114, 0, v114
    v_fmac_f32 v90, v44, v60
    v_cvt_pk_bf16_f32 v117, 0, v117
    v_cvt_pk_bf16_f32 v118, 0, v118
    v_fmac_f32 v92, v52, v60
    buffer_load_dwordx4 v23, s[24:27], s92 offen offset:3072 lds
    v_add_f32 v91, v91, v113
    v_add_f32 v93, v93, v117
    v_add_f32 v91, v91, v114
    v_add_f32 v93, v93, v118
    v_lshlrev_b32 v72, 16, v61
    v_and_b32 v61, s8, v61
    v_lshlrev_b32 v73, 16, v69
    s_add_u32 m0, s95, 65536
    s_nop 0
    buffer_load_dwordx4 v24, s[28:31], s93 offen offset:0 lds
    v_and_b32 v69, s8, v69
    v_lshlrev_b32 v112, 16, v45
    v_and_b32 v45, s8, v45
    v_lshlrev_b32 v116, 16, v53
    v_and_b32 v53, s8, v53
    v_mul_f32 v113, v112, v73
    v_mul_f32 v114, v45, v69
    buffer_load_dwordx4 v25, s[28:31], s93 offen offset:1024 lds
    v_fmac_f32 v90, v112, v72
    v_mul_f32 v117, v116, v73
    v_mul_f32 v118, v53, v69
    v_fmac_f32 v92, v116, v72
    v_cvt_pk_bf16_f32 v113, 0, v113
    v_cvt_pk_bf16_f32 v114, 0, v114
    v_fmac_f32 v90, v45, v61
    s_add_u32 m0, s95, 73728
    s_nop 0
    buffer_load_dwordx4 v26, s[28:31], s93 offen offset:0 lds
    v_cvt_pk_bf16_f32 v117, 0, v117
    v_cvt_pk_bf16_f32 v118, 0, v118
    v_fmac_f32 v92, v53, v61
    v_add_f32 v91, v91, v113
    v_add_f32 v93, v93, v117
    v_add_f32 v91, v91, v114
    v_add_f32 v93, v93, v118
    buffer_load_dword v15, v13, s[72:75], 0 offen offset:4 sc1
    v_lshlrev_b32 v72, 16, v62
    v_and_b32 v62, s8, v62
    v_lshlrev_b32 v73, 16, v70
    v_and_b32 v70, s8, v70
    v_lshlrev_b32 v112, 16, v46
    v_and_b32 v46, s8, v46
    v_lshlrev_b32 v116, 16, v54
    v_and_b32 v54, s8, v54
    v_mul_f32 v113, v112, v73
    v_mul_f32 v114, v46, v70
    v_fmac_f32 v90, v112, v72
    v_mul_f32 v117, v116, v73
    v_mul_f32 v118, v54, v70
    v_fmac_f32 v92, v116, v72
    v_cvt_pk_bf16_f32 v113, 0, v113
    v_cvt_pk_bf16_f32 v114, 0, v114
    v_fmac_f32 v90, v46, v62
    v_cvt_pk_bf16_f32 v117, 0, v117
    v_cvt_pk_bf16_f32 v118, 0, v118
    v_fmac_f32 v92, v54, v62
    v_add_f32 v91, v91, v113
    v_add_f32 v93, v93, v117
    v_add_f32 v91, v91, v114
    v_add_f32 v93, v93, v118
    v_lshlrev_b32 v72, 16, v63
L_bw3_0:
    s_waitcnt vmcnt(8)
    s_barrier
    s_add_u32 m0, s95, 73728
    s_nop 0
    buffer_load_dwordx4 v27, s[28:31], s93 offen offset:1024 lds
    v_and_b32 v63, s8, v63
    v_lshlrev_b32 v73, 16, v71
    v_and_b32 v71, s8, v71
    v_lshlrev_b32 v112, 16, v47
    v_and_b32 v47, s8, v47
    v_lshlrev_b32 v116, 16, v55
    v_and_b32 v55, s8, v55
    s_add_u32 m0, s95, 57344
    s_nop 0
    buffer_load_dwordx4 v28, s[28:31], s93 offen offset:0 lds
    v_mul_f32 v113, v112, v73
    v_mul_f32 v114, v47, v71
    v_fmac_f32 v90, v112, v72
    v_mul_f32 v117, v116, v73
    v_mul_f32 v118, v55, v71
    v_fmac_f32 v92, v116, v72
    v_cvt_pk_bf16_f32 v113, 0, v113
    buffer_load_dwordx4 v29, s[28:31], s93 offen offset:1024 lds
    v_cvt_pk_bf16_f32 v114, 0, v114
    v_fmac_f32 v90, v47, v63
    v_cvt_pk_bf16_f32 v117, 0, v117
    v_cvt_pk_bf16_f32 v118, 0, v118
    v_fmac_f32 v92, v55, v63
    v_add_f32 v91, v91, v113
    v_add_f32 v93, v93, v117
    s_bfe_u32 s91, s68, 0x40014
    s_lshl_b32 s92, s91, 7
    s_mul_i32 s93, s91, 393216
    s_add_u32 m0, s94, 81920
    s_nop 0
    buffer_load_dwordx4 v20, s[24:27], s92 offen offset:0 lds
    v_add_f32 v91, v91, v114
    v_add_f32 v93, v93, v118
    v_add_f32_dpp v90, v90, v90 row_shr:1 row_mask:0xf bank_mask:0xf
    v_add_f32_dpp v91, v91, v91 row_shr:1 row_mask:0xf bank_mask:0xf
    v_add_f32_dpp v92, v92, v92 row_shr:1 row_mask:0xf bank_mask:0xf
    v_add_f32_dpp v93, v93, v93 row_shr:1 row_mask:0xf bank_mask:0xf
    v_add_f32_dpp v90, v90, v90 row_shr:2 row_mask:0xf bank_mask:0xf
    buffer_load_dwordx4 v21, s[24:27], s92 offen offset:1024 lds
    v_add_f32_dpp v91, v91, v91 row_shr:2 row_mask:0xf bank_mask:0xf
    v_add_f32_dpp v92, v92, v92 row_shr:2 row_mask:0xf bank_mask:0xf
    v_add_f32_dpp v93, v93, v93 row_shr:2 row_mask:0xf bank_mask:0xf
    v_add_f32_dpp v90, v90, v90 row_shr:4 row_mask:0xf bank_mask:0xf
    v_add_f32_dpp v91, v91, v91 row_shr:4 row_mask:0xf bank_mask:0xf
    v_add_f32_dpp v92, v92, v92 row_shr:4 row_mask:0xf bank_mask:0xf
    v_add_f32_dpp v93, v93, v93 row_shr:4 row_mask:0xf bank_mask:0xf
    buffer_load_dwordx4 v22, s[24:27], s92 offen offset:2048 lds
    v_add_f32_dpp v90, v90, v90 row_shr:8 row_mask:0xf bank_mask:0xf
    v_add_f32_dpp v91, v91, v91 row_shr:8 row_mask:0xf bank_mask:0xf
    v_add_f32_dpp v92, v92, v92 row_shr:8 row_mask:0xf bank_mask:0xf
    v_add_f32_dpp v93, v93, v93 row_shr:8 row_mask:0xf bank_mask:0xf
    v_add_f32_dpp v90, v90, v90 row_bcast:15 row_mask:0xa bank_mask:0xf
    v_add_f32_dpp v91, v91, v91 row_bcast:15 row_mask:0xa bank_mask:0xf
    v_add_f32_dpp v92, v92, v92 row_bcast:15 row_mask:0xa bank_mask:0xf
    buffer_load_dwordx4 v23, s[24:27], s92 offen offset:3072 lds
    v_add_f32_dpp v93, v93, v93 row_bcast:15 row_mask:0xa bank_mask:0xf
    v_add_f32_dpp v90, v90, v90 row_bcast:31 row_mask:0xc bank_mask:0xf
    v_add_f32_dpp v91, v91, v91 row_bcast:31 row_mask:0xc bank_mask:0xf
    v_add_f32_dpp v92, v92, v92 row_bcast:31 row_mask:0xc bank_mask:0xf
    v_add_f32_dpp v93, v93, v93 row_bcast:31 row_mask:0xc bank_mask:0xf
    v_mov_b32 v97, 0x8000
    v_mov_b32 v98, 0xffff
    s_add_u32 m0, s95, 106496
    s_nop 0
    buffer_load_dwordx4 v24, s[28:31], s93 offen offset:0 lds
    v_cvt_pk_bf16_f32 v94, v90, v91
    v_cvt_pk_bf16_f32 v104, v92, v93
    v_and_b32 v95, 0xffff, v94
    v_and_b32 v96, 0x8000, v94
    v_and_b32 v94, 0xffff0000, v94
    v_cmp_ne_u32 vcc, 0, v96
    v_mul_f32 v94, 0xbfb8aa3b, v94
    buffer_load_dwordx4 v25, s[28:31], s93 offen offset:1024 lds
    v_exp_f32 v94, v94
    v_cndmask_b32 v96, v97, v98, vcc
    v_xor_b32 v95, v95, v96
    v_add_f32 v94, 1.0, v94
    v_lshlrev_b32 v95, 11, v95
    v_rcp_f32 v94, v94
    s_sub_u32 s12, 2047, s22
    v_or_b32 v100, s12, v95
    s_add_u32 m0, s95, 114688
    s_nop 0
    buffer_load_dwordx4 v26, s[28:31], s93 offen offset:0 lds
    v_cvt_pk_bf16_f32 v94, v94, v94
    v_lshlrev_b32 v102, 16, v94
    v_and_b32 v105, 0xffff, v104
    v_and_b32 v106, 0x8000, v104
    v_and_b32 v104, 0xffff0000, v104
    v_cmp_ne_u32 vcc, 0, v106
    v_mul_f32 v104, 0xbfb8aa3b, v104
    buffer_load_dwordx4 v27, s[28:31], s93 offen offset:1024 lds
    v_exp_f32 v104, v104
    v_cndmask_b32 v106, v97, v98, vcc
    v_xor_b32 v105, v105, v106
    v_add_f32 v104, 1.0, v104
    v_lshlrev_b32 v105, 11, v105
    v_rcp_f32 v104, v104
    s_sub_u32 s12, 2046, s22
    v_or_b32 v101, s12, v105
    s_add_u32 m0, s95, 98304
    s_nop 0
    buffer_load_dwordx4 v28, s[28:31], s93 offen offset:0 lds
    v_cvt_pk_bf16_f32 v104, v104, v104
    v_lshlrev_b32 v103, 16, v104
    v_max_u32 v100, v100, v101
    s_lshl_b32 s12, s22, 2
    s_add_u32 s12, s12, 4096
    s_lshl_b32 s13, s21, 2
    s_add_u32 s13, s13, 162880
    v_mov_b32 v14, s13
    s_mov_b32 exec_lo, 0
    s_mov_b32 exec_hi, 0x80000000
    buffer_store_dwordx2 v[102:103], v13, s[32:35], s12 offen sc1
    ds_write_b32 v14, v100
    s_mov_b64 exec, -1
    s_waitcnt lgkmcnt(0)
L_bw4_0:
    s_waitcnt vmcnt(10)
    s_barrier
    s_add_u32 m0, s95, 98304
    s_nop 0
    buffer_load_dwordx4 v29, s[28:31], s93 offen offset:1024 lds
    s_bfe_u32 s91, s68, 0x40018
    s_lshl_b32 s92, s91, 7
    s_mul_i32 s93, s91, 393216
    s_add_u32 m0, s94, 0
    s_nop 0
    buffer_load_dwordx4 v20, s[24:27], s92 offen offset:0 lds
    buffer_load_dwordx4 v21, s[24:27], s92 offen offset:1024 lds
    buffer_load_dwordx4 v22, s[24:27], s92 offen offset:2048 lds
    buffer_load_dwordx4 v23, s[24:27], s92 offen offset:3072 lds
    s_add_u32 m0, s95, 24576
    s_nop 0
    buffer_load_dwordx4 v24, s[28:31], s93 offen offset:0 lds
    buffer_load_dwordx4 v25, s[28:31], s93 offen offset:1024 lds
    s_add_u32 m0, s95, 32768
    s_nop 0
    buffer_load_dwordx4 v26, s[28:31], s93 offen offset:0 lds
    buffer_load_dwordx4 v27, s[28:31], s93 offen offset:1024 lds
    s_add_u32 m0, s95, 16384
    s_nop 0
    buffer_load_dwordx4 v28, s[28:31], s93 offen offset:0 lds
    buffer_load_dwordx4 v29, s[28:31], s93 offen offset:1024 lds
    s_waitcnt vmcnt(11)
L_bw5_0:
    s_waitcnt vmcnt(10)
    s_barrier
    s_bfe_u32 s91, s68, 0x4001c
    s_lshl_b32 s92, s91, 7
    s_mul_i32 s93, s91, 393216
    s_add_u32 m0, s94, 40960
    s_nop 0
    buffer_load_dwordx4 v20, s[24:27], s92 offen offset:0 lds
    buffer_load_dwordx4 v21, s[24:27], s92 offen offset:1024 lds
    buffer_load_dwordx4 v22, s[24:27], s92 offen offset:2048 lds
    buffer_load_dwordx4 v23, s[24:27], s92 offen offset:3072 lds
    s_add_u32 m0, s95, 65536
    s_nop 0
    buffer_load_dwordx4 v24, s[28:31], s93 offen offset:0 lds
    buffer_load_dwordx4 v25, s[28:31], s93 offen offset:1024 lds
    s_add_u32 m0, s95, 73728
    s_nop 0
    buffer_load_dwordx4 v26, s[28:31], s93 offen offset:0 lds
    buffer_load_dwordx4 v27, s[28:31], s93 offen offset:1024 lds
    s_add_u32 m0, s95, 57344
    s_nop 0
    buffer_load_dwordx4 v28, s[28:31], s93 offen offset:0 lds
    buffer_load_dwordx4 v29, s[28:31], s93 offen offset:1024 lds
    s_cmp_ge_u32 s10, 224
    s_cbranch_scc1 L_p31_0
    s_add_u32 s12, s9, 0
    buffer_load_dwordx4 v[160:163], v30, s[44:47], s12 offen nt
    s_add_u32 s12, s9, 7168
    buffer_load_dwordx4 v[164:167], v30, s[44:47], s12 offen nt
    s_add_u32 s12, s9, 14336
    buffer_load_dwordx4 v[168:171], v30, s[44:47], s12 offen nt
    s_add_u32 s12, s9, 21504
    buffer_load_dwordx4 v[172:175], v30, s[44:47], s12 offen nt
    s_add_u32 s12, s9, 28672
    buffer_load_dwordx4 v[176:179], v30, s[44:47], s12 offen nt
    s_add_u32 s12, s9, 35840
    buffer_load_dwordx4 v[180:183], v30, s[44:47], s12 offen nt
    s_add_u32 s12, s9, 43008
    buffer_load_dwordx4 v[184:187], v30, s[44:47], s12 offen nt
    s_add_u32 s12, s9, 50176
    buffer_load_dwordx4 v[188:191], v30, s[44:47], s12 offen nt
    s_branch L_p3e1_0
L_p31_0:
    s_mov_b64 exec, 63
    s_bfe_u32 s12, s69, 0x4000c
    s_mul_i32 s12, s12, 393216
    buffer_load_dword v160, v32, s[28:31], s12 offen
    s_bfe_u32 s12, s69, 0x40010
    s_mul_i32 s12, s12, 393216
    buffer_load_dword v164, v32, s[28:31], s12 offen
    s_bfe_u32 s12, s69, 0x40014
    s_mul_i32 s12, s12, 393216
    buffer_load_dword v168, v32, s[28:31], s12 offen
    s_bfe_u32 s12, s69, 0x40018
    s_mul_i32 s12, s12, 393216
    buffer_load_dword v172, v32, s[28:31], s12 offen
    s_bfe_u32 s12, s69, 0x4001c
    s_mul_i32 s12, s12, 393216
    buffer_load_dword v176, v32, s[28:31], s12 offen
    s_mov_b64 exec, 1
    s_bfe_u32 s12, s69, 0x4001c
    s_mul_i32 s12, s12, 393216
    buffer_load_dword v180, v32, s[28:31], s12 offen
    s_bfe_u32 s12, s69, 0x4001c
    s_mul_i32 s12, s12, 393216
    buffer_load_dword v184, v32, s[28:31], s12 offen
    s_bfe_u32 s12, s69, 0x4001c
    s_mul_i32 s12, s12, 393216
    buffer_load_dword v188, v32, s[28:31], s12 offen
    s_mov_b64 exec, -1
L_p3e1_0:
    s_mov_b32 exec_lo, 0xffff0000
    s_mov_b32 exec_hi, 0
    buffer_load_dword v19, v10, s[36:39], 0 offen
    s_mov_b64 exec, -1
    s_mov_b32 s13, 0
L_tagchk_0:
    v_readfirstlane_b32 s23, v15
    s_nop 1
    s_cmp_lg_u32 s23, 0
    s_cbranch_scc1 L_tagok_0
    s_add_u32 s13, s13, 1
    s_cmp_ge_u32 s13, 16384
    s_cbranch_scc1 L_tagok_0
    buffer_load_dword v15, v13, s[72:75], 0 offen offset:4 sc1
    s_waitcnt vmcnt(0)
    s_branch L_tagchk_0
L_tagok_0:
    s_and_b32 s76, s23, 0xff
    s_bfe_u32 s77, s23, 0x80008
    s_bfe_u32 s78, s23, 0x80010
    s_lshr_b32 s79, s23, 24
    v_and_b32 v35, 3, v2
    v_lshlrev_b32 v35, 3, v35
    v_bfe_u32 v35, s23, v35, 8
    s_cmp_lg_u32 s21, 0
    s_cbranch_scc1 L_nopub_0
    v_mov_b32 v14, 162880
    ds_read_b128 v[104:107], v14
    s_lshl_b32 s12, s2, 3
    s_add_u32 s12, s12, 0
    s_waitcnt lgkmcnt(0)
    v_max3_u32 v104, v104, v105, v106
    v_max_u32 v104, v104, v107
    v_mov_b32 v105, s23
    s_mov_b64 exec, 1
    buffer_store_dwordx2 v[104:105], v13, s[32:35], s12 offen sc1
    s_mov_b64 exec, -1
L_nopub_0:
L_bw6_0:
    s_waitcnt vmcnt(19)
    s_barrier
    s_bfe_u32 s91, s69, 0x40000
    s_lshl_b32 s92, s91, 7
    s_mul_i32 s93, s91, 393216
    s_add_u32 m0, s94, 81920
    s_nop 0
    buffer_load_dwordx4 v20, s[24:27], s92 offen offset:0 lds
    buffer_load_dwordx4 v21, s[24:27], s92 offen offset:1024 lds
    buffer_load_dwordx4 v22, s[24:27], s92 offen offset:2048 lds
    buffer_load_dwordx4 v23, s[24:27], s92 offen offset:3072 lds
    s_add_u32 m0, s95, 106496
    s_nop 0
    buffer_load_dwordx4 v24, s[28:31], s93 offen offset:0 lds
L_bw7_0:
    s_waitcnt vmcnt(14)
    s_barrier
    s_add_u32 m0, s95, 106496
    s_nop 0
    buffer_load_dwordx4 v25, s[28:31], s93 offen offset:1024 lds
    s_add_u32 m0, s95, 114688
    s_nop 0
    buffer_load_dwordx4 v26, s[28:31], s93 offen offset:0 lds
    buffer_load_dwordx4 v27, s[28:31], s93 offen offset:1024 lds
    s_add_u32 m0, s95, 98304
    s_nop 0
    buffer_load_dwordx4 v28, s[28:31], s93 offen offset:0 lds
    buffer_load_dwordx4 v29, s[28:31], s93 offen offset:1024 lds
    s_bfe_u32 s91, s69, 0x40004
    s_lshl_b32 s92, s91, 7
    s_mul_i32 s93, s91, 393216
    s_add_u32 m0, s94, 0
    s_nop 0
    buffer_load_dwordx4 v20, s[24:27], s92 offen offset:0 lds
    buffer_load_dwordx4 v21, s[24:27], s92 offen offset:1024 lds
    buffer_load_dwordx4 v22, s[24:27], s92 offen offset:2048 lds
    buffer_load_dwordx4 v23, s[24:27], s92 offen offset:3072 lds
    s_add_u32 m0, s95, 24576
    s_nop 0
    buffer_load_dwordx4 v24, s[28:31], s93 offen offset:0 lds
    buffer_load_dwordx4 v25, s[28:31], s93 offen offset:1024 lds
    s_add_u32 m0, s95, 32768
    s_nop 0
    buffer_load_dwordx4 v26, s[28:31], s93 offen offset:0 lds
L_bw8_0:
    s_waitcnt vmcnt(7)
    s_barrier
    s_add_u32 m0, s95, 32768
    s_nop 0
    buffer_load_dwordx4 v27, s[28:31], s93 offen offset:1024 lds
    s_add_u32 m0, s95, 16384
    s_nop 0
    buffer_load_dwordx4 v28, s[28:31], s93 offen offset:0 lds
    buffer_load_dwordx4 v29, s[28:31], s93 offen offset:1024 lds
    s_bfe_u32 s91, s69, 0x40008
    s_lshl_b32 s92, s91, 7
    s_mul_i32 s93, s91, 393216
    s_add_u32 m0, s94, 40960
    s_nop 0
    buffer_load_dwordx4 v20, s[24:27], s92 offen offset:0 lds
    buffer_load_dwordx4 v21, s[24:27], s92 offen offset:1024 lds
    buffer_load_dwordx4 v22, s[24:27], s92 offen offset:2048 lds
    buffer_load_dwordx4 v23, s[24:27], s92 offen offset:3072 lds
    s_add_u32 m0, s95, 65536
    s_nop 0
    buffer_load_dwordx4 v24, s[28:31], s93 offen offset:0 lds
    buffer_load_dwordx4 v25, s[28:31], s93 offen offset:1024 lds
    s_add_u32 m0, s95, 73728
    s_nop 0
    buffer_load_dwordx4 v26, s[28:31], s93 offen offset:0 lds
    buffer_load_dwordx4 v27, s[28:31], s93 offen offset:1024 lds
    s_add_u32 m0, s95, 57344
    s_nop 0
    buffer_load_dwordx4 v28, s[28:31], s93 offen offset:0 lds
L_bw9_0:
    s_waitcnt vmcnt(9)
    s_barrier
    s_add_u32 m0, s95, 57344
    s_nop 0
    buffer_load_dwordx4 v29, s[28:31], s93 offen offset:1024 lds
    s_bfe_u32 s91, s69, 0x4000c
    s_lshl_b32 s92, s91, 7
    s_mul_i32 s93, s91, 393216
    s_add_u32 m0, s94, 122880
    s_nop 0
    buffer_load_dwordx4 v20, s[24:27], s92 offen offset:0 lds
    buffer_load_dwordx4 v21, s[24:27], s92 offen offset:1024 lds
    buffer_load_dwordx4 v22, s[24:27], s92 offen offset:2048 lds
    buffer_load_dwordx4 v23, s[24:27], s92 offen offset:3072 lds
    s_add_u32 m0, s95, 106496
    s_nop 0
    buffer_load_dwordx4 v24, s[28:31], s93 offen offset:0 lds
    buffer_load_dwordx4 v25, s[28:31], s93 offen offset:1024 lds
    s_add_u32 m0, s95, 114688
    s_nop 0
    buffer_load_dwordx4 v26, s[28:31], s93 offen offset:0 lds
    buffer_load_dwordx4 v27, s[28:31], s93 offen offset:1024 lds
    s_mov_b32 s12, 0
    buffer_load_dwordx4 v[104:107], v5, s[32:35], s12 offen offset:0 sc1
    buffer_load_dwordx4 v[108:111], v5, s[32:35], s12 offen offset:1024 sc1
L_bw10_0:
    s_waitcnt vmcnt(10)
    s_barrier
    s_bfe_u32 s91, s69, 0x40010
    s_lshl_b32 s92, s91, 7
    s_mul_i32 s93, s91, 393216
    s_add_u32 m0, s94, 139264
    s_nop 0
    buffer_load_dwordx4 v20, s[24:27], s92 offen offset:0 lds
    buffer_load_dwordx4 v21, s[24:27], s92 offen offset:1024 lds
    buffer_load_dwordx4 v22, s[24:27], s92 offen offset:2048 lds
    buffer_load_dwordx4 v23, s[24:27], s92 offen offset:3072 lds
    s_add_u32 m0, s95, 24576
    s_nop 0
    buffer_load_dwordx4 v24, s[28:31], s93 offen offset:0 lds
    buffer_load_dwordx4 v25, s[28:31], s93 offen offset:1024 lds
    s_add_u32 m0, s95, 32768
    s_nop 0
    buffer_load_dwordx4 v26, s[28:31], s93 offen offset:0 lds
    buffer_load_dwordx4 v27, s[28:31], s93 offen offset:1024 lds
    s_add_u32 s12, s97, 0
    buffer_load_dwordx4 v[192:195], v31, s[64:67], s12 offen nt
    s_add_u32 s12, s97, 16384
    buffer_load_dwordx4 v[196:199], v31, s[64:67], s12 offen nt
    s_add_u32 s12, s97, 32768
    buffer_load_dwordx4 v[200:203], v31, s[64:67], s12 offen nt
    s_add_u32 s12, s97, 49152
    buffer_load_dwordx4 v[204:207], v31, s[64:67], s12 offen nt
    s_add_u32 s12, s97, 65536
    buffer_load_dwordx4 v[208:211], v31, s[64:67], s12 offen nt
    s_add_u32 s12, s97, 81920
    buffer_load_dwordx4 v[212:215], v31, s[64:67], s12 offen nt
    s_add_u32 s12, s97, 98304
    buffer_load_dwordx4 v[216:219], v31, s[64:67], s12 offen nt
L_bw11_0:
    s_waitcnt vmcnt(17)
    s_barrier
    s_bfe_u32 s91, s69, 0x40014
    s_lshl_b32 s92, s91, 7
    s_mul_i32 s93, s91, 393216
    s_add_u32 m0, s94, 40960
    s_nop 0
    buffer_load_dwordx4 v20, s[24:27], s92 offen offset:0 lds
    s_waitcnt vmcnt(16)
    s_mov_b32 s13, 0
    v_xor_b32 v105, s23, v105
    v_xor_b32 v107, s23, v107
    v_xor_b32 v109, s23, v109
    v_xor_b32 v111, s23, v111
    v_or3_b32 v105, v105, v107, v109
    v_or_b32 v105, v105, v111
    v_cmp_ne_u32 vcc, 0, v105
    s_cbranch_vccnz L_keyre_0
L_keyok_0:
    buffer_load_dwordx4 v21, s[24:27], s92 offen offset:1024 lds
    v_max3_u32 v104, v104, v106, v108
    v_max_u32 v104, v104, v110
    s_nop 1
    v_max_u32_dpp v104, v104, v104 row_shr:1 row_mask:0xf bank_mask:0xf
    s_nop 1
    v_max_u32_dpp v104, v104, v104 row_shr:2 row_mask:0xf bank_mask:0xf
    s_nop 1
    v_max_u32_dpp v104, v104, v104 row_shr:4 row_mask:0xf bank_mask:0xf
    s_nop 1
    v_max_u32_dpp v104, v104, v104 row_shr:8 row_mask:0xf bank_mask:0xf
    s_nop 1
    v_max_u32_dpp v104, v104, v104 row_bcast:15 row_mask:0xa bank_mask:0xf
    buffer_load_dwordx4 v22, s[24:27], s92 offen offset:2048 lds
    s_nop 0
    v_max_u32_dpp v104, v104, v104 row_bcast:31 row_mask:0xc bank_mask:0xf
    s_nop 0
    v_readlane_b32 s14, v104, 63
    s_nop 1
    s_and_b32 s15, s14, 2047
    s_sub_u32 s15, 2047, s15
    s_lshl_b32 s12, s15, 11
    s_lshl_b32 s13, s70, 1
    s_add_u32 s12, s12, s13
    buffer_load_dwordx4 v[36:39], v34, s[24:27], s12 offen
    s_lshr_b32 s12, s14, 11
    s_and_b32 s13, s12, 0x8000
    s_cmp_lg_u32 s13, 0
    s_mov_b32 s13, 0xffff
    s_cselect_b32 s13, 0x8000, s13
    s_xor_b32 s12, s12, s13
    s_lshl_b32 s12, s12, 16
    v_mov_b32 v105, s12
    buffer_load_dwordx4 v23, s[24:27], s92 offen offset:3072 lds
    v_mul_f32 v105, 0xbfb8aa3b, v105
    v_exp_f32 v105, v105
    s_nop 0
    v_add_f32 v105, 1.0, v105
    v_rcp_f32 v105, v105
    s_nop 0
    v_cvt_pk_bf16_f32 v105, v105, v105
    v_lshlrev_b32 v105, 16, v105
    s_add_u32 s12, s15, 1
    v_mov_b32 v104, s12
    s_add_u32 m0, s95, 65536
    s_nop 0
    buffer_load_dwordx4 v24, s[28:31], s93 offen offset:0 lds
    v_mov_b32 v106, s23
    v_readfirstlane_b32 s14, v105
    v_mov_b32 v14, 162864
    s_mov_b64 exec, 1
    ds_write_b96 v14, v[104:106]
    s_mov_b64 exec, -1
    s_waitcnt lgkmcnt(0)
L_bw12_0:
    s_waitcnt vmcnt(13)
    s_barrier
    s_add_u32 m0, s95, 65536
    s_nop 0
    buffer_load_dwordx4 v25, s[28:31], s93 offen offset:1024 lds
    s_waitcnt vmcnt(3)
    s_mov_b32 s8, 0xffff0000
    v_lshlrev_b32 v40, 16, v36
    v_and_b32 v41, s8, v36
    v_lshlrev_b32 v42, 16, v37
    v_and_b32 v43, s8, v37
    v_lshlrev_b32 v44, 16, v38
    s_add_u32 m0, s95, 73728
    s_nop 0
    buffer_load_dwordx4 v26, s[28:31], s93 offen offset:0 lds
    v_and_b32 v45, s8, v38
    v_lshlrev_b32 v46, 16, v39
    v_and_b32 v47, s8, v39
    v_lshlrev_b32 v48, 16, v128
    v_lshlrev_b32 v49, 16, v129
    v_and_b32 v128, s8, v128
    v_and_b32 v129, s8, v129
    v_mul_f32 v220, v48, v40
    v_mul_f32 v222, v49, v40
    v_mul_f32 v221, v128, v40
    v_mul_f32 v223, v129, v40
    v_lshlrev_b32 v50, 16, v130
    v_lshlrev_b32 v51, 16, v131
    v_and_b32 v130, s8, v130
    buffer_load_dwordx4 v27, s[28:31], s93 offen offset:1024 lds
    v_and_b32 v131, s8, v131
    v_mul_f32 v224, v50, v40
    v_mul_f32 v226, v51, v40
    v_mul_f32 v225, v130, v40
    v_mul_f32 v227, v131, v40
    v_lshlrev_b32 v48, 16, v160
    v_lshlrev_b32 v49, 16, v161
    v_and_b32 v160, s8, v160
    v_and_b32 v161, s8, v161
    v_mul_f32 v228, v48, v40
    v_mul_f32 v230, v49, v40
    v_mul_f32 v229, v160, v40
    v_mul_f32 v231, v161, v40
    v_lshlrev_b32 v50, 16, v162
    s_bfe_u32 s91, s69, 0x40018
    s_lshl_b32 s92, s91, 7
    s_mul_i32 s93, s91, 393216
    s_add_u32 m0, s94, 81920
    s_nop 0
    buffer_load_dwordx4 v20, s[24:27], s92 offen offset:0 lds
    v_lshlrev_b32 v51, 16, v163
    v_and_b32 v162, s8, v162
    v_and_b32 v163, s8, v163
    v_mul_f32 v232, v50, v40
    v_mul_f32 v234, v51, v40
    v_mul_f32 v233, v162, v40
    v_mul_f32 v235, v163, v40
    buffer_load_dwordx4 v21, s[24:27], s92 offen offset:1024 lds
    v_lshlrev_b32 v48, 16, v132
    v_lshlrev_b32 v49, 16, v133
    v_and_b32 v132, s8, v132
    v_and_b32 v133, s8, v133
    v_fmac_f32 v220, v48, v41
    v_fmac_f32 v222, v49, v41
    v_fmac_f32 v221, v132, v41
    buffer_load_dwordx4 v22, s[24:27], s92 offen offset:2048 lds
    v_fmac_f32 v223, v133, v41
    v_lshlrev_b32 v50, 16, v134
    v_lshlrev_b32 v51, 16, v135
    v_and_b32 v134, s8, v134
    v_and_b32 v135, s8, v135
    v_fmac_f32 v224, v50, v41
    v_fmac_f32 v226, v51, v41
    buffer_load_dwordx4 v23, s[24:27], s92 offen offset:3072 lds
    v_fmac_f32 v225, v134, v41
    v_fmac_f32 v227, v135, v41
    v_lshlrev_b32 v48, 16, v164
    v_lshlrev_b32 v49, 16, v165
    v_and_b32 v164, s8, v164
    v_and_b32 v165, s8, v165
    v_fmac_f32 v228, v48, v41
    s_add_u32 m0, s95, 106496
    s_nop 0
    buffer_load_dwordx4 v24, s[28:31], s93 offen offset:0 lds
    v_fmac_f32 v230, v49, v41
    v_fmac_f32 v229, v164, v41
    v_fmac_f32 v231, v165, v41
    v_lshlrev_b32 v50, 16, v166
    v_lshlrev_b32 v51, 16, v167
    v_and_b32 v166, s8, v166
    v_and_b32 v167, s8, v167
    buffer_load_dwordx4 v25, s[28:31], s93 offen offset:1024 lds
    v_fmac_f32 v232, v50, v41
    v_fmac_f32 v234, v51, v41
    v_fmac_f32 v233, v166, v41
    v_fmac_f32 v235, v167, v41
    v_lshlrev_b32 v48, 16, v136
    v_lshlrev_b32 v49, 16, v137
    v_and_b32 v136, s8, v136
    s_add_u32 m0, s95, 114688
    s_nop 0
    buffer_load_dwordx4 v26, s[28:31], s93 offen offset:0 lds
    v_and_b32 v137, s8, v137
    v_fmac_f32 v220, v48, v42
    v_fmac_f32 v222, v49, v42
    v_fmac_f32 v221, v136, v42
    v_fmac_f32 v223, v137, v42
    v_lshlrev_b32 v50, 16, v138
    v_lshlrev_b32 v51, 16, v139
    v_and_b32 v138, s8, v138
    v_and_b32 v139, s8, v139
    v_fmac_f32 v224, v50, v42
    v_fmac_f32 v226, v51, v42
    v_fmac_f32 v225, v138, v42
    v_fmac_f32 v227, v139, v42
    v_lshlrev_b32 v48, 16, v168
    v_lshlrev_b32 v49, 16, v169
    v_and_b32 v168, s8, v168
    v_and_b32 v169, s8, v169
    v_fmac_f32 v228, v48, v42
    v_fmac_f32 v230, v49, v42
    v_fmac_f32 v229, v168, v42
    v_fmac_f32 v231, v169, v42
    v_lshlrev_b32 v50, 16, v170
    v_lshlrev_b32 v51, 16, v171
    v_and_b32 v170, s8, v170
    v_and_b32 v171, s8, v171
    v_fmac_f32 v232, v50, v42
    v_fmac_f32 v234, v51, v42
    v_fmac_f32 v233, v170, v42
    v_fmac_f32 v235, v171, v42
    v_lshlrev_b32 v48, 16, v140
    v_lshlrev_b32 v49, 16, v141
    v_and_b32 v140, s8, v140
    v_and_b32 v141, s8, v141
    v_fmac_f32 v220, v48, v43
    v_fmac_f32 v222, v49, v43
    v_fmac_f32 v221, v140, v43
    v_fmac_f32 v223, v141, v43
    v_lshlrev_b32 v50, 16, v142
    v_lshlrev_b32 v51, 16, v143
L_bw13_0:
    s_waitcnt vmcnt(7)
    s_barrier
    s_add_u32 m0, s95, 114688
    s_nop 0
    buffer_load_dwordx4 v27, s[28:31], s93 offen offset:1024 lds
    v_and_b32 v142, s8, v142
    v_and_b32 v143, s8, v143
    v_fmac_f32 v224, v50, v43
    v_fmac_f32 v226, v51, v43
    v_fmac_f32 v225, v142, v43
    v_fmac_f32 v227, v143, v43
    v_lshlrev_b32 v48, 16, v172
    v_lshlrev_b32 v49, 16, v173
    v_and_b32 v172, s8, v172
    v_and_b32 v173, s8, v173
    v_fmac_f32 v228, v48, v43
    v_fmac_f32 v230, v49, v43
    v_fmac_f32 v229, v172, v43
    v_fmac_f32 v231, v173, v43
    s_bfe_u32 s91, s69, 0x4001c
    s_lshl_b32 s92, s91, 7
    s_mul_i32 s93, s91, 393216
    s_add_u32 m0, s94, 0
    s_nop 0
    buffer_load_dwordx4 v20, s[24:27], s92 offen offset:0 lds
    v_lshlrev_b32 v50, 16, v174
    v_lshlrev_b32 v51, 16, v175
    v_and_b32 v174, s8, v174
    v_and_b32 v175, s8, v175
    v_fmac_f32 v232, v50, v43
    v_fmac_f32 v234, v51, v43
    v_fmac_f32 v233, v174, v43
    buffer_load_dwordx4 v21, s[24:27], s92 offen offset:1024 lds
    v_fmac_f32 v235, v175, v43
    v_lshlrev_b32 v48, 16, v144
    v_lshlrev_b32 v49, 16, v145
    v_and_b32 v144, s8, v144
    v_and_b32 v145, s8, v145
    v_fmac_f32 v220, v48, v44
    v_fmac_f32 v222, v49, v44
    buffer_load_dwordx4 v22, s[24:27], s92 offen offset:2048 lds
    v_fmac_f32 v221, v144, v44
    v_fmac_f32 v223, v145, v44
    v_lshlrev_b32 v50, 16, v146
    v_lshlrev_b32 v51, 16, v147
    v_and_b32 v146, s8, v146
    v_and_b32 v147, s8, v147
    v_fmac_f32 v224, v50, v44
    buffer_load_dwordx4 v23, s[24:27], s92 offen offset:3072 lds
    v_fmac_f32 v226, v51, v44
    v_fmac_f32 v225, v146, v44
    v_fmac_f32 v227, v147, v44
    v_lshlrev_b32 v48, 16, v176
    v_lshlrev_b32 v49, 16, v177
    v_and_b32 v176, s8, v176
    v_and_b32 v177, s8, v177
    s_add_u32 m0, s95, 24576
    s_nop 0
    buffer_load_dwordx4 v24, s[28:31], s93 offen offset:0 lds
    v_fmac_f32 v228, v48, v44
    v_fmac_f32 v230, v49, v44
    v_fmac_f32 v229, v176, v44
    v_fmac_f32 v231, v177, v44
    v_lshlrev_b32 v50, 16, v178
    v_lshlrev_b32 v51, 16, v179
    v_and_b32 v178, s8, v178
    buffer_load_dwordx4 v25, s[28:31], s93 offen offset:1024 lds
    v_and_b32 v179, s8, v179
    v_fmac_f32 v232, v50, v44
    v_fmac_f32 v234, v51, v44
    v_fmac_f32 v233, v178, v44
    v_fmac_f32 v235, v179, v44
    v_lshlrev_b32 v48, 16, v148
    v_lshlrev_b32 v49, 16, v149
    s_add_u32 m0, s95, 32768
    s_nop 0
    buffer_load_dwordx4 v26, s[28:31], s93 offen offset:0 lds
    v_and_b32 v148, s8, v148
    v_and_b32 v149, s8, v149
    v_fmac_f32 v220, v48, v45
    v_fmac_f32 v222, v49, v45
    v_fmac_f32 v221, v148, v45
    v_fmac_f32 v223, v149, v45
    v_lshlrev_b32 v50, 16, v150
    v_lshlrev_b32 v51, 16, v151
    v_and_b32 v150, s8, v150
    v_and_b32 v151, s8, v151
    v_fmac_f32 v224, v50, v45
    v_fmac_f32 v226, v51, v45
    v_fmac_f32 v225, v150, v45
    v_fmac_f32 v227, v151, v45
    buffer_load_dwordx4 v27, s[28:31], s93 offen offset:1024 lds
    v_lshlrev_b32 v48, 16, v180
    v_lshlrev_b32 v49, 16, v181
    v_and_b32 v180, s8, v180
    v_and_b32 v181, s8, v181
    v_fmac_f32 v228, v48, v45
    v_fmac_f32 v230, v49, v45
    v_fmac_f32 v229, v180, v45
    v_fmac_f32 v231, v181, v45
    v_lshlrev_b32 v50, 16, v182
    v_lshlrev_b32 v51, 16, v183
    v_and_b32 v182, s8, v182
    v_and_b32 v183, s8, v183
    v_fmac_f32 v232, v50, v45
    v_fmac_f32 v234, v51, v45
    v_fmac_f32 v233, v182, v45
    v_fmac_f32 v235, v183, v45
    v_lshlrev_b32 v48, 16, v152
    v_lshlrev_b32 v49, 16, v153
    v_and_b32 v152, s8, v152
    v_and_b32 v153, s8, v153
    v_fmac_f32 v220, v48, v46
    v_fmac_f32 v222, v49, v46
    v_fmac_f32 v221, v152, v46
    v_fmac_f32 v223, v153, v46
    v_lshlrev_b32 v50, 16, v154
    v_lshlrev_b32 v51, 16, v155
    v_and_b32 v154, s8, v154
    v_and_b32 v155, s8, v155
    v_fmac_f32 v224, v50, v46
    v_fmac_f32 v226, v51, v46
    v_fmac_f32 v225, v154, v46
    v_fmac_f32 v227, v155, v46
    v_lshlrev_b32 v48, 16, v184
    v_lshlrev_b32 v49, 16, v185
    v_and_b32 v184, s8, v184
    v_and_b32 v185, s8, v185
    v_fmac_f32 v228, v48, v46
    v_fmac_f32 v230, v49, v46
    v_fmac_f32 v229, v184, v46
L_bw14_0:
    s_waitcnt vmcnt(8)
    s_barrier
    s_bfe_u32 s12, s69, 0x4000c
    s_mul_i32 s12, s12, 393216
    s_add_u32 m0, s95, 16384
    s_nop 0
    buffer_load_dwordx4 v28, s[28:31], s12 offen offset:0 lds
    buffer_load_dwordx4 v29, s[28:31], s12 offen offset:1024 lds
    s_bfe_u32 s12, s69, 0x40010
    s_mul_i32 s12, s12, 393216
    s_add_u32 m0, s95, 57344
    s_nop 0
    buffer_load_dwordx4 v28, s[28:31], s12 offen offset:0 lds
    buffer_load_dwordx4 v29, s[28:31], s12 offen offset:1024 lds
    s_mul_i32 s12, s21, 16
    s_add_u32 s12, s12, 0
    s_and_b32 s90, s88, 1
    s_lshl_b32 s90, s90, 6
    s_xor_b32 s12, s12, s90
    s_lshl_b32 s12, s12, 14
    s_add_u32 s90, s12, 0
    buffer_load_dwordx4 v[84:87], v33, s[36:39], s90 offen
    s_add_u32 s90, s12, 16384
    buffer_load_dwordx4 v[88:91], v33, s[36:39], s90 offen
    s_add_u32 s90, s12, 32768
    buffer_load_dwordx4 v[92:95], v33, s[36:39], s90 offen
    s_add_u32 s90, s12, 49152
    buffer_load_dwordx4 v[96:99], v33, s[36:39], s90 offen
    s_add_u32 s90, s12, 65536
    buffer_load_dwordx4 v[100:103], v33, s[36:39], s90 offen
    s_add_u32 s90, s12, 81920
    buffer_load_dwordx4 v[116:119], v33, s[36:39], s90 offen
    s_add_u32 s90, s12, 98304
    buffer_load_dwordx4 v[120:123], v33, s[36:39], s90 offen
    s_add_u32 s90, s12, 114688
    buffer_load_dwordx4 v[124:127], v33, s[36:39], s90 offen
    s_add_u32 s90, s12, 131072
    buffer_load_dwordx4 v[64:67], v33, s[36:39], s90 offen
    v_fmac_f32 v231, v185, v46
    v_lshlrev_b32 v50, 16, v186
    v_lshlrev_b32 v51, 16, v187
    v_and_b32 v186, s8, v186
    v_and_b32 v187, s8, v187
    v_fmac_f32 v232, v50, v46
    v_fmac_f32 v234, v51, v46
    v_fmac_f32 v233, v186, v46
    v_fmac_f32 v235, v187, v46
    v_lshlrev_b32 v48, 16, v156
    v_lshlrev_b32 v49, 16, v157
    v_and_b32 v156, s8, v156
    v_and_b32 v157, s8, v157
    v_fmac_f32 v220, v48, v47
    v_fmac_f32 v222, v49, v47
    v_fmac_f32 v221, v156, v47
    v_fmac_f32 v223, v157, v47
    v_lshlrev_b32 v50, 16, v158
    v_lshlrev_b32 v51, 16, v159
    v_and_b32 v158, s8, v158
    v_and_b32 v159, s8, v159
    v_fmac_f32 v224, v50, v47
    v_fmac_f32 v226, v51, v47
    v_fmac_f32 v225, v158, v47
    v_fmac_f32 v227, v159, v47
L_bw15_0:
    s_waitcnt vmcnt(13)
    s_barrier
    v_lshlrev_b32 v48, 16, v188
    v_lshlrev_b32 v49, 16, v189
    v_and_b32 v188, s8, v188
    v_and_b32 v189, s8, v189
    v_fmac_f32 v228, v48, v47
    v_fmac_f32 v230, v49, v47
    v_fmac_f32 v229, v188, v47
    v_fmac_f32 v231, v189, v47
    v_lshlrev_b32 v50, 16, v190
    v_lshlrev_b32 v51, 16, v191
    v_and_b32 v190, s8, v190
    v_and_b32 v191, s8, v191
    v_fmac_f32 v232, v50, v47
    v_fmac_f32 v234, v51, v47
    v_fmac_f32 v233, v190, v47
    v_fmac_f32 v235, v191, v47
    v_permlane32_swap_b32 v220, v228
    v_permlane32_swap_b32 v221, v229
    v_permlane32_swap_b32 v222, v230
    v_permlane32_swap_b32 v223, v231
    v_permlane32_swap_b32 v224, v232
    v_permlane32_swap_b32 v225, v233
    v_permlane32_swap_b32 v226, v234
    v_permlane32_swap_b32 v227, v235
    v_add_f32 v220, v220, v228
    v_add_f32 v221, v221, v229
    v_add_f32 v222, v222, v230
    v_add_f32 v223, v223, v231
    v_add_f32 v224, v224, v232
    v_add_f32 v225, v225, v233
    v_add_f32 v226, v226, v234
    v_add_f32 v227, v227, v235
    v_permlane16_swap_b32 v220, v224
    v_permlane16_swap_b32 v221, v225
    v_permlane16_swap_b32 v222, v226
    v_permlane16_swap_b32 v223, v227
    v_add_f32 v220, v220, v224
    v_add_f32 v221, v221, v225
    v_add_f32 v222, v222, v226
    v_add_f32 v223, v223, v227
    v_add_f32_dpp v220, v220, v220 row_ror:8 row_mask:0xf bank_mask:0xf
    v_add_f32_dpp v221, v221, v221 row_ror:8 row_mask:0xf bank_mask:0xf
    v_add_f32_dpp v222, v222, v222 row_ror:8 row_mask:0xf bank_mask:0xf
    v_add_f32_dpp v223, v223, v223 row_ror:8 row_mask:0xf bank_mask:0xf
    s_branch L_varend
.fill 421, 4, 0xbf800000
L_var1:
    s_nop 0
    s_waitcnt vmcnt(6)
    s_barrier
    s_add_u32 m0, s95, 73728
    s_nop 0
    buffer_load_dwordx4 v26, s[28:31], s93 offen offset:0 lds
    buffer_load_dwordx4 v27, s[28:31], s93 offen offset:1024 lds
    s_add_u32 m0, s95, 57344
    s_nop 0
    buffer_load_dwordx4 v28, s[28:31], s93 offen offset:0 lds
    buffer_load_dwordx4 v29, s[28:31], s93 offen offset:1024 lds
    s_bfe_u32 s91, s68, 0x40008
    s_lshl_b32 s92, s91, 7
    s_mul_i32 s93, s91, 393216
    s_add_u32 m0, s94, 81920
    s_nop 0
    buffer_load_dwordx4 v20, s[24:27], s92 offen offset:0 lds
    buffer_load_dwordx4 v21, s[24:27], s92 offen offset:1024 lds
    buffer_load_dwordx4 v22, s[24:27], s92 offen offset:2048 lds
    buffer_load_dwordx4 v23, s[24:27], s92 offen offset:3072 lds
    s_add_u32 m0, s95, 106496
    s_nop 0
    buffer_load_dwordx4 v24, s[28:31], s93 offen offset:0 lds
    buffer_load_dwordx4 v25, s[28:31], s93 offen offset:1024 lds
    s_add_u32 m0, s95, 114688
    s_nop 0
    buffer_load_dwordx4 v26, s[28:31], s93 offen offset:0 lds
    buffer_load_dwordx4 v27, s[28:31], s93 offen offset:1024 lds
    s_add_u32 m0, s95, 98304
    s_nop 0
    buffer_load_dwordx4 v28, s[28:31], s93 offen offset:0 lds
    buffer_load_dwordx4 v29, s[28:31], s93 offen offset:1024 lds
    s_lshl_b32 s12, s19, 2
    s_add_u32 s12, s12, s21
    s_lshl_b32 s12, s12, 10
    s_lshl_b32 s13, s21, 10
    s_add_u32 m0, s13, 155648
    s_nop 0
    buffer_load_dwordx4 v5, s[76:79], s12 offen lds
    s_lshl_b32 s12, s22, 11
    buffer_load_dwordx4 v[40:43], v5, s[24:27], s12 offen offset:0
    buffer_load_dwordx4 v[44:47], v5, s[24:27], s12 offen offset:1024
    buffer_load_dwordx4 v[48:51], v5, s[24:27], s12 offen offset:2048
    buffer_load_dwordx4 v[52:55], v5, s[24:27], s12 offen offset:3072
    buffer_load_dwordx4 v[56:59], v5, s[80:83], 0 offen offset:0
    buffer_load_dwordx4 v[60:63], v5, s[80:83], 0 offen offset:1024
    buffer_load_dwordx4 v[64:67], v5, s[84:87], 0 offen offset:0
    buffer_load_dwordx4 v[68:71], v5, s[84:87], 0 offen offset:1024
L_bw1_1:
    s_waitcnt vmcnt(19)
    s_barrier
    s_bfe_u32 s91, s68, 0x4000c
    s_lshl_b32 s92, s91, 7
    s_mul_i32 s93, s91, 393216
    s_add_u32 m0, s94, 0
    s_nop 0
    buffer_load_dwordx4 v20, s[24:27], s92 offen offset:0 lds
    s_waitcnt vmcnt(1)
    s_mov_b32 s8, 0xffff0000
    v_lshlrev_b32 v72, 16, v56
    v_and_b32 v56, s8, v56
    v_lshlrev_b32 v73, 16, v64
    v_and_b32 v64, s8, v64
    v_lshlrev_b32 v112, 16, v40
    buffer_load_dwordx4 v21, s[24:27], s92 offen offset:1024 lds
    v_and_b32 v40, s8, v40
    v_lshlrev_b32 v116, 16, v48
    v_and_b32 v48, s8, v48
    v_mul_f32 v113, v112, v73
    v_mul_f32 v114, v40, v64
    v_mul_f32 v90, v112, v72
    v_mul_f32 v117, v116, v73
    buffer_load_dwordx4 v22, s[24:27], s92 offen offset:2048 lds
    v_mul_f32 v118, v48, v64
    v_mul_f32 v92, v116, v72
    v_cvt_pk_bf16_f32 v113, 0, v113
    v_cvt_pk_bf16_f32 v114, 0, v114
    v_fmac_f32 v90, v40, v56
    v_cvt_pk_bf16_f32 v117, 0, v117
    v_cvt_pk_bf16_f32 v118, 0, v118
    buffer_load_dwordx4 v23, s[24:27], s92 offen offset:3072 lds
    v_fmac_f32 v92, v48, v56
    v_add_f32 v91, v113, v114
    v_add_f32 v93, v117, v118
    v_lshlrev_b32 v72, 16, v57
    v_and_b32 v57, s8, v57
    v_lshlrev_b32 v73, 16, v65
    v_and_b32 v65, s8, v65
    s_add_u32 m0, s95, 24576
    s_nop 0
    buffer_load_dwordx4 v24, s[28:31], s93 offen offset:0 lds
    v_lshlrev_b32 v112, 16, v41
    v_and_b32 v41, s8, v41
    v_lshlrev_b32 v116, 16, v49
    v_and_b32 v49, s8, v49
    v_mul_f32 v113, v112, v73
    v_mul_f32 v114, v41, v65
    v_fmac_f32 v90, v112, v72
    buffer_load_dwordx4 v25, s[28:31], s93 offen offset:1024 lds
    v_mul_f32 v117, v116, v73
    v_mul_f32 v118, v49, v65
    v_fmac_f32 v92, v116, v72
    v_cvt_pk_bf16_f32 v113, 0, v113
    v_cvt_pk_bf16_f32 v114, 0, v114
    v_fmac_f32 v90, v41, v57
    v_cvt_pk_bf16_f32 v117, 0, v117
    s_add_u32 m0, s95, 32768
    s_nop 0
    buffer_load_dwordx4 v26, s[28:31], s93 offen offset:0 lds
    v_cvt_pk_bf16_f32 v118, 0, v118
    v_fmac_f32 v92, v49, v57
    v_add_f32 v91, v91, v113
    v_add_f32 v93, v93, v117
    v_add_f32 v91, v91, v114
    v_add_f32 v93, v93, v118
    v_lshlrev_b32 v72, 16, v58
    buffer_load_dwordx4 v27, s[28:31], s93 offen offset:1024 lds
    v_and_b32 v58, s8, v58
    v_lshlrev_b32 v73, 16, v66
    v_and_b32 v66, s8, v66
    v_lshlrev_b32 v112, 16, v42
    v_and_b32 v42, s8, v42
    v_lshlrev_b32 v116, 16, v50
    v_and_b32 v50, s8, v50
    s_add_u32 m0, s95, 16384
    s_nop 0
    buffer_load_dwordx4 v28, s[28:31], s93 offen offset:0 lds
    v_mul_f32 v113, v112, v73
    v_mul_f32 v114, v42, v66
    v_fmac_f32 v90, v112, v72
    v_mul_f32 v117, v116, v73
    v_mul_f32 v118, v50, v66
    v_fmac_f32 v92, v116, v72
    v_cvt_pk_bf16_f32 v113, 0, v113
    buffer_load_dwordx4 v29, s[28:31], s93 offen offset:1024 lds
    v_cvt_pk_bf16_f32 v114, 0, v114
    v_fmac_f32 v90, v42, v58
    v_cvt_pk_bf16_f32 v117, 0, v117
    v_cvt_pk_bf16_f32 v118, 0, v118
    v_fmac_f32 v92, v50, v58
    v_add_f32 v91, v91, v113
    v_add_f32 v93, v93, v117
    s_cmp_lg_u32 s21, 0
    s_cbranch_scc1 L_noclr_1
    v_mov_b32 v104, -1
    v_mov_b32 v105, -1
    v_mov_b32 v106, -1
    v_mov_b32 v107, -1
    s_lshl_b32 s12, s19, 13
    s_lshl_b32 s13, s18, 9
    s_add_u32 s12, s12, s13
    s_add_u32 s12, s12, 32768
    s_lshl_b32 s13, s19, 11
    s_lshl_b32 s90, s18, 7
    s_add_u32 s13, s13, s90
    s_add_u32 s13, s13, 163840
    s_mov_b32 exec_hi, 0
    buffer_store_dwordx4 v[104:107], v5, s[32:35], s12 offen sc1
    s_mov_b32 exec_lo, 255
    buffer_store_dwordx4 v[104:107], v5, s[32:35], s13 offen sc1
    s_mov_b64 exec, -1
L_noclr_1:
    s_cmp_ge_u32 s10, 224
    s_cbranch_scc1 L_p30_1
    s_add_u32 s12, s71, 0
    buffer_load_dwordx4 v[128:131], v30, s[40:43], s12 offen nt
    s_add_u32 s12, s71, 7168
    buffer_load_dwordx4 v[132:135], v30, s[40:43], s12 offen nt
    s_add_u32 s12, s71, 14336
    buffer_load_dwordx4 v[136:139], v30, s[40:43], s12 offen nt
    s_add_u32 s12, s71, 21504
    buffer_load_dwordx4 v[140:143], v30, s[40:43], s12 offen nt
    s_add_u32 s12, s71, 28672
    buffer_load_dwordx4 v[144:147], v30, s[40:43], s12 offen nt
    s_add_u32 s12, s71, 35840
    buffer_load_dwordx4 v[148:151], v30, s[40:43], s12 offen nt
    s_add_u32 s12, s71, 43008
    buffer_load_dwordx4 v[152:155], v30, s[40:43], s12 offen nt
    s_add_u32 s12, s71, 50176
    buffer_load_dwordx4 v[156:159], v30, s[40:43], s12 offen nt
    s_branch L_p3e0_1
L_p30_1:
    s_mov_b64 exec, 63
    s_bfe_u32 s12, s68, 0x4000c
    s_mul_i32 s12, s12, 393216
    buffer_load_dword v128, v32, s[28:31], s12 offen
    s_bfe_u32 s12, s68, 0x40010
    s_mul_i32 s12, s12, 393216
    buffer_load_dword v132, v32, s[28:31], s12 offen
    s_bfe_u32 s12, s68, 0x40014
    s_mul_i32 s12, s12, 393216
    buffer_load_dword v136, v32, s[28:31], s12 offen
    s_bfe_u32 s12, s68, 0x40018
    s_mul_i32 s12, s12, 393216
    buffer_load_dword v140, v32, s[28:31], s12 offen
    s_bfe_u32 s12, s68, 0x4001c
    s_mul_i32 s12, s12, 393216
    buffer_load_dword v144, v32, s[28:31], s12 offen
    s_bfe_u32 s12, s69, 0x40000
    s_mul_i32 s12, s12, 393216
    buffer_load_dword v148, v32, s[28:31], s12 offen
    s_bfe_u32 s12, s69, 0x40004
    s_mul_i32 s12, s12, 393216
    buffer_load_dword v152, v32, s[28:31], s12 offen
    s_bfe_u32 s12, s69, 0x40008
    s_mul_i32 s12, s12, 393216
    buffer_load_dword v156, v32, s[28:31], s12 offen
    s_mov_b64 exec, -1
L_p3e0_1:
    v_add_f32 v91, v91, v114
    v_add_f32 v93, v93, v118
    v_lshlrev_b32 v72, 16, v59
    v_and_b32 v59, s8, v59
    v_lshlrev_b32 v73, 16, v67
    v_and_b32 v67, s8, v67
    v_lshlrev_b32 v112, 16, v43
    v_and_b32 v43, s8, v43
    v_lshlrev_b32 v116, 16, v51
    v_and_b32 v51, s8, v51
    v_mul_f32 v113, v112, v73
    v_mul_f32 v114, v43, v67
    v_fmac_f32 v90, v112, v72
    v_mul_f32 v117, v116, v73
    v_mul_f32 v118, v51, v67
    v_fmac_f32 v92, v116, v72
    v_cvt_pk_bf16_f32 v113, 0, v113
    v_cvt_pk_bf16_f32 v114, 0, v114
    v_fmac_f32 v90, v43, v59
    v_cvt_pk_bf16_f32 v117, 0, v117
    v_cvt_pk_bf16_f32 v118, 0, v118
    v_fmac_f32 v92, v51, v59
    v_add_f32 v91, v91, v113
    v_add_f32 v93, v93, v117
    v_add_f32 v91, v91, v114
L_bw2_1:
    s_barrier
    s_bfe_u32 s91, s68, 0x40010
    s_lshl_b32 s92, s91, 7
    s_mul_i32 s93, s91, 393216
    s_add_u32 m0, s94, 40960
    s_nop 0
    buffer_load_dwordx4 v20, s[24:27], s92 offen offset:0 lds
    v_add_f32 v93, v93, v118
    v_lshlrev_b32 v72, 16, v60
    v_and_b32 v60, s8, v60
    v_lshlrev_b32 v73, 16, v68
    v_and_b32 v68, s8, v68
    v_lshlrev_b32 v112, 16, v44
    v_and_b32 v44, s8, v44
    buffer_load_dwordx4 v21, s[24:27], s92 offen offset:1024 lds
    v_lshlrev_b32 v116, 16, v52
    v_and_b32 v52, s8, v52
    v_mul_f32 v113, v112, v73
    v_mul_f32 v114, v44, v68
    v_fmac_f32 v90, v112, v72
    v_mul_f32 v117, v116, v73
    v_mul_f32 v118, v52, v68
    buffer_load_dwordx4 v22, s[24:27], s92 offen offset:2048 lds
    v_fmac_f32 v92, v116, v72
    v_cvt_pk_bf16_f32 v113, 0, v113
    v_cvt_pk_bf16_f32 v114, 0, v114
    v_fmac_f32 v90, v44, v60
    v_cvt_pk_bf16_f32 v117, 0, v117
    v_cvt_pk_bf16_f32 v118, 0, v118
    v_fmac_f32 v92, v52, v60
    buffer_load_dwordx4 v23, s[24:27], s92 offen offset:3072 lds
    v_add_f32 v91, v91, v113
    v_add_f32 v93, v93, v117
    v_add_f32 v91, v91, v114
    v_add_f32 v93, v93, v118
    v_lshlrev_b32 v72, 16, v61
    v_and_b32 v61, s8, v61
    v_lshlrev_b32 v73, 16, v69
    s_add_u32 m0, s95, 65536
    s_nop 0
    buffer_load_dwordx4 v24, s[28:31], s93 offen offset:0 lds
    v_and_b32 v69, s8, v69
    v_lshlrev_b32 v112, 16, v45
    v_and_b32 v45, s8, v45
    v_lshlrev_b32 v116, 16, v53
    v_and_b32 v53, s8, v53
    v_mul_f32 v113, v112, v73
    v_mul_f32 v114, v45, v69
    buffer_load_dword v15, v13, s[72:75], 0 offen offset:4 sc1
    v_fmac_f32 v90, v112, v72
    v_mul_f32 v117, v116, v73
    v_mul_f32 v118, v53, v69
    v_fmac_f32 v92, v116, v72
    v_cvt_pk_bf16_f32 v113, 0, v113
    v_cvt_pk_bf16_f32 v114, 0, v114
    v_fmac_f32 v90, v45, v61
    v_cvt_pk_bf16_f32 v117, 0, v117
    v_cvt_pk_bf16_f32 v118, 0, v118
    v_fmac_f32 v92, v53, v61
    v_add_f32 v91, v91, v113
    v_add_f32 v93, v93, v117
    v_add_f32 v91, v91, v114
    v_add_f32 v93, v93, v118
    v_lshlrev_b32 v72, 16, v62
    v_and_b32 v62, s8, v62
    v_lshlrev_b32 v73, 16, v70
    v_and_b32 v70, s8, v70
    v_lshlrev_b32 v112, 16, v46
    v_and_b32 v46, s8, v46
    v_lshlrev_b32 v116, 16, v54
    v_and_b32 v54, s8, v54
    v_mul_f32 v113, v112, v73
    v_mul_f32 v114, v46, v70
    v_fmac_f32 v90, v112, v72
L_bw3_1:
    s_waitcnt vmcnt(14)
    s_barrier
    s_add_u32 m0, s95, 65536
    s_nop 0
    buffer_load_dwordx4 v25, s[28:31], s93 offen offset:1024 lds
    v_mul_f32 v117, v116, v73
    v_mul_f32 v118, v54, v70
    v_fmac_f32 v92, v116, v72
    v_cvt_pk_bf16_f32 v113, 0, v113
    v_cvt_pk_bf16_f32 v114, 0, v114
    v_fmac_f32 v90, v46, v62
    v_cvt_pk_bf16_f32 v117, 0, v117
    s_add_u32 m0, s95, 73728
    s_nop 0
    buffer_load_dwordx4 v26, s[28:31], s93 offen offset:0 lds
    v_cvt_pk_bf16_f32 v118, 0, v118
    v_fmac_f32 v92, v54, v62
    v_add_f32 v91, v91, v113
    v_add_f32 v93, v93, v117
    v_add_f32 v91, v91, v114
    v_add_f32 v93, v93, v118
    v_lshlrev_b32 v72, 16, v63
    buffer_load_dwordx4 v27, s[28:31], s93 offen offset:1024 lds
    v_and_b32 v63, s8, v63
    v_lshlrev_b32 v73, 16, v71
    v_and_b32 v71, s8, v71
    v_lshlrev_b32 v112, 16, v47
    v_and_b32 v47, s8, v47
    v_lshlrev_b32 v116, 16, v55
    v_and_b32 v55, s8, v55
    s_add_u32 m0, s95, 57344
    s_nop 0
    buffer_load_dwordx4 v28, s[28:31], s93 offen offset:0 lds
    v_mul_f32 v113, v112, v73
    v_mul_f32 v114, v47, v71
    v_fmac_f32 v90, v112, v72
    v_mul_f32 v117, v116, v73
    v_mul_f32 v118, v55, v71
    v_fmac_f32 v92, v116, v72
    v_cvt_pk_bf16_f32 v113, 0, v113
    buffer_load_dwordx4 v29, s[28:31], s93 offen offset:1024 lds
    v_cvt_pk_bf16_f32 v114, 0, v114
    v_fmac_f32 v90, v47, v63
    v_cvt_pk_bf16_f32 v117, 0, v117
    v_cvt_pk_bf16_f32 v118, 0, v118
    v_fmac_f32 v92, v55, v63
    v_add_f32 v91, v91, v113
    v_add_f32 v93, v93, v117
    s_bfe_u32 s91, s68, 0x40014
    s_lshl_b32 s92, s91, 7
    s_mul_i32 s93, s91, 393216
    s_add_u32 m0, s94, 81920
    s_nop 0
    buffer_load_dwordx4 v20, s[24:27], s92 offen offset:0 lds
    v_add_f32 v91, v91, v114
    v_add_f32 v93, v93, v118
    v_add_f32_dpp v90, v90, v90 row_shr:1 row_mask:0xf bank_mask:0xf
    v_add_f32_dpp v91, v91, v91 row_shr:1 row_mask:0xf bank_mask:0xf
    v_add_f32_dpp v92, v92, v92 row_shr:1 row_mask:0xf bank_mask:0xf
    v_add_f32_dpp v93, v93, v93 row_shr:1 row_mask:0xf bank_mask:0xf
    v_add_f32_dpp v90, v90, v90 row_shr:2 row_mask:0xf bank_mask:0xf
    buffer_load_dwordx4 v21, s[24:27], s92 offen offset:1024 lds
    v_add_f32_dpp v91, v91, v91 row_shr:2 row_mask:0xf bank_mask:0xf
    v_add_f32_dpp v92, v92, v92 row_shr:2 row_mask:0xf bank_mask:0xf
    v_add_f32_dpp v93, v93, v93 row_shr:2 row_mask:0xf bank_mask:0xf
    v_add_f32_dpp v90, v90, v90 row_shr:4 row_mask:0xf bank_mask:0xf
    v_add_f32_dpp v91, v91, v91 row_shr:4 row_mask:0xf bank_mask:0xf
    v_add_f32_dpp v92, v92, v92 row_shr:4 row_mask:0xf bank_mask:0xf
    v_add_f32_dpp v93, v93, v93 row_shr:4 row_mask:0xf bank_mask:0xf
    buffer_load_dwordx4 v22, s[24:27], s92 offen offset:2048 lds
    v_add_f32_dpp v90, v90, v90 row_shr:8 row_mask:0xf bank_mask:0xf
    v_add_f32_dpp v91, v91, v91 row_shr:8 row_mask:0xf bank_mask:0xf
    v_add_f32_dpp v92, v92, v92 row_shr:8 row_mask:0xf bank_mask:0xf
    v_add_f32_dpp v93, v93, v93 row_shr:8 row_mask:0xf bank_mask:0xf
    v_add_f32_dpp v90, v90, v90 row_bcast:15 row_mask:0xa bank_mask:0xf
    v_add_f32_dpp v91, v91, v91 row_bcast:15 row_mask:0xa bank_mask:0xf
    v_add_f32_dpp v92, v92, v92 row_bcast:15 row_mask:0xa bank_mask:0xf
    buffer_load_dwordx4 v23, s[24:27], s92 offen offset:3072 lds
    v_add_f32_dpp v93, v93, v93 row_bcast:15 row_mask:0xa bank_mask:0xf
    v_add_f32_dpp v90, v90, v90 row_bcast:31 row_mask:0xc bank_mask:0xf
    v_add_f32_dpp v91, v91, v91 row_bcast:31 row_mask:0xc bank_mask:0xf
    v_add_f32_dpp v92, v92, v92 row_bcast:31 row_mask:0xc bank_mask:0xf
    v_add_f32_dpp v93, v93, v93 row_bcast:31 row_mask:0xc bank_mask:0xf
    v_mov_b32 v97, 0x8000
    v_mov_b32 v98, 0xffff
    s_add_u32 m0, s95, 106496
    s_nop 0
    buffer_load_dwordx4 v24, s[28:31], s93 offen offset:0 lds
    v_cvt_pk_bf16_f32 v94, v90, v91
    v_cvt_pk_bf16_f32 v104, v92, v93
    v_and_b32 v95, 0xffff, v94
    v_and_b32 v96, 0x8000, v94
    v_and_b32 v94, 0xffff0000, v94
    v_cmp_ne_u32 vcc, 0, v96
    v_mul_f32 v94, 0xbfb8aa3b, v94
    buffer_load_dwordx4 v25, s[28:31], s93 offen offset:1024 lds
    v_exp_f32 v94, v94
    v_cndmask_b32 v96, v97, v98, vcc
    v_xor_b32 v95, v95, v96
    v_add_f32 v94, 1.0, v94
    v_lshlrev_b32 v95, 11, v95
    v_rcp_f32 v94, v94
    s_sub_u32 s12, 2047, s22
    v_or_b32 v100, s12, v95
    s_add_u32 m0, s95, 114688
    s_nop 0
    buffer_load_dwordx4 v26, s[28:31], s93 offen offset:0 lds
    v_cvt_pk_bf16_f32 v94, v94, v94
    v_lshlrev_b32 v102, 16, v94
    v_and_b32 v105, 0xffff, v104
    v_and_b32 v106, 0x8000, v104
    v_and_b32 v104, 0xffff0000, v104
    v_cmp_ne_u32 vcc, 0, v106
    v_mul_f32 v104, 0xbfb8aa3b, v104
    v_exp_f32 v104, v104
    v_cndmask_b32 v106, v97, v98, vcc
    v_xor_b32 v105, v105, v106
    v_add_f32 v104, 1.0, v104
    v_lshlrev_b32 v105, 11, v105
    v_rcp_f32 v104, v104
    s_sub_u32 s12, 2046, s22
    v_or_b32 v101, s12, v105
    v_cvt_pk_bf16_f32 v104, v104, v104
    v_lshlrev_b32 v103, 16, v104
    v_max_u32 v100, v100, v101
    s_lshl_b32 s12, s22, 2
    s_add_u32 s12, s12, 4096
    s_lshl_b32 s13, s21, 2
    s_add_u32 s13, s13, 162880
    v_mov_b32 v14, s13
    s_mov_b32 exec_lo, 0
    s_mov_b32 exec_hi, 0x80000000
    buffer_store_dwordx2 v[102:103], v13, s[32:35], s12 offen sc1
    ds_write_b32 v14, v100
    s_mov_b64 exec, -1
    s_waitcnt lgkmcnt(0)
L_bw4_1:
    s_waitcnt vmcnt(8)
    s_barrier
    s_add_u32 m0, s95, 114688
    s_nop 0
    buffer_load_dwordx4 v27, s[28:31], s93 offen offset:1024 lds
    s_add_u32 m0, s95, 98304
    s_nop 0
    buffer_load_dwordx4 v28, s[28:31], s93 offen offset:0 lds
    buffer_load_dwordx4 v29, s[28:31], s93 offen offset:1024 lds
    s_bfe_u32 s91, s68, 0x40018
    s_lshl_b32 s92, s91, 7
    s_mul_i32 s93, s91, 393216
    s_add_u32 m0, s94, 0
    s_nop 0
    buffer_load_dwordx4 v20, s[24:27], s92 offen offset:0 lds
    buffer_load_dwordx4 v21, s[24:27], s92 offen offset:1024 lds
    buffer_load_dwordx4 v22, s[24:27], s92 offen offset:2048 lds
    buffer_load_dwordx4 v23, s[24:27], s92 offen offset:3072 lds
    s_add_u32 m0, s95, 24576
    s_nop 0
    buffer_load_dwordx4 v24, s[28:31], s93 offen offset:0 lds
    buffer_load_dwordx4 v25, s[28:31], s93 offen offset:1024 lds
    s_add_u32 m0, s95, 32768
    s_nop 0
    buffer_load_dwordx4 v26, s[28:31], s93 offen offset:0 lds
    buffer_load_dwordx4 v27, s[28:31], s93 offen offset:1024 lds
    s_add_u32 m0, s95, 16384
    s_nop 0
    buffer_load_dwordx4 v28, s[28:31], s93 offen offset:0 lds
    s_waitcnt vmcnt(12)
L_bw5_1:
    s_waitcnt vmcnt(9)
    s_barrier
    s_add_u32 m0, s95, 16384
    s_nop 0
    buffer_load_dwordx4 v29, s[28:31], s93 offen offset:1024 lds
    s_bfe_u32 s91, s68, 0x4001c
    s_lshl_b32 s92, s91, 7
    s_mul_i32 s93, s91, 393216
    s_add_u32 m0, s94, 40960
    s_nop 0
    buffer_load_dwordx4 v20, s[24:27], s92 offen offset:0 lds
    buffer_load_dwordx4 v21, s[24:27], s92 offen offset:1024 lds
    buffer_load_dwordx4 v22, s[24:27], s92 offen offset:2048 lds
    buffer_load_dwordx4 v23, s[24:27], s92 offen offset:3072 lds
    s_add_u32 m0, s95, 65536
    s_nop 0
    buffer_load_dwordx4 v24, s[28:31], s93 offen offset:0 lds
    buffer_load_dwordx4 v25, s[28:31], s93 offen offset:1024 lds
    s_add_u32 m0, s95, 73728
    s_nop 0
    buffer_load_dwordx4 v26, s[28:31], s93 offen offset:0 lds
    buffer_load_dwordx4 v27, s[28:31], s93 offen offset:1024 lds
    s_add_u32 m0, s95, 57344
    s_nop 0
    buffer_load_dwordx4 v28, s[28:31], s93 offen offset:0 lds
    buffer_load_dwordx4 v29, s[28:31], s93 offen offset:1024 lds
    s_mov_b32 s13, 0
L_tagchk_1:
    v_readfirstlane_b32 s23, v15
    s_nop 1
    s_cmp_lg_u32 s23, 0
    s_cbranch_scc1 L_tagok_1
    s_add_u32 s13, s13, 1
    s_cmp_ge_u32 s13, 16384
    s_cbranch_scc1 L_tagok_1
    buffer_load_dword v15, v13, s[72:75], 0 offen offset:4 sc1
    s_waitcnt vmcnt(0)
    s_branch L_tagchk_1
L_tagok_1:
    s_and_b32 s76, s23, 0xff
    s_bfe_u32 s77, s23, 0x80008
    s_bfe_u32 s78, s23, 0x80010
    s_lshr_b32 s79, s23, 24
    v_and_b32 v35, 3, v2
    v_lshlrev_b32 v35, 3, v35
    v_bfe_u32 v35, s23, v35, 8
    s_cmp_lg_u32 s21, 0
    s_cbranch_scc1 L_nopub_1
    v_mov_b32 v14, 162880
    ds_read_b128 v[104:107], v14
    s_lshl_b32 s12, s2, 3
    s_add_u32 s12, s12, 0
    s_waitcnt lgkmcnt(0)
    v_max3_u32 v104, v104, v105, v106
    v_max_u32 v104, v104, v107
    v_mov_b32 v105, s23
    s_mov_b64 exec, 1
    buffer_store_dwordx2 v[104:105], v13, s[32:35], s12 offen sc1
    s_mov_b64 exec, -1
L_nopub_1:
L_bw6_1:
    s_waitcnt vmcnt(10)
    s_barrier
    s_bfe_u32 s91, s69, 0x40000
    s_lshl_b32 s92, s91, 7
    s_mul_i32 s93, s91, 393216
    s_add_u32 m0, s94, 81920
    s_nop 0
    buffer_load_dwordx4 v20, s[24:27], s92 offen offset:0 lds
    buffer_load_dwordx4 v21, s[24:27], s92 offen offset:1024 lds
    buffer_load_dwordx4 v22, s[24:27], s92 offen offset:2048 lds
    buffer_load_dwordx4 v23, s[24:27], s92 offen offset:3072 lds
    s_add_u32 m0, s95, 106496
    s_nop 0
    buffer_load_dwordx4 v24, s[28:31], s93 offen offset:0 lds
    buffer_load_dwordx4 v25, s[28:31], s93 offen offset:1024 lds
    s_add_u32 m0, s95, 114688
    s_nop 0
    buffer_load_dwordx4 v26, s[28:31], s93 offen offset:0 lds
    buffer_load_dwordx4 v27, s[28:31], s93 offen offset:1024 lds
    s_add_u32 m0, s95, 98304
    s_nop 0
    buffer_load_dwordx4 v28, s[28:31], s93 offen offset:0 lds
    buffer_load_dwordx4 v29, s[28:31], s93 offen offset:1024 lds
    s_cmp_ge_u32 s10, 224
    s_cbranch_scc1 L_p31_1
    s_add_u32 s12, s9, 0
    buffer_load_dwordx4 v[160:163], v30, s[44:47], s12 offen nt
    s_add_u32 s12, s9, 7168
    buffer_load_dwordx4 v[164:167], v30, s[44:47], s12 offen nt
    s_add_u32 s12, s9, 14336
    buffer_load_dwordx4 v[168:171], v30, s[44:47], s12 offen nt
    s_add_u32 s12, s9, 21504
    buffer_load_dwordx4 v[172:175], v30, s[44:47], s12 offen nt
    s_add_u32 s12, s9, 28672
    buffer_load_dwordx4 v[176:179], v30, s[44:47], s12 offen nt
    s_add_u32 s12, s9, 35840
    buffer_load_dwordx4 v[180:183], v30, s[44:47], s12 offen nt
    s_add_u32 s12, s9, 43008
    buffer_load_dwordx4 v[184:187], v30, s[44:47], s12 offen nt
    s_add_u32 s12, s9, 50176
    buffer_load_dwordx4 v[188:191], v30, s[44:47], s12 offen nt
    s_branch L_p3e1_1
L_p31_1:
    s_mov_b64 exec, 63
    s_bfe_u32 s12, s69, 0x4000c
    s_mul_i32 s12, s12, 393216
    buffer_load_dword v160, v32, s[28:31], s12 offen
    s_bfe_u32 s12, s69, 0x40010
    s_mul_i32 s12, s12, 393216
    buffer_load_dword v164, v32, s[28:31], s12 offen
    s_bfe_u32 s12, s69, 0x40014
    s_mul_i32 s12, s12, 393216
    buffer_load_dword v168, v32, s[28:31], s12 offen
    s_bfe_u32 s12, s69, 0x40018
    s_mul_i32 s12, s12, 393216
    buffer_load_dword v172, v32, s[28:31], s12 offen
    s_bfe_u32 s12, s69, 0x4001c
    s_mul_i32 s12, s12, 393216
    buffer_load_dword v176, v32, s[28:31], s12 offen
    s_mov_b64 exec, 1
    s_bfe_u32 s12, s69, 0x4001c
    s_mul_i32 s12, s12, 393216
    buffer_load_dword v180, v32, s[28:31], s12 offen
    s_bfe_u32 s12, s69, 0x4001c
    s_mul_i32 s12, s12, 393216
    buffer_load_dword v184, v32, s[28:31], s12 offen
    s_bfe_u32 s12, s69, 0x4001c
    s_mul_i32 s12, s12, 393216
    buffer_load_dword v188, v32, s[28:31], s12 offen
    s_mov_b64 exec, -1
L_p3e1_1:
    s_mov_b32 exec_lo, 0xffff0000
    s_mov_b32 exec_hi, 0
    buffer_load_dword v19, v10, s[36:39], 0 offen
    s_mov_b64 exec, -1
L_bw7_1:
    s_waitcnt vmcnt(19)
    s_barrier
    s_bfe_u32 s91, s69, 0x40004
    s_lshl_b32 s92, s91, 7
    s_mul_i32 s93, s91, 393216
    s_add_u32 m0, s94, 0
    s_nop 0
    buffer_load_dwordx4 v20, s[24:27], s92 offen offset:0 lds
    buffer_load_dwordx4 v21, s[24:27], s92 offen offset:1024 lds
    buffer_load_dwordx4 v22, s[24:27], s92 offen offset:2048 lds
    buffer_load_dwordx4 v23, s[24:27], s92 offen offset:3072 lds
    s_add_u32 m0, s95, 24576
    s_nop 0
    buffer_load_dwordx4 v24, s[28:31], s93 offen offset:0 lds
L_bw8_1:
    s_waitcnt vmcnt(14)
    s_barrier
    s_add_u32 m0, s95, 24576
    s_nop 0
    buffer_load_dwordx4 v25, s[28:31], s93 offen offset:1024 lds
    s_add_u32 m0, s95, 32768
    s_nop 0
    buffer_load_dwordx4 v26, s[28:31], s93 offen offset:0 lds
    buffer_load_dwordx4 v27, s[28:31], s93 offen offset:1024 lds
    s_add_u32 m0, s95, 16384
    s_nop 0
    buffer_load_dwordx4 v28, s[28:31], s93 offen offset:0 lds
    buffer_load_dwordx4 v29, s[28:31], s93 offen offset:1024 lds
    s_bfe_u32 s91, s69, 0x40008
    s_lshl_b32 s92, s91, 7
    s_mul_i32 s93, s91, 393216
    s_add_u32 m0, s94, 40960
    s_nop 0
    buffer_load_dwordx4 v20, s[24:27], s92 offen offset:0 lds
    buffer_load_dwordx4 v21, s[24:27], s92 offen offset:1024 lds
    buffer_load_dwordx4 v22, s[24:27], s92 offen offset:2048 lds
    buffer_load_dwordx4 v23, s[24:27], s92 offen offset:3072 lds
    s_add_u32 m0, s95, 65536
    s_nop 0
    buffer_load_dwordx4 v24, s[28:31], s93 offen offset:0 lds
    buffer_load_dwordx4 v25, s[28:31], s93 offen offset:1024 lds
    s_add_u32 m0, s95, 73728
    s_nop 0
    buffer_load_dwordx4 v26, s[28:31], s93 offen offset:0 lds
L_bw9_1:
    s_waitcnt vmcnt(7)
    s_barrier
    s_add_u32 m0, s95, 73728
    s_nop 0
    buffer_load_dwordx4 v27, s[28:31], s93 offen offset:1024 lds
    s_add_u32 m0, s95, 57344
    s_nop 0
    buffer_load_dwordx4 v28, s[28:31], s93 offen offset:0 lds
    buffer_load_dwordx4 v29, s[28:31], s93 offen offset:1024 lds
    s_bfe_u32 s91, s69, 0x4000c
    s_lshl_b32 s92, s91, 7
    s_mul_i32 s93, s91, 393216
    s_add_u32 m0, s94, 122880
    s_nop 0
    buffer_load_dwordx4 v20, s[24:27], s92 offen offset:0 lds
    buffer_load_dwordx4 v21, s[24:27], s92 offen offset:1024 lds
    buffer_load_dwordx4 v22, s[24:27], s92 offen offset:2048 lds
    buffer_load_dwordx4 v23, s[24:27], s92 offen offset:3072 lds
    s_add_u32 m0, s95, 106496
    s_nop 0
    buffer_load_dwordx4 v24, s[28:31], s93 offen offset:0 lds
    buffer_load_dwordx4 v25, s[28:31], s93 offen offset:1024 lds
    s_add_u32 m0, s95, 114688
    s_nop 0
    buffer_load_dwordx4 v26, s[28:31], s93 offen offset:0 lds
    buffer_load_dwordx4 v27, s[28:31], s93 offen offset:1024 lds
    s_mov_b32 s12, 0
    buffer_load_dwordx4 v[104:107], v5, s[32:35], s12 offen offset:0 sc1
    buffer_load_dwordx4 v[108:111], v5, s[32:35], s12 offen offset:1024 sc1
L_bw10_1:
    s_waitcnt vmcnt(10)
    s_barrier
    s_bfe_u32 s91, s69, 0x40010
    s_lshl_b32 s92, s91, 7
    s_mul_i32 s93, s91, 393216
    s_add_u32 m0, s94, 139264
    s_nop 0
    buffer_load_dwordx4 v20, s[24:27], s92 offen offset:0 lds
    buffer_load_dwordx4 v21, s[24:27], s92 offen offset:1024 lds
    buffer_load_dwordx4 v22, s[24:27], s92 offen offset:2048 lds
    buffer_load_dwordx4 v23, s[24:27], s92 offen offset:3072 lds
    s_add_u32 m0, s95, 24576
    s_nop 0
    buffer_load_dwordx4 v24, s[28:31], s93 offen offset:0 lds
    buffer_load_dwordx4 v25, s[28:31], s93 offen offset:1024 lds
    s_add_u32 m0, s95, 32768
    s_nop 0
    buffer_load_dwordx4 v26, s[28:31], s93 offen offset:0 lds
    buffer_load_dwordx4 v27, s[28:31], s93 offen offset:1024 lds
L_bw11_1:
    s_waitcnt vmcnt(10)
    s_barrier
    s_bfe_u32 s91, s69, 0x40014
    s_lshl_b32 s92, s91, 7
    s_mul_i32 s93, s91, 393216
    s_add_u32 m0, s94, 40960
    s_nop 0
    buffer_load_dwordx4 v20, s[24:27], s92 offen offset:0 lds
    s_waitcnt vmcnt(9)
    s_mov_b32 s13, 0
    v_xor_b32 v105, s23, v105
    v_xor_b32 v107, s23, v107
    v_xor_b32 v109, s23, v109
    v_xor_b32 v111, s23, v111
    v_or3_b32 v105, v105, v107, v109
    v_or_b32 v105, v105, v111
    v_cmp_ne_u32 vcc, 0, v105
    s_cbranch_vccnz L_keyre_1
L_keyok_1:
    buffer_load_dwordx4 v21, s[24:27], s92 offen offset:1024 lds
    v_max3_u32 v104, v104, v106, v108
    v_max_u32 v104, v104, v110
    s_nop 1
    v_max_u32_dpp v104, v104, v104 row_shr:1 row_mask:0xf bank_mask:0xf
    s_nop 1
    v_max_u32_dpp v104, v104, v104 row_shr:2 row_mask:0xf bank_mask:0xf
    s_nop 1
    v_max_u32_dpp v104, v104, v104 row_shr:4 row_mask:0xf bank_mask:0xf
    s_nop 1
    v_max_u32_dpp v104, v104, v104 row_shr:8 row_mask:0xf bank_mask:0xf
    s_nop 1
    v_max_u32_dpp v104, v104, v104 row_bcast:15 row_mask:0xa bank_mask:0xf
    buffer_load_dwordx4 v22, s[24:27], s92 offen offset:2048 lds
    s_nop 0
    v_max_u32_dpp v104, v104, v104 row_bcast:31 row_mask:0xc bank_mask:0xf
    s_nop 0
    v_readlane_b32 s14, v104, 63
    s_nop 1
    s_and_b32 s15, s14, 2047
    s_sub_u32 s15, 2047, s15
    s_lshl_b32 s12, s15, 11
    s_lshl_b32 s13, s70, 1
    s_add_u32 s12, s12, s13
    buffer_load_dwordx4 v[36:39], v34, s[24:27], s12 offen
    s_lshr_b32 s12, s14, 11
    s_and_b32 s13, s12, 0x8000
    s_cmp_lg_u32 s13, 0
    s_mov_b32 s13, 0xffff
    s_cselect_b32 s13, 0x8000, s13
    s_xor_b32 s12, s12, s13
    s_lshl_b32 s12, s12, 16
    v_mov_b32 v105, s12
    buffer_load_dwordx4 v23, s[24:27], s92 offen offset:3072 lds
    v_mul_f32 v105, 0xbfb8aa3b, v105
    v_exp_f32 v105, v105
    s_nop 0
    v_add_f32 v105, 1.0, v105
    v_rcp_f32 v105, v105
    s_nop 0
    v_cvt_pk_bf16_f32 v105, v105, v105
    v_lshlrev_b32 v105, 16, v105
    s_add_u32 s12, s15, 1
    v_mov_b32 v104, s12
    s_add_u32 m0, s95, 65536
    s_nop 0
    buffer_load_dwordx4 v24, s[28:31], s93 offen offset:0 lds
    v_mov_b32 v106, s23
    v_readfirstlane_b32 s14, v105
    v_mov_b32 v14, 162864
    s_mov_b64 exec, 1
    ds_write_b96 v14, v[104:106]
    s_mov_b64 exec, -1
    s_waitcnt lgkmcnt(0)
    buffer_load_dwordx4 v25, s[28:31], s93 offen offset:1024 lds
    s_add_u32 m0, s95, 73728
    s_nop 0
    buffer_load_dwordx4 v26, s[28:31], s93 offen offset:0 lds
    buffer_load_dwordx4 v27, s[28:31], s93 offen offset:1024 lds
    s_add_u32 s12, s97, 0
    buffer_load_dwordx4 v[192:195], v31, s[64:67], s12 offen nt
    s_add_u32 s12, s97, 16384
    buffer_load_dwordx4 v[196:199], v31, s[64:67], s12 offen nt
    s_add_u32 s12, s97, 32768
    buffer_load_dwordx4 v[200:203], v31, s[64:67], s12 offen nt
    s_add_u32 s12, s97, 49152
    buffer_load_dwordx4 v[204:207], v31, s[64:67], s12 offen nt
    s_add_u32 s12, s97, 65536
    buffer_load_dwordx4 v[208:211], v31, s[64:67], s12 offen nt
    s_add_u32 s12, s97, 81920
    buffer_load_dwordx4 v[212:215], v31, s[64:67], s12 offen nt
    s_add_u32 s12, s97, 98304
    buffer_load_dwordx4 v[216:219], v31, s[64:67], s12 offen nt
L_bw12_1:
    s_waitcnt vmcnt(16)
    s_barrier
    s_bfe_u32 s91, s69, 0x40018
    s_lshl_b32 s92, s91, 7
    s_mul_i32 s93, s91, 393216
    s_add_u32 m0, s94, 81920
    s_nop 0
    buffer_load_dwordx4 v20, s[24:27], s92 offen offset:0 lds
    s_waitcnt vmcnt(13)
    s_mov_b32 s8, 0xffff0000
    v_lshlrev_b32 v40, 16, v36
    v_and_b32 v41, s8, v36
    v_lshlrev_b32 v42, 16, v37
    v_and_b32 v43, s8, v37
    v_lshlrev_b32 v44, 16, v38
    buffer_load_dwordx4 v21, s[24:27], s92 offen offset:1024 lds
    v_and_b32 v45, s8, v38
    v_lshlrev_b32 v46, 16, v39
    v_and_b32 v47, s8, v39
    v_lshlrev_b32 v48, 16, v128
    v_lshlrev_b32 v49, 16, v129
    v_and_b32 v128, s8, v128
    v_and_b32 v129, s8, v129
    buffer_load_dwordx4 v22, s[24:27], s92 offen offset:2048 lds
    v_mul_f32 v220, v48, v40
    v_mul_f32 v222, v49, v40
    v_mul_f32 v221, v128, v40
    v_mul_f32 v223, v129, v40
    v_lshlrev_b32 v50, 16, v130
    v_lshlrev_b32 v51, 16, v131
    v_and_b32 v130, s8, v130
    buffer_load_dwordx4 v23, s[24:27], s92 offen offset:3072 lds
    v_and_b32 v131, s8, v131
    v_mul_f32 v224, v50, v40
    v_mul_f32 v226, v51, v40
    v_mul_f32 v225, v130, v40
    v_mul_f32 v227, v131, v40
    v_lshlrev_b32 v48, 16, v160
    v_lshlrev_b32 v49, 16, v161
    s_add_u32 m0, s95, 106496
    s_nop 0
    buffer_load_dwordx4 v24, s[28:31], s93 offen offset:0 lds
    v_and_b32 v160, s8, v160
    v_and_b32 v161, s8, v161
    v_mul_f32 v228, v48, v40
    v_mul_f32 v230, v49, v40
    v_mul_f32 v229, v160, v40
    v_mul_f32 v231, v161, v40
    v_lshlrev_b32 v50, 16, v162
    v_lshlrev_b32 v51, 16, v163
    v_and_b32 v162, s8, v162
    v_and_b32 v163, s8, v163
    v_mul_f32 v232, v50, v40
    v_mul_f32 v234, v51, v40
    v_mul_f32 v233, v162, v40
    v_mul_f32 v235, v163, v40
    v_lshlrev_b32 v48, 16, v132
    v_lshlrev_b32 v49, 16, v133
    v_and_b32 v132, s8, v132
    v_and_b32 v133, s8, v133
    v_fmac_f32 v220, v48, v41
    v_fmac_f32 v222, v49, v41
    v_fmac_f32 v221, v132, v41
    v_fmac_f32 v223, v133, v41
    v_lshlrev_b32 v50, 16, v134
    v_lshlrev_b32 v51, 16, v135
    v_and_b32 v134, s8, v134
    v_and_b32 v135, s8, v135
    v_fmac_f32 v224, v50, v41
    v_fmac_f32 v226, v51, v41
    v_fmac_f32 v225, v134, v41
    v_fmac_f32 v227, v135, v41
    v_lshlrev_b32 v48, 16, v164
    v_lshlrev_b32 v49, 16, v165
L_bw13_1:
    s_waitcnt vmcnt(12)
    s_barrier
    s_add_u32 m0, s95, 106496
    s_nop 0
    buffer_load_dwordx4 v25, s[28:31], s93 offen offset:1024 lds
    v_and_b32 v164, s8, v164
    v_and_b32 v165, s8, v165
    v_fmac_f32 v228, v48, v41
    v_fmac_f32 v230, v49, v41
    v_fmac_f32 v229, v164, v41
    v_fmac_f32 v231, v165, v41
    v_lshlrev_b32 v50, 16, v166
    s_add_u32 m0, s95, 114688
    s_nop 0
    buffer_load_dwordx4 v26, s[28:31], s93 offen offset:0 lds
    v_lshlrev_b32 v51, 16, v167
    v_and_b32 v166, s8, v166
    v_and_b32 v167, s8, v167
    v_fmac_f32 v232, v50, v41
    v_fmac_f32 v234, v51, v41
    v_fmac_f32 v233, v166, v41
    v_fmac_f32 v235, v167, v41
    v_lshlrev_b32 v48, 16, v136
    v_lshlrev_b32 v49, 16, v137
    v_and_b32 v136, s8, v136
    v_and_b32 v137, s8, v137
    v_fmac_f32 v220, v48, v42
    v_fmac_f32 v222, v49, v42
    v_fmac_f32 v221, v136, v42
    buffer_load_dwordx4 v27, s[28:31], s93 offen offset:1024 lds
    v_fmac_f32 v223, v137, v42
    v_lshlrev_b32 v50, 16, v138
    v_lshlrev_b32 v51, 16, v139
    v_and_b32 v138, s8, v138
    v_and_b32 v139, s8, v139
    v_fmac_f32 v224, v50, v42
    v_fmac_f32 v226, v51, v42
    v_fmac_f32 v225, v138, v42
    v_fmac_f32 v227, v139, v42
    v_lshlrev_b32 v48, 16, v168
    v_lshlrev_b32 v49, 16, v169
    v_and_b32 v168, s8, v168
    v_and_b32 v169, s8, v169
    v_fmac_f32 v228, v48, v42
    s_bfe_u32 s91, s69, 0x4001c
    s_lshl_b32 s92, s91, 7
    s_mul_i32 s93, s91, 393216
    s_add_u32 m0, s94, 0
    s_nop 0
    buffer_load_dwordx4 v20, s[24:27], s92 offen offset:0 lds
    v_fmac_f32 v230, v49, v42
    v_fmac_f32 v229, v168, v42
    v_fmac_f32 v231, v169, v42
    v_lshlrev_b32 v50, 16, v170
    v_lshlrev_b32 v51, 16, v171
    v_and_b32 v170, s8, v170
    v_and_b32 v171, s8, v171
    buffer_load_dwordx4 v21, s[24:27], s92 offen offset:1024 lds
    v_fmac_f32 v232, v50, v42
    v_fmac_f32 v234, v51, v42
    v_fmac_f32 v233, v170, v42
    v_fmac_f32 v235, v171, v42
    v_lshlrev_b32 v48, 16, v140
    v_lshlrev_b32 v49, 16, v141
    v_and_b32 v140, s8, v140
    buffer_load_dwordx4 v22, s[24:27], s92 offen offset:2048 lds
    v_and_b32 v141, s8, v141
    v_fmac_f32 v220, v48, v43
    v_fmac_f32 v222, v49, v43
    v_fmac_f32 v221, v140, v43
    v_fmac_f32 v223, v141, v43
    v_lshlrev_b32 v50, 16, v142
    v_lshlrev_b32 v51, 16, v143
    buffer_load_dwordx4 v23, s[24:27], s92 offen offset:3072 lds
    v_and_b32 v142, s8, v142
    v_and_b32 v143, s8, v143
    v_fmac_f32 v224, v50, v43
    v_fmac_f32 v226, v51, v43
    v_fmac_f32 v225, v142, v43
    v_fmac_f32 v227, v143, v43
    v_lshlrev_b32 v48, 16, v172
    s_add_u32 m0, s95, 24576
    s_nop 0
    buffer_load_dwordx4 v24, s[28:31], s93 offen offset:0 lds
    v_lshlrev_b32 v49, 16, v173
    v_and_b32 v172, s8, v172
    v_and_b32 v173, s8, v173
    v_fmac_f32 v228, v48, v43
    v_fmac_f32 v230, v49, v43
    v_fmac_f32 v229, v172, v43
    v_fmac_f32 v231, v173, v43
    buffer_load_dwordx4 v25, s[28:31], s93 offen offset:1024 lds
    v_lshlrev_b32 v50, 16, v174
    v_lshlrev_b32 v51, 16, v175
    v_and_b32 v174, s8, v174
    v_and_b32 v175, s8, v175
    v_fmac_f32 v232, v50, v43
    v_fmac_f32 v234, v51, v43
    v_fmac_f32 v233, v174, v43
    s_add_u32 m0, s95, 32768
    s_nop 0
    buffer_load_dwordx4 v26, s[28:31], s93 offen offset:0 lds
    v_fmac_f32 v235, v175, v43
    v_lshlrev_b32 v48, 16, v144
    v_lshlrev_b32 v49, 16, v145
    v_and_b32 v144, s8, v144
    v_and_b32 v145, s8, v145
    v_fmac_f32 v220, v48, v44
    v_fmac_f32 v222, v49, v44
    v_fmac_f32 v221, v144, v44
    v_fmac_f32 v223, v145, v44
    v_lshlrev_b32 v50, 16, v146
    v_lshlrev_b32 v51, 16, v147
    v_and_b32 v146, s8, v146
    v_and_b32 v147, s8, v147
    v_fmac_f32 v224, v50, v44
    v_fmac_f32 v226, v51, v44
    v_fmac_f32 v225, v146, v44
    v_fmac_f32 v227, v147, v44
    v_lshlrev_b32 v48, 16, v176
    v_lshlrev_b32 v49, 16, v177
    v_and_b32 v176, s8, v176
    v_and_b32 v177, s8, v177
    v_fmac_f32 v228, v48, v44
    v_fmac_f32 v230, v49, v44
    v_fmac_f32 v229, v176, v44
    v_fmac_f32 v231, v177, v44
    v_lshlrev_b32 v50, 16, v178
    v_lshlrev_b32 v51, 16, v179
    v_and_b32 v178, s8, v178
    v_and_b32 v179, s8, v179
    v_fmac_f32 v232, v50, v44
    v_fmac_f32 v234, v51, v44
    v_fmac_f32 v233, v178, v44
    v_fmac_f32 v235, v179, v44
    v_lshlrev_b32 v48, 16, v148
    v_lshlrev_b32 v49, 16, v149
    v_and_b32 v148, s8, v148
    v_and_b32 v149, s8, v149
    v_fmac_f32 v220, v48, v45
    v_fmac_f32 v222, v49, v45
L_bw14_1:
    s_waitcnt vmcnt(7)
    s_barrier
    s_add_u32 m0, s95, 32768
    s_nop 0
    buffer_load_dwordx4 v27, s[28:31], s93 offen offset:1024 lds
    v_fmac_f32 v221, v148, v45
    v_fmac_f32 v223, v149, v45
    v_lshlrev_b32 v50, 16, v150
    v_lshlrev_b32 v51, 16, v151
    v_and_b32 v150, s8, v150
    v_and_b32 v151, s8, v151
    v_fmac_f32 v224, v50, v45
    v_fmac_f32 v226, v51, v45
    v_fmac_f32 v225, v150, v45
    v_fmac_f32 v227, v151, v45
    v_lshlrev_b32 v48, 16, v180
    v_lshlrev_b32 v49, 16, v181
    v_and_b32 v180, s8, v180
    v_and_b32 v181, s8, v181
    s_bfe_u32 s12, s69, 0x4000c
    s_mul_i32 s12, s12, 393216
    s_add_u32 m0, s95, 16384
    s_nop 0
    buffer_load_dwordx4 v28, s[28:31], s12 offen offset:0 lds
    buffer_load_dwordx4 v29, s[28:31], s12 offen offset:1024 lds
    s_bfe_u32 s12, s69, 0x40010
    s_mul_i32 s12, s12, 393216
    s_add_u32 m0, s95, 57344
    s_nop 0
    buffer_load_dwordx4 v28, s[28:31], s12 offen offset:0 lds
    buffer_load_dwordx4 v29, s[28:31], s12 offen offset:1024 lds
    s_mul_i32 s12, s21, 16
    s_add_u32 s12, s12, 0
    s_and_b32 s90, s88, 1
    s_lshl_b32 s90, s90, 6
    s_xor_b32 s12, s12, s90
    s_lshl_b32 s12, s12, 14
    s_add_u32 s90, s12, 0
    buffer_load_dwordx4 v[84:87], v33, s[36:39], s90 offen
    s_add_u32 s90, s12, 16384
    buffer_load_dwordx4 v[88:91], v33, s[36:39], s90 offen
    s_add_u32 s90, s12, 32768
    buffer_load_dwordx4 v[92:95], v33, s[36:39], s90 offen
    s_add_u32 s90, s12, 49152
    buffer_load_dwordx4 v[96:99], v33, s[36:39], s90 offen
    s_add_u32 s90, s12, 65536
    buffer_load_dwordx4 v[100:103], v33, s[36:39], s90 offen
    s_add_u32 s90, s12, 81920
    buffer_load_dwordx4 v[116:119], v33, s[36:39], s90 offen
    s_add_u32 s90, s12, 98304
    buffer_load_dwordx4 v[120:123], v33, s[36:39], s90 offen
    s_add_u32 s90, s12, 114688
    buffer_load_dwordx4 v[124:127], v33, s[36:39], s90 offen
    s_add_u32 s90, s12, 131072
    buffer_load_dwordx4 v[64:67], v33, s[36:39], s90 offen
    v_fmac_f32 v228, v48, v45
    v_fmac_f32 v230, v49, v45
    v_fmac_f32 v229, v180, v45
    v_fmac_f32 v231, v181, v45
    v_lshlrev_b32 v50, 16, v182
    v_lshlrev_b32 v51, 16, v183
    v_and_b32 v182, s8, v182
    v_and_b32 v183, s8, v183
    v_fmac_f32 v232, v50, v45
    v_fmac_f32 v234, v51, v45
    v_fmac_f32 v233, v182, v45
    v_fmac_f32 v235, v183, v45
    v_lshlrev_b32 v48, 16, v152
    v_lshlrev_b32 v49, 16, v153
    v_and_b32 v152, s8, v152
    v_and_b32 v153, s8, v153
    v_fmac_f32 v220, v48, v46
    v_fmac_f32 v222, v49, v46
    v_fmac_f32 v221, v152, v46
    v_fmac_f32 v223, v153, v46
    v_lshlrev_b32 v50, 16, v154
    v_lshlrev_b32 v51, 16, v155
    v_and_b32 v154, s8, v154
    v_and_b32 v155, s8, v155
    v_fmac_f32 v224, v50, v46
L_bw15_1:
    s_waitcnt vmcnt(13)
    s_barrier
    v_fmac_f32 v226, v51, v46
    v_fmac_f32 v225, v154, v46
    v_fmac_f32 v227, v155, v46
    v_lshlrev_b32 v48, 16, v184
    v_lshlrev_b32 v49, 16, v185
    v_and_b32 v184, s8, v184
    v_and_b32 v185, s8, v185
    v_fmac_f32 v228, v48, v46
    v_fmac_f32 v230, v49, v46
    v_fmac_f32 v229, v184, v46
    v_fmac_f32 v231, v185, v46
    v_lshlrev_b32 v50, 16, v186
    v_lshlrev_b32 v51, 16, v187
    v_and_b32 v186, s8, v186
    v_and_b32 v187, s8, v187
    v_fmac_f32 v232, v50, v46
    v_fmac_f32 v234, v51, v46
    v_fmac_f32 v233, v186, v46
    v_fmac_f32 v235, v187, v46
    v_lshlrev_b32 v48, 16, v156
    v_lshlrev_b32 v49, 16, v157
    v_and_b32 v156, s8, v156
    v_and_b32 v157, s8, v157
    v_fmac_f32 v220, v48, v47
    v_fmac_f32 v222, v49, v47
    v_fmac_f32 v221, v156, v47
    v_fmac_f32 v223, v157, v47
    v_lshlrev_b32 v50, 16, v158
    v_lshlrev_b32 v51, 16, v159
    v_and_b32 v158, s8, v158
    v_and_b32 v159, s8, v159
    v_fmac_f32 v224, v50, v47
    v_fmac_f32 v226, v51, v47
    v_fmac_f32 v225, v158, v47
    v_fmac_f32 v227, v159, v47
    v_lshlrev_b32 v48, 16, v188
    v_lshlrev_b32 v49, 16, v189
    v_and_b32 v188, s8, v188
    v_and_b32 v189, s8, v189
    v_fmac_f32 v228, v48, v47
    v_fmac_f32 v230, v49, v47
    v_fmac_f32 v229, v188, v47
    v_fmac_f32 v231, v189, v47
    v_lshlrev_b32 v50, 16, v190
    v_lshlrev_b32 v51, 16, v191
    v_and_b32 v190, s8, v190
    v_and_b32 v191, s8, v191
    v_fmac_f32 v232, v50, v47
    v_fmac_f32 v234, v51, v47
    v_fmac_f32 v233, v190, v47
    v_fmac_f32 v235, v191, v47
    v_permlane32_swap_b32 v220, v228
    v_permlane32_swap_b32 v221, v229
    v_permlane32_swap_b32 v222, v230
    v_permlane32_swap_b32 v223, v231
    v_permlane32_swap_b32 v224, v232
    v_permlane32_swap_b32 v225, v233
    v_permlane32_swap_b32 v226, v234
    v_permlane32_swap_b32 v227, v235
    v_add_f32 v220, v220, v228
    v_add_f32 v221, v221, v229
    v_add_f32 v222, v222, v230
    v_add_f32 v223, v223, v231
    v_add_f32 v224, v224, v232
    v_add_f32 v225, v225, v233
    v_add_f32 v226, v226, v234
    v_add_f32 v227, v227, v235
    v_permlane16_swap_b32 v220, v224
    v_permlane16_swap_b32 v221, v225
    v_permlane16_swap_b32 v222, v226
    v_permlane16_swap_b32 v223, v227
    v_add_f32 v220, v220, v224
    v_add_f32 v221, v221, v225
    v_add_f32 v222, v222, v226
    v_add_f32 v223, v223, v227
    v_add_f32_dpp v220, v220, v220 row_ror:8 row_mask:0xf bank_mask:0xf
    v_add_f32_dpp v221, v221, v221 row_ror:8 row_mask:0xf bank_mask:0xf
    v_add_f32_dpp v222, v222, v222 row_ror:8 row_mask:0xf bank_mask:0xf
    v_add_f32_dpp v223, v223, v223 row_ror:8 row_mask:0xf bank_mask:0xf
    s_branch L_varend
.fill 429, 4, 0xbf800000
L_var2:
    s_nop 0
    s_waitcnt vmcnt(6)
    s_barrier
    s_add_u32 m0, s95, 73728
    s_nop 0
    buffer_load_dwordx4 v26, s[28:31], s93 offen offset:0 lds
    buffer_load_dwordx4 v27, s[28:31], s93 offen offset:1024 lds
    s_add_u32 m0, s95, 57344
    s_nop 0
    buffer_load_dwordx4 v28, s[28:31], s93 offen offset:0 lds
    buffer_load_dwordx4 v29, s[28:31], s93 offen offset:1024 lds
    s_bfe_u32 s91, s68, 0x40008
    s_lshl_b32 s92, s91, 7
    s_mul_i32 s93, s91, 393216
    s_add_u32 m0, s94, 81920
    s_nop 0
    buffer_load_dwordx4 v20, s[24:27], s92 offen offset:0 lds
    buffer_load_dwordx4 v21, s[24:27], s92 offen offset:1024 lds
    buffer_load_dwordx4 v22, s[24:27], s92 offen offset:2048 lds
    buffer_load_dwordx4 v23, s[24:27], s92 offen offset:3072 lds
    s_add_u32 m0, s95, 106496
    s_nop 0
    buffer_load_dwordx4 v24, s[28:31], s93 offen offset:0 lds
    buffer_load_dwordx4 v25, s[28:31], s93 offen offset:1024 lds
    s_add_u32 m0, s95, 114688
    s_nop 0
    buffer_load_dwordx4 v26, s[28:31], s93 offen offset:0 lds
    buffer_load_dwordx4 v27, s[28:31], s93 offen offset:1024 lds
    s_add_u32 m0, s95, 98304
    s_nop 0
    buffer_load_dwordx4 v28, s[28:31], s93 offen offset:0 lds
    buffer_load_dwordx4 v29, s[28:31], s93 offen offset:1024 lds
    s_lshl_b32 s12, s19, 2
    s_add_u32 s12, s12, s21
    s_lshl_b32 s12, s12, 10
    s_lshl_b32 s13, s21, 10
    s_add_u32 m0, s13, 155648
    s_nop 0
    buffer_load_dwordx4 v5, s[76:79], s12 offen lds
    s_lshl_b32 s12, s22, 11
    buffer_load_dwordx4 v[40:43], v5, s[24:27], s12 offen offset:0
    buffer_load_dwordx4 v[44:47], v5, s[24:27], s12 offen offset:1024
    buffer_load_dwordx4 v[48:51], v5, s[24:27], s12 offen offset:2048
    buffer_load_dwordx4 v[52:55], v5, s[24:27], s12 offen offset:3072
    buffer_load_dwordx4 v[56:59], v5, s[80:83], 0 offen offset:0
    buffer_load_dwordx4 v[60:63], v5, s[80:83], 0 offen offset:1024
    buffer_load_dwordx4 v[64:67], v5, s[84:87], 0 offen offset:0
    buffer_load_dwordx4 v[68:71], v5, s[84:87], 0 offen offset:1024
L_bw1_2:
    s_waitcnt vmcnt(19)
    s_barrier
    s_bfe_u32 s91, s68, 0x4000c
    s_lshl_b32 s92, s91, 7
    s_mul_i32 s93, s91, 393216
    s_add_u32 m0, s94, 0
    s_nop 0
    buffer_load_dwordx4 v20, s[24:27], s92 offen offset:0 lds
    s_waitcnt vmcnt(1)
    s_mov_b32 s8, 0xffff0000
    v_lshlrev_b32 v72, 16, v56
    v_and_b32 v56, s8, v56
    v_lshlrev_b32 v73, 16, v64
    v_and_b32 v64, s8, v64
    v_lshlrev_b32 v112, 16, v40
    buffer_load_dwordx4 v21, s[24:27], s92 offen offset:1024 lds
    v_and_b32 v40, s8, v40
    v_lshlrev_b32 v116, 16, v48
    v_and_b32 v48, s8, v48
    v_mul_f32 v113, v112, v73
    v_mul_f32 v114, v40, v64
    v_mul_f32 v90, v112, v72
    v_mul_f32 v117, v116, v73
    buffer_load_dwordx4 v22, s[24:27], s92 offen offset:2048 lds
    v_mul_f32 v118, v48, v64
    v_mul_f32 v92, v116, v72
    v_cvt_pk_bf16_f32 v113, 0, v113
    v_cvt_pk_bf16_f32 v114, 0, v114
    v_fmac_f32 v90, v40, v56
    v_cvt_pk_bf16_f32 v117, 0, v117
    v_cvt_pk_bf16_f32 v118, 0, v118
    buffer_load_dwordx4 v23, s[24:27], s92 offen offset:3072 lds
    v_fmac_f32 v92, v48, v56
    v_add_f32 v91, v113, v114
    v_add_f32 v93, v117, v118
    v_lshlrev_b32 v72, 16, v57
    v_and_b32 v57, s8, v57
    v_lshlrev_b32 v73, 16, v65
    v_and_b32 v65, s8, v65
    s_add_u32 m0, s95, 24576
    s_nop 0
    buffer_load_dwordx4 v24, s[28:31], s93 offen offset:0 lds
    v_lshlrev_b32 v112, 16, v41
    v_and_b32 v41, s8, v41
    v_lshlrev_b32 v116, 16, v49
    v_and_b32 v49, s8, v49
    v_mul_f32 v113, v112, v73
    v_mul_f32 v114, v41, v65
    v_fmac_f32 v90, v112, v72
    buffer_load_dwordx4 v25, s[28:31], s93 offen offset:1024 lds
    v_mul_f32 v117, v116, v73
    v_mul_f32 v118, v49, v65
    v_fmac_f32 v92, v116, v72
    v_cvt_pk_bf16_f32 v113, 0, v113
    v_cvt_pk_bf16_f32 v114, 0, v114
    v_fmac_f32 v90, v41, v57
    v_cvt_pk_bf16_f32 v117, 0, v117
    s_add_u32 m0, s95, 32768
    s_nop 0
    buffer_load_dwordx4 v26, s[28:31], s93 offen offset:0 lds
    v_cvt_pk_bf16_f32 v118, 0, v118
    v_fmac_f32 v92, v49, v57
    v_add_f32 v91, v91, v113
    v_add_f32 v93, v93, v117
    v_add_f32 v91, v91, v114
    v_add_f32 v93, v93, v118
    v_lshlrev_b32 v72, 16, v58
    buffer_load_dwordx4 v27, s[28:31], s93 offen offset:1024 lds
    v_and_b32 v58, s8, v58
    v_lshlrev_b32 v73, 16, v66
    v_and_b32 v66, s8, v66
    v_lshlrev_b32 v112, 16, v42
    v_and_b32 v42, s8, v42
    v_lshlrev_b32 v116, 16, v50
    v_and_b32 v50, s8, v50
    s_add_u32 m0, s95, 16384
    s_nop 0
    buffer_load_dwordx4 v28, s[28:31], s93 offen offset:0 lds
    v_mul_f32 v113, v112, v73
    v_mul_f32 v114, v42, v66
    v_fmac_f32 v90, v112, v72
    v_mul_f32 v117, v116, v73
    v_mul_f32 v118, v50, v66
    v_fmac_f32 v92, v116, v72
    v_cvt_pk_bf16_f32 v113, 0, v113
    buffer_load_dwordx4 v29, s[28:31], s93 offen offset:1024 lds
    v_cvt_pk_bf16_f32 v114, 0, v114
    v_fmac_f32 v90, v42, v58
    v_cvt_pk_bf16_f32 v117, 0, v117
    v_cvt_pk_bf16_f32 v118, 0, v118
    v_fmac_f32 v92, v50, v58
    v_add_f32 v91, v91, v113
    v_add_f32 v93, v93, v117
    s_cmp_lg_u32 s21, 0
    s_cbranch_scc1 L_noclr_2
    v_mov_b32 v104, -1
    v_mov_b32 v105, -1
    v_mov_b32 v106, -1
    v_mov_b32 v107, -1
    s_lshl_b32 s12, s19, 13
    s_lshl_b32 s13, s18, 9
    s_add_u32 s12, s12, s13
    s_add_u32 s12, s12, 32768
    s_lshl_b32 s13, s19, 11
    s_lshl_b32 s90, s18, 7
    s_add_u32 s13, s13, s90
    s_add_u32 s13, s13, 163840
    s_mov_b32 exec_hi, 0
    buffer_store_dwordx4 v[104:107], v5, s[32:35], s12 offen sc1
    s_mov_b32 exec_lo, 255
    buffer_store_dwordx4 v[104:107], v5, s[32:35], s13 offen sc1
    s_mov_b64 exec, -1
L_noclr_2:
    v_add_f32 v91, v91, v114
    v_add_f32 v93, v93, v118
    v_lshlrev_b32 v72, 16, v59
    v_and_b32 v59, s8, v59
    v_lshlrev_b32 v73, 16, v67
    v_and_b32 v67, s8, v67
    v_lshlrev_b32 v112, 16, v43
    v_and_b32 v43, s8, v43
    v_lshlrev_b32 v116, 16, v51
    v_and_b32 v51, s8, v51
    v_mul_f32 v113, v112, v73
    v_mul_f32 v114, v43, v67
    v_fmac_f32 v90, v112, v72
    v_mul_f32 v117, v116, v73
    v_mul_f32 v118, v51, v67
    v_fmac_f32 v92, v116, v72
    v_cvt_pk_bf16_f32 v113, 0, v113
    v_cvt_pk_bf16_f32 v114, 0, v114
    v_fmac_f32 v90, v43, v59
    v_cvt_pk_bf16_f32 v117, 0, v117
    v_cvt_pk_bf16_f32 v118, 0, v118
    v_fmac_f32 v92, v51, v59
    v_add_f32 v91, v91, v113
    v_add_f32 v93, v93, v117
    v_add_f32 v91, v91, v114
L_bw2_2:
    s_barrier
    s_bfe_u32 s91, s68, 0x40010
    s_lshl_b32 s92, s91, 7
    s_mul_i32 s93, s91, 393216
    s_add_u32 m0, s94, 40960
    s_nop 0
    buffer_load_dwordx4 v20, s[24:27], s92 offen offset:0 lds
    v_add_f32 v93, v93, v118
    v_lshlrev_b32 v72, 16, v60
    v_and_b32 v60, s8, v60
    v_lshlrev_b32 v73, 16, v68
    v_and_b32 v68, s8, v68
    v_lshlrev_b32 v112, 16, v44
    v_and_b32 v44, s8, v44
    buffer_load_dwordx4 v21, s[24:27], s92 offen offset:1024 lds
    v_lshlrev_b32 v116, 16, v52
    v_and_b32 v52, s8, v52
    v_mul_f32 v113, v112, v73
    v_mul_f32 v114, v44, v68
    v_fmac_f32 v90, v112, v72
    v_mul_f32 v117, v116, v73
    v_mul_f32 v118, v52, v68
    buffer_load_dwordx4 v22, s[24:27], s92 offen offset:2048 lds
    v_fmac_f32 v92, v116, v72
    v_cvt_pk_bf16_f32 v113, 0, v113
    v_cvt_pk_bf16_f32 v114, 0, v114
    v_fmac_f32 v90, v44, v60
    v_cvt_pk_bf16_f32 v117, 0, v117
    v_cvt_pk_bf16_f32 v118, 0, v118
    v_fmac_f32 v92, v52, v60
    buffer_load_dwordx4 v23, s[24:27], s92 offen offset:3072 lds
    v_add_f32 v91, v91, v113
    v_add_f32 v93, v93, v117
    v_add_f32 v91, v91, v114
    v_add_f32 v93, v93, v118
    v_lshlrev_b32 v72, 16, v61
    v_and_b32 v61, s8, v61
    v_lshlrev_b32 v73, 16, v69
    s_add_u32 m0, s95, 65536
    s_nop 0
    buffer_load_dwordx4 v24, s[28:31], s93 offen offset:0 lds
    v_and_b32 v69, s8, v69
    v_lshlrev_b32 v112, 16, v45
    v_and_b32 v45, s8, v45
    v_lshlrev_b32 v116, 16, v53
    v_and_b32 v53, s8, v53
    v_mul_f32 v113, v112, v73
    v_mul_f32 v114, v45, v69
    buffer_load_dwordx4 v25, s[28:31], s93 offen offset:1024 lds
    v_fmac_f32 v90, v112, v72
    v_mul_f32 v117, v116, v73
    v_mul_f32 v118, v53, v69
    v_fmac_f32 v92, v116, v72
    v_cvt_pk_bf16_f32 v113, 0, v113
    v_cvt_pk_bf16_f32 v114, 0, v114
    v_fmac_f32 v90, v45, v61
    s_add_u32 m0, s95, 73728
    s_nop 0
    buffer_load_dwordx4 v26, s[28:31], s93 offen offset:0 lds
    v_cvt_pk_bf16_f32 v117, 0, v117
    v_cvt_pk_bf16_f32 v118, 0, v118
    v_fmac_f32 v92, v53, v61
    v_add_f32 v91, v91, v113
    v_add_f32 v93, v93, v117
    v_add_f32 v91, v91, v114
    v_add_f32 v93, v93, v118
    buffer_load_dwordx4 v27, s[28:31], s93 offen offset:1024 lds
    v_lshlrev_b32 v72, 16, v62
    v_and_b32 v62, s8, v62
    v_lshlrev_b32 v73, 16, v70
    v_and_b32 v70, s8, v70
    v_lshlrev_b32 v112, 16, v46
    v_and_b32 v46, s8, v46
    v_lshlrev_b32 v116, 16, v54
    s_add_u32 m0, s95, 57344
    s_nop 0
    buffer_load_dwordx4 v28, s[28:31], s93 offen offset:0 lds
    v_and_b32 v54, s8, v54
    v_mul_f32 v113, v112, v73
    v_mul_f32 v114, v46, v70
    v_fmac_f32 v90, v112, v72
    v_mul_f32 v117, v116, v73
    v_mul_f32 v118, v54, v70
    v_fmac_f32 v92, v116, v72
    buffer_load_dwordx4 v29, s[28:31], s93 offen offset:1024 lds
    v_cvt_pk_bf16_f32 v113, 0, v113
    v_cvt_pk_bf16_f32 v114, 0, v114
    v_fmac_f32 v90, v46, v62
    v_cvt_pk_bf16_f32 v117, 0, v117
    v_cvt_pk_bf16_f32 v118, 0, v118
    v_fmac_f32 v92, v54, v62
    v_add_f32 v91, v91, v113
    s_cmp_ge_u32 s10, 224
    s_cbranch_scc1 L_p30_2
    s_add_u32 s12, s71, 0
    buffer_load_dwordx4 v[128:131], v30, s[40:43], s12 offen nt
    s_add_u32 s12, s71, 7168
    buffer_load_dwordx4 v[132:135], v30, s[40:43], s12 offen nt
    s_add_u32 s12, s71, 14336
    buffer_load_dwordx4 v[136:139], v30, s[40:43], s12 offen nt
    s_add_u32 s12, s71, 21504
    buffer_load_dwordx4 v[140:143], v30, s[40:43], s12 offen nt
    s_add_u32 s12, s71, 28672
    buffer_load_dwordx4 v[144:147], v30, s[40:43], s12 offen nt
    s_add_u32 s12, s71, 35840
    buffer_load_dwordx4 v[148:151], v30, s[40:43], s12 offen nt
    s_add_u32 s12, s71, 43008
    buffer_load_dwordx4 v[152:155], v30, s[40:43], s12 offen nt
    s_add_u32 s12, s71, 50176
    buffer_load_dwordx4 v[156:159], v30, s[40:43], s12 offen nt
    s_branch L_p3e0_2
L_p30_2:
    s_mov_b64 exec, 63
    s_bfe_u32 s12, s68, 0x4000c
    s_mul_i32 s12, s12, 393216
    buffer_load_dword v128, v32, s[28:31], s12 offen
    s_bfe_u32 s12, s68, 0x40010
    s_mul_i32 s12, s12, 393216
    buffer_load_dword v132, v32, s[28:31], s12 offen
    s_bfe_u32 s12, s68, 0x40014
    s_mul_i32 s12, s12, 393216
    buffer_load_dword v136, v32, s[28:31], s12 offen
    s_bfe_u32 s12, s68, 0x40018
    s_mul_i32 s12, s12, 393216
    buffer_load_dword v140, v32, s[28:31], s12 offen
    s_bfe_u32 s12, s68, 0x4001c
    s_mul_i32 s12, s12, 393216
    buffer_load_dword v144, v32, s[28:31], s12 offen
    s_bfe_u32 s12, s69, 0x40000
    s_mul_i32 s12, s12, 393216
    buffer_load_dword v148, v32, s[28:31], s12 offen
    s_bfe_u32 s12, s69, 0x40004
    s_mul_i32 s12, s12, 393216
    buffer_load_dword v152, v32, s[28:31], s12 offen
    s_bfe_u32 s12, s69, 0x40008
    s_mul_i32 s12, s12, 393216
    buffer_load_dword v156, v32, s[28:31], s12 offen
    s_mov_b64 exec, -1
L_p3e0_2:
    buffer_load_dword v15, v13, s[72:75], 0 offen offset:4 sc1
    v_add_f32 v93, v93, v117
    v_add_f32 v91, v91, v114
    v_add_f32 v93, v93, v118
    v_lshlrev_b32 v72, 16, v63
    v_and_b32 v63, s8, v63
    v_lshlrev_b32 v73, 16, v71
    v_and_b32 v71, s8, v71
    v_lshlrev_b32 v112, 16, v47
    v_and_b32 v47, s8, v47
    v_lshlrev_b32 v116, 16, v55
    v_and_b32 v55, s8, v55
    v_mul_f32 v113, v112, v73
    v_mul_f32 v114, v47, v71
    v_fmac_f32 v90, v112, v72
    v_mul_f32 v117, v116, v73
    v_mul_f32 v118, v55, v71
    v_fmac_f32 v92, v116, v72
    v_cvt_pk_bf16_f32 v113, 0, v113
    v_cvt_pk_bf16_f32 v114, 0, v114
    v_fmac_f32 v90, v47, v63
    v_cvt_pk_bf16_f32 v117, 0, v117
    v_cvt_pk_bf16_f32 v118, 0, v118
    v_fmac_f32 v92, v55, v63
    v_add_f32 v91, v91, v113
    v_add_f32 v93, v93, v117
L_bw3_2:
    s_waitcnt vmcnt(19)
    s_barrier
    s_bfe_u32 s91, s68, 0x40014
    s_lshl_b32 s92, s91, 7
    s_mul_i32 s93, s91, 393216
    s_add_u32 m0, s94, 81920
    s_nop 0
    buffer_load_dwordx4 v20, s[24:27], s92 offen offset:0 lds
    v_add_f32 v91, v91, v114
    v_add_f32 v93, v93, v118
    v_add_f32_dpp v90, v90, v90 row_shr:1 row_mask:0xf bank_mask:0xf
    v_add_f32_dpp v91, v91, v91 row_shr:1 row_mask:0xf bank_mask:0xf
    v_add_f32_dpp v92, v92, v92 row_shr:1 row_mask:0xf bank_mask:0xf
    v_add_f32_dpp v93, v93, v93 row_shr:1 row_mask:0xf bank_mask:0xf
    v_add_f32_dpp v90, v90, v90 row_shr:2 row_mask:0xf bank_mask:0xf
    buffer_load_dwordx4 v21, s[24:27], s92 offen offset:1024 lds
    v_add_f32_dpp v91, v91, v91 row_shr:2 row_mask:0xf bank_mask:0xf
    v_add_f32_dpp v92, v92, v92 row_shr:2 row_mask:0xf bank_mask:0xf
    v_add_f32_dpp v93, v93, v93 row_shr:2 row_mask:0xf bank_mask:0xf
    v_add_f32_dpp v90, v90, v90 row_shr:4 row_mask:0xf bank_mask:0xf
    v_add_f32_dpp v91, v91, v91 row_shr:4 row_mask:0xf bank_mask:0xf
    v_add_f32_dpp v92, v92, v92 row_shr:4 row_mask:0xf bank_mask:0xf
    v_add_f32_dpp v93, v93, v93 row_shr:4 row_mask:0xf bank_mask:0xf
    buffer_load_dwordx4 v22, s[24:27], s92 offen offset:2048 lds
    v_add_f32_dpp v90, v90, v90 row_shr:8 row_mask:0xf bank_mask:0xf
    v_add_f32_dpp v91, v91, v91 row_shr:8 row_mask:0xf bank_mask:0xf
    v_add_f32_dpp v92, v92, v92 row_shr:8 row_mask:0xf bank_mask:0xf
    v_add_f32_dpp v93, v93, v93 row_shr:8 row_mask:0xf bank_mask:0xf
    v_add_f32_dpp v90, v90, v90 row_bcast:15 row_mask:0xa bank_mask:0xf
    v_add_f32_dpp v91, v91, v91 row_bcast:15 row_mask:0xa bank_mask:0xf
    v_add_f32_dpp v92, v92, v92 row_bcast:15 row_mask:0xa bank_mask:0xf
    buffer_load_dwordx4 v23, s[24:27], s92 offen offset:3072 lds
    v_add_f32_dpp v93, v93, v93 row_bcast:15 row_mask:0xa bank_mask:0xf
    v_add_f32_dpp v90, v90, v90 row_bcast:31 row_mask:0xc bank_mask:0xf
    v_add_f32_dpp v91, v91, v91 row_bcast:31 row_mask:0xc bank_mask:0xf
    v_add_f32_dpp v92, v92, v92 row_bcast:31 row_mask:0xc bank_mask:0xf
    v_add_f32_dpp v93, v93, v93 row_bcast:31 row_mask:0xc bank_mask:0xf
    v_mov_b32 v97, 0x8000
    v_mov_b32 v98, 0xffff
    s_add_u32 m0, s95, 106496
    s_nop 0
    buffer_load_dwordx4 v24, s[28:31], s93 offen offset:0 lds
    v_cvt_pk_bf16_f32 v94, v90, v91
    v_cvt_pk_bf16_f32 v104, v92, v93
    v_and_b32 v95, 0xffff, v94
    v_and_b32 v96, 0x8000, v94
    v_and_b32 v94, 0xffff0000, v94
    v_cmp_ne_u32 vcc, 0, v96
    v_mul_f32 v94, 0xbfb8aa3b, v94
    v_exp_f32 v94, v94
    v_cndmask_b32 v96, v97, v98, vcc
    v_xor_b32 v95, v95, v96
    v_add_f32 v94, 1.0, v94
    v_lshlrev_b32 v95, 11, v95
    v_rcp_f32 v94, v94
    s_sub_u32 s12, 2047, s22
    v_or_b32 v100, s12, v95
    v_cvt_pk_bf16_f32 v94, v94, v94
    v_lshlrev_b32 v102, 16, v94
    v_and_b32 v105, 0xffff, v104
    v_and_b32 v106, 0x8000, v104
    v_and_b32 v104, 0xffff0000, v104
    v_cmp_ne_u32 vcc, 0, v106
    v_mul_f32 v104, 0xbfb8aa3b, v104
    v_exp_f32 v104, v104
    v_cndmask_b32 v106, v97, v98, vcc
    v_xor_b32 v105, v105, v106
    v_add_f32 v104, 1.0, v104
    v_lshlrev_b32 v105, 11, v105
    v_rcp_f32 v104, v104
    s_sub_u32 s12, 2046, s22
    v_or_b32 v101, s12, v105
    v_cvt_pk_bf16_f32 v104, v104, v104
    v_lshlrev_b32 v103, 16, v104
    v_max_u32 v100, v100, v101
    s_lshl_b32 s12, s22, 2
    s_add_u32 s12, s12, 4096
    s_lshl_b32 s13, s21, 2
    s_add_u32 s13, s13, 162880
    v_mov_b32 v14, s13
    s_mov_b32 exec_lo, 0
    s_mov_b32 exec_hi, 0x80000000
    buffer_store_dwordx2 v[102:103], v13, s[32:35], s12 offen sc1
    ds_write_b32 v14, v100
    s_mov_b64 exec, -1
    s_waitcnt lgkmcnt(0)
L_bw4_2:
    s_waitcnt vmcnt(15)
    s_barrier
    s_add_u32 m0, s95, 106496
    s_nop 0
    buffer_load_dwordx4 v25, s[28:31], s93 offen offset:1024 lds
    s_add_u32 m0, s95, 114688
    s_nop 0
    buffer_load_dwordx4 v26, s[28:31], s93 offen offset:0 lds
    buffer_load_dwordx4 v27, s[28:31], s93 offen offset:1024 lds
    s_add_u32 m0, s95, 98304
    s_nop 0
    buffer_load_dwordx4 v28, s[28:31], s93 offen offset:0 lds
    buffer_load_dwordx4 v29, s[28:31], s93 offen offset:1024 lds
    s_bfe_u32 s91, s68, 0x40018
    s_lshl_b32 s92, s91, 7
    s_mul_i32 s93, s91, 393216
    s_add_u32 m0, s94, 0
    s_nop 0
    buffer_load_dwordx4 v20, s[24:27], s92 offen offset:0 lds
    buffer_load_dwordx4 v21, s[24:27], s92 offen offset:1024 lds
    buffer_load_dwordx4 v22, s[24:27], s92 offen offset:2048 lds
    buffer_load_dwordx4 v23, s[24:27], s92 offen offset:3072 lds
    s_add_u32 m0, s95, 24576
    s_nop 0
    buffer_load_dwordx4 v24, s[28:31], s93 offen offset:0 lds
    buffer_load_dwordx4 v25, s[28:31], s93 offen offset:1024 lds
    s_add_u32 m0, s95, 32768
    s_nop 0
    buffer_load_dwordx4 v26, s[28:31], s93 offen offset:0 lds
    s_waitcnt vmcnt(12)
L_bw5_2:
    s_waitcnt vmcnt(7)
    s_barrier
    s_add_u32 m0, s95, 32768
    s_nop 0
    buffer_load_dwordx4 v27, s[28:31], s93 offen offset:1024 lds
    s_add_u32 m0, s95, 16384
    s_nop 0
    buffer_load_dwordx4 v28, s[28:31], s93 offen offset:0 lds
    buffer_load_dwordx4 v29, s[28:31], s93 offen offset:1024 lds
    s_bfe_u32 s91, s68, 0x4001c
    s_lshl_b32 s92, s91, 7
    s_mul_i32 s93, s91, 393216
    s_add_u32 m0, s94, 40960
    s_nop 0
    buffer_load_dwordx4 v20, s[24:27], s92 offen offset:0 lds
    buffer_load_dwordx4 v21, s[24:27], s92 offen offset:1024 lds
    buffer_load_dwordx4 v22, s[24:27], s92 offen offset:2048 lds
    buffer_load_dwordx4 v23, s[24:27], s92 offen offset:3072 lds
    s_add_u32 m0, s95, 65536
    s_nop 0
    buffer_load_dwordx4 v24, s[28:31], s93 offen offset:0 lds
    buffer_load_dwordx4 v25, s[28:31], s93 offen offset:1024 lds
    s_add_u32 m0, s95, 73728
    s_nop 0
    buffer_load_dwordx4 v26, s[28:31], s93 offen offset:0 lds
    buffer_load_dwordx4 v27, s[28:31], s93 offen offset:1024 lds
    s_add_u32 m0, s95, 57344
    s_nop 0
    buffer_load_dwordx4 v28, s[28:31], s93 offen offset:0 lds
    s_mov_b32 s13, 0
L_tagchk_2:
    v_readfirstlane_b32 s23, v15
    s_nop 1
    s_cmp_lg_u32 s23, 0
    s_cbranch_scc1 L_tagok_2
    s_add_u32 s13, s13, 1
    s_cmp_ge_u32 s13, 16384
    s_cbranch_scc1 L_tagok_2
    buffer_load_dword v15, v13, s[72:75], 0 offen offset:4 sc1
    s_waitcnt vmcnt(0)
    s_branch L_tagchk_2
L_tagok_2:
    s_and_b32 s76, s23, 0xff
    s_bfe_u32 s77, s23, 0x80008
    s_bfe_u32 s78, s23, 0x80010
    s_lshr_b32 s79, s23, 24
    v_and_b32 v35, 3, v2
    v_lshlrev_b32 v35, 3, v35
    v_bfe_u32 v35, s23, v35, 8
    s_cmp_lg_u32 s21, 0
    s_cbranch_scc1 L_nopub_2
    v_mov_b32 v14, 162880
    ds_read_b128 v[104:107], v14
    s_lshl_b32 s12, s2, 3
    s_add_u32 s12, s12, 0
    s_waitcnt lgkmcnt(0)
    v_max3_u32 v104, v104, v105, v106
    v_max_u32 v104, v104, v107
    v_mov_b32 v105, s23
    s_mov_b64 exec, 1
    buffer_store_dwordx2 v[104:105], v13, s[32:35], s12 offen sc1
    s_mov_b64 exec, -1
L_nopub_2:
L_bw6_2:
    s_waitcnt vmcnt(9)
    s_barrier
    s_add_u32 m0, s95, 57344
    s_nop 0
    buffer_load_dwordx4 v29, s[28:31], s93 offen offset:1024 lds
    s_bfe_u32 s91, s69, 0x40000
    s_lshl_b32 s92, s91, 7
    s_mul_i32 s93, s91, 393216
    s_add_u32 m0, s94, 81920
    s_nop 0
    buffer_load_dwordx4 v20, s[24:27], s92 offen offset:0 lds
    buffer_load_dwordx4 v21, s[24:27], s92 offen offset:1024 lds
    buffer_load_dwordx4 v22, s[24:27], s92 offen offset:2048 lds
    buffer_load_dwordx4 v23, s[24:27], s92 offen offset:3072 lds
    s_add_u32 m0, s95, 106496
    s_nop 0
    buffer_load_dwordx4 v24, s[28:31], s93 offen offset:0 lds
    buffer_load_dwordx4 v25, s[28:31], s93 offen offset:1024 lds
    s_add_u32 m0, s95, 114688
    s_nop 0
    buffer_load_dwordx4 v26, s[28:31], s93 offen offset:0 lds
    buffer_load_dwordx4 v27, s[28:31], s93 offen offset:1024 lds
    s_add_u32 m0, s95, 98304
    s_nop 0
    buffer_load_dwordx4 v28, s[28:31], s93 offen offset:0 lds
    buffer_load_dwordx4 v29, s[28:31], s93 offen offset:1024 lds
L_bw7_2:
    s_waitcnt vmcnt(10)
    s_barrier
    s_bfe_u32 s91, s69, 0x40004
    s_lshl_b32 s92, s91, 7
    s_mul_i32 s93, s91, 393216
    s_add_u32 m0, s94, 0
    s_nop 0
    buffer_load_dwordx4 v20, s[24:27], s92 offen offset:0 lds
    buffer_load_dwordx4 v21, s[24:27], s92 offen offset:1024 lds
    buffer_load_dwordx4 v22, s[24:27], s92 offen offset:2048 lds
    buffer_load_dwordx4 v23, s[24:27], s92 offen offset:3072 lds
    s_add_u32 m0, s95, 24576
    s_nop 0
    buffer_load_dwordx4 v24, s[28:31], s93 offen offset:0 lds
    buffer_load_dwordx4 v25, s[28:31], s93 offen offset:1024 lds
    s_add_u32 m0, s95, 32768
    s_nop 0
    buffer_load_dwordx4 v26, s[28:31], s93 offen offset:0 lds
    buffer_load_dwordx4 v27, s[28:31], s93 offen offset:1024 lds
    s_add_u32 m0, s95, 16384
    s_nop 0
    buffer_load_dwordx4 v28, s[28:31], s93 offen offset:0 lds
    buffer_load_dwordx4 v29, s[28:31], s93 offen offset:1024 lds
    s_cmp_ge_u32 s10, 224
    s_cbranch_scc1 L_p31_2
    s_add_u32 s12, s9, 0
    buffer_load_dwordx4 v[160:163], v30, s[44:47], s12 offen nt
    s_add_u32 s12, s9, 7168
    buffer_load_dwordx4 v[164:167], v30, s[44:47], s12 offen nt
    s_add_u32 s12, s9, 14336
    buffer_load_dwordx4 v[168:171], v30, s[44:47], s12 offen nt
    s_add_u32 s12, s9, 21504
    buffer_load_dwordx4 v[172:175], v30, s[44:47], s12 offen nt
    s_add_u32 s12, s9, 28672
    buffer_load_dwordx4 v[176:179], v30, s[44:47], s12 offen nt
    s_add_u32 s12, s9, 35840
    buffer_load_dwordx4 v[180:183], v30, s[44:47], s12 offen nt
    s_add_u32 s12, s9, 43008
    buffer_load_dwordx4 v[184:187], v30, s[44:47], s12 offen nt
    s_add_u32 s12, s9, 50176
    buffer_load_dwordx4 v[188:191], v30, s[44:47], s12 offen nt
    s_branch L_p3e1_2
L_p31_2:
    s_mov_b64 exec, 63
    s_bfe_u32 s12, s69, 0x4000c
    s_mul_i32 s12, s12, 393216
    buffer_load_dword v160, v32, s[28:31], s12 offen
    s_bfe_u32 s12, s69, 0x40010
    s_mul_i32 s12, s12, 393216
    buffer_load_dword v164, v32, s[28:31], s12 offen
    s_bfe_u32 s12, s69, 0x40014
    s_mul_i32 s12, s12, 393216
    buffer_load_dword v168, v32, s[28:31], s12 offen
    s_bfe_u32 s12, s69, 0x40018
    s_mul_i32 s12, s12, 393216
    buffer_load_dword v172, v32, s[28:31], s12 offen
    s_bfe_u32 s12, s69, 0x4001c
    s_mul_i32 s12, s12, 393216
    buffer_load_dword v176, v32, s[28:31], s12 offen
    s_mov_b64 exec, 1
    s_bfe_u32 s12, s69, 0x4001c
    s_mul_i32 s12, s12, 393216
    buffer_load_dword v180, v32, s[28:31], s12 offen
    s_bfe_u32 s12, s69, 0x4001c
    s_mul_i32 s12, s12, 393216
    buffer_load_dword v184, v32, s[28:31], s12 offen
    s_bfe_u32 s12, s69, 0x4001c
    s_mul_i32 s12, s12, 393216
    buffer_load_dword v188, v32, s[28:31], s12 offen
    s_mov_b64 exec, -1
L_p3e1_2:
    s_mov_b32 exec_lo, 0xffff0000
    s_mov_b32 exec_hi, 0
    buffer_load_dword v19, v10, s[36:39], 0 offen
    s_mov_b64 exec, -1
L_bw8_2:
    s_waitcnt vmcnt(19)
    s_barrier
    s_bfe_u32 s91, s69, 0x40008
    s_lshl_b32 s92, s91, 7
    s_mul_i32 s93, s91, 393216
    s_add_u32 m0, s94, 40960
    s_nop 0
    buffer_load_dwordx4 v20, s[24:27], s92 offen offset:0 lds
    buffer_load_dwordx4 v21, s[24:27], s92 offen offset:1024 lds
    buffer_load_dwordx4 v22, s[24:27], s92 offen offset:2048 lds
    buffer_load_dwordx4 v23, s[24:27], s92 offen offset:3072 lds
    s_add_u32 m0, s95, 65536
    s_nop 0
    buffer_load_dwordx4 v24, s[28:31], s93 offen offset:0 lds
L_bw9_2:
    s_waitcnt vmcnt(14)
    s_barrier
    s_add_u32 m0, s95, 65536
    s_nop 0
    buffer_load_dwordx4 v25, s[28:31], s93 offen offset:1024 lds
    s_add_u32 m0, s95, 73728
    s_nop 0
    buffer_load_dwordx4 v26, s[28:31], s93 offen offset:0 lds
    buffer_load_dwordx4 v27, s[28:31], s93 offen offset:1024 lds
    s_add_u32 m0, s95, 57344
    s_nop 0
    buffer_load_dwordx4 v28, s[28:31], s93 offen offset:0 lds
    buffer_load_dwordx4 v29, s[28:31], s93 offen offset:1024 lds
    s_bfe_u32 s91, s69, 0x4000c
    s_lshl_b32 s92, s91, 7
    s_mul_i32 s93, s91, 393216
    s_add_u32 m0, s94, 122880
    s_nop 0
    buffer_load_dwordx4 v20, s[24:27], s92 offen offset:0 lds
    buffer_load_dwordx4 v21, s[24:27], s92 offen offset:1024 lds
    buffer_load_dwordx4 v22, s[24:27], s92 offen offset:2048 lds
    buffer_load_dwordx4 v23, s[24:27], s92 offen offset:3072 lds
    s_add_u32 m0, s95, 106496
    s_nop 0
    buffer_load_dwordx4 v24, s[28:31], s93 offen offset:0 lds
    buffer_load_dwordx4 v25, s[28:31], s93 offen offset:1024 lds
    s_add_u32 m0, s95, 114688
    s_nop 0
    buffer_load_dwordx4 v26, s[28:31], s93 offen offset:0 lds
    s_mov_b32 s12, 0
    buffer_load_dwordx4 v[104:107], v5, s[32:35], s12 offen offset:0 sc1
    buffer_load_dwordx4 v[108:111], v5, s[32:35], s12 offen offset:1024 sc1
L_bw10_2:
    s_waitcnt vmcnt(9)
    s_barrier
    s_add_u32 m0, s95, 114688
    s_nop 0
    buffer_load_dwordx4 v27, s[28:31], s93 offen offset:1024 lds
    s_bfe_u32 s91, s69, 0x40010
    s_lshl_b32 s92, s91, 7
    s_mul_i32 s93, s91, 393216
    s_add_u32 m0, s94, 139264
    s_nop 0
    buffer_load_dwordx4 v20, s[24:27], s92 offen offset:0 lds
    buffer_load_dwordx4 v21, s[24:27], s92 offen offset:1024 lds
    buffer_load_dwordx4 v22, s[24:27], s92 offen offset:2048 lds
    buffer_load_dwordx4 v23, s[24:27], s92 offen offset:3072 lds
    s_add_u32 m0, s95, 24576
    s_nop 0
    buffer_load_dwordx4 v24, s[28:31], s93 offen offset:0 lds
    buffer_load_dwordx4 v25, s[28:31], s93 offen offset:1024 lds
    s_add_u32 m0, s95, 32768
    s_nop 0
    buffer_load_dwordx4 v26, s[28:31], s93 offen offset:0 lds
    buffer_load_dwordx4 v27, s[28:31], s93 offen offset:1024 lds
L_bw11_2:
    s_waitcnt vmcnt(8)
    s_barrier
    s_bfe_u32 s91, s69, 0x40014
    s_lshl_b32 s92, s91, 7
    s_mul_i32 s93, s91, 393216
    s_add_u32 m0, s94, 40960
    s_nop 0
    buffer_load_dwordx4 v20, s[24:27], s92 offen offset:0 lds
    s_mov_b32 s13, 0
    v_xor_b32 v105, s23, v105
    v_xor_b32 v107, s23, v107
    v_xor_b32 v109, s23, v109
    v_xor_b32 v111, s23, v111
    v_or3_b32 v105, v105, v107, v109
    v_or_b32 v105, v105, v111
    v_cmp_ne_u32 vcc, 0, v105
    s_cbranch_vccnz L_keyre_2
L_keyok_2:
    buffer_load_dwordx4 v21, s[24:27], s92 offen offset:1024 lds
    v_max3_u32 v104, v104, v106, v108
    v_max_u32 v104, v104, v110
    s_nop 1
    v_max_u32_dpp v104, v104, v104 row_shr:1 row_mask:0xf bank_mask:0xf
    s_nop 1
    v_max_u32_dpp v104, v104, v104 row_shr:2 row_mask:0xf bank_mask:0xf
    s_nop 1
    v_max_u32_dpp v104, v104, v104 row_shr:4 row_mask:0xf bank_mask:0xf
    s_nop 1
    v_max_u32_dpp v104, v104, v104 row_shr:8 row_mask:0xf bank_mask:0xf
    s_nop 1
    v_max_u32_dpp v104, v104, v104 row_bcast:15 row_mask:0xa bank_mask:0xf
    buffer_load_dwordx4 v22, s[24:27], s92 offen offset:2048 lds
    s_nop 0
    v_max_u32_dpp v104, v104, v104 row_bcast:31 row_mask:0xc bank_mask:0xf
    s_nop 0
    v_readlane_b32 s14, v104, 63
    s_nop 1
    s_and_b32 s15, s14, 2047
    s_sub_u32 s15, 2047, s15
    s_lshl_b32 s12, s15, 11
    s_lshl_b32 s13, s70, 1
    s_add_u32 s12, s12, s13
    buffer_load_dwordx4 v[36:39], v34, s[24:27], s12 offen
    s_lshr_b32 s12, s14, 11
    s_and_b32 s13, s12, 0x8000
    s_cmp_lg_u32 s13, 0
    s_mov_b32 s13, 0xffff
    s_cselect_b32 s13, 0x8000, s13
    s_xor_b32 s12, s12, s13
    s_lshl_b32 s12, s12, 16
    v_mov_b32 v105, s12
    buffer_load_dwordx4 v23, s[24:27], s92 offen offset:3072 lds
    v_mul_f32 v105, 0xbfb8aa3b, v105
    v_exp_f32 v105, v105
    s_nop 0
    v_add_f32 v105, 1.0, v105
    v_rcp_f32 v105, v105
    s_nop 0
    v_cvt_pk_bf16_f32 v105, v105, v105
    v_lshlrev_b32 v105, 16, v105
    s_add_u32 s12, s15, 1
    v_mov_b32 v104, s12
    s_add_u32 m0, s95, 65536
    s_nop 0
    buffer_load_dwordx4 v24, s[28:31], s93 offen offset:0 lds
    v_mov_b32 v106, s23
    v_readfirstlane_b32 s14, v105
    v_mov_b32 v14, 162864
    s_mov_b64 exec, 1
    ds_write_b96 v14, v[104:106]
    s_mov_b64 exec, -1
    s_waitcnt lgkmcnt(0)
    buffer_load_dwordx4 v25, s[28:31], s93 offen offset:1024 lds
    s_add_u32 m0, s95, 73728
    s_nop 0
    buffer_load_dwordx4 v26, s[28:31], s93 offen offset:0 lds
    buffer_load_dwordx4 v27, s[28:31], s93 offen offset:1024 lds
L_bw12_2:
    s_waitcnt vmcnt(9)
    s_barrier
    s_bfe_u32 s91, s69, 0x40018
    s_lshl_b32 s92, s91, 7
    s_mul_i32 s93, s91, 393216
    s_add_u32 m0, s94, 81920
    s_nop 0
    buffer_load_dwordx4 v20, s[24:27], s92 offen offset:0 lds
    s_waitcnt vmcnt(6)
    s_mov_b32 s8, 0xffff0000
    v_lshlrev_b32 v40, 16, v36
    v_and_b32 v41, s8, v36
    v_lshlrev_b32 v42, 16, v37
    v_and_b32 v43, s8, v37
    v_lshlrev_b32 v44, 16, v38
    buffer_load_dwordx4 v21, s[24:27], s92 offen offset:1024 lds
    v_and_b32 v45, s8, v38
    v_lshlrev_b32 v46, 16, v39
    v_and_b32 v47, s8, v39
    v_lshlrev_b32 v48, 16, v128
    v_lshlrev_b32 v49, 16, v129
    v_and_b32 v128, s8, v128
    v_and_b32 v129, s8, v129
    buffer_load_dwordx4 v22, s[24:27], s92 offen offset:2048 lds
    v_mul_f32 v220, v48, v40
    v_mul_f32 v222, v49, v40
    v_mul_f32 v221, v128, v40
    v_mul_f32 v223, v129, v40
    v_lshlrev_b32 v50, 16, v130
    v_lshlrev_b32 v51, 16, v131
    v_and_b32 v130, s8, v130
    buffer_load_dwordx4 v23, s[24:27], s92 offen offset:3072 lds
    v_and_b32 v131, s8, v131
    v_mul_f32 v224, v50, v40
    v_mul_f32 v226, v51, v40
    v_mul_f32 v225, v130, v40
    v_mul_f32 v227, v131, v40
    v_lshlrev_b32 v48, 16, v160
    v_lshlrev_b32 v49, 16, v161
    s_add_u32 m0, s95, 106496
    s_nop 0
    buffer_load_dwordx4 v24, s[28:31], s93 offen offset:0 lds
    v_and_b32 v160, s8, v160
    v_and_b32 v161, s8, v161
    v_mul_f32 v228, v48, v40
    v_mul_f32 v230, v49, v40
    v_mul_f32 v229, v160, v40
    v_mul_f32 v231, v161, v40
    v_lshlrev_b32 v50, 16, v162
    buffer_load_dwordx4 v25, s[28:31], s93 offen offset:1024 lds
    v_lshlrev_b32 v51, 16, v163
    v_and_b32 v162, s8, v162
    v_and_b32 v163, s8, v163
    v_mul_f32 v232, v50, v40
    v_mul_f32 v234, v51, v40
    v_mul_f32 v233, v162, v40
    v_mul_f32 v235, v163, v40
    s_add_u32 m0, s95, 114688
    s_nop 0
    buffer_load_dwordx4 v26, s[28:31], s93 offen offset:0 lds
    v_lshlrev_b32 v48, 16, v132
    v_lshlrev_b32 v49, 16, v133
    v_and_b32 v132, s8, v132
    v_and_b32 v133, s8, v133
    v_fmac_f32 v220, v48, v41
    v_fmac_f32 v222, v49, v41
    v_fmac_f32 v221, v132, v41
    v_fmac_f32 v223, v133, v41
    v_lshlrev_b32 v50, 16, v134
    v_lshlrev_b32 v51, 16, v135
    v_and_b32 v134, s8, v134
    v_and_b32 v135, s8, v135
    v_fmac_f32 v224, v50, v41
    v_fmac_f32 v226, v51, v41
    buffer_load_dwordx4 v27, s[28:31], s93 offen offset:1024 lds
    v_fmac_f32 v225, v134, v41
    v_fmac_f32 v227, v135, v41
    v_lshlrev_b32 v48, 16, v164
    v_lshlrev_b32 v49, 16, v165
    v_and_b32 v164, s8, v164
    v_and_b32 v165, s8, v165
    v_fmac_f32 v228, v48, v41
    v_fmac_f32 v230, v49, v41
    v_fmac_f32 v229, v164, v41
    v_fmac_f32 v231, v165, v41
    v_lshlrev_b32 v50, 16, v166
    v_lshlrev_b32 v51, 16, v167
    v_and_b32 v166, s8, v166
    v_and_b32 v167, s8, v167
    s_add_u32 s12, s97, 0
    buffer_load_dwordx4 v[192:195], v31, s[64:67], s12 offen nt
    s_add_u32 s12, s97, 16384
    buffer_load_dwordx4 v[196:199], v31, s[64:67], s12 offen nt
    s_add_u32 s12, s97, 32768
    buffer_load_dwordx4 v[200:203], v31, s[64:67], s12 offen nt
    s_add_u32 s12, s97, 49152
    buffer_load_dwordx4 v[204:207], v31, s[64:67], s12 offen nt
    s_add_u32 s12, s97, 65536
    buffer_load_dwordx4 v[208:211], v31, s[64:67], s12 offen nt
    s_add_u32 s12, s97, 81920
    buffer_load_dwordx4 v[212:215], v31, s[64:67], s12 offen nt
    s_add_u32 s12, s97, 98304
    buffer_load_dwordx4 v[216:219], v31, s[64:67], s12 offen nt
    v_fmac_f32 v232, v50, v41
    v_fmac_f32 v234, v51, v41
    v_fmac_f32 v233, v166, v41
    v_fmac_f32 v235, v167, v41
    v_lshlrev_b32 v48, 16, v136
    v_lshlrev_b32 v49, 16, v137
    v_and_b32 v136, s8, v136
    v_and_b32 v137, s8, v137
    v_fmac_f32 v220, v48, v42
    v_fmac_f32 v222, v49, v42
    v_fmac_f32 v221, v136, v42
    v_fmac_f32 v223, v137, v42
    v_lshlrev_b32 v50, 16, v138
    v_lshlrev_b32 v51, 16, v139
    v_and_b32 v138, s8, v138
    v_and_b32 v139, s8, v139
    v_fmac_f32 v224, v50, v42
    v_fmac_f32 v226, v51, v42
    v_fmac_f32 v225, v138, v42
    v_fmac_f32 v227, v139, v42
    v_lshlrev_b32 v48, 16, v168
    v_lshlrev_b32 v49, 16, v169
    v_and_b32 v168, s8, v168
    v_and_b32 v169, s8, v169
    v_fmac_f32 v228, v48, v42
L_bw13_2:
    s_waitcnt vmcnt(15)
    s_barrier
    s_bfe_u32 s91, s69, 0x4001c
    s_lshl_b32 s92, s91, 7
    s_mul_i32 s93, s91, 393216
    s_add_u32 m0, s94, 0
    s_nop 0
    buffer_load_dwordx4 v20, s[24:27], s92 offen offset:0 lds
    v_fmac_f32 v230, v49, v42
    v_fmac_f32 v229, v168, v42
    v_fmac_f32 v231, v169, v42
    v_lshlrev_b32 v50, 16, v170
    v_lshlrev_b32 v51, 16, v171
    v_and_b32 v170, s8, v170
    v_and_b32 v171, s8, v171
    buffer_load_dwordx4 v21, s[24:27], s92 offen offset:1024 lds
    v_fmac_f32 v232, v50, v42
    v_fmac_f32 v234, v51, v42
    v_fmac_f32 v233, v170, v42
    v_fmac_f32 v235, v171, v42
    v_lshlrev_b32 v48, 16, v140
    v_lshlrev_b32 v49, 16, v141
    v_and_b32 v140, s8, v140
    buffer_load_dwordx4 v22, s[24:27], s92 offen offset:2048 lds
    v_and_b32 v141, s8, v141
    v_fmac_f32 v220, v48, v43
    v_fmac_f32 v222, v49, v43
    v_fmac_f32 v221, v140, v43
    v_fmac_f32 v223, v141, v43
    v_lshlrev_b32 v50, 16, v142
    v_lshlrev_b32 v51, 16, v143
    buffer_load_dwordx4 v23, s[24:27], s92 offen offset:3072 lds
    v_and_b32 v142, s8, v142
    v_and_b32 v143, s8, v143
    v_fmac_f32 v224, v50, v43
    v_fmac_f32 v226, v51, v43
    v_fmac_f32 v225, v142, v43
    v_fmac_f32 v227, v143, v43
    v_lshlrev_b32 v48, 16, v172
    s_add_u32 m0, s95, 24576
    s_nop 0
    buffer_load_dwordx4 v24, s[28:31], s93 offen offset:0 lds
    v_lshlrev_b32 v49, 16, v173
    v_and_b32 v172, s8, v172
    v_and_b32 v173, s8, v173
    v_fmac_f32 v228, v48, v43
    v_fmac_f32 v230, v49, v43
    v_fmac_f32 v229, v172, v43
    v_fmac_f32 v231, v173, v43
    v_lshlrev_b32 v50, 16, v174
    v_lshlrev_b32 v51, 16, v175
    v_and_b32 v174, s8, v174
    v_and_b32 v175, s8, v175
    v_fmac_f32 v232, v50, v43
    v_fmac_f32 v234, v51, v43
    v_fmac_f32 v233, v174, v43
    v_fmac_f32 v235, v175, v43
    v_lshlrev_b32 v48, 16, v144
    v_lshlrev_b32 v49, 16, v145
    v_and_b32 v144, s8, v144
    v_and_b32 v145, s8, v145
    v_fmac_f32 v220, v48, v44
    v_fmac_f32 v222, v49, v44
    v_fmac_f32 v221, v144, v44
    v_fmac_f32 v223, v145, v44
    v_lshlrev_b32 v50, 16, v146
    v_lshlrev_b32 v51, 16, v147
    v_and_b32 v146, s8, v146
    v_and_b32 v147, s8, v147
    v_fmac_f32 v224, v50, v44
    v_fmac_f32 v226, v51, v44
    v_fmac_f32 v225, v146, v44
    v_fmac_f32 v227, v147, v44
    v_lshlrev_b32 v48, 16, v176
L_bw14_2:
    s_waitcnt vmcnt(12)
    s_barrier
    s_add_u32 m0, s95, 24576
    s_nop 0
    buffer_load_dwordx4 v25, s[28:31], s93 offen offset:1024 lds
    v_lshlrev_b32 v49, 16, v177
    v_and_b32 v176, s8, v176
    v_and_b32 v177, s8, v177
    v_fmac_f32 v228, v48, v44
    v_fmac_f32 v230, v49, v44
    v_fmac_f32 v229, v176, v44
    v_fmac_f32 v231, v177, v44
    s_add_u32 m0, s95, 32768
    s_nop 0
    buffer_load_dwordx4 v26, s[28:31], s93 offen offset:0 lds
    v_lshlrev_b32 v50, 16, v178
    v_lshlrev_b32 v51, 16, v179
    v_and_b32 v178, s8, v178
    v_and_b32 v179, s8, v179
    v_fmac_f32 v232, v50, v44
    v_fmac_f32 v234, v51, v44
    v_fmac_f32 v233, v178, v44
    v_fmac_f32 v235, v179, v44
    v_lshlrev_b32 v48, 16, v148
    v_lshlrev_b32 v49, 16, v149
    v_and_b32 v148, s8, v148
    v_and_b32 v149, s8, v149
    v_fmac_f32 v220, v48, v45
    v_fmac_f32 v222, v49, v45
    buffer_load_dwordx4 v27, s[28:31], s93 offen offset:1024 lds
    v_fmac_f32 v221, v148, v45
    v_fmac_f32 v223, v149, v45
    v_lshlrev_b32 v50, 16, v150
    v_lshlrev_b32 v51, 16, v151
    v_and_b32 v150, s8, v150
    v_and_b32 v151, s8, v151
    v_fmac_f32 v224, v50, v45
    v_fmac_f32 v226, v51, v45
    v_fmac_f32 v225, v150, v45
    v_fmac_f32 v227, v151, v45
    v_lshlrev_b32 v48, 16, v180
    v_lshlrev_b32 v49, 16, v181
    v_and_b32 v180, s8, v180
    v_and_b32 v181, s8, v181
    s_bfe_u32 s12, s69, 0x4000c
    s_mul_i32 s12, s12, 393216
    s_add_u32 m0, s95, 16384
    s_nop 0
    buffer_load_dwordx4 v28, s[28:31], s12 offen offset:0 lds
    buffer_load_dwordx4 v29, s[28:31], s12 offen offset:1024 lds
    s_bfe_u32 s12, s69, 0x40010
    s_mul_i32 s12, s12, 393216
    s_add_u32 m0, s95, 57344
    s_nop 0
    buffer_load_dwordx4 v28, s[28:31], s12 offen offset:0 lds
    buffer_load_dwordx4 v29, s[28:31], s12 offen offset:1024 lds
    s_mul_i32 s12, s21, 16
    s_add_u32 s12, s12, 0
    s_and_b32 s90, s88, 1
    s_lshl_b32 s90, s90, 6
    s_xor_b32 s12, s12, s90
    s_lshl_b32 s12, s12, 14
    s_add_u32 s90, s12, 0
    buffer_load_dwordx4 v[84:87], v33, s[36:39], s90 offen
    s_add_u32 s90, s12, 16384
    buffer_load_dwordx4 v[88:91], v33, s[36:39], s90 offen
    s_add_u32 s90, s12, 32768
    buffer_load_dwordx4 v[92:95], v33, s[36:39], s90 offen
    s_add_u32 s90, s12, 49152
    buffer_load_dwordx4 v[96:99], v33, s[36:39], s90 offen
    s_add_u32 s90, s12, 65536
    buffer_load_dwordx4 v[100:103], v33, s[36:39], s90 offen
    s_add_u32 s90, s12, 81920
    buffer_load_dwordx4 v[116:119], v33, s[36:39], s90 offen
    s_add_u32 s90, s12, 98304
    buffer_load_dwordx4 v[120:123], v33, s[36:39], s90 offen
    s_add_u32 s90, s12, 114688
    buffer_load_dwordx4 v[124:127], v33, s[36:39], s90 offen
    s_add_u32 s90, s12, 131072
    buffer_load_dwordx4 v[64:67], v33, s[36:39], s90 offen
    v_fmac_f32 v228, v48, v45
    v_fmac_f32 v230, v49, v45
    v_fmac_f32 v229, v180, v45
    v_fmac_f32 v231, v181, v45
    v_lshlrev_b32 v50, 16, v182
    v_lshlrev_b32 v51, 16, v183
    v_and_b32 v182, s8, v182
    v_and_b32 v183, s8, v183
    v_fmac_f32 v232, v50, v45
    v_fmac_f32 v234, v51, v45
    v_fmac_f32 v233, v182, v45
    v_fmac_f32 v235, v183, v45
    v_lshlrev_b32 v48, 16, v152
    v_lshlrev_b32 v49, 16, v153
    v_and_b32 v152, s8, v152
    v_and_b32 v153, s8, v153
    v_fmac_f32 v220, v48, v46
    v_fmac_f32 v222, v49, v46
    v_fmac_f32 v221, v152, v46
    v_fmac_f32 v223, v153, v46
    v_lshlrev_b32 v50, 16, v154
    v_lshlrev_b32 v51, 16, v155
    v_and_b32 v154, s8, v154
    v_and_b32 v155, s8, v155
    v_fmac_f32 v224, v50, v46
L_bw15_2:
    s_waitcnt vmcnt(13)
    s_barrier
    v_fmac_f32 v226, v51, v46
    v_fmac_f32 v225, v154, v46
    v_fmac_f32 v227, v155, v46
    v_lshlrev_b32 v48, 16, v184
    v_lshlrev_b32 v49, 16, v185
    v_and_b32 v184, s8, v184
    v_and_b32 v185, s8, v185
    v_fmac_f32 v228, v48, v46
    v_fmac_f32 v230, v49, v46
    v_fmac_f32 v229, v184, v46
    v_fmac_f32 v231, v185, v46
    v_lshlrev_b32 v50, 16, v186
    v_lshlrev_b32 v51, 16, v187
    v_and_b32 v186, s8, v186
    v_and_b32 v187, s8, v187
    v_fmac_f32 v232, v50, v46
    v_fmac_f32 v234, v51, v46
    v_fmac_f32 v233, v186, v46
    v_fmac_f32 v235, v187, v46
    v_lshlrev_b32 v48, 16, v156
    v_lshlrev_b32 v49, 16, v157
    v_and_b32 v156, s8, v156
    v_and_b32 v157, s8, v157
    v_fmac_f32 v220, v48, v47
    v_fmac_f32 v222, v49, v47
    v_fmac_f32 v221, v156, v47
    v_fmac_f32 v223, v157, v47
    v_lshlrev_b32 v50, 16, v158
    v_lshlrev_b32 v51, 16, v159
    v_and_b32 v158, s8, v158
    v_and_b32 v159, s8, v159
    v_fmac_f32 v224, v50, v47
    v_fmac_f32 v226, v51, v47
    v_fmac_f32 v225, v158, v47
    v_fmac_f32 v227, v159, v47
    v_lshlrev_b32 v48, 16, v188
    v_lshlrev_b32 v49, 16, v189
    v_and_b32 v188, s8, v188
    v_and_b32 v189, s8, v189
    v_fmac_f32 v228, v48, v47
    v_fmac_f32 v230, v49, v47
    v_fmac_f32 v229, v188, v47
    v_fmac_f32 v231, v189, v47
    v_lshlrev_b32 v50, 16, v190
    v_lshlrev_b32 v51, 16, v191
    v_and_b32 v190, s8, v190
    v_and_b32 v191, s8, v191
    v_fmac_f32 v232, v50, v47
    v_fmac_f32 v234, v51, v47
    v_fmac_f32 v233, v190, v47
    v_fmac_f32 v235, v191, v47
    v_permlane32_swap_b32 v220, v228
    v_permlane32_swap_b32 v221, v229
    v_permlane32_swap_b32 v222, v230
    v_permlane32_swap_b32 v223, v231
    v_permlane32_swap_b32 v224, v232
    v_permlane32_swap_b32 v225, v233
    v_permlane32_swap_b32 v226, v234
    v_permlane32_swap_b32 v227, v235
    v_add_f32 v220, v220, v228
    v_add_f32 v221, v221, v229
    v_add_f32 v222, v222, v230
    v_add_f32 v223, v223, v231
    v_add_f32 v224, v224, v232
    v_add_f32 v225, v225, v233
    v_add_f32 v226, v226, v234
    v_add_f32 v227, v227, v235
    v_permlane16_swap_b32 v220, v224
    v_permlane16_swap_b32 v221, v225
    v_permlane16_swap_b32 v222, v226
    v_permlane16_swap_b32 v223, v227
    v_add_f32 v220, v220, v224
    v_add_f32 v221, v221, v225
    v_add_f32 v222, v222, v226
    v_add_f32 v223, v223, v227
    v_add_f32_dpp v220, v220, v220 row_ror:8 row_mask:0xf bank_mask:0xf
    v_add_f32_dpp v221, v221, v221 row_ror:8 row_mask:0xf bank_mask:0xf
    v_add_f32_dpp v222, v222, v222 row_ror:8 row_mask:0xf bank_mask:0xf
    v_add_f32_dpp v223, v223, v223 row_ror:8 row_mask:0xf bank_mask:0xf
    s_branch L_varend
.fill 433, 4, 0xbf800000
L_var3:
    s_nop 0
    s_waitcnt vmcnt(6)
    s_barrier
    s_add_u32 m0, s95, 73728
    s_nop 0
    buffer_load_dwordx4 v26, s[28:31], s93 offen offset:0 lds
    buffer_load_dwordx4 v27, s[28:31], s93 offen offset:1024 lds
    s_add_u32 m0, s95, 57344
    s_nop 0
    buffer_load_dwordx4 v28, s[28:31], s93 offen offset:0 lds
    buffer_load_dwordx4 v29, s[28:31], s93 offen offset:1024 lds
    s_bfe_u32 s91, s68, 0x40008
    s_lshl_b32 s92, s91, 7
    s_mul_i32 s93, s91, 393216
    s_add_u32 m0, s94, 81920
    s_nop 0
    buffer_load_dwordx4 v20, s[24:27], s92 offen offset:0 lds
    buffer_load_dwordx4 v21, s[24:27], s92 offen offset:1024 lds
    buffer_load_dwordx4 v22, s[24:27], s92 offen offset:2048 lds
    buffer_load_dwordx4 v23, s[24:27], s92 offen offset:3072 lds
    s_add_u32 m0, s95, 106496
    s_nop 0
    buffer_load_dwordx4 v24, s[28:31], s93 offen offset:0 lds
    buffer_load_dwordx4 v25, s[28:31], s93 offen offset:1024 lds
    s_add_u32 m0, s95, 114688
    s_nop 0
    buffer_load_dwordx4 v26, s[28:31], s93 offen offset:0 lds
    buffer_load_dwordx4 v27, s[28:31], s93 offen offset:1024 lds
    s_add_u32 m0, s95, 98304
    s_nop 0
    buffer_load_dwordx4 v28, s[28:31], s93 offen offset:0 lds
    buffer_load_dwordx4 v29, s[28:31], s93 offen offset:1024 lds
    s_lshl_b32 s12, s19, 2
    s_add_u32 s12, s12, s21
    s_lshl_b32 s12, s12, 10
    s_lshl_b32 s13, s21, 10
    s_add_u32 m0, s13, 155648
    s_nop 0
    buffer_load_dwordx4 v5, s[76:79], s12 offen lds
    s_lshl_b32 s12, s22, 11
    buffer_load_dwordx4 v[40:43], v5, s[24:27], s12 offen offset:0
    buffer_load_dwordx4 v[44:47], v5, s[24:27], s12 offen offset:1024
    buffer_load_dwordx4 v[48:51], v5, s[24:27], s12 offen offset:2048
    buffer_load_dwordx4 v[52:55], v5, s[24:27], s12 offen offset:3072
    buffer_load_dwordx4 v[56:59], v5, s[80:83], 0 offen offset:0
    buffer_load_dwordx4 v[60:63], v5, s[80:83], 0 offen offset:1024
    buffer_load_dwordx4 v[64:67], v5, s[84:87], 0 offen offset:0
    buffer_load_dwordx4 v[68:71], v5, s[84:87], 0 offen offset:1024
L_bw1_3:
    s_waitcnt vmcnt(19)
    s_barrier
    s_bfe_u32 s91, s68, 0x4000c
    s_lshl_b32 s92, s91, 7
    s_mul_i32 s93, s91, 393216
    s_add_u32 m0, s94, 0
    s_nop 0
    buffer_load_dwordx4 v20, s[24:27], s92 offen offset:0 lds
    s_waitcnt vmcnt(1)
    s_mov_b32 s8, 0xffff0000
    v_lshlrev_b32 v72, 16, v56
    v_and_b32 v56, s8, v56
    v_lshlrev_b32 v73, 16, v64
    v_and_b32 v64, s8, v64
    v_lshlrev_b32 v112, 16, v40
    buffer_load_dwordx4 v21, s[24:27], s92 offen offset:1024 lds
    v_and_b32 v40, s8, v40
    v_lshlrev_b32 v116, 16, v48
    v_and_b32 v48, s8, v48
    v_mul_f32 v113, v112, v73
    v_mul_f32 v114, v40, v64
    v_mul_f32 v90, v112, v72
    v_mul_f32 v117, v116, v73
    buffer_load_dwordx4 v22, s[24:27], s92 offen offset:2048 lds
    v_mul_f32 v118, v48, v64
    v_mul_f32 v92, v116, v72
    v_cvt_pk_bf16_f32 v113, 0, v113
    v_cvt_pk_bf16_f32 v114, 0, v114
    v_fmac_f32 v90, v40, v56
    v_cvt_pk_bf16_f32 v117, 0, v117
    v_cvt_pk_bf16_f32 v118, 0, v118
    buffer_load_dwordx4 v23, s[24:27], s92 offen offset:3072 lds
    v_fmac_f32 v92, v48, v56
    v_add_f32 v91, v113, v114
    v_add_f32 v93, v117, v118
    v_lshlrev_b32 v72, 16, v57
    v_and_b32 v57, s8, v57
    v_lshlrev_b32 v73, 16, v65
    v_and_b32 v65, s8, v65
    s_add_u32 m0, s95, 24576
    s_nop 0
    buffer_load_dwordx4 v24, s[28:31], s93 offen offset:0 lds
    v_lshlrev_b32 v112, 16, v41
    v_and_b32 v41, s8, v41
    v_lshlrev_b32 v116, 16, v49
    v_and_b32 v49, s8, v49
    v_mul_f32 v113, v112, v73
    v_mul_f32 v114, v41, v65
    v_fmac_f32 v90, v112, v72
    buffer_load_dwordx4 v25, s[28:31], s93 offen offset:1024 lds
    v_mul_f32 v117, v116, v73
    v_mul_f32 v118, v49, v65
    v_fmac_f32 v92, v116, v72
    v_cvt_pk_bf16_f32 v113, 0, v113
    v_cvt_pk_bf16_f32 v114, 0, v114
    v_fmac_f32 v90, v41, v57
    v_cvt_pk_bf16_f32 v117, 0, v117
    s_add_u32 m0, s95, 32768
    s_nop 0
    buffer_load_dwordx4 v26, s[28:31], s93 offen offset:0 lds
    v_cvt_pk_bf16_f32 v118, 0, v118
    v_fmac_f32 v92, v49, v57
    v_add_f32 v91, v91, v113
    v_add_f32 v93, v93, v117
    v_add_f32 v91, v91, v114
    v_add_f32 v93, v93, v118
    v_lshlrev_b32 v72, 16, v58
    buffer_load_dwordx4 v27, s[28:31], s93 offen offset:1024 lds
    v_and_b32 v58, s8, v58
    v_lshlrev_b32 v73, 16, v66
    v_and_b32 v66, s8, v66
    v_lshlrev_b32 v112, 16, v42
    v_and_b32 v42, s8, v42
    v_lshlrev_b32 v116, 16, v50
    v_and_b32 v50, s8, v50
    s_add_u32 m0, s95, 16384
    s_nop 0
    buffer_load_dwordx4 v28, s[28:31], s93 offen offset:0 lds
    v_mul_f32 v113, v112, v73
    v_mul_f32 v114, v42, v66
    v_fmac_f32 v90, v112, v72
    v_mul_f32 v117, v116, v73
    v_mul_f32 v118, v50, v66
    v_fmac_f32 v92, v116, v72
    v_cvt_pk_bf16_f32 v113, 0, v113
    buffer_load_dwordx4 v29, s[28:31], s93 offen offset:1024 lds
    v_cvt_pk_bf16_f32 v114, 0, v114
    v_fmac_f32 v90, v42, v58
    v_cvt_pk_bf16_f32 v117, 0, v117
    v_cvt_pk_bf16_f32 v118, 0, v118
    v_fmac_f32 v92, v50, v58
    v_add_f32 v91, v91, v113
    v_add_f32 v93, v93, v117
    s_cmp_lg_u32 s21, 0
    s_cbranch_scc1 L_noclr_3
    v_mov_b32 v104, -1
    v_mov_b32 v105, -1
    v_mov_b32 v106, -1
    v_mov_b32 v107, -1
    s_lshl_b32 s12, s19, 13
    s_lshl_b32 s13, s18, 9
    s_add_u32 s12, s12, s13
    s_add_u32 s12, s12, 32768
    s_lshl_b32 s13, s19, 11
    s_lshl_b32 s90, s18, 7
    s_add_u32 s13, s13, s90
    s_add_u32 s13, s13, 163840
    s_mov_b32 exec_hi, 0
    buffer_store_dwordx4 v[104:107], v5, s[32:35], s12 offen sc1
    s_mov_b32 exec_lo, 255
    buffer_store_dwordx4 v[104:107], v5, s[32:35], s13 offen sc1
    s_mov_b64 exec, -1
L_noclr_3:
    v_add_f32 v91, v91, v114
    v_add_f32 v93, v93, v118
    v_lshlrev_b32 v72, 16, v59
    v_and_b32 v59, s8, v59
    v_lshlrev_b32 v73, 16, v67
    v_and_b32 v67, s8, v67
    v_lshlrev_b32 v112, 16, v43
    v_and_b32 v43, s8, v43
    v_lshlrev_b32 v116, 16, v51
    v_and_b32 v51, s8, v51
    v_mul_f32 v113, v112, v73
    v_mul_f32 v114, v43, v67
    v_fmac_f32 v90, v112, v72
    v_mul_f32 v117, v116, v73
    v_mul_f32 v118, v51, v67
    v_fmac_f32 v92, v116, v72
    v_cvt_pk_bf16_f32 v113, 0, v113
    v_cvt_pk_bf16_f32 v114, 0, v114
    v_fmac_f32 v90, v43, v59
    v_cvt_pk_bf16_f32 v117, 0, v117
    v_cvt_pk_bf16_f32 v118, 0, v118
    v_fmac_f32 v92, v51, v59
    v_add_f32 v91, v91, v113
    v_add_f32 v93, v93, v117
    v_add_f32 v91, v91, v114
L_bw2_3:
    s_barrier
    s_bfe_u32 s91, s68, 0x40010
    s_lshl_b32 s92, s91, 7
    s_mul_i32 s93, s91, 393216
    s_add_u32 m0, s94, 40960
    s_nop 0
    buffer_load_dwordx4 v20, s[24:27], s92 offen offset:0 lds
    v_add_f32 v93, v93, v118
    v_lshlrev_b32 v72, 16, v60
    v_and_b32 v60, s8, v60
    v_lshlrev_b32 v73, 16, v68
    v_and_b32 v68, s8, v68
    v_lshlrev_b32 v112, 16, v44
    v_and_b32 v44, s8, v44
    buffer_load_dwordx4 v21, s[24:27], s92 offen offset:1024 lds
    v_lshlrev_b32 v116, 16, v52
    v_and_b32 v52, s8, v52
    v_mul_f32 v113, v112, v73
    v_mul_f32 v114, v44, v68
    v_fmac_f32 v90, v112, v72
    v_mul_f32 v117, v116, v73
    v_mul_f32 v118, v52, v68
    buffer_load_dwordx4 v22, s[24:27], s92 offen offset:2048 lds
    v_fmac_f32 v92, v116, v72
    v_cvt_pk_bf16_f32 v113, 0, v113
    v_cvt_pk_bf16_f32 v114, 0, v114
    v_fmac_f32 v90, v44, v60
    v_cvt_pk_bf16_f32 v117, 0, v117
    v_cvt_pk_bf16_f32 v118, 0, v118
    v_fmac_f32 v92, v52, v60
    buffer_load_dwordx4 v23, s[24:27], s92 offen offset:3072 lds
    v_add_f32 v91, v91, v113
    v_add_f32 v93, v93, v117
    v_add_f32 v91, v91, v114
    v_add_f32 v93, v93, v118
    v_lshlrev_b32 v72, 16, v61
    v_and_b32 v61, s8, v61
    v_lshlrev_b32 v73, 16, v69
    s_add_u32 m0, s95, 65536
    s_nop 0
    buffer_load_dwordx4 v24, s[28:31], s93 offen offset:0 lds
    v_and_b32 v69, s8, v69
    v_lshlrev_b32 v112, 16, v45
    v_and_b32 v45, s8, v45
    v_lshlrev_b32 v116, 16, v53
    v_and_b32 v53, s8, v53
    v_mul_f32 v113, v112, v73
    v_mul_f32 v114, v45, v69
    buffer_load_dwordx4 v25, s[28:31], s93 offen offset:1024 lds
    v_fmac_f32 v90, v112, v72
    v_mul_f32 v117, v116, v73
    v_mul_f32 v118, v53, v69
    v_fmac_f32 v92, v116, v72
    v_cvt_pk_bf16_f32 v113, 0, v113
    v_cvt_pk_bf16_f32 v114, 0, v114
    v_fmac_f32 v90, v45, v61
    s_add_u32 m0, s95, 73728
    s_nop 0
    buffer_load_dwordx4 v26, s[28:31], s93 offen offset:0 lds
    v_cvt_pk_bf16_f32 v117, 0, v117
    v_cvt_pk_bf16_f32 v118, 0, v118
    v_fmac_f32 v92, v53, v61
    v_add_f32 v91, v91, v113
    v_add_f32 v93, v93, v117
    v_add_f32 v91, v91, v114
    v_add_f32 v93, v93, v118
    buffer_load_dwordx4 v27, s[28:31], s93 offen offset:1024 lds
    v_lshlrev_b32 v72, 16, v62
    v_and_b32 v62, s8, v62
    v_lshlrev_b32 v73, 16, v70
    v_and_b32 v70, s8, v70
    v_lshlrev_b32 v112, 16, v46
    v_and_b32 v46, s8, v46
    v_lshlrev_b32 v116, 16, v54
    s_add_u32 m0, s95, 57344
    s_nop 0
    buffer_load_dwordx4 v28, s[28:31], s93 offen offset:0 lds
    v_and_b32 v54, s8, v54
    v_mul_f32 v113, v112, v73
    v_mul_f32 v114, v46, v70
    v_fmac_f32 v90, v112, v72
    v_mul_f32 v117, v116, v73
    v_mul_f32 v118, v54, v70
    v_fmac_f32 v92, v116, v72
    buffer_load_dwordx4 v29, s[28:31], s93 offen offset:1024 lds
    v_cvt_pk_bf16_f32 v113, 0, v113
    v_cvt_pk_bf16_f32 v114, 0, v114
    v_fmac_f32 v90, v46, v62
    v_cvt_pk_bf16_f32 v117, 0, v117
    v_cvt_pk_bf16_f32 v118, 0, v118
    v_fmac_f32 v92, v54, v62
    v_add_f32 v91, v91, v113
    buffer_load_dword v15, v13, s[72:75], 0 offen offset:4 sc1
    v_add_f32 v93, v93, v117
    v_add_f32 v91, v91, v114
    v_add_f32 v93, v93, v118
    v_lshlrev_b32 v72, 16, v63
    v_and_b32 v63, s8, v63
    v_lshlrev_b32 v73, 16, v71
    v_and_b32 v71, s8, v71
    v_lshlrev_b32 v112, 16, v47
    v_and_b32 v47, s8, v47
    v_lshlrev_b32 v116, 16, v55
    v_and_b32 v55, s8, v55
    v_mul_f32 v113, v112, v73
    v_mul_f32 v114, v47, v71
    v_fmac_f32 v90, v112, v72
    v_mul_f32 v117, v116, v73
    v_mul_f32 v118, v55, v71
    v_fmac_f32 v92, v116, v72
    v_cvt_pk_bf16_f32 v113, 0, v113
    v_cvt_pk_bf16_f32 v114, 0, v114
    v_fmac_f32 v90, v47, v63
    v_cvt_pk_bf16_f32 v117, 0, v117
    v_cvt_pk_bf16_f32 v118, 0, v118
    v_fmac_f32 v92, v55, v63
    v_add_f32 v91, v91, v113
    v_add_f32 v93, v93, v117
L_bw3_3:
    s_waitcnt vmcnt(11)
    s_barrier
    s_bfe_u32 s91, s68, 0x40014
    s_lshl_b32 s92, s91, 7
    s_mul_i32 s93, s91, 393216
    s_add_u32 m0, s94, 81920
    s_nop 0
    buffer_load_dwordx4 v20, s[24:27], s92 offen offset:0 lds
    v_add_f32 v91, v91, v114
    v_add_f32 v93, v93, v118
    v_add_f32_dpp v90, v90, v90 row_shr:1 row_mask:0xf bank_mask:0xf
    v_add_f32_dpp v91, v91, v91 row_shr:1 row_mask:0xf bank_mask:0xf
    v_add_f32_dpp v92, v92, v92 row_shr:1 row_mask:0xf bank_mask:0xf
    v_add_f32_dpp v93, v93, v93 row_shr:1 row_mask:0xf bank_mask:0xf
    v_add_f32_dpp v90, v90, v90 row_shr:2 row_mask:0xf bank_mask:0xf
    buffer_load_dwordx4 v21, s[24:27], s92 offen offset:1024 lds
    v_add_f32_dpp v91, v91, v91 row_shr:2 row_mask:0xf bank_mask:0xf
    v_add_f32_dpp v92, v92, v92 row_shr:2 row_mask:0xf bank_mask:0xf
    v_add_f32_dpp v93, v93, v93 row_shr:2 row_mask:0xf bank_mask:0xf
    v_add_f32_dpp v90, v90, v90 row_shr:4 row_mask:0xf bank_mask:0xf
    v_add_f32_dpp v91, v91, v91 row_shr:4 row_mask:0xf bank_mask:0xf
    v_add_f32_dpp v92, v92, v92 row_shr:4 row_mask:0xf bank_mask:0xf
    v_add_f32_dpp v93, v93, v93 row_shr:4 row_mask:0xf bank_mask:0xf
    buffer_load_dwordx4 v22, s[24:27], s92 offen offset:2048 lds
    v_add_f32_dpp v90, v90, v90 row_shr:8 row_mask:0xf bank_mask:0xf
    v_add_f32_dpp v91, v91, v91 row_shr:8 row_mask:0xf bank_mask:0xf
    v_add_f32_dpp v92, v92, v92 row_shr:8 row_mask:0xf bank_mask:0xf
    v_add_f32_dpp v93, v93, v93 row_shr:8 row_mask:0xf bank_mask:0xf
    v_add_f32_dpp v90, v90, v90 row_bcast:15 row_mask:0xa bank_mask:0xf
    v_add_f32_dpp v91, v91, v91 row_bcast:15 row_mask:0xa bank_mask:0xf
    v_add_f32_dpp v92, v92, v92 row_bcast:15 row_mask:0xa bank_mask:0xf
    buffer_load_dwordx4 v23, s[24:27], s92 offen offset:3072 lds
    v_add_f32_dpp v93, v93, v93 row_bcast:15 row_mask:0xa bank_mask:0xf
    v_add_f32_dpp v90, v90, v90 row_bcast:31 row_mask:0xc bank_mask:0xf
    v_add_f32_dpp v91, v91, v91 row_bcast:31 row_mask:0xc bank_mask:0xf
    v_add_f32_dpp v92, v92, v92 row_bcast:31 row_mask:0xc bank_mask:0xf
    v_add_f32_dpp v93, v93, v93 row_bcast:31 row_mask:0xc bank_mask:0xf
    v_mov_b32 v97, 0x8000
    v_mov_b32 v98, 0xffff
    s_add_u32 m0, s95, 106496
    s_nop 0
    buffer_load_dwordx4 v24, s[28:31], s93 offen offset:0 lds
    v_cvt_pk_bf16_f32 v94, v90, v91
    v_cvt_pk_bf16_f32 v104, v92, v93
    v_and_b32 v95, 0xffff, v94
    v_and_b32 v96, 0x8000, v94
    v_and_b32 v94, 0xffff0000, v94
    v_cmp_ne_u32 vcc, 0, v96
    v_mul_f32 v94, 0xbfb8aa3b, v94
    buffer_load_dwordx4 v25, s[28:31], s93 offen offset:1024 lds
    v_exp_f32 v94, v94
    v_cndmask_b32 v96, v97, v98, vcc
    v_xor_b32 v95, v95, v96
    v_add_f32 v94, 1.0, v94
    v_lshlrev_b32 v95, 11, v95
    v_rcp_f32 v94, v94
    s_sub_u32 s12, 2047, s22
    v_or_b32 v100, s12, v95
    s_add_u32 m0, s95, 114688
    s_nop 0
    buffer_load_dwordx4 v26, s[28:31], s93 offen offset:0 lds
    v_cvt_pk_bf16_f32 v94, v94, v94
    v_lshlrev_b32 v102, 16, v94
    v_and_b32 v105, 0xffff, v104
    v_and_b32 v106, 0x8000, v104
    v_and_b32 v104, 0xffff0000, v104
    v_cmp_ne_u32 vcc, 0, v106
    v_mul_f32 v104, 0xbfb8aa3b, v104
    buffer_load_dwordx4 v27, s[28:31], s93 offen offset:1024 lds
    v_exp_f32 v104, v104
    v_cndmask_b32 v106, v97, v98, vcc
    v_xor_b32 v105, v105, v106
    v_add_f32 v104, 1.0, v104
    v_lshlrev_b32 v105, 11, v105
    v_rcp_f32 v104, v104
    s_sub_u32 s12, 2046, s22
    v_or_b32 v101, s12, v105
    s_add_u32 m0, s95, 98304
    s_nop 0
    buffer_load_dwordx4 v28, s[28:31], s93 offen offset:0 lds
    v_cvt_pk_bf16_f32 v104, v104, v104
    v_lshlrev_b32 v103, 16, v104
    v_max_u32 v100, v100, v101
    s_lshl_b32 s12, s22, 2
    s_add_u32 s12, s12, 4096
    s_lshl_b32 s13, s21, 2
    s_add_u32 s13, s13, 162880
    v_mov_b32 v14, s13
    s_mov_b32 exec_lo, 0
    s_mov_b32 exec_hi, 0x80000000
    buffer_store_dwordx2 v[102:103], v13, s[32:35], s12 offen sc1
    ds_write_b32 v14, v100
    s_mov_b64 exec, -1
    s_waitcnt lgkmcnt(0)
    buffer_load_dwordx4 v29, s[28:31], s93 offen offset:1024 lds
    s_cmp_ge_u32 s10, 224
    s_cbranch_scc1 L_p30_3
    s_add_u32 s12, s71, 0
    buffer_load_dwordx4 v[128:131], v30, s[40:43], s12 offen nt
    s_add_u32 s12, s71, 7168
    buffer_load_dwordx4 v[132:135], v30, s[40:43], s12 offen nt
    s_add_u32 s12, s71, 14336
    buffer_load_dwordx4 v[136:139], v30, s[40:43], s12 offen nt
    s_add_u32 s12, s71, 21504
    buffer_load_dwordx4 v[140:143], v30, s[40:43], s12 offen nt
    s_add_u32 s12, s71, 28672
    buffer_load_dwordx4 v[144:147], v30, s[40:43], s12 offen nt
    s_add_u32 s12, s71, 35840
    buffer_load_dwordx4 v[148:151], v30, s[40:43], s12 offen nt
    s_add_u32 s12, s71, 43008
    buffer_load_dwordx4 v[152:155], v30, s[40:43], s12 offen nt
    s_add_u32 s12, s71, 50176
    buffer_load_dwordx4 v[156:159], v30, s[40:43], s12 offen nt
    s_branch L_p3e0_3
L_p30_3:
    s_mov_b64 exec, 63
    s_bfe_u32 s12, s68, 0x4000c
    s_mul_i32 s12, s12, 393216
    buffer_load_dword v128, v32, s[28:31], s12 offen
    s_bfe_u32 s12, s68, 0x40010
    s_mul_i32 s12, s12, 393216
    buffer_load_dword v132, v32, s[28:31], s12 offen
    s_bfe_u32 s12, s68, 0x40014
    s_mul_i32 s12, s12, 393216
    buffer_load_dword v136, v32, s[28:31], s12 offen
    s_bfe_u32 s12, s68, 0x40018
    s_mul_i32 s12, s12, 393216
    buffer_load_dword v140, v32, s[28:31], s12 offen
    s_bfe_u32 s12, s68, 0x4001c
    s_mul_i32 s12, s12, 393216
    buffer_load_dword v144, v32, s[28:31], s12 offen
    s_bfe_u32 s12, s69, 0x40000
    s_mul_i32 s12, s12, 393216
    buffer_load_dword v148, v32, s[28:31], s12 offen
    s_bfe_u32 s12, s69, 0x40004
    s_mul_i32 s12, s12, 393216
    buffer_load_dword v152, v32, s[28:31], s12 offen
    s_bfe_u32 s12, s69, 0x40008
    s_mul_i32 s12, s12, 393216
    buffer_load_dword v156, v32, s[28:31], s12 offen
    s_mov_b64 exec, -1
L_p3e0_3:
L_bw4_3:
    s_waitcnt vmcnt(20)
    s_barrier
    s_bfe_u32 s91, s68, 0x40018
    s_lshl_b32 s92, s91, 7
    s_mul_i32 s93, s91, 393216
    s_add_u32 m0, s94, 0
    s_nop 0
    buffer_load_dwordx4 v20, s[24:27], s92 offen offset:0 lds
    buffer_load_dwordx4 v21, s[24:27], s92 offen offset:1024 lds
    buffer_load_dwordx4 v22, s[24:27], s92 offen offset:2048 lds
    buffer_load_dwordx4 v23, s[24:27], s92 offen offset:3072 lds
    s_add_u32 m0, s95, 24576
    s_nop 0
    buffer_load_dwordx4 v24, s[28:31], s93 offen offset:0 lds
    s_waitcnt vmcnt(14)
L_bw5_3:
    s_waitcnt vmcnt(13)
    s_barrier
    s_add_u32 m0, s95, 24576
    s_nop 0
    buffer_load_dwordx4 v25, s[28:31], s93 offen offset:1024 lds
    s_add_u32 m0, s95, 32768
    s_nop 0
    buffer_load_dwordx4 v26, s[28:31], s93 offen offset:0 lds
    buffer_load_dwordx4 v27, s[28:31], s93 offen offset:1024 lds
    s_add_u32 m0, s95, 16384
    s_nop 0
    buffer_load_dwordx4 v28, s[28:31], s93 offen offset:0 lds
    buffer_load_dwordx4 v29, s[28:31], s93 offen offset:1024 lds
    s_bfe_u32 s91, s68, 0x4001c
    s_lshl_b32 s92, s91, 7
    s_mul_i32 s93, s91, 393216
    s_add_u32 m0, s94, 40960
    s_nop 0
    buffer_load_dwordx4 v20, s[24:27], s92 offen offset:0 lds
    buffer_load_dwordx4 v21, s[24:27], s92 offen offset:1024 lds
    buffer_load_dwordx4 v22, s[24:27], s92 offen offset:2048 lds
    buffer_load_dwordx4 v23, s[24:27], s92 offen offset:3072 lds
    s_add_u32 m0, s95, 65536
    s_nop 0
    buffer_load_dwordx4 v24, s[28:31], s93 offen offset:0 lds
    buffer_load_dwordx4 v25, s[28:31], s93 offen offset:1024 lds
    s_add_u32 m0, s95, 73728
    s_nop 0
    buffer_load_dwordx4 v26, s[28:31], s93 offen offset:0 lds
    s_mov_b32 s13, 0
L_tagchk_3:
    v_readfirstlane_b32 s23, v15
    s_nop 1
    s_cmp_lg_u32 s23, 0
    s_cbranch_scc1 L_tagok_3
    s_add_u32 s13, s13, 1
    s_cmp_ge_u32 s13, 16384
    s_cbranch_scc1 L_tagok_3
    buffer_load_dword v15, v13, s[72:75], 0 offen offset:4 sc1
    s_waitcnt vmcnt(0)
    s_branch L_tagchk_3
L_tagok_3:
    s_and_b32 s76, s23, 0xff
    s_bfe_u32 s77, s23, 0x80008
    s_bfe_u32 s78, s23, 0x80010
    s_lshr_b32 s79, s23, 24
    v_and_b32 v35, 3, v2
    v_lshlrev_b32 v35, 3, v35
    v_bfe_u32 v35, s23, v35, 8
    s_cmp_lg_u32 s21, 0
    s_cbranch_scc1 L_nopub_3
    v_mov_b32 v14, 162880
    ds_read_b128 v[104:107], v14
    s_lshl_b32 s12, s2, 3
    s_add_u32 s12, s12, 0
    s_waitcnt lgkmcnt(0)
    v_max3_u32 v104, v104, v105, v106
    v_max_u32 v104, v104, v107
    v_mov_b32 v105, s23
    s_mov_b64 exec, 1
    buffer_store_dwordx2 v[104:105], v13, s[32:35], s12 offen sc1
    s_mov_b64 exec, -1
L_nopub_3:
L_bw6_3:
    s_waitcnt vmcnt(7)
    s_barrier
    s_add_u32 m0, s95, 73728
    s_nop 0
    buffer_load_dwordx4 v27, s[28:31], s93 offen offset:1024 lds
    s_add_u32 m0, s95, 57344
    s_nop 0
    buffer_load_dwordx4 v28, s[28:31], s93 offen offset:0 lds
    buffer_load_dwordx4 v29, s[28:31], s93 offen offset:1024 lds
    s_bfe_u32 s91, s69, 0x40000
    s_lshl_b32 s92, s91, 7
    s_mul_i32 s93, s91, 393216
    s_add_u32 m0, s94, 81920
    s_nop 0
    buffer_load_dwordx4 v20, s[24:27], s92 offen offset:0 lds
    buffer_load_dwordx4 v21, s[24:27], s92 offen offset:1024 lds
    buffer_load_dwordx4 v22, s[24:27], s92 offen offset:2048 lds
    buffer_load_dwordx4 v23, s[24:27], s92 offen offset:3072 lds
    s_add_u32 m0, s95, 106496
    s_nop 0
    buffer_load_dwordx4 v24, s[28:31], s93 offen offset:0 lds
    buffer_load_dwordx4 v25, s[28:31], s93 offen offset:1024 lds
    s_add_u32 m0, s95, 114688
    s_nop 0
    buffer_load_dwordx4 v26, s[28:31], s93 offen offset:0 lds
    buffer_load_dwordx4 v27, s[28:31], s93 offen offset:1024 lds
    s_add_u32 m0, s95, 98304
    s_nop 0
    buffer_load_dwordx4 v28, s[28:31], s93 offen offset:0 lds
L_bw7_3:
    s_waitcnt vmcnt(9)
    s_barrier
    s_add_u32 m0, s95, 98304
    s_nop 0
    buffer_load_dwordx4 v29, s[28:31], s93 offen offset:1024 lds
    s_bfe_u32 s91, s69, 0x40004
    s_lshl_b32 s92, s91, 7
    s_mul_i32 s93, s91, 393216
    s_add_u32 m0, s94, 0
    s_nop 0
    buffer_load_dwordx4 v20, s[24:27], s92 offen offset:0 lds
    buffer_load_dwordx4 v21, s[24:27], s92 offen offset:1024 lds
    buffer_load_dwordx4 v22, s[24:27], s92 offen offset:2048 lds
    buffer_load_dwordx4 v23, s[24:27], s92 offen offset:3072 lds
    s_add_u32 m0, s95, 24576
    s_nop 0
    buffer_load_dwordx4 v24, s[28:31], s93 offen offset:0 lds
    buffer_load_dwordx4 v25, s[28:31], s93 offen offset:1024 lds
    s_add_u32 m0, s95, 32768
    s_nop 0
    buffer_load_dwordx4 v26, s[28:31], s93 offen offset:0 lds
    buffer_load_dwordx4 v27, s[28:31], s93 offen offset:1024 lds
    s_add_u32 m0, s95, 16384
    s_nop 0
    buffer_load_dwordx4 v28, s[28:31], s93 offen offset:0 lds
    buffer_load_dwordx4 v29, s[28:31], s93 offen offset:1024 lds
L_bw8_3:
    s_waitcnt vmcnt(10)
    s_barrier
    s_bfe_u32 s91, s69, 0x40008
    s_lshl_b32 s92, s91, 7
    s_mul_i32 s93, s91, 393216
    s_add_u32 m0, s94, 40960
    s_nop 0
    buffer_load_dwordx4 v20, s[24:27], s92 offen offset:0 lds
    buffer_load_dwordx4 v21, s[24:27], s92 offen offset:1024 lds
    buffer_load_dwordx4 v22, s[24:27], s92 offen offset:2048 lds
    buffer_load_dwordx4 v23, s[24:27], s92 offen offset:3072 lds
    s_add_u32 m0, s95, 65536
    s_nop 0
    buffer_load_dwordx4 v24, s[28:31], s93 offen offset:0 lds
    buffer_load_dwordx4 v25, s[28:31], s93 offen offset:1024 lds
    s_add_u32 m0, s95, 73728
    s_nop 0
    buffer_load_dwordx4 v26, s[28:31], s93 offen offset:0 lds
    buffer_load_dwordx4 v27, s[28:31], s93 offen offset:1024 lds
    s_add_u32 m0, s95, 57344
    s_nop 0
    buffer_load_dwordx4 v28, s[28:31], s93 offen offset:0 lds
    buffer_load_dwordx4 v29, s[28:31], s93 offen offset:1024 lds
    s_cmp_ge_u32 s10, 224
    s_cbranch_scc1 L_p31_3
    s_add_u32 s12, s9, 0
    buffer_load_dwordx4 v[160:163], v30, s[44:47], s12 offen nt
    s_add_u32 s12, s9, 7168
    buffer_load_dwordx4 v[164:167], v30, s[44:47], s12 offen nt
    s_add_u32 s12, s9, 14336
    buffer_load_dwordx4 v[168:171], v30, s[44:47], s12 offen nt
    s_add_u32 s12, s9, 21504
    buffer_load_dwordx4 v[172:175], v30, s[44:47], s12 offen nt
    s_add_u32 s12, s9, 28672
    buffer_load_dwordx4 v[176:179], v30, s[44:47], s12 offen nt
    s_add_u32 s12, s9, 35840
    buffer_load_dwordx4 v[180:183], v30, s[44:47], s12 offen nt
    s_add_u32 s12, s9, 43008
    buffer_load_dwordx4 v[184:187], v30, s[44:47], s12 offen nt
    s_add_u32 s12, s9, 50176
    buffer_load_dwordx4 v[188:191], v30, s[44:47], s12 offen nt
    s_branch L_p3e1_3
L_p31_3:
    s_mov_b64 exec, 63
    s_bfe_u32 s12, s69, 0x4000c
    s_mul_i32 s12, s12, 393216
    buffer_load_dword v160, v32, s[28:31], s12 offen
    s_bfe_u32 s12, s69, 0x40010
    s_mul_i32 s12, s12, 393216
    buffer_load_dword v164, v32, s[28:31], s12 offen
    s_bfe_u32 s12, s69, 0x40014
    s_mul_i32 s12, s12, 393216
    buffer_load_dword v168, v32, s[28:31], s12 offen
    s_bfe_u32 s12, s69, 0x40018
    s_mul_i32 s12, s12, 393216
    buffer_load_dword v172, v32, s[28:31], s12 offen
    s_bfe_u32 s12, s69, 0x4001c
    s_mul_i32 s12, s12, 393216
    buffer_load_dword v176, v32, s[28:31], s12 offen
    s_mov_b64 exec, 1
    s_bfe_u32 s12, s69, 0x4001c
    s_mul_i32 s12, s12, 393216
    buffer_load_dword v180, v32, s[28:31], s12 offen
    s_bfe_u32 s12, s69, 0x4001c
    s_mul_i32 s12, s12, 393216
    buffer_load_dword v184, v32, s[28:31], s12 offen
    s_bfe_u32 s12, s69, 0x4001c
    s_mul_i32 s12, s12, 393216
    buffer_load_dword v188, v32, s[28:31], s12 offen
    s_mov_b64 exec, -1
L_p3e1_3:
    s_mov_b32 exec_lo, 0xffff0000
    s_mov_b32 exec_hi, 0
    buffer_load_dword v19, v10, s[36:39], 0 offen
    s_mov_b64 exec, -1
L_bw9_3:
    s_waitcnt vmcnt(19)
    s_barrier
    s_bfe_u32 s91, s69, 0x4000c
    s_lshl_b32 s92, s91, 7
    s_mul_i32 s93, s91, 393216
    s_add_u32 m0, s94, 122880
    s_nop 0
    buffer_load_dwordx4 v20, s[24:27], s92 offen offset:0 lds
    buffer_load_dwordx4 v21, s[24:27], s92 offen offset:1024 lds
    buffer_load_dwordx4 v22, s[24:27], s92 offen offset:2048 lds
    buffer_load_dwordx4 v23, s[24:27], s92 offen offset:3072 lds
    s_add_u32 m0, s95, 106496
    s_nop 0
    buffer_load_dwordx4 v24, s[28:31], s93 offen offset:0 lds
    s_mov_b32 s12, 0
    buffer_load_dwordx4 v[104:107], v5, s[32:35], s12 offen offset:0 sc1
    buffer_load_dwordx4 v[108:111], v5, s[32:35], s12 offen offset:1024 sc1
L_bw10_3:
    s_waitcnt vmcnt(16)
    s_barrier
    s_add_u32 m0, s95, 106496
    s_nop 0
    buffer_load_dwordx4 v25, s[28:31], s93 offen offset:1024 lds
    s_add_u32 m0, s95, 114688
    s_nop 0
    buffer_load_dwordx4 v26, s[28:31], s93 offen offset:0 lds
    buffer_load_dwordx4 v27, s[28:31], s93 offen offset:1024 lds
    s_bfe_u32 s91, s69, 0x40010
    s_lshl_b32 s92, s91, 7
    s_mul_i32 s93, s91, 393216
    s_add_u32 m0, s94, 139264
    s_nop 0
    buffer_load_dwordx4 v20, s[24:27], s92 offen offset:0 lds
    buffer_load_dwordx4 v21, s[24:27], s92 offen offset:1024 lds
    buffer_load_dwordx4 v22, s[24:27], s92 offen offset:2048 lds
    buffer_load_dwordx4 v23, s[24:27], s92 offen offset:3072 lds
    s_add_u32 m0, s95, 24576
    s_nop 0
    buffer_load_dwordx4 v24, s[28:31], s93 offen offset:0 lds
    buffer_load_dwordx4 v25, s[28:31], s93 offen offset:1024 lds
    s_add_u32 m0, s95, 32768
    s_nop 0
    buffer_load_dwordx4 v26, s[28:31], s93 offen offset:0 lds
L_bw11_3:
    s_waitcnt vmcnt(7)
    s_barrier
    s_add_u32 m0, s95, 32768
    s_nop 0
    buffer_load_dwordx4 v27, s[28:31], s93 offen offset:1024 lds
    s_mov_b32 s13, 0
    v_xor_b32 v105, s23, v105
    v_xor_b32 v107, s23, v107
    v_xor_b32 v109, s23, v109
    v_xor_b32 v111, s23, v111
    v_or3_b32 v105, v105, v107, v109
    v_or_b32 v105, v105, v111
    v_cmp_ne_u32 vcc, 0, v105
    s_cbranch_vccnz L_keyre_3
L_keyok_3:
    v_max3_u32 v104, v104, v106, v108
    v_max_u32 v104, v104, v110
    s_nop 1
    v_max_u32_dpp v104, v104, v104 row_shr:1 row_mask:0xf bank_mask:0xf
    s_nop 1
    v_max_u32_dpp v104, v104, v104 row_shr:2 row_mask:0xf bank_mask:0xf
    s_nop 1
    v_max_u32_dpp v104, v104, v104 row_shr:4 row_mask:0xf bank_mask:0xf
    s_bfe_u32 s91, s69, 0x40014
    s_lshl_b32 s92, s91, 7
    s_mul_i32 s93, s91, 393216
    s_add_u32 m0, s94, 40960
    s_nop 0
    buffer_load_dwordx4 v20, s[24:27], s92 offen offset:0 lds
    v_max_u32_dpp v104, v104, v104 row_shr:8 row_mask:0xf bank_mask:0xf
    s_nop 1
    v_max_u32_dpp v104, v104, v104 row_bcast:15 row_mask:0xa bank_mask:0xf
    s_nop 1
    v_max_u32_dpp v104, v104, v104 row_bcast:31 row_mask:0xc bank_mask:0xf
    s_nop 0
    v_readlane_b32 s14, v104, 63
    s_nop 1
    s_and_b32 s15, s14, 2047
    s_sub_u32 s15, 2047, s15
    s_lshl_b32 s12, s15, 11
    s_lshl_b32 s13, s70, 1
    s_add_u32 s12, s12, s13
    buffer_load_dwordx4 v[36:39], v34, s[24:27], s12 offen
    buffer_load_dwordx4 v21, s[24:27], s92 offen offset:1024 lds
    s_lshr_b32 s12, s14, 11
    s_and_b32 s13, s12, 0x8000
    s_cmp_lg_u32 s13, 0
    s_mov_b32 s13, 0xffff
    s_cselect_b32 s13, 0x8000, s13
    s_xor_b32 s12, s12, s13
    s_lshl_b32 s12, s12, 16
    v_mov_b32 v105, s12
    buffer_load_dwordx4 v22, s[24:27], s92 offen offset:2048 lds
    v_mul_f32 v105, 0xbfb8aa3b, v105
    v_exp_f32 v105, v105
    s_nop 0
    v_add_f32 v105, 1.0, v105
    v_rcp_f32 v105, v105
    s_nop 0
    v_cvt_pk_bf16_f32 v105, v105, v105
    v_lshlrev_b32 v105, 16, v105
    s_add_u32 s12, s15, 1
    v_mov_b32 v104, s12
    buffer_load_dwordx4 v23, s[24:27], s92 offen offset:3072 lds
    v_mov_b32 v106, s23
    v_readfirstlane_b32 s14, v105
    v_mov_b32 v14, 162864
    s_mov_b64 exec, 1
    ds_write_b96 v14, v[104:106]
    s_mov_b64 exec, -1
    s_waitcnt lgkmcnt(0)
    s_add_u32 m0, s95, 65536
    s_nop 0
    buffer_load_dwordx4 v24, s[28:31], s93 offen offset:0 lds
    buffer_load_dwordx4 v25, s[28:31], s93 offen offset:1024 lds
    s_add_u32 m0, s95, 73728
    s_nop 0
    buffer_load_dwordx4 v26, s[28:31], s93 offen offset:0 lds
    buffer_load_dwordx4 v27, s[28:31], s93 offen offset:1024 lds
L_bw12_3:
    s_waitcnt vmcnt(9)
    s_barrier
    s_bfe_u32 s91, s69, 0x40018
    s_lshl_b32 s92, s91, 7
    s_mul_i32 s93, s91, 393216
    s_add_u32 m0, s94, 81920
    s_nop 0
    buffer_load_dwordx4 v20, s[24:27], s92 offen offset:0 lds
    s_waitcnt vmcnt(8)
    s_mov_b32 s8, 0xffff0000
    v_lshlrev_b32 v40, 16, v36
    v_and_b32 v41, s8, v36
    v_lshlrev_b32 v42, 16, v37
    v_and_b32 v43, s8, v37
    v_lshlrev_b32 v44, 16, v38
    buffer_load_dwordx4 v21, s[24:27], s92 offen offset:1024 lds
    v_and_b32 v45, s8, v38
    v_lshlrev_b32 v46, 16, v39
    v_and_b32 v47, s8, v39
    v_lshlrev_b32 v48, 16, v128
    v_lshlrev_b32 v49, 16, v129
    v_and_b32 v128, s8, v128
    v_and_b32 v129, s8, v129
    buffer_load_dwordx4 v22, s[24:27], s92 offen offset:2048 lds
    v_mul_f32 v220, v48, v40
    v_mul_f32 v222, v49, v40
    v_mul_f32 v221, v128, v40
    v_mul_f32 v223, v129, v40
    v_lshlrev_b32 v50, 16, v130
    v_lshlrev_b32 v51, 16, v131
    v_and_b32 v130, s8, v130
    buffer_load_dwordx4 v23, s[24:27], s92 offen offset:3072 lds
    v_and_b32 v131, s8, v131
    v_mul_f32 v224, v50, v40
    v_mul_f32 v226, v51, v40
    v_mul_f32 v225, v130, v40
    v_mul_f32 v227, v131, v40
    v_lshlrev_b32 v48, 16, v160
    v_lshlrev_b32 v49, 16, v161
    s_add_u32 m0, s95, 106496
    s_nop 0
    buffer_load_dwordx4 v24, s[28:31], s93 offen offset:0 lds
    v_and_b32 v160, s8, v160
    v_and_b32 v161, s8, v161
    v_mul_f32 v228, v48, v40
    v_mul_f32 v230, v49, v40
    v_mul_f32 v229, v160, v40
    v_mul_f32 v231, v161, v40
    v_lshlrev_b32 v50, 16, v162
    buffer_load_dwordx4 v25, s[28:31], s93 offen offset:1024 lds
    v_lshlrev_b32 v51, 16, v163
    v_and_b32 v162, s8, v162
    v_and_b32 v163, s8, v163
    v_mul_f32 v232, v50, v40
    v_mul_f32 v234, v51, v40
    v_mul_f32 v233, v162, v40
    v_mul_f32 v235, v163, v40
    s_add_u32 m0, s95, 114688
    s_nop 0
    buffer_load_dwordx4 v26, s[28:31], s93 offen offset:0 lds
    v_lshlrev_b32 v48, 16, v132
    v_lshlrev_b32 v49, 16, v133
    v_and_b32 v132, s8, v132
    v_and_b32 v133, s8, v133
    v_fmac_f32 v220, v48, v41
    v_fmac_f32 v222, v49, v41
    v_fmac_f32 v221, v132, v41
    v_fmac_f32 v223, v133, v41
    v_lshlrev_b32 v50, 16, v134
    v_lshlrev_b32 v51, 16, v135
    v_and_b32 v134, s8, v134
    v_and_b32 v135, s8, v135
    v_fmac_f32 v224, v50, v41
    v_fmac_f32 v226, v51, v41
    buffer_load_dwordx4 v27, s[28:31], s93 offen offset:1024 lds
    v_fmac_f32 v225, v134, v41
    v_fmac_f32 v227, v135, v41
    v_lshlrev_b32 v48, 16, v164
    v_lshlrev_b32 v49, 16, v165
    v_and_b32 v164, s8, v164
    v_and_b32 v165, s8, v165
    v_fmac_f32 v228, v48, v41
    v_fmac_f32 v230, v49, v41
    v_fmac_f32 v229, v164, v41
    v_fmac_f32 v231, v165, v41
    v_lshlrev_b32 v50, 16, v166
    v_lshlrev_b32 v51, 16, v167
    v_and_b32 v166, s8, v166
    v_and_b32 v167, s8, v167
    v_fmac_f32 v232, v50, v41
    v_fmac_f32 v234, v51, v41
    v_fmac_f32 v233, v166, v41
    v_fmac_f32 v235, v167, v41
    v_lshlrev_b32 v48, 16, v136
    v_lshlrev_b32 v49, 16, v137
    v_and_b32 v136, s8, v136
    v_and_b32 v137, s8, v137
    v_fmac_f32 v220, v48, v42
    v_fmac_f32 v222, v49, v42
    v_fmac_f32 v221, v136, v42
    v_fmac_f32 v223, v137, v42
    v_lshlrev_b32 v50, 16, v138
    v_lshlrev_b32 v51, 16, v139
    v_and_b32 v138, s8, v138
    v_and_b32 v139, s8, v139
    v_fmac_f32 v224, v50, v42
    v_fmac_f32 v226, v51, v42
    v_fmac_f32 v225, v138, v42
    v_fmac_f32 v227, v139, v42
    v_lshlrev_b32 v48, 16, v168
    v_lshlrev_b32 v49, 16, v169
    v_and_b32 v168, s8, v168
    v_and_b32 v169, s8, v169
    v_fmac_f32 v228, v48, v42
L_bw13_3:
    s_waitcnt vmcnt(8)
    s_barrier
    s_bfe_u32 s91, s69, 0x4001c
    s_lshl_b32 s92, s91, 7
    s_mul_i32 s93, s91, 393216
    s_add_u32 m0, s94, 0
    s_nop 0
    buffer_load_dwordx4 v20, s[24:27], s92 offen offset:0 lds
    v_fmac_f32 v230, v49, v42
    v_fmac_f32 v229, v168, v42
    v_fmac_f32 v231, v169, v42
    v_lshlrev_b32 v50, 16, v170
    v_lshlrev_b32 v51, 16, v171
    v_and_b32 v170, s8, v170
    v_and_b32 v171, s8, v171
    buffer_load_dwordx4 v21, s[24:27], s92 offen offset:1024 lds
    v_fmac_f32 v232, v50, v42
    v_fmac_f32 v234, v51, v42
    v_fmac_f32 v233, v170, v42
    v_fmac_f32 v235, v171, v42
    v_lshlrev_b32 v48, 16, v140
    v_lshlrev_b32 v49, 16, v141
    v_and_b32 v140, s8, v140
    buffer_load_dwordx4 v22, s[24:27], s92 offen offset:2048 lds
    v_and_b32 v141, s8, v141
    v_fmac_f32 v220, v48, v43
    v_fmac_f32 v222, v49, v43
    v_fmac_f32 v221, v140, v43
    v_fmac_f32 v223, v141, v43
    v_lshlrev_b32 v50, 16, v142
    v_lshlrev_b32 v51, 16, v143
    buffer_load_dwordx4 v23, s[24:27], s92 offen offset:3072 lds
    v_and_b32 v142, s8, v142
    v_and_b32 v143, s8, v143
    v_fmac_f32 v224, v50, v43
    v_fmac_f32 v226, v51, v43
    v_fmac_f32 v225, v142, v43
    v_fmac_f32 v227, v143, v43
    v_lshlrev_b32 v48, 16, v172
    s_add_u32 m0, s95, 24576
    s_nop 0
    buffer_load_dwordx4 v24, s[28:31], s93 offen offset:0 lds
    v_lshlrev_b32 v49, 16, v173
    v_and_b32 v172, s8, v172
    v_and_b32 v173, s8, v173
    v_fmac_f32 v228, v48, v43
    v_fmac_f32 v230, v49, v43
    v_fmac_f32 v229, v172, v43
    v_fmac_f32 v231, v173, v43
    buffer_load_dwordx4 v25, s[28:31], s93 offen offset:1024 lds
    v_lshlrev_b32 v50, 16, v174
    v_lshlrev_b32 v51, 16, v175
    v_and_b32 v174, s8, v174
    v_and_b32 v175, s8, v175
    v_fmac_f32 v232, v50, v43
    v_fmac_f32 v234, v51, v43
    v_fmac_f32 v233, v174, v43
    s_add_u32 m0, s95, 32768
    s_nop 0
    buffer_load_dwordx4 v26, s[28:31], s93 offen offset:0 lds
    v_fmac_f32 v235, v175, v43
    v_lshlrev_b32 v48, 16, v144
    v_lshlrev_b32 v49, 16, v145
    v_and_b32 v144, s8, v144
    v_and_b32 v145, s8, v145
    v_fmac_f32 v220, v48, v44
    v_fmac_f32 v222, v49, v44
    v_fmac_f32 v221, v144, v44
    v_fmac_f32 v223, v145, v44
    v_lshlrev_b32 v50, 16, v146
    v_lshlrev_b32 v51, 16, v147
    v_and_b32 v146, s8, v146
    v_and_b32 v147, s8, v147
    v_fmac_f32 v224, v50, v44
    buffer_load_dwordx4 v27, s[28:31], s93 offen offset:1024 lds
    v_fmac_f32 v226, v51, v44
    v_fmac_f32 v225, v146, v44
    v_fmac_f32 v227, v147, v44
    v_lshlrev_b32 v48, 16, v176
    v_lshlrev_b32 v49, 16, v177
    v_and_b32 v176, s8, v176
    v_and_b32 v177, s8, v177
    v_fmac_f32 v228, v48, v44
    v_fmac_f32 v230, v49, v44
    v_fmac_f32 v229, v176, v44
    v_fmac_f32 v231, v177, v44
    v_lshlrev_b32 v50, 16, v178
    v_lshlrev_b32 v51, 16, v179
    v_and_b32 v178, s8, v178
    s_add_u32 s12, s97, 0
    buffer_load_dwordx4 v[192:195], v31, s[64:67], s12 offen nt
    s_add_u32 s12, s97, 16384
    buffer_load_dwordx4 v[196:199], v31, s[64:67], s12 offen nt
    s_add_u32 s12, s97, 32768
    buffer_load_dwordx4 v[200:203], v31, s[64:67], s12 offen nt
    s_add_u32 s12, s97, 49152
    buffer_load_dwordx4 v[204:207], v31, s[64:67], s12 offen nt
    s_add_u32 s12, s97, 65536
    buffer_load_dwordx4 v[208:211], v31, s[64:67], s12 offen nt
    s_add_u32 s12, s97, 81920
    buffer_load_dwordx4 v[212:215], v31, s[64:67], s12 offen nt
    s_add_u32 s12, s97, 98304
    buffer_load_dwordx4 v[216:219], v31, s[64:67], s12 offen nt
    v_and_b32 v179, s8, v179
    v_fmac_f32 v232, v50, v44
    v_fmac_f32 v234, v51, v44
    v_fmac_f32 v233, v178, v44
    v_fmac_f32 v235, v179, v44
    v_lshlrev_b32 v48, 16, v148
    v_lshlrev_b32 v49, 16, v149
    v_and_b32 v148, s8, v148
    v_and_b32 v149, s8, v149
    v_fmac_f32 v220, v48, v45
    v_fmac_f32 v222, v49, v45
    v_fmac_f32 v221, v148, v45
    v_fmac_f32 v223, v149, v45
    v_lshlrev_b32 v50, 16, v150
    v_lshlrev_b32 v51, 16, v151
    v_and_b32 v150, s8, v150
    v_and_b32 v151, s8, v151
    v_fmac_f32 v224, v50, v45
    v_fmac_f32 v226, v51, v45
    v_fmac_f32 v225, v150, v45
    v_fmac_f32 v227, v151, v45
    v_lshlrev_b32 v48, 16, v180
    v_lshlrev_b32 v49, 16, v181
    v_and_b32 v180, s8, v180
    v_and_b32 v181, s8, v181
L_bw14_3:
    s_waitcnt vmcnt(15)
    s_barrier
    s_bfe_u32 s12, s69, 0x4000c
    s_mul_i32 s12, s12, 393216
    s_add_u32 m0, s95, 16384
    s_nop 0
    buffer_load_dwordx4 v28, s[28:31], s12 offen offset:0 lds
    buffer_load_dwordx4 v29, s[28:31], s12 offen offset:1024 lds
    s_bfe_u32 s12, s69, 0x40010
    s_mul_i32 s12, s12, 393216
    s_add_u32 m0, s95, 57344
    s_nop 0
    buffer_load_dwordx4 v28, s[28:31], s12 offen offset:0 lds
    buffer_load_dwordx4 v29, s[28:31], s12 offen offset:1024 lds
    s_mul_i32 s12, s21, 16
    s_add_u32 s12, s12, 0
    s_and_b32 s90, s88, 1
    s_lshl_b32 s90, s90, 6
    s_xor_b32 s12, s12, s90
    s_lshl_b32 s12, s12, 14
    s_add_u32 s90, s12, 0
    buffer_load_dwordx4 v[84:87], v33, s[36:39], s90 offen
    s_add_u32 s90, s12, 16384
    buffer_load_dwordx4 v[88:91], v33, s[36:39], s90 offen
    s_add_u32 s90, s12, 32768
    buffer_load_dwordx4 v[92:95], v33, s[36:39], s90 offen
    s_add_u32 s90, s12, 49152
    buffer_load_dwordx4 v[96:99], v33, s[36:39], s90 offen
    s_add_u32 s90, s12, 65536
    buffer_load_dwordx4 v[100:103], v33, s[36:39], s90 offen
    s_add_u32 s90, s12, 81920
    buffer_load_dwordx4 v[116:119], v33, s[36:39], s90 offen
    s_add_u32 s90, s12, 98304
    buffer_load_dwordx4 v[120:123], v33, s[36:39], s90 offen
    s_add_u32 s90, s12, 114688
    buffer_load_dwordx4 v[124:127], v33, s[36:39], s90 offen
    s_add_u32 s90, s12, 131072
    buffer_load_dwordx4 v[64:67], v33, s[36:39], s90 offen
    v_fmac_f32 v228, v48, v45
    v_fmac_f32 v230, v49, v45
    v_fmac_f32 v229, v180, v45
    v_fmac_f32 v231, v181, v45
    v_lshlrev_b32 v50, 16, v182
    v_lshlrev_b32 v51, 16, v183
    v_and_b32 v182, s8, v182
    v_and_b32 v183, s8, v183
    v_fmac_f32 v232, v50, v45
    v_fmac_f32 v234, v51, v45
    v_fmac_f32 v233, v182, v45
    v_fmac_f32 v235, v183, v45
    v_lshlrev_b32 v48, 16, v152
    v_lshlrev_b32 v49, 16, v153
    v_and_b32 v152, s8, v152
    v_and_b32 v153, s8, v153
    v_fmac_f32 v220, v48, v46
    v_fmac_f32 v222, v49, v46
    v_fmac_f32 v221, v152, v46
    v_fmac_f32 v223, v153, v46
    v_lshlrev_b32 v50, 16, v154
    v_lshlrev_b32 v51, 16, v155
    v_and_b32 v154, s8, v154
    v_and_b32 v155, s8, v155
    v_fmac_f32 v224, v50, v46
L_bw15_3:
    s_waitcnt vmcnt(20)
    s_barrier
    v_fmac_f32 v226, v51, v46
    v_fmac_f32 v225, v154, v46
    v_fmac_f32 v227, v155, v46
    v_lshlrev_b32 v48, 16, v184
    v_lshlrev_b32 v49, 16, v185
    v_and_b32 v184, s8, v184
    v_and_b32 v185, s8, v185
    v_fmac_f32 v228, v48, v46
    v_fmac_f32 v230, v49, v46
    v_fmac_f32 v229, v184, v46
    v_fmac_f32 v231, v185, v46
    v_lshlrev_b32 v50, 16, v186
    v_lshlrev_b32 v51, 16, v187
    v_and_b32 v186, s8, v186
    v_and_b32 v187, s8, v187
    v_fmac_f32 v232, v50, v46
    v_fmac_f32 v234, v51, v46
    v_fmac_f32 v233, v186, v46
    v_fmac_f32 v235, v187, v46
    v_lshlrev_b32 v48, 16, v156
    v_lshlrev_b32 v49, 16, v157
    v_and_b32 v156, s8, v156
    v_and_b32 v157, s8, v157
    v_fmac_f32 v220, v48, v47
    v_fmac_f32 v222, v49, v47
    v_fmac_f32 v221, v156, v47
    v_fmac_f32 v223, v157, v47
    v_lshlrev_b32 v50, 16, v158
    v_lshlrev_b32 v51, 16, v159
    v_and_b32 v158, s8, v158
    v_and_b32 v159, s8, v159
    v_fmac_f32 v224, v50, v47
    v_fmac_f32 v226, v51, v47
    v_fmac_f32 v225, v158, v47
    v_fmac_f32 v227, v159, v47
    v_lshlrev_b32 v48, 16, v188
    v_lshlrev_b32 v49, 16, v189
    v_and_b32 v188, s8, v188
    v_and_b32 v189, s8, v189
    v_fmac_f32 v228, v48, v47
    v_fmac_f32 v230, v49, v47
    v_fmac_f32 v229, v188, v47
    v_fmac_f32 v231, v189, v47
    v_lshlrev_b32 v50, 16, v190
    v_lshlrev_b32 v51, 16, v191
    v_and_b32 v190, s8, v190
    v_and_b32 v191, s8, v191
    v_fmac_f32 v232, v50, v47
    v_fmac_f32 v234, v51, v47
    v_fmac_f32 v233, v190, v47
    v_fmac_f32 v235, v191, v47
    v_permlane32_swap_b32 v220, v228
    v_permlane32_swap_b32 v221, v229
    v_permlane32_swap_b32 v222, v230
    v_permlane32_swap_b32 v223, v231
    v_permlane32_swap_b32 v224, v232
    v_permlane32_swap_b32 v225, v233
    v_permlane32_swap_b32 v226, v234
    v_permlane32_swap_b32 v227, v235
    v_add_f32 v220, v220, v228
    v_add_f32 v221, v221, v229
    v_add_f32 v222, v222, v230
    v_add_f32 v223, v223, v231
    v_add_f32 v224, v224, v232
    v_add_f32 v225, v225, v233
    v_add_f32 v226, v226, v234
    v_add_f32 v227, v227, v235
    v_permlane16_swap_b32 v220, v224
    v_permlane16_swap_b32 v221, v225
    v_permlane16_swap_b32 v222, v226
    v_permlane16_swap_b32 v223, v227
    v_add_f32 v220, v220, v224
    v_add_f32 v221, v221, v225
    v_add_f32 v222, v222, v226
    v_add_f32 v223, v223, v227
    v_add_f32_dpp v220, v220, v220 row_ror:8 row_mask:0xf bank_mask:0xf
    v_add_f32_dpp v221, v221, v221 row_ror:8 row_mask:0xf bank_mask:0xf
    v_add_f32_dpp v222, v222, v222 row_ror:8 row_mask:0xf bank_mask:0xf
    v_add_f32_dpp v223, v223, v223 row_ror:8 row_mask:0xf bank_mask:0xf
    s_branch L_varend
.fill 411, 4, 0xbf800000
L_var4:
    s_nop 0
    s_waitcnt vmcnt(6)
    s_barrier
    s_add_u32 m0, s95, 73728
    s_nop 0
    buffer_load_dwordx4 v26, s[28:31], s93 offen offset:0 lds
    buffer_load_dwordx4 v27, s[28:31], s93 offen offset:1024 lds
    s_add_u32 m0, s95, 57344
    s_nop 0
    buffer_load_dwordx4 v28, s[28:31], s93 offen offset:0 lds
    buffer_load_dwordx4 v29, s[28:31], s93 offen offset:1024 lds
    s_bfe_u32 s91, s68, 0x40008
    s_lshl_b32 s92, s91, 7
    s_mul_i32 s93, s91, 393216
    s_add_u32 m0, s94, 81920
    s_nop 0
    buffer_load_dwordx4 v20, s[24:27], s92 offen offset:0 lds
    buffer_load_dwordx4 v21, s[24:27], s92 offen offset:1024 lds
    buffer_load_dwordx4 v22, s[24:27], s92 offen offset:2048 lds
    buffer_load_dwordx4 v23, s[24:27], s92 offen offset:3072 lds
    s_add_u32 m0, s95, 106496
    s_nop 0
    buffer_load_dwordx4 v24, s[28:31], s93 offen offset:0 lds
    buffer_load_dwordx4 v25, s[28:31], s93 offen offset:1024 lds
    s_add_u32 m0, s95, 114688
    s_nop 0
    buffer_load_dwordx4 v26, s[28:31], s93 offen offset:0 lds
    buffer_load_dwordx4 v27, s[28:31], s93 offen offset:1024 lds
    s_add_u32 m0, s95, 98304
    s_nop 0
    buffer_load_dwordx4 v28, s[28:31], s93 offen offset:0 lds
    buffer_load_dwordx4 v29, s[28:31], s93 offen offset:1024 lds
    s_lshl_b32 s12, s19, 2
    s_add_u32 s12, s12, s21
    s_lshl_b32 s12, s12, 10
    s_lshl_b32 s13, s21, 10
    s_add_u32 m0, s13, 155648
    s_nop 0
    buffer_load_dwordx4 v5, s[76:79], s12 offen lds
    s_lshl_b32 s12, s22, 11
    buffer_load_dwordx4 v[40:43], v5, s[24:27], s12 offen offset:0
    buffer_load_dwordx4 v[44:47], v5, s[24:27], s12 offen offset:1024
    buffer_load_dwordx4 v[48:51], v5, s[24:27], s12 offen offset:2048
    buffer_load_dwordx4 v[52:55], v5, s[24:27], s12 offen offset:3072
    buffer_load_dwordx4 v[56:59], v5, s[80:83], 0 offen offset:0
    buffer_load_dwordx4 v[60:63], v5, s[80:83], 0 offen offset:1024
    buffer_load_dwordx4 v[64:67], v5, s[84:87], 0 offen offset:0
    buffer_load_dwordx4 v[68:71], v5, s[84:87], 0 offen offset:1024
L_bw1_4:
    s_waitcnt vmcnt(19)
    s_barrier
    s_bfe_u32 s91, s68, 0x4000c
    s_lshl_b32 s92, s91, 7
    s_mul_i32 s93, s91, 393216
    s_add_u32 m0, s94, 0
    s_nop 0
    buffer_load_dwordx4 v20, s[24:27], s92 offen offset:0 lds
    s_waitcnt vmcnt(1)
    s_mov_b32 s8, 0xffff0000
    v_lshlrev_b32 v72, 16, v56
    v_and_b32 v56, s8, v56
    v_lshlrev_b32 v73, 16, v64
    v_and_b32 v64, s8, v64
    v_lshlrev_b32 v112, 16, v40
    buffer_load_dwordx4 v21, s[24:27], s92 offen offset:1024 lds
    v_and_b32 v40, s8, v40
    v_lshlrev_b32 v116, 16, v48
    v_and_b32 v48, s8, v48
    v_mul_f32 v113, v112, v73
    v_mul_f32 v114, v40, v64
    v_mul_f32 v90, v112, v72
    v_mul_f32 v117, v116, v73
    buffer_load_dwordx4 v22, s[24:27], s92 offen offset:2048 lds
    v_mul_f32 v118, v48, v64
    v_mul_f32 v92, v116, v72
    v_cvt_pk_bf16_f32 v113, 0, v113
    v_cvt_pk_bf16_f32 v114, 0, v114
    v_fmac_f32 v90, v40, v56
    v_cvt_pk_bf16_f32 v117, 0, v117
    v_cvt_pk_bf16_f32 v118, 0, v118
    buffer_load_dwordx4 v23, s[24:27], s92 offen offset:3072 lds
    v_fmac_f32 v92, v48, v56
    v_add_f32 v91, v113, v114
    v_add_f32 v93, v117, v118
    v_lshlrev_b32 v72, 16, v57
    v_and_b32 v57, s8, v57
    v_lshlrev_b32 v73, 16, v65
    v_and_b32 v65, s8, v65
    s_add_u32 m0, s95, 24576
    s_nop 0
    buffer_load_dwordx4 v24, s[28:31], s93 offen offset:0 lds
    v_lshlrev_b32 v112, 16, v41
    v_and_b32 v41, s8, v41
    v_lshlrev_b32 v116, 16, v49
    v_and_b32 v49, s8, v49
    v_mul_f32 v113, v112, v73
    v_mul_f32 v114, v41, v65
    v_fmac_f32 v90, v112, v72
    buffer_load_dwordx4 v25, s[28:31], s93 offen offset:1024 lds
    v_mul_f32 v117, v116, v73
    v_mul_f32 v118, v49, v65
    v_fmac_f32 v92, v116, v72
    v_cvt_pk_bf16_f32 v113, 0, v113
    v_cvt_pk_bf16_f32 v114, 0, v114
    v_fmac_f32 v90, v41, v57
    v_cvt_pk_bf16_f32 v117, 0, v117
    s_add_u32 m0, s95, 32768
    s_nop 0
    buffer_load_dwordx4 v26, s[28:31], s93 offen offset:0 lds
    v_cvt_pk_bf16_f32 v118, 0, v118
    v_fmac_f32 v92, v49, v57
    v_add_f32 v91, v91, v113
    v_add_f32 v93, v93, v117
    v_add_f32 v91, v91, v114
    v_add_f32 v93, v93, v118
    v_lshlrev_b32 v72, 16, v58
    buffer_load_dwordx4 v27, s[28:31], s93 offen offset:1024 lds
    v_and_b32 v58, s8, v58
    v_lshlrev_b32 v73, 16, v66
    v_and_b32 v66, s8, v66
    v_lshlrev_b32 v112, 16, v42
    v_and_b32 v42, s8, v42
    v_lshlrev_b32 v116, 16, v50
    v_and_b32 v50, s8, v50
    s_add_u32 m0, s95, 16384
    s_nop 0
    buffer_load_dwordx4 v28, s[28:31], s93 offen offset:0 lds
    v_mul_f32 v113, v112, v73
    v_mul_f32 v114, v42, v66
    v_fmac_f32 v90, v112, v72
    v_mul_f32 v117, v116, v73
    v_mul_f32 v118, v50, v66
    v_fmac_f32 v92, v116, v72
    v_cvt_pk_bf16_f32 v113, 0, v113
    buffer_load_dwordx4 v29, s[28:31], s93 offen offset:1024 lds
    v_cvt_pk_bf16_f32 v114, 0, v114
    v_fmac_f32 v90, v42, v58
    v_cvt_pk_bf16_f32 v117, 0, v117
    v_cvt_pk_bf16_f32 v118, 0, v118
    v_fmac_f32 v92, v50, v58
    v_add_f32 v91, v91, v113
    v_add_f32 v93, v93, v117
    s_cmp_lg_u32 s21, 0
    s_cbranch_scc1 L_noclr_4
    v_mov_b32 v104, -1
    v_mov_b32 v105, -1
    v_mov_b32 v106, -1
    v_mov_b32 v107, -1
    s_lshl_b32 s12, s19, 13
    s_lshl_b32 s13, s18, 9
    s_add_u32 s12, s12, s13
    s_add_u32 s12, s12, 32768
    s_lshl_b32 s13, s19, 11
    s_lshl_b32 s90, s18, 7
    s_add_u32 s13, s13, s90
    s_add_u32 s13, s13, 163840
    s_mov_b32 exec_hi, 0
    buffer_store_dwordx4 v[104:107], v5, s[32:35], s12 offen sc1
    s_mov_b32 exec_lo, 255
    buffer_store_dwordx4 v[104:107], v5, s[32:35], s13 offen sc1
    s_mov_b64 exec, -1
L_noclr_4:
    v_add_f32 v91, v91, v114
    v_add_f32 v93, v93, v118
    v_lshlrev_b32 v72, 16, v59
    v_and_b32 v59, s8, v59
    v_lshlrev_b32 v73, 16, v67
    v_and_b32 v67, s8, v67
    v_lshlrev_b32 v112, 16, v43
    v_and_b32 v43, s8, v43
    v_lshlrev_b32 v116, 16, v51
    v_and_b32 v51, s8, v51
    v_mul_f32 v113, v112, v73
    v_mul_f32 v114, v43, v67
    v_fmac_f32 v90, v112, v72
    v_mul_f32 v117, v116, v73
    v_mul_f32 v118, v51, v67
    v_fmac_f32 v92, v116, v72
    v_cvt_pk_bf16_f32 v113, 0, v113
    v_cvt_pk_bf16_f32 v114, 0, v114
    v_fmac_f32 v90, v43, v59
    v_cvt_pk_bf16_f32 v117, 0, v117
    v_cvt_pk_bf16_f32 v118, 0, v118
    v_fmac_f32 v92, v51, v59
    v_add_f32 v91, v91, v113
    v_add_f32 v93, v93, v117
    v_add_f32 v91, v91, v114
L_bw2_4:
    s_barrier
    s_bfe_u32 s91, s68, 0x40010
    s_lshl_b32 s92, s91, 7
    s_mul_i32 s93, s91, 393216
    s_add_u32 m0, s94, 40960
    s_nop 0
    buffer_load_dwordx4 v20, s[24:27], s92 offen offset:0 lds
    v_add_f32 v93, v93, v118
    v_lshlrev_b32 v72, 16, v60
    v_and_b32 v60, s8, v60
    v_lshlrev_b32 v73, 16, v68
    v_and_b32 v68, s8, v68
    v_lshlrev_b32 v112, 16, v44
    v_and_b32 v44, s8, v44
    buffer_load_dwordx4 v21, s[24:27], s92 offen offset:1024 lds
    v_lshlrev_b32 v116, 16, v52
    v_and_b32 v52, s8, v52
    v_mul_f32 v113, v112, v73
    v_mul_f32 v114, v44, v68
    v_fmac_f32 v90, v112, v72
    v_mul_f32 v117, v116, v73
    v_mul_f32 v118, v52, v68
    buffer_load_dwordx4 v22, s[24:27], s92 offen offset:2048 lds
    v_fmac_f32 v92, v116, v72
    v_cvt_pk_bf16_f32 v113, 0, v113
    v_cvt_pk_bf16_f32 v114, 0, v114
    v_fmac_f32 v90, v44, v60
    v_cvt_pk_bf16_f32 v117, 0, v117
    v_cvt_pk_bf16_f32 v118, 0, v118
    v_fmac_f32 v92, v52, v60
    buffer_load_dwordx4 v23, s[24:27], s92 offen offset:3072 lds
    v_add_f32 v91, v91, v113
    v_add_f32 v93, v93, v117
    v_add_f32 v91, v91, v114
    v_add_f32 v93, v93, v118
    v_lshlrev_b32 v72, 16, v61
    v_and_b32 v61, s8, v61
    v_lshlrev_b32 v73, 16, v69
    s_add_u32 m0, s95, 65536
    s_nop 0
    buffer_load_dwordx4 v24, s[28:31], s93 offen offset:0 lds
    v_and_b32 v69, s8, v69
    v_lshlrev_b32 v112, 16, v45
    v_and_b32 v45, s8, v45
    v_lshlrev_b32 v116, 16, v53
    v_and_b32 v53, s8, v53
    v_mul_f32 v113, v112, v73
    v_mul_f32 v114, v45, v69
    buffer_load_dwordx4 v25, s[28:31], s93 offen offset:1024 lds
    v_fmac_f32 v90, v112, v72
    v_mul_f32 v117, v116, v73
    v_mul_f32 v118, v53, v69
    v_fmac_f32 v92, v116, v72
    v_cvt_pk_bf16_f32 v113, 0, v113
    v_cvt_pk_bf16_f32 v114, 0, v114
    v_fmac_f32 v90, v45, v61
    s_add_u32 m0, s95, 73728
    s_nop 0
    buffer_load_dwordx4 v26, s[28:31], s93 offen offset:0 lds
    v_cvt_pk_bf16_f32 v117, 0, v117
    v_cvt_pk_bf16_f32 v118, 0, v118
    v_fmac_f32 v92, v53, v61
    v_add_f32 v91, v91, v113
    v_add_f32 v93, v93, v117
    v_add_f32 v91, v91, v114
    v_add_f32 v93, v93, v118
    buffer_load_dwordx4 v27, s[28:31], s93 offen offset:1024 lds
    v_lshlrev_b32 v72, 16, v62
    v_and_b32 v62, s8, v62
    v_lshlrev_b32 v73, 16, v70
    v_and_b32 v70, s8, v70
    v_lshlrev_b32 v112, 16, v46
    v_and_b32 v46, s8, v46
    v_lshlrev_b32 v116, 16, v54
    s_add_u32 m0, s95, 57344
    s_nop 0
    buffer_load_dwordx4 v28, s[28:31], s93 offen offset:0 lds
    v_and_b32 v54, s8, v54
    v_mul_f32 v113, v112, v73
    v_mul_f32 v114, v46, v70
    v_fmac_f32 v90, v112, v72
    v_mul_f32 v117, v116, v73
    v_mul_f32 v118, v54, v70
    v_fmac_f32 v92, v116, v72
    buffer_load_dwordx4 v29, s[28:31], s93 offen offset:1024 lds
    v_cvt_pk_bf16_f32 v113, 0, v113
    v_cvt_pk_bf16_f32 v114, 0, v114
    v_fmac_f32 v90, v46, v62
    v_cvt_pk_bf16_f32 v117, 0, v117
    v_cvt_pk_bf16_f32 v118, 0, v118
    v_fmac_f32 v92, v54, v62
    v_add_f32 v91, v91, v113
    buffer_load_dword v15, v13, s[72:75], 0 offen offset:4 sc1
    v_add_f32 v93, v93, v117
    v_add_f32 v91, v91, v114
    v_add_f32 v93, v93, v118
    v_lshlrev_b32 v72, 16, v63
    v_and_b32 v63, s8, v63
    v_lshlrev_b32 v73, 16, v71
    v_and_b32 v71, s8, v71
    v_lshlrev_b32 v112, 16, v47
    v_and_b32 v47, s8, v47
    v_lshlrev_b32 v116, 16, v55
    v_and_b32 v55, s8, v55
    v_mul_f32 v113, v112, v73
    v_mul_f32 v114, v47, v71
    v_fmac_f32 v90, v112, v72
    v_mul_f32 v117, v116, v73
    v_mul_f32 v118, v55, v71
    v_fmac_f32 v92, v116, v72
    v_cvt_pk_bf16_f32 v113, 0, v113
    v_cvt_pk_bf16_f32 v114, 0, v114
    v_fmac_f32 v90, v47, v63
    v_cvt_pk_bf16_f32 v117, 0, v117
    v_cvt_pk_bf16_f32 v118, 0, v118
    v_fmac_f32 v92, v55, v63
    v_add_f32 v91, v91, v113
    v_add_f32 v93, v93, v117
L_bw3_4:
    s_waitcnt vmcnt(11)
    s_barrier
    s_bfe_u32 s91, s68, 0x40014
    s_lshl_b32 s92, s91, 7
    s_mul_i32 s93, s91, 393216
    s_add_u32 m0, s94, 81920
    s_nop 0
    buffer_load_dwordx4 v20, s[24:27], s92 offen offset:0 lds
    v_add_f32 v91, v91, v114
    v_add_f32 v93, v93, v118
    v_add_f32_dpp v90, v90, v90 row_shr:1 row_mask:0xf bank_mask:0xf
    v_add_f32_dpp v91, v91, v91 row_shr:1 row_mask:0xf bank_mask:0xf
    v_add_f32_dpp v92, v92, v92 row_shr:1 row_mask:0xf bank_mask:0xf
    v_add_f32_dpp v93, v93, v93 row_shr:1 row_mask:0xf bank_mask:0xf
    v_add_f32_dpp v90, v90, v90 row_shr:2 row_mask:0xf bank_mask:0xf
    buffer_load_dwordx4 v21, s[24:27], s92 offen offset:1024 lds
    v_add_f32_dpp v91, v91, v91 row_shr:2 row_mask:0xf bank_mask:0xf
    v_add_f32_dpp v92, v92, v92 row_shr:2 row_mask:0xf bank_mask:0xf
    v_add_f32_dpp v93, v93, v93 row_shr:2 row_mask:0xf bank_mask:0xf
    v_add_f32_dpp v90, v90, v90 row_shr:4 row_mask:0xf bank_mask:0xf
    v_add_f32_dpp v91, v91, v91 row_shr:4 row_mask:0xf bank_mask:0xf
    v_add_f32_dpp v92, v92, v92 row_shr:4 row_mask:0xf bank_mask:0xf
    v_add_f32_dpp v93, v93, v93 row_shr:4 row_mask:0xf bank_mask:0xf
    buffer_load_dwordx4 v22, s[24:27], s92 offen offset:2048 lds
    v_add_f32_dpp v90, v90, v90 row_shr:8 row_mask:0xf bank_mask:0xf
    v_add_f32_dpp v91, v91, v91 row_shr:8 row_mask:0xf bank_mask:0xf
    v_add_f32_dpp v92, v92, v92 row_shr:8 row_mask:0xf bank_mask:0xf
    v_add_f32_dpp v93, v93, v93 row_shr:8 row_mask:0xf bank_mask:0xf
    v_add_f32_dpp v90, v90, v90 row_bcast:15 row_mask:0xa bank_mask:0xf
    v_add_f32_dpp v91, v91, v91 row_bcast:15 row_mask:0xa bank_mask:0xf
    v_add_f32_dpp v92, v92, v92 row_bcast:15 row_mask:0xa bank_mask:0xf
    buffer_load_dwordx4 v23, s[24:27], s92 offen offset:3072 lds
    v_add_f32_dpp v93, v93, v93 row_bcast:15 row_mask:0xa bank_mask:0xf
    v_add_f32_dpp v90, v90, v90 row_bcast:31 row_mask:0xc bank_mask:0xf
    v_add_f32_dpp v91, v91, v91 row_bcast:31 row_mask:0xc bank_mask:0xf
    v_add_f32_dpp v92, v92, v92 row_bcast:31 row_mask:0xc bank_mask:0xf
    v_add_f32_dpp v93, v93, v93 row_bcast:31 row_mask:0xc bank_mask:0xf
    v_mov_b32 v97, 0x8000
    v_mov_b32 v98, 0xffff
    s_add_u32 m0, s95, 106496
    s_nop 0
    buffer_load_dwordx4 v24, s[28:31], s93 offen offset:0 lds
    v_cvt_pk_bf16_f32 v94, v90, v91
    v_cvt_pk_bf16_f32 v104, v92, v93
    v_and_b32 v95, 0xffff, v94
    v_and_b32 v96, 0x8000, v94
    v_and_b32 v94, 0xffff0000, v94
    v_cmp_ne_u32 vcc, 0, v96
    v_mul_f32 v94, 0xbfb8aa3b, v94
    buffer_load_dwordx4 v25, s[28:31], s93 offen offset:1024 lds
    v_exp_f32 v94, v94
    v_cndmask_b32 v96, v97, v98, vcc
    v_xor_b32 v95, v95, v96
    v_add_f32 v94, 1.0, v94
    v_lshlrev_b32 v95, 11, v95
    v_rcp_f32 v94, v94
    s_sub_u32 s12, 2047, s22
    v_or_b32 v100, s12, v95
    s_add_u32 m0, s95, 114688
    s_nop 0
    buffer_load_dwordx4 v26, s[28:31], s93 offen offset:0 lds
    v_cvt_pk_bf16_f32 v94, v94, v94
    v_lshlrev_b32 v102, 16, v94
    v_and_b32 v105, 0xffff, v104
    v_and_b32 v106, 0x8000, v104
    v_and_b32 v104, 0xffff0000, v104
    v_cmp_ne_u32 vcc, 0, v106
    v_mul_f32 v104, 0xbfb8aa3b, v104
    buffer_load_dwordx4 v27, s[28:31], s93 offen offset:1024 lds
    v_exp_f32 v104, v104
    v_cndmask_b32 v106, v97, v98, vcc
    v_xor_b32 v105, v105, v106
    v_add_f32 v104, 1.0, v104
    v_lshlrev_b32 v105, 11, v105
    v_rcp_f32 v104, v104
    s_sub_u32 s12, 2046, s22
    v_or_b32 v101, s12, v105
    s_add_u32 m0, s95, 98304
    s_nop 0
    buffer_load_dwordx4 v28, s[28:31], s93 offen offset:0 lds
    v_cvt_pk_bf16_f32 v104, v104, v104
    v_lshlrev_b32 v103, 16, v104
    v_max_u32 v100, v100, v101
    s_lshl_b32 s12, s22, 2
    s_add_u32 s12, s12, 4096
    s_lshl_b32 s13, s21, 2
    s_add_u32 s13, s13, 162880
    v_mov_b32 v14, s13
    s_mov_b32 exec_lo, 0
    s_mov_b32 exec_hi, 0x80000000
    buffer_store_dwordx2 v[102:103], v13, s[32:35], s12 offen sc1
    ds_write_b32 v14, v100
    s_mov_b64 exec, -1
    s_waitcnt lgkmcnt(0)
    buffer_load_dwordx4 v29, s[28:31], s93 offen offset:1024 lds
L_bw4_4:
    s_waitcnt vmcnt(12)
    s_barrier
    s_bfe_u32 s91, s68, 0x40018
    s_lshl_b32 s92, s91, 7
    s_mul_i32 s93, s91, 393216
    s_add_u32 m0, s94, 0
    s_nop 0
    buffer_load_dwordx4 v20, s[24:27], s92 offen offset:0 lds
    buffer_load_dwordx4 v21, s[24:27], s92 offen offset:1024 lds
    buffer_load_dwordx4 v22, s[24:27], s92 offen offset:2048 lds
    buffer_load_dwordx4 v23, s[24:27], s92 offen offset:3072 lds
    s_add_u32 m0, s95, 24576
    s_nop 0
    buffer_load_dwordx4 v24, s[28:31], s93 offen offset:0 lds
    buffer_load_dwordx4 v25, s[28:31], s93 offen offset:1024 lds
    s_add_u32 m0, s95, 32768
    s_nop 0
    buffer_load_dwordx4 v26, s[28:31], s93 offen offset:0 lds
    buffer_load_dwordx4 v27, s[28:31], s93 offen offset:1024 lds
    s_add_u32 m0, s95, 16384
    s_nop 0
    buffer_load_dwordx4 v28, s[28:31], s93 offen offset:0 lds
    buffer_load_dwordx4 v29, s[28:31], s93 offen offset:1024 lds
    s_cmp_ge_u32 s10, 224
    s_cbranch_scc1 L_p30_4
    s_add_u32 s12, s71, 0
    buffer_load_dwordx4 v[128:131], v30, s[40:43], s12 offen nt
    s_add_u32 s12, s71, 7168
    buffer_load_dwordx4 v[132:135], v30, s[40:43], s12 offen nt
    s_add_u32 s12, s71, 14336
    buffer_load_dwordx4 v[136:139], v30, s[40:43], s12 offen nt
    s_add_u32 s12, s71, 21504
    buffer_load_dwordx4 v[140:143], v30, s[40:43], s12 offen nt
    s_add_u32 s12, s71, 28672
    buffer_load_dwordx4 v[144:147], v30, s[40:43], s12 offen nt
    s_add_u32 s12, s71, 35840
    buffer_load_dwordx4 v[148:151], v30, s[40:43], s12 offen nt
    s_add_u32 s12, s71, 43008
    buffer_load_dwordx4 v[152:155], v30, s[40:43], s12 offen nt
    s_add_u32 s12, s71, 50176
    buffer_load_dwordx4 v[156:159], v30, s[40:43], s12 offen nt
    s_branch L_p3e0_4
L_p30_4:
    s_mov_b64 exec, 63
    s_bfe_u32 s12, s68, 0x4000c
    s_mul_i32 s12, s12, 393216
    buffer_load_dword v128, v32, s[28:31], s12 offen
    s_bfe_u32 s12, s68, 0x40010
    s_mul_i32 s12, s12, 393216
    buffer_load_dword v132, v32, s[28:31], s12 offen
    s_bfe_u32 s12, s68, 0x40014
    s_mul_i32 s12, s12, 393216
    buffer_load_dword v136, v32, s[28:31], s12 offen
    s_bfe_u32 s12, s68, 0x40018
    s_mul_i32 s12, s12, 393216
    buffer_load_dword v140, v32, s[28:31], s12 offen
    s_bfe_u32 s12, s68, 0x4001c
    s_mul_i32 s12, s12, 393216
    buffer_load_dword v144, v32, s[28:31], s12 offen
    s_bfe_u32 s12, s69, 0x40000
    s_mul_i32 s12, s12, 393216
    buffer_load_dword v148, v32, s[28:31], s12 offen
    s_bfe_u32 s12, s69, 0x40004
    s_mul_i32 s12, s12, 393216
    buffer_load_dword v152, v32, s[28:31], s12 offen
    s_bfe_u32 s12, s69, 0x40008
    s_mul_i32 s12, s12, 393216
    buffer_load_dword v156, v32, s[28:31], s12 offen
    s_mov_b64 exec, -1
L_p3e0_4:
    s_waitcnt vmcnt(19)
L_bw5_4:
    s_waitcnt vmcnt(18)
    s_barrier
    s_bfe_u32 s91, s68, 0x4001c
    s_lshl_b32 s92, s91, 7
    s_mul_i32 s93, s91, 393216
    s_add_u32 m0, s94, 40960
    s_nop 0
    buffer_load_dwordx4 v20, s[24:27], s92 offen offset:0 lds
    buffer_load_dwordx4 v21, s[24:27], s92 offen offset:1024 lds
    buffer_load_dwordx4 v22, s[24:27], s92 offen offset:2048 lds
    buffer_load_dwordx4 v23, s[24:27], s92 offen offset:3072 lds
    s_add_u32 m0, s95, 65536
    s_nop 0
    buffer_load_dwordx4 v24, s[28:31], s93 offen offset:0 lds
    s_mov_b32 s13, 0
L_tagchk_4:
    v_readfirstlane_b32 s23, v15
    s_nop 1
    s_cmp_lg_u32 s23, 0
    s_cbranch_scc1 L_tagok_4
    s_add_u32 s13, s13, 1
    s_cmp_ge_u32 s13, 16384
    s_cbranch_scc1 L_tagok_4
    buffer_load_dword v15, v13, s[72:75], 0 offen offset:4 sc1
    s_waitcnt vmcnt(0)
    s_branch L_tagchk_4
L_tagok_4:
    s_and_b32 s76, s23, 0xff
    s_bfe_u32 s77, s23, 0x80008
    s_bfe_u32 s78, s23, 0x80010
    s_lshr_b32 s79, s23, 24
    v_and_b32 v35, 3, v2
    v_lshlrev_b32 v35, 3, v35
    v_bfe_u32 v35, s23, v35, 8
    s_cmp_lg_u32 s21, 0
    s_cbranch_scc1 L_nopub_4
    v_mov_b32 v14, 162880
    ds_read_b128 v[104:107], v14
    s_lshl_b32 s12, s2, 3
    s_add_u32 s12, s12, 0
    s_waitcnt lgkmcnt(0)
    v_max3_u32 v104, v104, v105, v106
    v_max_u32 v104, v104, v107
    v_mov_b32 v105, s23
    s_mov_b64 exec, 1
    buffer_store_dwordx2 v[104:105], v13, s[32:35], s12 offen sc1
    s_mov_b64 exec, -1
L_nopub_4:
L_bw6_4:
    s_waitcnt vmcnt(13)
    s_barrier
    s_add_u32 m0, s95, 65536
    s_nop 0
    buffer_load_dwordx4 v25, s[28:31], s93 offen offset:1024 lds
    s_add_u32 m0, s95, 73728
    s_nop 0
    buffer_load_dwordx4 v26, s[28:31], s93 offen offset:0 lds
    buffer_load_dwordx4 v27, s[28:31], s93 offen offset:1024 lds
    s_add_u32 m0, s95, 57344
    s_nop 0
    buffer_load_dwordx4 v28, s[28:31], s93 offen offset:0 lds
    buffer_load_dwordx4 v29, s[28:31], s93 offen offset:1024 lds
    s_bfe_u32 s91, s69, 0x40000
    s_lshl_b32 s92, s91, 7
    s_mul_i32 s93, s91, 393216
    s_add_u32 m0, s94, 81920
    s_nop 0
    buffer_load_dwordx4 v20, s[24:27], s92 offen offset:0 lds
    buffer_load_dwordx4 v21, s[24:27], s92 offen offset:1024 lds
    buffer_load_dwordx4 v22, s[24:27], s92 offen offset:2048 lds
    buffer_load_dwordx4 v23, s[24:27], s92 offen offset:3072 lds
    s_add_u32 m0, s95, 106496
    s_nop 0
    buffer_load_dwordx4 v24, s[28:31], s93 offen offset:0 lds
    buffer_load_dwordx4 v25, s[28:31], s93 offen offset:1024 lds
    s_add_u32 m0, s95, 114688
    s_nop 0
    buffer_load_dwordx4 v26, s[28:31], s93 offen offset:0 lds
L_bw7_4:
    s_waitcnt vmcnt(7)
    s_barrier
    s_add_u32 m0, s95, 114688
    s_nop 0
    buffer_load_dwordx4 v27, s[28:31], s93 offen offset:1024 lds
    s_add_u32 m0, s95, 98304
    s_nop 0
    buffer_load_dwordx4 v28, s[28:31], s93 offen offset:0 lds
    buffer_load_dwordx4 v29, s[28:31], s93 offen offset:1024 lds
    s_bfe_u32 s91, s69, 0x40004
    s_lshl_b32 s92, s91, 7
    s_mul_i32 s93, s91, 393216
    s_add_u32 m0, s94, 0
    s_nop 0
    buffer_load_dwordx4 v20, s[24:27], s92 offen offset:0 lds
    buffer_load_dwordx4 v21, s[24:27], s92 offen offset:1024 lds
    buffer_load_dwordx4 v22, s[24:27], s92 offen offset:2048 lds
    buffer_load_dwordx4 v23, s[24:27], s92 offen offset:3072 lds
    s_add_u32 m0, s95, 24576
    s_nop 0
    buffer_load_dwordx4 v24, s[28:31], s93 offen offset:0 lds
    buffer_load_dwordx4 v25, s[28:31], s93 offen offset:1024 lds
    s_add_u32 m0, s95, 32768
    s_nop 0
    buffer_load_dwordx4 v26, s[28:31], s93 offen offset:0 lds
    buffer_load_dwordx4 v27, s[28:31], s93 offen offset:1024 lds
    s_add_u32 m0, s95, 16384
    s_nop 0
    buffer_load_dwordx4 v28, s[28:31], s93 offen offset:0 lds
L_bw8_4:
    s_waitcnt vmcnt(9)
    s_barrier
    s_add_u32 m0, s95, 16384
    s_nop 0
    buffer_load_dwordx4 v29, s[28:31], s93 offen offset:1024 lds
    s_bfe_u32 s91, s69, 0x40008
    s_lshl_b32 s92, s91, 7
    s_mul_i32 s93, s91, 393216
    s_add_u32 m0, s94, 40960
    s_nop 0
    buffer_load_dwordx4 v20, s[24:27], s92 offen offset:0 lds
    buffer_load_dwordx4 v21, s[24:27], s92 offen offset:1024 lds
    buffer_load_dwordx4 v22, s[24:27], s92 offen offset:2048 lds
    buffer_load_dwordx4 v23, s[24:27], s92 offen offset:3072 lds
    s_add_u32 m0, s95, 65536
    s_nop 0
    buffer_load_dwordx4 v24, s[28:31], s93 offen offset:0 lds
    buffer_load_dwordx4 v25, s[28:31], s93 offen offset:1024 lds
    s_add_u32 m0, s95, 73728
    s_nop 0
    buffer_load_dwordx4 v26, s[28:31], s93 offen offset:0 lds
    buffer_load_dwordx4 v27, s[28:31], s93 offen offset:1024 lds
    s_add_u32 m0, s95, 57344
    s_nop 0
    buffer_load_dwordx4 v28, s[28:31], s93 offen offset:0 lds
    buffer_load_dwordx4 v29, s[28:31], s93 offen offset:1024 lds
L_bw9_4:
    s_waitcnt vmcnt(10)
    s_barrier
    s_bfe_u32 s91, s69, 0x4000c
    s_lshl_b32 s92, s91, 7
    s_mul_i32 s93, s91, 393216
    s_add_u32 m0, s94, 122880
    s_nop 0
    buffer_load_dwordx4 v20, s[24:27], s92 offen offset:0 lds
    buffer_load_dwordx4 v21, s[24:27], s92 offen offset:1024 lds
    buffer_load_dwordx4 v22, s[24:27], s92 offen offset:2048 lds
    buffer_load_dwordx4 v23, s[24:27], s92 offen offset:3072 lds
    s_add_u32 m0, s95, 106496
    s_nop 0
    buffer_load_dwordx4 v24, s[28:31], s93 offen offset:0 lds
    buffer_load_dwordx4 v25, s[28:31], s93 offen offset:1024 lds
    s_add_u32 m0, s95, 114688
    s_nop 0
    buffer_load_dwordx4 v26, s[28:31], s93 offen offset:0 lds
    buffer_load_dwordx4 v27, s[28:31], s93 offen offset:1024 lds
    s_cmp_ge_u32 s10, 224
    s_cbranch_scc1 L_p31_4
    s_add_u32 s12, s9, 0
    buffer_load_dwordx4 v[160:163], v30, s[44:47], s12 offen nt
    s_add_u32 s12, s9, 7168
    buffer_load_dwordx4 v[164:167], v30, s[44:47], s12 offen nt
    s_add_u32 s12, s9, 14336
    buffer_load_dwordx4 v[168:171], v30, s[44:47], s12 offen nt
    s_add_u32 s12, s9, 21504
    buffer_load_dwordx4 v[172:175], v30, s[44:47], s12 offen nt
    s_add_u32 s12, s9, 28672
    buffer_load_dwordx4 v[176:179], v30, s[44:47], s12 offen nt
    s_add_u32 s12, s9, 35840
    buffer_load_dwordx4 v[180:183], v30, s[44:47], s12 offen nt
    s_add_u32 s12, s9, 43008
    buffer_load_dwordx4 v[184:187], v30, s[44:47], s12 offen nt
    s_add_u32 s12, s9, 50176
    buffer_load_dwordx4 v[188:191], v30, s[44:47], s12 offen nt
    s_branch L_p3e1_4
L_p31_4:
    s_mov_b64 exec, 63
    s_bfe_u32 s12, s69, 0x4000c
    s_mul_i32 s12, s12, 393216
    buffer_load_dword v160, v32, s[28:31], s12 offen
    s_bfe_u32 s12, s69, 0x40010
    s_mul_i32 s12, s12, 393216
    buffer_load_dword v164, v32, s[28:31], s12 offen
    s_bfe_u32 s12, s69, 0x40014
    s_mul_i32 s12, s12, 393216
    buffer_load_dword v168, v32, s[28:31], s12 offen
    s_bfe_u32 s12, s69, 0x40018
    s_mul_i32 s12, s12, 393216
    buffer_load_dword v172, v32, s[28:31], s12 offen
    s_bfe_u32 s12, s69, 0x4001c
    s_mul_i32 s12, s12, 393216
    buffer_load_dword v176, v32, s[28:31], s12 offen
    s_mov_b64 exec, 1
    s_bfe_u32 s12, s69, 0x4001c
    s_mul_i32 s12, s12, 393216
    buffer_load_dword v180, v32, s[28:31], s12 offen
    s_bfe_u32 s12, s69, 0x4001c
    s_mul_i32 s12, s12, 393216
    buffer_load_dword v184, v32, s[28:31], s12 offen
    s_bfe_u32 s12, s69, 0x4001c
    s_mul_i32 s12, s12, 393216
    buffer_load_dword v188, v32, s[28:31], s12 offen
    s_mov_b64 exec, -1
L_p3e1_4:
    s_mov_b32 exec_lo, 0xffff0000
    s_mov_b32 exec_hi, 0
    buffer_load_dword v19, v10, s[36:39], 0 offen
    s_mov_b64 exec, -1
    s_mov_b32 s12, 0
    buffer_load_dwordx4 v[104:107], v5, s[32:35], s12 offen offset:0 sc1
    buffer_load_dwordx4 v[108:111], v5, s[32:35], s12 offen offset:1024 sc1
L_bw10_4:
    s_waitcnt vmcnt(19)
    s_barrier
    s_bfe_u32 s91, s69, 0x40010
    s_lshl_b32 s92, s91, 7
    s_mul_i32 s93, s91, 393216
    s_add_u32 m0, s94, 139264
    s_nop 0
    buffer_load_dwordx4 v20, s[24:27], s92 offen offset:0 lds
    buffer_load_dwordx4 v21, s[24:27], s92 offen offset:1024 lds
    buffer_load_dwordx4 v22, s[24:27], s92 offen offset:2048 lds
    buffer_load_dwordx4 v23, s[24:27], s92 offen offset:3072 lds
    s_add_u32 m0, s95, 24576
    s_nop 0
    buffer_load_dwordx4 v24, s[28:31], s93 offen offset:0 lds
L_bw11_4:
    s_waitcnt vmcnt(16)
    s_barrier
    s_add_u32 m0, s95, 24576
    s_nop 0
    buffer_load_dwordx4 v25, s[28:31], s93 offen offset:1024 lds
    s_waitcnt vmcnt(6)
    s_mov_b32 s13, 0
    v_xor_b32 v105, s23, v105
    v_xor_b32 v107, s23, v107
    v_xor_b32 v109, s23, v109
    v_xor_b32 v111, s23, v111
    v_or3_b32 v105, v105, v107, v109
    v_or_b32 v105, v105, v111
    v_cmp_ne_u32 vcc, 0, v105
    s_cbranch_vccnz L_keyre_4
L_keyok_4:
    s_add_u32 m0, s95, 32768
    s_nop 0
    buffer_load_dwordx4 v26, s[28:31], s93 offen offset:0 lds
    v_max3_u32 v104, v104, v106, v108
    v_max_u32 v104, v104, v110
    s_nop 1
    v_max_u32_dpp v104, v104, v104 row_shr:1 row_mask:0xf bank_mask:0xf
    s_nop 1
    v_max_u32_dpp v104, v104, v104 row_shr:2 row_mask:0xf bank_mask:0xf
    s_nop 1
    v_max_u32_dpp v104, v104, v104 row_shr:4 row_mask:0xf bank_mask:0xf
    s_nop 1
    v_max_u32_dpp v104, v104, v104 row_shr:8 row_mask:0xf bank_mask:0xf
    s_nop 1
    v_max_u32_dpp v104, v104, v104 row_bcast:15 row_mask:0xa bank_mask:0xf
    s_nop 1
    v_max_u32_dpp v104, v104, v104 row_bcast:31 row_mask:0xc bank_mask:0xf
    s_nop 0
    v_readlane_b32 s14, v104, 63
    s_nop 1
    s_and_b32 s15, s14, 2047
    s_sub_u32 s15, 2047, s15
    s_lshl_b32 s12, s15, 11
    s_lshl_b32 s13, s70, 1
    s_add_u32 s12, s12, s13
    buffer_load_dwordx4 v[36:39], v34, s[24:27], s12 offen
    s_lshr_b32 s12, s14, 11
    s_and_b32 s13, s12, 0x8000
    s_cmp_lg_u32 s13, 0
    s_mov_b32 s13, 0xffff
    s_cselect_b32 s13, 0x8000, s13
    s_xor_b32 s12, s12, s13
    s_lshl_b32 s12, s12, 16
    v_mov_b32 v105, s12
    buffer_load_dwordx4 v27, s[28:31], s93 offen offset:1024 lds
    v_mul_f32 v105, 0xbfb8aa3b, v105
    v_exp_f32 v105, v105
    s_nop 0
    v_add_f32 v105, 1.0, v105
    v_rcp_f32 v105, v105
    s_nop 0
    v_cvt_pk_bf16_f32 v105, v105, v105
    v_lshlrev_b32 v105, 16, v105
    s_add_u32 s12, s15, 1
    v_mov_b32 v104, s12
    v_mov_b32 v106, s23
    v_readfirstlane_b32 s14, v105
    v_mov_b32 v14, 162864
    s_mov_b64 exec, 1
    ds_write_b96 v14, v[104:106]
    s_mov_b64 exec, -1
    s_waitcnt lgkmcnt(0)
    s_bfe_u32 s91, s69, 0x40014
    s_lshl_b32 s92, s91, 7
    s_mul_i32 s93, s91, 393216
    s_add_u32 m0, s94, 40960
    s_nop 0
    buffer_load_dwordx4 v20, s[24:27], s92 offen offset:0 lds
    buffer_load_dwordx4 v21, s[24:27], s92 offen offset:1024 lds
    buffer_load_dwordx4 v22, s[24:27], s92 offen offset:2048 lds
    buffer_load_dwordx4 v23, s[24:27], s92 offen offset:3072 lds
    s_add_u32 m0, s95, 65536
    s_nop 0
    buffer_load_dwordx4 v24, s[28:31], s93 offen offset:0 lds
    buffer_load_dwordx4 v25, s[28:31], s93 offen offset:1024 lds
    s_add_u32 m0, s95, 73728
    s_nop 0
    buffer_load_dwordx4 v26, s[28:31], s93 offen offset:0 lds
L_bw12_4:
    s_waitcnt vmcnt(7)
    s_barrier
    s_add_u32 m0, s95, 73728
    s_nop 0
    buffer_load_dwordx4 v27, s[28:31], s93 offen offset:1024 lds
    s_mov_b32 s8, 0xffff0000
    v_lshlrev_b32 v40, 16, v36
    v_and_b32 v41, s8, v36
    v_lshlrev_b32 v42, 16, v37
    v_and_b32 v43, s8, v37
    v_lshlrev_b32 v44, 16, v38
    v_and_b32 v45, s8, v38
    v_lshlrev_b32 v46, 16, v39
    v_and_b32 v47, s8, v39
    v_lshlrev_b32 v48, 16, v128
    v_lshlrev_b32 v49, 16, v129
    v_and_b32 v128, s8, v128
    v_and_b32 v129, s8, v129
    s_bfe_u32 s91, s69, 0x40018
    s_lshl_b32 s92, s91, 7
    s_mul_i32 s93, s91, 393216
    s_add_u32 m0, s94, 81920
    s_nop 0
    buffer_load_dwordx4 v20, s[24:27], s92 offen offset:0 lds
    v_mul_f32 v220, v48, v40
    v_mul_f32 v222, v49, v40
    v_mul_f32 v221, v128, v40
    v_mul_f32 v223, v129, v40
    v_lshlrev_b32 v50, 16, v130
    v_lshlrev_b32 v51, 16, v131
    v_and_b32 v130, s8, v130
    buffer_load_dwordx4 v21, s[24:27], s92 offen offset:1024 lds
    v_and_b32 v131, s8, v131
    v_mul_f32 v224, v50, v40
    v_mul_f32 v226, v51, v40
    v_mul_f32 v225, v130, v40
    v_mul_f32 v227, v131, v40
    v_lshlrev_b32 v48, 16, v160
    v_lshlrev_b32 v49, 16, v161
    buffer_load_dwordx4 v22, s[24:27], s92 offen offset:2048 lds
    v_and_b32 v160, s8, v160
    v_and_b32 v161, s8, v161
    v_mul_f32 v228, v48, v40
    v_mul_f32 v230, v49, v40
    v_mul_f32 v229, v160, v40
    v_mul_f32 v231, v161, v40
    v_lshlrev_b32 v50, 16, v162
    buffer_load_dwordx4 v23, s[24:27], s92 offen offset:3072 lds
    v_lshlrev_b32 v51, 16, v163
    v_and_b32 v162, s8, v162
    v_and_b32 v163, s8, v163
    v_mul_f32 v232, v50, v40
    v_mul_f32 v234, v51, v40
    v_mul_f32 v233, v162, v40
    v_mul_f32 v235, v163, v40
    s_add_u32 m0, s95, 106496
    s_nop 0
    buffer_load_dwordx4 v24, s[28:31], s93 offen offset:0 lds
    v_lshlrev_b32 v48, 16, v132
    v_lshlrev_b32 v49, 16, v133
    v_and_b32 v132, s8, v132
    v_and_b32 v133, s8, v133
    v_fmac_f32 v220, v48, v41
    v_fmac_f32 v222, v49, v41
    v_fmac_f32 v221, v132, v41
    buffer_load_dwordx4 v25, s[28:31], s93 offen offset:1024 lds
    v_fmac_f32 v223, v133, v41
    v_lshlrev_b32 v50, 16, v134
    v_lshlrev_b32 v51, 16, v135
    v_and_b32 v134, s8, v134
    v_and_b32 v135, s8, v135
    v_fmac_f32 v224, v50, v41
    v_fmac_f32 v226, v51, v41
    s_add_u32 m0, s95, 114688
    s_nop 0
    buffer_load_dwordx4 v26, s[28:31], s93 offen offset:0 lds
    v_fmac_f32 v225, v134, v41
    v_fmac_f32 v227, v135, v41
    v_lshlrev_b32 v48, 16, v164
    v_lshlrev_b32 v49, 16, v165
    v_and_b32 v164, s8, v164
    v_and_b32 v165, s8, v165
    v_fmac_f32 v228, v48, v41
    v_fmac_f32 v230, v49, v41
    v_fmac_f32 v229, v164, v41
    v_fmac_f32 v231, v165, v41
    v_lshlrev_b32 v50, 16, v166
    v_lshlrev_b32 v51, 16, v167
    v_and_b32 v166, s8, v166
    v_and_b32 v167, s8, v167
    buffer_load_dwordx4 v27, s[28:31], s93 offen offset:1024 lds
    v_fmac_f32 v232, v50, v41
    v_fmac_f32 v234, v51, v41
    v_fmac_f32 v233, v166, v41
    v_fmac_f32 v235, v167, v41
    v_lshlrev_b32 v48, 16, v136
    v_lshlrev_b32 v49, 16, v137
    v_and_b32 v136, s8, v136
    v_and_b32 v137, s8, v137
    v_fmac_f32 v220, v48, v42
    v_fmac_f32 v222, v49, v42
    v_fmac_f32 v221, v136, v42
    v_fmac_f32 v223, v137, v42
    v_lshlrev_b32 v50, 16, v138
    v_lshlrev_b32 v51, 16, v139
    v_and_b32 v138, s8, v138
    v_and_b32 v139, s8, v139
    v_fmac_f32 v224, v50, v42
    v_fmac_f32 v226, v51, v42
    v_fmac_f32 v225, v138, v42
    v_fmac_f32 v227, v139, v42
    v_lshlrev_b32 v48, 16, v168
    v_lshlrev_b32 v49, 16, v169
    v_and_b32 v168, s8, v168
    v_and_b32 v169, s8, v169
    v_fmac_f32 v228, v48, v42
    v_fmac_f32 v230, v49, v42
    v_fmac_f32 v229, v168, v42
    v_fmac_f32 v231, v169, v42
    v_lshlrev_b32 v50, 16, v170
    v_lshlrev_b32 v51, 16, v171
    v_and_b32 v170, s8, v170
    v_and_b32 v171, s8, v171
    v_fmac_f32 v232, v50, v42
    v_fmac_f32 v234, v51, v42
    v_fmac_f32 v233, v170, v42
    v_fmac_f32 v235, v171, v42
    v_lshlrev_b32 v48, 16, v140
    v_lshlrev_b32 v49, 16, v141
    v_and_b32 v140, s8, v140
L_bw13_4:
    s_waitcnt vmcnt(8)
    s_barrier
    s_bfe_u32 s91, s69, 0x4001c
    s_lshl_b32 s92, s91, 7
    s_mul_i32 s93, s91, 393216
    s_add_u32 m0, s94, 0
    s_nop 0
    buffer_load_dwordx4 v20, s[24:27], s92 offen offset:0 lds
    v_and_b32 v141, s8, v141
    v_fmac_f32 v220, v48, v43
    v_fmac_f32 v222, v49, v43
    v_fmac_f32 v221, v140, v43
    v_fmac_f32 v223, v141, v43
    v_lshlrev_b32 v50, 16, v142
    v_lshlrev_b32 v51, 16, v143
    buffer_load_dwordx4 v21, s[24:27], s92 offen offset:1024 lds
    v_and_b32 v142, s8, v142
    v_and_b32 v143, s8, v143
    v_fmac_f32 v224, v50, v43
    v_fmac_f32 v226, v51, v43
    v_fmac_f32 v225, v142, v43
    v_fmac_f32 v227, v143, v43
    v_lshlrev_b32 v48, 16, v172
    buffer_load_dwordx4 v22, s[24:27], s92 offen offset:2048 lds
    v_lshlrev_b32 v49, 16, v173
    v_and_b32 v172, s8, v172
    v_and_b32 v173, s8, v173
    v_fmac_f32 v228, v48, v43
    v_fmac_f32 v230, v49, v43
    v_fmac_f32 v229, v172, v43
    v_fmac_f32 v231, v173, v43
    buffer_load_dwordx4 v23, s[24:27], s92 offen offset:3072 lds
    v_lshlrev_b32 v50, 16, v174
    v_lshlrev_b32 v51, 16, v175
    v_and_b32 v174, s8, v174
    v_and_b32 v175, s8, v175
    v_fmac_f32 v232, v50, v43
    v_fmac_f32 v234, v51, v43
    v_fmac_f32 v233, v174, v43
    s_add_u32 m0, s95, 24576
    s_nop 0
    buffer_load_dwordx4 v24, s[28:31], s93 offen offset:0 lds
    v_fmac_f32 v235, v175, v43
    v_lshlrev_b32 v48, 16, v144
    v_lshlrev_b32 v49, 16, v145
    v_and_b32 v144, s8, v144
    v_and_b32 v145, s8, v145
    v_fmac_f32 v220, v48, v44
    v_fmac_f32 v222, v49, v44
    buffer_load_dwordx4 v25, s[28:31], s93 offen offset:1024 lds
    v_fmac_f32 v221, v144, v44
    v_fmac_f32 v223, v145, v44
    v_lshlrev_b32 v50, 16, v146
    v_lshlrev_b32 v51, 16, v147
    v_and_b32 v146, s8, v146
    v_and_b32 v147, s8, v147
    v_fmac_f32 v224, v50, v44
    s_add_u32 m0, s95, 32768
    s_nop 0
    buffer_load_dwordx4 v26, s[28:31], s93 offen offset:0 lds
    v_fmac_f32 v226, v51, v44
    v_fmac_f32 v225, v146, v44
    v_fmac_f32 v227, v147, v44
    v_lshlrev_b32 v48, 16, v176
    v_lshlrev_b32 v49, 16, v177
    v_and_b32 v176, s8, v176
    v_and_b32 v177, s8, v177
    v_fmac_f32 v228, v48, v44
    v_fmac_f32 v230, v49, v44
    v_fmac_f32 v229, v176, v44
    v_fmac_f32 v231, v177, v44
    v_lshlrev_b32 v50, 16, v178
    v_lshlrev_b32 v51, 16, v179
    v_and_b32 v178, s8, v178
    buffer_load_dwordx4 v27, s[28:31], s93 offen offset:1024 lds
    v_and_b32 v179, s8, v179
    v_fmac_f32 v232, v50, v44
    v_fmac_f32 v234, v51, v44
    v_fmac_f32 v233, v178, v44
    v_fmac_f32 v235, v179, v44
    v_lshlrev_b32 v48, 16, v148
    v_lshlrev_b32 v49, 16, v149
    v_and_b32 v148, s8, v148
    v_and_b32 v149, s8, v149
    v_fmac_f32 v220, v48, v45
    v_fmac_f32 v222, v49, v45
    v_fmac_f32 v221, v148, v45
    v_fmac_f32 v223, v149, v45
    v_lshlrev_b32 v50, 16, v150
    v_lshlrev_b32 v51, 16, v151
    v_and_b32 v150, s8, v150
    v_and_b32 v151, s8, v151
    v_fmac_f32 v224, v50, v45
    v_fmac_f32 v226, v51, v45
    v_fmac_f32 v225, v150, v45
    v_fmac_f32 v227, v151, v45
    v_lshlrev_b32 v48, 16, v180
    v_lshlrev_b32 v49, 16, v181
    v_and_b32 v180, s8, v180
    v_and_b32 v181, s8, v181
    v_fmac_f32 v228, v48, v45
    v_fmac_f32 v230, v49, v45
    v_fmac_f32 v229, v180, v45
    v_fmac_f32 v231, v181, v45
    v_lshlrev_b32 v50, 16, v182
    v_lshlrev_b32 v51, 16, v183
    v_and_b32 v182, s8, v182
    v_and_b32 v183, s8, v183
    v_fmac_f32 v232, v50, v45
    v_fmac_f32 v234, v51, v45
    v_fmac_f32 v233, v182, v45
    v_fmac_f32 v235, v183, v45
    v_lshlrev_b32 v48, 16, v152
    v_lshlrev_b32 v49, 16, v153
L_bw14_4:
    s_waitcnt vmcnt(8)
    s_barrier
    s_add_u32 s12, s97, 0
    buffer_load_dwordx4 v[192:195], v31, s[64:67], s12 offen nt
    s_add_u32 s12, s97, 16384
    buffer_load_dwordx4 v[196:199], v31, s[64:67], s12 offen nt
    s_add_u32 s12, s97, 32768
    buffer_load_dwordx4 v[200:203], v31, s[64:67], s12 offen nt
    s_add_u32 s12, s97, 49152
    buffer_load_dwordx4 v[204:207], v31, s[64:67], s12 offen nt
    s_add_u32 s12, s97, 65536
    buffer_load_dwordx4 v[208:211], v31, s[64:67], s12 offen nt
    s_add_u32 s12, s97, 81920
    buffer_load_dwordx4 v[212:215], v31, s[64:67], s12 offen nt
    s_add_u32 s12, s97, 98304
    buffer_load_dwordx4 v[216:219], v31, s[64:67], s12 offen nt
    s_bfe_u32 s12, s69, 0x4000c
    s_mul_i32 s12, s12, 393216
    s_add_u32 m0, s95, 16384
    s_nop 0
    buffer_load_dwordx4 v28, s[28:31], s12 offen offset:0 lds
    buffer_load_dwordx4 v29, s[28:31], s12 offen offset:1024 lds
    s_bfe_u32 s12, s69, 0x40010
    s_mul_i32 s12, s12, 393216
    s_add_u32 m0, s95, 57344
    s_nop 0
    buffer_load_dwordx4 v28, s[28:31], s12 offen offset:0 lds
    buffer_load_dwordx4 v29, s[28:31], s12 offen offset:1024 lds
    s_mul_i32 s12, s21, 16
    s_add_u32 s12, s12, 0
    s_and_b32 s90, s88, 1
    s_lshl_b32 s90, s90, 6
    s_xor_b32 s12, s12, s90
    s_lshl_b32 s12, s12, 14
    s_add_u32 s90, s12, 0
    buffer_load_dwordx4 v[84:87], v33, s[36:39], s90 offen
    s_add_u32 s90, s12, 16384
    buffer_load_dwordx4 v[88:91], v33, s[36:39], s90 offen
    s_add_u32 s90, s12, 32768
    buffer_load_dwordx4 v[92:95], v33, s[36:39], s90 offen
    s_add_u32 s90, s12, 49152
    buffer_load_dwordx4 v[96:99], v33, s[36:39], s90 offen
    s_add_u32 s90, s12, 65536
    buffer_load_dwordx4 v[100:103], v33, s[36:39], s90 offen
    s_add_u32 s90, s12, 81920
    buffer_load_dwordx4 v[116:119], v33, s[36:39], s90 offen
    s_add_u32 s90, s12, 98304
    buffer_load_dwordx4 v[120:123], v33, s[36:39], s90 offen
    s_add_u32 s90, s12, 114688
    buffer_load_dwordx4 v[124:127], v33, s[36:39], s90 offen
    s_add_u32 s90, s12, 131072
    buffer_load_dwordx4 v[64:67], v33, s[36:39], s90 offen
    v_and_b32 v152, s8, v152
    v_and_b32 v153, s8, v153
    v_fmac_f32 v220, v48, v46
    v_fmac_f32 v222, v49, v46
    v_fmac_f32 v221, v152, v46
    v_fmac_f32 v223, v153, v46
    v_lshlrev_b32 v50, 16, v154
    v_lshlrev_b32 v51, 16, v155
    v_and_b32 v154, s8, v154
    v_and_b32 v155, s8, v155
    v_fmac_f32 v224, v50, v46
    v_fmac_f32 v226, v51, v46
    v_fmac_f32 v225, v154, v46
    v_fmac_f32 v227, v155, v46
    v_lshlrev_b32 v48, 16, v184
    v_lshlrev_b32 v49, 16, v185
    v_and_b32 v184, s8, v184
    v_and_b32 v185, s8, v185
    v_fmac_f32 v228, v48, v46
    v_fmac_f32 v230, v49, v46
    v_fmac_f32 v229, v184, v46
    v_fmac_f32 v231, v185, v46
    v_lshlrev_b32 v50, 16, v186
    v_lshlrev_b32 v51, 16, v187
    v_and_b32 v186, s8, v186
L_bw15_4:
    s_waitcnt vmcnt(20)
    s_barrier
    v_and_b32 v187, s8, v187
    v_fmac_f32 v232, v50, v46
    v_fmac_f32 v234, v51, v46
    v_fmac_f32 v233, v186, v46
    v_fmac_f32 v235, v187, v46
    v_lshlrev_b32 v48, 16, v156
    v_lshlrev_b32 v49, 16, v157
    v_and_b32 v156, s8, v156
    v_and_b32 v157, s8, v157
    v_fmac_f32 v220, v48, v47
    v_fmac_f32 v222, v49, v47
    v_fmac_f32 v221, v156, v47
    v_fmac_f32 v223, v157, v47
    v_lshlrev_b32 v50, 16, v158
    v_lshlrev_b32 v51, 16, v159
    v_and_b32 v158, s8, v158
    v_and_b32 v159, s8, v159
    v_fmac_f32 v224, v50, v47
    v_fmac_f32 v226, v51, v47
    v_fmac_f32 v225, v158, v47
    v_fmac_f32 v227, v159, v47
    v_lshlrev_b32 v48, 16, v188
    v_lshlrev_b32 v49, 16, v189
    v_and_b32 v188, s8, v188
    v_and_b32 v189, s8, v189
    v_fmac_f32 v228, v48, v47
    v_fmac_f32 v230, v49, v47
    v_fmac_f32 v229, v188, v47
    v_fmac_f32 v231, v189, v47
    v_lshlrev_b32 v50, 16, v190
    v_lshlrev_b32 v51, 16, v191
    v_and_b32 v190, s8, v190
    v_and_b32 v191, s8, v191
    v_fmac_f32 v232, v50, v47
    v_fmac_f32 v234, v51, v47
    v_fmac_f32 v233, v190, v47
    v_fmac_f32 v235, v191, v47
    v_permlane32_swap_b32 v220, v228
    v_permlane32_swap_b32 v221, v229
    v_permlane32_swap_b32 v222, v230
    v_permlane32_swap_b32 v223, v231
    v_permlane32_swap_b32 v224, v232
    v_permlane32_swap_b32 v225, v233
    v_permlane32_swap_b32 v226, v234
    v_permlane32_swap_b32 v227, v235
    v_add_f32 v220, v220, v228
    v_add_f32 v221, v221, v229
    v_add_f32 v222, v222, v230
    v_add_f32 v223, v223, v231
    v_add_f32 v224, v224, v232
    v_add_f32 v225, v225, v233
    v_add_f32 v226, v226, v234
    v_add_f32 v227, v227, v235
    v_permlane16_swap_b32 v220, v224
    v_permlane16_swap_b32 v221, v225
    v_permlane16_swap_b32 v222, v226
    v_permlane16_swap_b32 v223, v227
    v_add_f32 v220, v220, v224
    v_add_f32 v221, v221, v225
    v_add_f32 v222, v222, v226
    v_add_f32 v223, v223, v227
    v_add_f32_dpp v220, v220, v220 row_ror:8 row_mask:0xf bank_mask:0xf
    v_add_f32_dpp v221, v221, v221 row_ror:8 row_mask:0xf bank_mask:0xf
    v_add_f32_dpp v222, v222, v222 row_ror:8 row_mask:0xf bank_mask:0xf
    v_add_f32_dpp v223, v223, v223 row_ror:8 row_mask:0xf bank_mask:0xf
    s_branch L_varend
.fill 260, 4, 0xbf800000
L_varend:
    s_nop 0
    v_lshrrev_b32 v14, 5, v2
    v_lshlrev_b32 v14, 8, v14
    v_lshl_add_u32 v14, v6, 5, v14
    v_and_b32 v16, 16, v2
    v_add_u32 v14, v14, v16
    s_lshl_b32 s12, s21, 9
    s_add_u32 s12, s12, 159744
    v_add_u32 v14, s12, v14
    ds_write_b128 v14, v[220:223]
    v_mov_b32 v14, 162848
    v_mov_b32 v16, 1
    s_mov_b64 exec, 1
    ds_add_rtn_u32 v17, v14, v16
    s_mov_b64 exec, -1
    s_waitcnt lgkmcnt(0)
    v_readfirstlane_b32 s12, v17
    s_nop 1
    s_cmp_lg_u32 s12, 3
    s_cbranch_scc1 L_nogu
    s_cmp_ge_u32 s10, 224
    s_cbranch_scc1 L_nogu
    v_lshlrev_b32 v14, 2, v2
    v_add_u32 v14, 159744, v14
    ds_read2st64_b32 v[220:221], v14 offset0:0 offset1:1
    ds_read2st64_b32 v[222:223], v14 offset0:2 offset1:3
    ds_read2st64_b32 v[224:225], v14 offset0:4 offset1:5
    ds_read2st64_b32 v[226:227], v14 offset0:6 offset1:7
    s_and_b32 s12, s10, 3
    s_mul_i32 s12, s12, 28672
    s_lshr_b32 s13, s10, 2
    s_lshl_b32 s13, s13, 8
    s_add_u32 s12, s12, 327680
    s_xor_b32 s90, s13, 1024
    s_add_u32 s90, s90, s12
    s_add_u32 s90, s90, 14336
    s_add_u32 s12, s12, s13
    v_lshlrev_b32 v14, 2, v2
    v_and_b32 v16, 1, v2
    v_lshlrev_b32 v16, 4, v16
    v_lshrrev_b32 v16, v16, s23
    v_bfe_u32 v17, v16, 8, 8
    v_and_b32 v16, 0xff, v16
    s_mov_b32 s13, 0xffffff00
    s_waitcnt lgkmcnt(0)
    v_pk_add_f32 v[220:221], v[220:221], v[222:223]
    v_pk_add_f32 v[224:225], v[224:225], v[226:227]
    v_pk_add_f32 v[220:221], v[220:221], v[224:225]
    v_and_or_b32 v220, v220, s13, v16
    v_and_or_b32 v221, v221, s13, v17
    buffer_store_dword v220, v14, s[32:35], s12 offen sc1
    buffer_store_dword v221, v14, s[32:35], s90 offen sc1
L_nogu:
    s_bfe_u32 s12, s69, 0x40014
    s_mul_i32 s12, s12, 393216
    s_add_u32 m0, s95, 65536
    s_nop 0
    buffer_load_dwordx4 v28, s[28:31], s12 offen offset:0 lds
    buffer_load_dwordx4 v29, s[28:31], s12 offen offset:1024 lds
    s_bfe_u32 s12, s69, 0x40018
    s_mul_i32 s12, s12, 393216
    s_add_u32 m0, s95, 73728
    s_nop 0
    buffer_load_dwordx4 v28, s[28:31], s12 offen offset:0 lds
    buffer_load_dwordx4 v29, s[28:31], s12 offen offset:1024 lds
    s_mul_i32 s12, s21, 16
    s_add_u32 s12, s12, 0
    s_and_b32 s90, s88, 1
    s_lshl_b32 s90, s90, 6
    s_xor_b32 s12, s12, s90
    s_lshl_b32 s12, s12, 14
    s_add_u32 s90, s12, 147456
    buffer_load_dwordx4 v[68:71], v33, s[36:39], s90 offen
    s_add_u32 s90, s12, 163840
    buffer_load_dwordx4 v[72:75], v33, s[36:39], s90 offen
    s_add_u32 s90, s12, 180224
    buffer_load_dwordx4 v[236:239], v33, s[36:39], s90 offen
    s_add_u32 s90, s12, 196608
    buffer_load_dwordx4 v[240:243], v33, s[36:39], s90 offen
    s_add_u32 s90, s12, 212992
    buffer_load_dwordx4 v[244:247], v33, s[36:39], s90 offen
    s_add_u32 s90, s12, 229376
    buffer_load_dwordx4 v[248:251], v33, s[36:39], s90 offen
    s_add_u32 s90, s12, 245760
    buffer_load_dwordx4 v[252:255], v33, s[36:39], s90 offen
    s_mul_i32 s12, s21, 4
    s_add_u32 s12, s12, 64
    s_and_b32 s90, s88, 1
    s_lshl_b32 s90, s90, 6
    s_xor_b32 s12, s12, s90
    s_lshl_b32 s12, s12, 14
    s_add_u32 s90, s12, 0
    buffer_load_dwordx4 v[220:223], v33, s[36:39], s90 offen
    s_add_u32 s90, s12, 16384
    buffer_load_dwordx4 v[224:227], v33, s[36:39], s90 offen
    s_add_u32 s90, s12, 32768
    buffer_load_dwordx4 v[228:231], v33, s[36:39], s90 offen
    s_add_u32 s90, s12, 49152
    buffer_load_dwordx4 v[232:235], v33, s[36:39], s90 offen
    v_mov_b32 v14, 162816
    s_mov_b32 s13, 0
L_dspin_g:
    ds_read_b128 v[104:107], v14
    s_add_u32 s13, s13, 1
    s_cmp_ge_u32 s13, 262144
    s_cbranch_scc1 L_dok_g
    s_waitcnt lgkmcnt(0)
    v_and_b32 v104, v104, v105
    v_and_b32 v106, v106, v107
    v_and_b32 v104, v104, v106
    v_cmp_eq_u32 vcc, 1, v104
    s_cbranch_vccz L_dspin_g
L_dok_g:
    s_waitcnt lgkmcnt(0)
    s_bfe_u32 s12, s69, 0x4001c
    s_mul_i32 s12, s12, 393216
    s_add_u32 m0, s95, 24576
    s_nop 0
    buffer_load_dwordx4 v28, s[28:31], s12 offen offset:0 lds
    buffer_load_dwordx4 v29, s[28:31], s12 offen offset:1024 lds
    s_cmp_eq_u32 s21, 0
    s_cbranch_scc1 L_nowrx
    s_mul_i32 s12, s21, 16
    s_add_u32 s12, s12, 64
    s_and_b32 s90, s88, 1
    s_lshl_b32 s90, s90, 6
    s_xor_b32 s12, s12, s90
    s_lshl_b32 s12, s12, 14
    s_add_u32 s90, s12, 0
    buffer_load_dwordx4 v[128:131], v33, s[36:39], s90 offen
    s_add_u32 s90, s12, 16384
    buffer_load_dwordx4 v[132:135], v33, s[36:39], s90 offen
    s_add_u32 s90, s12, 32768
    buffer_load_dwordx4 v[136:139], v33, s[36:39], s90 offen
    s_add_u32 s90, s12, 49152
    buffer_load_dwordx4 v[140:143], v33, s[36:39], s90 offen
    s_add_u32 s90, s12, 65536
    buffer_load_dwordx4 v[144:147], v33, s[36:39], s90 offen
    s_add_u32 s90, s12, 81920
    buffer_load_dwordx4 v[148:151], v33, s[36:39], s90 offen
    s_add_u32 s90, s12, 98304
    buffer_load_dwordx4 v[152:155], v33, s[36:39], s90 offen
    s_add_u32 s90, s12, 114688
    buffer_load_dwordx4 v[156:159], v33, s[36:39], s90 offen
    s_add_u32 s90, s12, 131072
    buffer_load_dwordx4 v[160:163], v33, s[36:39], s90 offen
    s_add_u32 s90, s12, 147456
    buffer_load_dwordx4 v[164:167], v33, s[36:39], s90 offen
    s_add_u32 s90, s12, 163840
    buffer_load_dwordx4 v[168:171], v33, s[36:39], s90 offen
    s_add_u32 s90, s12, 180224
    buffer_load_dwordx4 v[172:175], v33, s[36:39], s90 offen
    s_add_u32 s90, s12, 196608
    buffer_load_dwordx4 v[176:179], v33, s[36:39], s90 offen
    s_add_u32 s90, s12, 212992
    buffer_load_dwordx4 v[180:183], v33, s[36:39], s90 offen
    s_add_u32 s90, s12, 229376
    buffer_load_dwordx4 v[184:187], v33, s[36:39], s90 offen
    s_add_u32 s90, s12, 245760
    buffer_load_dwordx4 v[188:191], v33, s[36:39], s90 offen
L_nowrx:
    v_mov_b32 v62, v6
    v_mov_b32 v63, v35
    s_mov_b32 s86, s96
    s_mov_b32 s4, s15
    s_mov_b32 s5, s14
    v_mov_b32 v61, v33
    s_mov_b32 s68, s58
    s_and_b32 s69, s59, 0xffff
    s_mov_b32 s70, 4194304
    s_mov_b32 s71, 0x00020000
    s_and_b32 s90, s20, 3
    s_lshr_b32 s91, s20, 2
    s_lshl_b32 s12, s88, 3
    s_lshl_b32 s13, s90, 1
    s_add_u32 s12, s12, s13
    s_add_u32 s92, s12, s91
    s_lshl_b32 s12, s92, 4
    v_and_b32 v3, 15, v2
    v_add_u32 v6, s12, v3
    v_lshlrev_b32 v8, 2, v6
    v_bfe_u32 v9, v2, 4, 1
    v_lshrrev_b32 v10, 5, v2
    v_lshlrev_b32 v7, 11, v6
    v_lshl_add_u32 v7, v9, 6, v7
    v_lshl_add_u32 v7, v10, 4, v7
    s_lshl_b32 s12, s89, 7
    v_add_u32 v7, s12, v7
    s_mov_b32 s12, 4096
    buffer_load_dwordx4 v[24:27], v7, s[24:27], 0 offen
    buffer_load_dwordx4 v[28:31], v7, s[24:27], 0 offen offset:32
    buffer_load_dword v48, v8, s[32:35], s12 offen sc1
    v_lshlrev_b32 v22, 8, v3
    v_lshl_add_u32 v22, v9, 7, v22
    v_lshl_add_u32 v22, v10, 5, v22
    v_lshlrev_b32 v10, 9, v10
    v_bfe_u32 v11, v2, 2, 2
    v_lshl_add_u32 v10, v11, 7, v10
    v_bfe_u32 v11, v2, 3, 1
    v_lshl_add_u32 v10, v11, 6, v10
    v_lshl_add_u32 v10, v9, 5, v10
    v_and_b32 v11, 3, v2
    v_lshl_add_u32 v10, v11, 3, v10
    v_xor_b32 v11, 64, v10
    s_lshl_b32 s12, s91, 8
    v_xor_b32 v17, s12, v5
    v_lshlrev_b32 v8, 2, v3
    s_lshl_b32 s12, s20, 12
    s_mov_b32 s15, 32768
    s_cmp_lt_u32 s20, 6
    s_cselect_b32 s13, s15, 131072
    s_add_u32 s12, s12, s13
    v_add_u32 v20, s12, v5
    s_xor_b32 s14, s20, 4
    s_lshl_b32 s12, s14, 12
    s_cmp_lt_u32 s14, 6
    s_cselect_b32 s13, s15, 131072
    s_add_u32 s12, s12, s13
    v_add_u32 v21, s12, v5
    s_lshl_b32 s12, s88, 2
    s_add_u32 s12, s12, s90
    s_lshl_b32 s13, s12, 16
    s_lshl_b32 s14, s91, 15
    s_add_u32 s13, s13, s14
    s_add_u32 s95, s13, 8388608
    s_lshl_b32 s12, s88, 12
    s_lshl_b32 s13, s89, 8
    s_mul_i32 s13, s13, 1
    s_add_u32 s12, s12, s13
    s_lshr_b32 s13, s90, 1
    s_lshl_b32 s13, s13, 7
    s_add_u32 s12, s12, s13
    s_lshl_b32 s13, s91, 6
    s_add_u32 s12, s12, s13
    s_add_u32 s15, s12, 524288
    s_lshl_b32 s97, s91, 4
    v_lshlrev_b32 v8, 7, v3
    s_lshl_b32 s12, s88, 1
    s_lshr_b32 s13, s90, 1
    s_add_u32 s12, s12, s13
    s_lshl_b32 s12, s12, 12
    s_lshl_b32 s13, s91, 11
    s_add_u32 s12, s12, s13
    s_and_b32 s13, s89, 0
    s_lshl_b32 s13, s13, 17
    s_add_u32 s12, s12, s13
    s_add_u32 s15, s12, 6291456
    s_mov_b32 s93, s89
    s_lshl_b32 s12, s21, 2
    s_add_u32 s12, s12, 162960
    v_mov_b32 v78, s12
    v_mov_b32 v79, 1
    s_cmp_eq_u32 s21, 0
    s_cbranch_scc1 L_wqw0
    s_waitcnt vmcnt(19)
    s_branch L_wqw1
L_wqw0:
    s_waitcnt vmcnt(3)
L_wqw1:
    s_mov_b64 exec, 1
    ds_write_b32 v78, v79
    s_mov_b64 exec, -1
    s_cmp_lg_u32 s21, 0
    s_cbranch_scc0 L_hop
    s_waitcnt vmcnt(0)
    v_sub_f32 v50, 1.0, v48
    v_cvt_pk_bf16_f32 v50, v50, v50
    v_lshlrev_b32 v50, 16, v50
    v_lshlrev_b32 v32, 16, v24
    v_and_b32 v33, 0xffff0000, v24
    v_lshlrev_b32 v34, 16, v25
    v_and_b32 v35, 0xffff0000, v25
    v_lshlrev_b32 v36, 16, v26
    v_and_b32 v37, 0xffff0000, v26
    v_lshlrev_b32 v38, 16, v27
    v_and_b32 v39, 0xffff0000, v27
    v_lshlrev_b32 v40, 16, v28
    v_and_b32 v41, 0xffff0000, v28
    v_lshlrev_b32 v42, 16, v29
    v_and_b32 v43, 0xffff0000, v29
    v_lshlrev_b32 v44, 16, v30
    v_and_b32 v45, 0xffff0000, v30
    v_lshlrev_b32 v46, 16, v31
    v_and_b32 v47, 0xffff0000, v31
    v_pk_mul_f32 v[32:33], v[32:33], v[50:51] op_sel_hi:[1,0]
    v_pk_mul_f32 v[34:35], v[34:35], v[50:51] op_sel_hi:[1,0]
    v_pk_mul_f32 v[36:37], v[36:37], v[50:51] op_sel_hi:[1,0]
    v_pk_mul_f32 v[38:39], v[38:39], v[50:51] op_sel_hi:[1,0]
    v_pk_mul_f32 v[40:41], v[40:41], v[50:51] op_sel_hi:[1,0]
    v_pk_mul_f32 v[42:43], v[42:43], v[50:51] op_sel_hi:[1,0]
    v_pk_mul_f32 v[44:45], v[44:45], v[50:51] op_sel_hi:[1,0]
    v_pk_mul_f32 v[46:47], v[46:47], v[50:51] op_sel_hi:[1,0]
    v_cvt_pk_bf16_f32 v33, v32, v33
    v_cvt_pk_bf16_f32 v35, v34, v35
    v_cvt_pk_bf16_f32 v37, v36, v37
    v_cvt_pk_bf16_f32 v39, v38, v39
    v_cvt_pk_bf16_f32 v41, v40, v41
    v_cvt_pk_bf16_f32 v43, v42, v43
    v_cvt_pk_bf16_f32 v45, v44, v45
    v_cvt_pk_bf16_f32 v47, v46, v47
    v_permlane32_swap_b32 v33, v37
    v_permlane32_swap_b32 v35, v39
    v_permlane32_swap_b32 v41, v45
    v_permlane32_swap_b32 v43, v47
    v_lshlrev_b32 v32, 16, v33
    v_and_b32 v33, 0xffff0000, v33
    v_lshlrev_b32 v34, 16, v35
    v_and_b32 v35, 0xffff0000, v35
    v_lshlrev_b32 v36, 16, v37
    v_and_b32 v37, 0xffff0000, v37
    v_lshlrev_b32 v38, 16, v39
    v_and_b32 v39, 0xffff0000, v39
    v_lshlrev_b32 v40, 16, v41
    v_and_b32 v41, 0xffff0000, v41
    v_lshlrev_b32 v42, 16, v43
    v_and_b32 v43, 0xffff0000, v43
    v_lshlrev_b32 v44, 16, v45
    v_and_b32 v45, 0xffff0000, v45
    v_lshlrev_b32 v46, 16, v47
    v_and_b32 v47, 0xffff0000, v47
    v_mov_b32 v78, 162928
    s_mov_b32 s13, 0
L_gtu:
    ds_read_b128 v[104:107], v78
    s_add_u32 s13, s13, 1
    s_cmp_ge_u32 s13, 262144
    s_cbranch_scc1 L_gxu
    s_waitcnt lgkmcnt(0)
    v_and_b32 v104, v104, v105
    v_and_b32 v106, v106, v107
    v_and_b32 v104, v104, v106
    v_cmp_eq_u32 vcc, 1, v104
    s_cbranch_vccz L_gtu
L_gxu:
    s_waitcnt lgkmcnt(0)
    s_branch L_nohop
L_hop:
    v_mov_b32 v78, 162992
    s_mov_b32 s13, 0
L_gth:
    ds_read_b128 v[104:107], v78
    s_add_u32 s13, s13, 1
    s_cmp_ge_u32 s13, 262144
    s_cbranch_scc1 L_gxh
    s_waitcnt lgkmcnt(0)
    v_and_b32 v104, v104, v105
    v_and_b32 v106, v106, v107
    v_and_b32 v104, v104, v106
    v_cmp_eq_u32 vcc, 1, v104
    s_cbranch_vccz L_gth
L_gxh:
    s_waitcnt lgkmcnt(0)
    s_lshl_b32 s12, s19, 18
    s_lshl_b32 s13, s18, 14
    s_add_u32 s12, s12, s13
    s_add_u32 s80, s12, 1048576
    s_add_u32 s81, s80, 4096
    s_add_u32 s82, s80, 8192
    s_add_u32 s83, s80, 12288
    s_mov_b32 s13, 0
    s_lshl_b32 s12, s19, 13
    s_lshr_b32 s84, s18, 2
    s_lshl_b32 s84, s84, 11
    s_add_u32 s12, s12, s84
    s_bfe_u32 s84, s18, 0x10001
    s_lshl_b32 s84, s84, 6
    s_add_u32 s12, s12, s84
    s_and_b32 s84, s18, 1
    s_lshl_b32 s84, s84, 4
    s_add_u32 s12, s12, s84
    s_add_u32 s84, s12, 5242880
    v_and_b32 v80, 15, v2
    v_lshlrev_b32 v80, 7, v80
    v_lshrrev_b32 v78, 5, v2
    v_lshl_add_u32 v80, v78, 5, v80
    s_mov_b32 s87, 1
    s_mov_b32 s85, 0xffff
L_h1:
    buffer_load_dwordx4 v[104:107], v80, s[32:35], s84 offen sc1
    s_add_u32 s13, s13, 1
    s_cmp_ge_u32 s13, 16384
    s_cbranch_scc1 L_h1ok
    s_cmp_lg_u32 s87, 0
    s_cbranch_scc1 L_h1d
    s_waitcnt vmcnt(0)
    v_msad_u8 v108, v104, s76, 0
    v_msad_u8 v108, v105, s77, v108
    v_msad_u8 v108, v106, s78, v108
    v_msad_u8 v108, v107, s79, v108
    v_cmp_ne_u32 vcc, 0, v108
    s_nop 1
    s_or_b32 s12, vcc_lo, vcc_hi
    s_and_b32 s12, s12, 0xffff
    s_bcnt1_i32_b32 s12, s12
    s_cmp_le_u32 s12, 6
    s_cselect_b32 s87, 1, 0
    s_branch L_h1
L_h1d:
    s_bitcmp1_b32 s85, 0
    s_cselect_b64 exec, -1, 0
    buffer_load_dwordx4 v[128:131], v5, s[32:35], s80 offen offset:0 sc1
    s_bitcmp1_b32 s85, 1
    s_cselect_b64 exec, -1, 0
    buffer_load_dwordx4 v[132:135], v5, s[32:35], s80 offen offset:1024 sc1
    s_bitcmp1_b32 s85, 2
    s_cselect_b64 exec, -1, 0
    buffer_load_dwordx4 v[136:139], v5, s[32:35], s80 offen offset:2048 sc1
    s_bitcmp1_b32 s85, 3
    s_cselect_b64 exec, -1, 0
    buffer_load_dwordx4 v[140:143], v5, s[32:35], s80 offen offset:3072 sc1
    s_bitcmp1_b32 s85, 4
    s_cselect_b64 exec, -1, 0
    buffer_load_dwordx4 v[144:147], v5, s[32:35], s81 offen offset:0 sc1
    s_bitcmp1_b32 s85, 5
    s_cselect_b64 exec, -1, 0
    buffer_load_dwordx4 v[148:151], v5, s[32:35], s81 offen offset:1024 sc1
    s_bitcmp1_b32 s85, 6
    s_cselect_b64 exec, -1, 0
    buffer_load_dwordx4 v[152:155], v5, s[32:35], s81 offen offset:2048 sc1
    s_bitcmp1_b32 s85, 7
    s_cselect_b64 exec, -1, 0
    buffer_load_dwordx4 v[156:159], v5, s[32:35], s81 offen offset:3072 sc1
    s_bitcmp1_b32 s85, 8
    s_cselect_b64 exec, -1, 0
    buffer_load_dwordx4 v[160:163], v5, s[32:35], s82 offen offset:0 sc1
    s_bitcmp1_b32 s85, 9
    s_cselect_b64 exec, -1, 0
    buffer_load_dwordx4 v[164:167], v5, s[32:35], s82 offen offset:1024 sc1
    s_bitcmp1_b32 s85, 10
    s_cselect_b64 exec, -1, 0
    buffer_load_dwordx4 v[168:171], v5, s[32:35], s82 offen offset:2048 sc1
    s_bitcmp1_b32 s85, 11
    s_cselect_b64 exec, -1, 0
    buffer_load_dwordx4 v[172:175], v5, s[32:35], s82 offen offset:3072 sc1
    s_bitcmp1_b32 s85, 12
    s_cselect_b64 exec, -1, 0
    buffer_load_dwordx4 v[176:179], v5, s[32:35], s83 offen offset:0 sc1
    s_bitcmp1_b32 s85, 13
    s_cselect_b64 exec, -1, 0
    buffer_load_dwordx4 v[180:183], v5, s[32:35], s83 offen offset:1024 sc1
    s_bitcmp1_b32 s85, 14
    s_cselect_b64 exec, -1, 0
    buffer_load_dwordx4 v[184:187], v5, s[32:35], s83 offen offset:2048 sc1
    s_bitcmp1_b32 s85, 15
    s_cselect_b64 exec, -1, 0
    buffer_load_dwordx4 v[188:191], v5, s[32:35], s83 offen offset:3072 sc1
    s_mov_b64 exec, -1
    s_waitcnt vmcnt(16)
    v_msad_u8 v108, v104, s76, 0
    v_msad_u8 v108, v105, s77, v108
    v_msad_u8 v108, v106, s78, v108
    v_msad_u8 v108, v107, s79, v108
    v_cmp_ne_u32 vcc, 0, v108
    s_nop 1
    s_or_b32 s85, vcc_lo, vcc_hi
    s_and_b32 s85, s85, 0xffff
    s_bcnt1_i32_b32 s12, s85
    s_cmp_le_u32 s12, 6
    s_cselect_b32 s87, 1, 0
    s_cmp_lg_u32 s85, 0
    s_waitcnt vmcnt(0)
    s_cbranch_scc1 L_h1
    v_msad_u8 v108, v128, v63, 0
    v_msad_u8 v109, v132, v63, 0
    v_msad_u8 v108, v136, v63, v108
    v_msad_u8 v109, v140, v63, v109
    v_msad_u8 v108, v144, v63, v108
    v_msad_u8 v109, v148, v63, v109
    v_msad_u8 v108, v152, v63, v108
    v_msad_u8 v109, v156, v63, v109
    v_msad_u8 v108, v160, v63, v108
    v_msad_u8 v109, v164, v63, v109
    v_msad_u8 v108, v168, v63, v108
    v_msad_u8 v109, v172, v63, v109
    v_msad_u8 v108, v176, v63, v108
    v_msad_u8 v109, v180, v63, v109
    v_msad_u8 v108, v184, v63, v108
    v_msad_u8 v109, v188, v63, v109
    v_or_b32 v108, v108, v109
    v_cmp_ne_u32 vcc, 0, v108
    s_mov_b32 s85, 0xffff
    s_cbranch_vccnz L_h1
L_h1ok:
    s_waitcnt vmcnt(0)
    v_pk_add_f32 v[128:129], v[128:129], v[160:161]
    v_pk_add_f32 v[130:131], v[130:131], v[162:163]
    v_pk_add_f32 v[132:133], v[132:133], v[164:165]
    v_pk_add_f32 v[134:135], v[134:135], v[166:167]
    v_pk_add_f32 v[136:137], v[136:137], v[168:169]
    v_pk_add_f32 v[138:139], v[138:139], v[170:171]
    v_pk_add_f32 v[140:141], v[140:141], v[172:173]
    v_pk_add_f32 v[142:143], v[142:143], v[174:175]
    v_pk_add_f32 v[144:145], v[144:145], v[176:177]
    v_pk_add_f32 v[146:147], v[146:147], v[178:179]
    v_pk_add_f32 v[148:149], v[148:149], v[180:181]
    v_pk_add_f32 v[150:151], v[150:151], v[182:183]
    v_pk_add_f32 v[152:153], v[152:153], v[184:185]
    v_pk_add_f32 v[154:155], v[154:155], v[186:187]
    v_pk_add_f32 v[156:157], v[156:157], v[188:189]
    v_pk_add_f32 v[158:159], v[158:159], v[190:191]
    v_pk_add_f32 v[128:129], v[128:129], v[144:145]
    v_pk_add_f32 v[130:131], v[130:131], v[146:147]
    v_pk_add_f32 v[132:133], v[132:133], v[148:149]
    v_pk_add_f32 v[134:135], v[134:135], v[150:151]
    v_pk_add_f32 v[136:137], v[136:137], v[152:153]
    v_pk_add_f32 v[138:139], v[138:139], v[154:155]
    v_pk_add_f32 v[140:141], v[140:141], v[156:157]
    v_pk_add_f32 v[142:143], v[142:143], v[158:159]
    v_pk_add_f32 v[128:129], v[128:129], v[136:137]
    v_pk_add_f32 v[130:131], v[130:131], v[138:139]
    v_pk_add_f32 v[132:133], v[132:133], v[140:141]
    v_pk_add_f32 v[134:135], v[134:135], v[142:143]
    v_pk_add_f32 v[128:129], v[128:129], v[132:133]
    v_pk_add_f32 v[130:131], v[130:131], v[134:135]
    v_add_f32_dpp v104, v104, v104 row_ror:1 row_mask:0xf bank_mask:0xf
    v_add_f32_dpp v105, v105, v105 row_ror:1 row_mask:0xf bank_mask:0xf
    v_add_f32_dpp v106, v106, v106 row_ror:1 row_mask:0xf bank_mask:0xf
    v_add_f32_dpp v107, v107, v107 row_ror:1 row_mask:0xf bank_mask:0xf
    v_add_f32_dpp v104, v104, v104 row_ror:2 row_mask:0xf bank_mask:0xf
    v_add_f32_dpp v105, v105, v105 row_ror:2 row_mask:0xf bank_mask:0xf
    v_add_f32_dpp v106, v106, v106 row_ror:2 row_mask:0xf bank_mask:0xf
    v_add_f32_dpp v107, v107, v107 row_ror:2 row_mask:0xf bank_mask:0xf
    v_add_f32_dpp v104, v104, v104 row_ror:4 row_mask:0xf bank_mask:0xf
    v_add_f32_dpp v105, v105, v105 row_ror:4 row_mask:0xf bank_mask:0xf
    v_add_f32_dpp v106, v106, v106 row_ror:4 row_mask:0xf bank_mask:0xf
    v_add_f32_dpp v107, v107, v107 row_ror:4 row_mask:0xf bank_mask:0xf
    v_add_f32_dpp v104, v104, v104 row_ror:8 row_mask:0xf bank_mask:0xf
    v_add_f32_dpp v105, v105, v105 row_ror:8 row_mask:0xf bank_mask:0xf
    v_add_f32_dpp v106, v106, v106 row_ror:8 row_mask:0xf bank_mask:0xf
    v_add_f32_dpp v107, v107, v107 row_ror:8 row_mask:0xf bank_mask:0xf
    v_cvt_pk_bf16_f32 v108, v128, v129
    v_cvt_pk_bf16_f32 v109, v130, v131
    v_cvt_pk_bf16_f32 v112, v104, v105
    v_cvt_pk_bf16_f32 v113, v106, v107
    v_mov_b32 v110, v108
    v_mov_b32 v111, v109
    v_mov_b32 v114, v112
    v_mov_b32 v115, v113
    s_lshl_b32 s12, s19, 13
    s_lshl_b32 s13, s18, 9
    s_add_u32 s12, s12, s13
    s_add_u32 s12, s12, 32768
    s_lshl_b32 s13, s19, 11
    s_lshl_b32 s80, s18, 7
    s_add_u32 s13, s13, s80
    s_add_u32 s13, s13, 163840
    v_permlane32_swap_b32 v108, v110
    v_permlane32_swap_b32 v109, v111
    v_permlane32_swap_b32 v112, v114
    v_permlane32_swap_b32 v113, v115
    s_mov_b32 exec_hi, 0
    buffer_store_dwordx4 v[108:111], v5, s[32:35], s12 offen sc1
    s_mov_b32 exec_lo, 255
    buffer_store_dwordx4 v[112:115], v5, s[32:35], s13 offen sc1
    s_mov_b64 exec, -1
L_nohop:
    v_min_u32 v80, 6, v62
    v_lshl_add_u32 v80, v80, 3, v4
    v_lshlrev_b32 v80, 2, v80
    s_lshl_b32 s12, s86, 2
    s_add_u32 s80, s12, 327680
    s_add_u32 s81, s80, 28672
    s_add_u32 s82, s80, 57344
    s_add_u32 s83, s80, 86016
    v_and_b32 v78, 1, v4
    v_lshlrev_b32 v78, 4, v78
    v_lshrrev_b32 v78, v78, s23
    v_bfe_u32 v79, v78, 8, 8
    v_and_b32 v78, 0xff, v78
    s_mov_b32 s13, 0
    v_add_u32 v81, 14336, v80
L_gu:
    buffer_load_dword v104, v80, s[32:35], s80 offen sc1
    buffer_load_dword v105, v81, s[32:35], s80 offen sc1
    buffer_load_dword v106, v80, s[32:35], s81 offen sc1
    buffer_load_dword v107, v81, s[32:35], s81 offen sc1
    buffer_load_dword v108, v80, s[32:35], s82 offen sc1
    buffer_load_dword v109, v81, s[32:35], s82 offen sc1
    buffer_load_dword v110, v80, s[32:35], s83 offen sc1
    buffer_load_dword v111, v81, s[32:35], s83 offen sc1
    s_add_u32 s13, s13, 1
L_guw:
    s_cmp_lg_u32 s21, 0
    s_cbranch_scc1 L_nofl
    s_waitcnt vmcnt(8)
    v_mov_b32 v112, 162896
    v_mov_b32 v113, 1
    s_mov_b64 exec, 1
    ds_write_b32 v112, v113
    s_mov_b64 exec, -1
L_nofl:
    s_cmp_lg_u32 s13, 1
    s_cbranch_scc1 L_noflush
    s_mov_b32 s7, s90
    s_mul_i32 s12, s21, 16
    s_add_u32 s12, s12, 0
    s_and_b32 s90, s88, 1
    s_lshl_b32 s90, s90, 6
    s_xor_b32 s12, s12, s90
    s_cmp_ge_u32 s12, 32
    s_cselect_b32 s90, 24, 0
    s_add_u32 s12, s12, s90
    s_lshl_b32 s12, s12, 10
    v_add_u32 v76, s12, v5
    s_mul_i32 s12, s21, 16
    s_add_u32 s12, s12, 64
    s_and_b32 s90, s88, 1
    s_lshl_b32 s90, s90, 6
    s_xor_b32 s12, s12, s90
    s_cmp_ge_u32 s12, 32
    s_cselect_b32 s90, 24, 0
    s_add_u32 s12, s12, s90
    s_lshl_b32 s12, s12, 10
    v_add_u32 v77, s12, v5
    s_mul_i32 s12, s21, 4
    s_add_u32 s12, s12, 64
    s_and_b32 s90, s88, 1
    s_lshl_b32 s90, s90, 6
    s_xor_b32 s12, s12, s90
    s_cmp_ge_u32 s12, 32
    s_cselect_b32 s90, 24, 0
    s_add_u32 s12, s12, s90
    s_lshl_b32 s12, s12, 10
    v_add_u32 v60, s12, v5
    s_mov_b32 s90, s7
    v_mov_b32 v113, 162976
    s_mov_b32 s13, 0
L_gtf:
    ds_read_b64 v[114:115], v113
    ds_read_b64 v[82:83], v113 offset:8
    s_add_u32 s13, s13, 1
    s_cmp_ge_u32 s13, 262144
    s_cbranch_scc1 L_gxf
    s_waitcnt lgkmcnt(0)
    v_and_b32 v114, v114, v115
    v_and_b32 v82, v82, v83
    v_and_b32 v114, v114, v82
    v_cmp_eq_u32 vcc, 1, v114
    s_cbranch_vccz L_gtf
L_gxf:
    s_waitcnt lgkmcnt(0)
    ds_write_b128 v76, v[84:87] offset:0
    ds_write_b128 v76, v[88:91] offset:1024
    ds_write_b128 v76, v[92:95] offset:2048
    ds_write_b128 v76, v[96:99] offset:3072
    ds_write_b128 v76, v[100:103] offset:4096
    ds_write_b128 v76, v[116:119] offset:5120
    ds_write_b128 v76, v[120:123] offset:6144
    ds_write_b128 v76, v[124:127] offset:7168
    ds_write_b128 v76, v[64:67] offset:8192
    ds_write_b128 v76, v[68:71] offset:9216
    ds_write_b128 v76, v[72:75] offset:10240
    ds_write_b128 v76, v[236:239] offset:11264
    ds_write_b128 v76, v[240:243] offset:12288
    ds_write_b128 v76, v[244:247] offset:13312
    ds_write_b128 v76, v[248:251] offset:14336
    ds_write_b128 v76, v[252:255] offset:15360
    ds_write_b128 v60, v[220:223] offset:0
    ds_write_b128 v60, v[224:227] offset:1024
    ds_write_b128 v60, v[228:231] offset:2048
    ds_write_b128 v60, v[232:235] offset:3072
    s_cmp_eq_u32 s21, 0
    s_cbranch_scc1 L_nofx
    ds_write_b128 v77, v[128:131] offset:0
    ds_write_b128 v77, v[132:135] offset:1024
    ds_write_b128 v77, v[136:139] offset:2048
    ds_write_b128 v77, v[140:143] offset:3072
    ds_write_b128 v77, v[144:147] offset:4096
    ds_write_b128 v77, v[148:151] offset:5120
    ds_write_b128 v77, v[152:155] offset:6144
    ds_write_b128 v77, v[156:159] offset:7168
    ds_write_b128 v77, v[160:163] offset:8192
    ds_write_b128 v77, v[164:167] offset:9216
    ds_write_b128 v77, v[168:171] offset:10240
    ds_write_b128 v77, v[172:175] offset:11264
    ds_write_b128 v77, v[176:179] offset:12288
    ds_write_b128 v77, v[180:183] offset:13312
    ds_write_b128 v77, v[184:187] offset:14336
    ds_write_b128 v77, v[188:191] offset:15360
L_nofx:
    s_waitcnt lgkmcnt(0)
    s_mov_b32 s13, 1
L_noflush:
    s_waitcnt vmcnt(0)
    v_msad_u8 v112, v104, v78, 0
    v_msad_u8 v112, v105, v79, v112
    v_msad_u8 v112, v106, v78, v112
    v_msad_u8 v112, v107, v79, v112
    v_msad_u8 v112, v108, v78, v112
    v_msad_u8 v112, v109, v79, v112
    v_msad_u8 v112, v110, v78, v112
    v_msad_u8 v112, v111, v79, v112
    v_cmp_ne_u32 vcc, 0, v112
    s_cbranch_vccz L_guok
    s_cmp_lt_u32 s13, 16384
    s_cbranch_scc1 L_gu
L_guok:
    v_pk_add_f32 v[104:105], v[104:105], v[106:107]
    v_pk_add_f32 v[108:109], v[108:109], v[110:111]
    v_pk_add_f32 v[104:105], v[104:105], v[108:109]
    v_cvt_pk_bf16_f32 v104, v104, v105
    v_and_b32 v105, 0xffff0000, v104
    v_lshlrev_b32 v104, 16, v104
    v_mul_f32 v106, 0xbfb8aa3b, v104
    v_exp_f32 v106, v106
    s_nop 0
    v_add_f32 v106, 1.0, v106
    v_rcp_f32 v106, v106
    s_nop 0
    v_mul_f32 v106, v106, v104
    v_cvt_pk_bf16_f32 v106, v106, v106
    v_lshlrev_b32 v106, 16, v106
    v_mul_f32 v106, v106, v105
    v_cvt_pk_bf16_f32 v106, v106, v106
    ds_swizzle_b32 v64, v106 offset:0x18
    ds_swizzle_b32 v66, v106 offset:0x38
    ds_swizzle_b32 v68, v106 offset:0x58
    ds_swizzle_b32 v70, v106 offset:0x78
    ds_swizzle_b32 v72, v106 offset:0x98
    ds_swizzle_b32 v74, v106 offset:0xb8
    ds_swizzle_b32 v76, v106 offset:0xd8
    s_waitcnt lgkmcnt(0)
    v_and_b32 v65, 0xffff0000, v64
    v_and_b32 v64, 0xffff, v64
    v_and_b32 v67, 0xffff0000, v66
    v_and_b32 v66, 0xffff, v66
    v_and_b32 v69, 0xffff0000, v68
    v_and_b32 v68, 0xffff, v68
    v_and_b32 v71, 0xffff0000, v70
    v_and_b32 v70, 0xffff, v70
    v_and_b32 v73, 0xffff0000, v72
    v_and_b32 v72, 0xffff, v72
    v_and_b32 v75, 0xffff0000, v74
    v_and_b32 v74, 0xffff, v74
    v_and_b32 v77, 0xffff0000, v76
    v_and_b32 v76, 0xffff, v76
    v_dot2_f32_bf16 v220, v192, v64, 0
    v_dot2_f32_bf16 v221, v192, v65, 0
    v_dot2_f32_bf16 v222, v193, v64, 0
    v_dot2_f32_bf16 v223, v193, v65, 0
    v_dot2_f32_bf16 v224, v194, v64, 0
    v_dot2_f32_bf16 v225, v194, v65, 0
    v_dot2_f32_bf16 v226, v195, v64, 0
    v_dot2_f32_bf16 v227, v195, v65, 0
    v_dot2_f32_bf16 v220, v196, v66, v220
    v_dot2_f32_bf16 v221, v196, v67, v221
    v_dot2_f32_bf16 v222, v197, v66, v222
    v_dot2_f32_bf16 v223, v197, v67, v223
    v_dot2_f32_bf16 v224, v198, v66, v224
    v_dot2_f32_bf16 v225, v198, v67, v225
    v_dot2_f32_bf16 v226, v199, v66, v226
    v_dot2_f32_bf16 v227, v199, v67, v227
    v_dot2_f32_bf16 v220, v200, v68, v220
    v_dot2_f32_bf16 v221, v200, v69, v221
    v_dot2_f32_bf16 v222, v201, v68, v222
    v_dot2_f32_bf16 v223, v201, v69, v223
    v_dot2_f32_bf16 v224, v202, v68, v224
    v_dot2_f32_bf16 v225, v202, v69, v225
    v_dot2_f32_bf16 v226, v203, v68, v226
    v_dot2_f32_bf16 v227, v203, v69, v227
    v_dot2_f32_bf16 v220, v204, v70, v220
    v_dot2_f32_bf16 v221, v204, v71, v221
    v_dot2_f32_bf16 v222, v205, v70, v222
    v_dot2_f32_bf16 v223, v205, v71, v223
    v_dot2_f32_bf16 v224, v206, v70, v224
    v_dot2_f32_bf16 v225, v206, v71, v225
    v_dot2_f32_bf16 v226, v207, v70, v226
    v_dot2_f32_bf16 v227, v207, v71, v227
    v_dot2_f32_bf16 v220, v208, v72, v220
    v_dot2_f32_bf16 v221, v208, v73, v221
    v_dot2_f32_bf16 v222, v209, v72, v222
    v_dot2_f32_bf16 v223, v209, v73, v223
    v_dot2_f32_bf16 v224, v210, v72, v224
    v_dot2_f32_bf16 v225, v210, v73, v225
    v_dot2_f32_bf16 v226, v211, v72, v226
    v_dot2_f32_bf16 v227, v211, v73, v227
    v_dot2_f32_bf16 v220, v212, v74, v220
    v_dot2_f32_bf16 v221, v212, v75, v221
    v_dot2_f32_bf16 v222, v213, v74, v222
    v_dot2_f32_bf16 v223, v213, v75, v223
    v_dot2_f32_bf16 v224, v214, v74, v224
    v_dot2_f32_bf16 v225, v214, v75, v225
    v_dot2_f32_bf16 v226, v215, v74, v226
    v_dot2_f32_bf16 v227, v215, v75, v227
    v_dot2_f32_bf16 v220, v216, v76, v220
    v_dot2_f32_bf16 v221, v216, v77, v221
    v_dot2_f32_bf16 v222, v217, v76, v222
    v_dot2_f32_bf16 v223, v217, v77, v223
    v_dot2_f32_bf16 v224, v218, v76, v224
    v_dot2_f32_bf16 v225, v218, v77, v225
    v_dot2_f32_bf16 v226, v219, v76, v226
    v_dot2_f32_bf16 v227, v219, v77, v227
    v_permlane32_swap_b32 v220, v224
    v_permlane32_swap_b32 v221, v225
    v_permlane32_swap_b32 v222, v226
    v_permlane32_swap_b32 v223, v227
    v_add_f32 v220, v220, v224
    v_add_f32 v221, v221, v225
    v_add_f32 v222, v222, v226
    v_add_f32 v223, v223, v227
    s_nop 0
    v_permlane16_swap_b32 v220, v222
    v_permlane16_swap_b32 v221, v223
    v_add_f32 v220, v220, v222
    v_add_f32 v221, v221, v223
    s_nop 0
    v_add_f32_dpp v220, v220, v220 row_ror:8 row_mask:0xf bank_mask:0xf
    v_add_f32_dpp v221, v221, v221 row_ror:8 row_mask:0xf bank_mask:0xf
    v_lshrrev_b32 v80, 4, v2
    v_lshlrev_b32 v80, 3, v80
    v_lshl_add_u32 v80, v62, 5, v80
    s_lshl_b32 s12, s21, 8
    s_add_u32 s12, s12, 161792
    v_add_u32 v80, s12, v80
    ds_write_b64 v80, v[220:221]
    v_mov_b32 v80, 162848
    v_mov_b32 v78, 1
    s_mov_b64 exec, 1
    ds_add_rtn_u32 v79, v80, v78 offset:4
    s_mov_b64 exec, -1
    s_waitcnt lgkmcnt(0)
    v_readfirstlane_b32 s12, v79
    s_nop 1
    s_cmp_lg_u32 s12, 3
    s_cbranch_scc1 L_noy
    v_lshlrev_b32 v78, 2, v2
    v_add_u32 v80, 161792, v78
    ds_read2st64_b32 v[220:221], v80 offset0:0 offset1:1
    ds_read2st64_b32 v[222:223], v80 offset0:2 offset1:3
    s_lshl_b32 s12, s11, 8
    s_add_u32 s12, s12, 458752
    s_mov_b32 s13, 0xffffff00
    s_waitcnt lgkmcnt(0)
    v_pk_add_f32 v[220:221], v[220:221], v[222:223]
    v_add_f32 v220, v220, v221
    v_and_or_b32 v220, v220, s13, v63
    buffer_store_dword v220, v78, s[32:35], s12 offen sc1
L_noy:
    s_cmp_lg_u32 s21, 0
    s_cbranch_scc1 L_prepd
    s_waitcnt vmcnt(0)
    v_sub_f32 v50, 1.0, v48
    v_cvt_pk_bf16_f32 v50, v50, v50
    v_lshlrev_b32 v50, 16, v50
    v_lshlrev_b32 v32, 16, v24
    v_and_b32 v33, 0xffff0000, v24
    v_lshlrev_b32 v34, 16, v25
    v_and_b32 v35, 0xffff0000, v25
    v_lshlrev_b32 v36, 16, v26
    v_and_b32 v37, 0xffff0000, v26
    v_lshlrev_b32 v38, 16, v27
    v_and_b32 v39, 0xffff0000, v27
    v_lshlrev_b32 v40, 16, v28
    v_and_b32 v41, 0xffff0000, v28
    v_lshlrev_b32 v42, 16, v29
    v_and_b32 v43, 0xffff0000, v29
    v_lshlrev_b32 v44, 16, v30
    v_and_b32 v45, 0xffff0000, v30
    v_lshlrev_b32 v46, 16, v31
    v_and_b32 v47, 0xffff0000, v31
    v_pk_mul_f32 v[32:33], v[32:33], v[50:51] op_sel_hi:[1,0]
    v_pk_mul_f32 v[34:35], v[34:35], v[50:51] op_sel_hi:[1,0]
    v_pk_mul_f32 v[36:37], v[36:37], v[50:51] op_sel_hi:[1,0]
    v_pk_mul_f32 v[38:39], v[38:39], v[50:51] op_sel_hi:[1,0]
    v_pk_mul_f32 v[40:41], v[40:41], v[50:51] op_sel_hi:[1,0]
    v_pk_mul_f32 v[42:43], v[42:43], v[50:51] op_sel_hi:[1,0]
    v_pk_mul_f32 v[44:45], v[44:45], v[50:51] op_sel_hi:[1,0]
    v_pk_mul_f32 v[46:47], v[46:47], v[50:51] op_sel_hi:[1,0]
    v_cvt_pk_bf16_f32 v33, v32, v33
    v_cvt_pk_bf16_f32 v35, v34, v35
    v_cvt_pk_bf16_f32 v37, v36, v37
    v_cvt_pk_bf16_f32 v39, v38, v39
    v_cvt_pk_bf16_f32 v41, v40, v41
    v_cvt_pk_bf16_f32 v43, v42, v43
    v_cvt_pk_bf16_f32 v45, v44, v45
    v_cvt_pk_bf16_f32 v47, v46, v47
    v_permlane32_swap_b32 v33, v37
    v_permlane32_swap_b32 v35, v39
    v_permlane32_swap_b32 v41, v45
    v_permlane32_swap_b32 v43, v47
    v_lshlrev_b32 v32, 16, v33
    v_and_b32 v33, 0xffff0000, v33
    v_lshlrev_b32 v34, 16, v35
    v_and_b32 v35, 0xffff0000, v35
    v_lshlrev_b32 v36, 16, v37
    v_and_b32 v37, 0xffff0000, v37
    v_lshlrev_b32 v38, 16, v39
    v_and_b32 v39, 0xffff0000, v39
    v_lshlrev_b32 v40, 16, v41
    v_and_b32 v41, 0xffff0000, v41
    v_lshlrev_b32 v42, 16, v43
    v_and_b32 v43, 0xffff0000, v43
    v_lshlrev_b32 v44, 16, v45
    v_and_b32 v45, 0xffff0000, v45
    v_lshlrev_b32 v46, 16, v47
    v_and_b32 v47, 0xffff0000, v47
L_prepd:
    s_mov_b32 s21, s4
    s_mov_b32 s22, s5
    s_mov_b32 s45, 0
    s_lshr_b32 s12, s21, 4
    s_cmp_eq_u32 s12, s92
    s_cselect_b32 s46, 1, 0
    s_mov_b32 s45, 1
    s_branch L_phaseb
L_keyre_0:
    s_add_u32 s13, s13, 1
    s_cmp_ge_u32 s13, 16384
    s_cbranch_scc1 L_keyok_0
    s_mov_b32 s12, 0
    buffer_load_dwordx4 v[104:107], v5, s[32:35], s12 offen offset:0 sc1
    buffer_load_dwordx4 v[108:111], v5, s[32:35], s12 offen offset:1024 sc1
    s_waitcnt vmcnt(0)
    v_xor_b32 v105, s23, v105
    v_xor_b32 v107, s23, v107
    v_xor_b32 v109, s23, v109
    v_xor_b32 v111, s23, v111
    v_or3_b32 v105, v105, v107, v109
    v_or_b32 v105, v105, v111
    v_cmp_ne_u32 vcc, 0, v105
    s_cbranch_vccnz L_keyre_0
    s_branch L_keyok_0
L_keyre_1:
    s_add_u32 s13, s13, 1
    s_cmp_ge_u32 s13, 16384
    s_cbranch_scc1 L_keyok_1
    s_mov_b32 s12, 0
    buffer_load_dwordx4 v[104:107], v5, s[32:35], s12 offen offset:0 sc1
    buffer_load_dwordx4 v[108:111], v5, s[32:35], s12 offen offset:1024 sc1
    s_waitcnt vmcnt(0)
    v_xor_b32 v105, s23, v105
    v_xor_b32 v107, s23, v107
    v_xor_b32 v109, s23, v109
    v_xor_b32 v111, s23, v111
    v_or3_b32 v105, v105, v107, v109
    v_or_b32 v105, v105, v111
    v_cmp_ne_u32 vcc, 0, v105
    s_cbranch_vccnz L_keyre_1
    s_branch L_keyok_1
L_keyre_2:
    s_add_u32 s13, s13, 1
    s_cmp_ge_u32 s13, 16384
    s_cbranch_scc1 L_keyok_2
    s_mov_b32 s12, 0
    buffer_load_dwordx4 v[104:107], v5, s[32:35], s12 offen offset:0 sc1
    buffer_load_dwordx4 v[108:111], v5, s[32:35], s12 offen offset:1024 sc1
    s_waitcnt vmcnt(0)
    v_xor_b32 v105, s23, v105
    v_xor_b32 v107, s23, v107
    v_xor_b32 v109, s23, v109
    v_xor_b32 v111, s23, v111
    v_or3_b32 v105, v105, v107, v109
    v_or_b32 v105, v105, v111
    v_cmp_ne_u32 vcc, 0, v105
    s_cbranch_vccnz L_keyre_2
    s_branch L_keyok_2
L_keyre_3:
    s_add_u32 s13, s13, 1
    s_cmp_ge_u32 s13, 16384
    s_cbranch_scc1 L_keyok_3
    s_mov_b32 s12, 0
    buffer_load_dwordx4 v[104:107], v5, s[32:35], s12 offen offset:0 sc1
    buffer_load_dwordx4 v[108:111], v5, s[32:35], s12 offen offset:1024 sc1
    s_waitcnt vmcnt(0)
    v_xor_b32 v105, s23, v105
    v_xor_b32 v107, s23, v107
    v_xor_b32 v109, s23, v109
    v_xor_b32 v111, s23, v111
    v_or3_b32 v105, v105, v107, v109
    v_or_b32 v105, v105, v111
    v_cmp_ne_u32 vcc, 0, v105
    s_cbranch_vccnz L_keyre_3
    s_branch L_keyok_3
L_keyre_4:
    s_add_u32 s13, s13, 1
    s_cmp_ge_u32 s13, 16384
    s_cbranch_scc1 L_keyok_4
    s_mov_b32 s12, 0
    buffer_load_dwordx4 v[104:107], v5, s[32:35], s12 offen offset:0 sc1
    buffer_load_dwordx4 v[108:111], v5, s[32:35], s12 offen offset:1024 sc1
    s_waitcnt vmcnt(0)
    v_xor_b32 v105, s23, v105
    v_xor_b32 v107, s23, v107
    v_xor_b32 v109, s23, v109
    v_xor_b32 v111, s23, v111
    v_or3_b32 v105, v105, v107, v109
    v_or_b32 v105, v105, v111
    v_cmp_ne_u32 vcc, 0, v105
    s_cbranch_vccnz L_keyre_4
    s_branch L_keyok_4
.fill 788, 4, 0xbf800000
L_compute:
    s_setprio 1
    s_lshr_b32 s21, s20, 1
    s_and_b32 s22, s20, 1
    v_lshrrev_b32 v3, 5, v2
    v_and_b32 v4, 31, v2
    s_lshl_b32 s12, s21, 13
    v_lshlrev_b32 v6, 7, v4
    v_add_u32 v6, s12, v6
    v_bfe_u32 v7, v2, 1, 3
    v_add_u32 v8, 0, v3
    v_xor_b32 v8, v8, v7
    v_lshl_add_u32 v20, v8, 4, v6
    v_add_u32 v8, 2, v3
    v_xor_b32 v8, v8, v7
    v_lshl_add_u32 v21, v8, 4, v6
    v_add_u32 v8, 4, v3
    v_xor_b32 v8, v8, v7
    v_lshl_add_u32 v22, v8, 4, v6
    v_add_u32 v8, 6, v3
    v_xor_b32 v8, v8, v7
    v_lshl_add_u32 v23, v8, 4, v6
    v_lshlrev_b32 v6, 10, v3
    v_bfe_u32 v7, v2, 2, 2
    v_lshl_add_u32 v6, v7, 7, v6
    v_bfe_u32 v8, v2, 3, 1
    v_xor_b32 v8, s22, v8
    v_lshl_add_u32 v6, v8, 6, v6
    v_bfe_u32 v8, v2, 4, 1
    v_lshlrev_b32 v8, 5, v8
    v_and_b32 v9, 3, v2
    v_lshl_add_u32 v8, v9, 3, v8
    v_add_u32 v6, v6, v8
    v_add_u32 v36, 16384, v6
    v_lshl_add_u32 v7, v3, 2, v7
    v_lshl_add_u32 v12, v7, 6, v8
    s_lshl_b32 s12, s22, 11
    s_add_u32 s12, s12, 155648
    v_add_u32 v12, s12, v12
    v_lshlrev_b32 v6, 14, v3
    v_lshl_add_u32 v6, v4, 4, v6
    v_lshlrev_b32 v7, 9, v3
    s_lshl_b32 s12, s22, 3
    s_lshl_b32 s13, s21, 2
    s_add_u32 s12, s12, s13
    s_lshl_b32 s13, s12, 14
    s_lshl_b32 s14, s19, 18
    s_add_u32 s13, s13, s14
    s_lshl_b32 s14, s18, 10
    s_add_u32 s13, s13, s14
    s_add_u32 s40, s13, 1048576
    s_add_u32 s41, s40, 32768
    s_lshl_b32 s13, s12, 9
    s_lshl_b32 s14, s19, 13
    s_add_u32 s13, s13, s14
    s_lshl_b32 s14, s18, 5
    s_add_u32 s13, s13, s14
    s_add_u32 s42, s13, 5242880
    s_add_u32 s43, s42, 1024
    s_lshl_b32 s13, s21, 4
    s_lshl_b32 s44, 1, s13
    s_xor_b32 s13, s13, 16
    s_lshl_b32 s45, 1, s13
    s_lshl_b32 s13, s22, 1
    s_add_u32 s13, s13, s21
    s_lshl_b32 s13, s13, 11
    s_lshl_b32 s14, s19, 13
    s_add_u32 s13, s13, s14
    s_lshl_b32 s14, s18, 7
    s_add_u32 s13, s13, s14
    s_add_u32 s42, s13, 5242880
    s_mov_b32 s45, 0x10001
    v_lshlrev_b32 v7, 2, v2
    v_mov_b32 v68, 0
    v_mov_b32 v69, 0
    v_mov_b32 v70, 0
    v_mov_b32 v71, 0
    v_mov_b32 v160, 0
    v_mov_b32 v161, 0
    v_mov_b32 v162, 0
    v_mov_b32 v163, 0
    v_mov_b32 v164, 0
    v_mov_b32 v165, 0
    v_mov_b32 v166, 0
    v_mov_b32 v167, 0
    v_mov_b32 v168, 0
    v_mov_b32 v169, 0
    v_mov_b32 v170, 0
    v_mov_b32 v171, 0
    v_mov_b32 v172, 0
    v_mov_b32 v173, 0
    v_mov_b32 v174, 0
    v_mov_b32 v175, 0
    v_mov_b32 v176, 0
    v_mov_b32 v177, 0
    v_mov_b32 v178, 0
    v_mov_b32 v179, 0
    v_mov_b32 v180, 0
    v_mov_b32 v181, 0
    v_mov_b32 v182, 0
    v_mov_b32 v183, 0
    v_mov_b32 v184, 0
    v_mov_b32 v185, 0
    v_mov_b32 v186, 0
    v_mov_b32 v187, 0
    v_mov_b32 v188, 0
    v_mov_b32 v189, 0
    v_mov_b32 v190, 0
    v_mov_b32 v191, 0
    v_mov_b32 v192, 0
    v_mov_b32 v193, 0
    v_mov_b32 v194, 0
    v_mov_b32 v195, 0
    v_mov_b32 v196, 0
    v_mov_b32 v197, 0
    v_mov_b32 v198, 0
    v_mov_b32 v199, 0
    v_mov_b32 v200, 0
    v_mov_b32 v201, 0
    v_mov_b32 v202, 0
    v_mov_b32 v203, 0
    v_mov_b32 v204, 0
    v_mov_b32 v205, 0
    v_mov_b32 v206, 0
    v_mov_b32 v207, 0
    v_mov_b32 v208, 0
    v_mov_b32 v209, 0
    v_mov_b32 v210, 0
    v_mov_b32 v211, 0
    v_mov_b32 v212, 0
    v_mov_b32 v213, 0
    v_mov_b32 v214, 0
    v_mov_b32 v215, 0
    v_mov_b32 v216, 0
    v_mov_b32 v217, 0
    v_mov_b32 v218, 0
    v_mov_b32 v219, 0
    v_mov_b32 v220, 0
    v_mov_b32 v221, 0
    v_mov_b32 v222, 0
    v_mov_b32 v223, 0
    v_mov_b32 v224, 0
    v_mov_b32 v225, 0
    v_mov_b32 v226, 0
    v_mov_b32 v227, 0
    v_mov_b32 v228, 0
    v_mov_b32 v229, 0
    v_mov_b32 v230, 0
    v_mov_b32 v231, 0
    v_mov_b32 v232, 0
    v_mov_b32 v233, 0
    v_mov_b32 v234, 0
    v_mov_b32 v235, 0
    v_mov_b32 v236, 0
    v_mov_b32 v237, 0
    v_mov_b32 v238, 0
    v_mov_b32 v239, 0
    v_mov_b32 v240, 0
    v_mov_b32 v241, 0
    v_mov_b32 v242, 0
    v_mov_b32 v243, 0
    v_mov_b32 v244, 0
    v_mov_b32 v245, 0
    v_mov_b32 v246, 0
    v_mov_b32 v247, 0
    v_mov_b32 v248, 0
    v_mov_b32 v249, 0
    v_mov_b32 v250, 0
    v_mov_b32 v251, 0
    v_mov_b32 v252, 0
    v_mov_b32 v253, 0
    v_mov_b32 v254, 0
    v_mov_b32 v255, 0
    v_lshlrev_b32 v8, 2, v3
    v_sub_u32 v8, v4, v8
    v_mov_b32 v9, 0x3f80
    v_mov_b32 v10, 0x3f800000
    v_cmp_eq_u32 vcc, 0, v8
    s_nop 1
    v_cndmask_b32 v11, 0, v9, vcc
    v_cmp_eq_u32 vcc, 1, v8
    s_nop 1
    v_cndmask_b32 v48, v11, v10, vcc
    v_cmp_eq_u32 vcc, 2, v8
    s_nop 1
    v_cndmask_b32 v11, 0, v9, vcc
    v_cmp_eq_u32 vcc, 3, v8
    s_nop 1
    v_cndmask_b32 v49, v11, v10, vcc
    v_cmp_eq_u32 vcc, 8, v8
    s_nop 1
    v_cndmask_b32 v11, 0, v9, vcc
    v_cmp_eq_u32 vcc, 9, v8
    s_nop 1
    v_cndmask_b32 v50, v11, v10, vcc
    v_cmp_eq_u32 vcc, 10, v8
    s_nop 1
    v_cndmask_b32 v11, 0, v9, vcc
    v_cmp_eq_u32 vcc, 11, v8
    s_nop 1
    v_cndmask_b32 v51, v11, v10, vcc
    v_cmp_eq_u32 vcc, 16, v8
    s_nop 1
    v_cndmask_b32 v11, 0, v9, vcc
    v_cmp_eq_u32 vcc, 17, v8
    s_nop 1
    v_cndmask_b32 v52, v11, v10, vcc
    v_cmp_eq_u32 vcc, 18, v8
    s_nop 1
    v_cndmask_b32 v11, 0, v9, vcc
    v_cmp_eq_u32 vcc, 19, v8
    s_nop 1
    v_cndmask_b32 v53, v11, v10, vcc
    v_cmp_eq_u32 vcc, 24, v8
    s_nop 1
    v_cndmask_b32 v11, 0, v9, vcc
    v_cmp_eq_u32 vcc, 25, v8
    s_nop 1
    v_cndmask_b32 v54, v11, v10, vcc
    v_cmp_eq_u32 vcc, 26, v8
    s_nop 1
    v_cndmask_b32 v11, 0, v9, vcc
    v_cmp_eq_u32 vcc, 27, v8
    s_nop 1
    v_cndmask_b32 v55, v11, v10, vcc
    v_mov_b32 v9, 0x3f803f80
    v_cmp_gt_u32 vcc, 16, v4
    s_nop 1
    v_cndmask_b32 v56, 0, v9, vcc
    v_cndmask_b32 v60, v9, 0, vcc
    v_cndmask_b32 v57, 0, v9, vcc
    v_cndmask_b32 v61, v9, 0, vcc
    v_cndmask_b32 v58, 0, v9, vcc
    v_cndmask_b32 v62, v9, 0, vcc
    v_cndmask_b32 v59, 0, v9, vcc
    v_cndmask_b32 v63, v9, 0, vcc
    s_waitcnt lgkmcnt(0)
    s_mov_b32 s32, s62
    s_and_b32 s33, s63, 0xffff
    s_mov_b32 s34, 33554432
    s_mov_b32 s35, 0x00020000
    s_mov_b32 s24, s4
    s_and_b32 s25, s5, 0xffff
    s_mov_b32 s26, 4194304
    s_mov_b32 s27, 0x00020000
    s_cmp_lg_u32 s20, 0
    s_cbranch_scc1 L_c_noinit
    v_add_u32 v8, 162816, v5
    s_mov_b64 exec, 0xffff
    ds_write_b128 v8, v[68:71]
    s_mov_b64 exec, -1
    s_cmp_lg_u32 s2, 0
    s_cbranch_scc1 L_c_noinit
    s_mov_b32 s72, s60
    s_and_b32 s73, s61, 0xffff
    s_mov_b32 s74, 256
    s_mov_b32 s75, 0x00020000
    s_memrealtime s[14:15]
    s_waitcnt lgkmcnt(0)
    s_mul_i32 s14, s14, 0x9e3779b1
    s_or_b32 s14, s14, 0x01010101
    v_mov_b32 v8, s14
    s_mov_b64 exec, 1
    buffer_store_dword v8, v68, s[72:75], 0 offen offset:4 sc1
    s_mov_b64 exec, -1
L_c_noinit:
    s_lshl_b32 s14, s22, 1
    s_add_u32 s15, s14, s21
    s_xor_b32 s14, s15, 1
    s_mul_i32 s14, s14, 4352
    s_mul_i32 s15, s15, 4352
    s_add_u32 s14, s14, 98304
    s_add_u32 s15, s15, 98304
    v_add_u32 v8, s14, v5
    v_add_u32 v9, s15, v5
    v_lshlrev_b32 v11, 4, v3
    v_add_u32 v10, s14, v11
    v_add_u32 v11, s15, v11
    s_lshl_b32 s14, s20, 2
    s_add_u32 s15, s14, 162832
    v_mov_b32 v13, s15
    v_xor_b32 v14, 8, v13
    v_subrev_u32 v17, 16, v13
    v_mov_b32 v15, 1
    v_bfe_u32 v16, v2, 4, 1
    v_cmp_eq_u32 vcc, s21, v16
    s_nop 1
    v_cndmask_b32 v10, v10, v11, vcc
    s_lshl_b32 s14, s21, 7
    v_add_u32 v10, s14, v10
    v_lshrrev_b32 v11, 2, v5
    v_sub_u32 v16, v9, v5
    v_add_u32 v11, v16, v11
    s_waitcnt lgkmcnt(0)
    s_barrier
    ds_read_b128 v[100:103], v20
    ds_read_b64_tr_b16 v[108:109], v36 offset:0
    ds_read_b64_tr_b16 v[110:111], v36 offset:512
    ds_read_b128 v[104:107], v20 offset:4096
    ds_read_b64_tr_b16 v[112:113], v36 offset:8192
    ds_read_b64_tr_b16 v[114:115], v36 offset:8704
    ds_read_b64_tr_b16 v[116:117], v36 offset:16384
    ds_read_b64_tr_b16 v[118:119], v36 offset:16896
    s_mov_b32 s48, 0
    s_mov_b32 s49, 0
    s_mov_b32 s64, 16384
    s_mov_b32 s65, 4294868992
    s_mov_b32 s66, 40960
    s_mov_b32 s67, 4294885376
.p2align 3
L_c_loop:
    s_add_u32 s49, s49, 1
    s_cmp_eq_u32 s49, 3
    s_mov_b32 s50, 40960
    s_cselect_b32 s50, 4294885376, s50
    s_cselect_b32 s49, 0, s49
    s_cmp_eq_u32 s48, 10
    s_cselect_b32 s51, 81920, s50
    s_waitcnt lgkmcnt(5)
    v_mfma_f32_32x32x16_bf16 v[160:175], v[108:111], v[100:103], v[160:175]
    ds_read_b128 v[120:123], v21
    ds_read_b64_tr_b16 v[128:129], v36 offset:2048
    s_waitcnt lgkmcnt(6)
    v_mfma_f32_32x32x16_bf16 v[176:191], v[108:111], v[104:107], v[176:191]
    ds_read_b64_tr_b16 v[130:131], v36 offset:2560
    s_waitcnt lgkmcnt(5)
    v_mfma_f32_32x32x16_bf16 v[192:207], v[112:115], v[100:103], v[192:207]
    ds_read_b128 v[124:127], v21 offset:4096
    v_mfma_f32_32x32x16_bf16 v[208:223], v[112:115], v[104:107], v[208:223]
    ds_read_b64_tr_b16 v[132:133], v36 offset:10240
    ds_read_b64_tr_b16 v[134:135], v36 offset:10752
    s_waitcnt lgkmcnt(6)
    v_mfma_f32_32x32x16_bf16 v[224:239], v[100:103], v[116:119], v[224:239]
    ds_read_b64_tr_b16 v[136:137], v36 offset:18432
    v_add_u32 v21, s51, v21
    v_mfma_f32_32x32x16_bf16 v[240:255], v[104:107], v[116:119], v[240:255]
    ds_read_b64_tr_b16 v[138:139], v36 offset:18944
    v_add_u32 v20, s51, v20
    s_waitcnt lgkmcnt(5)
    v_mfma_f32_32x32x16_bf16 v[160:175], v[128:131], v[120:123], v[160:175]
    ds_read_b128 v[100:103], v22
    ds_read_b64_tr_b16 v[108:109], v36 offset:4096
    s_waitcnt lgkmcnt(6)
    v_mfma_f32_32x32x16_bf16 v[176:191], v[128:131], v[124:127], v[176:191]
    ds_read_b64_tr_b16 v[110:111], v36 offset:4608
    s_waitcnt lgkmcnt(5)
    v_mfma_f32_32x32x16_bf16 v[192:207], v[132:135], v[120:123], v[192:207]
    ds_read_b128 v[104:107], v22 offset:4096
    v_mfma_f32_32x32x16_bf16 v[208:223], v[132:135], v[124:127], v[208:223]
    ds_read_b64_tr_b16 v[112:113], v36 offset:12288
    ds_read_b64_tr_b16 v[114:115], v36 offset:12800
    s_waitcnt lgkmcnt(6)
    v_mfma_f32_32x32x16_bf16 v[224:239], v[120:123], v[136:139], v[224:239]
    ds_read_b64_tr_b16 v[116:117], v36 offset:20480
    v_add_u32 v22, s51, v22
    v_mfma_f32_32x32x16_bf16 v[240:255], v[124:127], v[136:139], v[240:255]
    ds_read_b64_tr_b16 v[118:119], v36 offset:20992
    s_waitcnt lgkmcnt(5)
    v_mfma_f32_32x32x16_bf16 v[160:175], v[108:111], v[100:103], v[160:175]
    ds_read_b128 v[120:123], v23
    ds_read_b64_tr_b16 v[128:129], v36 offset:6144
    ds_read_b64_tr_b16 v[130:131], v36 offset:6656
    s_waitcnt lgkmcnt(7)
    v_mfma_f32_32x32x16_bf16 v[176:191], v[108:111], v[104:107], v[176:191]
    ds_read_b128 v[124:127], v23 offset:4096
    ds_read_b64_tr_b16 v[132:133], v36 offset:14336
    ds_read_b64_tr_b16 v[134:135], v36 offset:14848
    s_waitcnt lgkmcnt(8)
    v_mfma_f32_32x32x16_bf16 v[192:207], v[112:115], v[100:103], v[192:207]
    ds_read_b64_tr_b16 v[136:137], v36 offset:22528
    ds_read_b64_tr_b16 v[138:139], v36 offset:23040
    v_mfma_f32_32x32x16_bf16 v[208:223], v[112:115], v[104:107], v[208:223]
    s_waitcnt lgkmcnt(8)
    v_mfma_f32_32x32x16_bf16 v[224:239], v[100:103], v[116:119], v[224:239]
    v_add_u32 v23, s51, v23
    v_mfma_f32_32x32x16_bf16 v[240:255], v[104:107], v[116:119], v[240:255]
    v_add_u32 v36, s50, v36
    s_waitcnt lgkmcnt(0)
    v_mfma_f32_32x32x16_bf16 v[160:175], v[128:131], v[120:123], v[160:175]
    s_barrier
    ds_read_b128 v[100:103], v20
    ds_read_b64_tr_b16 v[108:109], v36 offset:0
    ds_read_b64_tr_b16 v[110:111], v36 offset:512
    v_mfma_f32_32x32x16_bf16 v[176:191], v[128:131], v[124:127], v[176:191]
    ds_read_b128 v[104:107], v20 offset:4096
    ds_read_b64_tr_b16 v[112:113], v36 offset:8192
    ds_read_b64_tr_b16 v[114:115], v36 offset:8704
    v_mfma_f32_32x32x16_bf16 v[192:207], v[132:135], v[120:123], v[192:207]
    ds_read_b64_tr_b16 v[116:117], v36 offset:16384
    ds_read_b64_tr_b16 v[118:119], v36 offset:16896
    v_mfma_f32_32x32x16_bf16 v[208:223], v[132:135], v[124:127], v[208:223]
    v_mfma_f32_32x32x16_bf16 v[224:239], v[120:123], v[136:139], v[224:239]
    s_add_u32 s48, s48, 1
    s_cmp_lt_u32 s48, 11
    v_mfma_f32_32x32x16_bf16 v[240:255], v[124:127], v[136:139], v[240:255]
    s_cbranch_scc1 L_c_loop
    s_waitcnt lgkmcnt(2)
.p2align 3
L_c_loop2:
    s_add_u32 s49, s49, 1
    s_cmp_eq_u32 s49, 3
    s_mov_b32 s50, 40960
    s_cselect_b32 s50, 4294885376, s50
    s_cselect_b32 s49, 0, s49
    s_mov_b32 s51, s64
    s_mov_b32 s64, s65
    s_mov_b32 s65, s66
    s_mov_b32 s66, s67
    s_waitcnt lgkmcnt(3)
    v_mfma_f32_32x32x16_bf16 v[192:207], v[112:115], v[100:103], v[192:207]
    ds_read_b128 v[120:123], v21
    ds_read_b64_tr_b16 v[132:133], v36 offset:10240
    s_waitcnt lgkmcnt(4)
    v_mfma_f32_32x32x16_bf16 v[208:223], v[112:115], v[104:107], v[208:223]
    ds_read_b64_tr_b16 v[134:135], v36 offset:10752
    ds_read_b128 v[124:127], v21 offset:4096
    s_waitcnt lgkmcnt(4)
    v_mfma_f32_32x32x16_bf16 v[224:239], v[100:103], v[116:119], v[224:239]
    ds_read_b64_tr_b16 v[136:137], v36 offset:18432
    v_add_u32 v21, s51, v21
    v_mfma_f32_32x32x16_bf16 v[240:255], v[104:107], v[116:119], v[240:255]
    ds_read_b64_tr_b16 v[138:139], v36 offset:18944
    v_add_u32 v20, s51, v20
    s_waitcnt lgkmcnt(3)
    v_mfma_f32_32x32x16_bf16 v[192:207], v[132:135], v[120:123], v[192:207]
    ds_read_b128 v[100:103], v22
    ds_read_b64_tr_b16 v[112:113], v36 offset:12288
    s_waitcnt lgkmcnt(4)
    v_mfma_f32_32x32x16_bf16 v[208:223], v[132:135], v[124:127], v[208:223]
    ds_read_b64_tr_b16 v[114:115], v36 offset:12800
    ds_read_b128 v[104:107], v22 offset:4096
    s_waitcnt lgkmcnt(4)
    v_mfma_f32_32x32x16_bf16 v[224:239], v[120:123], v[136:139], v[224:239]
    ds_read_b64_tr_b16 v[116:117], v36 offset:20480
    v_add_u32 v22, s51, v22
    v_mfma_f32_32x32x16_bf16 v[240:255], v[124:127], v[136:139], v[240:255]
    ds_read_b64_tr_b16 v[118:119], v36 offset:20992
    s_waitcnt lgkmcnt(3)
    v_mfma_f32_32x32x16_bf16 v[192:207], v[112:115], v[100:103], v[192:207]
    ds_read_b128 v[120:123], v23
    ds_read_b64_tr_b16 v[132:133], v36 offset:14336
    ds_read_b64_tr_b16 v[134:135], v36 offset:14848
    s_waitcnt lgkmcnt(5)
    v_mfma_f32_32x32x16_bf16 v[208:223], v[112:115], v[104:107], v[208:223]
    ds_read_b128 v[124:127], v23 offset:4096
    ds_read_b64_tr_b16 v[136:137], v36 offset:22528
    ds_read_b64_tr_b16 v[138:139], v36 offset:23040
    s_waitcnt lgkmcnt(6)
    v_mfma_f32_32x32x16_bf16 v[224:239], v[100:103], v[116:119], v[224:239]
    v_add_u32 v23, s51, v23
    v_mfma_f32_32x32x16_bf16 v[240:255], v[104:107], v[116:119], v[240:255]
    v_add_u32 v36, s50, v36
    s_waitcnt lgkmcnt(0)
    v_mfma_f32_32x32x16_bf16 v[192:207], v[132:135], v[120:123], v[192:207]
    s_barrier
    ds_read_b128 v[100:103], v20
    ds_read_b64_tr_b16 v[112:113], v36 offset:8192
    ds_read_b64_tr_b16 v[114:115], v36 offset:8704
    v_mfma_f32_32x32x16_bf16 v[208:223], v[132:135], v[124:127], v[208:223]
    ds_read_b128 v[104:107], v20 offset:4096
    ds_read_b64_tr_b16 v[116:117], v36 offset:16384
    ds_read_b64_tr_b16 v[118:119], v36 offset:16896
    v_mfma_f32_32x32x16_bf16 v[224:239], v[120:123], v[136:139], v[224:239]
    s_add_u32 s48, s48, 1
    s_cmp_lt_u32 s48, 15
    v_mfma_f32_32x32x16_bf16 v[240:255], v[124:127], v[136:139], v[240:255]
    s_cbranch_scc1 L_c_loop2
    s_waitcnt lgkmcnt(3)
    v_mfma_f32_32x32x16_bf16 v[192:207], v[112:115], v[100:103], v[192:207]
    ds_read_b128 v[120:123], v21
    ds_read_b64_tr_b16 v[132:133], v36 offset:10240
    s_waitcnt lgkmcnt(4)
    v_mfma_f32_32x32x16_bf16 v[208:223], v[112:115], v[104:107], v[208:223]
    ds_read_b64_tr_b16 v[134:135], v36 offset:10752
    ds_read_b128 v[124:127], v21 offset:4096
    s_waitcnt lgkmcnt(4)
    v_mfma_f32_32x32x16_bf16 v[224:239], v[100:103], v[116:119], v[224:239]
    ds_read_b64_tr_b16 v[136:137], v36 offset:18432
    v_mfma_f32_32x32x16_bf16 v[240:255], v[104:107], v[116:119], v[240:255]
    ds_read_b64_tr_b16 v[138:139], v36 offset:18944
    s_waitcnt lgkmcnt(3)
    v_mfma_f32_32x32x16_bf16 v[192:207], v[132:135], v[120:123], v[192:207]
    ds_read_b128 v[100:103], v22
    ds_read_b64_tr_b16 v[112:113], v36 offset:12288
    s_waitcnt lgkmcnt(4)
    v_mfma_f32_32x32x16_bf16 v[208:223], v[132:135], v[124:127], v[208:223]
    ds_read_b64_tr_b16 v[114:115], v36 offset:12800
    ds_read_b128 v[104:107], v22 offset:4096
    s_waitcnt lgkmcnt(4)
    v_mfma_f32_32x32x16_bf16 v[224:239], v[120:123], v[136:139], v[224:239]
    ds_read_b64_tr_b16 v[116:117], v36 offset:20480
    v_mfma_f32_32x32x16_bf16 v[240:255], v[124:127], v[136:139], v[240:255]
    ds_read_b64_tr_b16 v[118:119], v36 offset:20992
    s_waitcnt lgkmcnt(3)
    v_mfma_f32_32x32x16_bf16 v[192:207], v[112:115], v[100:103], v[192:207]
    ds_read_b128 v[120:123], v23
    ds_read_b64_tr_b16 v[132:133], v36 offset:14336
    ds_read_b64_tr_b16 v[134:135], v36 offset:14848
    s_waitcnt lgkmcnt(5)
    v_mfma_f32_32x32x16_bf16 v[208:223], v[112:115], v[104:107], v[208:223]
    ds_read_b128 v[124:127], v23 offset:4096
    ds_read_b64_tr_b16 v[136:137], v36 offset:22528
    ds_read_b64_tr_b16 v[138:139], v36 offset:23040
    s_waitcnt lgkmcnt(6)
    v_mfma_f32_32x32x16_bf16 v[224:239], v[100:103], v[116:119], v[224:239]
    v_mfma_f32_32x32x16_bf16 v[240:255], v[104:107], v[116:119], v[240:255]
    s_waitcnt lgkmcnt(0)
    v_mfma_f32_32x32x16_bf16 v[192:207], v[132:135], v[120:123], v[192:207]
    s_mov_b64 exec, 1
    ds_write_b32 v17, v15
    s_mov_b64 exec, -1
    ds_read_b64_tr_b16 v[40:41], v12 offset:0
    ds_read_b64_tr_b16 v[42:43], v12 offset:512
    ds_read_b64_tr_b16 v[44:45], v12 offset:1024
    ds_read_b64_tr_b16 v[46:47], v12 offset:1536
    v_mov_b32 v16, 162864
    ds_read_b96 v[24:26], v16
    v_mfma_f32_32x32x16_bf16 v[208:223], v[132:135], v[124:127], v[208:223]
    v_mfma_f32_32x32x16_bf16 v[224:239], v[120:123], v[136:139], v[224:239]
    v_mfma_f32_32x32x16_bf16 v[240:255], v[124:127], v[136:139], v[240:255]
L_c_ta:
    s_mov_b32 s48, 0x3fb8aa3b
    s_mov_b32 s52, 0xbfb8aa3b
    v_cvt_pk_bf16_f32 v64, v192, v193
    v_cvt_pk_bf16_f32 v65, v194, v195
    v_cvt_pk_bf16_f32 v66, v196, v197
    v_cvt_pk_bf16_f32 v67, v198, v199
    v_cvt_pk_bf16_f32 v68, v200, v201
    v_cvt_pk_bf16_f32 v69, v202, v203
    v_cvt_pk_bf16_f32 v70, v204, v205
    v_cvt_pk_bf16_f32 v71, v206, v207
    s_waitcnt lgkmcnt(0)
    v_mfma_f32_32x32x16_bf16 v[192:207], v[40:43], v[64:67], 0
    v_mfma_f32_32x32x16_bf16 v[192:207], v[44:47], v[68:71], v[192:207]
    v_cvt_pk_bf16_f32 v72, v208, v209
    v_cvt_pk_bf16_f32 v73, v210, v211
    v_cvt_pk_bf16_f32 v74, v212, v213
    v_cvt_pk_bf16_f32 v75, v214, v215
    v_cvt_pk_bf16_f32 v76, v216, v217
    v_cvt_pk_bf16_f32 v77, v218, v219
    v_cvt_pk_bf16_f32 v78, v220, v221
    v_cvt_pk_bf16_f32 v79, v222, v223
    v_mfma_f32_32x32x16_bf16 v[208:223], v[40:43], v[72:75], 0
    s_nop 0
    v_mfma_f32_32x32x16_bf16 v[208:223], v[44:47], v[76:79], v[208:223]
    v_readfirstlane_b32 s72, v24
    v_readfirstlane_b32 s73, v25
    v_readfirstlane_b32 s74, v26
    v_and_b32 v27, 3, v2
    v_lshlrev_b32 v27, 3, v27
    v_bfe_u32 v27, v26, v27, 8
    v_mov_b32 v28, 0xffffff00
    s_and_b32 s76, s74, 0xff
    s_bfe_u32 s77, s74, 0x80008
    s_bfe_u32 s78, s74, 0x80010
    s_lshr_b32 s79, s74, 24
    v_cvt_pk_bf16_f32 v80, v224, v225
    v_cvt_pk_bf16_f32 v81, v226, v227
    v_cvt_pk_bf16_f32 v82, v228, v229
    v_cvt_pk_bf16_f32 v83, v230, v231
    v_cvt_pk_bf16_f32 v84, v232, v233
    v_cvt_pk_bf16_f32 v85, v234, v235
    v_cvt_pk_bf16_f32 v86, v236, v237
    v_cvt_pk_bf16_f32 v87, v238, v239
    v_cvt_pk_bf16_f32 v88, v240, v241
    v_cvt_pk_bf16_f32 v89, v242, v243
    v_cvt_pk_bf16_f32 v90, v244, v245
    v_cvt_pk_bf16_f32 v91, v246, v247
    v_cvt_pk_bf16_f32 v92, v248, v249
    v_cvt_pk_bf16_f32 v93, v250, v251
    v_cvt_pk_bf16_f32 v94, v252, v253
    v_cvt_pk_bf16_f32 v95, v254, v255
    v_cvt_pk_bf16_f32 v64, v192, v193
    v_cvt_pk_bf16_f32 v65, v194, v195
    v_cvt_pk_bf16_f32 v66, v196, v197
    v_cvt_pk_bf16_f32 v67, v198, v199
    v_cvt_pk_bf16_f32 v68, v200, v201
    v_cvt_pk_bf16_f32 v69, v202, v203
    v_cvt_pk_bf16_f32 v70, v204, v205
    v_cvt_pk_bf16_f32 v71, v206, v207
    v_lshlrev_b32 v192, 16, v64
    v_and_b32 v193, 0xffff0000, v64
    v_lshlrev_b32 v194, 16, v65
    v_and_b32 v195, 0xffff0000, v65
    v_lshlrev_b32 v196, 16, v66
    v_and_b32 v197, 0xffff0000, v66
    v_lshlrev_b32 v198, 16, v67
    v_and_b32 v199, 0xffff0000, v67
    v_lshlrev_b32 v200, 16, v68
    v_and_b32 v201, 0xffff0000, v68
    v_lshlrev_b32 v202, 16, v69
    v_and_b32 v203, 0xffff0000, v69
    v_lshlrev_b32 v204, 16, v70
    v_and_b32 v205, 0xffff0000, v70
    v_lshlrev_b32 v206, 16, v71
    v_and_b32 v207, 0xffff0000, v71
    v_max3_f32 v144, v192, v193, v194
    v_max3_f32 v145, v195, v196, v197
    v_max3_f32 v146, v198, v199, v200
    v_max3_f32 v147, v201, v202, v203
    v_max3_f32 v148, v204, v205, v206
    v_max3_f32 v144, v144, v145, v207
    v_max3_f32 v146, v146, v147, v148
    v_max_f32 v144, v144, v146
    v_min3_f32 v150, v192, v193, v194
    v_min3_f32 v151, v195, v196, v197
    v_min3_f32 v152, v198, v199, v200
    v_min3_f32 v153, v201, v202, v203
    v_min3_f32 v154, v204, v205, v206
    v_min3_f32 v150, v150, v151, v207
    v_min3_f32 v152, v152, v153, v154
    v_min_f32 v150, v150, v152
    v_mov_b32 v145, v144
    v_mov_b32 v151, v150
    s_nop 0
    v_permlane32_swap_b32 v144, v145
    v_permlane32_swap_b32 v150, v151
    v_max_f32 v144, v144, v145
    v_min_f32 v150, v150, v151
    v_mul_f32 v144, s52, v144
    v_mul_f32 v150, s48, v150
    v_pk_fma_f32 v[224:225], v[192:193], s[48:49], v[144:145] op_sel_hi:[1,0,0]
    v_pk_fma_f32 v[112:113], v[192:193], s[52:53], v[150:151] op_sel_hi:[1,0,0]
    v_pk_fma_f32 v[226:227], v[194:195], s[48:49], v[144:145] op_sel_hi:[1,0,0]
    v_pk_fma_f32 v[114:115], v[194:195], s[52:53], v[150:151] op_sel_hi:[1,0,0]
    v_pk_fma_f32 v[228:229], v[196:197], s[48:49], v[144:145] op_sel_hi:[1,0,0]
    v_pk_fma_f32 v[116:117], v[196:197], s[52:53], v[150:151] op_sel_hi:[1,0,0]
    v_pk_fma_f32 v[230:231], v[198:199], s[48:49], v[144:145] op_sel_hi:[1,0,0]
    v_pk_fma_f32 v[118:119], v[198:199], s[52:53], v[150:151] op_sel_hi:[1,0,0]
    v_pk_fma_f32 v[232:233], v[200:201], s[48:49], v[144:145] op_sel_hi:[1,0,0]
    v_pk_fma_f32 v[120:121], v[200:201], s[52:53], v[150:151] op_sel_hi:[1,0,0]
    v_pk_fma_f32 v[234:235], v[202:203], s[48:49], v[144:145] op_sel_hi:[1,0,0]
    v_pk_fma_f32 v[122:123], v[202:203], s[52:53], v[150:151] op_sel_hi:[1,0,0]
    v_pk_fma_f32 v[236:237], v[204:205], s[48:49], v[144:145] op_sel_hi:[1,0,0]
    v_pk_fma_f32 v[124:125], v[204:205], s[52:53], v[150:151] op_sel_hi:[1,0,0]
    v_pk_fma_f32 v[238:239], v[206:207], s[48:49], v[144:145] op_sel_hi:[1,0,0]
    v_pk_fma_f32 v[126:127], v[206:207], s[52:53], v[150:151] op_sel_hi:[1,0,0]
    v_exp_f32 v224, v224
    v_exp_f32 v112, v112
    v_exp_f32 v225, v225
    v_exp_f32 v113, v113
    v_exp_f32 v226, v226
    v_exp_f32 v114, v114
    v_exp_f32 v227, v227
    v_exp_f32 v115, v115
    v_exp_f32 v228, v228
    v_exp_f32 v116, v116
    v_exp_f32 v229, v229
    v_exp_f32 v117, v117
    v_exp_f32 v230, v230
    v_exp_f32 v118, v118
    v_exp_f32 v231, v231
    v_exp_f32 v119, v119
    v_exp_f32 v232, v232
    v_exp_f32 v120, v120
    v_exp_f32 v233, v233
    v_exp_f32 v121, v121
    v_exp_f32 v234, v234
    v_exp_f32 v122, v122
    v_exp_f32 v235, v235
    v_exp_f32 v123, v123
    v_exp_f32 v236, v236
    v_exp_f32 v124, v124
    v_exp_f32 v237, v237
    v_exp_f32 v125, v125
    v_exp_f32 v238, v238
    v_exp_f32 v126, v126
    v_exp_f32 v239, v239
    v_exp_f32 v127, v127
    v_pk_add_f32 v[144:145], v[224:225], v[226:227]
    v_pk_add_f32 v[146:147], v[228:229], v[230:231]
    v_pk_add_f32 v[148:149], v[232:233], v[234:235]
    v_pk_add_f32 v[150:151], v[112:113], v[114:115]
    v_pk_add_f32 v[152:153], v[116:117], v[118:119]
    v_pk_add_f32 v[154:155], v[120:121], v[122:123]
    v_pk_add_f32 v[144:145], v[144:145], v[236:237]
    v_pk_add_f32 v[146:147], v[146:147], v[238:239]
    v_pk_add_f32 v[150:151], v[150:151], v[124:125]
    v_pk_add_f32 v[152:153], v[152:153], v[126:127]
    v_pk_add_f32 v[144:145], v[144:145], v[148:149]
    v_pk_add_f32 v[150:151], v[150:151], v[154:155]
    v_pk_add_f32 v[144:145], v[144:145], v[146:147]
    v_pk_add_f32 v[150:151], v[150:151], v[152:153]
    v_add_f32 v144, v144, v145
    v_add_f32 v150, v150, v151
    v_mov_b32 v145, v144
    v_mov_b32 v151, v150
    s_nop 0
    v_permlane32_swap_b32 v144, v145
    v_permlane32_swap_b32 v150, v151
    v_add_f32 v144, v144, v145
    v_add_f32 v150, v150, v151
    v_rcp_f32 v144, v144
    v_rcp_f32 v150, v150
    v_pk_mul_f32 v[224:225], v[224:225], v[144:145] op_sel_hi:[1,0]
    v_pk_mul_f32 v[112:113], v[112:113], v[150:151] op_sel_hi:[1,0]
    v_pk_mul_f32 v[226:227], v[226:227], v[144:145] op_sel_hi:[1,0]
    v_pk_mul_f32 v[114:115], v[114:115], v[150:151] op_sel_hi:[1,0]
    v_pk_mul_f32 v[228:229], v[228:229], v[144:145] op_sel_hi:[1,0]
    v_pk_mul_f32 v[116:117], v[116:117], v[150:151] op_sel_hi:[1,0]
    v_pk_mul_f32 v[230:231], v[230:231], v[144:145] op_sel_hi:[1,0]
    v_pk_mul_f32 v[118:119], v[118:119], v[150:151] op_sel_hi:[1,0]
    v_pk_mul_f32 v[232:233], v[232:233], v[144:145] op_sel_hi:[1,0]
    v_pk_mul_f32 v[120:121], v[120:121], v[150:151] op_sel_hi:[1,0]
    v_pk_mul_f32 v[234:235], v[234:235], v[144:145] op_sel_hi:[1,0]
    v_pk_mul_f32 v[122:123], v[122:123], v[150:151] op_sel_hi:[1,0]
    v_pk_mul_f32 v[236:237], v[236:237], v[144:145] op_sel_hi:[1,0]
    v_pk_mul_f32 v[124:125], v[124:125], v[150:151] op_sel_hi:[1,0]
    v_pk_mul_f32 v[238:239], v[238:239], v[144:145] op_sel_hi:[1,0]
    v_pk_mul_f32 v[126:127], v[126:127], v[150:151] op_sel_hi:[1,0]
    v_cvt_pk_bf16_f32 v64, v224, v225
    v_cvt_pk_bf16_f32 v96, v112, v113
    v_cvt_pk_bf16_f32 v65, v226, v227
    v_cvt_pk_bf16_f32 v97, v114, v115
    v_cvt_pk_bf16_f32 v66, v228, v229
    v_cvt_pk_bf16_f32 v98, v116, v117
    v_cvt_pk_bf16_f32 v67, v230, v231
    v_cvt_pk_bf16_f32 v99, v118, v119
    v_cvt_pk_bf16_f32 v68, v232, v233
    v_cvt_pk_bf16_f32 v100, v120, v121
    v_cvt_pk_bf16_f32 v69, v234, v235
    v_cvt_pk_bf16_f32 v101, v122, v123
    v_cvt_pk_bf16_f32 v70, v236, v237
    v_cvt_pk_bf16_f32 v102, v124, v125
    v_cvt_pk_bf16_f32 v71, v238, v239
    v_cvt_pk_bf16_f32 v103, v126, v127
    v_mfma_f32_32x32x16_bf16 v[192:207], v[64:67], v[48:51], 0
    v_cvt_pk_bf16_f32 v72, v208, v209
    v_cvt_pk_bf16_f32 v73, v210, v211
    v_cvt_pk_bf16_f32 v74, v212, v213
    v_cvt_pk_bf16_f32 v75, v214, v215
    v_cvt_pk_bf16_f32 v76, v216, v217
    v_cvt_pk_bf16_f32 v77, v218, v219
    v_cvt_pk_bf16_f32 v78, v220, v221
    v_mfma_f32_32x32x16_bf16 v[192:207], v[68:71], v[52:55], v[192:207]
    v_cvt_pk_bf16_f32 v79, v222, v223
    v_lshlrev_b32 v208, 16, v72
    v_and_b32 v209, 0xffff0000, v72
    v_lshlrev_b32 v210, 16, v73
    v_and_b32 v211, 0xffff0000, v73
    v_lshlrev_b32 v212, 16, v74
    v_and_b32 v213, 0xffff0000, v74
    v_mfma_f32_32x32x16_bf16 v[224:239], v[96:99], v[48:51], 0
    v_lshlrev_b32 v214, 16, v75
    v_and_b32 v215, 0xffff0000, v75
    v_lshlrev_b32 v216, 16, v76
    v_and_b32 v217, 0xffff0000, v76
    v_lshlrev_b32 v218, 16, v77
    v_and_b32 v219, 0xffff0000, v77
    v_lshlrev_b32 v220, 16, v78
    v_mfma_f32_32x32x16_bf16 v[224:239], v[100:103], v[52:55], v[224:239]
    v_and_b32 v221, 0xffff0000, v78
    v_lshlrev_b32 v222, 16, v79
    v_and_b32 v223, 0xffff0000, v79
    v_max3_f32 v144, v208, v209, v210
    v_max3_f32 v145, v211, v212, v213
    v_max3_f32 v146, v214, v215, v216
    v_max3_f32 v147, v217, v218, v219
    v_max3_f32 v148, v220, v221, v222
    v_max3_f32 v144, v144, v145, v223
    v_max3_f32 v146, v146, v147, v148
    v_max_f32 v144, v144, v146
    v_min3_f32 v150, v208, v209, v210
    v_min3_f32 v151, v211, v212, v213
    v_min3_f32 v152, v214, v215, v216
    v_min3_f32 v153, v217, v218, v219
    v_min3_f32 v154, v220, v221, v222
    v_min3_f32 v150, v150, v151, v223
    v_min3_f32 v152, v152, v153, v154
    v_min_f32 v150, v150, v152
    v_mov_b32 v145, v144
    v_mov_b32 v151, v150
    s_nop 0
    v_permlane32_swap_b32 v144, v145
    v_permlane32_swap_b32 v150, v151
    v_max_f32 v144, v144, v145
    v_min_f32 v150, v150, v151
    v_mul_f32 v144, s52, v144
    v_mul_f32 v150, s48, v150
    v_pk_fma_f32 v[240:241], v[208:209], s[48:49], v[144:145] op_sel_hi:[1,0,0]
    v_pk_fma_f32 v[128:129], v[208:209], s[52:53], v[150:151] op_sel_hi:[1,0,0]
    v_pk_fma_f32 v[242:243], v[210:211], s[48:49], v[144:145] op_sel_hi:[1,0,0]
    v_pk_fma_f32 v[130:131], v[210:211], s[52:53], v[150:151] op_sel_hi:[1,0,0]
    v_pk_fma_f32 v[244:245], v[212:213], s[48:49], v[144:145] op_sel_hi:[1,0,0]
    v_pk_fma_f32 v[132:133], v[212:213], s[52:53], v[150:151] op_sel_hi:[1,0,0]
    v_pk_fma_f32 v[246:247], v[214:215], s[48:49], v[144:145] op_sel_hi:[1,0,0]
    v_pk_fma_f32 v[134:135], v[214:215], s[52:53], v[150:151] op_sel_hi:[1,0,0]
    v_pk_fma_f32 v[248:249], v[216:217], s[48:49], v[144:145] op_sel_hi:[1,0,0]
    v_pk_fma_f32 v[136:137], v[216:217], s[52:53], v[150:151] op_sel_hi:[1,0,0]
    v_pk_fma_f32 v[250:251], v[218:219], s[48:49], v[144:145] op_sel_hi:[1,0,0]
    v_pk_fma_f32 v[138:139], v[218:219], s[52:53], v[150:151] op_sel_hi:[1,0,0]
    v_pk_fma_f32 v[252:253], v[220:221], s[48:49], v[144:145] op_sel_hi:[1,0,0]
    v_pk_fma_f32 v[140:141], v[220:221], s[52:53], v[150:151] op_sel_hi:[1,0,0]
    v_pk_fma_f32 v[254:255], v[222:223], s[48:49], v[144:145] op_sel_hi:[1,0,0]
    v_pk_fma_f32 v[142:143], v[222:223], s[52:53], v[150:151] op_sel_hi:[1,0,0]
    v_cvt_pk_bf16_f32 v64, v192, v193
    v_cvt_pk_bf16_f32 v65, v194, v195
    v_cvt_pk_bf16_f32 v66, v196, v197
    v_cvt_pk_bf16_f32 v67, v198, v199
    v_cvt_pk_bf16_f32 v68, v200, v201
    v_cvt_pk_bf16_f32 v69, v202, v203
    v_cvt_pk_bf16_f32 v70, v204, v205
    v_cvt_pk_bf16_f32 v71, v206, v207
    v_cvt_pk_bf16_f32 v96, v224, v225
    v_cvt_pk_bf16_f32 v97, v226, v227
    v_cvt_pk_bf16_f32 v98, v228, v229
    v_cvt_pk_bf16_f32 v99, v230, v231
    v_cvt_pk_bf16_f32 v100, v232, v233
    v_cvt_pk_bf16_f32 v101, v234, v235
    v_cvt_pk_bf16_f32 v102, v236, v237
    v_cvt_pk_bf16_f32 v103, v238, v239
    v_mfma_f32_32x32x16_bf16 v[112:127], v[64:67], v[80:83], 0
    v_exp_f32 v240, v240
    v_exp_f32 v128, v128
    v_exp_f32 v241, v241
    v_exp_f32 v129, v129
    v_mfma_f32_32x32x16_bf16 v[112:127], v[68:71], v[84:87], v[112:127]
    v_exp_f32 v242, v242
    v_exp_f32 v130, v130
    v_exp_f32 v243, v243
    v_exp_f32 v131, v131
    v_mfma_f32_32x32x16_bf16 v[192:207], v[96:99], v[80:83], 0
    v_exp_f32 v244, v244
    v_exp_f32 v132, v132
    v_exp_f32 v245, v245
    v_exp_f32 v133, v133
    v_mfma_f32_32x32x16_bf16 v[192:207], v[100:103], v[84:87], v[192:207]
    v_exp_f32 v246, v246
    v_exp_f32 v134, v134
    v_exp_f32 v247, v247
    v_exp_f32 v135, v135
    v_mfma_f32_32x32x16_bf16 v[224:239], v[64:67], v[56:59], 0
    v_exp_f32 v248, v248
    v_exp_f32 v136, v136
    v_exp_f32 v249, v249
    v_exp_f32 v137, v137
    v_mfma_f32_32x32x16_bf16 v[224:239], v[68:71], v[56:59], v[224:239]
    v_exp_f32 v250, v250
    v_exp_f32 v138, v138
    v_exp_f32 v251, v251
    v_exp_f32 v139, v139
    v_mfma_f32_32x32x16_bf16 v[224:239], v[96:99], v[60:63], v[224:239]
    v_exp_f32 v252, v252
    v_exp_f32 v140, v140
    v_exp_f32 v253, v253
    v_exp_f32 v141, v141
    v_mfma_f32_32x32x16_bf16 v[224:239], v[100:103], v[60:63], v[224:239]
    v_exp_f32 v254, v254
    v_exp_f32 v142, v142
    v_exp_f32 v255, v255
    v_exp_f32 v143, v143
    v_pk_add_f32 v[144:145], v[240:241], v[242:243]
    v_pk_add_f32 v[146:147], v[244:245], v[246:247]
    v_pk_add_f32 v[148:149], v[248:249], v[250:251]
    v_pk_add_f32 v[150:151], v[128:129], v[130:131]
    v_pk_add_f32 v[152:153], v[132:133], v[134:135]
    v_pk_add_f32 v[154:155], v[136:137], v[138:139]
    v_pk_add_f32 v[144:145], v[144:145], v[252:253]
    v_pk_add_f32 v[146:147], v[146:147], v[254:255]
    v_pk_add_f32 v[150:151], v[150:151], v[140:141]
    v_pk_add_f32 v[152:153], v[152:153], v[142:143]
    v_pk_add_f32 v[144:145], v[144:145], v[148:149]
    v_pk_add_f32 v[150:151], v[150:151], v[154:155]
    v_pk_add_f32 v[144:145], v[144:145], v[146:147]
    v_pk_add_f32 v[150:151], v[150:151], v[152:153]
    v_add_f32 v144, v144, v145
    v_add_f32 v150, v150, v151
    v_mov_b32 v145, v144
    v_mov_b32 v151, v150
    s_nop 0
    v_permlane32_swap_b32 v144, v145
    v_permlane32_swap_b32 v150, v151
    v_add_f32 v144, v144, v145
    v_add_f32 v150, v150, v151
    v_rcp_f32 v144, v144
    v_rcp_f32 v150, v150
    v_pk_mul_f32 v[240:241], v[240:241], v[144:145] op_sel_hi:[1,0]
    v_pk_mul_f32 v[128:129], v[128:129], v[150:151] op_sel_hi:[1,0]
    v_pk_mul_f32 v[242:243], v[242:243], v[144:145] op_sel_hi:[1,0]
    v_pk_mul_f32 v[130:131], v[130:131], v[150:151] op_sel_hi:[1,0]
    v_pk_mul_f32 v[244:245], v[244:245], v[144:145] op_sel_hi:[1,0]
    v_pk_mul_f32 v[132:133], v[132:133], v[150:151] op_sel_hi:[1,0]
    v_pk_mul_f32 v[246:247], v[246:247], v[144:145] op_sel_hi:[1,0]
    v_pk_mul_f32 v[134:135], v[134:135], v[150:151] op_sel_hi:[1,0]
    v_pk_mul_f32 v[248:249], v[248:249], v[144:145] op_sel_hi:[1,0]
    v_pk_mul_f32 v[136:137], v[136:137], v[150:151] op_sel_hi:[1,0]
    v_pk_mul_f32 v[250:251], v[250:251], v[144:145] op_sel_hi:[1,0]
    v_pk_mul_f32 v[138:139], v[138:139], v[150:151] op_sel_hi:[1,0]
    v_pk_mul_f32 v[252:253], v[252:253], v[144:145] op_sel_hi:[1,0]
    v_pk_mul_f32 v[140:141], v[140:141], v[150:151] op_sel_hi:[1,0]
    v_pk_mul_f32 v[254:255], v[254:255], v[144:145] op_sel_hi:[1,0]
    v_pk_mul_f32 v[142:143], v[142:143], v[150:151] op_sel_hi:[1,0]
    s_cmp_eq_u32 s21, 0
    s_cbranch_scc0 L_c_rw1
    v_cvt_pk_bf16_f32 v104, v128, v129
    v_cvt_pk_bf16_f32 v105, v130, v131
    v_cvt_pk_bf16_f32 v106, v132, v133
    v_cvt_pk_bf16_f32 v107, v134, v135
    v_cvt_pk_bf16_f32 v108, v136, v137
    v_cvt_pk_bf16_f32 v109, v138, v139
    v_cvt_pk_bf16_f32 v110, v140, v141
    v_cvt_pk_bf16_f32 v111, v142, v143
    v_mfma_f32_32x32x16_bf16 v[208:223], v[104:107], v[48:51], 0
    v_cvt_pk_bf16_f32 v72, v240, v241
    v_cvt_pk_bf16_f32 v73, v242, v243
    v_cvt_pk_bf16_f32 v74, v244, v245
    v_cvt_pk_bf16_f32 v75, v246, v247
    v_mfma_f32_32x32x16_bf16 v[208:223], v[108:111], v[52:55], v[208:223]
    v_cvt_pk_bf16_f32 v76, v248, v249
    v_cvt_pk_bf16_f32 v77, v250, v251
    v_cvt_pk_bf16_f32 v78, v252, v253
    v_cvt_pk_bf16_f32 v79, v254, v255
    v_mfma_f32_32x32x16_bf16 v[240:255], v[72:75], v[48:51], 0
    s_nop 0
    v_mfma_f32_32x32x16_bf16 v[240:255], v[76:79], v[52:55], v[240:255]
    s_nop 4
    v_cvt_pk_bf16_f32 v104, v208, v209
    v_cvt_pk_bf16_f32 v105, v210, v211
    v_cvt_pk_bf16_f32 v106, v212, v213
    v_cvt_pk_bf16_f32 v107, v214, v215
    v_cvt_pk_bf16_f32 v108, v216, v217
    v_cvt_pk_bf16_f32 v109, v218, v219
    v_cvt_pk_bf16_f32 v110, v220, v221
    v_cvt_pk_bf16_f32 v111, v222, v223
    v_mfma_f32_32x32x16_bf16 v[192:207], v[104:107], v[88:91], v[192:207]
    v_cvt_pk_bf16_f32 v72, v240, v241
    v_cvt_pk_bf16_f32 v73, v242, v243
    v_cvt_pk_bf16_f32 v74, v244, v245
    v_cvt_pk_bf16_f32 v75, v246, v247
    v_mfma_f32_32x32x16_bf16 v[192:207], v[108:111], v[92:95], v[192:207]
    v_cvt_pk_bf16_f32 v76, v248, v249
    v_cvt_pk_bf16_f32 v77, v250, v251
    v_cvt_pk_bf16_f32 v78, v252, v253
    v_cvt_pk_bf16_f32 v79, v254, v255
    v_mfma_f32_32x32x16_bf16 v[224:239], v[104:107], v[60:63], v[224:239]
    s_nop 0
    v_mfma_f32_32x32x16_bf16 v[224:239], v[108:111], v[60:63], v[224:239]
    s_nop 4
    ds_write_b128 v8, v[192:195] offset:0
    v_mfma_f32_32x32x16_bf16 v[224:239], v[72:75], v[56:59], v[224:239]
    ds_write_b128 v8, v[196:199] offset:1024
    v_mfma_f32_32x32x16_bf16 v[224:239], v[76:79], v[56:59], v[224:239]
    ds_write_b128 v8, v[200:203] offset:2048
    ds_write_b128 v8, v[204:207] offset:3072
    v_mfma_f32_32x32x16_bf16 v[112:127], v[72:75], v[88:91], v[112:127]
    v_mfma_f32_32x32x16_bf16 v[112:127], v[76:79], v[92:95], v[112:127]
    s_mov_b32 exec_lo, s45
    s_mov_b32 exec_hi, s45
    s_nop 5
    ds_write_b128 v10, v[224:227] offset:4096
    ds_write_b128 v10, v[228:231] offset:4128
    ds_write_b128 v10, v[232:235] offset:4160
    ds_write_b128 v10, v[236:239] offset:4192
    ds_write_b32 v13, v15
    s_mov_b64 exec, -1
    s_mov_b32 s13, 0
L_c_x0:
    ds_read_b32 v16, v14
    ds_read_b128 v[128:131], v9 offset:0
    ds_read_b128 v[132:135], v9 offset:1024
    ds_read_b128 v[136:139], v9 offset:2048
    ds_read_b128 v[140:143], v9 offset:3072
    ds_read_b32 v144, v11 offset:4096
    ds_read_b32 v145, v11 offset:4224
    s_add_u32 s13, s13, 1
    s_cmp_ge_u32 s13, 262144
    s_cbranch_scc1 L_c_y0
    s_waitcnt lgkmcnt(6)
    v_cmp_eq_u32 vcc, 1, v16
    s_cbranch_vccz L_c_x0
L_c_y0:
    s_waitcnt lgkmcnt(2)
    v_pk_add_f32 v[112:113], v[112:113], v[128:129]
    v_pk_add_f32 v[114:115], v[114:115], v[130:131]
    v_pk_add_f32 v[116:117], v[116:117], v[132:133]
    v_pk_add_f32 v[118:119], v[118:119], v[134:135]
    v_pk_add_f32 v[120:121], v[120:121], v[136:137]
    v_pk_add_f32 v[122:123], v[122:123], v[138:139]
    v_pk_add_f32 v[124:125], v[124:125], v[140:141]
    v_pk_add_f32 v[126:127], v[126:127], v[142:143]
    v_and_or_b32 v112, v112, v28, v27
    buffer_store_dwordx4 v[112:115], v6, s[32:35], s40 offen offset:0 sc1
    v_and_or_b32 v116, v116, v28, v27
    buffer_store_dwordx4 v[116:119], v6, s[32:35], s40 offen offset:512 sc1
    v_and_or_b32 v120, v120, v28, v27
    buffer_store_dwordx4 v[120:123], v6, s[32:35], s41 offen offset:0 sc1
    v_and_or_b32 v124, v124, v28, v27
    buffer_store_dwordx4 v[124:127], v6, s[32:35], s41 offen offset:512 sc1
    s_branch L_c_zs
L_c_rw1:
    s_nop 1
    v_cvt_pk_bf16_f32 v72, v240, v241
    v_cvt_pk_bf16_f32 v73, v242, v243
    v_cvt_pk_bf16_f32 v74, v244, v245
    v_cvt_pk_bf16_f32 v75, v246, v247
    v_cvt_pk_bf16_f32 v76, v248, v249
    v_cvt_pk_bf16_f32 v77, v250, v251
    v_cvt_pk_bf16_f32 v78, v252, v253
    v_cvt_pk_bf16_f32 v79, v254, v255
    v_mfma_f32_32x32x16_bf16 v[208:223], v[72:75], v[48:51], 0
    v_cvt_pk_bf16_f32 v104, v128, v129
    v_cvt_pk_bf16_f32 v105, v130, v131
    v_cvt_pk_bf16_f32 v106, v132, v133
    v_cvt_pk_bf16_f32 v107, v134, v135
    v_mfma_f32_32x32x16_bf16 v[208:223], v[76:79], v[52:55], v[208:223]
    v_cvt_pk_bf16_f32 v108, v136, v137
    v_cvt_pk_bf16_f32 v109, v138, v139
    v_cvt_pk_bf16_f32 v110, v140, v141
    v_cvt_pk_bf16_f32 v111, v142, v143
    v_mfma_f32_32x32x16_bf16 v[240:255], v[104:107], v[48:51], 0
    s_nop 0
    v_mfma_f32_32x32x16_bf16 v[240:255], v[108:111], v[52:55], v[240:255]
    s_nop 4
    v_cvt_pk_bf16_f32 v72, v208, v209
    v_cvt_pk_bf16_f32 v73, v210, v211
    v_cvt_pk_bf16_f32 v74, v212, v213
    v_cvt_pk_bf16_f32 v75, v214, v215
    v_cvt_pk_bf16_f32 v76, v216, v217
    v_cvt_pk_bf16_f32 v77, v218, v219
    v_cvt_pk_bf16_f32 v78, v220, v221
    v_cvt_pk_bf16_f32 v79, v222, v223
    v_mfma_f32_32x32x16_bf16 v[112:127], v[72:75], v[88:91], v[112:127]
    v_cvt_pk_bf16_f32 v104, v240, v241
    v_cvt_pk_bf16_f32 v105, v242, v243
    v_cvt_pk_bf16_f32 v106, v244, v245
    v_cvt_pk_bf16_f32 v107, v246, v247
    v_mfma_f32_32x32x16_bf16 v[112:127], v[76:79], v[92:95], v[112:127]
    v_cvt_pk_bf16_f32 v108, v248, v249
    v_cvt_pk_bf16_f32 v109, v250, v251
    v_cvt_pk_bf16_f32 v110, v252, v253
    v_cvt_pk_bf16_f32 v111, v254, v255
    v_mfma_f32_32x32x16_bf16 v[224:239], v[72:75], v[56:59], v[224:239]
    s_nop 0
    v_mfma_f32_32x32x16_bf16 v[224:239], v[76:79], v[56:59], v[224:239]
    s_nop 4
    ds_write_b128 v8, v[112:115] offset:0
    v_mfma_f32_32x32x16_bf16 v[224:239], v[104:107], v[60:63], v[224:239]
    ds_write_b128 v8, v[116:119] offset:1024
    v_mfma_f32_32x32x16_bf16 v[224:239], v[108:111], v[60:63], v[224:239]
    ds_write_b128 v8, v[120:123] offset:2048
    ds_write_b128 v8, v[124:127] offset:3072
    v_mfma_f32_32x32x16_bf16 v[192:207], v[104:107], v[88:91], v[192:207]
    v_mfma_f32_32x32x16_bf16 v[192:207], v[108:111], v[92:95], v[192:207]
    s_mov_b32 exec_lo, s45
    s_mov_b32 exec_hi, s45
    s_nop 5
    ds_write_b128 v10, v[224:227] offset:4096
    ds_write_b128 v10, v[228:231] offset:4128
    ds_write_b128 v10, v[232:235] offset:4160
    ds_write_b128 v10, v[236:239] offset:4192
    ds_write_b32 v13, v15
    s_mov_b64 exec, -1
    s_mov_b32 s13, 0
L_c_x1:
    ds_read_b32 v16, v14
    ds_read_b128 v[128:131], v9 offset:0
    ds_read_b128 v[132:135], v9 offset:1024
    ds_read_b128 v[136:139], v9 offset:2048
    ds_read_b128 v[140:143], v9 offset:3072
    ds_read_b32 v144, v11 offset:4096
    ds_read_b32 v145, v11 offset:4224
    s_add_u32 s13, s13, 1
    s_cmp_ge_u32 s13, 262144
    s_cbranch_scc1 L_c_y1
    s_waitcnt lgkmcnt(6)
    v_cmp_eq_u32 vcc, 1, v16
    s_cbranch_vccz L_c_x1
L_c_y1:
    s_waitcnt lgkmcnt(2)
    v_pk_add_f32 v[192:193], v[192:193], v[128:129]
    v_pk_add_f32 v[194:195], v[194:195], v[130:131]
    v_pk_add_f32 v[196:197], v[196:197], v[132:133]
    v_pk_add_f32 v[198:199], v[198:199], v[134:135]
    v_pk_add_f32 v[200:201], v[200:201], v[136:137]
    v_pk_add_f32 v[202:203], v[202:203], v[138:139]
    v_pk_add_f32 v[204:205], v[204:205], v[140:141]
    v_pk_add_f32 v[206:207], v[206:207], v[142:143]
    v_and_or_b32 v192, v192, v28, v27
    buffer_store_dwordx4 v[192:195], v6, s[32:35], s40 offen offset:0 sc1
    v_and_or_b32 v196, v196, v28, v27
    buffer_store_dwordx4 v[196:199], v6, s[32:35], s40 offen offset:512 sc1
    v_and_or_b32 v200, v200, v28, v27
    buffer_store_dwordx4 v[200:203], v6, s[32:35], s41 offen offset:0 sc1
    v_and_or_b32 v204, v204, v28, v27
    buffer_store_dwordx4 v[204:207], v6, s[32:35], s41 offen offset:512 sc1
L_c_zs:
    s_waitcnt lgkmcnt(0)
    v_add_f32 v144, v144, v145
    v_and_or_b32 v144, v144, v28, v27
    s_mov_b32 exec_hi, 0
    buffer_store_dword v144, v7, s[32:35], s42 offen sc1
    s_mov_b32 exec_lo, 1
    ds_write_b32 v13, v15 offset:96
    s_mov_b64 exec, -1
    v_mov_b32 v16, 162960
    s_mov_b32 s13, 0
L_c_wq:
    ds_read_b128 v[64:67], v16
    s_add_u32 s13, s13, 1
    s_cmp_ge_u32 s13, 262144
    s_cbranch_scc1 L_c_wqok
    s_waitcnt lgkmcnt(0)
    v_and_b32 v64, v64, v65
    v_and_b32 v66, v66, v67
    v_and_b32 v64, v64, v66
    v_cmp_eq_u32 vcc, 1, v64
    s_cbranch_vccz L_c_wq
L_c_wqok:
    s_waitcnt lgkmcnt(0)
    v_add_u32 v36, 0x2000, v36
    ds_read_b64_tr_b16 v[72:73], v36 offset:0
    ds_read_b64_tr_b16 v[74:75], v36 offset:512
    ds_read_b128 v[64:67], v20
    ds_read_b128 v[68:71], v20 offset:4096
    ds_read_b64_tr_b16 v[84:85], v36 offset:2048
    ds_read_b64_tr_b16 v[86:87], v36 offset:2560
    ds_read_b128 v[76:79], v21
    ds_read_b128 v[80:83], v21 offset:4096
    ds_read_b64_tr_b16 v[96:97], v36 offset:4096
    ds_read_b64_tr_b16 v[98:99], v36 offset:4608
    ds_read_b128 v[88:91], v22
    ds_read_b128 v[92:95], v22 offset:4096
    s_waitcnt lgkmcnt(9)
    v_mfma_f32_32x32x16_bf16 v[160:175], v[72:75], v[64:67], v[160:175]
    s_waitcnt lgkmcnt(8)
    v_mfma_f32_32x32x16_bf16 v[176:191], v[72:75], v[68:71], v[176:191]
    ds_read_b64_tr_b16 v[108:109], v36 offset:6144
    ds_read_b64_tr_b16 v[110:111], v36 offset:6656
    ds_read_b128 v[100:103], v23
    ds_read_b128 v[104:107], v23 offset:4096
    s_waitcnt lgkmcnt(9)
    v_mfma_f32_32x32x16_bf16 v[160:175], v[84:87], v[76:79], v[160:175]
    s_waitcnt lgkmcnt(8)
    v_mfma_f32_32x32x16_bf16 v[176:191], v[84:87], v[80:83], v[176:191]
    v_add_u32 v20, 0x14000, v20
    v_add_u32 v36, 0xc000, v36
    ds_read_b64_tr_b16 v[72:73], v36 offset:0
    ds_read_b64_tr_b16 v[74:75], v36 offset:512
    ds_read_b128 v[64:67], v20
    ds_read_b128 v[68:71], v20 offset:4096
    s_waitcnt lgkmcnt(9)
    v_mfma_f32_32x32x16_bf16 v[160:175], v[96:99], v[88:91], v[160:175]
    s_waitcnt lgkmcnt(8)
    v_mfma_f32_32x32x16_bf16 v[176:191], v[96:99], v[92:95], v[176:191]
    v_add_u32 v21, 0x14000, v21
    ds_read_b64_tr_b16 v[84:85], v36 offset:2048
    ds_read_b64_tr_b16 v[86:87], v36 offset:2560
    ds_read_b128 v[76:79], v21
    ds_read_b128 v[80:83], v21 offset:4096
    s_waitcnt lgkmcnt(9)
    v_mfma_f32_32x32x16_bf16 v[160:175], v[108:111], v[100:103], v[160:175]
    s_waitcnt lgkmcnt(8)
    v_mfma_f32_32x32x16_bf16 v[176:191], v[108:111], v[104:107], v[176:191]
    v_add_u32 v22, 0x14000, v22
    ds_read_b64_tr_b16 v[96:97], v36 offset:4096
    ds_read_b64_tr_b16 v[98:99], v36 offset:4608
    ds_read_b128 v[88:91], v22
    ds_read_b128 v[92:95], v22 offset:4096
    s_waitcnt lgkmcnt(9)
    v_mfma_f32_32x32x16_bf16 v[160:175], v[72:75], v[64:67], v[160:175]
    s_waitcnt lgkmcnt(8)
    v_mfma_f32_32x32x16_bf16 v[176:191], v[72:75], v[68:71], v[176:191]
    v_add_u32 v23, 0x14000, v23
    ds_read_b64_tr_b16 v[108:109], v36 offset:6144
    ds_read_b64_tr_b16 v[110:111], v36 offset:6656
    ds_read_b128 v[100:103], v23
    ds_read_b128 v[104:107], v23 offset:4096
    s_waitcnt lgkmcnt(9)
    v_mfma_f32_32x32x16_bf16 v[160:175], v[84:87], v[76:79], v[160:175]
    s_waitcnt lgkmcnt(8)
    v_mfma_f32_32x32x16_bf16 v[176:191], v[84:87], v[80:83], v[176:191]
    v_add_u32 v20, 0xffff6000, v20
    v_add_u32 v36, 0xffffe000, v36
    ds_read_b64_tr_b16 v[72:73], v36 offset:0
    ds_read_b64_tr_b16 v[74:75], v36 offset:512
    ds_read_b128 v[64:67], v20
    ds_read_b128 v[68:71], v20 offset:4096
    s_waitcnt lgkmcnt(9)
    v_mfma_f32_32x32x16_bf16 v[160:175], v[96:99], v[88:91], v[160:175]
    s_waitcnt lgkmcnt(8)
    v_mfma_f32_32x32x16_bf16 v[176:191], v[96:99], v[92:95], v[176:191]
    v_add_u32 v21, 0xffff6000, v21
    ds_read_b64_tr_b16 v[84:85], v36 offset:2048
    ds_read_b64_tr_b16 v[86:87], v36 offset:2560
    ds_read_b128 v[76:79], v21
    ds_read_b128 v[80:83], v21 offset:4096
    s_waitcnt lgkmcnt(9)
    v_mfma_f32_32x32x16_bf16 v[160:175], v[108:111], v[100:103], v[160:175]
    s_waitcnt lgkmcnt(8)
    v_mfma_f32_32x32x16_bf16 v[176:191], v[108:111], v[104:107], v[176:191]
    v_add_u32 v22, 0xffff6000, v22
    ds_read_b64_tr_b16 v[96:97], v36 offset:4096
    ds_read_b64_tr_b16 v[98:99], v36 offset:4608
    ds_read_b128 v[88:91], v22
    ds_read_b128 v[92:95], v22 offset:4096
    s_mov_b64 exec, 1
    ds_write_b32 v13, v15 offset:160
    s_mov_b64 exec, -1
    s_waitcnt lgkmcnt(9)
    v_mfma_f32_32x32x16_bf16 v[160:175], v[72:75], v[64:67], v[160:175]
    s_waitcnt lgkmcnt(8)
    v_mfma_f32_32x32x16_bf16 v[176:191], v[72:75], v[68:71], v[176:191]
    v_add_u32 v23, 0xffff6000, v23
    ds_read_b64_tr_b16 v[108:109], v36 offset:6144
    ds_read_b64_tr_b16 v[110:111], v36 offset:6656
    ds_read_b128 v[100:103], v23
    ds_read_b128 v[104:107], v23 offset:4096
    s_waitcnt lgkmcnt(9)
    v_mfma_f32_32x32x16_bf16 v[160:175], v[84:87], v[76:79], v[160:175]
    s_waitcnt lgkmcnt(8)
    v_mfma_f32_32x32x16_bf16 v[176:191], v[84:87], v[80:83], v[176:191]
    v_add_u32 v20, 0x18000, v20
    v_add_u32 v36, 0xffffe000, v36
    ds_read_b64_tr_b16 v[72:73], v36 offset:0
    ds_read_b64_tr_b16 v[74:75], v36 offset:512
    ds_read_b128 v[64:67], v20
    ds_read_b128 v[68:71], v20 offset:4096
    s_waitcnt lgkmcnt(9)
    v_mfma_f32_32x32x16_bf16 v[160:175], v[96:99], v[88:91], v[160:175]
    s_waitcnt lgkmcnt(8)
    v_mfma_f32_32x32x16_bf16 v[176:191], v[96:99], v[92:95], v[176:191]
    v_add_u32 v21, 0x18000, v21
    ds_read_b64_tr_b16 v[84:85], v36 offset:2048
    ds_read_b64_tr_b16 v[86:87], v36 offset:2560
    ds_read_b128 v[76:79], v21
    ds_read_b128 v[80:83], v21 offset:4096
    s_waitcnt lgkmcnt(9)
    v_mfma_f32_32x32x16_bf16 v[160:175], v[108:111], v[100:103], v[160:175]
    s_waitcnt lgkmcnt(8)
    v_mfma_f32_32x32x16_bf16 v[176:191], v[108:111], v[104:107], v[176:191]
    v_add_u32 v22, 0x18000, v22
    ds_read_b64_tr_b16 v[96:97], v36 offset:4096
    ds_read_b64_tr_b16 v[98:99], v36 offset:4608
    ds_read_b128 v[88:91], v22
    ds_read_b128 v[92:95], v22 offset:4096
    s_waitcnt lgkmcnt(9)
    v_mfma_f32_32x32x16_bf16 v[160:175], v[72:75], v[64:67], v[160:175]
    s_waitcnt lgkmcnt(8)
    v_mfma_f32_32x32x16_bf16 v[176:191], v[72:75], v[68:71], v[176:191]
    v_add_u32 v23, 0x18000, v23
    ds_read_b64_tr_b16 v[108:109], v36 offset:6144
    ds_read_b64_tr_b16 v[110:111], v36 offset:6656
    ds_read_b128 v[100:103], v23
    ds_read_b128 v[104:107], v23 offset:4096
    s_waitcnt lgkmcnt(9)
    v_mfma_f32_32x32x16_bf16 v[160:175], v[84:87], v[76:79], v[160:175]
    s_waitcnt lgkmcnt(8)
    v_mfma_f32_32x32x16_bf16 v[176:191], v[84:87], v[80:83], v[176:191]
    v_add_u32 v20, 0xffffc000, v20
    v_add_u32 v36, 0xffff6000, v36
    ds_read_b64_tr_b16 v[72:73], v36 offset:0
    ds_read_b64_tr_b16 v[74:75], v36 offset:512
    ds_read_b128 v[64:67], v20
    ds_read_b128 v[68:71], v20 offset:4096
    s_waitcnt lgkmcnt(9)
    v_mfma_f32_32x32x16_bf16 v[160:175], v[96:99], v[88:91], v[160:175]
    s_waitcnt lgkmcnt(8)
    v_mfma_f32_32x32x16_bf16 v[176:191], v[96:99], v[92:95], v[176:191]
    v_add_u32 v21, 0xffffc000, v21
    ds_read_b64_tr_b16 v[84:85], v36 offset:2048
    ds_read_b64_tr_b16 v[86:87], v36 offset:2560
    ds_read_b128 v[76:79], v21
    ds_read_b128 v[80:83], v21 offset:4096
    s_waitcnt lgkmcnt(9)
    v_mfma_f32_32x32x16_bf16 v[160:175], v[108:111], v[100:103], v[160:175]
    s_waitcnt lgkmcnt(8)
    v_mfma_f32_32x32x16_bf16 v[176:191], v[108:111], v[104:107], v[176:191]
    v_add_u32 v22, 0xffffc000, v22
    ds_read_b64_tr_b16 v[96:97], v36 offset:4096
    ds_read_b64_tr_b16 v[98:99], v36 offset:4608
    ds_read_b128 v[88:91], v22
    ds_read_b128 v[92:95], v22 offset:4096
    s_waitcnt lgkmcnt(9)
    v_mfma_f32_32x32x16_bf16 v[160:175], v[72:75], v[64:67], v[160:175]
    s_waitcnt lgkmcnt(8)
    v_mfma_f32_32x32x16_bf16 v[176:191], v[72:75], v[68:71], v[176:191]
    v_add_u32 v23, 0xffffc000, v23
    ds_read_b64_tr_b16 v[108:109], v36 offset:6144
    ds_read_b64_tr_b16 v[110:111], v36 offset:6656
    ds_read_b128 v[100:103], v23
    ds_read_b128 v[104:107], v23 offset:4096
    s_waitcnt lgkmcnt(9)
    v_mfma_f32_32x32x16_bf16 v[160:175], v[84:87], v[76:79], v[160:175]
    s_waitcnt lgkmcnt(8)
    v_mfma_f32_32x32x16_bf16 v[176:191], v[84:87], v[80:83], v[176:191]
    s_waitcnt lgkmcnt(5)
    v_mfma_f32_32x32x16_bf16 v[160:175], v[96:99], v[88:91], v[160:175]
    s_waitcnt lgkmcnt(4)
    v_mfma_f32_32x32x16_bf16 v[176:191], v[96:99], v[92:95], v[176:191]
    s_waitcnt lgkmcnt(1)
    v_mfma_f32_32x32x16_bf16 v[160:175], v[108:111], v[100:103], v[160:175]
    s_waitcnt lgkmcnt(0)
    v_mfma_f32_32x32x16_bf16 v[176:191], v[108:111], v[104:107], v[176:191]
    s_mov_b64 exec, 1
    ds_write_b32 v13, v15 offset:144
    s_mov_b64 exec, -1
    s_nop 6
    v_cvt_pk_bf16_f32 v64, v160, v161
    v_cvt_pk_bf16_f32 v65, v162, v163
    v_cvt_pk_bf16_f32 v66, v164, v165
    v_cvt_pk_bf16_f32 v67, v166, v167
    v_cvt_pk_bf16_f32 v68, v168, v169
    v_cvt_pk_bf16_f32 v69, v170, v171
    v_cvt_pk_bf16_f32 v70, v172, v173
    v_cvt_pk_bf16_f32 v71, v174, v175
    v_mfma_f32_32x32x16_bf16 v[160:175], v[40:43], v[64:67], 0
    s_nop 0
    v_mfma_f32_32x32x16_bf16 v[160:175], v[44:47], v[68:71], v[160:175]
    v_cvt_pk_bf16_f32 v72, v176, v177
    v_cvt_pk_bf16_f32 v73, v178, v179
    v_cvt_pk_bf16_f32 v74, v180, v181
    v_cvt_pk_bf16_f32 v75, v182, v183
    v_cvt_pk_bf16_f32 v76, v184, v185
    v_cvt_pk_bf16_f32 v77, v186, v187
    v_cvt_pk_bf16_f32 v78, v188, v189
    v_cvt_pk_bf16_f32 v79, v190, v191
    v_mfma_f32_32x32x16_bf16 v[176:191], v[40:43], v[72:75], 0
    s_nop 0
    v_mfma_f32_32x32x16_bf16 v[176:191], v[44:47], v[76:79], v[176:191]
    s_nop 0
    v_cvt_pk_bf16_f32 v64, v160, v161
    v_cvt_pk_bf16_f32 v65, v162, v163
    v_cvt_pk_bf16_f32 v66, v164, v165
    v_cvt_pk_bf16_f32 v67, v166, v167
    v_cvt_pk_bf16_f32 v68, v168, v169
    v_cvt_pk_bf16_f32 v69, v170, v171
    v_cvt_pk_bf16_f32 v70, v172, v173
    v_cvt_pk_bf16_f32 v71, v174, v175
    v_lshlrev_b32 v160, 16, v64
    v_and_b32 v161, 0xffff0000, v64
    v_lshlrev_b32 v162, 16, v65
    v_and_b32 v163, 0xffff0000, v65
    v_lshlrev_b32 v164, 16, v66
    v_and_b32 v165, 0xffff0000, v66
    v_lshlrev_b32 v166, 16, v67
    v_and_b32 v167, 0xffff0000, v67
    v_lshlrev_b32 v168, 16, v68
    v_and_b32 v169, 0xffff0000, v68
    v_lshlrev_b32 v170, 16, v69
    v_and_b32 v171, 0xffff0000, v69
    v_lshlrev_b32 v172, 16, v70
    v_and_b32 v173, 0xffff0000, v70
    v_lshlrev_b32 v174, 16, v71
    v_and_b32 v175, 0xffff0000, v71
    v_cvt_pk_bf16_f32 v72, v176, v177
    v_cvt_pk_bf16_f32 v73, v178, v179
    v_cvt_pk_bf16_f32 v74, v180, v181
    v_cvt_pk_bf16_f32 v75, v182, v183
    v_cvt_pk_bf16_f32 v76, v184, v185
    v_cvt_pk_bf16_f32 v77, v186, v187
    v_cvt_pk_bf16_f32 v78, v188, v189
    v_cvt_pk_bf16_f32 v79, v190, v191
    v_lshlrev_b32 v176, 16, v72
    v_and_b32 v177, 0xffff0000, v72
    v_lshlrev_b32 v178, 16, v73
    v_and_b32 v179, 0xffff0000, v73
    v_lshlrev_b32 v180, 16, v74
    v_and_b32 v181, 0xffff0000, v74
    v_lshlrev_b32 v182, 16, v75
    v_and_b32 v183, 0xffff0000, v75
    v_lshlrev_b32 v184, 16, v76
    v_and_b32 v185, 0xffff0000, v76
    v_lshlrev_b32 v186, 16, v77
    v_and_b32 v187, 0xffff0000, v77
    v_lshlrev_b32 v188, 16, v78
    v_and_b32 v189, 0xffff0000, v78
    v_lshlrev_b32 v190, 16, v79
    v_and_b32 v191, 0xffff0000, v79
    v_max3_f32 v24, v160, v161, v162
    v_max3_f32 v25, v163, v164, v165
    v_max3_f32 v26, v166, v167, v168
    v_max3_f32 v27, v169, v170, v171
    v_max3_f32 v28, v172, v173, v174
    v_max3_f32 v24, v24, v25, v175
    v_max3_f32 v26, v26, v27, v28
    v_max_f32 v24, v24, v26
    v_min3_f32 v30, v160, v161, v162
    v_min3_f32 v31, v163, v164, v165
    v_min3_f32 v32, v166, v167, v168
    v_min3_f32 v33, v169, v170, v171
    v_min3_f32 v34, v172, v173, v174
    v_min3_f32 v30, v30, v31, v175
    v_min3_f32 v32, v32, v33, v34
    v_min_f32 v30, v30, v32
    v_mov_b32 v25, v24
    v_mov_b32 v31, v30
    s_nop 0
    v_permlane32_swap_b32 v24, v25
    v_permlane32_swap_b32 v30, v31
    v_max_f32 v24, v24, v25
    v_min_f32 v30, v30, v31
    v_mul_f32 v24, s52, v24
    v_mul_f32 v30, s48, v30
    v_pk_fma_f32 v[192:193], v[160:161], s[48:49], v[24:25] op_sel_hi:[1,0,0]
    v_pk_fma_f32 v[224:225], v[160:161], s[52:53], v[30:31] op_sel_hi:[1,0,0]
    v_pk_fma_f32 v[194:195], v[162:163], s[48:49], v[24:25] op_sel_hi:[1,0,0]
    v_pk_fma_f32 v[226:227], v[162:163], s[52:53], v[30:31] op_sel_hi:[1,0,0]
    v_pk_fma_f32 v[196:197], v[164:165], s[48:49], v[24:25] op_sel_hi:[1,0,0]
    v_pk_fma_f32 v[228:229], v[164:165], s[52:53], v[30:31] op_sel_hi:[1,0,0]
    v_pk_fma_f32 v[198:199], v[166:167], s[48:49], v[24:25] op_sel_hi:[1,0,0]
    v_pk_fma_f32 v[230:231], v[166:167], s[52:53], v[30:31] op_sel_hi:[1,0,0]
    v_pk_fma_f32 v[200:201], v[168:169], s[48:49], v[24:25] op_sel_hi:[1,0,0]
    v_pk_fma_f32 v[232:233], v[168:169], s[52:53], v[30:31] op_sel_hi:[1,0,0]
    v_pk_fma_f32 v[202:203], v[170:171], s[48:49], v[24:25] op_sel_hi:[1,0,0]
    v_pk_fma_f32 v[234:235], v[170:171], s[52:53], v[30:31] op_sel_hi:[1,0,0]
    v_pk_fma_f32 v[204:205], v[172:173], s[48:49], v[24:25] op_sel_hi:[1,0,0]
    v_pk_fma_f32 v[236:237], v[172:173], s[52:53], v[30:31] op_sel_hi:[1,0,0]
    v_pk_fma_f32 v[206:207], v[174:175], s[48:49], v[24:25] op_sel_hi:[1,0,0]
    v_pk_fma_f32 v[238:239], v[174:175], s[52:53], v[30:31] op_sel_hi:[1,0,0]
    v_exp_f32 v192, v192
    v_exp_f32 v224, v224
    v_exp_f32 v193, v193
    v_exp_f32 v225, v225
    v_exp_f32 v194, v194
    v_exp_f32 v226, v226
    v_exp_f32 v195, v195
    v_exp_f32 v227, v227
    v_exp_f32 v196, v196
    v_exp_f32 v228, v228
    v_exp_f32 v197, v197
    v_exp_f32 v229, v229
    v_exp_f32 v198, v198
    v_exp_f32 v230, v230
    v_exp_f32 v199, v199
    v_exp_f32 v231, v231
    v_exp_f32 v200, v200
    v_exp_f32 v232, v232
    v_exp_f32 v201, v201
    v_exp_f32 v233, v233
    v_exp_f32 v202, v202
    v_exp_f32 v234, v234
    v_exp_f32 v203, v203
    v_exp_f32 v235, v235
    v_exp_f32 v204, v204
    v_exp_f32 v236, v236
    v_exp_f32 v205, v205
    v_exp_f32 v237, v237
    v_exp_f32 v206, v206
    v_exp_f32 v238, v238
    v_exp_f32 v207, v207
    v_exp_f32 v239, v239
    v_pk_add_f32 v[24:25], v[192:193], v[194:195]
    v_pk_add_f32 v[26:27], v[196:197], v[198:199]
    v_pk_add_f32 v[28:29], v[200:201], v[202:203]
    v_pk_add_f32 v[30:31], v[224:225], v[226:227]
    v_pk_add_f32 v[32:33], v[228:229], v[230:231]
    v_pk_add_f32 v[34:35], v[232:233], v[234:235]
    v_pk_add_f32 v[24:25], v[24:25], v[204:205]
    v_pk_add_f32 v[26:27], v[26:27], v[206:207]
    v_pk_add_f32 v[30:31], v[30:31], v[236:237]
    v_pk_add_f32 v[32:33], v[32:33], v[238:239]
    v_pk_add_f32 v[24:25], v[24:25], v[28:29]
    v_pk_add_f32 v[30:31], v[30:31], v[34:35]
    v_pk_add_f32 v[24:25], v[24:25], v[26:27]
    v_pk_add_f32 v[30:31], v[30:31], v[32:33]
    v_add_f32 v24, v24, v25
    v_add_f32 v30, v30, v31
    v_mov_b32 v25, v24
    v_mov_b32 v31, v30
    s_nop 0
    v_permlane32_swap_b32 v24, v25
    v_permlane32_swap_b32 v30, v31
    v_add_f32 v24, v24, v25
    v_add_f32 v30, v30, v31
    v_rcp_f32 v24, v24
    v_rcp_f32 v30, v30
    v_pk_mul_f32 v[192:193], v[192:193], v[24:25] op_sel_hi:[1,0]
    v_pk_mul_f32 v[224:225], v[224:225], v[30:31] op_sel_hi:[1,0]
    v_pk_mul_f32 v[194:195], v[194:195], v[24:25] op_sel_hi:[1,0]
    v_pk_mul_f32 v[226:227], v[226:227], v[30:31] op_sel_hi:[1,0]
    v_pk_mul_f32 v[196:197], v[196:197], v[24:25] op_sel_hi:[1,0]
    v_pk_mul_f32 v[228:229], v[228:229], v[30:31] op_sel_hi:[1,0]
    v_pk_mul_f32 v[198:199], v[198:199], v[24:25] op_sel_hi:[1,0]
    v_pk_mul_f32 v[230:231], v[230:231], v[30:31] op_sel_hi:[1,0]
    v_pk_mul_f32 v[200:201], v[200:201], v[24:25] op_sel_hi:[1,0]
    v_pk_mul_f32 v[232:233], v[232:233], v[30:31] op_sel_hi:[1,0]
    v_pk_mul_f32 v[202:203], v[202:203], v[24:25] op_sel_hi:[1,0]
    v_pk_mul_f32 v[234:235], v[234:235], v[30:31] op_sel_hi:[1,0]
    v_pk_mul_f32 v[204:205], v[204:205], v[24:25] op_sel_hi:[1,0]
    v_pk_mul_f32 v[236:237], v[236:237], v[30:31] op_sel_hi:[1,0]
    v_pk_mul_f32 v[206:207], v[206:207], v[24:25] op_sel_hi:[1,0]
    v_pk_mul_f32 v[238:239], v[238:239], v[30:31] op_sel_hi:[1,0]
    v_cvt_pk_bf16_f32 v80, v192, v193
    v_cvt_pk_bf16_f32 v88, v224, v225
    v_cvt_pk_bf16_f32 v81, v194, v195
    v_cvt_pk_bf16_f32 v89, v226, v227
    v_cvt_pk_bf16_f32 v82, v196, v197
    v_cvt_pk_bf16_f32 v90, v228, v229
    v_cvt_pk_bf16_f32 v83, v198, v199
    v_cvt_pk_bf16_f32 v91, v230, v231
    v_cvt_pk_bf16_f32 v84, v200, v201
    v_cvt_pk_bf16_f32 v92, v232, v233
    v_cvt_pk_bf16_f32 v85, v202, v203
    v_cvt_pk_bf16_f32 v93, v234, v235
    v_cvt_pk_bf16_f32 v86, v204, v205
    v_cvt_pk_bf16_f32 v94, v236, v237
    v_cvt_pk_bf16_f32 v87, v206, v207
    v_cvt_pk_bf16_f32 v95, v238, v239
    v_max3_f32 v24, v176, v177, v178
    v_max3_f32 v25, v179, v180, v181
    v_max3_f32 v26, v182, v183, v184
    v_max3_f32 v27, v185, v186, v187
    v_max3_f32 v28, v188, v189, v190
    v_max3_f32 v24, v24, v25, v191
    v_max3_f32 v26, v26, v27, v28
    v_max_f32 v24, v24, v26
    v_min3_f32 v30, v176, v177, v178
    v_min3_f32 v31, v179, v180, v181
    v_min3_f32 v32, v182, v183, v184
    v_min3_f32 v33, v185, v186, v187
    v_min3_f32 v34, v188, v189, v190
    v_min3_f32 v30, v30, v31, v191
    v_min3_f32 v32, v32, v33, v34
    v_min_f32 v30, v30, v32
    v_mov_b32 v25, v24
    v_mov_b32 v31, v30
    s_nop 0
    v_permlane32_swap_b32 v24, v25
    v_permlane32_swap_b32 v30, v31
    v_max_f32 v24, v24, v25
    v_min_f32 v30, v30, v31
    v_mul_f32 v24, s52, v24
    v_mul_f32 v30, s48, v30
    v_pk_fma_f32 v[208:209], v[176:177], s[48:49], v[24:25] op_sel_hi:[1,0,0]
    v_pk_fma_f32 v[240:241], v[176:177], s[52:53], v[30:31] op_sel_hi:[1,0,0]
    v_pk_fma_f32 v[210:211], v[178:179], s[48:49], v[24:25] op_sel_hi:[1,0,0]
    v_pk_fma_f32 v[242:243], v[178:179], s[52:53], v[30:31] op_sel_hi:[1,0,0]
    v_pk_fma_f32 v[212:213], v[180:181], s[48:49], v[24:25] op_sel_hi:[1,0,0]
    v_pk_fma_f32 v[244:245], v[180:181], s[52:53], v[30:31] op_sel_hi:[1,0,0]
    v_pk_fma_f32 v[214:215], v[182:183], s[48:49], v[24:25] op_sel_hi:[1,0,0]
    v_pk_fma_f32 v[246:247], v[182:183], s[52:53], v[30:31] op_sel_hi:[1,0,0]
    v_pk_fma_f32 v[216:217], v[184:185], s[48:49], v[24:25] op_sel_hi:[1,0,0]
    v_pk_fma_f32 v[248:249], v[184:185], s[52:53], v[30:31] op_sel_hi:[1,0,0]
    v_pk_fma_f32 v[218:219], v[186:187], s[48:49], v[24:25] op_sel_hi:[1,0,0]
    v_pk_fma_f32 v[250:251], v[186:187], s[52:53], v[30:31] op_sel_hi:[1,0,0]
    v_pk_fma_f32 v[220:221], v[188:189], s[48:49], v[24:25] op_sel_hi:[1,0,0]
    v_pk_fma_f32 v[252:253], v[188:189], s[52:53], v[30:31] op_sel_hi:[1,0,0]
    v_pk_fma_f32 v[222:223], v[190:191], s[48:49], v[24:25] op_sel_hi:[1,0,0]
    v_pk_fma_f32 v[254:255], v[190:191], s[52:53], v[30:31] op_sel_hi:[1,0,0]
    v_exp_f32 v208, v208
    v_exp_f32 v240, v240
    v_exp_f32 v209, v209
    v_exp_f32 v241, v241
    v_exp_f32 v210, v210
    v_exp_f32 v242, v242
    v_exp_f32 v211, v211
    v_exp_f32 v243, v243
    v_exp_f32 v212, v212
    v_exp_f32 v244, v244
    v_exp_f32 v213, v213
    v_exp_f32 v245, v245
    v_exp_f32 v214, v214
    v_exp_f32 v246, v246
    v_exp_f32 v215, v215
    v_exp_f32 v247, v247
    v_exp_f32 v216, v216
    v_exp_f32 v248, v248
    v_exp_f32 v217, v217
    v_exp_f32 v249, v249
    v_exp_f32 v218, v218
    v_exp_f32 v250, v250
    v_exp_f32 v219, v219
    v_exp_f32 v251, v251
    v_exp_f32 v220, v220
    v_exp_f32 v252, v252
    v_exp_f32 v221, v221
    v_exp_f32 v253, v253
    v_exp_f32 v222, v222
    v_exp_f32 v254, v254
    v_exp_f32 v223, v223
    v_exp_f32 v255, v255
    v_pk_add_f32 v[24:25], v[208:209], v[210:211]
    v_pk_add_f32 v[26:27], v[212:213], v[214:215]
    v_pk_add_f32 v[28:29], v[216:217], v[218:219]
    v_pk_add_f32 v[30:31], v[240:241], v[242:243]
    v_pk_add_f32 v[32:33], v[244:245], v[246:247]
    v_pk_add_f32 v[34:35], v[248:249], v[250:251]
    v_pk_add_f32 v[24:25], v[24:25], v[220:221]
    v_pk_add_f32 v[26:27], v[26:27], v[222:223]
    v_pk_add_f32 v[30:31], v[30:31], v[252:253]
    v_pk_add_f32 v[32:33], v[32:33], v[254:255]
    v_pk_add_f32 v[24:25], v[24:25], v[28:29]
    v_pk_add_f32 v[30:31], v[30:31], v[34:35]
    v_pk_add_f32 v[24:25], v[24:25], v[26:27]
    v_pk_add_f32 v[30:31], v[30:31], v[32:33]
    v_add_f32 v24, v24, v25
    v_add_f32 v30, v30, v31
    v_mov_b32 v25, v24
    v_mov_b32 v31, v30
    s_nop 0
    v_permlane32_swap_b32 v24, v25
    v_permlane32_swap_b32 v30, v31
    v_add_f32 v24, v24, v25
    v_add_f32 v30, v30, v31
    v_rcp_f32 v24, v24
    v_rcp_f32 v30, v30
    v_pk_mul_f32 v[208:209], v[208:209], v[24:25] op_sel_hi:[1,0]
    v_pk_mul_f32 v[240:241], v[240:241], v[30:31] op_sel_hi:[1,0]
    v_pk_mul_f32 v[210:211], v[210:211], v[24:25] op_sel_hi:[1,0]
    v_pk_mul_f32 v[242:243], v[242:243], v[30:31] op_sel_hi:[1,0]
    v_pk_mul_f32 v[212:213], v[212:213], v[24:25] op_sel_hi:[1,0]
    v_pk_mul_f32 v[244:245], v[244:245], v[30:31] op_sel_hi:[1,0]
    v_pk_mul_f32 v[214:215], v[214:215], v[24:25] op_sel_hi:[1,0]
    v_pk_mul_f32 v[246:247], v[246:247], v[30:31] op_sel_hi:[1,0]
    v_pk_mul_f32 v[216:217], v[216:217], v[24:25] op_sel_hi:[1,0]
    v_pk_mul_f32 v[248:249], v[248:249], v[30:31] op_sel_hi:[1,0]
    v_pk_mul_f32 v[218:219], v[218:219], v[24:25] op_sel_hi:[1,0]
    v_pk_mul_f32 v[250:251], v[250:251], v[30:31] op_sel_hi:[1,0]
    v_pk_mul_f32 v[220:221], v[220:221], v[24:25] op_sel_hi:[1,0]
    v_pk_mul_f32 v[252:253], v[252:253], v[30:31] op_sel_hi:[1,0]
    v_pk_mul_f32 v[222:223], v[222:223], v[24:25] op_sel_hi:[1,0]
    v_pk_mul_f32 v[254:255], v[254:255], v[30:31] op_sel_hi:[1,0]
    v_cvt_pk_bf16_f32 v96, v208, v209
    v_cvt_pk_bf16_f32 v104, v240, v241
    v_cvt_pk_bf16_f32 v97, v210, v211
    v_cvt_pk_bf16_f32 v105, v242, v243
    v_cvt_pk_bf16_f32 v98, v212, v213
    v_cvt_pk_bf16_f32 v106, v244, v245
    v_cvt_pk_bf16_f32 v99, v214, v215
    v_cvt_pk_bf16_f32 v107, v246, v247
    v_cvt_pk_bf16_f32 v100, v216, v217
    v_cvt_pk_bf16_f32 v108, v248, v249
    v_cvt_pk_bf16_f32 v101, v218, v219
    v_cvt_pk_bf16_f32 v109, v250, v251
    v_cvt_pk_bf16_f32 v102, v220, v221
    v_cvt_pk_bf16_f32 v110, v252, v253
    v_cvt_pk_bf16_f32 v103, v222, v223
    v_cvt_pk_bf16_f32 v111, v254, v255
    s_lshl_b32 s12, s19, 1
    s_add_u32 s23, s12, s22
    s_lshl_b32 s12, s23, 12
    s_add_u32 s43, s12, 32768
    s_lshl_b32 s14, s23, 10
    s_add_u32 s46, s14, 163840
    v_lshlrev_b32 v52, 7, v3
    v_lshrrev_b32 v53, 2, v4
    v_lshlrev_b32 v53, 7, v53
    s_lshl_b32 s40, s18, 1
    s_add_u32 s40, s40, s21
    s_lshl_b32 s41, s40, 6
    s_add_u32 s41, s41, s23
    s_lshl_b32 s41, s41, 11
    s_add_u32 s41, s41, 8388608
    s_add_u32 s42, s41, 65536
    s_lshl_b32 s12, s18, 10
    s_lshl_b32 s40, s21, 5
    s_add_u32 s40, s40, s12
    s_add_u32 s40, s40, s23
    s_lshl_b32 s40, s40, 2
    s_add_u32 s40, s40, 524288
    s_sub_u32 s21, s72, 1
    s_mov_b32 s22, s73
    s_mov_b32 s23, s74
    s_lshl_b32 s40, s18, 1
    s_lshr_b32 s12, s20, 1
    s_add_u32 s40, s40, s12
    s_lshl_b32 s40, s40, 5
    s_lshl_b32 s12, s19, 1
    s_add_u32 s40, s40, s12
    s_and_b32 s12, s20, 1
    s_add_u32 s40, s40, s12
    s_lshl_b32 s40, s40, 7
    s_add_u32 s40, s40, 6291456
    s_and_b32 s88, s16, 1
    s_lshl_b32 s88, s88, 3
    s_lshr_b32 s89, s16, 1
    s_lshl_b32 s89, s89, 1
    s_add_u32 s88, s88, s89
    s_lshr_b32 s89, s17, 4
    s_add_u32 s88, s88, s89
    s_and_b32 s89, s17, 15
    s_mov_b32 s68, s58
    s_and_b32 s69, s59, 0xffff
    s_mov_b32 s70, 4194304
    s_mov_b32 s71, 0x00020000
    s_and_b32 s90, s20, 3
    s_lshr_b32 s91, s20, 2
    s_lshl_b32 s12, s88, 3
    s_lshl_b32 s13, s90, 1
    s_add_u32 s12, s12, s13
    s_add_u32 s92, s12, s91
    s_lshl_b32 s12, s92, 4
    v_and_b32 v3, 15, v2
    v_add_u32 v6, s12, v3
    v_lshlrev_b32 v8, 2, v6
    v_bfe_u32 v9, v2, 4, 1
    v_lshrrev_b32 v10, 5, v2
    v_lshlrev_b32 v7, 11, v6
    v_lshl_add_u32 v7, v9, 6, v7
    v_lshl_add_u32 v7, v10, 4, v7
    s_lshl_b32 s12, s89, 7
    v_add_u32 v7, s12, v7
    s_mov_b32 s12, 4096
    buffer_load_dwordx4 v[24:27], v7, s[24:27], 0 offen
    buffer_load_dwordx4 v[28:31], v7, s[24:27], 0 offen offset:32
    buffer_load_dword v48, v8, s[32:35], s12 offen sc1
    v_lshlrev_b32 v22, 8, v3
    v_lshl_add_u32 v22, v9, 7, v22
    v_lshl_add_u32 v22, v10, 5, v22
    v_lshlrev_b32 v10, 9, v10
    v_bfe_u32 v11, v2, 2, 2
    v_lshl_add_u32 v10, v11, 7, v10
    v_bfe_u32 v11, v2, 3, 1
    v_lshl_add_u32 v10, v11, 6, v10
    v_lshl_add_u32 v10, v9, 5, v10
    v_and_b32 v11, 3, v2
    v_lshl_add_u32 v10, v11, 3, v10
    v_xor_b32 v11, 64, v10
    s_lshl_b32 s12, s91, 8
    v_xor_b32 v17, s12, v5
    v_lshlrev_b32 v8, 2, v3
    s_lshl_b32 s12, s20, 12
    s_mov_b32 s15, 32768
    s_cmp_lt_u32 s20, 6
    s_cselect_b32 s13, s15, 131072
    s_add_u32 s12, s12, s13
    v_add_u32 v20, s12, v5
    s_xor_b32 s14, s20, 4
    s_lshl_b32 s12, s14, 12
    s_cmp_lt_u32 s14, 6
    s_cselect_b32 s13, s15, 131072
    s_add_u32 s12, s12, s13
    v_add_u32 v21, s12, v5
    s_lshl_b32 s12, s88, 2
    s_add_u32 s12, s12, s90
    s_lshl_b32 s13, s12, 16
    s_lshl_b32 s14, s91, 15
    s_add_u32 s13, s13, s14
    s_add_u32 s95, s13, 8388608
    s_lshl_b32 s12, s88, 12
    s_lshl_b32 s13, s89, 8
    s_mul_i32 s13, s13, 1
    s_add_u32 s12, s12, s13
    s_lshr_b32 s13, s90, 1
    s_lshl_b32 s13, s13, 7
    s_add_u32 s12, s12, s13
    s_lshl_b32 s13, s91, 6
    s_add_u32 s12, s12, s13
    s_add_u32 s15, s12, 524288
    s_lshl_b32 s97, s91, 4
    v_lshlrev_b32 v8, 7, v3
    s_lshl_b32 s12, s88, 1
    s_lshr_b32 s13, s90, 1
    s_add_u32 s12, s12, s13
    s_lshl_b32 s12, s12, 12
    s_lshl_b32 s13, s91, 11
    s_add_u32 s12, s12, s13
    s_and_b32 s13, s89, 0
    s_lshl_b32 s13, s13, 17
    s_add_u32 s12, s12, s13
    s_add_u32 s15, s12, 6291456
    s_mov_b32 s93, s89
    s_waitcnt vmcnt(0)
    v_sub_f32 v50, 1.0, v48
    v_cvt_pk_bf16_f32 v50, v50, v50
    v_lshlrev_b32 v50, 16, v50
    v_lshlrev_b32 v32, 16, v24
    v_and_b32 v33, 0xffff0000, v24
    v_lshlrev_b32 v34, 16, v25
    v_and_b32 v35, 0xffff0000, v25
    v_lshlrev_b32 v36, 16, v26
    v_and_b32 v37, 0xffff0000, v26
    v_lshlrev_b32 v38, 16, v27
    v_and_b32 v39, 0xffff0000, v27
    v_lshlrev_b32 v40, 16, v28
    v_and_b32 v41, 0xffff0000, v28
    v_lshlrev_b32 v42, 16, v29
    v_and_b32 v43, 0xffff0000, v29
    v_lshlrev_b32 v44, 16, v30
    v_and_b32 v45, 0xffff0000, v30
    v_lshlrev_b32 v46, 16, v31
    v_and_b32 v47, 0xffff0000, v31
    v_pk_mul_f32 v[32:33], v[32:33], v[50:51] op_sel_hi:[1,0]
    v_pk_mul_f32 v[34:35], v[34:35], v[50:51] op_sel_hi:[1,0]
    v_pk_mul_f32 v[36:37], v[36:37], v[50:51] op_sel_hi:[1,0]
    v_pk_mul_f32 v[38:39], v[38:39], v[50:51] op_sel_hi:[1,0]
    v_pk_mul_f32 v[40:41], v[40:41], v[50:51] op_sel_hi:[1,0]
    v_pk_mul_f32 v[42:43], v[42:43], v[50:51] op_sel_hi:[1,0]
    v_pk_mul_f32 v[44:45], v[44:45], v[50:51] op_sel_hi:[1,0]
    v_pk_mul_f32 v[46:47], v[46:47], v[50:51] op_sel_hi:[1,0]
    v_cvt_pk_bf16_f32 v33, v32, v33
    v_cvt_pk_bf16_f32 v35, v34, v35
    v_cvt_pk_bf16_f32 v37, v36, v37
    v_cvt_pk_bf16_f32 v39, v38, v39
    v_cvt_pk_bf16_f32 v41, v40, v41
    v_cvt_pk_bf16_f32 v43, v42, v43
    v_cvt_pk_bf16_f32 v45, v44, v45
    v_cvt_pk_bf16_f32 v47, v46, v47
    v_permlane32_swap_b32 v33, v37
    v_permlane32_swap_b32 v35, v39
    v_permlane32_swap_b32 v41, v45
    v_permlane32_swap_b32 v43, v47
    v_lshlrev_b32 v32, 16, v33
    v_and_b32 v33, 0xffff0000, v33
    v_lshlrev_b32 v34, 16, v35
    v_and_b32 v35, 0xffff0000, v35
    v_lshlrev_b32 v36, 16, v37
    v_and_b32 v37, 0xffff0000, v37
    v_lshlrev_b32 v38, 16, v39
    v_and_b32 v39, 0xffff0000, v39
    v_lshlrev_b32 v40, 16, v41
    v_and_b32 v41, 0xffff0000, v41
    v_lshlrev_b32 v42, 16, v43
    v_and_b32 v43, 0xffff0000, v43
    v_lshlrev_b32 v44, 16, v45
    v_and_b32 v45, 0xffff0000, v45
    v_lshlrev_b32 v46, 16, v47
    v_and_b32 v47, 0xffff0000, v47
    s_mov_b32 s13, 0
    v_mov_b32 v54, 162896
L_c_kz:
    ds_read_b32 v55, v54
    s_add_u32 s13, s13, 1
    s_cmp_ge_u32 s13, 262144
    s_cbranch_scc1 L_c_kzok
    s_waitcnt lgkmcnt(0)
    v_cmp_eq_u32 vcc, 1, v55
    s_cbranch_vccz L_c_kz
L_c_kzok:
    s_mov_b32 s13, 0
L_c_kv:
    buffer_load_dwordx4 v[112:115], v5, s[32:35], s43 offen offset:0 sc1
    buffer_load_dwordx4 v[116:119], v5, s[32:35], s43 offen offset:1024 sc1
    buffer_load_dwordx4 v[120:123], v5, s[32:35], s43 offen offset:2048 sc1
    buffer_load_dwordx4 v[124:127], v5, s[32:35], s43 offen offset:3072 sc1
    buffer_load_dwordx4 v[128:131], v52, s[32:35], s46 offen offset:0 sc1
    buffer_load_dwordx4 v[132:135], v52, s[32:35], s46 offen offset:256 sc1
    buffer_load_dwordx4 v[136:139], v52, s[32:35], s46 offen offset:512 sc1
    buffer_load_dwordx4 v[140:143], v52, s[32:35], s46 offen offset:768 sc1
    s_add_u32 s13, s13, 1
    s_waitcnt vmcnt(0)
    v_max3_u32 v55, v112, v113, v114
    v_max3_u32 v55, v55, v115, v116
    v_max3_u32 v55, v55, v117, v118
    v_max3_u32 v55, v55, v119, v120
    v_max3_u32 v55, v55, v121, v122
    v_max3_u32 v55, v55, v123, v124
    v_max3_u32 v55, v55, v125, v126
    v_max3_u32 v55, v55, v127, v128
    v_max3_u32 v55, v55, v129, v130
    v_max3_u32 v55, v55, v131, v132
    v_max3_u32 v55, v55, v133, v134
    v_max3_u32 v55, v55, v135, v136
    v_max3_u32 v55, v55, v137, v138
    v_max3_u32 v55, v55, v139, v140
    v_max3_u32 v55, v55, v141, v142
    v_max_u32 v55, v55, v143
    v_cmp_eq_u32 vcc, -1, v55
    s_cbranch_vccz L_c_kvok
    s_cmp_lt_u32 s13, 16384
    s_cbranch_scc1 L_c_kv
L_c_kvok:
    v_mfma_f32_32x32x16_bf16 v[192:207], v[128:131], v[80:83], 0
    v_mfma_f32_32x32x16_bf16 v[192:207], v[132:135], v[84:87], v[192:207]
    v_mfma_f32_32x32x16_bf16 v[192:207], v[136:139], v[88:91], v[192:207]
    v_mfma_f32_32x32x16_bf16 v[192:207], v[140:143], v[92:95], v[192:207]
    v_mfma_f32_32x32x16_bf16 v[160:175], v[112:115], v[80:83], 0
    s_mov_b32 s45, 0
    s_lshr_b32 s12, s21, 4
    s_cmp_eq_u32 s12, s92
    s_cselect_b32 s46, 1, 0
    s_mov_b32 s45, 1
    v_mfma_f32_32x32x16_bf16 v[160:175], v[116:119], v[84:87], v[160:175]
    v_mov_b32 v56, s23
    v_mov_b32 v57, s23
    v_mov_b32 v58, s23
    v_mov_b32 v59, s23
    v_mfma_f32_32x32x16_bf16 v[160:175], v[120:123], v[88:91], v[160:175]
    v_lshrrev_b32 v60, 3, v2
    v_lshlrev_b32 v60, 17, v60
    v_and_b32 v61, 0x70, v5
    v_add_u32 v60, v60, v61
    v_mfma_f32_32x32x16_bf16 v[160:175], v[124:127], v[92:95], v[160:175]
    v_cvt_pk_bf16_f32 v54, 0, v192
    v_add_f32 v54, 0x358637bd, v54
    v_cvt_pk_bf16_f32 v54, 0, v54
    v_rcp_f32 v54, v54
    v_mfma_f32_32x32x16_bf16 v[208:223], v[128:131], v[96:99], 0
    s_nop 6
    v_cvt_pk_bf16_f32 v160, 0, v160
    v_cvt_pk_bf16_f32 v161, 0, v161
    v_cvt_pk_bf16_f32 v162, 0, v162
    v_cvt_pk_bf16_f32 v163, 0, v163
    v_cvt_pk_bf16_f32 v164, 0, v164
    v_mfma_f32_32x32x16_bf16 v[208:223], v[132:135], v[100:103], v[208:223]
    v_cvt_pk_bf16_f32 v165, 0, v165
    v_cvt_pk_bf16_f32 v166, 0, v166
    v_cvt_pk_bf16_f32 v167, 0, v167
    v_cvt_pk_bf16_f32 v168, 0, v168
    v_cvt_pk_bf16_f32 v169, 0, v169
    v_mfma_f32_32x32x16_bf16 v[208:223], v[136:139], v[104:107], v[208:223]
    v_cvt_pk_bf16_f32 v170, 0, v170
    v_cvt_pk_bf16_f32 v171, 0, v171
    v_cvt_pk_bf16_f32 v172, 0, v172
    v_cvt_pk_bf16_f32 v173, 0, v173
    v_cvt_pk_bf16_f32 v174, 0, v174
    v_mfma_f32_32x32x16_bf16 v[208:223], v[140:143], v[108:111], v[208:223]
    v_cvt_pk_bf16_f32 v175, 0, v175
    v_mul_f32 v160, v160, v54
    v_mul_f32 v161, v161, v54
    v_mul_f32 v162, v162, v54
    v_mul_f32 v163, v163, v54
    v_mfma_f32_32x32x16_bf16 v[176:191], v[112:115], v[96:99], 0
    v_mul_f32 v164, v164, v54
    v_mul_f32 v165, v165, v54
    v_mul_f32 v166, v166, v54
    v_mul_f32 v167, v167, v54
    v_mul_f32 v168, v168, v54
    v_mfma_f32_32x32x16_bf16 v[176:191], v[116:119], v[100:103], v[176:191]
    v_mul_f32 v169, v169, v54
    v_mul_f32 v170, v170, v54
    v_mul_f32 v171, v171, v54
    v_mul_f32 v172, v172, v54
    v_mul_f32 v173, v173, v54
    v_mfma_f32_32x32x16_bf16 v[176:191], v[120:123], v[104:107], v[176:191]
    v_mul_f32 v174, v174, v54
    v_mul_f32 v175, v175, v54
    v_cvt_pk_bf16_f32 v64, v160, v161
    v_cvt_pk_bf16_f32 v65, v162, v163
    v_cvt_pk_bf16_f32 v66, v164, v165
    v_mfma_f32_32x32x16_bf16 v[176:191], v[124:127], v[108:111], v[176:191]
    v_cvt_pk_bf16_f32 v67, v166, v167
    buffer_store_dwordx4 v[64:67], v5, s[32:35], s41 offen sc1
    v_cvt_pk_bf16_f32 v68, v168, v169
    v_cvt_pk_bf16_f32 v69, v170, v171
    v_cvt_pk_bf16_f32 v70, v172, v173
    v_cvt_pk_bf16_f32 v71, v174, v175
    buffer_store_dwordx4 v[68:71], v5, s[32:35], s41 offen offset:1024 sc1
    v_cvt_pk_bf16_f32 v62, 0, v208
    v_add_f32 v62, 0x358637bd, v62
    v_cvt_pk_bf16_f32 v62, 0, v62
    v_rcp_f32 v62, v62
    s_nop 0
    v_cvt_pk_bf16_f32 v176, 0, v176
    v_cvt_pk_bf16_f32 v177, 0, v177
    v_cvt_pk_bf16_f32 v178, 0, v178
    v_cvt_pk_bf16_f32 v179, 0, v179
    v_cvt_pk_bf16_f32 v180, 0, v180
    v_cvt_pk_bf16_f32 v181, 0, v181
    v_cvt_pk_bf16_f32 v182, 0, v182
    v_cvt_pk_bf16_f32 v183, 0, v183
    v_pk_mul_f32 v[176:177], v[176:177], v[62:63] op_sel_hi:[1,0]
    v_pk_mul_f32 v[178:179], v[178:179], v[62:63] op_sel_hi:[1,0]
    v_pk_mul_f32 v[180:181], v[180:181], v[62:63] op_sel_hi:[1,0]
    v_pk_mul_f32 v[182:183], v[182:183], v[62:63] op_sel_hi:[1,0]
    v_cvt_pk_bf16_f32 v72, v176, v177
    v_cvt_pk_bf16_f32 v73, v178, v179
    v_cvt_pk_bf16_f32 v74, v180, v181
    v_cvt_pk_bf16_f32 v75, v182, v183
    buffer_store_dwordx4 v[72:75], v5, s[32:35], s42 offen sc1
    v_cvt_pk_bf16_f32 v184, 0, v184
    v_cvt_pk_bf16_f32 v185, 0, v185
    v_cvt_pk_bf16_f32 v186, 0, v186
    v_cvt_pk_bf16_f32 v187, 0, v187
    v_cvt_pk_bf16_f32 v188, 0, v188
    v_cvt_pk_bf16_f32 v189, 0, v189
    v_cvt_pk_bf16_f32 v190, 0, v190
    v_cvt_pk_bf16_f32 v191, 0, v191
    v_pk_mul_f32 v[184:185], v[184:185], v[62:63] op_sel_hi:[1,0]
    v_pk_mul_f32 v[186:187], v[186:187], v[62:63] op_sel_hi:[1,0]
    v_pk_mul_f32 v[188:189], v[188:189], v[62:63] op_sel_hi:[1,0]
    v_pk_mul_f32 v[190:191], v[190:191], v[62:63] op_sel_hi:[1,0]
    v_cvt_pk_bf16_f32 v76, v184, v185
    v_cvt_pk_bf16_f32 v77, v186, v187
    v_cvt_pk_bf16_f32 v78, v188, v189
    v_cvt_pk_bf16_f32 v79, v190, v191
    buffer_store_dwordx4 v[76:79], v5, s[32:35], s42 offen offset:1024 sc1
    s_waitcnt vmcnt(0)
    s_mov_b32 exec_lo, 0xff
    s_mov_b32 exec_hi, 0
    buffer_store_dwordx4 v[56:59], v60, s[32:35], s40 offen sc1
    s_mov_b64 exec, -1
L_phaseb:
    s_setprio 0
    s_nop 4
L_own_r0:
    s_nop 0
    s_barrier
    s_mov_b32 s14, 0xffff0000
    s_mov_b32 s47, 0
    s_mov_b32 s96, 0
    s_cmp_lg_u32 s96, 0
    s_cbranch_scc1 L_pk0
L_pl0:
    buffer_load_dword v52, v8, s[32:35], s15 offen sc1
    s_add_u32 s47, s47, 1
    s_cmp_ge_u32 s47, 16384
    s_cselect_b32 s12, -1, 0
    s_waitcnt vmcnt(0)
    v_cmp_eq_u32 vcc, s23, v52
    s_nop 1
    s_or_b32 s12, s12, vcc_lo
    s_lshr_b32 s12, s12, s93
    s_or_b32 s96, s96, s12
    s_andn2_b32 s96, s96, s14
    s_cbranch_scc0 L_pl0
L_pk0:
    s_ff1_i32_b32 s12, s96
    s_bitset0_b32 s96, s12
    s_bitset1_b32 s14, s12
    s_add_u32 s12, s12, s93
    s_and_b32 s80, s12, 15
    s_lshl_b32 s94, s80, 11
    s_add_u32 s94, s94, s95
    buffer_load_dwordx4 v[96:99], v17, s[32:35], s94 offen
    buffer_load_dwordx4 v[100:103], v17, s[32:35], s94 offen offset:1024
    s_add_u32 s12, s80, s97
    s_lshl_b32 s13, s12, 12
    s_cmp_ge_u32 s12, 8
    s_cselect_b32 s12, 24576, 0
    s_add_u32 s13, s13, s12
    v_add_u32 v12, s13, v10
    v_add_u32 v13, s13, v11
    ds_read_b64_tr_b16 v[120:121], v12 offset:0
    ds_read_b64_tr_b16 v[122:123], v12 offset:1024
    ds_read_b64_tr_b16 v[124:125], v13 offset:0
    ds_read_b64_tr_b16 v[126:127], v13 offset:1024
    ds_read_b64_tr_b16 v[128:129], v12 offset:2048
    ds_read_b64_tr_b16 v[130:131], v12 offset:3072
    ds_read_b64_tr_b16 v[132:133], v13 offset:2048
    ds_read_b64_tr_b16 v[134:135], v13 offset:3072
    s_cmp_lg_u32 s96, 0
    s_cbranch_scc1 L_pk1
L_pl1:
    buffer_load_dword v53, v8, s[32:35], s15 offen sc1
    s_add_u32 s47, s47, 1
    s_cmp_ge_u32 s47, 16384
    s_cselect_b32 s12, -1, 0
    s_waitcnt vmcnt(0)
    v_cmp_eq_u32 vcc, s23, v53
    s_nop 1
    s_or_b32 s12, s12, vcc_lo
    s_lshr_b32 s12, s12, s93
    s_or_b32 s96, s96, s12
    s_andn2_b32 s96, s96, s14
    s_cbranch_scc0 L_pl1
L_pk1:
    s_ff1_i32_b32 s12, s96
    s_bitset0_b32 s96, s12
    s_bitset1_b32 s14, s12
    s_add_u32 s12, s12, s93
    s_and_b32 s81, s12, 15
    s_lshl_b32 s94, s81, 11
    s_add_u32 s94, s94, s95
    buffer_load_dwordx4 v[104:107], v17, s[32:35], s94 offen
    buffer_load_dwordx4 v[108:111], v17, s[32:35], s94 offen offset:1024
    s_cmp_lg_u32 s96, 0
    s_cbranch_scc1 L_pk2
L_pl2:
    buffer_load_dword v54, v8, s[32:35], s15 offen sc1
    s_add_u32 s47, s47, 1
    s_cmp_ge_u32 s47, 16384
    s_cselect_b32 s12, -1, 0
    s_waitcnt vmcnt(0)
    v_cmp_eq_u32 vcc, s23, v54
    s_nop 1
    s_or_b32 s12, s12, vcc_lo
    s_lshr_b32 s12, s12, s93
    s_or_b32 s96, s96, s12
    s_andn2_b32 s96, s96, s14
    s_cbranch_scc0 L_pl2
L_pk2:
    s_ff1_i32_b32 s12, s96
    s_bitset0_b32 s96, s12
    s_bitset1_b32 s14, s12
    s_add_u32 s12, s12, s93
    s_and_b32 s82, s12, 15
    s_lshl_b32 s94, s82, 11
    s_add_u32 s94, s94, s95
    buffer_load_dwordx4 v[112:115], v17, s[32:35], s94 offen
    buffer_load_dwordx4 v[116:119], v17, s[32:35], s94 offen offset:1024
    s_add_u32 s12, s81, s97
    s_lshl_b32 s13, s12, 12
    s_cmp_ge_u32 s12, 8
    s_cselect_b32 s12, 24576, 0
    s_add_u32 s13, s13, s12
    v_add_u32 v14, s13, v10
    v_add_u32 v15, s13, v11
    s_waitcnt vmcnt(4)
    s_waitcnt lgkmcnt(6)
    v_mfma_f32_32x32x16_bf16 v[64:79], v[120:123], v[96:99], 0
    ds_read_b64_tr_b16 v[136:137], v14 offset:0
    ds_read_b64_tr_b16 v[138:139], v14 offset:1024
    s_waitcnt lgkmcnt(6)
    v_mfma_f32_32x32x16_bf16 v[80:95], v[124:127], v[96:99], 0
    ds_read_b64_tr_b16 v[140:141], v15 offset:0
    ds_read_b64_tr_b16 v[142:143], v15 offset:1024
    s_waitcnt lgkmcnt(6)
    v_mfma_f32_32x32x16_bf16 v[64:79], v[128:131], v[100:103], v[64:79]
    ds_read_b64_tr_b16 v[144:145], v14 offset:2048
    ds_read_b64_tr_b16 v[146:147], v14 offset:3072
    s_waitcnt lgkmcnt(6)
    v_mfma_f32_32x32x16_bf16 v[80:95], v[132:135], v[100:103], v[80:95]
    ds_read_b64_tr_b16 v[148:149], v15 offset:2048
    ds_read_b64_tr_b16 v[150:151], v15 offset:3072
    s_cmp_lg_u32 s96, 0
    s_cbranch_scc1 L_pk3
L_pl3:
    buffer_load_dword v55, v8, s[32:35], s15 offen sc1
    s_add_u32 s47, s47, 1
    s_cmp_ge_u32 s47, 16384
    s_cselect_b32 s12, -1, 0
    s_waitcnt vmcnt(0)
    v_cmp_eq_u32 vcc, s23, v55
    s_nop 1
    s_or_b32 s12, s12, vcc_lo
    s_lshr_b32 s12, s12, s93
    s_or_b32 s96, s96, s12
    s_andn2_b32 s96, s96, s14
    s_cbranch_scc0 L_pl3
L_pk3:
    s_ff1_i32_b32 s12, s96
    s_bitset0_b32 s96, s12
    s_bitset1_b32 s14, s12
    s_add_u32 s12, s12, s93
    s_and_b32 s83, s12, 15
    s_lshl_b32 s94, s83, 11
    s_add_u32 s94, s94, s95
    buffer_load_dwordx4 v[96:99], v17, s[32:35], s94 offen
    buffer_load_dwordx4 v[100:103], v17, s[32:35], s94 offen offset:1024
    s_add_u32 s12, s82, s97
    s_lshl_b32 s13, s12, 12
    s_cmp_ge_u32 s12, 8
    s_cselect_b32 s12, 24576, 0
    s_add_u32 s13, s13, s12
    v_add_u32 v12, s13, v10
    v_add_u32 v13, s13, v11
    s_waitcnt vmcnt(4)
    s_waitcnt lgkmcnt(6)
    v_mfma_f32_32x32x16_bf16 v[64:79], v[136:139], v[104:107], v[64:79]
    ds_read_b64_tr_b16 v[120:121], v12 offset:0
    ds_read_b64_tr_b16 v[122:123], v12 offset:1024
    s_waitcnt lgkmcnt(6)
    v_mfma_f32_32x32x16_bf16 v[80:95], v[140:143], v[104:107], v[80:95]
    ds_read_b64_tr_b16 v[124:125], v13 offset:0
    ds_read_b64_tr_b16 v[126:127], v13 offset:1024
    s_waitcnt lgkmcnt(6)
    v_mfma_f32_32x32x16_bf16 v[64:79], v[144:147], v[108:111], v[64:79]
    ds_read_b64_tr_b16 v[128:129], v12 offset:2048
    ds_read_b64_tr_b16 v[130:131], v12 offset:3072
    s_waitcnt lgkmcnt(6)
    v_mfma_f32_32x32x16_bf16 v[80:95], v[148:151], v[108:111], v[80:95]
    ds_read_b64_tr_b16 v[132:133], v13 offset:2048
    ds_read_b64_tr_b16 v[134:135], v13 offset:3072
    s_cmp_lg_u32 s96, 0
    s_cbranch_scc1 L_pk4
L_pl4:
    buffer_load_dword v56, v8, s[32:35], s15 offen sc1
    s_add_u32 s47, s47, 1
    s_cmp_ge_u32 s47, 16384
    s_cselect_b32 s12, -1, 0
    s_waitcnt vmcnt(0)
    v_cmp_eq_u32 vcc, s23, v56
    s_nop 1
    s_or_b32 s12, s12, vcc_lo
    s_lshr_b32 s12, s12, s93
    s_or_b32 s96, s96, s12
    s_andn2_b32 s96, s96, s14
    s_cbranch_scc0 L_pl4
L_pk4:
    s_ff1_i32_b32 s12, s96
    s_bitset0_b32 s96, s12
    s_bitset1_b32 s14, s12
    s_add_u32 s12, s12, s93
    s_and_b32 s84, s12, 15
    s_lshl_b32 s94, s84, 11
    s_add_u32 s94, s94, s95
    buffer_load_dwordx4 v[104:107], v17, s[32:35], s94 offen
    buffer_load_dwordx4 v[108:111], v17, s[32:35], s94 offen offset:1024
    s_add_u32 s12, s83, s97
    s_lshl_b32 s13, s12, 12
    s_cmp_ge_u32 s12, 8
    s_cselect_b32 s12, 24576, 0
    s_add_u32 s13, s13, s12
    v_add_u32 v14, s13, v10
    v_add_u32 v15, s13, v11
    s_waitcnt vmcnt(4)
    s_waitcnt lgkmcnt(6)
    v_mfma_f32_32x32x16_bf16 v[64:79], v[120:123], v[112:115], v[64:79]
    ds_read_b64_tr_b16 v[136:137], v14 offset:0
    ds_read_b64_tr_b16 v[138:139], v14 offset:1024
    s_waitcnt lgkmcnt(6)
    v_mfma_f32_32x32x16_bf16 v[80:95], v[124:127], v[112:115], v[80:95]
    ds_read_b64_tr_b16 v[140:141], v15 offset:0
    ds_read_b64_tr_b16 v[142:143], v15 offset:1024
    s_waitcnt lgkmcnt(6)
    v_mfma_f32_32x32x16_bf16 v[64:79], v[128:131], v[116:119], v[64:79]
    ds_read_b64_tr_b16 v[144:145], v14 offset:2048
    ds_read_b64_tr_b16 v[146:147], v14 offset:3072
    s_waitcnt lgkmcnt(6)
    v_mfma_f32_32x32x16_bf16 v[80:95], v[132:135], v[116:119], v[80:95]
    ds_read_b64_tr_b16 v[148:149], v15 offset:2048
    ds_read_b64_tr_b16 v[150:151], v15 offset:3072
    s_cmp_lg_u32 s96, 0
    s_cbranch_scc1 L_pk5
L_pl5:
    buffer_load_dword v57, v8, s[32:35], s15 offen sc1
    s_add_u32 s47, s47, 1
    s_cmp_ge_u32 s47, 16384
    s_cselect_b32 s12, -1, 0
    s_waitcnt vmcnt(0)
    v_cmp_eq_u32 vcc, s23, v57
    s_nop 1
    s_or_b32 s12, s12, vcc_lo
    s_lshr_b32 s12, s12, s93
    s_or_b32 s96, s96, s12
    s_andn2_b32 s96, s96, s14
    s_cbranch_scc0 L_pl5
L_pk5:
    s_ff1_i32_b32 s12, s96
    s_bitset0_b32 s96, s12
    s_bitset1_b32 s14, s12
    s_add_u32 s12, s12, s93
    s_and_b32 s85, s12, 15
    s_lshl_b32 s94, s85, 11
    s_add_u32 s94, s94, s95
    buffer_load_dwordx4 v[112:115], v17, s[32:35], s94 offen
    buffer_load_dwordx4 v[116:119], v17, s[32:35], s94 offen offset:1024
    s_add_u32 s12, s84, s97
    s_lshl_b32 s13, s12, 12
    s_cmp_ge_u32 s12, 8
    s_cselect_b32 s12, 24576, 0
    s_add_u32 s13, s13, s12
    v_add_u32 v12, s13, v10
    v_add_u32 v13, s13, v11
    s_waitcnt vmcnt(4)
    s_waitcnt lgkmcnt(6)
    v_mfma_f32_32x32x16_bf16 v[64:79], v[136:139], v[96:99], v[64:79]
    ds_read_b64_tr_b16 v[120:121], v12 offset:0
    ds_read_b64_tr_b16 v[122:123], v12 offset:1024
    s_waitcnt lgkmcnt(6)
    v_mfma_f32_32x32x16_bf16 v[80:95], v[140:143], v[96:99], v[80:95]
    ds_read_b64_tr_b16 v[124:125], v13 offset:0
    ds_read_b64_tr_b16 v[126:127], v13 offset:1024
    s_waitcnt lgkmcnt(6)
    v_mfma_f32_32x32x16_bf16 v[64:79], v[144:147], v[100:103], v[64:79]
    ds_read_b64_tr_b16 v[128:129], v12 offset:2048
    ds_read_b64_tr_b16 v[130:131], v12 offset:3072
    s_waitcnt lgkmcnt(6)
    v_mfma_f32_32x32x16_bf16 v[80:95], v[148:151], v[100:103], v[80:95]
    ds_read_b64_tr_b16 v[132:133], v13 offset:2048
    ds_read_b64_tr_b16 v[134:135], v13 offset:3072
    s_cmp_lg_u32 s96, 0
    s_cbranch_scc1 L_pk6
L_pl6:
    buffer_load_dword v58, v8, s[32:35], s15 offen sc1
    s_add_u32 s47, s47, 1
    s_cmp_ge_u32 s47, 16384
    s_cselect_b32 s12, -1, 0
    s_waitcnt vmcnt(0)
    v_cmp_eq_u32 vcc, s23, v58
    s_nop 1
    s_or_b32 s12, s12, vcc_lo
    s_lshr_b32 s12, s12, s93
    s_or_b32 s96, s96, s12
    s_andn2_b32 s96, s96, s14
    s_cbranch_scc0 L_pl6
L_pk6:
    s_ff1_i32_b32 s12, s96
    s_bitset0_b32 s96, s12
    s_bitset1_b32 s14, s12
    s_add_u32 s12, s12, s93
    s_and_b32 s86, s12, 15
    s_lshl_b32 s94, s86, 11
    s_add_u32 s94, s94, s95
    buffer_load_dwordx4 v[96:99], v17, s[32:35], s94 offen
    buffer_load_dwordx4 v[100:103], v17, s[32:35], s94 offen offset:1024
    s_add_u32 s12, s85, s97
    s_lshl_b32 s13, s12, 12
    s_cmp_ge_u32 s12, 8
    s_cselect_b32 s12, 24576, 0
    s_add_u32 s13, s13, s12
    v_add_u32 v14, s13, v10
    v_add_u32 v15, s13, v11
    s_waitcnt vmcnt(4)
    s_waitcnt lgkmcnt(6)
    v_mfma_f32_32x32x16_bf16 v[64:79], v[120:123], v[104:107], v[64:79]
    ds_read_b64_tr_b16 v[136:137], v14 offset:0
    ds_read_b64_tr_b16 v[138:139], v14 offset:1024
    s_waitcnt lgkmcnt(6)
    v_mfma_f32_32x32x16_bf16 v[80:95], v[124:127], v[104:107], v[80:95]
    ds_read_b64_tr_b16 v[140:141], v15 offset:0
    ds_read_b64_tr_b16 v[142:143], v15 offset:1024
    s_waitcnt lgkmcnt(6)
    v_mfma_f32_32x32x16_bf16 v[64:79], v[128:131], v[108:111], v[64:79]
    ds_read_b64_tr_b16 v[144:145], v14 offset:2048
    ds_read_b64_tr_b16 v[146:147], v14 offset:3072
    s_waitcnt lgkmcnt(6)
    v_mfma_f32_32x32x16_bf16 v[80:95], v[132:135], v[108:111], v[80:95]
    ds_read_b64_tr_b16 v[148:149], v15 offset:2048
    ds_read_b64_tr_b16 v[150:151], v15 offset:3072
    s_cmp_lg_u32 s96, 0
    s_cbranch_scc1 L_pk7
L_pl7:
    buffer_load_dword v59, v8, s[32:35], s15 offen sc1
    s_add_u32 s47, s47, 1
    s_cmp_ge_u32 s47, 16384
    s_cselect_b32 s12, -1, 0
    s_waitcnt vmcnt(0)
    v_cmp_eq_u32 vcc, s23, v59
    s_nop 1
    s_or_b32 s12, s12, vcc_lo
    s_lshr_b32 s12, s12, s93
    s_or_b32 s96, s96, s12
    s_andn2_b32 s96, s96, s14
    s_cbranch_scc0 L_pl7
L_pk7:
    s_ff1_i32_b32 s12, s96
    s_bitset0_b32 s96, s12
    s_bitset1_b32 s14, s12
    s_add_u32 s12, s12, s93
    s_and_b32 s87, s12, 15
    s_lshl_b32 s94, s87, 11
    s_add_u32 s94, s94, s95
    buffer_load_dwordx4 v[104:107], v17, s[32:35], s94 offen
    buffer_load_dwordx4 v[108:111], v17, s[32:35], s94 offen offset:1024
    s_add_u32 s12, s86, s97
    s_lshl_b32 s13, s12, 12
    s_cmp_ge_u32 s12, 8
    s_cselect_b32 s12, 24576, 0
    s_add_u32 s13, s13, s12
    v_add_u32 v12, s13, v10
    v_add_u32 v13, s13, v11
    s_waitcnt vmcnt(4)
    s_waitcnt lgkmcnt(6)
    v_mfma_f32_32x32x16_bf16 v[64:79], v[136:139], v[112:115], v[64:79]
    ds_read_b64_tr_b16 v[120:121], v12 offset:0
    ds_read_b64_tr_b16 v[122:123], v12 offset:1024
    s_waitcnt lgkmcnt(6)
    v_mfma_f32_32x32x16_bf16 v[80:95], v[140:143], v[112:115], v[80:95]
    ds_read_b64_tr_b16 v[124:125], v13 offset:0
    ds_read_b64_tr_b16 v[126:127], v13 offset:1024
    s_waitcnt lgkmcnt(6)
    v_mfma_f32_32x32x16_bf16 v[64:79], v[144:147], v[116:119], v[64:79]
    ds_read_b64_tr_b16 v[128:129], v12 offset:2048
    ds_read_b64_tr_b16 v[130:131], v12 offset:3072
    s_waitcnt lgkmcnt(6)
    v_mfma_f32_32x32x16_bf16 v[80:95], v[148:151], v[116:119], v[80:95]
    ds_read_b64_tr_b16 v[132:133], v13 offset:2048
    ds_read_b64_tr_b16 v[134:135], v13 offset:3072
    s_cmp_lg_u32 s96, 0
    s_cbranch_scc1 L_pk8
L_pl8:
    buffer_load_dword v52, v8, s[32:35], s15 offen sc1
    s_add_u32 s47, s47, 1
    s_cmp_ge_u32 s47, 16384
    s_cselect_b32 s12, -1, 0
    s_waitcnt vmcnt(0)
    v_cmp_eq_u32 vcc, s23, v52
    s_nop 1
    s_or_b32 s12, s12, vcc_lo
    s_lshr_b32 s12, s12, s93
    s_or_b32 s96, s96, s12
    s_andn2_b32 s96, s96, s14
    s_cbranch_scc0 L_pl8
L_pk8:
    s_ff1_i32_b32 s12, s96
    s_bitset0_b32 s96, s12
    s_bitset1_b32 s14, s12
    s_add_u32 s12, s12, s93
    s_and_b32 s80, s12, 15
    s_lshl_b32 s94, s80, 11
    s_add_u32 s94, s94, s95
    buffer_load_dwordx4 v[112:115], v17, s[32:35], s94 offen
    buffer_load_dwordx4 v[116:119], v17, s[32:35], s94 offen offset:1024
    s_add_u32 s12, s87, s97
    s_lshl_b32 s13, s12, 12
    s_cmp_ge_u32 s12, 8
    s_cselect_b32 s12, 24576, 0
    s_add_u32 s13, s13, s12
    v_add_u32 v14, s13, v10
    v_add_u32 v15, s13, v11
    s_waitcnt vmcnt(4)
    s_waitcnt lgkmcnt(6)
    v_mfma_f32_32x32x16_bf16 v[64:79], v[120:123], v[96:99], v[64:79]
    ds_read_b64_tr_b16 v[136:137], v14 offset:0
    ds_read_b64_tr_b16 v[138:139], v14 offset:1024
    s_waitcnt lgkmcnt(6)
    v_mfma_f32_32x32x16_bf16 v[80:95], v[124:127], v[96:99], v[80:95]
    ds_read_b64_tr_b16 v[140:141], v15 offset:0
    ds_read_b64_tr_b16 v[142:143], v15 offset:1024
    s_waitcnt lgkmcnt(6)
    v_mfma_f32_32x32x16_bf16 v[64:79], v[128:131], v[100:103], v[64:79]
    ds_read_b64_tr_b16 v[144:145], v14 offset:2048
    ds_read_b64_tr_b16 v[146:147], v14 offset:3072
    s_waitcnt lgkmcnt(6)
    v_mfma_f32_32x32x16_bf16 v[80:95], v[132:135], v[100:103], v[80:95]
    ds_read_b64_tr_b16 v[148:149], v15 offset:2048
    ds_read_b64_tr_b16 v[150:151], v15 offset:3072
    s_cmp_lg_u32 s96, 0
    s_cbranch_scc1 L_pk9
L_pl9:
    buffer_load_dword v53, v8, s[32:35], s15 offen sc1
    s_add_u32 s47, s47, 1
    s_cmp_ge_u32 s47, 16384
    s_cselect_b32 s12, -1, 0
    s_waitcnt vmcnt(0)
    v_cmp_eq_u32 vcc, s23, v53
    s_nop 1
    s_or_b32 s12, s12, vcc_lo
    s_lshr_b32 s12, s12, s93
    s_or_b32 s96, s96, s12
    s_andn2_b32 s96, s96, s14
    s_cbranch_scc0 L_pl9
L_pk9:
    s_ff1_i32_b32 s12, s96
    s_bitset0_b32 s96, s12
    s_bitset1_b32 s14, s12
    s_add_u32 s12, s12, s93
    s_and_b32 s81, s12, 15
    s_lshl_b32 s94, s81, 11
    s_add_u32 s94, s94, s95
    buffer_load_dwordx4 v[96:99], v17, s[32:35], s94 offen
    buffer_load_dwordx4 v[100:103], v17, s[32:35], s94 offen offset:1024
    s_add_u32 s12, s80, s97
    s_lshl_b32 s13, s12, 12
    s_cmp_ge_u32 s12, 8
    s_cselect_b32 s12, 24576, 0
    s_add_u32 s13, s13, s12
    v_add_u32 v12, s13, v10
    v_add_u32 v13, s13, v11
    s_waitcnt vmcnt(4)
    s_waitcnt lgkmcnt(6)
    v_mfma_f32_32x32x16_bf16 v[64:79], v[136:139], v[104:107], v[64:79]
    ds_read_b64_tr_b16 v[120:121], v12 offset:0
    ds_read_b64_tr_b16 v[122:123], v12 offset:1024
    s_waitcnt lgkmcnt(6)
    v_mfma_f32_32x32x16_bf16 v[80:95], v[140:143], v[104:107], v[80:95]
    ds_read_b64_tr_b16 v[124:125], v13 offset:0
    ds_read_b64_tr_b16 v[126:127], v13 offset:1024
    s_waitcnt lgkmcnt(6)
    v_mfma_f32_32x32x16_bf16 v[64:79], v[144:147], v[108:111], v[64:79]
    ds_read_b64_tr_b16 v[128:129], v12 offset:2048
    ds_read_b64_tr_b16 v[130:131], v12 offset:3072
    s_waitcnt lgkmcnt(6)
    v_mfma_f32_32x32x16_bf16 v[80:95], v[148:151], v[108:111], v[80:95]
    ds_read_b64_tr_b16 v[132:133], v13 offset:2048
    ds_read_b64_tr_b16 v[134:135], v13 offset:3072
    s_cmp_lg_u32 s96, 0
    s_cbranch_scc1 L_pk10
L_pl10:
    buffer_load_dword v54, v8, s[32:35], s15 offen sc1
    s_add_u32 s47, s47, 1
    s_cmp_ge_u32 s47, 16384
    s_cselect_b32 s12, -1, 0
    s_waitcnt vmcnt(0)
    v_cmp_eq_u32 vcc, s23, v54
    s_nop 1
    s_or_b32 s12, s12, vcc_lo
    s_lshr_b32 s12, s12, s93
    s_or_b32 s96, s96, s12
    s_andn2_b32 s96, s96, s14
    s_cbranch_scc0 L_pl10
L_pk10:
    s_ff1_i32_b32 s12, s96
    s_bitset0_b32 s96, s12
    s_bitset1_b32 s14, s12
    s_add_u32 s12, s12, s93
    s_and_b32 s82, s12, 15
    s_lshl_b32 s94, s82, 11
    s_add_u32 s94, s94, s95
    buffer_load_dwordx4 v[104:107], v17, s[32:35], s94 offen
    buffer_load_dwordx4 v[108:111], v17, s[32:35], s94 offen offset:1024
    s_add_u32 s12, s81, s97
    s_lshl_b32 s13, s12, 12
    s_cmp_ge_u32 s12, 8
    s_cselect_b32 s12, 24576, 0
    s_add_u32 s13, s13, s12
    v_add_u32 v14, s13, v10
    v_add_u32 v15, s13, v11
    s_waitcnt vmcnt(4)
    s_waitcnt lgkmcnt(6)
    v_mfma_f32_32x32x16_bf16 v[64:79], v[120:123], v[112:115], v[64:79]
    ds_read_b64_tr_b16 v[136:137], v14 offset:0
    ds_read_b64_tr_b16 v[138:139], v14 offset:1024
    s_waitcnt lgkmcnt(6)
    v_mfma_f32_32x32x16_bf16 v[80:95], v[124:127], v[112:115], v[80:95]
    ds_read_b64_tr_b16 v[140:141], v15 offset:0
    ds_read_b64_tr_b16 v[142:143], v15 offset:1024
    s_waitcnt lgkmcnt(6)
    v_mfma_f32_32x32x16_bf16 v[64:79], v[128:131], v[116:119], v[64:79]
    ds_read_b64_tr_b16 v[144:145], v14 offset:2048
    ds_read_b64_tr_b16 v[146:147], v14 offset:3072
    s_waitcnt lgkmcnt(6)
    v_mfma_f32_32x32x16_bf16 v[80:95], v[132:135], v[116:119], v[80:95]
    ds_read_b64_tr_b16 v[148:149], v15 offset:2048
    ds_read_b64_tr_b16 v[150:151], v15 offset:3072
    s_cmp_lg_u32 s96, 0
    s_cbranch_scc1 L_pk11
L_pl11:
    buffer_load_dword v55, v8, s[32:35], s15 offen sc1
    s_add_u32 s47, s47, 1
    s_cmp_ge_u32 s47, 16384
    s_cselect_b32 s12, -1, 0
    s_waitcnt vmcnt(0)
    v_cmp_eq_u32 vcc, s23, v55
    s_nop 1
    s_or_b32 s12, s12, vcc_lo
    s_lshr_b32 s12, s12, s93
    s_or_b32 s96, s96, s12
    s_andn2_b32 s96, s96, s14
    s_cbranch_scc0 L_pl11
L_pk11:
    s_ff1_i32_b32 s12, s96
    s_bitset0_b32 s96, s12
    s_bitset1_b32 s14, s12
    s_add_u32 s12, s12, s93
    s_and_b32 s83, s12, 15
    s_lshl_b32 s94, s83, 11
    s_add_u32 s94, s94, s95
    buffer_load_dwordx4 v[112:115], v17, s[32:35], s94 offen
    buffer_load_dwordx4 v[116:119], v17, s[32:35], s94 offen offset:1024
    s_mov_b32 s45, 1
    s_cmp_eq_u32 s46, 0
    s_cbranch_scc1 L_b_nold
    s_lshl_b32 s12, s89, 12
    s_add_u32 s12, s12, 458752
    buffer_load_dwordx4 v[224:227], v22, s[32:35], s12 offen offset:0 sc1
    buffer_load_dwordx4 v[228:231], v22, s[32:35], s12 offen offset:16 sc1
    buffer_load_dwordx4 v[232:235], v22, s[32:35], s12 offen offset:64 sc1
    buffer_load_dwordx4 v[236:239], v22, s[32:35], s12 offen offset:80 sc1
L_b_nold:
    s_add_u32 s12, s82, s97
    s_lshl_b32 s13, s12, 12
    s_cmp_ge_u32 s12, 8
    s_cselect_b32 s12, 24576, 0
    s_add_u32 s13, s13, s12
    v_add_u32 v12, s13, v10
    v_add_u32 v13, s13, v11
    s_waitcnt vmcnt(4)
    s_waitcnt lgkmcnt(6)
    v_mfma_f32_32x32x16_bf16 v[64:79], v[136:139], v[96:99], v[64:79]
    ds_read_b64_tr_b16 v[120:121], v12 offset:0
    ds_read_b64_tr_b16 v[122:123], v12 offset:1024
    s_waitcnt lgkmcnt(6)
    v_mfma_f32_32x32x16_bf16 v[80:95], v[140:143], v[96:99], v[80:95]
    ds_read_b64_tr_b16 v[124:125], v13 offset:0
    ds_read_b64_tr_b16 v[126:127], v13 offset:1024
    s_waitcnt lgkmcnt(6)
    v_mfma_f32_32x32x16_bf16 v[64:79], v[144:147], v[100:103], v[64:79]
    ds_read_b64_tr_b16 v[128:129], v12 offset:2048
    ds_read_b64_tr_b16 v[130:131], v12 offset:3072
    s_waitcnt lgkmcnt(6)
    v_mfma_f32_32x32x16_bf16 v[80:95], v[148:151], v[100:103], v[80:95]
    ds_read_b64_tr_b16 v[132:133], v13 offset:2048
    ds_read_b64_tr_b16 v[134:135], v13 offset:3072
    s_cmp_lg_u32 s96, 0
    s_cbranch_scc1 L_pk12
L_pl12:
    buffer_load_dword v56, v8, s[32:35], s15 offen sc1
    s_add_u32 s47, s47, 1
    s_cmp_ge_u32 s47, 16384
    s_cselect_b32 s12, -1, 0
    s_waitcnt vmcnt(0)
    v_cmp_eq_u32 vcc, s23, v56
    s_nop 1
    s_or_b32 s12, s12, vcc_lo
    s_lshr_b32 s12, s12, s93
    s_or_b32 s96, s96, s12
    s_andn2_b32 s96, s96, s14
    s_cbranch_scc0 L_pl12
L_pk12:
    s_ff1_i32_b32 s12, s96
    s_bitset0_b32 s96, s12
    s_bitset1_b32 s14, s12
    s_add_u32 s12, s12, s93
    s_and_b32 s84, s12, 15
    s_lshl_b32 s94, s84, 11
    s_add_u32 s94, s94, s95
    buffer_load_dwordx4 v[96:99], v17, s[32:35], s94 offen
    buffer_load_dwordx4 v[100:103], v17, s[32:35], s94 offen offset:1024
    s_add_u32 s12, s83, s97
    s_lshl_b32 s13, s12, 12
    s_cmp_ge_u32 s12, 8
    s_cselect_b32 s12, 24576, 0
    s_add_u32 s13, s13, s12
    v_add_u32 v14, s13, v10
    v_add_u32 v15, s13, v11
    s_waitcnt vmcnt(4)
    s_waitcnt lgkmcnt(6)
    v_mfma_f32_32x32x16_bf16 v[64:79], v[120:123], v[104:107], v[64:79]
    ds_read_b64_tr_b16 v[136:137], v14 offset:0
    ds_read_b64_tr_b16 v[138:139], v14 offset:1024
    s_waitcnt lgkmcnt(6)
    v_mfma_f32_32x32x16_bf16 v[80:95], v[124:127], v[104:107], v[80:95]
    ds_read_b64_tr_b16 v[140:141], v15 offset:0
    ds_read_b64_tr_b16 v[142:143], v15 offset:1024
    s_waitcnt lgkmcnt(6)
    v_mfma_f32_32x32x16_bf16 v[64:79], v[128:131], v[108:111], v[64:79]
    ds_read_b64_tr_b16 v[144:145], v14 offset:2048
    ds_read_b64_tr_b16 v[146:147], v14 offset:3072
    s_waitcnt lgkmcnt(6)
    v_mfma_f32_32x32x16_bf16 v[80:95], v[132:135], v[108:111], v[80:95]
    ds_read_b64_tr_b16 v[148:149], v15 offset:2048
    ds_read_b64_tr_b16 v[150:151], v15 offset:3072
    s_cmp_lg_u32 s96, 0
    s_cbranch_scc1 L_pk13
L_pl13:
    buffer_load_dword v57, v8, s[32:35], s15 offen sc1
    s_add_u32 s47, s47, 1
    s_cmp_ge_u32 s47, 16384
    s_cselect_b32 s12, -1, 0
    s_waitcnt vmcnt(0)
    v_cmp_eq_u32 vcc, s23, v57
    s_nop 1
    s_or_b32 s12, s12, vcc_lo
    s_lshr_b32 s12, s12, s93
    s_or_b32 s96, s96, s12
    s_andn2_b32 s96, s96, s14
    s_cbranch_scc0 L_pl13
L_pk13:
    s_ff1_i32_b32 s12, s96
    s_bitset0_b32 s96, s12
    s_bitset1_b32 s14, s12
    s_add_u32 s12, s12, s93
    s_and_b32 s85, s12, 15
    s_lshl_b32 s94, s85, 11
    s_add_u32 s94, s94, s95
    buffer_load_dwordx4 v[104:107], v17, s[32:35], s94 offen
    buffer_load_dwordx4 v[108:111], v17, s[32:35], s94 offen offset:1024
    s_cmp_lg_u32 s46, 0
    s_cbranch_scc1 L_own
L_own_r1:
    s_add_u32 s12, s84, s97
    s_lshl_b32 s13, s12, 12
    s_cmp_ge_u32 s12, 8
    s_cselect_b32 s12, 24576, 0
    s_add_u32 s13, s13, s12
    v_add_u32 v12, s13, v10
    v_add_u32 v13, s13, v11
    s_waitcnt vmcnt(4)
    s_waitcnt lgkmcnt(6)
    v_mfma_f32_32x32x16_bf16 v[64:79], v[136:139], v[112:115], v[64:79]
    ds_read_b64_tr_b16 v[120:121], v12 offset:0
    ds_read_b64_tr_b16 v[122:123], v12 offset:1024
    s_waitcnt lgkmcnt(6)
    v_mfma_f32_32x32x16_bf16 v[80:95], v[140:143], v[112:115], v[80:95]
    ds_read_b64_tr_b16 v[124:125], v13 offset:0
    ds_read_b64_tr_b16 v[126:127], v13 offset:1024
    s_waitcnt lgkmcnt(6)
    v_mfma_f32_32x32x16_bf16 v[64:79], v[144:147], v[116:119], v[64:79]
    ds_read_b64_tr_b16 v[128:129], v12 offset:2048
    ds_read_b64_tr_b16 v[130:131], v12 offset:3072
    s_waitcnt lgkmcnt(6)
    v_mfma_f32_32x32x16_bf16 v[80:95], v[148:151], v[116:119], v[80:95]
    ds_read_b64_tr_b16 v[132:133], v13 offset:2048
    ds_read_b64_tr_b16 v[134:135], v13 offset:3072
    s_cmp_lg_u32 s96, 0
    s_cbranch_scc1 L_pk14
L_pl14:
    buffer_load_dword v58, v8, s[32:35], s15 offen sc1
    s_add_u32 s47, s47, 1
    s_cmp_ge_u32 s47, 16384
    s_cselect_b32 s12, -1, 0
    s_waitcnt vmcnt(0)
    v_cmp_eq_u32 vcc, s23, v58
    s_nop 1
    s_or_b32 s12, s12, vcc_lo
    s_lshr_b32 s12, s12, s93
    s_or_b32 s96, s96, s12
    s_andn2_b32 s96, s96, s14
    s_cbranch_scc0 L_pl14
L_pk14:
    s_ff1_i32_b32 s12, s96
    s_bitset0_b32 s96, s12
    s_bitset1_b32 s14, s12
    s_add_u32 s12, s12, s93
    s_and_b32 s86, s12, 15
    s_lshl_b32 s94, s86, 11
    s_add_u32 s94, s94, s95
    buffer_load_dwordx4 v[112:115], v17, s[32:35], s94 offen
    buffer_load_dwordx4 v[116:119], v17, s[32:35], s94 offen offset:1024
    s_add_u32 s12, s85, s97
    s_lshl_b32 s13, s12, 12
    s_cmp_ge_u32 s12, 8
    s_cselect_b32 s12, 24576, 0
    s_add_u32 s13, s13, s12
    v_add_u32 v14, s13, v10
    v_add_u32 v15, s13, v11
    s_waitcnt vmcnt(4)
    s_waitcnt lgkmcnt(6)
    v_mfma_f32_32x32x16_bf16 v[64:79], v[120:123], v[96:99], v[64:79]
    ds_read_b64_tr_b16 v[136:137], v14 offset:0
    ds_read_b64_tr_b16 v[138:139], v14 offset:1024
    s_waitcnt lgkmcnt(6)
    v_mfma_f32_32x32x16_bf16 v[80:95], v[124:127], v[96:99], v[80:95]
    ds_read_b64_tr_b16 v[140:141], v15 offset:0
    ds_read_b64_tr_b16 v[142:143], v15 offset:1024
    s_waitcnt lgkmcnt(6)
    v_mfma_f32_32x32x16_bf16 v[64:79], v[128:131], v[100:103], v[64:79]
    ds_read_b64_tr_b16 v[144:145], v14 offset:2048
    ds_read_b64_tr_b16 v[146:147], v14 offset:3072
    s_waitcnt lgkmcnt(6)
    v_mfma_f32_32x32x16_bf16 v[80:95], v[132:135], v[100:103], v[80:95]
    ds_read_b64_tr_b16 v[148:149], v15 offset:2048
    ds_read_b64_tr_b16 v[150:151], v15 offset:3072
    s_cmp_lg_u32 s96, 0
    s_cbranch_scc1 L_pk15
L_pl15:
    buffer_load_dword v59, v8, s[32:35], s15 offen sc1
    s_add_u32 s47, s47, 1
    s_cmp_ge_u32 s47, 16384
    s_cselect_b32 s12, -1, 0
    s_waitcnt vmcnt(0)
    v_cmp_eq_u32 vcc, s23, v59
    s_nop 1
    s_or_b32 s12, s12, vcc_lo
    s_lshr_b32 s12, s12, s93
    s_or_b32 s96, s96, s12
    s_andn2_b32 s96, s96, s14
    s_cbranch_scc0 L_pl15
L_pk15:
    s_ff1_i32_b32 s12, s96
    s_bitset0_b32 s96, s12
    s_bitset1_b32 s14, s12
    s_add_u32 s12, s12, s93
    s_and_b32 s87, s12, 15
    s_lshl_b32 s94, s87, 11
    s_add_u32 s94, s94, s95
    buffer_load_dwordx4 v[96:99], v17, s[32:35], s94 offen
    buffer_load_dwordx4 v[100:103], v17, s[32:35], s94 offen offset:1024
    s_add_u32 s12, s86, s97
    s_lshl_b32 s13, s12, 12
    s_cmp_ge_u32 s12, 8
    s_cselect_b32 s12, 24576, 0
    s_add_u32 s13, s13, s12
    v_add_u32 v12, s13, v10
    v_add_u32 v13, s13, v11
    s_waitcnt vmcnt(4)
    s_waitcnt lgkmcnt(6)
    v_mfma_f32_32x32x16_bf16 v[64:79], v[136:139], v[104:107], v[64:79]
    ds_read_b64_tr_b16 v[120:121], v12 offset:0
    ds_read_b64_tr_b16 v[122:123], v12 offset:1024
    s_waitcnt lgkmcnt(6)
    v_mfma_f32_32x32x16_bf16 v[80:95], v[140:143], v[104:107], v[80:95]
    ds_read_b64_tr_b16 v[124:125], v13 offset:0
    ds_read_b64_tr_b16 v[126:127], v13 offset:1024
    s_waitcnt lgkmcnt(6)
    v_mfma_f32_32x32x16_bf16 v[64:79], v[144:147], v[108:111], v[64:79]
    ds_read_b64_tr_b16 v[128:129], v12 offset:2048
    ds_read_b64_tr_b16 v[130:131], v12 offset:3072
    s_waitcnt lgkmcnt(6)
    v_mfma_f32_32x32x16_bf16 v[80:95], v[148:151], v[108:111], v[80:95]
    ds_read_b64_tr_b16 v[132:133], v13 offset:2048
    ds_read_b64_tr_b16 v[134:135], v13 offset:3072
    s_add_u32 s12, s87, s97
    s_lshl_b32 s13, s12, 12
    s_cmp_ge_u32 s12, 8
    s_cselect_b32 s12, 24576, 0
    s_add_u32 s13, s13, s12
    v_add_u32 v14, s13, v10
    v_add_u32 v15, s13, v11
    s_waitcnt vmcnt(2)
    s_waitcnt lgkmcnt(6)
    v_mfma_f32_32x32x16_bf16 v[64:79], v[120:123], v[112:115], v[64:79]
    ds_read_b64_tr_b16 v[136:137], v14 offset:0
    ds_read_b64_tr_b16 v[138:139], v14 offset:1024
    s_waitcnt lgkmcnt(6)
    v_mfma_f32_32x32x16_bf16 v[80:95], v[124:127], v[112:115], v[80:95]
    ds_read_b64_tr_b16 v[140:141], v15 offset:0
    ds_read_b64_tr_b16 v[142:143], v15 offset:1024
    s_waitcnt lgkmcnt(6)
    v_mfma_f32_32x32x16_bf16 v[64:79], v[128:131], v[116:119], v[64:79]
    ds_read_b64_tr_b16 v[144:145], v14 offset:2048
    ds_read_b64_tr_b16 v[146:147], v14 offset:3072
    s_waitcnt lgkmcnt(6)
    v_mfma_f32_32x32x16_bf16 v[80:95], v[132:135], v[116:119], v[80:95]
    ds_read_b64_tr_b16 v[148:149], v15 offset:2048
    ds_read_b64_tr_b16 v[150:151], v15 offset:3072
    s_waitcnt vmcnt(0)
    s_waitcnt lgkmcnt(6)
    v_mfma_f32_32x32x16_bf16 v[64:79], v[136:139], v[96:99], v[64:79]
    s_waitcnt lgkmcnt(4)
    v_mfma_f32_32x32x16_bf16 v[80:95], v[140:143], v[96:99], v[80:95]
    s_waitcnt lgkmcnt(2)
    v_mfma_f32_32x32x16_bf16 v[64:79], v[144:147], v[100:103], v[64:79]
    s_waitcnt lgkmcnt(0)
    v_mfma_f32_32x32x16_bf16 v[80:95], v[148:151], v[100:103], v[80:95]
    v_bfe_u32 v9, v2, 3, 1
    v_mul_u32_u24 v9, 16352, v9
    v_sub_u32 v7, v7, v9
    s_mov_b32 s12, 16384
    s_nop 7
    v_permlane16_swap_b32 v64, v80
    v_permlane16_swap_b32 v65, v81
    v_permlane16_swap_b32 v66, v82
    v_permlane16_swap_b32 v67, v83
    ds_write_b128 v20, v[80:83] offset:0
    v_permlane16_swap_b32 v68, v84
    v_permlane16_swap_b32 v69, v85
    v_permlane16_swap_b32 v70, v86
    v_permlane16_swap_b32 v71, v87
    ds_write_b128 v20, v[84:87] offset:1024
    v_permlane16_swap_b32 v72, v88
    v_permlane16_swap_b32 v73, v89
    v_permlane16_swap_b32 v74, v90
    v_permlane16_swap_b32 v75, v91
    ds_write_b128 v20, v[88:91] offset:2048
    v_permlane16_swap_b32 v76, v92
    v_permlane16_swap_b32 v77, v93
    v_permlane16_swap_b32 v78, v94
    v_permlane16_swap_b32 v79, v95
    ds_write_b128 v20, v[92:95] offset:3072
    s_waitcnt lgkmcnt(0)
    s_barrier
    ds_read_b128 v[80:83], v21 offset:0
    ds_read_b128 v[84:87], v21 offset:1024
    ds_read_b128 v[88:91], v21 offset:2048
    ds_read_b128 v[92:95], v21 offset:3072
    s_waitcnt lgkmcnt(3)
    v_pk_add_f32 v[64:65], v[64:65], v[80:81]
    v_pk_add_f32 v[66:67], v[66:67], v[82:83]
    v_cvt_pk_bf16_f32 v64, 0, v64
    v_cvt_pk_bf16_f32 v65, 0, v65
    v_cvt_pk_bf16_f32 v66, 0, v66
    v_cvt_pk_bf16_f32 v67, 0, v67
    v_pk_mul_f32 v[64:65], v[64:65], v[48:49] op_sel_hi:[1,0]
    v_pk_mul_f32 v[66:67], v[66:67], v[48:49] op_sel_hi:[1,0]
    v_cvt_pk_bf16_f32 v64, 0, v64
    v_cvt_pk_bf16_f32 v65, 0, v65
    v_cvt_pk_bf16_f32 v66, 0, v66
    v_cvt_pk_bf16_f32 v67, 0, v67
    v_pk_add_f32 v[64:65], v[64:65], v[32:33]
    v_pk_add_f32 v[66:67], v[66:67], v[34:35]
    v_cvt_pk_bf16_f32 v96, v64, v65
    v_cvt_pk_bf16_f32 v97, v66, v67
    s_waitcnt lgkmcnt(2)
    v_pk_add_f32 v[68:69], v[68:69], v[84:85]
    v_pk_add_f32 v[70:71], v[70:71], v[86:87]
    v_cvt_pk_bf16_f32 v68, 0, v68
    v_cvt_pk_bf16_f32 v69, 0, v69
    v_cvt_pk_bf16_f32 v70, 0, v70
    v_cvt_pk_bf16_f32 v71, 0, v71
    v_pk_mul_f32 v[68:69], v[68:69], v[48:49] op_sel_hi:[1,0]
    v_pk_mul_f32 v[70:71], v[70:71], v[48:49] op_sel_hi:[1,0]
    v_cvt_pk_bf16_f32 v68, 0, v68
    v_cvt_pk_bf16_f32 v69, 0, v69
    v_cvt_pk_bf16_f32 v70, 0, v70
    v_cvt_pk_bf16_f32 v71, 0, v71
    v_pk_add_f32 v[68:69], v[68:69], v[36:37]
    v_pk_add_f32 v[70:71], v[70:71], v[38:39]
    v_cvt_pk_bf16_f32 v98, v68, v69
    v_cvt_pk_bf16_f32 v99, v70, v71
    s_waitcnt lgkmcnt(1)
    v_pk_add_f32 v[72:73], v[72:73], v[88:89]
    v_pk_add_f32 v[74:75], v[74:75], v[90:91]
    v_cvt_pk_bf16_f32 v72, 0, v72
    v_cvt_pk_bf16_f32 v73, 0, v73
    v_cvt_pk_bf16_f32 v74, 0, v74
    v_cvt_pk_bf16_f32 v75, 0, v75
    v_pk_mul_f32 v[72:73], v[72:73], v[48:49] op_sel_hi:[1,0]
    v_pk_mul_f32 v[74:75], v[74:75], v[48:49] op_sel_hi:[1,0]
    v_cvt_pk_bf16_f32 v72, 0, v72
    v_cvt_pk_bf16_f32 v73, 0, v73
    v_cvt_pk_bf16_f32 v74, 0, v74
    v_cvt_pk_bf16_f32 v75, 0, v75
    v_pk_add_f32 v[72:73], v[72:73], v[40:41]
    v_pk_add_f32 v[74:75], v[74:75], v[42:43]
    v_cvt_pk_bf16_f32 v100, v72, v73
    v_cvt_pk_bf16_f32 v101, v74, v75
    s_waitcnt lgkmcnt(0)
    v_pk_add_f32 v[76:77], v[76:77], v[92:93]
    v_pk_add_f32 v[78:79], v[78:79], v[94:95]
    v_cvt_pk_bf16_f32 v76, 0, v76
    v_cvt_pk_bf16_f32 v77, 0, v77
    v_cvt_pk_bf16_f32 v78, 0, v78
    v_cvt_pk_bf16_f32 v79, 0, v79
    v_pk_mul_f32 v[76:77], v[76:77], v[48:49] op_sel_hi:[1,0]
    v_pk_mul_f32 v[78:79], v[78:79], v[48:49] op_sel_hi:[1,0]
    v_cvt_pk_bf16_f32 v76, 0, v76
    v_cvt_pk_bf16_f32 v77, 0, v77
    v_cvt_pk_bf16_f32 v78, 0, v78
    v_cvt_pk_bf16_f32 v79, 0, v79
    v_pk_add_f32 v[76:77], v[76:77], v[44:45]
    v_pk_add_f32 v[78:79], v[78:79], v[46:47]
    v_cvt_pk_bf16_f32 v102, v76, v77
    v_cvt_pk_bf16_f32 v103, v78, v79
    v_permlane32_swap_b32 v96, v98
    v_permlane32_swap_b32 v97, v99
    v_permlane32_swap_b32 v100, v102
    v_permlane32_swap_b32 v101, v103
    v_mov_b32 v104, v96
    v_mov_b32 v105, v97
    v_mov_b32 v106, v98
    v_mov_b32 v107, v99
    v_mov_b32_dpp v96, v100 row_ror:8 row_mask:0xf bank_mask:0xc
    v_mov_b32_dpp v97, v101 row_ror:8 row_mask:0xf bank_mask:0xc
    v_mov_b32_dpp v98, v102 row_ror:8 row_mask:0xf bank_mask:0xc
    v_mov_b32_dpp v99, v103 row_ror:8 row_mask:0xf bank_mask:0xc
    buffer_store_dwordx4 v[96:99], v7, s[68:71], 0 offen sc1
    v_mov_b32_dpp v100, v104 row_ror:8 row_mask:0xf bank_mask:0x3
    v_mov_b32_dpp v101, v105 row_ror:8 row_mask:0xf bank_mask:0x3
    v_mov_b32_dpp v102, v106 row_ror:8 row_mask:0xf bank_mask:0x3
    v_mov_b32_dpp v103, v107 row_ror:8 row_mask:0xf bank_mask:0x3
    buffer_store_dwordx4 v[100:103], v7, s[68:71], s12 offen sc1
    s_endpgm
L_own:
    s_mov_b32 s13, 0
L_b_y:
    s_waitcnt vmcnt(0)
    v_msad_u8 v240, v224, s76, 0
    v_msad_u8 v240, v225, s77, v240
    v_msad_u8 v240, v226, s78, v240
    v_msad_u8 v240, v227, s79, v240
    v_msad_u8 v240, v228, s76, v240
    v_msad_u8 v240, v229, s77, v240
    v_msad_u8 v240, v230, s78, v240
    v_msad_u8 v240, v231, s79, v240
    v_msad_u8 v240, v232, s76, v240
    v_msad_u8 v240, v233, s77, v240
    v_msad_u8 v240, v234, s78, v240
    v_msad_u8 v240, v235, s79, v240
    v_msad_u8 v240, v236, s76, v240
    v_msad_u8 v240, v237, s77, v240
    v_msad_u8 v240, v238, s78, v240
    v_msad_u8 v240, v239, s79, v240
    v_cmp_ne_u32 vcc, 0, v240
    s_nop 1
    s_or_b32 s46, vcc_lo, vcc_hi
    s_cbranch_scc0 L_b_yok
    s_cmp_eq_u32 s45, 0
    s_cbranch_scc1 L_b_yok
    s_lshl_b32 s12, s89, 12
    s_add_u32 s12, s12, 458752
    buffer_load_dwordx4 v[224:227], v22, s[32:35], s12 offen offset:0 sc1
    buffer_load_dwordx4 v[228:231], v22, s[32:35], s12 offen offset:16 sc1
    buffer_load_dwordx4 v[232:235], v22, s[32:35], s12 offen offset:64 sc1
    buffer_load_dwordx4 v[236:239], v22, s[32:35], s12 offen offset:80 sc1
    s_add_u32 s13, s13, 1
    s_cmp_lt_u32 s13, 16384
    s_cbranch_scc1 L_b_y
    s_waitcnt vmcnt(0)
    s_mov_b32 s46, 0
L_b_yok:
    v_add_f32_dpp v224, v224, v224 row_ror:1 row_mask:0xf bank_mask:0xf
    v_add_f32_dpp v225, v225, v225 row_ror:1 row_mask:0xf bank_mask:0xf
    v_add_f32_dpp v226, v226, v226 row_ror:1 row_mask:0xf bank_mask:0xf
    v_add_f32_dpp v227, v227, v227 row_ror:1 row_mask:0xf bank_mask:0xf
    v_add_f32_dpp v228, v228, v228 row_ror:1 row_mask:0xf bank_mask:0xf
    v_add_f32_dpp v229, v229, v229 row_ror:1 row_mask:0xf bank_mask:0xf
    v_add_f32_dpp v230, v230, v230 row_ror:1 row_mask:0xf bank_mask:0xf
    v_add_f32_dpp v231, v231, v231 row_ror:1 row_mask:0xf bank_mask:0xf
    v_add_f32_dpp v232, v232, v232 row_ror:1 row_mask:0xf bank_mask:0xf
    v_add_f32_dpp v233, v233, v233 row_ror:1 row_mask:0xf bank_mask:0xf
    v_add_f32_dpp v234, v234, v234 row_ror:1 row_mask:0xf bank_mask:0xf
    v_add_f32_dpp v235, v235, v235 row_ror:1 row_mask:0xf bank_mask:0xf
    v_add_f32_dpp v236, v236, v236 row_ror:1 row_mask:0xf bank_mask:0xf
    v_add_f32_dpp v237, v237, v237 row_ror:1 row_mask:0xf bank_mask:0xf
    v_add_f32_dpp v238, v238, v238 row_ror:1 row_mask:0xf bank_mask:0xf
    v_add_f32_dpp v239, v239, v239 row_ror:1 row_mask:0xf bank_mask:0xf
    v_add_f32_dpp v224, v224, v224 row_ror:2 row_mask:0xf bank_mask:0xf
    v_add_f32_dpp v225, v225, v225 row_ror:2 row_mask:0xf bank_mask:0xf
    v_add_f32_dpp v226, v226, v226 row_ror:2 row_mask:0xf bank_mask:0xf
    v_add_f32_dpp v227, v227, v227 row_ror:2 row_mask:0xf bank_mask:0xf
    v_add_f32_dpp v228, v228, v228 row_ror:2 row_mask:0xf bank_mask:0xf
    v_add_f32_dpp v229, v229, v229 row_ror:2 row_mask:0xf bank_mask:0xf
    v_add_f32_dpp v230, v230, v230 row_ror:2 row_mask:0xf bank_mask:0xf
    v_add_f32_dpp v231, v231, v231 row_ror:2 row_mask:0xf bank_mask:0xf
    v_add_f32_dpp v232, v232, v232 row_ror:2 row_mask:0xf bank_mask:0xf
    v_add_f32_dpp v233, v233, v233 row_ror:2 row_mask:0xf bank_mask:0xf
    v_add_f32_dpp v234, v234, v234 row_ror:2 row_mask:0xf bank_mask:0xf
    v_add_f32_dpp v235, v235, v235 row_ror:2 row_mask:0xf bank_mask:0xf
    v_add_f32_dpp v236, v236, v236 row_ror:2 row_mask:0xf bank_mask:0xf
    v_add_f32_dpp v237, v237, v237 row_ror:2 row_mask:0xf bank_mask:0xf
    v_add_f32_dpp v238, v238, v238 row_ror:2 row_mask:0xf bank_mask:0xf
    v_add_f32_dpp v239, v239, v239 row_ror:2 row_mask:0xf bank_mask:0xf
    v_add_f32_dpp v224, v224, v224 row_ror:4 row_mask:0xf bank_mask:0xf
    v_add_f32_dpp v225, v225, v225 row_ror:4 row_mask:0xf bank_mask:0xf
    v_add_f32_dpp v226, v226, v226 row_ror:4 row_mask:0xf bank_mask:0xf
    v_add_f32_dpp v227, v227, v227 row_ror:4 row_mask:0xf bank_mask:0xf
    v_add_f32_dpp v228, v228, v228 row_ror:4 row_mask:0xf bank_mask:0xf
    v_add_f32_dpp v229, v229, v229 row_ror:4 row_mask:0xf bank_mask:0xf
    v_add_f32_dpp v230, v230, v230 row_ror:4 row_mask:0xf bank_mask:0xf
    v_add_f32_dpp v231, v231, v231 row_ror:4 row_mask:0xf bank_mask:0xf
    v_add_f32_dpp v232, v232, v232 row_ror:4 row_mask:0xf bank_mask:0xf
    v_add_f32_dpp v233, v233, v233 row_ror:4 row_mask:0xf bank_mask:0xf
    v_add_f32_dpp v234, v234, v234 row_ror:4 row_mask:0xf bank_mask:0xf
    v_add_f32_dpp v235, v235, v235 row_ror:4 row_mask:0xf bank_mask:0xf
    v_add_f32_dpp v236, v236, v236 row_ror:4 row_mask:0xf bank_mask:0xf
    v_add_f32_dpp v237, v237, v237 row_ror:4 row_mask:0xf bank_mask:0xf
    v_add_f32_dpp v238, v238, v238 row_ror:4 row_mask:0xf bank_mask:0xf
    v_add_f32_dpp v239, v239, v239 row_ror:4 row_mask:0xf bank_mask:0xf
    v_add_f32_dpp v224, v224, v224 row_ror:8 row_mask:0xf bank_mask:0xf
    v_add_f32_dpp v225, v225, v225 row_ror:8 row_mask:0xf bank_mask:0xf
    v_add_f32_dpp v226, v226, v226 row_ror:8 row_mask:0xf bank_mask:0xf
    v_add_f32_dpp v227, v227, v227 row_ror:8 row_mask:0xf bank_mask:0xf
    v_add_f32_dpp v228, v228, v228 row_ror:8 row_mask:0xf bank_mask:0xf
    v_add_f32_dpp v229, v229, v229 row_ror:8 row_mask:0xf bank_mask:0xf
    v_add_f32_dpp v230, v230, v230 row_ror:8 row_mask:0xf bank_mask:0xf
    v_add_f32_dpp v231, v231, v231 row_ror:8 row_mask:0xf bank_mask:0xf
    v_add_f32_dpp v232, v232, v232 row_ror:8 row_mask:0xf bank_mask:0xf
    v_add_f32_dpp v233, v233, v233 row_ror:8 row_mask:0xf bank_mask:0xf
    v_add_f32_dpp v234, v234, v234 row_ror:8 row_mask:0xf bank_mask:0xf
    v_add_f32_dpp v235, v235, v235 row_ror:8 row_mask:0xf bank_mask:0xf
    v_add_f32_dpp v236, v236, v236 row_ror:8 row_mask:0xf bank_mask:0xf
    v_add_f32_dpp v237, v237, v237 row_ror:8 row_mask:0xf bank_mask:0xf
    v_add_f32_dpp v238, v238, v238 row_ror:8 row_mask:0xf bank_mask:0xf
    v_add_f32_dpp v239, v239, v239 row_ror:8 row_mask:0xf bank_mask:0xf
    v_cvt_pk_bf16_f32 v240, v224, v225
    v_cvt_pk_bf16_f32 v241, v226, v227
    v_cvt_pk_bf16_f32 v242, v228, v229
    v_cvt_pk_bf16_f32 v243, v230, v231
    v_cvt_pk_bf16_f32 v244, v232, v233
    v_cvt_pk_bf16_f32 v245, v234, v235
    v_cvt_pk_bf16_f32 v246, v236, v237
    v_cvt_pk_bf16_f32 v247, v238, v239
    v_lshlrev_b32 v224, 16, v240
    v_and_b32 v225, 0xffff0000, v240
    v_lshlrev_b32 v226, 16, v241
    v_and_b32 v227, 0xffff0000, v241
    v_lshlrev_b32 v228, 16, v242
    v_and_b32 v229, 0xffff0000, v242
    v_lshlrev_b32 v230, 16, v243
    v_and_b32 v231, 0xffff0000, v243
    v_lshlrev_b32 v232, 16, v244
    v_and_b32 v233, 0xffff0000, v244
    v_lshlrev_b32 v234, 16, v245
    v_and_b32 v235, 0xffff0000, v245
    v_lshlrev_b32 v236, 16, v246
    v_and_b32 v237, 0xffff0000, v246
    v_lshlrev_b32 v238, 16, v247
    v_and_b32 v239, 0xffff0000, v247
    v_pk_mul_f32 v[224:225], v[224:225], s[22:23] op_sel_hi:[1,0]
    v_pk_mul_f32 v[226:227], v[226:227], s[22:23] op_sel_hi:[1,0]
    v_pk_mul_f32 v[228:229], v[228:229], s[22:23] op_sel_hi:[1,0]
    v_pk_mul_f32 v[230:231], v[230:231], s[22:23] op_sel_hi:[1,0]
    v_pk_mul_f32 v[232:233], v[232:233], s[22:23] op_sel_hi:[1,0]
    v_pk_mul_f32 v[234:235], v[234:235], s[22:23] op_sel_hi:[1,0]
    v_pk_mul_f32 v[236:237], v[236:237], s[22:23] op_sel_hi:[1,0]
    v_pk_mul_f32 v[238:239], v[238:239], s[22:23] op_sel_hi:[1,0]
    v_cvt_pk_bf16_f32 v240, v224, v225
    v_cvt_pk_bf16_f32 v241, v226, v227
    v_cvt_pk_bf16_f32 v242, v228, v229
    v_cvt_pk_bf16_f32 v243, v230, v231
    v_cvt_pk_bf16_f32 v244, v232, v233
    v_cvt_pk_bf16_f32 v245, v234, v235
    v_cvt_pk_bf16_f32 v246, v236, v237
    v_cvt_pk_bf16_f32 v247, v238, v239
    v_lshlrev_b32 v224, 16, v240
    v_and_b32 v225, 0xffff0000, v240
    v_lshlrev_b32 v226, 16, v241
    v_and_b32 v227, 0xffff0000, v241
    v_lshlrev_b32 v228, 16, v242
    v_and_b32 v229, 0xffff0000, v242
    v_lshlrev_b32 v230, 16, v243
    v_and_b32 v231, 0xffff0000, v243
    v_lshlrev_b32 v232, 16, v244
    v_and_b32 v233, 0xffff0000, v244
    v_lshlrev_b32 v234, 16, v245
    v_and_b32 v235, 0xffff0000, v245
    v_lshlrev_b32 v236, 16, v246
    v_and_b32 v237, 0xffff0000, v246
    v_lshlrev_b32 v238, 16, v247
    v_and_b32 v239, 0xffff0000, v247
    v_lshlrev_b32 v32, 16, v24
    v_and_b32 v33, 0xffff0000, v24
    v_lshlrev_b32 v34, 16, v25
    v_and_b32 v35, 0xffff0000, v25
    v_lshlrev_b32 v36, 16, v26
    v_and_b32 v37, 0xffff0000, v26
    v_lshlrev_b32 v38, 16, v27
    v_and_b32 v39, 0xffff0000, v27
    v_lshlrev_b32 v40, 16, v28
    v_and_b32 v41, 0xffff0000, v28
    v_lshlrev_b32 v42, 16, v29
    v_and_b32 v43, 0xffff0000, v29
    v_lshlrev_b32 v44, 16, v30
    v_and_b32 v45, 0xffff0000, v30
    v_lshlrev_b32 v46, 16, v31
    v_and_b32 v47, 0xffff0000, v31
    v_pk_add_f32 v[224:225], v[224:225], v[32:33]
    v_pk_add_f32 v[226:227], v[226:227], v[34:35]
    v_pk_add_f32 v[228:229], v[228:229], v[36:37]
    v_pk_add_f32 v[230:231], v[230:231], v[38:39]
    v_pk_add_f32 v[232:233], v[232:233], v[40:41]
    v_pk_add_f32 v[234:235], v[234:235], v[42:43]
    v_pk_add_f32 v[236:237], v[236:237], v[44:45]
    v_pk_add_f32 v[238:239], v[238:239], v[46:47]
    v_cvt_pk_bf16_f32 v240, v224, v225
    v_cvt_pk_bf16_f32 v241, v226, v227
    v_cvt_pk_bf16_f32 v242, v228, v229
    v_cvt_pk_bf16_f32 v243, v230, v231
    v_cvt_pk_bf16_f32 v244, v232, v233
    v_cvt_pk_bf16_f32 v245, v234, v235
    v_cvt_pk_bf16_f32 v246, v236, v237
    v_cvt_pk_bf16_f32 v247, v238, v239
    s_cmp_eq_u32 s46, 0
    s_cselect_b32 s12, s21, -1
    v_cmp_eq_u32 vcc, s12, v6
    s_nop 1
    v_cndmask_b32 v24, v24, v240, vcc
    v_cndmask_b32 v25, v25, v241, vcc
    v_cndmask_b32 v26, v26, v242, vcc
    v_cndmask_b32 v27, v27, v243, vcc
    v_cndmask_b32 v28, v28, v244, vcc
    v_cndmask_b32 v29, v29, v245, vcc
    v_cndmask_b32 v30, v30, v246, vcc
    v_cndmask_b32 v31, v31, v247, vcc
    v_lshlrev_b32 v32, 16, v24
    v_and_b32 v33, 0xffff0000, v24
    v_lshlrev_b32 v34, 16, v25
    v_and_b32 v35, 0xffff0000, v25
    v_lshlrev_b32 v36, 16, v26
    v_and_b32 v37, 0xffff0000, v26
    v_lshlrev_b32 v38, 16, v27
    v_and_b32 v39, 0xffff0000, v27
    v_lshlrev_b32 v40, 16, v28
    v_and_b32 v41, 0xffff0000, v28
    v_lshlrev_b32 v42, 16, v29
    v_and_b32 v43, 0xffff0000, v29
    v_lshlrev_b32 v44, 16, v30
    v_and_b32 v45, 0xffff0000, v30
    v_lshlrev_b32 v46, 16, v31
    v_and_b32 v47, 0xffff0000, v31
    v_pk_mul_f32 v[32:33], v[32:33], v[50:51] op_sel_hi:[1,0]
    v_pk_mul_f32 v[34:35], v[34:35], v[50:51] op_sel_hi:[1,0]
    v_pk_mul_f32 v[36:37], v[36:37], v[50:51] op_sel_hi:[1,0]
    v_pk_mul_f32 v[38:39], v[38:39], v[50:51] op_sel_hi:[1,0]
    v_pk_mul_f32 v[40:41], v[40:41], v[50:51] op_sel_hi:[1,0]
    v_pk_mul_f32 v[42:43], v[42:43], v[50:51] op_sel_hi:[1,0]
    v_pk_mul_f32 v[44:45], v[44:45], v[50:51] op_sel_hi:[1,0]
    v_pk_mul_f32 v[46:47], v[46:47], v[50:51] op_sel_hi:[1,0]
    v_cvt_pk_bf16_f32 v33, v32, v33
    v_cvt_pk_bf16_f32 v35, v34, v35
    v_cvt_pk_bf16_f32 v37, v36, v37
    v_cvt_pk_bf16_f32 v39, v38, v39
    v_cvt_pk_bf16_f32 v41, v40, v41
    v_cvt_pk_bf16_f32 v43, v42, v43
    v_cvt_pk_bf16_f32 v45, v44, v45
    v_cvt_pk_bf16_f32 v47, v46, v47
    v_permlane32_swap_b32 v33, v37
    v_permlane32_swap_b32 v35, v39
    v_permlane32_swap_b32 v41, v45
    v_permlane32_swap_b32 v43, v47
    v_lshlrev_b32 v32, 16, v33
    v_and_b32 v33, 0xffff0000, v33
    v_lshlrev_b32 v34, 16, v35
    v_and_b32 v35, 0xffff0000, v35
    v_lshlrev_b32 v36, 16, v37
    v_and_b32 v37, 0xffff0000, v37
    v_lshlrev_b32 v38, 16, v39
    v_and_b32 v39, 0xffff0000, v39
    v_lshlrev_b32 v40, 16, v41
    v_and_b32 v41, 0xffff0000, v41
    v_lshlrev_b32 v42, 16, v43
    v_and_b32 v43, 0xffff0000, v43
    v_lshlrev_b32 v44, 16, v45
    v_and_b32 v45, 0xffff0000, v45
    v_lshlrev_b32 v46, 16, v47
    v_and_b32 v47, 0xffff0000, v47
    s_branch L_own_r1
L_end:
    s_endpgm
.section .rodata,"a"
.p2align 6
.amdhsa_kernel gated_mix__linear_kernel_hedgehog__moe_arch_mod__prompt_kernel
  .amdhsa_next_free_vgpr 256
  .amdhsa_next_free_sgpr 102
  .amdhsa_accum_offset 256
  .amdhsa_group_segment_fixed_size 0
  .amdhsa_kernarg_size 104
  .amdhsa_user_sgpr_count 2
  .amdhsa_user_sgpr_kernarg_segment_ptr 1
  .amdhsa_system_sgpr_workgroup_id_x 1
.end_amdhsa_kernel
```
